```python
import torch

def _softmax(x, axis=-1):
    return torch.softmax(x, dim=axis)
def _gelu(x):
    return torch.nn.functional.gelu(x, approximate="tanh")
def _silu(x):
    return torch.nn.functional.silu(x)
def _sigmoid(x):
    return torch.sigmoid(x)
def _layernorm(x, axis=-1, eps=1e-5):
    m = x.mean(dim=axis, keepdim=True)
    v = x.var(dim=axis, keepdim=True, unbiased=False)
    return (x - m) / torch.sqrt(v + eps)
def _scatter_add(tgt, idx, src, axis=0):
    return tgt.clone().index_add_(axis, idx, src)
def _segment_sum(src, seg, n):
    out = torch.zeros((n,) + src.shape[1:], dtype=src.dtype)
    return out.index_add_(0, seg, src)
def _pad(x, pw):
    flat = tuple(v for pair in reversed(pw) for v in pair)
    return torch.nn.functional.pad(x, flat)

kernel_name = 'recurrent_scan__sliding_block_cached__mixer_token_mlp__prompt'

def setup_inputs():

    _w = (lambda a: (lambda t: t.to(torch.bfloat16) if t.is_floating_point() else t)(torch.as_tensor(a)))
    def _A_setup():
        B, Sq, D = 1, 2048, 1024
        Hq, Hkv, Sk, Dh = 32, 4, 2048, 128
        assert Hq % Hkv == 0, (Hq, Hkv)
        return {
            "x": _w((lambda *s: torch.randn(*s, dtype=torch.bfloat16) * 0.05)(B, Sq, D)),
            "k_cache": _w((lambda *s: torch.randn(*s, dtype=torch.bfloat16) * 1.6)(B, Hkv, Sk, Dh)),
            "v_cache": _w((lambda *s: torch.randn(*s, dtype=torch.bfloat16) * 0.8)(B, Hkv, Sk, Dh)),
            "wq": _w((lambda *s: torch.randn(*s, dtype=torch.bfloat16) * 1.6)(D, Hq * Dh) * (D ** -0.5)),
            "wo": _w((lambda *s: torch.randn(*s, dtype=torch.bfloat16) * 0.8)(Hq * Dh, D) * ((Hq * Dh) ** -0.5)),
        }
    _A_in = _A_setup()

    def _B_setup():
        B, S, D, F = 1, 2048, 1024, 3584
        return {
            "x": _w((lambda *s: torch.randn(*s, dtype=torch.bfloat16) * 0.05)(B, S, D)),
            "w1": _w((lambda *s: torch.randn(*s, dtype=torch.bfloat16) * 1.6)(S, F) * (S ** -0.5)),
            "b1": _w((lambda *s: torch.randn(*s, dtype=torch.bfloat16) * 1.6)(F) * 0.02),
            "w2": _w((lambda *s: torch.randn(*s, dtype=torch.bfloat16) * 0.2)(F, S) * (F ** -0.5)),
            "b2": _w((lambda *s: torch.randn(*s, dtype=torch.bfloat16) * 0.2)(S) * 0.02),
        }
    _B_in = _B_setup()

    return {
        "A_x": _A_in["x"],
        "A_k_cache": _A_in["k_cache"],
        "A_v_cache": _A_in["v_cache"],
        "A_wq": _A_in["wq"],
        "A_wo": _A_in["wo"],
        "B_x": _B_in["x"],
        "B_w1": _B_in["w1"],
        "B_b1": _B_in["b1"],
        "B_w2": _B_in["w2"],
        "B_b2": _B_in["b2"],
    }

def reference(A_x, A_k_cache, A_v_cache, A_wq, A_wo, B_x, B_w1, B_b1, B_w2, B_b2):
    def _A_ref(x, k_cache, v_cache, wq, wo):
        B, Sq, D = x.shape
        Hq, Dh = 32, 128
        Hkv, Sk = k_cache.shape[1], k_cache.shape[2]
        W = min(4096, max(256, Sk // 4))
        rep = Hq // Hkv
        q = (lambda x, *d: x.permute(*d))((x @ wq).reshape(B, Sq, Hq, Dh), 0, 2, 1, 3)
        k = (lambda x, n, axis: torch.repeat_interleave(x, n, dim=axis))(k_cache[:, :, Sk - W:, :], rep, axis=1)
        v = (lambda x, n, axis: torch.repeat_interleave(x, n, dim=axis))(v_cache[:, :, Sk - W:, :], rep, axis=1)
        scores = torch.einsum("bhqd,bhkd->bhqk", q, k) * (Dh ** -0.5)
        p = _softmax(scores, axis=-1)
        o = torch.einsum("bhqk,bhkd->bhqd", p, v)
        return (lambda x, *d: x.permute(*d))(o, 0, 2, 1, 3).reshape(B, Sq, Hq * Dh) @ wo

    def _B_ref(x, w1, b1, w2, b2):
        B, S, D = x.shape
        h = _layernorm(x, axis=-1)
        u = torch.einsum("bsd,sf->bdf", h, w1) + b1
        u = _gelu(u)
        y = torch.einsum("bdf,fs->bds", u, w2) + b2
        return (lambda x, *d: x.permute(*d))(y, 0, 2, 1)

    x = A_x
    xn = _layernorm(x, axis=-1)
    s = _A_ref(xn, A_k_cache, A_v_cache, A_wq, A_wo)
    g = _silu(_B_ref(xn, B_w1, B_b1, B_w2, B_b2))
    return x + s * g
```

```asm
; @launch grid=(256,1,1) block=(256,1,1) lds=163840
.amdgcn_target "amdgcn-amd-amdhsa--gfx950"
.text
.globl recurrent_scan__sliding_block_cached__mixer_token_mlp__prompt_kernel
.p2align 8
.type recurrent_scan__sliding_block_cached__mixer_token_mlp__prompt_kernel,@function
recurrent_scan__sliding_block_cached__mixer_token_mlp__prompt_kernel:
    s_cmp_ge_u32 s2, 256
    s_cbranch_scc1 km_end
    s_load_dwordx16 s[40:55], s[0:1], 0
    s_and_b32 s3, s2, 1
    s_lshl_b32 s3, s3, 2
    s_bfe_u32 s82, s2, 0x20001
    s_or_b32 s3, s3, s82
    s_andn2_b32 s2, s2, 7
    s_or_b32 s2, s2, s3
    s_load_dwordx8 s[56:63], s[0:1], 64
    s_load_dwordx2 s[64:65], s[0:1], 96
    s_getpc_b64 s[4:5]
    v_and_b32 v1, 63, v0
    s_and_b32 s24, s4, 0xffffff00
    s_mov_b32 s25, s5
    s_mov_b32 s26, km_codeend - recurrent_scan__sliding_block_cached__mixer_token_mlp__prompt_kernel
    s_mov_b32 s27, 0x00020000
    v_lshlrev_b32 v30, 5, v0
    buffer_load_dword v31, v30, s[24:27], 0 offen
    v_lshrrev_b32 v7, 6, v0
    s_and_b32 s3, s2, 7
    v_readfirstlane_b32 s71, v7
    s_lshr_b32 s81, s2, 3
    s_lshr_b32 s82, s3, 1
    s_and_b32 s83, s3, 1
    s_lshl_b32 s83, s83, 2
    s_lshr_b32 s72, s71, 1
    s_and_b32 s73, s71, 1
    v_lshlrev_b32 v7, 4, v1
    s_lshr_b32 s84, s2, 2
    s_lshl_b32 s84, s84, 5
    s_and_b32 s85, s2, 3
    s_lshl_b32 s85, s85, 2
    s_add_u32 s84, s84, s85
    s_lshl_b32 s85, s73, 1
    s_add_u32 s84, s84, s85
    s_lshl_b32 s85, s72, 4
    s_add_u32 s84, s84, s85
    s_lshl_b32 s86, s84, 11
    s_lshr_b32 s74, s81, 3
    s_add_u32 s74, s74, s83
    s_and_b32 s75, s81, 7
    s_lshl_b32 s84, s82, 3
    s_add_u32 s75, s75, s84
    s_lshl_b32 s76, s82, 3
    s_cmp_eq_u32 s82, 3
    s_cselect_b32 s76, 22, s76
    s_lshr_b32 s84, s81, 2
    s_add_u32 s76, s76, s84
    s_and_b32 s77, s81, 3
    s_add_u32 s77, s77, s83
    s_and_b32 s78, s82, 1
    s_lshl_b32 s78, s78, 3
    s_lshl_b32 s85, s84, 2
    s_lshr_b32 s85, 0x51764320, s85
    s_and_b32 s85, s85, 7
    s_bitcmp1_b32 s2, 2
    s_cselect_b32 s85, s85, s84
    s_add_u32 s78, s78, s85
    s_mov_b32 s79, s77
    s_lshl_b32 s80, s78, 3
    s_add_u32 s80, s80, s79
    s_bfe_u32 s3, s2, 0x10002
    s_cmp_ge_u32 s2, 192
    s_cselect_b32 s84, s3, 0
    s_add_u32 s3, s3, s84
    v_lshrrev_b32 v160, 4, v1
    v_and_b32 v161, 15, v1
    v_lshlrev_b32 v162, 2, v160
    v_xor_b32 v162, v162, v161
    v_lshlrev_b32 v162, 4, v162
    v_lshl_add_u32 v24, v160, 8, v162
    s_lshl_b32 s68, s71, 12
    s_lshl_b32 s69, s71, 13
    s_mov_b32 s30, 4194304
    s_mov_b32 s31, 0x00020000
    s_waitcnt lgkmcnt(0)
    s_mov_b32 s28, s40
    s_mov_b32 s29, s41
    buffer_load_dwordx4 v[144:147], v7, s[28:31], s86 offen offset:0 nt
    buffer_load_dwordx4 v[148:151], v7, s[28:31], s86 offen offset:1024 nt
    buffer_load_dwordx4 v[152:155], v7, s[28:31], s86 offen offset:2048 nt
    buffer_load_dwordx4 v[156:159], v7, s[28:31], s86 offen offset:3072 nt
    s_mov_b32 s32, s62
    s_mov_b32 s33, s63
    s_mov_b32 s34, 0x100
    s_mov_b32 s35, 0x00020000
    s_or_b32 s84, s2, s71
    s_cmp_lg_u32 s84, 0
    s_cbranch_scc1 km_nonz
    s_memrealtime s[88:89]
    s_waitcnt lgkmcnt(0)
    s_or_b32 s84, s88, 1
    v_mov_b32 v162, s84
    v_mov_b32 v163, s89
    s_mov_b64 exec, 1
    buffer_store_dwordx2 v[162:163], off, s[32:35], 0 sc1
    s_mov_b64 exec, -1
km_nonz:
    s_lshl_b32 s84, s81, 2
    s_add_u32 s84, s84, s71
    s_lshl_b32 s84, s84, 10
    v_and_b32 v162, 7, v1
    v_lshlrev_b32 v162, 7, v162
    buffer_load_dword v31, v162, s[24:27], s84 offen
    s_lshl_b32 s84, s75, 8
    v_lshrrev_b32 v176, 4, v1
    v_and_b32 v177, 15, v1
    v_add_u32 v178, 0, v176
    v_lshlrev_b32 v178, 1, v178
    v_xor_b32 v178, v178, v177
    v_lshlrev_b32 v178, 4, v178
    v_add_u32 v179, 0, v176
    v_mul_u32_u24 v179, 8192, v179
    v_add3_u32 v2, v178, v179, s84
    v_add_u32 v178, 4, v176
    v_lshlrev_b32 v178, 1, v178
    v_xor_b32 v178, v178, v177
    v_lshlrev_b32 v178, 4, v178
    v_add_u32 v179, 4, v176
    v_mul_u32_u24 v179, 8192, v179
    v_add3_u32 v3, v178, v179, s84
    v_subrev_u32 v3, 1024, v3
    v_add_u32 v178, 0, v176
    v_lshlrev_b32 v178, 1, v178
    v_xor_b32 v178, v178, v177
    v_lshlrev_b32 v178, 4, v178
    v_add_u32 v179, 8, v176
    v_mul_u32_u24 v179, 8192, v179
    v_add3_u32 v4, v178, v179, s84
    v_subrev_u32 v4, 2048, v4
    v_add_u32 v178, 4, v176
    v_lshlrev_b32 v178, 1, v178
    v_xor_b32 v178, v178, v177
    v_lshlrev_b32 v178, 4, v178
    v_add_u32 v179, 12, v176
    v_mul_u32_u24 v179, 8192, v179
    v_add3_u32 v5, v178, v179, s84
    v_subrev_u32 v5, 3072, v5
    s_cmp_eq_u32 s3, 1
    s_cbranch_scc1 km_e_y
    s_mul_i32 s66, s71, 131072
    s_sub_u32 s66, s66, 524288
    s_mov_b32 s8, s46
    s_mov_b32 s9, s47
    s_mov_b32 s10, 0x800000
    s_mov_b32 s11, 0x00020000
    s_add_u32 m0, s68, 131072
    s_add_u32 s66, s66, 524288
    buffer_load_dwordx4 v2, s[8:11], s66 offen offset:0 lds
    buffer_load_dwordx4 v3, s[8:11], s66 offen offset:1024 lds
    buffer_load_dwordx4 v4, s[8:11], s66 offen offset:2048 lds
    buffer_load_dwordx4 v5, s[8:11], s66 offen offset:3072 lds
    s_add_u32 m0, s68, 147456
    s_add_u32 s66, s66, 524288
    buffer_load_dwordx4 v2, s[8:11], s66 offen offset:0 lds
    buffer_load_dwordx4 v3, s[8:11], s66 offen offset:1024 lds
    buffer_load_dwordx4 v4, s[8:11], s66 offen offset:2048 lds
    buffer_load_dwordx4 v5, s[8:11], s66 offen offset:3072 lds
    s_add_u32 m0, s68, 114688
    s_add_u32 s66, s66, 524288
    buffer_load_dwordx4 v2, s[8:11], s66 offen offset:0 lds
    buffer_load_dwordx4 v3, s[8:11], s66 offen offset:1024 lds
    buffer_load_dwordx4 v4, s[8:11], s66 offen offset:2048 lds
    buffer_load_dwordx4 v5, s[8:11], s66 offen offset:3072 lds
    v_mov_b32 v8, 0
    v_mov_b32 v9, 0
    v_mov_b32 v10, 0
    v_mov_b32 v11, 0
    v_mov_b32 v12, 0
    s_branch km_e_j
km_e_y:
    s_lshl_b32 s84, s76, 8
    v_lshrrev_b32 v176, 4, v1
    v_and_b32 v177, 15, v1
    v_add_u32 v178, 0, v176
    v_lshlrev_b32 v178, 1, v178
    v_xor_b32 v178, v178, v177
    v_lshlrev_b32 v178, 4, v178
    v_add_u32 v179, 0, v176
    v_mul_u32_u24 v179, 7168, v179
    v_add3_u32 v8, v178, v179, s84
    v_add_u32 v178, 4, v176
    v_lshlrev_b32 v178, 1, v178
    v_xor_b32 v178, v178, v177
    v_lshlrev_b32 v178, 4, v178
    v_add_u32 v179, 4, v176
    v_mul_u32_u24 v179, 7168, v179
    v_add3_u32 v9, v178, v179, s84
    v_subrev_u32 v9, 1024, v9
    v_add_u32 v178, 0, v176
    v_lshlrev_b32 v178, 1, v178
    v_xor_b32 v178, v178, v177
    v_lshlrev_b32 v178, 4, v178
    v_add_u32 v179, 8, v176
    v_mul_u32_u24 v179, 7168, v179
    v_add3_u32 v10, v178, v179, s84
    v_subrev_u32 v10, 2048, v10
    v_add_u32 v178, 4, v176
    v_lshlrev_b32 v178, 1, v178
    v_xor_b32 v178, v178, v177
    v_lshlrev_b32 v178, 4, v178
    v_add_u32 v179, 12, v176
    v_mul_u32_u24 v179, 7168, v179
    v_add3_u32 v11, v178, v179, s84
    v_subrev_u32 v11, 3072, v11
    s_lshl_b32 s84, s77, 1
    s_add_u32 s84, s84, s73
    s_lshl_b32 s84, s84, 12
    v_add_u32 v12, s84, v7
    v_bfe_u32 v176, v12, 7, 3
    v_xor_b32 v176, 3, v176
    v_min_u32 v176, 1, v176
    v_add_u32 v176, -1, v176
    v_and_b32 v176, 0x3fffe80, v176
    v_add_u32 v12, v12, v176
    s_mul_i32 s66, s71, 229376
    s_add_u32 s66, s66, 0xfff3c000
    s_mov_b32 s8, s52
    s_mov_b32 s9, s53
    s_mov_b32 s10, 0xe00000
    s_mov_b32 s11, 0x00020000
    s_add_u32 m0, s69, 131072
    s_add_u32 s66, s66, 802816
    buffer_load_dwordx4 v8, s[8:11], s66 offen offset:0 lds
    buffer_load_dwordx4 v9, s[8:11], s66 offen offset:1024 lds
    buffer_load_dwordx4 v10, s[8:11], s66 offen offset:2048 lds
    buffer_load_dwordx4 v11, s[8:11], s66 offen offset:3072 lds
    s_add_u32 m0, s69, 135168
    s_add_u32 s66, s66, 114688
    buffer_load_dwordx4 v8, s[8:11], s66 offen offset:0 lds
    buffer_load_dwordx4 v9, s[8:11], s66 offen offset:1024 lds
    buffer_load_dwordx4 v10, s[8:11], s66 offen offset:2048 lds
    buffer_load_dwordx4 v11, s[8:11], s66 offen offset:3072 lds
    s_add_u32 m0, s69, 0
    s_add_u32 s66, s66, 802816
    buffer_load_dwordx4 v8, s[8:11], s66 offen offset:0 lds
    buffer_load_dwordx4 v9, s[8:11], s66 offen offset:1024 lds
    buffer_load_dwordx4 v10, s[8:11], s66 offen offset:2048 lds
    buffer_load_dwordx4 v11, s[8:11], s66 offen offset:3072 lds
km_e_j:
    s_lshl_b32 s84, s74, 2
    s_add_u32 s84, s84, s71
    s_lshl_b32 s84, s84, 12
    v_add_u32 v6, s84, v7
    s_lshl_b32 s84, s82, 19
    s_add_u32 s84, s84, 393216
    s_add_u32 s16, s42, s84
    s_addc_u32 s17, s43, 0
    s_mov_b32 s18, 0x20000
    s_mov_b32 s19, 0x00020000
    s_add_u32 s20, s44, s84
    s_addc_u32 s21, s45, 0
    s_mov_b32 s22, 0x20000
    s_mov_b32 s23, 0x00020000
    s_mov_b32 s67, 0
    s_mov_b32 s12, s64
    s_mov_b32 s13, s65
    s_mov_b32 s14, 0x4400000
    s_mov_b32 s15, 0x00020000
    s_add_u32 s24, s64, 0x400000
    s_addc_u32 s25, s65, 0
    s_mov_b32 s26, 0x4400000
    s_mov_b32 s27, 0x00020000
    s_add_u32 s36, s64, 0x2800000
    s_addc_u32 s37, s65, 0
    s_mov_b32 s38, 0x8000
    s_mov_b32 s39, 0x00020000
    s_mul_i32 s84, s71, 4224
    s_add_u32 s84, s84, 65536
    v_add_u32 v168, s84, v7
    v_and_b32 v162, 7, v1
    v_lshrrev_b32 v163, 3, v1
    s_lshl_b32 s84, s71, 5
    v_add_u32 v163, s84, v163
    v_mul_u32_u24 v169, 2112, v162
    v_lshrrev_b32 v170, 2, v163
    v_lshl_add_u32 v169, v170, 6, v169
    v_and_b32 v163, 3, v163
    v_lshl_add_u32 v169, v163, 3, v169
    v_add_u32 v169, 65536, v169
    v_lshlrev_b32 v170, 17, v170
    v_lshl_add_u32 v170, v163, 8, v170
    v_lshl_add_u32 v170, v162, 4, v170
    s_lshr_b32 s84, s2, 2
    s_lshr_b32 s85, s2, 1
    s_lshl_b32 s85, s85, 10
    s_and_b32 s86, s2, 3
    s_and_b32 s87, s2, 1
    s_lshl_b32 s87, s87, 7
    s_add_u32 s85, s85, s87
    v_add_u32 v170, s85, v170
    v_lshrrev_b32 v162, 2, v161
    v_and_b32 v163, 3, v161
    s_lshl_b32 s85, s71, 4
    v_add_u32 v164, s85, v160
    v_mul_u32_u24 v171, 2112, v162
    v_lshl_add_u32 v171, v164, 5, v171
    v_lshl_add_u32 v171, v163, 3, v171
    v_add_u32 v171, 65536, v171
    v_lshlrev_b32 v172, 10, v164
    v_lshl_add_u32 v172, v161, 4, v172
    s_lshl_b32 s84, s84, 16
    s_lshl_b32 s86, s86, 8
    s_add_u32 s84, s84, s86
    v_add_u32 v172, s84, v172
    v_bfe_u32 v162, v6, 7, 3
    v_xor_b32 v162, 3, v162
    v_min_u32 v162, 1, v162
    v_add_u32 v162, -1, v162
    v_and_b32 v162, 0x3fffe80, v162
    v_add_u32 v6, v6, v162
    v_bfe_u32 v162, v170, 7, 3
    v_xor_b32 v162, 3, v162
    v_min_u32 v162, 1, v162
    v_add_u32 v162, -1, v162
    v_and_b32 v162, 0x3fffe80, v162
    v_add_u32 v170, v170, v162
    v_bfe_u32 v162, v172, 7, 3
    v_xor_b32 v162, 3, v162
    v_min_u32 v162, 1, v162
    v_add_u32 v162, -1, v162
    v_and_b32 v162, 0x3fffe80, v162
    v_add_u32 v172, v172, v162
    s_waitcnt vmcnt(13)
    s_cmp_lg_u32 s71, 0
    s_cbranch_scc1 km_np1
    buffer_load_dwordx2 v[166:167], off, s[32:35], 0 sc1
km_np1:
    v_mov_b64 v[48:49], v[144:145]
    v_mov_b64 v[50:51], v[146:147]
    v_mov_b64 v[52:53], v[148:149]
    v_mov_b64 v[54:55], v[150:151]
    v_mov_b64 v[56:57], v[152:153]
    v_mov_b64 v[58:59], v[154:155]
    v_mov_b64 v[60:61], v[156:157]
    v_mov_b64 v[62:63], v[158:159]
    s_call_b64 s[6:7], km_ln
    ds_write_b128 v168, v[48:51] offset:0
    ds_write_b128 v168, v[52:55] offset:1024
    ds_write_b128 v168, v[56:59] offset:2112
    ds_write_b128 v168, v[60:63] offset:3136
    s_waitcnt lgkmcnt(0)
    s_barrier
    ds_read2_b64 v[144:147], v169 offset0:0 offset1:4
    ds_read2_b64 v[148:151], v169 offset0:16 offset1:20
    ds_read2_b64 v[152:155], v169 offset0:32 offset1:36
    ds_read2_b64 v[156:159], v169 offset0:48 offset1:52
    s_mov_b32 s84, 0
    s_waitcnt lgkmcnt(3)
    buffer_store_dwordx4 v[144:147], v170, s[12:15], s84 offen sc1
    s_mov_b32 s84, 262144
    s_waitcnt lgkmcnt(2)
    buffer_store_dwordx4 v[148:151], v170, s[12:15], s84 offen sc1
    s_mov_b32 s84, 524288
    s_waitcnt lgkmcnt(1)
    buffer_store_dwordx4 v[152:155], v170, s[12:15], s84 offen sc1
    s_mov_b32 s84, 786432
    s_waitcnt lgkmcnt(0)
    buffer_store_dwordx4 v[156:159], v170, s[12:15], s84 offen sc1
    s_call_b64 s[6:7], km_ln
    ds_write_b128 v168, v[48:51] offset:16896
    ds_write_b128 v168, v[52:55] offset:17920
    ds_write_b128 v168, v[56:59] offset:19008
    ds_write_b128 v168, v[60:63] offset:20032
    s_waitcnt vmcnt(0)
    v_mov_b32 v162, 99328
    s_cmp_lg_u32 s71, 0
    s_cbranch_scc1 km_np2
    s_mov_b32 s83, 0
km_np3:
    v_cmp_ne_u32 vcc, 0, v166
    s_add_u32 s83, s83, 1
    s_cbranch_vccnz km_np4
    s_cmp_gt_u32 s83, 0x20000
    s_cbranch_scc1 km_np4
    buffer_load_dwordx2 v[166:167], off, s[32:35], 0 sc1
    s_waitcnt vmcnt(0)
    s_branch km_np3
km_np4:
    ds_write_b64 v162, v[166:167]
    v_readfirstlane_b32 s50, v166
    v_readfirstlane_b32 s51, v167
km_np2:
    s_waitcnt lgkmcnt(0)
    s_barrier
    ds_read_b64 v[166:167], v162
    ds_read_b64_tr_b16 v[144:145], v171 offset:16896
    ds_read_b64_tr_b16 v[146:147], v171 offset:25344
    ds_read_b64_tr_b16 v[148:149], v171 offset:17024
    ds_read_b64_tr_b16 v[150:151], v171 offset:25472
    ds_read_b64_tr_b16 v[152:153], v171 offset:17152
    ds_read_b64_tr_b16 v[154:155], v171 offset:25600
    ds_read_b64_tr_b16 v[156:157], v171 offset:17280
    ds_read_b64_tr_b16 v[158:159], v171 offset:25728
    s_lshl_b32 s82, s2, 3
    s_add_u32 s82, s82, 0
    v_mov_b32 v248, s50
    v_mov_b32 v249, s51
    v_lshlrev_b32 v250, 11, v0
    v_cmp_gt_u32 vcc, 4, v0
    s_and_saveexec_b64 s[84:85], vcc
    s_cbranch_execz 1f
    buffer_store_dwordx2 v[248:249], v250, s[36:39], s82 offen sc1
1:
    s_mov_b64 exec, s[84:85]
    s_mov_b32 s84, 0
    s_waitcnt lgkmcnt(6)
    buffer_store_dwordx4 v[144:147], v172, s[24:27], s84 offen sc1
    s_mov_b32 s84, 4096
    s_waitcnt lgkmcnt(4)
    buffer_store_dwordx4 v[148:151], v172, s[24:27], s84 offen sc1
    s_mov_b32 s84, 8192
    s_waitcnt lgkmcnt(2)
    buffer_store_dwordx4 v[152:155], v172, s[24:27], s84 offen sc1
    s_mov_b32 s84, 12288
    s_waitcnt lgkmcnt(0)
    buffer_store_dwordx4 v[156:159], v172, s[24:27], s84 offen sc1
    v_readfirstlane_b32 s50, v166
    v_readfirstlane_b32 s51, v167
    s_cmp_lg_u32 s3, 0
    s_cbranch_scc1 km_yprog
    s_branch km_sprog
km_ln:
    v_lshlrev_b32 v64, 16, v48
    v_and_b32 v65, 0xffff0000, v48
    v_lshlrev_b32 v80, 16, v56
    v_and_b32 v81, 0xffff0000, v56
    v_lshlrev_b32 v66, 16, v49
    v_and_b32 v67, 0xffff0000, v49
    v_lshlrev_b32 v82, 16, v57
    v_and_b32 v83, 0xffff0000, v57
    v_lshlrev_b32 v68, 16, v50
    v_and_b32 v69, 0xffff0000, v50
    v_lshlrev_b32 v84, 16, v58
    v_and_b32 v85, 0xffff0000, v58
    v_lshlrev_b32 v70, 16, v51
    v_and_b32 v71, 0xffff0000, v51
    v_lshlrev_b32 v86, 16, v59
    v_and_b32 v87, 0xffff0000, v59
    v_lshlrev_b32 v72, 16, v52
    v_and_b32 v73, 0xffff0000, v52
    v_lshlrev_b32 v88, 16, v60
    v_and_b32 v89, 0xffff0000, v60
    v_lshlrev_b32 v74, 16, v53
    v_and_b32 v75, 0xffff0000, v53
    v_lshlrev_b32 v90, 16, v61
    v_and_b32 v91, 0xffff0000, v61
    v_lshlrev_b32 v76, 16, v54
    v_and_b32 v77, 0xffff0000, v54
    v_lshlrev_b32 v92, 16, v62
    v_and_b32 v93, 0xffff0000, v62
    v_lshlrev_b32 v78, 16, v55
    v_and_b32 v79, 0xffff0000, v55
    v_lshlrev_b32 v94, 16, v63
    v_and_b32 v95, 0xffff0000, v63
    v_pk_add_f32 v[136:137], v[64:65], v[66:67]
    v_pk_add_f32 v[138:139], v[80:81], v[82:83]
    v_pk_add_f32 v[136:137], v[136:137], v[68:69]
    v_pk_add_f32 v[138:139], v[138:139], v[84:85]
    v_pk_add_f32 v[136:137], v[136:137], v[70:71]
    v_pk_add_f32 v[138:139], v[138:139], v[86:87]
    v_pk_add_f32 v[136:137], v[136:137], v[72:73]
    v_pk_add_f32 v[138:139], v[138:139], v[88:89]
    v_pk_add_f32 v[136:137], v[136:137], v[74:75]
    v_pk_add_f32 v[138:139], v[138:139], v[90:91]
    v_pk_add_f32 v[136:137], v[136:137], v[76:77]
    v_pk_add_f32 v[138:139], v[138:139], v[92:93]
    v_pk_add_f32 v[136:137], v[136:137], v[78:79]
    v_pk_add_f32 v[138:139], v[138:139], v[94:95]
    v_add_f32 v128, v136, v137
    v_add_f32 v129, v138, v139
    s_nop 0
    v_add_f32_dpp v130, v128, v128 quad_perm:[1,0,3,2] row_mask:0xf bank_mask:0xf
    v_add_f32_dpp v131, v129, v129 quad_perm:[1,0,3,2] row_mask:0xf bank_mask:0xf
    s_nop 0
    v_add_f32_dpp v128, v130, v130 quad_perm:[2,3,0,1] row_mask:0xf bank_mask:0xf
    v_add_f32_dpp v129, v131, v131 quad_perm:[2,3,0,1] row_mask:0xf bank_mask:0xf
    s_nop 0
    v_add_f32_dpp v130, v128, v128 row_half_mirror row_mask:0xf bank_mask:0xf
    v_add_f32_dpp v131, v129, v129 row_half_mirror row_mask:0xf bank_mask:0xf
    s_nop 0
    v_add_f32_dpp v128, v130, v130 row_mirror row_mask:0xf bank_mask:0xf
    v_add_f32_dpp v129, v131, v131 row_mirror row_mask:0xf bank_mask:0xf
    v_mov_b64 v[130:131], v[128:129]
    s_nop 1
    v_permlane16_swap_b32 v128, v130
    v_permlane16_swap_b32 v129, v131
    s_nop 0
    v_pk_add_f32 v[128:129], v[128:129], v[130:131]
    v_mov_b64 v[130:131], v[128:129]
    s_nop 1
    v_permlane32_swap_b32 v128, v130
    v_permlane32_swap_b32 v129, v131
    s_nop 0
    v_pk_add_f32 v[128:129], v[128:129], v[130:131]
    v_mul_f32 v132, 0x3a800000, v128
    v_mul_f32 v133, 0x3a800000, v129
    v_pk_add_f32 v[96:97], v[64:65], v[132:133] op_sel_hi:[1,0] neg_lo:[0,1] neg_hi:[0,1]
    v_pk_add_f32 v[112:113], v[80:81], v[132:133] op_sel:[0,1] op_sel_hi:[1,1] neg_lo:[0,1] neg_hi:[0,1]
    v_pk_add_f32 v[98:99], v[66:67], v[132:133] op_sel_hi:[1,0] neg_lo:[0,1] neg_hi:[0,1]
    v_pk_add_f32 v[114:115], v[82:83], v[132:133] op_sel:[0,1] op_sel_hi:[1,1] neg_lo:[0,1] neg_hi:[0,1]
    v_pk_add_f32 v[100:101], v[68:69], v[132:133] op_sel_hi:[1,0] neg_lo:[0,1] neg_hi:[0,1]
    v_pk_add_f32 v[116:117], v[84:85], v[132:133] op_sel:[0,1] op_sel_hi:[1,1] neg_lo:[0,1] neg_hi:[0,1]
    v_pk_add_f32 v[102:103], v[70:71], v[132:133] op_sel_hi:[1,0] neg_lo:[0,1] neg_hi:[0,1]
    v_pk_add_f32 v[118:119], v[86:87], v[132:133] op_sel:[0,1] op_sel_hi:[1,1] neg_lo:[0,1] neg_hi:[0,1]
    v_pk_add_f32 v[104:105], v[72:73], v[132:133] op_sel_hi:[1,0] neg_lo:[0,1] neg_hi:[0,1]
    v_pk_add_f32 v[120:121], v[88:89], v[132:133] op_sel:[0,1] op_sel_hi:[1,1] neg_lo:[0,1] neg_hi:[0,1]
    v_pk_add_f32 v[106:107], v[74:75], v[132:133] op_sel_hi:[1,0] neg_lo:[0,1] neg_hi:[0,1]
    v_pk_add_f32 v[122:123], v[90:91], v[132:133] op_sel:[0,1] op_sel_hi:[1,1] neg_lo:[0,1] neg_hi:[0,1]
    v_pk_add_f32 v[108:109], v[76:77], v[132:133] op_sel_hi:[1,0] neg_lo:[0,1] neg_hi:[0,1]
    v_pk_add_f32 v[124:125], v[92:93], v[132:133] op_sel:[0,1] op_sel_hi:[1,1] neg_lo:[0,1] neg_hi:[0,1]
    v_pk_add_f32 v[110:111], v[78:79], v[132:133] op_sel_hi:[1,0] neg_lo:[0,1] neg_hi:[0,1]
    v_pk_add_f32 v[126:127], v[94:95], v[132:133] op_sel:[0,1] op_sel_hi:[1,1] neg_lo:[0,1] neg_hi:[0,1]
    v_pk_mul_f32 v[136:137], v[96:97], v[96:97]
    v_pk_mul_f32 v[138:139], v[112:113], v[112:113]
    v_pk_fma_f32 v[136:137], v[98:99], v[98:99], v[136:137]
    v_pk_fma_f32 v[138:139], v[114:115], v[114:115], v[138:139]
    v_pk_fma_f32 v[136:137], v[100:101], v[100:101], v[136:137]
    v_pk_fma_f32 v[138:139], v[116:117], v[116:117], v[138:139]
    v_pk_fma_f32 v[136:137], v[102:103], v[102:103], v[136:137]
    v_pk_fma_f32 v[138:139], v[118:119], v[118:119], v[138:139]
    v_pk_fma_f32 v[136:137], v[104:105], v[104:105], v[136:137]
    v_pk_fma_f32 v[138:139], v[120:121], v[120:121], v[138:139]
    v_pk_fma_f32 v[136:137], v[106:107], v[106:107], v[136:137]
    v_pk_fma_f32 v[138:139], v[122:123], v[122:123], v[138:139]
    v_pk_fma_f32 v[136:137], v[108:109], v[108:109], v[136:137]
    v_pk_fma_f32 v[138:139], v[124:125], v[124:125], v[138:139]
    v_pk_fma_f32 v[136:137], v[110:111], v[110:111], v[136:137]
    v_pk_fma_f32 v[138:139], v[126:127], v[126:127], v[138:139]
    v_cvt_pk_bf16_f32 v130, v132, v133
    v_lshlrev_b32 v132, 16, v130
    v_and_b32 v133, 0xffff0000, v130
    v_add_f32 v128, v136, v137
    v_add_f32 v129, v138, v139
    s_nop 0
    v_add_f32_dpp v130, v128, v128 quad_perm:[1,0,3,2] row_mask:0xf bank_mask:0xf
    v_add_f32_dpp v131, v129, v129 quad_perm:[1,0,3,2] row_mask:0xf bank_mask:0xf
    s_nop 0
    v_add_f32_dpp v128, v130, v130 quad_perm:[2,3,0,1] row_mask:0xf bank_mask:0xf
    v_add_f32_dpp v129, v131, v131 quad_perm:[2,3,0,1] row_mask:0xf bank_mask:0xf
    s_nop 0
    v_add_f32_dpp v130, v128, v128 row_half_mirror row_mask:0xf bank_mask:0xf
    v_add_f32_dpp v131, v129, v129 row_half_mirror row_mask:0xf bank_mask:0xf
    s_nop 0
    v_add_f32_dpp v128, v130, v130 row_mirror row_mask:0xf bank_mask:0xf
    v_add_f32_dpp v129, v131, v131 row_mirror row_mask:0xf bank_mask:0xf
    v_mov_b64 v[130:131], v[128:129]
    s_nop 1
    v_permlane16_swap_b32 v128, v130
    v_permlane16_swap_b32 v129, v131
    s_nop 0
    v_pk_add_f32 v[128:129], v[128:129], v[130:131]
    v_mov_b64 v[130:131], v[128:129]
    s_nop 1
    v_permlane32_swap_b32 v128, v130
    v_permlane32_swap_b32 v129, v131
    s_nop 0
    v_pk_add_f32 v[128:129], v[128:129], v[130:131]
    v_mul_f32 v134, 0x3a800000, v128
    v_mul_f32 v135, 0x3a800000, v129
    v_cvt_pk_bf16_f32 v130, v134, v135
    v_lshlrev_b32 v134, 16, v130
    v_and_b32 v135, 0xffff0000, v130
    v_add_f32 v134, 0x3727c5ac, v134
    v_add_f32 v135, 0x3727c5ac, v135
    v_cvt_pk_bf16_f32 v130, v134, v135
    v_lshlrev_b32 v134, 16, v130
    v_and_b32 v135, 0xffff0000, v130
    v_sqrt_f32 v134, v134
    v_sqrt_f32 v135, v135
    v_pk_add_f32 v[96:97], v[64:65], v[132:133] op_sel_hi:[1,0] neg_lo:[0,1] neg_hi:[0,1]
    v_pk_add_f32 v[112:113], v[80:81], v[132:133] op_sel:[0,1] op_sel_hi:[1,1] neg_lo:[0,1] neg_hi:[0,1]
    v_pk_add_f32 v[98:99], v[66:67], v[132:133] op_sel_hi:[1,0] neg_lo:[0,1] neg_hi:[0,1]
    v_pk_add_f32 v[114:115], v[82:83], v[132:133] op_sel:[0,1] op_sel_hi:[1,1] neg_lo:[0,1] neg_hi:[0,1]
    v_pk_add_f32 v[100:101], v[68:69], v[132:133] op_sel_hi:[1,0] neg_lo:[0,1] neg_hi:[0,1]
    v_pk_add_f32 v[116:117], v[84:85], v[132:133] op_sel:[0,1] op_sel_hi:[1,1] neg_lo:[0,1] neg_hi:[0,1]
    v_pk_add_f32 v[102:103], v[70:71], v[132:133] op_sel_hi:[1,0] neg_lo:[0,1] neg_hi:[0,1]
    v_pk_add_f32 v[118:119], v[86:87], v[132:133] op_sel:[0,1] op_sel_hi:[1,1] neg_lo:[0,1] neg_hi:[0,1]
    v_pk_add_f32 v[104:105], v[72:73], v[132:133] op_sel_hi:[1,0] neg_lo:[0,1] neg_hi:[0,1]
    v_pk_add_f32 v[120:121], v[88:89], v[132:133] op_sel:[0,1] op_sel_hi:[1,1] neg_lo:[0,1] neg_hi:[0,1]
    v_pk_add_f32 v[106:107], v[74:75], v[132:133] op_sel_hi:[1,0] neg_lo:[0,1] neg_hi:[0,1]
    v_pk_add_f32 v[122:123], v[90:91], v[132:133] op_sel:[0,1] op_sel_hi:[1,1] neg_lo:[0,1] neg_hi:[0,1]
    v_pk_add_f32 v[108:109], v[76:77], v[132:133] op_sel_hi:[1,0] neg_lo:[0,1] neg_hi:[0,1]
    v_pk_add_f32 v[124:125], v[92:93], v[132:133] op_sel:[0,1] op_sel_hi:[1,1] neg_lo:[0,1] neg_hi:[0,1]
    v_pk_add_f32 v[110:111], v[78:79], v[132:133] op_sel_hi:[1,0] neg_lo:[0,1] neg_hi:[0,1]
    v_pk_add_f32 v[126:127], v[94:95], v[132:133] op_sel:[0,1] op_sel_hi:[1,1] neg_lo:[0,1] neg_hi:[0,1]
    v_cvt_pk_bf16_f32 v130, v134, v135
    v_lshlrev_b32 v134, 16, v130
    v_and_b32 v135, 0xffff0000, v130
    v_rcp_f32 v134, v134
    v_rcp_f32 v135, v135
    v_cvt_pk_bf16_f32 v48, v96, v97
    v_cvt_pk_bf16_f32 v56, v112, v113
    v_cvt_pk_bf16_f32 v49, v98, v99
    v_cvt_pk_bf16_f32 v57, v114, v115
    v_cvt_pk_bf16_f32 v50, v100, v101
    v_cvt_pk_bf16_f32 v58, v116, v117
    v_cvt_pk_bf16_f32 v51, v102, v103
    v_cvt_pk_bf16_f32 v59, v118, v119
    v_cvt_pk_bf16_f32 v52, v104, v105
    v_cvt_pk_bf16_f32 v60, v120, v121
    v_cvt_pk_bf16_f32 v53, v106, v107
    v_cvt_pk_bf16_f32 v61, v122, v123
    v_cvt_pk_bf16_f32 v54, v108, v109
    v_cvt_pk_bf16_f32 v62, v124, v125
    v_cvt_pk_bf16_f32 v55, v110, v111
    v_cvt_pk_bf16_f32 v63, v126, v127
    v_lshlrev_b32 v96, 16, v48
    v_and_b32 v97, 0xffff0000, v48
    v_lshlrev_b32 v112, 16, v56
    v_and_b32 v113, 0xffff0000, v56
    v_lshlrev_b32 v98, 16, v49
    v_and_b32 v99, 0xffff0000, v49
    v_lshlrev_b32 v114, 16, v57
    v_and_b32 v115, 0xffff0000, v57
    v_lshlrev_b32 v100, 16, v50
    v_and_b32 v101, 0xffff0000, v50
    v_lshlrev_b32 v116, 16, v58
    v_and_b32 v117, 0xffff0000, v58
    v_lshlrev_b32 v102, 16, v51
    v_and_b32 v103, 0xffff0000, v51
    v_lshlrev_b32 v118, 16, v59
    v_and_b32 v119, 0xffff0000, v59
    v_lshlrev_b32 v104, 16, v52
    v_and_b32 v105, 0xffff0000, v52
    v_lshlrev_b32 v120, 16, v60
    v_and_b32 v121, 0xffff0000, v60
    v_lshlrev_b32 v106, 16, v53
    v_and_b32 v107, 0xffff0000, v53
    v_lshlrev_b32 v122, 16, v61
    v_and_b32 v123, 0xffff0000, v61
    v_lshlrev_b32 v108, 16, v54
    v_and_b32 v109, 0xffff0000, v54
    v_lshlrev_b32 v124, 16, v62
    v_and_b32 v125, 0xffff0000, v62
    v_lshlrev_b32 v110, 16, v55
    v_and_b32 v111, 0xffff0000, v55
    v_lshlrev_b32 v126, 16, v63
    v_and_b32 v127, 0xffff0000, v63
    v_pk_mul_f32 v[96:97], v[96:97], v[134:135] op_sel_hi:[1,0]
    v_pk_mul_f32 v[112:113], v[112:113], v[134:135] op_sel:[0,1] op_sel_hi:[1,1]
    v_pk_mul_f32 v[98:99], v[98:99], v[134:135] op_sel_hi:[1,0]
    v_pk_mul_f32 v[114:115], v[114:115], v[134:135] op_sel:[0,1] op_sel_hi:[1,1]
    v_pk_mul_f32 v[100:101], v[100:101], v[134:135] op_sel_hi:[1,0]
    v_pk_mul_f32 v[116:117], v[116:117], v[134:135] op_sel:[0,1] op_sel_hi:[1,1]
    v_pk_mul_f32 v[102:103], v[102:103], v[134:135] op_sel_hi:[1,0]
    v_pk_mul_f32 v[118:119], v[118:119], v[134:135] op_sel:[0,1] op_sel_hi:[1,1]
    v_pk_mul_f32 v[104:105], v[104:105], v[134:135] op_sel_hi:[1,0]
    v_pk_mul_f32 v[120:121], v[120:121], v[134:135] op_sel:[0,1] op_sel_hi:[1,1]
    v_pk_mul_f32 v[106:107], v[106:107], v[134:135] op_sel_hi:[1,0]
    v_pk_mul_f32 v[122:123], v[122:123], v[134:135] op_sel:[0,1] op_sel_hi:[1,1]
    v_pk_mul_f32 v[108:109], v[108:109], v[134:135] op_sel_hi:[1,0]
    v_pk_mul_f32 v[124:125], v[124:125], v[134:135] op_sel:[0,1] op_sel_hi:[1,1]
    v_pk_mul_f32 v[110:111], v[110:111], v[134:135] op_sel_hi:[1,0]
    v_pk_mul_f32 v[126:127], v[126:127], v[134:135] op_sel:[0,1] op_sel_hi:[1,1]
    v_cvt_pk_bf16_f32 v48, v96, v97
    v_cvt_pk_bf16_f32 v56, v112, v113
    v_cvt_pk_bf16_f32 v49, v98, v99
    v_cvt_pk_bf16_f32 v57, v114, v115
    v_cvt_pk_bf16_f32 v50, v100, v101
    v_cvt_pk_bf16_f32 v58, v116, v117
    v_cvt_pk_bf16_f32 v51, v102, v103
    v_cvt_pk_bf16_f32 v59, v118, v119
    v_cvt_pk_bf16_f32 v52, v104, v105
    v_cvt_pk_bf16_f32 v60, v120, v121
    v_cvt_pk_bf16_f32 v53, v106, v107
    v_cvt_pk_bf16_f32 v61, v122, v123
    v_cvt_pk_bf16_f32 v54, v108, v109
    v_cvt_pk_bf16_f32 v62, v124, v125
    v_cvt_pk_bf16_f32 v55, v110, v111
    v_cvt_pk_bf16_f32 v63, v126, v127
    s_setpc_b64 s[6:7]
km_sprog:
    v_and_b32 v165, 31, v1
    v_lshlrev_b32 v165, 3, v165
    s_and_b32 s84, s81, 3
    s_lshl_b32 s84, s84, 11
    s_lshl_b32 s85, s74, 8
    s_add_u32 s84, s84, s85
    s_add_u32 s84, s84, 0
    v_add_u32 v30, s84, v165
    v_lshrrev_b32 v186, 4, v1
    v_and_b32 v187, 15, v1
    v_lshrrev_b32 v188, 2, v187
    v_and_b32 v189, 3, v187
    v_mov_b32 v26, 0
    v_mov_b32 v27, 0
    v_lshl_add_u32 v181, v186, 2, v188
    v_and_b32 v182, 7, v181
    s_lshl_b32 s84, s72, 2
    v_xor_b32 v182, s84, v182
    v_lshlrev_b32 v181, 8, v181
    v_lshl_add_u32 v181, v189, 3, v181
    s_lshl_b32 s84, s72, 14
    v_add_u32 v181, s84, v181
    v_xor_b32 v183, 0, v182
    v_lshl_add_u32 v32, v183, 5, v181
    v_add_u32 v40, 98304, v32
    v_xor_b32 v183, 1, v182
    v_lshl_add_u32 v33, v183, 5, v181
    v_add_u32 v41, 98304, v33
    v_xor_b32 v183, 2, v182
    v_lshl_add_u32 v34, v183, 5, v181
    v_add_u32 v42, 98304, v34
    v_xor_b32 v183, 3, v182
    v_lshl_add_u32 v35, v183, 5, v181
    v_add_u32 v43, 98304, v35
    v_xor_b32 v183, 4, v182
    v_lshl_add_u32 v36, v183, 5, v181
    v_add_u32 v44, 98304, v36
    v_xor_b32 v183, 5, v182
    v_lshl_add_u32 v37, v183, 5, v181
    v_add_u32 v45, 98304, v37
    v_xor_b32 v183, 6, v182
    v_lshl_add_u32 v38, v183, 5, v181
    v_add_u32 v46, 98304, v38
    v_xor_b32 v183, 7, v182
    v_lshl_add_u32 v39, v183, 5, v181
    v_add_u32 v47, 98304, v39
    s_lshl_b32 s84, s72, 14
    v_subrev_u32 v40, s84, v40
    v_subrev_u32 v41, s84, v41
    v_subrev_u32 v42, s84, v42
    v_subrev_u32 v43, s84, v43
    v_subrev_u32 v44, s84, v44
    v_subrev_u32 v45, s84, v45
    v_subrev_u32 v46, s84, v46
    v_subrev_u32 v47, s84, v47
    s_waitcnt vmcnt(0)
    s_barrier
    s_cmp_lg_u32 s71, 1
    s_cbranch_scc1 km_px0
    buffer_load_dwordx2 v[252:253], v30, s[36:39], 0 offen sc1
km_px0:
    s_lshl_b32 s82, s2, 3
    s_add_u32 s82, s82, 8192
    v_mov_b32 v248, s50
    v_mov_b32 v249, s51
    v_lshlrev_b32 v250, 11, v0
    v_cmp_gt_u32 vcc, 4, v0
    s_and_saveexec_b64 s[84:85], vcc
    s_cbranch_execz 1f
    buffer_store_dwordx2 v[248:249], v250, s[36:39], s82 offen sc1
1:
    s_mov_b64 exec, s[84:85]
    s_add_u32 s24, s64, 0x1000000
    s_addc_u32 s25, s65, 0
    s_mov_b32 s26, 0x5000000
    s_mov_b32 s27, 0x00020000
    ds_read_b64_tr_b16 v[48:49], v40 offset:32768
    ds_read_b64_tr_b16 v[50:51], v40 offset:36864
    ds_read_b64_tr_b16 v[52:53], v41 offset:32768
    ds_read_b64_tr_b16 v[54:55], v41 offset:36864
    ds_read_b64_tr_b16 v[56:57], v42 offset:32768
    ds_read_b64_tr_b16 v[58:59], v42 offset:36864
    ds_read_b64_tr_b16 v[60:61], v43 offset:32768
    ds_read_b64_tr_b16 v[62:63], v43 offset:36864
    ds_read_b64_tr_b16 v[64:65], v44 offset:32768
    ds_read_b64_tr_b16 v[66:67], v44 offset:36864
    ds_read_b64_tr_b16 v[68:69], v45 offset:32768
    ds_read_b64_tr_b16 v[70:71], v45 offset:36864
    ds_read_b64_tr_b16 v[72:73], v46 offset:32768
    ds_read_b64_tr_b16 v[74:75], v46 offset:36864
    ds_read_b64_tr_b16 v[76:77], v47 offset:32768
    ds_read_b64_tr_b16 v[78:79], v47 offset:36864
    v_mov_b32 v112, 0
    v_mov_b32 v113, 0
    v_mov_b64 v[114:115], v[112:113]
    v_mov_b64 v[116:117], v[112:113]
    v_mov_b64 v[118:119], v[112:113]
    v_mov_b64 v[120:121], v[112:113]
    v_mov_b64 v[122:123], v[112:113]
    v_mov_b64 v[124:125], v[112:113]
    v_mov_b64 v[126:127], v[112:113]
    v_mov_b64 v[128:129], v[112:113]
    v_mov_b64 v[130:131], v[112:113]
    v_mov_b64 v[132:133], v[112:113]
    v_mov_b64 v[134:135], v[112:113]
    v_mov_b64 v[136:137], v[112:113]
    v_mov_b64 v[138:139], v[112:113]
    v_mov_b64 v[140:141], v[112:113]
    v_mov_b64 v[142:143], v[112:113]
    v_mov_b64 v[144:145], v[112:113]
    v_mov_b64 v[146:147], v[112:113]
    v_mov_b64 v[148:149], v[112:113]
    v_mov_b64 v[150:151], v[112:113]
    v_mov_b64 v[152:153], v[112:113]
    v_mov_b64 v[154:155], v[112:113]
    v_mov_b64 v[156:157], v[112:113]
    v_mov_b64 v[158:159], v[112:113]
    v_mov_b64 v[160:161], v[112:113]
    v_mov_b64 v[162:163], v[112:113]
    v_mov_b64 v[164:165], v[112:113]
    v_mov_b64 v[166:167], v[112:113]
    v_mov_b64 v[168:169], v[112:113]
    v_mov_b64 v[170:171], v[112:113]
    v_mov_b64 v[172:173], v[112:113]
    v_mov_b64 v[174:175], v[112:113]
    v_mov_b64 v[176:177], v[112:113]
    v_mov_b64 v[178:179], v[112:113]
    v_mov_b64 v[180:181], v[112:113]
    v_mov_b64 v[182:183], v[112:113]
    v_mov_b64 v[184:185], v[112:113]
    v_mov_b64 v[186:187], v[112:113]
    v_mov_b64 v[188:189], v[112:113]
    v_mov_b64 v[190:191], v[112:113]
    v_mov_b64 v[192:193], v[112:113]
    v_mov_b64 v[194:195], v[112:113]
    v_mov_b64 v[196:197], v[112:113]
    v_mov_b64 v[198:199], v[112:113]
    v_mov_b64 v[200:201], v[112:113]
    v_mov_b64 v[202:203], v[112:113]
    v_mov_b64 v[204:205], v[112:113]
    v_mov_b64 v[206:207], v[112:113]
    v_mov_b64 v[208:209], v[112:113]
    v_mov_b64 v[210:211], v[112:113]
    v_mov_b64 v[212:213], v[112:113]
    v_mov_b64 v[214:215], v[112:113]
    v_mov_b64 v[216:217], v[112:113]
    v_mov_b64 v[218:219], v[112:113]
    v_mov_b64 v[220:221], v[112:113]
    v_mov_b64 v[222:223], v[112:113]
    v_mov_b64 v[224:225], v[112:113]
    v_mov_b64 v[226:227], v[112:113]
    v_mov_b64 v[228:229], v[112:113]
    v_mov_b64 v[230:231], v[112:113]
    v_mov_b64 v[232:233], v[112:113]
    v_mov_b64 v[234:235], v[112:113]
    v_mov_b64 v[236:237], v[112:113]
    v_mov_b64 v[238:239], v[112:113]
    s_cmp_lg_u32 s71, 1
    s_cbranch_scc1 km_px_ok
    s_waitcnt vmcnt(0)
    s_mov_b32 s83, 0
km_px_chk:
    v_cmp_ne_u64 vcc, s[50:51], v[252:253]
    s_add_u32 s83, s83, 1
    s_cbranch_vccz km_px_ok
    s_cmp_gt_u32 s83, 0x20000
    s_cbranch_scc1 km_px_ok
    s_sleep 1
    buffer_load_dwordx2 v[252:253], v30, s[36:39], 0 offen sc1
    s_waitcnt vmcnt(0)
    s_branch km_px_chk
km_px_ok:
    s_barrier
    buffer_load_dwordx4 a[192:195], v6, s[12:15], s67 offen offset:0 sc1
    buffer_load_dwordx4 a[196:199], v6, s[12:15], s67 offen offset:1024 sc1
    buffer_load_dwordx4 a[200:203], v6, s[12:15], s67 offen offset:2048 sc1
    buffer_load_dwordx4 a[204:207], v6, s[12:15], s67 offen offset:3072 sc1
    s_add_u32 s67, s67, 131072
    buffer_load_dwordx4 a[208:211], v6, s[12:15], s67 offen offset:0 sc1
    buffer_load_dwordx4 a[212:215], v6, s[12:15], s67 offen offset:1024 sc1
    buffer_load_dwordx4 a[216:219], v6, s[12:15], s67 offen offset:2048 sc1
    buffer_load_dwordx4 a[220:223], v6, s[12:15], s67 offen offset:3072 sc1
    s_add_u32 s67, s67, 131072
    buffer_load_dwordx4 a[224:227], v6, s[12:15], s67 offen offset:0 sc1
    buffer_load_dwordx4 a[228:231], v6, s[12:15], s67 offen offset:1024 sc1
    buffer_load_dwordx4 a[232:235], v6, s[12:15], s67 offen offset:2048 sc1
    buffer_load_dwordx4 a[236:239], v6, s[12:15], s67 offen offset:3072 sc1
    s_add_u32 s67, s67, 131072
    buffer_load_dwordx4 a[240:243], v6, s[12:15], s67 offen offset:0 sc1
    buffer_load_dwordx4 a[244:247], v6, s[12:15], s67 offen offset:1024 sc1
    buffer_load_dwordx4 a[248:251], v6, s[12:15], s67 offen offset:2048 sc1
    buffer_load_dwordx4 a[252:255], v6, s[12:15], s67 offen offset:3072 sc1
    s_add_u32 s67, s67, 131072
    buffer_load_dwordx4 a[128:131], v6, s[12:15], s67 offen offset:0 sc1
    buffer_load_dwordx4 a[132:135], v6, s[12:15], s67 offen offset:1024 sc1
    buffer_load_dwordx4 a[136:139], v6, s[12:15], s67 offen offset:2048 sc1
    buffer_load_dwordx4 a[140:143], v6, s[12:15], s67 offen offset:3072 sc1
    s_add_u32 s67, s67, 131072
    buffer_load_dwordx4 a[144:147], v6, s[12:15], s67 offen offset:0 sc1
    buffer_load_dwordx4 a[148:151], v6, s[12:15], s67 offen offset:1024 sc1
    buffer_load_dwordx4 a[152:155], v6, s[12:15], s67 offen offset:2048 sc1
    buffer_load_dwordx4 a[156:159], v6, s[12:15], s67 offen offset:3072 sc1
    s_add_u32 s67, s67, 131072
    s_and_b32 s84, s2, 1
    s_lshl_b32 s84, s84, 5
    s_add_u32 s87, s81, s84
    s_lshl_b32 s87, s87, 11
    s_lshl_b32 s84, s71, 9
    s_add_u32 s87, s87, s84
    v_and_b32 v30, 3, v1
    v_lshlrev_b32 v30, 7, v30
    buffer_load_dword v31, v30, s[16:19], s87 offen
    buffer_load_dword v31, v30, s[20:23], s87 offen
    s_and_b32 s84, s2, 1
    s_lshl_b32 s84, s84, 5
    s_add_u32 s87, s81, s84
    s_lshl_b32 s87, s87, 11
    s_lshl_b32 s84, s71, 9
    s_add_u32 s87, s87, s84
    v_and_b32 v30, 3, v1
    v_lshlrev_b32 v30, 7, v30
    buffer_load_dword v31, v30, s[16:19], s87 offen
    buffer_load_dword v31, v30, s[20:23], s87 offen
    v_lshrrev_b32 v240, 4, v1
    v_and_b32 v241, 15, v1
    v_lshrrev_b32 v242, 2, v241
    v_and_b32 v243, 3, v241
    v_lshrrev_b32 v244, 1, v240
    v_and_b32 v246, 1, v240
    v_lshl_add_u32 v245, v244, 2, v242
    v_lshlrev_b32 v245, 8, v245
    v_lshl_add_u32 v245, v246, 5, v245
    v_lshl_add_u32 v245, v243, 3, v245
    v_add_u32 v245, 65536, v245
    v_xor_b32 v246, 0, v242
    v_lshl_add_u32 v16, v246, 6, v245
    v_xor_b32 v246, 1, v242
    v_lshl_add_u32 v17, v246, 6, v245
    v_xor_b32 v246, 2, v242
    v_lshl_add_u32 v18, v246, 6, v245
    v_xor_b32 v246, 3, v242
    v_lshl_add_u32 v19, v246, 6, v245
    v_add_u32 v246, 0, v240
    v_xor_b32 v246, v246, v241
    v_lshlrev_b32 v246, 4, v246
    v_lshl_add_u32 v20, v240, 8, v246
    v_add_u32 v246, 4, v240
    v_xor_b32 v246, v246, v241
    v_lshlrev_b32 v246, 4, v246
    v_lshl_add_u32 v21, v240, 8, v246
    v_add_u32 v246, 8, v240
    v_xor_b32 v246, v246, v241
    v_lshlrev_b32 v246, 4, v246
    v_lshl_add_u32 v22, v240, 8, v246
    v_add_u32 v246, 12, v240
    v_xor_b32 v246, v246, v241
    v_lshlrev_b32 v246, 4, v246
    v_lshl_add_u32 v23, v240, 8, v246
    v_and_b32 v245, 31, v1
    v_lshlrev_b32 v246, 8, v245
    v_xor_b32 v247, v244, v241
    s_lshl_b32 s84, s72, 3
    v_xor_b32 v247, s84, v247
    v_xor_b32 v248, 0, v247
    v_lshl_add_u32 v8, v248, 4, v246
    v_xor_b32 v248, 2, v247
    v_lshl_add_u32 v9, v248, 4, v246
    v_xor_b32 v248, 4, v247
    v_lshl_add_u32 v10, v248, 4, v246
    v_xor_b32 v248, 6, v247
    v_lshl_add_u32 v11, v248, 4, v246
    v_xor_b32 v248, 8, v247
    v_lshl_add_u32 v12, v248, 4, v246
    v_xor_b32 v248, 10, v247
    v_lshl_add_u32 v13, v248, 4, v246
    v_xor_b32 v248, 12, v247
    v_lshl_add_u32 v14, v248, 4, v246
    v_xor_b32 v248, 14, v247
    v_lshl_add_u32 v15, v248, 4, v246
    v_bfe_u32 v246, v245, 2, 1
    v_lshlrev_b32 v246, 10, v246
    v_lshl_add_u32 v246, v244, 8, v246
    v_lshrrev_b32 v247, 3, v245
    v_lshl_add_u32 v246, v247, 6, v246
    v_and_b32 v247, 3, v245
    v_lshl_add_u32 v246, v247, 4, v246
    s_lshl_b32 s84, s74, 2
    s_add_u32 s84, s84, s71
    s_lshl_b32 s84, s84, 12
    v_add_u32 v25, s84, v246
    s_waitcnt vmcnt(20) lgkmcnt(0)
    s_mov_b32 s70, 3
.p2align 6
kms_qloop:
    v_mfma_f32_16x16x32_bf16 v[112:115], v[48:51], a[192:195], v[112:115]
    ds_read_b64_tr_b16 v[80:81], v40 offset:40960
    v_mfma_f32_16x16x32_bf16 v[116:119], v[48:51], a[196:199], v[116:119]
    ds_read_b64_tr_b16 v[82:83], v40 offset:45056
    s_add_u32 m0, s68, 98304
    s_add_u32 s66, s66, 524288
    v_mfma_f32_16x16x32_bf16 v[120:123], v[48:51], a[200:203], v[120:123]
    ds_read_b64_tr_b16 v[84:85], v41 offset:40960
    buffer_load_dwordx4 v2, s[8:11], s66 offen offset:0 lds
    v_mfma_f32_16x16x32_bf16 v[124:127], v[48:51], a[204:207], v[124:127]
    ds_read_b64_tr_b16 v[86:87], v41 offset:45056
    v_mfma_f32_16x16x32_bf16 v[128:131], v[52:55], a[192:195], v[128:131]
    buffer_load_dwordx4 v3, s[8:11], s66 offen offset:1024 lds
    v_mfma_f32_16x16x32_bf16 v[132:135], v[52:55], a[196:199], v[132:135]
    ds_read_b64_tr_b16 v[88:89], v42 offset:40960
    v_mfma_f32_16x16x32_bf16 v[136:139], v[52:55], a[200:203], v[136:139]
    ds_read_b64_tr_b16 v[90:91], v42 offset:45056
    v_mfma_f32_16x16x32_bf16 v[140:143], v[52:55], a[204:207], v[140:143]
    ds_read_b64_tr_b16 v[92:93], v43 offset:40960
    v_mfma_f32_16x16x32_bf16 v[144:147], v[56:59], a[192:195], v[144:147]
    ds_read_b64_tr_b16 v[94:95], v43 offset:45056
    buffer_load_dwordx4 v4, s[8:11], s66 offen offset:2048 lds
    v_mfma_f32_16x16x32_bf16 v[148:151], v[56:59], a[196:199], v[148:151]
    v_mfma_f32_16x16x32_bf16 v[152:155], v[56:59], a[200:203], v[152:155]
    ds_read_b64_tr_b16 v[96:97], v44 offset:40960
    v_mfma_f32_16x16x32_bf16 v[156:159], v[56:59], a[204:207], v[156:159]
    ds_read_b64_tr_b16 v[98:99], v44 offset:45056
    v_mfma_f32_16x16x32_bf16 v[160:163], v[60:63], a[192:195], v[160:163]
    ds_read_b64_tr_b16 v[100:101], v45 offset:40960
    buffer_load_dwordx4 v5, s[8:11], s66 offen offset:3072 lds
    v_mfma_f32_16x16x32_bf16 v[164:167], v[60:63], a[196:199], v[164:167]
    ds_read_b64_tr_b16 v[102:103], v45 offset:45056
    v_mfma_f32_16x16x32_bf16 v[168:171], v[60:63], a[200:203], v[168:171]
    v_mfma_f32_16x16x32_bf16 v[172:175], v[60:63], a[204:207], v[172:175]
    ds_read_b64_tr_b16 v[104:105], v46 offset:40960
    v_mfma_f32_16x16x32_bf16 v[176:179], v[64:67], a[192:195], v[176:179]
    ds_read_b64_tr_b16 v[106:107], v46 offset:45056
    buffer_load_dwordx4 a[160:163], v6, s[12:15], s67 offen offset:0 sc1
    v_mfma_f32_16x16x32_bf16 v[180:183], v[64:67], a[196:199], v[180:183]
    ds_read_b64_tr_b16 v[108:109], v47 offset:40960
    v_mfma_f32_16x16x32_bf16 v[184:187], v[64:67], a[200:203], v[184:187]
    ds_read_b64_tr_b16 v[110:111], v47 offset:45056
    v_mfma_f32_16x16x32_bf16 v[188:191], v[64:67], a[204:207], v[188:191]
    v_mfma_f32_16x16x32_bf16 v[192:195], v[68:71], a[192:195], v[192:195]
    buffer_load_dwordx4 a[164:167], v6, s[12:15], s67 offen offset:1024 sc1
    v_mfma_f32_16x16x32_bf16 v[196:199], v[68:71], a[196:199], v[196:199]
    v_mfma_f32_16x16x32_bf16 v[200:203], v[68:71], a[200:203], v[200:203]
    v_mfma_f32_16x16x32_bf16 v[204:207], v[68:71], a[204:207], v[204:207]
    v_mfma_f32_16x16x32_bf16 v[208:211], v[72:75], a[192:195], v[208:211]
    buffer_load_dwordx4 a[168:171], v6, s[12:15], s67 offen offset:2048 sc1
    v_mfma_f32_16x16x32_bf16 v[212:215], v[72:75], a[196:199], v[212:215]
    v_mfma_f32_16x16x32_bf16 v[216:219], v[72:75], a[200:203], v[216:219]
    v_mfma_f32_16x16x32_bf16 v[220:223], v[72:75], a[204:207], v[220:223]
    v_mfma_f32_16x16x32_bf16 v[224:227], v[76:79], a[192:195], v[224:227]
    buffer_load_dwordx4 a[172:175], v6, s[12:15], s67 offen offset:3072 sc1
    v_mfma_f32_16x16x32_bf16 v[228:231], v[76:79], a[196:199], v[228:231]
    v_mfma_f32_16x16x32_bf16 v[232:235], v[76:79], a[200:203], v[232:235]
    v_mfma_f32_16x16x32_bf16 v[236:239], v[76:79], a[204:207], v[236:239]
    s_add_u32 s67, s67, 131072
    s_waitcnt vmcnt(20) lgkmcnt(0)
    s_barrier
    v_mfma_f32_16x16x32_bf16 v[112:115], v[80:83], a[208:211], v[112:115]
    ds_read_b64_tr_b16 v[48:49], v40 offset:49152
    v_mfma_f32_16x16x32_bf16 v[116:119], v[80:83], a[212:215], v[116:119]
    ds_read_b64_tr_b16 v[50:51], v40 offset:53248
    buffer_load_dwordx4 a[176:179], v6, s[12:15], s67 offen offset:0 sc1
    v_mfma_f32_16x16x32_bf16 v[120:123], v[80:83], a[216:219], v[120:123]
    ds_read_b64_tr_b16 v[52:53], v41 offset:49152
    v_mfma_f32_16x16x32_bf16 v[124:127], v[80:83], a[220:223], v[124:127]
    ds_read_b64_tr_b16 v[54:55], v41 offset:53248
    v_mfma_f32_16x16x32_bf16 v[128:131], v[84:87], a[208:211], v[128:131]
    v_mfma_f32_16x16x32_bf16 v[132:135], v[84:87], a[212:215], v[132:135]
    ds_read_b64_tr_b16 v[56:57], v42 offset:49152
    v_mfma_f32_16x16x32_bf16 v[136:139], v[84:87], a[216:219], v[136:139]
    ds_read_b64_tr_b16 v[58:59], v42 offset:53248
    v_mfma_f32_16x16x32_bf16 v[140:143], v[84:87], a[220:223], v[140:143]
    ds_read_b64_tr_b16 v[60:61], v43 offset:49152
    v_mfma_f32_16x16x32_bf16 v[144:147], v[88:91], a[208:211], v[144:147]
    ds_read_b64_tr_b16 v[62:63], v43 offset:53248
    buffer_load_dwordx4 a[180:183], v6, s[12:15], s67 offen offset:1024 sc1
    v_mfma_f32_16x16x32_bf16 v[148:151], v[88:91], a[212:215], v[148:151]
    v_mfma_f32_16x16x32_bf16 v[152:155], v[88:91], a[216:219], v[152:155]
    ds_read_b64_tr_b16 v[64:65], v44 offset:49152
    v_mfma_f32_16x16x32_bf16 v[156:159], v[88:91], a[220:223], v[156:159]
    ds_read_b64_tr_b16 v[66:67], v44 offset:53248
    v_mfma_f32_16x16x32_bf16 v[160:163], v[92:95], a[208:211], v[160:163]
    ds_read_b64_tr_b16 v[68:69], v45 offset:49152
    v_mfma_f32_16x16x32_bf16 v[164:167], v[92:95], a[212:215], v[164:167]
    ds_read_b64_tr_b16 v[70:71], v45 offset:53248
    v_mfma_f32_16x16x32_bf16 v[168:171], v[92:95], a[216:219], v[168:171]
    v_mfma_f32_16x16x32_bf16 v[172:175], v[92:95], a[220:223], v[172:175]
    ds_read_b64_tr_b16 v[72:73], v46 offset:49152
    v_mfma_f32_16x16x32_bf16 v[176:179], v[96:99], a[208:211], v[176:179]
    ds_read_b64_tr_b16 v[74:75], v46 offset:53248
    buffer_load_dwordx4 a[184:187], v6, s[12:15], s67 offen offset:2048 sc1
    v_mfma_f32_16x16x32_bf16 v[180:183], v[96:99], a[212:215], v[180:183]
    ds_read_b64_tr_b16 v[76:77], v47 offset:49152
    v_mfma_f32_16x16x32_bf16 v[184:187], v[96:99], a[216:219], v[184:187]
    ds_read_b64_tr_b16 v[78:79], v47 offset:53248
    v_mfma_f32_16x16x32_bf16 v[188:191], v[96:99], a[220:223], v[188:191]
    v_mfma_f32_16x16x32_bf16 v[192:195], v[100:103], a[208:211], v[192:195]
    v_mfma_f32_16x16x32_bf16 v[196:199], v[100:103], a[212:215], v[196:199]
    v_mfma_f32_16x16x32_bf16 v[200:203], v[100:103], a[216:219], v[200:203]
    v_mfma_f32_16x16x32_bf16 v[204:207], v[100:103], a[220:223], v[204:207]
    v_mfma_f32_16x16x32_bf16 v[208:211], v[104:107], a[208:211], v[208:211]
    buffer_load_dwordx4 a[188:191], v6, s[12:15], s67 offen offset:3072 sc1
    v_mfma_f32_16x16x32_bf16 v[212:215], v[104:107], a[212:215], v[212:215]
    v_mfma_f32_16x16x32_bf16 v[216:219], v[104:107], a[216:219], v[216:219]
    v_mfma_f32_16x16x32_bf16 v[220:223], v[104:107], a[220:223], v[220:223]
    v_mfma_f32_16x16x32_bf16 v[224:227], v[108:111], a[208:211], v[224:227]
    v_mfma_f32_16x16x32_bf16 v[228:231], v[108:111], a[212:215], v[228:231]
    v_mfma_f32_16x16x32_bf16 v[232:235], v[108:111], a[216:219], v[232:235]
    v_mfma_f32_16x16x32_bf16 v[236:239], v[108:111], a[220:223], v[236:239]
    s_add_u32 s67, s67, 131072
    s_waitcnt lgkmcnt(0)
    v_mfma_f32_16x16x32_bf16 v[112:115], v[48:51], a[224:227], v[112:115]
    ds_read_b64_tr_b16 v[80:81], v40 offset:57344
    v_mfma_f32_16x16x32_bf16 v[116:119], v[48:51], a[228:231], v[116:119]
    ds_read_b64_tr_b16 v[82:83], v40 offset:61440
    s_add_u32 m0, s68, 131072
    s_add_u32 s66, s66, 524288
    v_mfma_f32_16x16x32_bf16 v[120:123], v[48:51], a[232:235], v[120:123]
    ds_read_b64_tr_b16 v[84:85], v41 offset:57344
    buffer_load_dwordx4 v2, s[8:11], s66 offen offset:0 lds
    v_mfma_f32_16x16x32_bf16 v[124:127], v[48:51], a[236:239], v[124:127]
    ds_read_b64_tr_b16 v[86:87], v41 offset:61440
    v_mfma_f32_16x16x32_bf16 v[128:131], v[52:55], a[224:227], v[128:131]
    buffer_load_dwordx4 v3, s[8:11], s66 offen offset:1024 lds
    v_mfma_f32_16x16x32_bf16 v[132:135], v[52:55], a[228:231], v[132:135]
    ds_read_b64_tr_b16 v[88:89], v42 offset:57344
    v_mfma_f32_16x16x32_bf16 v[136:139], v[52:55], a[232:235], v[136:139]
    ds_read_b64_tr_b16 v[90:91], v42 offset:61440
    v_mfma_f32_16x16x32_bf16 v[140:143], v[52:55], a[236:239], v[140:143]
    ds_read_b64_tr_b16 v[92:93], v43 offset:57344
    v_mfma_f32_16x16x32_bf16 v[144:147], v[56:59], a[224:227], v[144:147]
    ds_read_b64_tr_b16 v[94:95], v43 offset:61440
    buffer_load_dwordx4 v4, s[8:11], s66 offen offset:2048 lds
    v_mfma_f32_16x16x32_bf16 v[148:151], v[56:59], a[228:231], v[148:151]
    v_mfma_f32_16x16x32_bf16 v[152:155], v[56:59], a[232:235], v[152:155]
    ds_read_b64_tr_b16 v[96:97], v44 offset:57344
    v_mfma_f32_16x16x32_bf16 v[156:159], v[56:59], a[236:239], v[156:159]
    ds_read_b64_tr_b16 v[98:99], v44 offset:61440
    v_mfma_f32_16x16x32_bf16 v[160:163], v[60:63], a[224:227], v[160:163]
    ds_read_b64_tr_b16 v[100:101], v45 offset:57344
    buffer_load_dwordx4 v5, s[8:11], s66 offen offset:3072 lds
    v_mfma_f32_16x16x32_bf16 v[164:167], v[60:63], a[228:231], v[164:167]
    ds_read_b64_tr_b16 v[102:103], v45 offset:61440
    v_mfma_f32_16x16x32_bf16 v[168:171], v[60:63], a[232:235], v[168:171]
    v_mfma_f32_16x16x32_bf16 v[172:175], v[60:63], a[236:239], v[172:175]
    ds_read_b64_tr_b16 v[104:105], v46 offset:57344
    v_mfma_f32_16x16x32_bf16 v[176:179], v[64:67], a[224:227], v[176:179]
    ds_read_b64_tr_b16 v[106:107], v46 offset:61440
    buffer_load_dwordx4 a[192:195], v6, s[12:15], s67 offen offset:0 sc1
    v_mfma_f32_16x16x32_bf16 v[180:183], v[64:67], a[228:231], v[180:183]
    ds_read_b64_tr_b16 v[108:109], v47 offset:57344
    v_mfma_f32_16x16x32_bf16 v[184:187], v[64:67], a[232:235], v[184:187]
    ds_read_b64_tr_b16 v[110:111], v47 offset:61440
    v_mfma_f32_16x16x32_bf16 v[188:191], v[64:67], a[236:239], v[188:191]
    v_mfma_f32_16x16x32_bf16 v[192:195], v[68:71], a[224:227], v[192:195]
    buffer_load_dwordx4 a[196:199], v6, s[12:15], s67 offen offset:1024 sc1
    v_mfma_f32_16x16x32_bf16 v[196:199], v[68:71], a[228:231], v[196:199]
    v_mfma_f32_16x16x32_bf16 v[200:203], v[68:71], a[232:235], v[200:203]
    v_mfma_f32_16x16x32_bf16 v[204:207], v[68:71], a[236:239], v[204:207]
    v_mfma_f32_16x16x32_bf16 v[208:211], v[72:75], a[224:227], v[208:211]
    buffer_load_dwordx4 a[200:203], v6, s[12:15], s67 offen offset:2048 sc1
    v_mfma_f32_16x16x32_bf16 v[212:215], v[72:75], a[228:231], v[212:215]
    v_mfma_f32_16x16x32_bf16 v[216:219], v[72:75], a[232:235], v[216:219]
    v_mfma_f32_16x16x32_bf16 v[220:223], v[72:75], a[236:239], v[220:223]
    v_mfma_f32_16x16x32_bf16 v[224:227], v[76:79], a[224:227], v[224:227]
    buffer_load_dwordx4 a[204:207], v6, s[12:15], s67 offen offset:3072 sc1
    v_mfma_f32_16x16x32_bf16 v[228:231], v[76:79], a[228:231], v[228:231]
    v_mfma_f32_16x16x32_bf16 v[232:235], v[76:79], a[232:235], v[232:235]
    v_mfma_f32_16x16x32_bf16 v[236:239], v[76:79], a[236:239], v[236:239]
    s_add_u32 s67, s67, 131072
    s_waitcnt vmcnt(20) lgkmcnt(0)
    s_barrier
    v_mfma_f32_16x16x32_bf16 v[112:115], v[80:83], a[240:243], v[112:115]
    ds_read_b64_tr_b16 v[48:49], v40 offset:16384
    v_mfma_f32_16x16x32_bf16 v[116:119], v[80:83], a[244:247], v[116:119]
    ds_read_b64_tr_b16 v[50:51], v40 offset:20480
    buffer_load_dwordx4 a[208:211], v6, s[12:15], s67 offen offset:0 sc1
    v_mfma_f32_16x16x32_bf16 v[120:123], v[80:83], a[248:251], v[120:123]
    ds_read_b64_tr_b16 v[52:53], v41 offset:16384
    v_mfma_f32_16x16x32_bf16 v[124:127], v[80:83], a[252:255], v[124:127]
    ds_read_b64_tr_b16 v[54:55], v41 offset:20480
    v_mfma_f32_16x16x32_bf16 v[128:131], v[84:87], a[240:243], v[128:131]
    v_mfma_f32_16x16x32_bf16 v[132:135], v[84:87], a[244:247], v[132:135]
    ds_read_b64_tr_b16 v[56:57], v42 offset:16384
    v_mfma_f32_16x16x32_bf16 v[136:139], v[84:87], a[248:251], v[136:139]
    ds_read_b64_tr_b16 v[58:59], v42 offset:20480
    v_mfma_f32_16x16x32_bf16 v[140:143], v[84:87], a[252:255], v[140:143]
    ds_read_b64_tr_b16 v[60:61], v43 offset:16384
    v_mfma_f32_16x16x32_bf16 v[144:147], v[88:91], a[240:243], v[144:147]
    ds_read_b64_tr_b16 v[62:63], v43 offset:20480
    buffer_load_dwordx4 a[212:215], v6, s[12:15], s67 offen offset:1024 sc1
    v_mfma_f32_16x16x32_bf16 v[148:151], v[88:91], a[244:247], v[148:151]
    v_mfma_f32_16x16x32_bf16 v[152:155], v[88:91], a[248:251], v[152:155]
    ds_read_b64_tr_b16 v[64:65], v44 offset:16384
    v_mfma_f32_16x16x32_bf16 v[156:159], v[88:91], a[252:255], v[156:159]
    ds_read_b64_tr_b16 v[66:67], v44 offset:20480
    v_mfma_f32_16x16x32_bf16 v[160:163], v[92:95], a[240:243], v[160:163]
    ds_read_b64_tr_b16 v[68:69], v45 offset:16384
    v_mfma_f32_16x16x32_bf16 v[164:167], v[92:95], a[244:247], v[164:167]
    ds_read_b64_tr_b16 v[70:71], v45 offset:20480
    v_mfma_f32_16x16x32_bf16 v[168:171], v[92:95], a[248:251], v[168:171]
    v_mfma_f32_16x16x32_bf16 v[172:175], v[92:95], a[252:255], v[172:175]
    ds_read_b64_tr_b16 v[72:73], v46 offset:16384
    v_mfma_f32_16x16x32_bf16 v[176:179], v[96:99], a[240:243], v[176:179]
    ds_read_b64_tr_b16 v[74:75], v46 offset:20480
    buffer_load_dwordx4 a[216:219], v6, s[12:15], s67 offen offset:2048 sc1
    v_mfma_f32_16x16x32_bf16 v[180:183], v[96:99], a[244:247], v[180:183]
    ds_read_b64_tr_b16 v[76:77], v47 offset:16384
    v_mfma_f32_16x16x32_bf16 v[184:187], v[96:99], a[248:251], v[184:187]
    ds_read_b64_tr_b16 v[78:79], v47 offset:20480
    v_mfma_f32_16x16x32_bf16 v[188:191], v[96:99], a[252:255], v[188:191]
    v_mfma_f32_16x16x32_bf16 v[192:195], v[100:103], a[240:243], v[192:195]
    v_mfma_f32_16x16x32_bf16 v[196:199], v[100:103], a[244:247], v[196:199]
    v_mfma_f32_16x16x32_bf16 v[200:203], v[100:103], a[248:251], v[200:203]
    v_mfma_f32_16x16x32_bf16 v[204:207], v[100:103], a[252:255], v[204:207]
    v_mfma_f32_16x16x32_bf16 v[208:211], v[104:107], a[240:243], v[208:211]
    buffer_load_dwordx4 a[220:223], v6, s[12:15], s67 offen offset:3072 sc1
    v_mfma_f32_16x16x32_bf16 v[212:215], v[104:107], a[244:247], v[212:215]
    v_mfma_f32_16x16x32_bf16 v[216:219], v[104:107], a[248:251], v[216:219]
    v_mfma_f32_16x16x32_bf16 v[220:223], v[104:107], a[252:255], v[220:223]
    v_mfma_f32_16x16x32_bf16 v[224:227], v[108:111], a[240:243], v[224:227]
    v_mfma_f32_16x16x32_bf16 v[228:231], v[108:111], a[244:247], v[228:231]
    v_mfma_f32_16x16x32_bf16 v[232:235], v[108:111], a[248:251], v[232:235]
    v_mfma_f32_16x16x32_bf16 v[236:239], v[108:111], a[252:255], v[236:239]
    s_add_u32 s67, s67, 131072
    s_waitcnt lgkmcnt(0)
    v_mfma_f32_16x16x32_bf16 v[112:115], v[48:51], a[128:131], v[112:115]
    ds_read_b64_tr_b16 v[80:81], v40 offset:24576
    v_mfma_f32_16x16x32_bf16 v[116:119], v[48:51], a[132:135], v[116:119]
    ds_read_b64_tr_b16 v[82:83], v40 offset:28672
    s_add_u32 m0, s68, 147456
    s_add_u32 s66, s66, 524288
    v_mfma_f32_16x16x32_bf16 v[120:123], v[48:51], a[136:139], v[120:123]
    ds_read_b64_tr_b16 v[84:85], v41 offset:24576
    buffer_load_dwordx4 v2, s[8:11], s66 offen offset:0 lds
    v_mfma_f32_16x16x32_bf16 v[124:127], v[48:51], a[140:143], v[124:127]
    ds_read_b64_tr_b16 v[86:87], v41 offset:28672
    v_mfma_f32_16x16x32_bf16 v[128:131], v[52:55], a[128:131], v[128:131]
    buffer_load_dwordx4 v3, s[8:11], s66 offen offset:1024 lds
    v_mfma_f32_16x16x32_bf16 v[132:135], v[52:55], a[132:135], v[132:135]
    ds_read_b64_tr_b16 v[88:89], v42 offset:24576
    v_mfma_f32_16x16x32_bf16 v[136:139], v[52:55], a[136:139], v[136:139]
    ds_read_b64_tr_b16 v[90:91], v42 offset:28672
    v_mfma_f32_16x16x32_bf16 v[140:143], v[52:55], a[140:143], v[140:143]
    ds_read_b64_tr_b16 v[92:93], v43 offset:24576
    v_mfma_f32_16x16x32_bf16 v[144:147], v[56:59], a[128:131], v[144:147]
    ds_read_b64_tr_b16 v[94:95], v43 offset:28672
    buffer_load_dwordx4 v4, s[8:11], s66 offen offset:2048 lds
    v_mfma_f32_16x16x32_bf16 v[148:151], v[56:59], a[132:135], v[148:151]
    v_mfma_f32_16x16x32_bf16 v[152:155], v[56:59], a[136:139], v[152:155]
    ds_read_b64_tr_b16 v[96:97], v44 offset:24576
    v_mfma_f32_16x16x32_bf16 v[156:159], v[56:59], a[140:143], v[156:159]
    ds_read_b64_tr_b16 v[98:99], v44 offset:28672
    v_mfma_f32_16x16x32_bf16 v[160:163], v[60:63], a[128:131], v[160:163]
    ds_read_b64_tr_b16 v[100:101], v45 offset:24576
    buffer_load_dwordx4 v5, s[8:11], s66 offen offset:3072 lds
    v_mfma_f32_16x16x32_bf16 v[164:167], v[60:63], a[132:135], v[164:167]
    ds_read_b64_tr_b16 v[102:103], v45 offset:28672
    v_mfma_f32_16x16x32_bf16 v[168:171], v[60:63], a[136:139], v[168:171]
    v_mfma_f32_16x16x32_bf16 v[172:175], v[60:63], a[140:143], v[172:175]
    ds_read_b64_tr_b16 v[104:105], v46 offset:24576
    v_mfma_f32_16x16x32_bf16 v[176:179], v[64:67], a[128:131], v[176:179]
    ds_read_b64_tr_b16 v[106:107], v46 offset:28672
    buffer_load_dwordx4 a[224:227], v6, s[12:15], s67 offen offset:0 sc1
    v_mfma_f32_16x16x32_bf16 v[180:183], v[64:67], a[132:135], v[180:183]
    ds_read_b64_tr_b16 v[108:109], v47 offset:24576
    v_mfma_f32_16x16x32_bf16 v[184:187], v[64:67], a[136:139], v[184:187]
    ds_read_b64_tr_b16 v[110:111], v47 offset:28672
    v_mfma_f32_16x16x32_bf16 v[188:191], v[64:67], a[140:143], v[188:191]
    v_mfma_f32_16x16x32_bf16 v[192:195], v[68:71], a[128:131], v[192:195]
    buffer_load_dwordx4 a[228:231], v6, s[12:15], s67 offen offset:1024 sc1
    v_mfma_f32_16x16x32_bf16 v[196:199], v[68:71], a[132:135], v[196:199]
    v_mfma_f32_16x16x32_bf16 v[200:203], v[68:71], a[136:139], v[200:203]
    v_mfma_f32_16x16x32_bf16 v[204:207], v[68:71], a[140:143], v[204:207]
    v_mfma_f32_16x16x32_bf16 v[208:211], v[72:75], a[128:131], v[208:211]
    buffer_load_dwordx4 a[232:235], v6, s[12:15], s67 offen offset:2048 sc1
    v_mfma_f32_16x16x32_bf16 v[212:215], v[72:75], a[132:135], v[212:215]
    v_mfma_f32_16x16x32_bf16 v[216:219], v[72:75], a[136:139], v[216:219]
    v_mfma_f32_16x16x32_bf16 v[220:223], v[72:75], a[140:143], v[220:223]
    v_mfma_f32_16x16x32_bf16 v[224:227], v[76:79], a[128:131], v[224:227]
    buffer_load_dwordx4 a[236:239], v6, s[12:15], s67 offen offset:3072 sc1
    v_mfma_f32_16x16x32_bf16 v[228:231], v[76:79], a[132:135], v[228:231]
    v_mfma_f32_16x16x32_bf16 v[232:235], v[76:79], a[136:139], v[232:235]
    v_mfma_f32_16x16x32_bf16 v[236:239], v[76:79], a[140:143], v[236:239]
    s_add_u32 s67, s67, 131072
    s_waitcnt vmcnt(20) lgkmcnt(0)
    s_barrier
    v_mfma_f32_16x16x32_bf16 v[112:115], v[80:83], a[144:147], v[112:115]
    ds_read_b64_tr_b16 v[48:49], v40 offset:0
    v_mfma_f32_16x16x32_bf16 v[116:119], v[80:83], a[148:151], v[116:119]
    ds_read_b64_tr_b16 v[50:51], v40 offset:4096
    buffer_load_dwordx4 a[240:243], v6, s[12:15], s67 offen offset:0 sc1
    v_mfma_f32_16x16x32_bf16 v[120:123], v[80:83], a[152:155], v[120:123]
    ds_read_b64_tr_b16 v[52:53], v41 offset:0
    v_mfma_f32_16x16x32_bf16 v[124:127], v[80:83], a[156:159], v[124:127]
    ds_read_b64_tr_b16 v[54:55], v41 offset:4096
    v_mfma_f32_16x16x32_bf16 v[128:131], v[84:87], a[144:147], v[128:131]
    v_mfma_f32_16x16x32_bf16 v[132:135], v[84:87], a[148:151], v[132:135]
    ds_read_b64_tr_b16 v[56:57], v42 offset:0
    v_mfma_f32_16x16x32_bf16 v[136:139], v[84:87], a[152:155], v[136:139]
    ds_read_b64_tr_b16 v[58:59], v42 offset:4096
    v_mfma_f32_16x16x32_bf16 v[140:143], v[84:87], a[156:159], v[140:143]
    ds_read_b64_tr_b16 v[60:61], v43 offset:0
    v_mfma_f32_16x16x32_bf16 v[144:147], v[88:91], a[144:147], v[144:147]
    ds_read_b64_tr_b16 v[62:63], v43 offset:4096
    buffer_load_dwordx4 a[244:247], v6, s[12:15], s67 offen offset:1024 sc1
    v_mfma_f32_16x16x32_bf16 v[148:151], v[88:91], a[148:151], v[148:151]
    v_mfma_f32_16x16x32_bf16 v[152:155], v[88:91], a[152:155], v[152:155]
    ds_read_b64_tr_b16 v[64:65], v44 offset:0
    v_mfma_f32_16x16x32_bf16 v[156:159], v[88:91], a[156:159], v[156:159]
    ds_read_b64_tr_b16 v[66:67], v44 offset:4096
    v_mfma_f32_16x16x32_bf16 v[160:163], v[92:95], a[144:147], v[160:163]
    ds_read_b64_tr_b16 v[68:69], v45 offset:0
    v_mfma_f32_16x16x32_bf16 v[164:167], v[92:95], a[148:151], v[164:167]
    ds_read_b64_tr_b16 v[70:71], v45 offset:4096
    v_mfma_f32_16x16x32_bf16 v[168:171], v[92:95], a[152:155], v[168:171]
    v_mfma_f32_16x16x32_bf16 v[172:175], v[92:95], a[156:159], v[172:175]
    ds_read_b64_tr_b16 v[72:73], v46 offset:0
    v_mfma_f32_16x16x32_bf16 v[176:179], v[96:99], a[144:147], v[176:179]
    ds_read_b64_tr_b16 v[74:75], v46 offset:4096
    buffer_load_dwordx4 a[248:251], v6, s[12:15], s67 offen offset:2048 sc1
    v_mfma_f32_16x16x32_bf16 v[180:183], v[96:99], a[148:151], v[180:183]
    ds_read_b64_tr_b16 v[76:77], v47 offset:0
    v_mfma_f32_16x16x32_bf16 v[184:187], v[96:99], a[152:155], v[184:187]
    ds_read_b64_tr_b16 v[78:79], v47 offset:4096
    v_mfma_f32_16x16x32_bf16 v[188:191], v[96:99], a[156:159], v[188:191]
    v_mfma_f32_16x16x32_bf16 v[192:195], v[100:103], a[144:147], v[192:195]
    v_mfma_f32_16x16x32_bf16 v[196:199], v[100:103], a[148:151], v[196:199]
    v_mfma_f32_16x16x32_bf16 v[200:203], v[100:103], a[152:155], v[200:203]
    v_mfma_f32_16x16x32_bf16 v[204:207], v[100:103], a[156:159], v[204:207]
    v_mfma_f32_16x16x32_bf16 v[208:211], v[104:107], a[144:147], v[208:211]
    buffer_load_dwordx4 a[252:255], v6, s[12:15], s67 offen offset:3072 sc1
    v_mfma_f32_16x16x32_bf16 v[212:215], v[104:107], a[148:151], v[212:215]
    v_mfma_f32_16x16x32_bf16 v[216:219], v[104:107], a[152:155], v[216:219]
    v_mfma_f32_16x16x32_bf16 v[220:223], v[104:107], a[156:159], v[220:223]
    v_mfma_f32_16x16x32_bf16 v[224:227], v[108:111], a[144:147], v[224:227]
    v_mfma_f32_16x16x32_bf16 v[228:231], v[108:111], a[148:151], v[228:231]
    v_mfma_f32_16x16x32_bf16 v[232:235], v[108:111], a[152:155], v[232:235]
    v_mfma_f32_16x16x32_bf16 v[236:239], v[108:111], a[156:159], v[236:239]
    s_add_u32 s67, s67, 131072
    s_waitcnt lgkmcnt(0)
    v_mfma_f32_16x16x32_bf16 v[112:115], v[48:51], a[160:163], v[112:115]
    ds_read_b64_tr_b16 v[80:81], v40 offset:8192
    v_mfma_f32_16x16x32_bf16 v[116:119], v[48:51], a[164:167], v[116:119]
    ds_read_b64_tr_b16 v[82:83], v40 offset:12288
    s_add_u32 m0, s68, 114688
    s_add_u32 s66, s66, 524288
    v_mfma_f32_16x16x32_bf16 v[120:123], v[48:51], a[168:171], v[120:123]
    ds_read_b64_tr_b16 v[84:85], v41 offset:8192
    buffer_load_dwordx4 v2, s[8:11], s66 offen offset:0 lds
    v_mfma_f32_16x16x32_bf16 v[124:127], v[48:51], a[172:175], v[124:127]
    ds_read_b64_tr_b16 v[86:87], v41 offset:12288
    v_mfma_f32_16x16x32_bf16 v[128:131], v[52:55], a[160:163], v[128:131]
    buffer_load_dwordx4 v3, s[8:11], s66 offen offset:1024 lds
    v_mfma_f32_16x16x32_bf16 v[132:135], v[52:55], a[164:167], v[132:135]
    ds_read_b64_tr_b16 v[88:89], v42 offset:8192
    v_mfma_f32_16x16x32_bf16 v[136:139], v[52:55], a[168:171], v[136:139]
    ds_read_b64_tr_b16 v[90:91], v42 offset:12288
    v_mfma_f32_16x16x32_bf16 v[140:143], v[52:55], a[172:175], v[140:143]
    ds_read_b64_tr_b16 v[92:93], v43 offset:8192
    v_mfma_f32_16x16x32_bf16 v[144:147], v[56:59], a[160:163], v[144:147]
    ds_read_b64_tr_b16 v[94:95], v43 offset:12288
    buffer_load_dwordx4 v4, s[8:11], s66 offen offset:2048 lds
    v_mfma_f32_16x16x32_bf16 v[148:151], v[56:59], a[164:167], v[148:151]
    v_mfma_f32_16x16x32_bf16 v[152:155], v[56:59], a[168:171], v[152:155]
    ds_read_b64_tr_b16 v[96:97], v44 offset:8192
    v_mfma_f32_16x16x32_bf16 v[156:159], v[56:59], a[172:175], v[156:159]
    ds_read_b64_tr_b16 v[98:99], v44 offset:12288
    v_mfma_f32_16x16x32_bf16 v[160:163], v[60:63], a[160:163], v[160:163]
    ds_read_b64_tr_b16 v[100:101], v45 offset:8192
    buffer_load_dwordx4 v5, s[8:11], s66 offen offset:3072 lds
    v_mfma_f32_16x16x32_bf16 v[164:167], v[60:63], a[164:167], v[164:167]
    ds_read_b64_tr_b16 v[102:103], v45 offset:12288
    v_mfma_f32_16x16x32_bf16 v[168:171], v[60:63], a[168:171], v[168:171]
    v_mfma_f32_16x16x32_bf16 v[172:175], v[60:63], a[172:175], v[172:175]
    ds_read_b64_tr_b16 v[104:105], v46 offset:8192
    v_mfma_f32_16x16x32_bf16 v[176:179], v[64:67], a[160:163], v[176:179]
    ds_read_b64_tr_b16 v[106:107], v46 offset:12288
    buffer_load_dwordx4 a[128:131], v6, s[12:15], s67 offen offset:0 sc1
    v_mfma_f32_16x16x32_bf16 v[180:183], v[64:67], a[164:167], v[180:183]
    ds_read_b64_tr_b16 v[108:109], v47 offset:8192
    v_mfma_f32_16x16x32_bf16 v[184:187], v[64:67], a[168:171], v[184:187]
    ds_read_b64_tr_b16 v[110:111], v47 offset:12288
    v_mfma_f32_16x16x32_bf16 v[188:191], v[64:67], a[172:175], v[188:191]
    v_mfma_f32_16x16x32_bf16 v[192:195], v[68:71], a[160:163], v[192:195]
    buffer_load_dwordx4 a[132:135], v6, s[12:15], s67 offen offset:1024 sc1
    v_mfma_f32_16x16x32_bf16 v[196:199], v[68:71], a[164:167], v[196:199]
    v_mfma_f32_16x16x32_bf16 v[200:203], v[68:71], a[168:171], v[200:203]
    v_mfma_f32_16x16x32_bf16 v[204:207], v[68:71], a[172:175], v[204:207]
    v_mfma_f32_16x16x32_bf16 v[208:211], v[72:75], a[160:163], v[208:211]
    buffer_load_dwordx4 a[136:139], v6, s[12:15], s67 offen offset:2048 sc1
    v_mfma_f32_16x16x32_bf16 v[212:215], v[72:75], a[164:167], v[212:215]
    v_mfma_f32_16x16x32_bf16 v[216:219], v[72:75], a[168:171], v[216:219]
    v_mfma_f32_16x16x32_bf16 v[220:223], v[72:75], a[172:175], v[220:223]
    v_mfma_f32_16x16x32_bf16 v[224:227], v[76:79], a[160:163], v[224:227]
    buffer_load_dwordx4 a[140:143], v6, s[12:15], s67 offen offset:3072 sc1
    v_mfma_f32_16x16x32_bf16 v[228:231], v[76:79], a[164:167], v[228:231]
    v_mfma_f32_16x16x32_bf16 v[232:235], v[76:79], a[168:171], v[232:235]
    v_mfma_f32_16x16x32_bf16 v[236:239], v[76:79], a[172:175], v[236:239]
    s_add_u32 s67, s67, 131072
    s_waitcnt vmcnt(20) lgkmcnt(0)
    s_barrier
    v_mfma_f32_16x16x32_bf16 v[112:115], v[80:83], a[176:179], v[112:115]
    ds_read_b64_tr_b16 v[48:49], v40 offset:32768
    v_mfma_f32_16x16x32_bf16 v[116:119], v[80:83], a[180:183], v[116:119]
    ds_read_b64_tr_b16 v[50:51], v40 offset:36864
    buffer_load_dwordx4 a[144:147], v6, s[12:15], s67 offen offset:0 sc1
    v_mfma_f32_16x16x32_bf16 v[120:123], v[80:83], a[184:187], v[120:123]
    ds_read_b64_tr_b16 v[52:53], v41 offset:32768
    v_mfma_f32_16x16x32_bf16 v[124:127], v[80:83], a[188:191], v[124:127]
    ds_read_b64_tr_b16 v[54:55], v41 offset:36864
    v_mfma_f32_16x16x32_bf16 v[128:131], v[84:87], a[176:179], v[128:131]
    v_mfma_f32_16x16x32_bf16 v[132:135], v[84:87], a[180:183], v[132:135]
    ds_read_b64_tr_b16 v[56:57], v42 offset:32768
    v_mfma_f32_16x16x32_bf16 v[136:139], v[84:87], a[184:187], v[136:139]
    ds_read_b64_tr_b16 v[58:59], v42 offset:36864
    v_mfma_f32_16x16x32_bf16 v[140:143], v[84:87], a[188:191], v[140:143]
    ds_read_b64_tr_b16 v[60:61], v43 offset:32768
    v_mfma_f32_16x16x32_bf16 v[144:147], v[88:91], a[176:179], v[144:147]
    ds_read_b64_tr_b16 v[62:63], v43 offset:36864
    buffer_load_dwordx4 a[148:151], v6, s[12:15], s67 offen offset:1024 sc1
    v_mfma_f32_16x16x32_bf16 v[148:151], v[88:91], a[180:183], v[148:151]
    v_mfma_f32_16x16x32_bf16 v[152:155], v[88:91], a[184:187], v[152:155]
    ds_read_b64_tr_b16 v[64:65], v44 offset:32768
    v_mfma_f32_16x16x32_bf16 v[156:159], v[88:91], a[188:191], v[156:159]
    ds_read_b64_tr_b16 v[66:67], v44 offset:36864
    v_mfma_f32_16x16x32_bf16 v[160:163], v[92:95], a[176:179], v[160:163]
    ds_read_b64_tr_b16 v[68:69], v45 offset:32768
    v_mfma_f32_16x16x32_bf16 v[164:167], v[92:95], a[180:183], v[164:167]
    ds_read_b64_tr_b16 v[70:71], v45 offset:36864
    v_mfma_f32_16x16x32_bf16 v[168:171], v[92:95], a[184:187], v[168:171]
    v_mfma_f32_16x16x32_bf16 v[172:175], v[92:95], a[188:191], v[172:175]
    ds_read_b64_tr_b16 v[72:73], v46 offset:32768
    v_mfma_f32_16x16x32_bf16 v[176:179], v[96:99], a[176:179], v[176:179]
    ds_read_b64_tr_b16 v[74:75], v46 offset:36864
    buffer_load_dwordx4 a[152:155], v6, s[12:15], s67 offen offset:2048 sc1
    v_mfma_f32_16x16x32_bf16 v[180:183], v[96:99], a[180:183], v[180:183]
    ds_read_b64_tr_b16 v[76:77], v47 offset:32768
    v_mfma_f32_16x16x32_bf16 v[184:187], v[96:99], a[184:187], v[184:187]
    ds_read_b64_tr_b16 v[78:79], v47 offset:36864
    v_mfma_f32_16x16x32_bf16 v[188:191], v[96:99], a[188:191], v[188:191]
    v_mfma_f32_16x16x32_bf16 v[192:195], v[100:103], a[176:179], v[192:195]
    v_mfma_f32_16x16x32_bf16 v[196:199], v[100:103], a[180:183], v[196:199]
    v_mfma_f32_16x16x32_bf16 v[200:203], v[100:103], a[184:187], v[200:203]
    v_mfma_f32_16x16x32_bf16 v[204:207], v[100:103], a[188:191], v[204:207]
    v_mfma_f32_16x16x32_bf16 v[208:211], v[104:107], a[176:179], v[208:211]
    buffer_load_dwordx4 a[156:159], v6, s[12:15], s67 offen offset:3072 sc1
    v_mfma_f32_16x16x32_bf16 v[212:215], v[104:107], a[180:183], v[212:215]
    v_mfma_f32_16x16x32_bf16 v[216:219], v[104:107], a[184:187], v[216:219]
    v_mfma_f32_16x16x32_bf16 v[220:223], v[104:107], a[188:191], v[220:223]
    v_mfma_f32_16x16x32_bf16 v[224:227], v[108:111], a[176:179], v[224:227]
    v_mfma_f32_16x16x32_bf16 v[228:231], v[108:111], a[180:183], v[228:231]
    v_mfma_f32_16x16x32_bf16 v[232:235], v[108:111], a[184:187], v[232:235]
    v_mfma_f32_16x16x32_bf16 v[236:239], v[108:111], a[188:191], v[236:239]
    s_add_u32 s67, s67, 131072
    s_sub_u32 s70, s70, 1
    s_cmp_eq_u32 s70, 0
    s_waitcnt lgkmcnt(0)
    s_cbranch_scc0 kms_qloop
    v_mfma_f32_16x16x32_bf16 v[112:115], v[48:51], a[192:195], v[112:115]
    ds_read_b64_tr_b16 v[80:81], v40 offset:40960
    v_mfma_f32_16x16x32_bf16 v[116:119], v[48:51], a[196:199], v[116:119]
    ds_read_b64_tr_b16 v[82:83], v40 offset:45056
    s_add_u32 m0, s68, 98304
    s_add_u32 s66, s66, 524288
    v_mfma_f32_16x16x32_bf16 v[120:123], v[48:51], a[200:203], v[120:123]
    ds_read_b64_tr_b16 v[84:85], v41 offset:40960
    buffer_load_dwordx4 v2, s[8:11], s66 offen offset:0 lds
    v_mfma_f32_16x16x32_bf16 v[124:127], v[48:51], a[204:207], v[124:127]
    ds_read_b64_tr_b16 v[86:87], v41 offset:45056
    v_mfma_f32_16x16x32_bf16 v[128:131], v[52:55], a[192:195], v[128:131]
    buffer_load_dwordx4 v3, s[8:11], s66 offen offset:1024 lds
    v_mfma_f32_16x16x32_bf16 v[132:135], v[52:55], a[196:199], v[132:135]
    ds_read_b64_tr_b16 v[88:89], v42 offset:40960
    v_mfma_f32_16x16x32_bf16 v[136:139], v[52:55], a[200:203], v[136:139]
    ds_read_b64_tr_b16 v[90:91], v42 offset:45056
    v_mfma_f32_16x16x32_bf16 v[140:143], v[52:55], a[204:207], v[140:143]
    ds_read_b64_tr_b16 v[92:93], v43 offset:40960
    v_mfma_f32_16x16x32_bf16 v[144:147], v[56:59], a[192:195], v[144:147]
    ds_read_b64_tr_b16 v[94:95], v43 offset:45056
    buffer_load_dwordx4 v4, s[8:11], s66 offen offset:2048 lds
    v_mfma_f32_16x16x32_bf16 v[148:151], v[56:59], a[196:199], v[148:151]
    v_mfma_f32_16x16x32_bf16 v[152:155], v[56:59], a[200:203], v[152:155]
    ds_read_b64_tr_b16 v[96:97], v44 offset:40960
    v_mfma_f32_16x16x32_bf16 v[156:159], v[56:59], a[204:207], v[156:159]
    ds_read_b64_tr_b16 v[98:99], v44 offset:45056
    v_mfma_f32_16x16x32_bf16 v[160:163], v[60:63], a[192:195], v[160:163]
    ds_read_b64_tr_b16 v[100:101], v45 offset:40960
    buffer_load_dwordx4 v5, s[8:11], s66 offen offset:3072 lds
    v_mfma_f32_16x16x32_bf16 v[164:167], v[60:63], a[196:199], v[164:167]
    ds_read_b64_tr_b16 v[102:103], v45 offset:45056
    v_mfma_f32_16x16x32_bf16 v[168:171], v[60:63], a[200:203], v[168:171]
    v_mfma_f32_16x16x32_bf16 v[172:175], v[60:63], a[204:207], v[172:175]
    ds_read_b64_tr_b16 v[104:105], v46 offset:40960
    v_mfma_f32_16x16x32_bf16 v[176:179], v[64:67], a[192:195], v[176:179]
    ds_read_b64_tr_b16 v[106:107], v46 offset:45056
    buffer_load_dwordx4 a[160:163], v6, s[12:15], s67 offen offset:0 sc1
    v_mfma_f32_16x16x32_bf16 v[180:183], v[64:67], a[196:199], v[180:183]
    ds_read_b64_tr_b16 v[108:109], v47 offset:40960
    v_mfma_f32_16x16x32_bf16 v[184:187], v[64:67], a[200:203], v[184:187]
    ds_read_b64_tr_b16 v[110:111], v47 offset:45056
    v_mfma_f32_16x16x32_bf16 v[188:191], v[64:67], a[204:207], v[188:191]
    v_mfma_f32_16x16x32_bf16 v[192:195], v[68:71], a[192:195], v[192:195]
    buffer_load_dwordx4 a[164:167], v6, s[12:15], s67 offen offset:1024 sc1
    v_mfma_f32_16x16x32_bf16 v[196:199], v[68:71], a[196:199], v[196:199]
    v_mfma_f32_16x16x32_bf16 v[200:203], v[68:71], a[200:203], v[200:203]
    v_mfma_f32_16x16x32_bf16 v[204:207], v[68:71], a[204:207], v[204:207]
    v_mfma_f32_16x16x32_bf16 v[208:211], v[72:75], a[192:195], v[208:211]
    buffer_load_dwordx4 a[168:171], v6, s[12:15], s67 offen offset:2048 sc1
    v_mfma_f32_16x16x32_bf16 v[212:215], v[72:75], a[196:199], v[212:215]
    v_mfma_f32_16x16x32_bf16 v[216:219], v[72:75], a[200:203], v[216:219]
    v_mfma_f32_16x16x32_bf16 v[220:223], v[72:75], a[204:207], v[220:223]
    v_mfma_f32_16x16x32_bf16 v[224:227], v[76:79], a[192:195], v[224:227]
    buffer_load_dwordx4 a[172:175], v6, s[12:15], s67 offen offset:3072 sc1
    v_mfma_f32_16x16x32_bf16 v[228:231], v[76:79], a[196:199], v[228:231]
    v_mfma_f32_16x16x32_bf16 v[232:235], v[76:79], a[200:203], v[232:235]
    v_mfma_f32_16x16x32_bf16 v[236:239], v[76:79], a[204:207], v[236:239]
    s_add_u32 s67, s67, 131072
    s_waitcnt vmcnt(20) lgkmcnt(0)
    s_barrier
    v_mfma_f32_16x16x32_bf16 v[112:115], v[80:83], a[208:211], v[112:115]
    ds_read_b64_tr_b16 v[48:49], v40 offset:49152
    v_mfma_f32_16x16x32_bf16 v[116:119], v[80:83], a[212:215], v[116:119]
    ds_read_b64_tr_b16 v[50:51], v40 offset:53248
    buffer_load_dwordx4 a[176:179], v6, s[12:15], s67 offen offset:0 sc1
    v_mfma_f32_16x16x32_bf16 v[120:123], v[80:83], a[216:219], v[120:123]
    ds_read_b64_tr_b16 v[52:53], v41 offset:49152
    v_mfma_f32_16x16x32_bf16 v[124:127], v[80:83], a[220:223], v[124:127]
    ds_read_b64_tr_b16 v[54:55], v41 offset:53248
    v_mfma_f32_16x16x32_bf16 v[128:131], v[84:87], a[208:211], v[128:131]
    v_mfma_f32_16x16x32_bf16 v[132:135], v[84:87], a[212:215], v[132:135]
    ds_read_b64_tr_b16 v[56:57], v42 offset:49152
    v_mfma_f32_16x16x32_bf16 v[136:139], v[84:87], a[216:219], v[136:139]
    ds_read_b64_tr_b16 v[58:59], v42 offset:53248
    v_mfma_f32_16x16x32_bf16 v[140:143], v[84:87], a[220:223], v[140:143]
    ds_read_b64_tr_b16 v[60:61], v43 offset:49152
    v_mfma_f32_16x16x32_bf16 v[144:147], v[88:91], a[208:211], v[144:147]
    ds_read_b64_tr_b16 v[62:63], v43 offset:53248
    buffer_load_dwordx4 a[180:183], v6, s[12:15], s67 offen offset:1024 sc1
    v_mfma_f32_16x16x32_bf16 v[148:151], v[88:91], a[212:215], v[148:151]
    v_mfma_f32_16x16x32_bf16 v[152:155], v[88:91], a[216:219], v[152:155]
    ds_read_b64_tr_b16 v[64:65], v44 offset:49152
    v_mfma_f32_16x16x32_bf16 v[156:159], v[88:91], a[220:223], v[156:159]
    ds_read_b64_tr_b16 v[66:67], v44 offset:53248
    v_mfma_f32_16x16x32_bf16 v[160:163], v[92:95], a[208:211], v[160:163]
    ds_read_b64_tr_b16 v[68:69], v45 offset:49152
    v_mfma_f32_16x16x32_bf16 v[164:167], v[92:95], a[212:215], v[164:167]
    ds_read_b64_tr_b16 v[70:71], v45 offset:53248
    v_mfma_f32_16x16x32_bf16 v[168:171], v[92:95], a[216:219], v[168:171]
    v_mfma_f32_16x16x32_bf16 v[172:175], v[92:95], a[220:223], v[172:175]
    ds_read_b64_tr_b16 v[72:73], v46 offset:49152
    v_mfma_f32_16x16x32_bf16 v[176:179], v[96:99], a[208:211], v[176:179]
    ds_read_b64_tr_b16 v[74:75], v46 offset:53248
    buffer_load_dwordx4 a[184:187], v6, s[12:15], s67 offen offset:2048 sc1
    v_mfma_f32_16x16x32_bf16 v[180:183], v[96:99], a[212:215], v[180:183]
    ds_read_b64_tr_b16 v[76:77], v47 offset:49152
    v_mfma_f32_16x16x32_bf16 v[184:187], v[96:99], a[216:219], v[184:187]
    ds_read_b64_tr_b16 v[78:79], v47 offset:53248
    v_mfma_f32_16x16x32_bf16 v[188:191], v[96:99], a[220:223], v[188:191]
    v_mfma_f32_16x16x32_bf16 v[192:195], v[100:103], a[208:211], v[192:195]
    v_mfma_f32_16x16x32_bf16 v[196:199], v[100:103], a[212:215], v[196:199]
    v_mfma_f32_16x16x32_bf16 v[200:203], v[100:103], a[216:219], v[200:203]
    v_mfma_f32_16x16x32_bf16 v[204:207], v[100:103], a[220:223], v[204:207]
    v_mfma_f32_16x16x32_bf16 v[208:211], v[104:107], a[208:211], v[208:211]
    buffer_load_dwordx4 a[188:191], v6, s[12:15], s67 offen offset:3072 sc1
    v_mfma_f32_16x16x32_bf16 v[212:215], v[104:107], a[212:215], v[212:215]
    v_mfma_f32_16x16x32_bf16 v[216:219], v[104:107], a[216:219], v[216:219]
    v_mfma_f32_16x16x32_bf16 v[220:223], v[104:107], a[220:223], v[220:223]
    v_mfma_f32_16x16x32_bf16 v[224:227], v[108:111], a[208:211], v[224:227]
    v_mfma_f32_16x16x32_bf16 v[228:231], v[108:111], a[212:215], v[228:231]
    v_mfma_f32_16x16x32_bf16 v[232:235], v[108:111], a[216:219], v[232:235]
    v_mfma_f32_16x16x32_bf16 v[236:239], v[108:111], a[220:223], v[236:239]
    s_add_u32 s67, s67, 131072
    s_waitcnt lgkmcnt(0)
    v_mfma_f32_16x16x32_bf16 v[112:115], v[48:51], a[224:227], v[112:115]
    ds_read_b64_tr_b16 v[80:81], v40 offset:57344
    v_mfma_f32_16x16x32_bf16 v[116:119], v[48:51], a[228:231], v[116:119]
    ds_read_b64_tr_b16 v[82:83], v40 offset:61440
    s_add_u32 m0, s68, 0
    s_add_u32 s86, s68, 0
    v_mfma_f32_16x16x32_bf16 v[120:123], v[48:51], a[232:235], v[120:123]
    ds_read_b64_tr_b16 v[84:85], v41 offset:57344
    buffer_load_dwordx4 v20, s[16:19], s86 offen offset:0 lds
    v_mfma_f32_16x16x32_bf16 v[124:127], v[48:51], a[236:239], v[124:127]
    ds_read_b64_tr_b16 v[86:87], v41 offset:61440
    v_mfma_f32_16x16x32_bf16 v[128:131], v[52:55], a[224:227], v[128:131]
    v_mfma_f32_16x16x32_bf16 v[132:135], v[52:55], a[228:231], v[132:135]
    ds_read_b64_tr_b16 v[88:89], v42 offset:57344
    v_mfma_f32_16x16x32_bf16 v[136:139], v[52:55], a[232:235], v[136:139]
    ds_read_b64_tr_b16 v[90:91], v42 offset:61440
    v_mfma_f32_16x16x32_bf16 v[140:143], v[52:55], a[236:239], v[140:143]
    ds_read_b64_tr_b16 v[92:93], v43 offset:57344
    v_mfma_f32_16x16x32_bf16 v[144:147], v[56:59], a[224:227], v[144:147]
    ds_read_b64_tr_b16 v[94:95], v43 offset:61440
    buffer_load_dwordx4 v21, s[16:19], s86 offen offset:1024 lds
    v_mfma_f32_16x16x32_bf16 v[148:151], v[56:59], a[228:231], v[148:151]
    v_mfma_f32_16x16x32_bf16 v[152:155], v[56:59], a[232:235], v[152:155]
    ds_read_b64_tr_b16 v[96:97], v44 offset:57344
    v_mfma_f32_16x16x32_bf16 v[156:159], v[56:59], a[236:239], v[156:159]
    ds_read_b64_tr_b16 v[98:99], v44 offset:61440
    v_mfma_f32_16x16x32_bf16 v[160:163], v[60:63], a[224:227], v[160:163]
    ds_read_b64_tr_b16 v[100:101], v45 offset:57344
    v_mfma_f32_16x16x32_bf16 v[164:167], v[60:63], a[228:231], v[164:167]
    ds_read_b64_tr_b16 v[102:103], v45 offset:61440
    v_mfma_f32_16x16x32_bf16 v[168:171], v[60:63], a[232:235], v[168:171]
    v_mfma_f32_16x16x32_bf16 v[172:175], v[60:63], a[236:239], v[172:175]
    ds_read_b64_tr_b16 v[104:105], v46 offset:57344
    v_mfma_f32_16x16x32_bf16 v[176:179], v[64:67], a[224:227], v[176:179]
    ds_read_b64_tr_b16 v[106:107], v46 offset:61440
    buffer_load_dwordx4 v22, s[16:19], s86 offen offset:2048 lds
    v_mfma_f32_16x16x32_bf16 v[180:183], v[64:67], a[228:231], v[180:183]
    ds_read_b64_tr_b16 v[108:109], v47 offset:57344
    v_mfma_f32_16x16x32_bf16 v[184:187], v[64:67], a[232:235], v[184:187]
    ds_read_b64_tr_b16 v[110:111], v47 offset:61440
    v_mfma_f32_16x16x32_bf16 v[188:191], v[64:67], a[236:239], v[188:191]
    v_mfma_f32_16x16x32_bf16 v[192:195], v[68:71], a[224:227], v[192:195]
    v_mfma_f32_16x16x32_bf16 v[196:199], v[68:71], a[228:231], v[196:199]
    v_mfma_f32_16x16x32_bf16 v[200:203], v[68:71], a[232:235], v[200:203]
    v_mfma_f32_16x16x32_bf16 v[204:207], v[68:71], a[236:239], v[204:207]
    v_mfma_f32_16x16x32_bf16 v[208:211], v[72:75], a[224:227], v[208:211]
    buffer_load_dwordx4 v23, s[16:19], s86 offen offset:3072 lds
    v_mfma_f32_16x16x32_bf16 v[212:215], v[72:75], a[228:231], v[212:215]
    v_mfma_f32_16x16x32_bf16 v[216:219], v[72:75], a[232:235], v[216:219]
    v_mfma_f32_16x16x32_bf16 v[220:223], v[72:75], a[236:239], v[220:223]
    v_mfma_f32_16x16x32_bf16 v[224:227], v[76:79], a[224:227], v[224:227]
    v_mfma_f32_16x16x32_bf16 v[228:231], v[76:79], a[228:231], v[228:231]
    v_mfma_f32_16x16x32_bf16 v[232:235], v[76:79], a[232:235], v[232:235]
    v_mfma_f32_16x16x32_bf16 v[236:239], v[76:79], a[236:239], v[236:239]
    s_waitcnt vmcnt(16) lgkmcnt(0)
    s_barrier
    v_mfma_f32_16x16x32_bf16 v[112:115], v[80:83], a[240:243], v[112:115]
    ds_read_b64_tr_b16 v[48:49], v40 offset:16384
    v_mfma_f32_16x16x32_bf16 v[116:119], v[80:83], a[244:247], v[116:119]
    ds_read_b64_tr_b16 v[50:51], v40 offset:20480
    s_add_u32 m0, s68, 16384
    s_add_u32 s86, s68, 16384
    v_mfma_f32_16x16x32_bf16 v[120:123], v[80:83], a[248:251], v[120:123]
    ds_read_b64_tr_b16 v[52:53], v41 offset:16384
    buffer_load_dwordx4 v20, s[16:19], s86 offen offset:0 lds
    v_mfma_f32_16x16x32_bf16 v[124:127], v[80:83], a[252:255], v[124:127]
    ds_read_b64_tr_b16 v[54:55], v41 offset:20480
    v_mfma_f32_16x16x32_bf16 v[128:131], v[84:87], a[240:243], v[128:131]
    v_mfma_f32_16x16x32_bf16 v[132:135], v[84:87], a[244:247], v[132:135]
    ds_read_b64_tr_b16 v[56:57], v42 offset:16384
    v_mfma_f32_16x16x32_bf16 v[136:139], v[84:87], a[248:251], v[136:139]
    ds_read_b64_tr_b16 v[58:59], v42 offset:20480
    v_mfma_f32_16x16x32_bf16 v[140:143], v[84:87], a[252:255], v[140:143]
    ds_read_b64_tr_b16 v[60:61], v43 offset:16384
    v_mfma_f32_16x16x32_bf16 v[144:147], v[88:91], a[240:243], v[144:147]
    ds_read_b64_tr_b16 v[62:63], v43 offset:20480
    buffer_load_dwordx4 v21, s[16:19], s86 offen offset:1024 lds
    v_mfma_f32_16x16x32_bf16 v[148:151], v[88:91], a[244:247], v[148:151]
    v_mfma_f32_16x16x32_bf16 v[152:155], v[88:91], a[248:251], v[152:155]
    ds_read_b64_tr_b16 v[64:65], v44 offset:16384
    v_mfma_f32_16x16x32_bf16 v[156:159], v[88:91], a[252:255], v[156:159]
    ds_read_b64_tr_b16 v[66:67], v44 offset:20480
    v_mfma_f32_16x16x32_bf16 v[160:163], v[92:95], a[240:243], v[160:163]
    ds_read_b64_tr_b16 v[68:69], v45 offset:16384
    v_mfma_f32_16x16x32_bf16 v[164:167], v[92:95], a[244:247], v[164:167]
    ds_read_b64_tr_b16 v[70:71], v45 offset:20480
    v_mfma_f32_16x16x32_bf16 v[168:171], v[92:95], a[248:251], v[168:171]
    v_mfma_f32_16x16x32_bf16 v[172:175], v[92:95], a[252:255], v[172:175]
    ds_read_b64_tr_b16 v[72:73], v46 offset:16384
    v_mfma_f32_16x16x32_bf16 v[176:179], v[96:99], a[240:243], v[176:179]
    ds_read_b64_tr_b16 v[74:75], v46 offset:20480
    buffer_load_dwordx4 v22, s[16:19], s86 offen offset:2048 lds
    v_mfma_f32_16x16x32_bf16 v[180:183], v[96:99], a[244:247], v[180:183]
    ds_read_b64_tr_b16 v[76:77], v47 offset:16384
    v_mfma_f32_16x16x32_bf16 v[184:187], v[96:99], a[248:251], v[184:187]
    ds_read_b64_tr_b16 v[78:79], v47 offset:20480
    v_mfma_f32_16x16x32_bf16 v[188:191], v[96:99], a[252:255], v[188:191]
    v_mfma_f32_16x16x32_bf16 v[192:195], v[100:103], a[240:243], v[192:195]
    v_mfma_f32_16x16x32_bf16 v[196:199], v[100:103], a[244:247], v[196:199]
    v_mfma_f32_16x16x32_bf16 v[200:203], v[100:103], a[248:251], v[200:203]
    v_mfma_f32_16x16x32_bf16 v[204:207], v[100:103], a[252:255], v[204:207]
    v_mfma_f32_16x16x32_bf16 v[208:211], v[104:107], a[240:243], v[208:211]
    buffer_load_dwordx4 v23, s[16:19], s86 offen offset:3072 lds
    v_mfma_f32_16x16x32_bf16 v[212:215], v[104:107], a[244:247], v[212:215]
    v_mfma_f32_16x16x32_bf16 v[216:219], v[104:107], a[248:251], v[216:219]
    v_mfma_f32_16x16x32_bf16 v[220:223], v[104:107], a[252:255], v[220:223]
    v_mfma_f32_16x16x32_bf16 v[224:227], v[108:111], a[240:243], v[224:227]
    v_mfma_f32_16x16x32_bf16 v[228:231], v[108:111], a[244:247], v[228:231]
    v_mfma_f32_16x16x32_bf16 v[232:235], v[108:111], a[248:251], v[232:235]
    v_mfma_f32_16x16x32_bf16 v[236:239], v[108:111], a[252:255], v[236:239]
    s_waitcnt lgkmcnt(0)
    v_mfma_f32_16x16x32_bf16 v[112:115], v[48:51], a[128:131], v[112:115]
    ds_read_b64_tr_b16 v[80:81], v40 offset:24576
    v_mfma_f32_16x16x32_bf16 v[116:119], v[48:51], a[132:135], v[116:119]
    ds_read_b64_tr_b16 v[82:83], v40 offset:28672
    s_add_u32 m0, s68, 65536
    s_add_u32 s86, s68, 0
    v_mfma_f32_16x16x32_bf16 v[120:123], v[48:51], a[136:139], v[120:123]
    ds_read_b64_tr_b16 v[84:85], v41 offset:24576
    buffer_load_dwordx4 v24, s[20:23], s86 offen offset:0 lds
    v_mfma_f32_16x16x32_bf16 v[124:127], v[48:51], a[140:143], v[124:127]
    ds_read_b64_tr_b16 v[86:87], v41 offset:28672
    v_mfma_f32_16x16x32_bf16 v[128:131], v[52:55], a[128:131], v[128:131]
    v_mfma_f32_16x16x32_bf16 v[132:135], v[52:55], a[132:135], v[132:135]
    ds_read_b64_tr_b16 v[88:89], v42 offset:24576
    v_mfma_f32_16x16x32_bf16 v[136:139], v[52:55], a[136:139], v[136:139]
    ds_read_b64_tr_b16 v[90:91], v42 offset:28672
    v_mfma_f32_16x16x32_bf16 v[140:143], v[52:55], a[140:143], v[140:143]
    ds_read_b64_tr_b16 v[92:93], v43 offset:24576
    v_mfma_f32_16x16x32_bf16 v[144:147], v[56:59], a[128:131], v[144:147]
    ds_read_b64_tr_b16 v[94:95], v43 offset:28672
    buffer_load_dwordx4 v24, s[20:23], s86 offen offset:1024 lds
    v_mfma_f32_16x16x32_bf16 v[148:151], v[56:59], a[132:135], v[148:151]
    v_mfma_f32_16x16x32_bf16 v[152:155], v[56:59], a[136:139], v[152:155]
    ds_read_b64_tr_b16 v[96:97], v44 offset:24576
    v_mfma_f32_16x16x32_bf16 v[156:159], v[56:59], a[140:143], v[156:159]
    ds_read_b64_tr_b16 v[98:99], v44 offset:28672
    v_mfma_f32_16x16x32_bf16 v[160:163], v[60:63], a[128:131], v[160:163]
    ds_read_b64_tr_b16 v[100:101], v45 offset:24576
    v_mfma_f32_16x16x32_bf16 v[164:167], v[60:63], a[132:135], v[164:167]
    ds_read_b64_tr_b16 v[102:103], v45 offset:28672
    v_mfma_f32_16x16x32_bf16 v[168:171], v[60:63], a[136:139], v[168:171]
    v_mfma_f32_16x16x32_bf16 v[172:175], v[60:63], a[140:143], v[172:175]
    ds_read_b64_tr_b16 v[104:105], v46 offset:24576
    v_mfma_f32_16x16x32_bf16 v[176:179], v[64:67], a[128:131], v[176:179]
    ds_read_b64_tr_b16 v[106:107], v46 offset:28672
    buffer_load_dwordx4 v24, s[20:23], s86 offen offset:2048 lds
    v_mfma_f32_16x16x32_bf16 v[180:183], v[64:67], a[132:135], v[180:183]
    ds_read_b64_tr_b16 v[108:109], v47 offset:24576
    v_mfma_f32_16x16x32_bf16 v[184:187], v[64:67], a[136:139], v[184:187]
    ds_read_b64_tr_b16 v[110:111], v47 offset:28672
    v_mfma_f32_16x16x32_bf16 v[188:191], v[64:67], a[140:143], v[188:191]
    v_mfma_f32_16x16x32_bf16 v[192:195], v[68:71], a[128:131], v[192:195]
    v_mfma_f32_16x16x32_bf16 v[196:199], v[68:71], a[132:135], v[196:199]
    v_mfma_f32_16x16x32_bf16 v[200:203], v[68:71], a[136:139], v[200:203]
    v_mfma_f32_16x16x32_bf16 v[204:207], v[68:71], a[140:143], v[204:207]
    v_mfma_f32_16x16x32_bf16 v[208:211], v[72:75], a[128:131], v[208:211]
    buffer_load_dwordx4 v24, s[20:23], s86 offen offset:3072 lds
    v_mfma_f32_16x16x32_bf16 v[212:215], v[72:75], a[132:135], v[212:215]
    v_mfma_f32_16x16x32_bf16 v[216:219], v[72:75], a[136:139], v[216:219]
    v_mfma_f32_16x16x32_bf16 v[220:223], v[72:75], a[140:143], v[220:223]
    v_mfma_f32_16x16x32_bf16 v[224:227], v[76:79], a[128:131], v[224:227]
    v_mfma_f32_16x16x32_bf16 v[228:231], v[76:79], a[132:135], v[228:231]
    v_mfma_f32_16x16x32_bf16 v[232:235], v[76:79], a[136:139], v[232:235]
    v_mfma_f32_16x16x32_bf16 v[236:239], v[76:79], a[140:143], v[236:239]
    s_waitcnt vmcnt(12) lgkmcnt(0)
    s_barrier
    v_mfma_f32_16x16x32_bf16 v[112:115], v[80:83], a[144:147], v[112:115]
    ds_read_b64_tr_b16 v[48:49], v40 offset:0
    v_mfma_f32_16x16x32_bf16 v[116:119], v[80:83], a[148:151], v[116:119]
    ds_read_b64_tr_b16 v[50:51], v40 offset:4096
    s_add_u32 m0, s68, 32768
    s_add_u32 s86, s68, 32768
    v_mfma_f32_16x16x32_bf16 v[120:123], v[80:83], a[152:155], v[120:123]
    ds_read_b64_tr_b16 v[52:53], v41 offset:0
    buffer_load_dwordx4 v20, s[16:19], s86 offen offset:0 lds
    v_mfma_f32_16x16x32_bf16 v[124:127], v[80:83], a[156:159], v[124:127]
    ds_read_b64_tr_b16 v[54:55], v41 offset:4096
    v_mfma_f32_16x16x32_bf16 v[128:131], v[84:87], a[144:147], v[128:131]
    v_mfma_f32_16x16x32_bf16 v[132:135], v[84:87], a[148:151], v[132:135]
    ds_read_b64_tr_b16 v[56:57], v42 offset:0
    v_mfma_f32_16x16x32_bf16 v[136:139], v[84:87], a[152:155], v[136:139]
    ds_read_b64_tr_b16 v[58:59], v42 offset:4096
    v_mfma_f32_16x16x32_bf16 v[140:143], v[84:87], a[156:159], v[140:143]
    ds_read_b64_tr_b16 v[60:61], v43 offset:0
    v_mfma_f32_16x16x32_bf16 v[144:147], v[88:91], a[144:147], v[144:147]
    ds_read_b64_tr_b16 v[62:63], v43 offset:4096
    buffer_load_dwordx4 v21, s[16:19], s86 offen offset:1024 lds
    v_mfma_f32_16x16x32_bf16 v[148:151], v[88:91], a[148:151], v[148:151]
    v_mfma_f32_16x16x32_bf16 v[152:155], v[88:91], a[152:155], v[152:155]
    ds_read_b64_tr_b16 v[64:65], v44 offset:0
    v_mfma_f32_16x16x32_bf16 v[156:159], v[88:91], a[156:159], v[156:159]
    ds_read_b64_tr_b16 v[66:67], v44 offset:4096
    v_mfma_f32_16x16x32_bf16 v[160:163], v[92:95], a[144:147], v[160:163]
    ds_read_b64_tr_b16 v[68:69], v45 offset:0
    v_mfma_f32_16x16x32_bf16 v[164:167], v[92:95], a[148:151], v[164:167]
    ds_read_b64_tr_b16 v[70:71], v45 offset:4096
    v_mfma_f32_16x16x32_bf16 v[168:171], v[92:95], a[152:155], v[168:171]
    v_mfma_f32_16x16x32_bf16 v[172:175], v[92:95], a[156:159], v[172:175]
    ds_read_b64_tr_b16 v[72:73], v46 offset:0
    v_mfma_f32_16x16x32_bf16 v[176:179], v[96:99], a[144:147], v[176:179]
    ds_read_b64_tr_b16 v[74:75], v46 offset:4096
    buffer_load_dwordx4 v22, s[16:19], s86 offen offset:2048 lds
    v_mfma_f32_16x16x32_bf16 v[180:183], v[96:99], a[148:151], v[180:183]
    ds_read_b64_tr_b16 v[76:77], v47 offset:0
    v_mfma_f32_16x16x32_bf16 v[184:187], v[96:99], a[152:155], v[184:187]
    ds_read_b64_tr_b16 v[78:79], v47 offset:4096
    v_mfma_f32_16x16x32_bf16 v[188:191], v[96:99], a[156:159], v[188:191]
    v_mfma_f32_16x16x32_bf16 v[192:195], v[100:103], a[144:147], v[192:195]
    v_mfma_f32_16x16x32_bf16 v[196:199], v[100:103], a[148:151], v[196:199]
    v_mfma_f32_16x16x32_bf16 v[200:203], v[100:103], a[152:155], v[200:203]
    v_mfma_f32_16x16x32_bf16 v[204:207], v[100:103], a[156:159], v[204:207]
    v_mfma_f32_16x16x32_bf16 v[208:211], v[104:107], a[144:147], v[208:211]
    buffer_load_dwordx4 v23, s[16:19], s86 offen offset:3072 lds
    v_mfma_f32_16x16x32_bf16 v[212:215], v[104:107], a[148:151], v[212:215]
    v_mfma_f32_16x16x32_bf16 v[216:219], v[104:107], a[152:155], v[216:219]
    v_mfma_f32_16x16x32_bf16 v[220:223], v[104:107], a[156:159], v[220:223]
    v_mfma_f32_16x16x32_bf16 v[224:227], v[108:111], a[144:147], v[224:227]
    v_mfma_f32_16x16x32_bf16 v[228:231], v[108:111], a[148:151], v[228:231]
    v_mfma_f32_16x16x32_bf16 v[232:235], v[108:111], a[152:155], v[232:235]
    v_mfma_f32_16x16x32_bf16 v[236:239], v[108:111], a[156:159], v[236:239]
    s_waitcnt lgkmcnt(0)
    v_mfma_f32_16x16x32_bf16 v[112:115], v[48:51], a[160:163], v[112:115]
    ds_read_b64_tr_b16 v[80:81], v40 offset:8192
    v_mfma_f32_16x16x32_bf16 v[116:119], v[48:51], a[164:167], v[116:119]
    ds_read_b64_tr_b16 v[82:83], v40 offset:12288
    s_add_u32 m0, s68, 81920
    s_add_u32 s86, s68, 16384
    v_mfma_f32_16x16x32_bf16 v[120:123], v[48:51], a[168:171], v[120:123]
    ds_read_b64_tr_b16 v[84:85], v41 offset:8192
    buffer_load_dwordx4 v24, s[20:23], s86 offen offset:0 lds
    v_mfma_f32_16x16x32_bf16 v[124:127], v[48:51], a[172:175], v[124:127]
    ds_read_b64_tr_b16 v[86:87], v41 offset:12288
    v_mfma_f32_16x16x32_bf16 v[128:131], v[52:55], a[160:163], v[128:131]
    v_mfma_f32_16x16x32_bf16 v[132:135], v[52:55], a[164:167], v[132:135]
    ds_read_b64_tr_b16 v[88:89], v42 offset:8192
    v_mfma_f32_16x16x32_bf16 v[136:139], v[52:55], a[168:171], v[136:139]
    ds_read_b64_tr_b16 v[90:91], v42 offset:12288
    v_mfma_f32_16x16x32_bf16 v[140:143], v[52:55], a[172:175], v[140:143]
    ds_read_b64_tr_b16 v[92:93], v43 offset:8192
    v_mfma_f32_16x16x32_bf16 v[144:147], v[56:59], a[160:163], v[144:147]
    ds_read_b64_tr_b16 v[94:95], v43 offset:12288
    buffer_load_dwordx4 v24, s[20:23], s86 offen offset:1024 lds
    v_mfma_f32_16x16x32_bf16 v[148:151], v[56:59], a[164:167], v[148:151]
    v_mfma_f32_16x16x32_bf16 v[152:155], v[56:59], a[168:171], v[152:155]
    ds_read_b64_tr_b16 v[96:97], v44 offset:8192
    v_mfma_f32_16x16x32_bf16 v[156:159], v[56:59], a[172:175], v[156:159]
    ds_read_b64_tr_b16 v[98:99], v44 offset:12288
    v_mfma_f32_16x16x32_bf16 v[160:163], v[60:63], a[160:163], v[160:163]
    ds_read_b64_tr_b16 v[100:101], v45 offset:8192
    v_mfma_f32_16x16x32_bf16 v[164:167], v[60:63], a[164:167], v[164:167]
    ds_read_b64_tr_b16 v[102:103], v45 offset:12288
    v_mfma_f32_16x16x32_bf16 v[168:171], v[60:63], a[168:171], v[168:171]
    v_mfma_f32_16x16x32_bf16 v[172:175], v[60:63], a[172:175], v[172:175]
    ds_read_b64_tr_b16 v[104:105], v46 offset:8192
    v_mfma_f32_16x16x32_bf16 v[176:179], v[64:67], a[160:163], v[176:179]
    ds_read_b64_tr_b16 v[106:107], v46 offset:12288
    buffer_load_dwordx4 v24, s[20:23], s86 offen offset:2048 lds
    v_mfma_f32_16x16x32_bf16 v[180:183], v[64:67], a[164:167], v[180:183]
    ds_read_b64_tr_b16 v[108:109], v47 offset:8192
    v_mfma_f32_16x16x32_bf16 v[184:187], v[64:67], a[168:171], v[184:187]
    ds_read_b64_tr_b16 v[110:111], v47 offset:12288
    v_mfma_f32_16x16x32_bf16 v[188:191], v[64:67], a[172:175], v[188:191]
    v_mfma_f32_16x16x32_bf16 v[192:195], v[68:71], a[160:163], v[192:195]
    v_mfma_f32_16x16x32_bf16 v[196:199], v[68:71], a[164:167], v[196:199]
    v_mfma_f32_16x16x32_bf16 v[200:203], v[68:71], a[168:171], v[200:203]
    v_mfma_f32_16x16x32_bf16 v[204:207], v[68:71], a[172:175], v[204:207]
    v_mfma_f32_16x16x32_bf16 v[208:211], v[72:75], a[160:163], v[208:211]
    buffer_load_dwordx4 v24, s[20:23], s86 offen offset:3072 lds
    v_mfma_f32_16x16x32_bf16 v[212:215], v[72:75], a[164:167], v[212:215]
    v_mfma_f32_16x16x32_bf16 v[216:219], v[72:75], a[168:171], v[216:219]
    v_mfma_f32_16x16x32_bf16 v[220:223], v[72:75], a[172:175], v[220:223]
    v_mfma_f32_16x16x32_bf16 v[224:227], v[76:79], a[160:163], v[224:227]
    v_mfma_f32_16x16x32_bf16 v[228:231], v[76:79], a[164:167], v[228:231]
    v_mfma_f32_16x16x32_bf16 v[232:235], v[76:79], a[168:171], v[232:235]
    v_mfma_f32_16x16x32_bf16 v[236:239], v[76:79], a[172:175], v[236:239]
    s_waitcnt vmcnt(8) lgkmcnt(0)
    s_barrier
    v_mfma_f32_16x16x32_bf16 v[112:115], v[80:83], a[176:179], v[112:115]
    v_mfma_f32_16x16x32_bf16 v[116:119], v[80:83], a[180:183], v[116:119]
    s_add_u32 m0, s68, 49152
    s_add_u32 s86, s68, 49152
    buffer_load_dwordx4 v20, s[16:19], s86 offen offset:0 lds
    v_mfma_f32_16x16x32_bf16 v[120:123], v[80:83], a[184:187], v[120:123]
    v_mfma_f32_16x16x32_bf16 v[124:127], v[80:83], a[188:191], v[124:127]
    v_mfma_f32_16x16x32_bf16 v[128:131], v[84:87], a[176:179], v[128:131]
    v_mfma_f32_16x16x32_bf16 v[132:135], v[84:87], a[180:183], v[132:135]
    v_mfma_f32_16x16x32_bf16 v[136:139], v[84:87], a[184:187], v[136:139]
    v_mfma_f32_16x16x32_bf16 v[140:143], v[84:87], a[188:191], v[140:143]
    v_mfma_f32_16x16x32_bf16 v[144:147], v[88:91], a[176:179], v[144:147]
    buffer_load_dwordx4 v21, s[16:19], s86 offen offset:1024 lds
    v_mfma_f32_16x16x32_bf16 v[148:151], v[88:91], a[180:183], v[148:151]
    v_mfma_f32_16x16x32_bf16 v[152:155], v[88:91], a[184:187], v[152:155]
    v_mfma_f32_16x16x32_bf16 v[156:159], v[88:91], a[188:191], v[156:159]
    v_mfma_f32_16x16x32_bf16 v[160:163], v[92:95], a[176:179], v[160:163]
    v_mfma_f32_16x16x32_bf16 v[164:167], v[92:95], a[180:183], v[164:167]
    v_mfma_f32_16x16x32_bf16 v[168:171], v[92:95], a[184:187], v[168:171]
    v_mfma_f32_16x16x32_bf16 v[172:175], v[92:95], a[188:191], v[172:175]
    v_mfma_f32_16x16x32_bf16 v[176:179], v[96:99], a[176:179], v[176:179]
    buffer_load_dwordx4 v22, s[16:19], s86 offen offset:2048 lds
    v_mfma_f32_16x16x32_bf16 v[180:183], v[96:99], a[180:183], v[180:183]
    v_mfma_f32_16x16x32_bf16 v[184:187], v[96:99], a[184:187], v[184:187]
    v_mfma_f32_16x16x32_bf16 v[188:191], v[96:99], a[188:191], v[188:191]
    v_mfma_f32_16x16x32_bf16 v[192:195], v[100:103], a[176:179], v[192:195]
    v_mfma_f32_16x16x32_bf16 v[196:199], v[100:103], a[180:183], v[196:199]
    v_mfma_f32_16x16x32_bf16 v[200:203], v[100:103], a[184:187], v[200:203]
    v_mfma_f32_16x16x32_bf16 v[204:207], v[100:103], a[188:191], v[204:207]
    v_mfma_f32_16x16x32_bf16 v[208:211], v[104:107], a[176:179], v[208:211]
    buffer_load_dwordx4 v23, s[16:19], s86 offen offset:3072 lds
    v_mfma_f32_16x16x32_bf16 v[212:215], v[104:107], a[180:183], v[212:215]
    v_mfma_f32_16x16x32_bf16 v[216:219], v[104:107], a[184:187], v[216:219]
    v_mfma_f32_16x16x32_bf16 v[220:223], v[104:107], a[188:191], v[220:223]
    v_mfma_f32_16x16x32_bf16 v[224:227], v[108:111], a[176:179], v[224:227]
    v_mfma_f32_16x16x32_bf16 v[228:231], v[108:111], a[180:183], v[228:231]
    v_mfma_f32_16x16x32_bf16 v[232:235], v[108:111], a[184:187], v[232:235]
    v_mfma_f32_16x16x32_bf16 v[236:239], v[108:111], a[188:191], v[236:239]
    ds_read_b128 a[128:131], v8 offset:0
    ds_read_b128 a[132:135], v9 offset:0
    ds_read_b128 a[136:139], v10 offset:0
    ds_read_b128 a[140:143], v11 offset:0
    ds_read_b128 a[144:147], v12 offset:0
    ds_read_b128 a[148:151], v13 offset:0
    ds_read_b128 a[152:155], v14 offset:0
    ds_read_b128 a[156:159], v15 offset:0
    s_add_u32 m0, s68, 98304
    s_add_u32 s86, s68, 32768
    buffer_load_dwordx4 v24, s[20:23], s86 offen offset:0 lds
    buffer_load_dwordx4 v24, s[20:23], s86 offen offset:1024 lds
    buffer_load_dwordx4 v24, s[20:23], s86 offen offset:2048 lds
    buffer_load_dwordx4 v24, s[20:23], s86 offen offset:3072 lds
    s_add_u32 m0, s68, 114688
    s_add_u32 s86, s68, 49152
    buffer_load_dwordx4 v24, s[20:23], s86 offen offset:0 lds
    buffer_load_dwordx4 v24, s[20:23], s86 offen offset:1024 lds
    buffer_load_dwordx4 v24, s[20:23], s86 offen offset:2048 lds
    buffer_load_dwordx4 v24, s[20:23], s86 offen offset:3072 lds
    s_mov_b32 s88, 0x3e0293ee
    s_mov_b32 s89, 0x3e0293ee
    v_mov_b32 v240, 0
    v_mov_b32 v241, 0
    v_mov_b32 v242, 0
    v_mov_b32 v243, 0
    v_pk_mul_f32 v[112:113], v[112:113], s[88:89]
    v_pk_mul_f32 v[114:115], v[114:115], s[88:89]
    v_pk_mul_f32 v[116:117], v[116:117], s[88:89]
    v_pk_mul_f32 v[118:119], v[118:119], s[88:89]
    v_cvt_pk_bf16_f32 v48, v112, v113
    v_cvt_pk_bf16_f32 v49, v114, v115
    v_cvt_pk_bf16_f32 v50, v116, v117
    v_cvt_pk_bf16_f32 v51, v118, v119
    v_pk_mul_f32 v[120:121], v[120:121], s[88:89]
    v_pk_mul_f32 v[122:123], v[122:123], s[88:89]
    v_pk_mul_f32 v[124:125], v[124:125], s[88:89]
    v_pk_mul_f32 v[126:127], v[126:127], s[88:89]
    v_permlane16_swap_b32 v48, v50
    v_permlane16_swap_b32 v49, v51
    v_cvt_pk_bf16_f32 v52, v120, v121
    v_cvt_pk_bf16_f32 v53, v122, v123
    v_cvt_pk_bf16_f32 v54, v124, v125
    v_cvt_pk_bf16_f32 v55, v126, v127
    v_pk_mul_f32 v[128:129], v[128:129], s[88:89]
    v_pk_mul_f32 v[130:131], v[130:131], s[88:89]
    v_pk_mul_f32 v[132:133], v[132:133], s[88:89]
    v_pk_mul_f32 v[134:135], v[134:135], s[88:89]
    v_permlane16_swap_b32 v52, v54
    v_permlane16_swap_b32 v53, v55
    v_cvt_pk_bf16_f32 v56, v128, v129
    v_cvt_pk_bf16_f32 v57, v130, v131
    v_cvt_pk_bf16_f32 v58, v132, v133
    v_cvt_pk_bf16_f32 v59, v134, v135
    v_pk_mul_f32 v[136:137], v[136:137], s[88:89]
    v_pk_mul_f32 v[138:139], v[138:139], s[88:89]
    v_pk_mul_f32 v[140:141], v[140:141], s[88:89]
    v_pk_mul_f32 v[142:143], v[142:143], s[88:89]
    v_permlane16_swap_b32 v56, v58
    v_permlane16_swap_b32 v57, v59
    v_cvt_pk_bf16_f32 v60, v136, v137
    v_cvt_pk_bf16_f32 v61, v138, v139
    v_cvt_pk_bf16_f32 v62, v140, v141
    v_cvt_pk_bf16_f32 v63, v142, v143
    v_pk_mul_f32 v[144:145], v[144:145], s[88:89]
    v_pk_mul_f32 v[146:147], v[146:147], s[88:89]
    v_pk_mul_f32 v[148:149], v[148:149], s[88:89]
    v_pk_mul_f32 v[150:151], v[150:151], s[88:89]
    v_permlane16_swap_b32 v60, v62
    v_permlane16_swap_b32 v61, v63
    v_cvt_pk_bf16_f32 v64, v144, v145
    v_cvt_pk_bf16_f32 v65, v146, v147
    v_cvt_pk_bf16_f32 v66, v148, v149
    v_cvt_pk_bf16_f32 v67, v150, v151
    v_pk_mul_f32 v[152:153], v[152:153], s[88:89]
    v_pk_mul_f32 v[154:155], v[154:155], s[88:89]
    v_pk_mul_f32 v[156:157], v[156:157], s[88:89]
    v_pk_mul_f32 v[158:159], v[158:159], s[88:89]
    v_permlane16_swap_b32 v64, v66
    v_permlane16_swap_b32 v65, v67
    v_cvt_pk_bf16_f32 v68, v152, v153
    v_cvt_pk_bf16_f32 v69, v154, v155
    v_cvt_pk_bf16_f32 v70, v156, v157
    v_cvt_pk_bf16_f32 v71, v158, v159
    v_pk_mul_f32 v[160:161], v[160:161], s[88:89]
    v_pk_mul_f32 v[162:163], v[162:163], s[88:89]
    v_pk_mul_f32 v[164:165], v[164:165], s[88:89]
    v_pk_mul_f32 v[166:167], v[166:167], s[88:89]
    v_permlane16_swap_b32 v68, v70
    v_permlane16_swap_b32 v69, v71
    v_cvt_pk_bf16_f32 v72, v160, v161
    v_cvt_pk_bf16_f32 v73, v162, v163
    v_cvt_pk_bf16_f32 v74, v164, v165
    v_cvt_pk_bf16_f32 v75, v166, v167
    v_pk_mul_f32 v[168:169], v[168:169], s[88:89]
    v_pk_mul_f32 v[170:171], v[170:171], s[88:89]
    v_pk_mul_f32 v[172:173], v[172:173], s[88:89]
    v_pk_mul_f32 v[174:175], v[174:175], s[88:89]
    v_permlane16_swap_b32 v72, v74
    v_permlane16_swap_b32 v73, v75
    v_cvt_pk_bf16_f32 v76, v168, v169
    v_cvt_pk_bf16_f32 v77, v170, v171
    v_cvt_pk_bf16_f32 v78, v172, v173
    v_cvt_pk_bf16_f32 v79, v174, v175
    v_pk_mul_f32 v[176:177], v[176:177], s[88:89]
    v_pk_mul_f32 v[178:179], v[178:179], s[88:89]
    v_pk_mul_f32 v[180:181], v[180:181], s[88:89]
    v_pk_mul_f32 v[182:183], v[182:183], s[88:89]
    v_permlane16_swap_b32 v76, v78
    v_permlane16_swap_b32 v77, v79
    v_cvt_pk_bf16_f32 v80, v176, v177
    v_cvt_pk_bf16_f32 v81, v178, v179
    v_cvt_pk_bf16_f32 v82, v180, v181
    v_cvt_pk_bf16_f32 v83, v182, v183
    v_pk_mul_f32 v[184:185], v[184:185], s[88:89]
    v_pk_mul_f32 v[186:187], v[186:187], s[88:89]
    v_pk_mul_f32 v[188:189], v[188:189], s[88:89]
    v_pk_mul_f32 v[190:191], v[190:191], s[88:89]
    v_permlane16_swap_b32 v80, v82
    v_permlane16_swap_b32 v81, v83
    v_cvt_pk_bf16_f32 v84, v184, v185
    v_cvt_pk_bf16_f32 v85, v186, v187
    v_cvt_pk_bf16_f32 v86, v188, v189
    v_cvt_pk_bf16_f32 v87, v190, v191
    v_pk_mul_f32 v[192:193], v[192:193], s[88:89]
    v_pk_mul_f32 v[194:195], v[194:195], s[88:89]
    v_pk_mul_f32 v[196:197], v[196:197], s[88:89]
    v_pk_mul_f32 v[198:199], v[198:199], s[88:89]
    v_permlane16_swap_b32 v84, v86
    v_permlane16_swap_b32 v85, v87
    v_cvt_pk_bf16_f32 v88, v192, v193
    v_cvt_pk_bf16_f32 v89, v194, v195
    v_cvt_pk_bf16_f32 v90, v196, v197
    v_cvt_pk_bf16_f32 v91, v198, v199
    v_pk_mul_f32 v[200:201], v[200:201], s[88:89]
    v_pk_mul_f32 v[202:203], v[202:203], s[88:89]
    v_pk_mul_f32 v[204:205], v[204:205], s[88:89]
    v_pk_mul_f32 v[206:207], v[206:207], s[88:89]
    v_permlane16_swap_b32 v88, v90
    v_permlane16_swap_b32 v89, v91
    v_cvt_pk_bf16_f32 v92, v200, v201
    v_cvt_pk_bf16_f32 v93, v202, v203
    v_cvt_pk_bf16_f32 v94, v204, v205
    v_cvt_pk_bf16_f32 v95, v206, v207
    v_pk_mul_f32 v[208:209], v[208:209], s[88:89]
    v_pk_mul_f32 v[210:211], v[210:211], s[88:89]
    v_pk_mul_f32 v[212:213], v[212:213], s[88:89]
    v_pk_mul_f32 v[214:215], v[214:215], s[88:89]
    v_permlane16_swap_b32 v92, v94
    v_permlane16_swap_b32 v93, v95
    v_cvt_pk_bf16_f32 v96, v208, v209
    v_cvt_pk_bf16_f32 v97, v210, v211
    v_cvt_pk_bf16_f32 v98, v212, v213
    v_cvt_pk_bf16_f32 v99, v214, v215
    v_pk_mul_f32 v[216:217], v[216:217], s[88:89]
    v_pk_mul_f32 v[218:219], v[218:219], s[88:89]
    v_pk_mul_f32 v[220:221], v[220:221], s[88:89]
    v_pk_mul_f32 v[222:223], v[222:223], s[88:89]
    v_permlane16_swap_b32 v96, v98
    v_permlane16_swap_b32 v97, v99
    v_cvt_pk_bf16_f32 v100, v216, v217
    v_cvt_pk_bf16_f32 v101, v218, v219
    v_cvt_pk_bf16_f32 v102, v220, v221
    v_cvt_pk_bf16_f32 v103, v222, v223
    v_pk_mul_f32 v[224:225], v[224:225], s[88:89]
    v_pk_mul_f32 v[226:227], v[226:227], s[88:89]
    v_pk_mul_f32 v[228:229], v[228:229], s[88:89]
    v_pk_mul_f32 v[230:231], v[230:231], s[88:89]
    v_permlane16_swap_b32 v100, v102
    v_permlane16_swap_b32 v101, v103
    v_cvt_pk_bf16_f32 v104, v224, v225
    v_cvt_pk_bf16_f32 v105, v226, v227
    v_cvt_pk_bf16_f32 v106, v228, v229
    v_cvt_pk_bf16_f32 v107, v230, v231
    v_pk_mul_f32 v[232:233], v[232:233], s[88:89]
    v_pk_mul_f32 v[234:235], v[234:235], s[88:89]
    v_pk_mul_f32 v[236:237], v[236:237], s[88:89]
    v_pk_mul_f32 v[238:239], v[238:239], s[88:89]
    v_permlane16_swap_b32 v104, v106
    v_permlane16_swap_b32 v105, v107
    v_cvt_pk_bf16_f32 v108, v232, v233
    v_cvt_pk_bf16_f32 v109, v234, v235
    v_cvt_pk_bf16_f32 v110, v236, v237
    v_cvt_pk_bf16_f32 v111, v238, v239
    s_nop 1
    v_permlane16_swap_b32 v108, v110
    v_permlane16_swap_b32 v109, v111
    s_waitcnt lgkmcnt(0)
    v_mfma_f32_32x32x16_bf16 v[112:127], a[128:131], v[48:51], 0
    s_lshl_b32 s84, s72, 14
    v_add_u32 v40, s84, v40
    v_add_u32 v41, s84, v41
    v_add_u32 v42, s84, v42
    v_add_u32 v43, s84, v43
    v_mfma_f32_32x32x16_bf16 v[128:143], a[128:131], v[52:55], 0
    v_add_u32 v44, s84, v44
    v_add_u32 v45, s84, v45
    v_add_u32 v46, s84, v46
    v_add_u32 v47, s84, v47
    s_lshl_b32 s84, s76, 8
    v_mfma_f32_32x32x16_bf16 v[112:127], a[132:135], v[56:59], v[112:127]
    v_lshrrev_b32 v246, 4, v1
    v_and_b32 v247, 15, v1
    v_add_u32 v248, 0, v246
    v_lshlrev_b32 v248, 1, v248
    v_xor_b32 v248, v248, v247
    v_mfma_f32_32x32x16_bf16 v[128:143], a[132:135], v[60:63], v[128:143]
    v_lshlrev_b32 v248, 4, v248
    v_add_u32 v249, 0, v246
    v_mul_u32_u24 v249, 7168, v249
    v_add3_u32 v2, v248, v249, s84
    v_add_u32 v248, 4, v246
    v_mfma_f32_32x32x16_bf16 v[112:127], a[136:139], v[64:67], v[112:127]
    v_lshlrev_b32 v248, 1, v248
    v_xor_b32 v248, v248, v247
    v_lshlrev_b32 v248, 4, v248
    v_add_u32 v249, 4, v246
    v_mul_u32_u24 v249, 7168, v249
    v_mfma_f32_32x32x16_bf16 v[128:143], a[136:139], v[68:71], v[128:143]
    v_add3_u32 v3, v248, v249, s84
    v_subrev_u32 v3, 1024, v3
    v_add_u32 v248, 0, v246
    v_lshlrev_b32 v248, 1, v248
    v_xor_b32 v248, v248, v247
    v_mfma_f32_32x32x16_bf16 v[112:127], a[140:143], v[72:75], v[112:127]
    v_lshlrev_b32 v248, 4, v248
    v_add_u32 v249, 8, v246
    v_mul_u32_u24 v249, 7168, v249
    v_add3_u32 v4, v248, v249, s84
    v_subrev_u32 v4, 2048, v4
    v_mfma_f32_32x32x16_bf16 v[128:143], a[140:143], v[76:79], v[128:143]
    v_add_u32 v248, 4, v246
    v_lshlrev_b32 v248, 1, v248
    v_xor_b32 v248, v248, v247
    v_lshlrev_b32 v248, 4, v248
    v_add_u32 v249, 12, v246
    v_mfma_f32_32x32x16_bf16 v[112:127], a[144:147], v[80:83], v[112:127]
    v_mul_u32_u24 v249, 7168, v249
    v_add3_u32 v5, v248, v249, s84
    v_subrev_u32 v5, 3072, v5
    s_lshl_b32 s84, s77, 1
    s_add_u32 s84, s84, s73
    v_mfma_f32_32x32x16_bf16 v[128:143], a[144:147], v[84:87], v[128:143]
    s_lshl_b32 s84, s84, 12
    v_add_u32 v6, s84, v7
    v_bfe_u32 v246, v6, 7, 3
    v_xor_b32 v246, 3, v246
    v_min_u32 v246, 1, v246
    v_mfma_f32_32x32x16_bf16 v[112:127], a[148:151], v[88:91], v[112:127]
    v_add_u32 v246, -1, v246
    v_and_b32 v246, 0x3fffe80, v246
    v_add_u32 v6, v6, v246
    s_lshl_b32 s84, s71, 11
    s_add_u32 s84, s84, 8192
    v_mfma_f32_32x32x16_bf16 v[128:143], a[148:151], v[92:95], v[128:143]
    v_add_u32 v26, s84, v7
    s_mul_i32 s66, s71, 229376
    s_add_u32 s66, s66, 0xfff3c000
    s_mul_i32 s67, s72, 131072
    s_mov_b32 s8, s52
    v_mfma_f32_32x32x16_bf16 v[112:127], a[152:155], v[96:99], v[112:127]
    s_mov_b32 s9, s53
    s_mov_b32 s10, 0xe00000
    s_mov_b32 s11, 0x00020000
    s_add_u32 s12, s64, 0x400000
    s_addc_u32 s13, s65, 0
    v_mfma_f32_32x32x16_bf16 v[128:143], a[152:155], v[100:103], v[128:143]
    s_mov_b32 s14, 0x4400000
    s_mov_b32 s15, 0x00020000
    v_mfma_f32_32x32x16_bf16 v[112:127], a[156:159], v[104:107], v[112:127]
    v_mfma_f32_32x32x16_bf16 v[128:143], a[156:159], v[108:111], v[128:143]
    ds_read_b128 a[128:131], v8 offset:8192
    ds_read_b128 a[132:135], v9 offset:8192
    ds_read_b128 a[136:139], v10 offset:8192
    ds_read_b128 a[140:143], v11 offset:8192
    ds_read_b128 a[144:147], v12 offset:8192
    ds_read_b128 a[148:151], v13 offset:8192
    ds_read_b128 a[152:155], v14 offset:8192
    ds_read_b128 a[156:159], v15 offset:8192
    s_nop 5
    v_max3_f32 v244, v112, v113, v114
    v_max3_f32 v244, v244, v115, v116
    v_max3_f32 v244, v244, v117, v118
    v_max3_f32 v244, v244, v119, v120
    v_max3_f32 v244, v244, v121, v122
    v_max3_f32 v244, v244, v123, v124
    v_max3_f32 v244, v244, v125, v126
    v_max_f32 v244, v244, v127
    v_max3_f32 v245, v128, v129, v130
    v_max3_f32 v245, v245, v131, v132
    v_max3_f32 v245, v245, v133, v134
    v_max3_f32 v245, v245, v135, v136
    v_max3_f32 v245, v245, v137, v138
    v_max3_f32 v245, v245, v139, v140
    v_max3_f32 v245, v245, v141, v142
    v_max_f32 v245, v245, v143
    v_mov_b32 v246, v244
    v_mov_b32 v247, v245
    s_nop 1
    v_permlane32_swap_b32 v244, v246
    v_permlane32_swap_b32 v245, v247
    s_nop 0
    v_max_f32 v244, v244, v246
    v_max_f32 v245, v245, v247
    v_sub_f32 v176, 0, v244
    v_sub_f32 v177, 0, v244
    v_sub_f32 v192, 0, v245
    v_sub_f32 v193, 0, v245
    v_mov_b64 v[178:179], v[176:177]
    v_mov_b64 v[180:181], v[176:177]
    v_mov_b64 v[182:183], v[176:177]
    v_mov_b64 v[184:185], v[176:177]
    v_mov_b64 v[186:187], v[176:177]
    v_mov_b64 v[188:189], v[176:177]
    v_mov_b64 v[190:191], v[176:177]
    v_mov_b64 v[194:195], v[192:193]
    v_mov_b64 v[196:197], v[192:193]
    v_mov_b64 v[198:199], v[192:193]
    v_mov_b64 v[200:201], v[192:193]
    v_mov_b64 v[202:203], v[192:193]
    v_mov_b64 v[204:205], v[192:193]
    v_mov_b64 v[206:207], v[192:193]
    v_pk_add_f32 v[112:113], v[112:113], v[176:177]
    v_pk_add_f32 v[114:115], v[114:115], v[176:177]
    v_pk_add_f32 v[116:117], v[116:117], v[176:177]
    v_pk_add_f32 v[118:119], v[118:119], v[176:177]
    v_pk_add_f32 v[120:121], v[120:121], v[176:177]
    v_pk_add_f32 v[122:123], v[122:123], v[176:177]
    v_pk_add_f32 v[124:125], v[124:125], v[176:177]
    v_pk_add_f32 v[126:127], v[126:127], v[176:177]
    v_pk_add_f32 v[128:129], v[128:129], v[192:193]
    v_pk_add_f32 v[130:131], v[130:131], v[192:193]
    v_pk_add_f32 v[132:133], v[132:133], v[192:193]
    v_pk_add_f32 v[134:135], v[134:135], v[192:193]
    v_pk_add_f32 v[136:137], v[136:137], v[192:193]
    v_pk_add_f32 v[138:139], v[138:139], v[192:193]
    v_pk_add_f32 v[140:141], v[140:141], v[192:193]
    v_pk_add_f32 v[142:143], v[142:143], v[192:193]
    s_waitcnt lgkmcnt(0)
    v_mfma_f32_32x32x16_bf16 v[144:159], a[128:131], v[48:51], v[176:191]
    v_exp_f32 v112, v112
    v_exp_f32 v113, v113
    v_exp_f32 v114, v114
    v_mfma_f32_32x32x16_bf16 v[160:175], a[128:131], v[52:55], v[192:207]
    v_exp_f32 v115, v115
    v_add_f32 v240, v240, v112
    v_mfma_f32_32x32x16_bf16 v[144:159], a[132:135], v[56:59], v[144:159]
    v_add_f32 v241, v241, v113
    v_cvt_pk_bf16_f32 v208, v112, v113
    v_exp_f32 v116, v116
    v_mfma_f32_32x32x16_bf16 v[160:175], a[132:135], v[60:63], v[160:175]
    v_exp_f32 v117, v117
    v_add_f32 v240, v240, v114
    v_mfma_f32_32x32x16_bf16 v[144:159], a[136:139], v[64:67], v[144:159]
    v_add_f32 v241, v241, v115
    v_cvt_pk_bf16_f32 v209, v114, v115
    v_exp_f32 v118, v118
    v_mfma_f32_32x32x16_bf16 v[160:175], a[136:139], v[68:71], v[160:175]
    v_exp_f32 v119, v119
    v_add_f32 v240, v240, v116
    v_mfma_f32_32x32x16_bf16 v[144:159], a[140:143], v[72:75], v[144:159]
    v_add_f32 v241, v241, v117
    v_cvt_pk_bf16_f32 v210, v116, v117
    v_exp_f32 v120, v120
    v_mfma_f32_32x32x16_bf16 v[160:175], a[140:143], v[76:79], v[160:175]
    v_exp_f32 v121, v121
    v_add_f32 v240, v240, v118
    v_mfma_f32_32x32x16_bf16 v[144:159], a[144:147], v[80:83], v[144:159]
    v_add_f32 v241, v241, v119
    v_cvt_pk_bf16_f32 v211, v118, v119
    v_exp_f32 v122, v122
    v_mfma_f32_32x32x16_bf16 v[160:175], a[144:147], v[84:87], v[160:175]
    v_exp_f32 v123, v123
    v_add_f32 v240, v240, v120
    v_mfma_f32_32x32x16_bf16 v[144:159], a[148:151], v[88:91], v[144:159]
    v_add_f32 v241, v241, v121
    v_cvt_pk_bf16_f32 v212, v120, v121
    v_exp_f32 v124, v124
    v_mfma_f32_32x32x16_bf16 v[160:175], a[148:151], v[92:95], v[160:175]
    v_exp_f32 v125, v125
    v_add_f32 v240, v240, v122
    v_mfma_f32_32x32x16_bf16 v[144:159], a[152:155], v[96:99], v[144:159]
    v_add_f32 v241, v241, v123
    v_cvt_pk_bf16_f32 v213, v122, v123
    v_exp_f32 v126, v126
    v_mfma_f32_32x32x16_bf16 v[160:175], a[152:155], v[100:103], v[160:175]
    v_exp_f32 v127, v127
    v_add_f32 v240, v240, v124
    v_mfma_f32_32x32x16_bf16 v[144:159], a[156:159], v[104:107], v[144:159]
    v_add_f32 v241, v241, v125
    v_cvt_pk_bf16_f32 v214, v124, v125
    v_exp_f32 v128, v128
    v_mfma_f32_32x32x16_bf16 v[160:175], a[156:159], v[108:111], v[160:175]
    v_exp_f32 v129, v129
    v_add_f32 v240, v240, v126
    ds_read_b128 a[128:131], v8 offset:16384
    ds_read_b128 a[132:135], v9 offset:16384
    ds_read_b128 a[136:139], v10 offset:16384
    ds_read_b128 a[140:143], v11 offset:16384
    ds_read_b128 a[144:147], v12 offset:16384
    ds_read_b128 a[148:151], v13 offset:16384
    ds_read_b128 a[152:155], v14 offset:16384
    ds_read_b128 a[156:159], v15 offset:16384
    v_add_f32 v241, v241, v127
    v_cvt_pk_bf16_f32 v215, v126, v127
    v_exp_f32 v130, v130
    v_exp_f32 v131, v131
    v_add_f32 v242, v242, v128
    v_add_f32 v243, v243, v129
    v_cvt_pk_bf16_f32 v216, v128, v129
    v_exp_f32 v132, v132
    v_exp_f32 v133, v133
    v_add_f32 v242, v242, v130
    v_add_f32 v243, v243, v131
    v_cvt_pk_bf16_f32 v217, v130, v131
    v_exp_f32 v134, v134
    v_exp_f32 v135, v135
    v_add_f32 v242, v242, v132
    v_add_f32 v243, v243, v133
    v_cvt_pk_bf16_f32 v218, v132, v133
    v_exp_f32 v136, v136
    v_exp_f32 v137, v137
    v_add_f32 v242, v242, v134
    v_add_f32 v243, v243, v135
    v_cvt_pk_bf16_f32 v219, v134, v135
    v_exp_f32 v138, v138
    v_exp_f32 v139, v139
    v_add_f32 v242, v242, v136
    v_add_f32 v243, v243, v137
    v_cvt_pk_bf16_f32 v220, v136, v137
    v_exp_f32 v140, v140
    v_exp_f32 v141, v141
    v_add_f32 v242, v242, v138
    v_add_f32 v243, v243, v139
    v_cvt_pk_bf16_f32 v221, v138, v139
    v_exp_f32 v142, v142
    v_exp_f32 v143, v143
    v_add_f32 v242, v242, v140
    v_add_f32 v243, v243, v141
    v_cvt_pk_bf16_f32 v222, v140, v141
    s_nop 0
    v_add_f32 v242, v242, v142
    v_add_f32 v243, v243, v143
    v_cvt_pk_bf16_f32 v223, v142, v143
    s_waitcnt lgkmcnt(0)
    v_mfma_f32_32x32x16_bf16 v[112:127], a[128:131], v[48:51], v[176:191]
    ds_read_b64_tr_b16 a[160:161], v16 offset:0
    ds_read_b64_tr_b16 a[162:163], v16 offset:2048
    v_exp_f32 v144, v144
    v_exp_f32 v145, v145
    v_mfma_f32_32x32x16_bf16 v[128:143], a[128:131], v[52:55], v[192:207]
    ds_read_b64_tr_b16 a[164:165], v17 offset:0
    ds_read_b64_tr_b16 a[166:167], v17 offset:2048
    v_exp_f32 v146, v146
    v_exp_f32 v147, v147
    v_mfma_f32_32x32x16_bf16 v[112:127], a[132:135], v[56:59], v[112:127]
    ds_read_b64_tr_b16 a[168:169], v18 offset:0
    v_add_f32 v240, v240, v144
    v_add_f32 v241, v241, v145
    v_cvt_pk_bf16_f32 v224, v144, v145
    v_exp_f32 v148, v148
    v_mfma_f32_32x32x16_bf16 v[128:143], a[132:135], v[60:63], v[128:143]
    ds_read_b64_tr_b16 a[170:171], v18 offset:2048
    ds_read_b64_tr_b16 a[172:173], v19 offset:0
    v_exp_f32 v149, v149
    v_add_f32 v240, v240, v146
    v_mfma_f32_32x32x16_bf16 v[112:127], a[136:139], v[64:67], v[112:127]
    ds_read_b64_tr_b16 a[174:175], v19 offset:2048
    v_add_f32 v241, v241, v147
    v_cvt_pk_bf16_f32 v225, v146, v147
    v_exp_f32 v150, v150
    v_mfma_f32_32x32x16_bf16 v[128:143], a[136:139], v[68:71], v[128:143]
    ds_read_b64_tr_b16 a[176:177], v16 offset:4096
    ds_read_b64_tr_b16 a[178:179], v16 offset:6144
    v_exp_f32 v151, v151
    v_add_f32 v240, v240, v148
    v_mfma_f32_32x32x16_bf16 v[112:127], a[140:143], v[72:75], v[112:127]
    ds_read_b64_tr_b16 a[180:181], v17 offset:4096
    ds_read_b64_tr_b16 a[182:183], v17 offset:6144
    v_add_f32 v241, v241, v149
    v_cvt_pk_bf16_f32 v226, v148, v149
    v_exp_f32 v152, v152
    v_mfma_f32_32x32x16_bf16 v[128:143], a[140:143], v[76:79], v[128:143]
    ds_read_b64_tr_b16 a[184:185], v18 offset:4096
    v_exp_f32 v153, v153
    v_add_f32 v240, v240, v150
    v_mfma_f32_32x32x16_bf16 v[112:127], a[144:147], v[80:83], v[112:127]
    ds_read_b64_tr_b16 a[186:187], v18 offset:6144
    ds_read_b64_tr_b16 a[188:189], v19 offset:4096
    v_add_f32 v241, v241, v151
    v_cvt_pk_bf16_f32 v227, v150, v151
    v_exp_f32 v154, v154
    v_mfma_f32_32x32x16_bf16 v[128:143], a[144:147], v[84:87], v[128:143]
    ds_read_b64_tr_b16 a[190:191], v19 offset:6144
    v_exp_f32 v155, v155
    v_add_f32 v240, v240, v152
    v_mfma_f32_32x32x16_bf16 v[112:127], a[148:151], v[88:91], v[112:127]
    v_add_f32 v241, v241, v153
    v_cvt_pk_bf16_f32 v228, v152, v153
    v_exp_f32 v156, v156
    v_mfma_f32_32x32x16_bf16 v[128:143], a[148:151], v[92:95], v[128:143]
    v_exp_f32 v157, v157
    v_add_f32 v240, v240, v154
    v_mfma_f32_32x32x16_bf16 v[112:127], a[152:155], v[96:99], v[112:127]
    v_add_f32 v241, v241, v155
    v_cvt_pk_bf16_f32 v229, v154, v155
    v_exp_f32 v158, v158
    v_mfma_f32_32x32x16_bf16 v[128:143], a[152:155], v[100:103], v[128:143]
    v_exp_f32 v159, v159
    v_add_f32 v240, v240, v156
    v_mfma_f32_32x32x16_bf16 v[112:127], a[156:159], v[104:107], v[112:127]
    v_add_f32 v241, v241, v157
    v_cvt_pk_bf16_f32 v230, v156, v157
    v_exp_f32 v160, v160
    v_mfma_f32_32x32x16_bf16 v[128:143], a[156:159], v[108:111], v[128:143]
    v_exp_f32 v161, v161
    v_add_f32 v240, v240, v158
    s_waitcnt lgkmcnt(0)
    v_mfma_f32_32x32x16_bf16 a[0:15], a[160:163], v[208:211], 0
    ds_read_b128 a[128:131], v8 offset:24576
    s_mov_b32 s28, s52
    s_mov_b32 s29, s53
    s_mov_b32 s30, 0xe00000
    s_mov_b32 s31, 0x00020000
    s_xor_b32 s87, s71, 3
    v_mfma_f32_32x32x16_bf16 a[16:31], a[160:163], v[216:219], 0
    ds_read_b128 a[132:135], v9 offset:24576
    s_lshl_b32 s87, s87, 5
    s_add_u32 s87, s87, s81
    s_lshl_b32 s87, s87, 2
    s_and_b32 s85, s2, 3
    s_add_u32 s87, s87, s85
    v_mfma_f32_32x32x16_bf16 a[32:47], a[164:167], v[208:211], 0
    ds_read_b128 a[136:139], v10 offset:24576
    s_mul_i32 s87, s87, 14336
    s_add_u32 s87, s87, 7340032
    v_and_b32 v30, 31, v1
    v_min_u32 v30, 31, v30
    v_lshlrev_b32 v30, 7, v30
    v_mfma_f32_32x32x16_bf16 a[48:63], a[164:167], v[216:219], 0
    ds_read_b128 a[140:143], v11 offset:24576
    v_lshrrev_b32 v29, 5, v1
    v_mul_u32_u24 v29, 7168, v29
    v_add_u32 v30, v30, v29
    buffer_load_dword v31, v30, s[28:31], s87 offen
    v_add_f32 v241, v241, v159
    v_mfma_f32_32x32x16_bf16 a[64:79], a[168:171], v[208:211], 0
    v_cvt_pk_bf16_f32 v231, v158, v159
    v_exp_f32 v162, v162
    v_exp_f32 v163, v163
    v_add_f32 v242, v242, v160
    v_mfma_f32_32x32x16_bf16 a[80:95], a[168:171], v[216:219], 0
    ds_read_b128 a[144:147], v12 offset:24576
    v_add_f32 v243, v243, v161
    v_cvt_pk_bf16_f32 v232, v160, v161
    v_exp_f32 v164, v164
    v_mfma_f32_32x32x16_bf16 a[96:111], a[172:175], v[208:211], 0
    ds_read_b128 a[148:151], v13 offset:24576
    v_exp_f32 v165, v165
    v_add_f32 v242, v242, v162
    v_add_f32 v243, v243, v163
    v_cvt_pk_bf16_f32 v233, v162, v163
    v_mfma_f32_32x32x16_bf16 a[112:127], a[172:175], v[216:219], 0
    ds_read_b128 a[152:155], v14 offset:24576
    v_exp_f32 v166, v166
    v_exp_f32 v167, v167
    v_add_f32 v242, v242, v164
    v_add_f32 v243, v243, v165
    v_mfma_f32_32x32x16_bf16 a[0:15], a[176:179], v[212:215], a[0:15]
    ds_read_b128 a[156:159], v15 offset:24576
    v_cvt_pk_bf16_f32 v234, v164, v165
    v_exp_f32 v168, v168
    v_exp_f32 v169, v169
    v_mfma_f32_32x32x16_bf16 a[16:31], a[176:179], v[220:223], a[16:31]
    v_add_f32 v242, v242, v166
    v_add_f32 v243, v243, v167
    v_cvt_pk_bf16_f32 v235, v166, v167
    v_exp_f32 v170, v170
    v_mfma_f32_32x32x16_bf16 a[32:47], a[180:183], v[212:215], a[32:47]
    v_exp_f32 v171, v171
    v_add_f32 v242, v242, v168
    v_add_f32 v243, v243, v169
    v_cvt_pk_bf16_f32 v236, v168, v169
    v_exp_f32 v172, v172
    v_mfma_f32_32x32x16_bf16 a[48:63], a[180:183], v[220:223], a[48:63]
    v_exp_f32 v173, v173
    v_add_f32 v242, v242, v170
    v_add_f32 v243, v243, v171
    v_cvt_pk_bf16_f32 v237, v170, v171
    v_mfma_f32_32x32x16_bf16 a[64:79], a[184:187], v[212:215], a[64:79]
    v_exp_f32 v174, v174
    v_exp_f32 v175, v175
    v_add_f32 v242, v242, v172
    v_add_f32 v243, v243, v173
    v_mfma_f32_32x32x16_bf16 a[80:95], a[184:187], v[220:223], a[80:95]
    v_cvt_pk_bf16_f32 v238, v172, v173
    s_nop 0
    v_add_f32 v242, v242, v174
    v_mfma_f32_32x32x16_bf16 a[96:111], a[188:191], v[212:215], a[96:111]
    v_add_f32 v243, v243, v175
    v_cvt_pk_bf16_f32 v239, v174, v175
    v_mfma_f32_32x32x16_bf16 a[112:127], a[188:191], v[220:223], a[112:127]
    s_waitcnt lgkmcnt(0)
    s_waitcnt vmcnt(13)
    s_barrier
    v_mfma_f32_32x32x16_bf16 v[144:159], a[128:131], v[48:51], v[176:191]
    ds_read_b64_tr_b16 a[160:161], v16 offset:8192
    ds_read_b64_tr_b16 a[162:163], v16 offset:10240
    v_exp_f32 v112, v112
    v_exp_f32 v113, v113
    v_mfma_f32_32x32x16_bf16 v[160:175], a[128:131], v[52:55], v[192:207]
    ds_read_b64_tr_b16 a[164:165], v17 offset:8192
    ds_read_b64_tr_b16 a[166:167], v17 offset:10240
    v_exp_f32 v114, v114
    v_exp_f32 v115, v115
    v_mfma_f32_32x32x16_bf16 v[144:159], a[132:135], v[56:59], v[144:159]
    ds_read_b64_tr_b16 a[168:169], v18 offset:8192
    v_add_f32 v240, v240, v112
    v_add_f32 v241, v241, v113
    v_cvt_pk_bf16_f32 v208, v112, v113
    v_exp_f32 v116, v116
    v_mfma_f32_32x32x16_bf16 v[160:175], a[132:135], v[60:63], v[160:175]
    ds_read_b64_tr_b16 a[170:171], v18 offset:10240
    ds_read_b64_tr_b16 a[172:173], v19 offset:8192
    v_exp_f32 v117, v117
    v_add_f32 v240, v240, v114
    v_mfma_f32_32x32x16_bf16 v[144:159], a[136:139], v[64:67], v[144:159]
    ds_read_b64_tr_b16 a[174:175], v19 offset:10240
    v_add_f32 v241, v241, v115
    v_cvt_pk_bf16_f32 v209, v114, v115
    v_exp_f32 v118, v118
    v_mfma_f32_32x32x16_bf16 v[160:175], a[136:139], v[68:71], v[160:175]
    ds_read_b64_tr_b16 a[176:177], v16 offset:12288
    ds_read_b64_tr_b16 a[178:179], v16 offset:14336
    v_exp_f32 v119, v119
    v_add_f32 v240, v240, v116
    v_mfma_f32_32x32x16_bf16 v[144:159], a[140:143], v[72:75], v[144:159]
    ds_read_b64_tr_b16 a[180:181], v17 offset:12288
    ds_read_b64_tr_b16 a[182:183], v17 offset:14336
    v_add_f32 v241, v241, v117
    v_cvt_pk_bf16_f32 v210, v116, v117
    v_exp_f32 v120, v120
    v_mfma_f32_32x32x16_bf16 v[160:175], a[140:143], v[76:79], v[160:175]
    ds_read_b64_tr_b16 a[184:185], v18 offset:12288
    v_exp_f32 v121, v121
    v_add_f32 v240, v240, v118
    v_mfma_f32_32x32x16_bf16 v[144:159], a[144:147], v[80:83], v[144:159]
    ds_read_b64_tr_b16 a[186:187], v18 offset:14336
    ds_read_b64_tr_b16 a[188:189], v19 offset:12288
    v_add_f32 v241, v241, v119
    v_cvt_pk_bf16_f32 v211, v118, v119
    v_exp_f32 v122, v122
    v_mfma_f32_32x32x16_bf16 v[160:175], a[144:147], v[84:87], v[160:175]
    ds_read_b64_tr_b16 a[190:191], v19 offset:14336
    v_exp_f32 v123, v123
    v_add_f32 v240, v240, v120
    v_mfma_f32_32x32x16_bf16 v[144:159], a[148:151], v[88:91], v[144:159]
    v_add_f32 v241, v241, v121
    v_cvt_pk_bf16_f32 v212, v120, v121
    v_exp_f32 v124, v124
    v_mfma_f32_32x32x16_bf16 v[160:175], a[148:151], v[92:95], v[160:175]
    v_exp_f32 v125, v125
    v_add_f32 v240, v240, v122
    v_mfma_f32_32x32x16_bf16 v[144:159], a[152:155], v[96:99], v[144:159]
    v_add_f32 v241, v241, v123
    v_cvt_pk_bf16_f32 v213, v122, v123
    v_exp_f32 v126, v126
    v_mfma_f32_32x32x16_bf16 v[160:175], a[152:155], v[100:103], v[160:175]
    v_exp_f32 v127, v127
    v_add_f32 v240, v240, v124
    v_mfma_f32_32x32x16_bf16 v[144:159], a[156:159], v[104:107], v[144:159]
    v_add_f32 v241, v241, v125
    v_cvt_pk_bf16_f32 v214, v124, v125
    v_exp_f32 v128, v128
    v_mfma_f32_32x32x16_bf16 v[160:175], a[156:159], v[108:111], v[160:175]
    v_exp_f32 v129, v129
    v_add_f32 v240, v240, v126
    s_waitcnt lgkmcnt(0)
    v_mfma_f32_32x32x16_bf16 a[0:15], a[160:163], v[224:227], a[0:15]
    ds_read_b128 a[128:131], v8 offset:32768
    s_add_u32 m0, s68, 0
    s_add_u32 s86, s68, 65536
    buffer_load_dwordx4 v20, s[16:19], s86 offen offset:0 lds
    v_add_f32 v241, v241, v127
    v_cvt_pk_bf16_f32 v215, v126, v127
    v_mfma_f32_32x32x16_bf16 a[16:31], a[160:163], v[232:235], a[16:31]
    ds_read_b128 a[132:135], v9 offset:32768
    v_exp_f32 v130, v130
    v_exp_f32 v131, v131
    v_add_f32 v242, v242, v128
    v_mfma_f32_32x32x16_bf16 a[32:47], a[164:167], v[224:227], a[32:47]
    ds_read_b128 a[136:139], v10 offset:32768
    buffer_load_dwordx4 v21, s[16:19], s86 offen offset:1024 lds
    v_add_f32 v243, v243, v129
    v_cvt_pk_bf16_f32 v216, v128, v129
    v_exp_f32 v132, v132
    v_mfma_f32_32x32x16_bf16 a[48:63], a[164:167], v[232:235], a[48:63]
    ds_read_b128 a[140:143], v11 offset:32768
    v_exp_f32 v133, v133
    v_add_f32 v242, v242, v130
    v_add_f32 v243, v243, v131
    v_mfma_f32_32x32x16_bf16 a[64:79], a[168:171], v[224:227], a[64:79]
    buffer_load_dwordx4 v22, s[16:19], s86 offen offset:2048 lds
    v_cvt_pk_bf16_f32 v217, v130, v131
    v_exp_f32 v134, v134
    v_exp_f32 v135, v135
    v_mfma_f32_32x32x16_bf16 a[80:95], a[168:171], v[232:235], a[80:95]
    ds_read_b128 a[144:147], v12 offset:32768
    v_add_f32 v242, v242, v132
    v_add_f32 v243, v243, v133
    v_cvt_pk_bf16_f32 v218, v132, v133
    v_mfma_f32_32x32x16_bf16 a[96:111], a[172:175], v[224:227], a[96:111]
    ds_read_b128 a[148:151], v13 offset:32768
    buffer_load_dwordx4 v23, s[16:19], s86 offen offset:3072 lds
    v_exp_f32 v136, v136
    v_exp_f32 v137, v137
    v_add_f32 v242, v242, v134
    v_mfma_f32_32x32x16_bf16 a[112:127], a[172:175], v[232:235], a[112:127]
    ds_read_b128 a[152:155], v14 offset:32768
    v_add_f32 v243, v243, v135
    v_cvt_pk_bf16_f32 v219, v134, v135
    v_mfma_f32_32x32x16_bf16 a[0:15], a[176:179], v[228:231], a[0:15]
    ds_read_b128 a[156:159], v15 offset:32768
    s_add_u32 m0, s68, 16384
    s_add_u32 s86, s68, 81920
    buffer_load_dwordx4 v20, s[16:19], s86 offen offset:0 lds
    v_exp_f32 v138, v138
    v_mfma_f32_32x32x16_bf16 a[16:31], a[176:179], v[236:239], a[16:31]
    v_exp_f32 v139, v139
    v_add_f32 v242, v242, v136
    v_add_f32 v243, v243, v137
    v_cvt_pk_bf16_f32 v220, v136, v137
    v_exp_f32 v140, v140
    v_mfma_f32_32x32x16_bf16 a[32:47], a[180:183], v[228:231], a[32:47]
    buffer_load_dwordx4 v21, s[16:19], s86 offen offset:1024 lds
    v_exp_f32 v141, v141
    v_add_f32 v242, v242, v138
    v_add_f32 v243, v243, v139
    v_mfma_f32_32x32x16_bf16 a[48:63], a[180:183], v[236:239], a[48:63]
    v_cvt_pk_bf16_f32 v221, v138, v139
    v_exp_f32 v142, v142
    v_mfma_f32_32x32x16_bf16 a[64:79], a[184:187], v[228:231], a[64:79]
    buffer_load_dwordx4 v22, s[16:19], s86 offen offset:2048 lds
    v_exp_f32 v143, v143
    v_add_f32 v242, v242, v140
    v_add_f32 v243, v243, v141
    v_mfma_f32_32x32x16_bf16 a[80:95], a[184:187], v[236:239], a[80:95]
    v_cvt_pk_bf16_f32 v222, v140, v141
    s_nop 0
    v_add_f32 v242, v242, v142
    v_mfma_f32_32x32x16_bf16 a[96:111], a[188:191], v[228:231], a[96:111]
    buffer_load_dwordx4 v23, s[16:19], s86 offen offset:3072 lds
    v_add_f32 v243, v243, v143
    v_cvt_pk_bf16_f32 v223, v142, v143
    v_mfma_f32_32x32x16_bf16 a[112:127], a[188:191], v[236:239], a[112:127]
    s_waitcnt lgkmcnt(0)
    v_mfma_f32_32x32x16_bf16 v[112:127], a[128:131], v[48:51], v[176:191]
    ds_read_b64_tr_b16 a[160:161], v16 offset:16384
    ds_read_b64_tr_b16 a[162:163], v16 offset:18432
    v_exp_f32 v144, v144
    v_exp_f32 v145, v145
    v_mfma_f32_32x32x16_bf16 v[128:143], a[128:131], v[52:55], v[192:207]
    ds_read_b64_tr_b16 a[164:165], v17 offset:16384
    ds_read_b64_tr_b16 a[166:167], v17 offset:18432
    v_exp_f32 v146, v146
    v_exp_f32 v147, v147
    v_mfma_f32_32x32x16_bf16 v[112:127], a[132:135], v[56:59], v[112:127]
    ds_read_b64_tr_b16 a[168:169], v18 offset:16384
    v_add_f32 v240, v240, v144
    v_add_f32 v241, v241, v145
    v_cvt_pk_bf16_f32 v224, v144, v145
    v_exp_f32 v148, v148
    v_mfma_f32_32x32x16_bf16 v[128:143], a[132:135], v[60:63], v[128:143]
    ds_read_b64_tr_b16 a[170:171], v18 offset:18432
    ds_read_b64_tr_b16 a[172:173], v19 offset:16384
    v_exp_f32 v149, v149
    v_add_f32 v240, v240, v146
    v_mfma_f32_32x32x16_bf16 v[112:127], a[136:139], v[64:67], v[112:127]
    ds_read_b64_tr_b16 a[174:175], v19 offset:18432
    v_add_f32 v241, v241, v147
    v_cvt_pk_bf16_f32 v225, v146, v147
    v_exp_f32 v150, v150
    v_mfma_f32_32x32x16_bf16 v[128:143], a[136:139], v[68:71], v[128:143]
    ds_read_b64_tr_b16 a[176:177], v16 offset:20480
    ds_read_b64_tr_b16 a[178:179], v16 offset:22528
    v_exp_f32 v151, v151
    v_add_f32 v240, v240, v148
    v_mfma_f32_32x32x16_bf16 v[112:127], a[140:143], v[72:75], v[112:127]
    ds_read_b64_tr_b16 a[180:181], v17 offset:20480
    ds_read_b64_tr_b16 a[182:183], v17 offset:22528
    v_add_f32 v241, v241, v149
    v_cvt_pk_bf16_f32 v226, v148, v149
    v_exp_f32 v152, v152
    v_mfma_f32_32x32x16_bf16 v[128:143], a[140:143], v[76:79], v[128:143]
    ds_read_b64_tr_b16 a[184:185], v18 offset:20480
    v_exp_f32 v153, v153
    v_add_f32 v240, v240, v150
    v_mfma_f32_32x32x16_bf16 v[112:127], a[144:147], v[80:83], v[112:127]
    ds_read_b64_tr_b16 a[186:187], v18 offset:22528
    ds_read_b64_tr_b16 a[188:189], v19 offset:20480
    v_add_f32 v241, v241, v151
    v_cvt_pk_bf16_f32 v227, v150, v151
    v_exp_f32 v154, v154
    v_mfma_f32_32x32x16_bf16 v[128:143], a[144:147], v[84:87], v[128:143]
    ds_read_b64_tr_b16 a[190:191], v19 offset:22528
    v_exp_f32 v155, v155
    v_add_f32 v240, v240, v152
    v_mfma_f32_32x32x16_bf16 v[112:127], a[148:151], v[88:91], v[112:127]
    v_add_f32 v241, v241, v153
    v_cvt_pk_bf16_f32 v228, v152, v153
    v_exp_f32 v156, v156
    v_mfma_f32_32x32x16_bf16 v[128:143], a[148:151], v[92:95], v[128:143]
    v_exp_f32 v157, v157
    v_add_f32 v240, v240, v154
    v_mfma_f32_32x32x16_bf16 v[112:127], a[152:155], v[96:99], v[112:127]
    v_add_f32 v241, v241, v155
    v_cvt_pk_bf16_f32 v229, v154, v155
    v_exp_f32 v158, v158
    v_mfma_f32_32x32x16_bf16 v[128:143], a[152:155], v[100:103], v[128:143]
    v_exp_f32 v159, v159
    v_add_f32 v240, v240, v156
    v_mfma_f32_32x32x16_bf16 v[112:127], a[156:159], v[104:107], v[112:127]
    v_add_f32 v241, v241, v157
    v_cvt_pk_bf16_f32 v230, v156, v157
    v_exp_f32 v160, v160
    v_mfma_f32_32x32x16_bf16 v[128:143], a[156:159], v[108:111], v[128:143]
    v_exp_f32 v161, v161
    v_add_f32 v240, v240, v158
    s_waitcnt lgkmcnt(0)
    v_mfma_f32_32x32x16_bf16 a[0:15], a[160:163], v[208:211], a[0:15]
    ds_read_b128 a[128:131], v8 offset:40960
    v_add_f32 v241, v241, v159
    v_cvt_pk_bf16_f32 v231, v158, v159
    v_exp_f32 v162, v162
    v_mfma_f32_32x32x16_bf16 a[16:31], a[160:163], v[216:219], a[16:31]
    ds_read_b128 a[132:135], v9 offset:40960
    v_exp_f32 v163, v163
    v_add_f32 v242, v242, v160
    v_add_f32 v243, v243, v161
    v_mfma_f32_32x32x16_bf16 a[32:47], a[164:167], v[208:211], a[32:47]
    ds_read_b128 a[136:139], v10 offset:40960
    v_cvt_pk_bf16_f32 v232, v160, v161
    v_exp_f32 v164, v164
    v_exp_f32 v165, v165
    v_mfma_f32_32x32x16_bf16 a[48:63], a[164:167], v[216:219], a[48:63]
    ds_read_b128 a[140:143], v11 offset:40960
    v_add_f32 v242, v242, v162
    v_add_f32 v243, v243, v163
    v_mfma_f32_32x32x16_bf16 a[64:79], a[168:171], v[208:211], a[64:79]
    v_cvt_pk_bf16_f32 v233, v162, v163
    v_exp_f32 v166, v166
    v_exp_f32 v167, v167
    v_mfma_f32_32x32x16_bf16 a[80:95], a[168:171], v[216:219], a[80:95]
    ds_read_b128 a[144:147], v12 offset:40960
    v_add_f32 v242, v242, v164
    v_add_f32 v243, v243, v165
    v_cvt_pk_bf16_f32 v234, v164, v165
    v_mfma_f32_32x32x16_bf16 a[96:111], a[172:175], v[208:211], a[96:111]
    ds_read_b128 a[148:151], v13 offset:40960
    v_exp_f32 v168, v168
    v_exp_f32 v169, v169
    v_add_f32 v242, v242, v166
    v_mfma_f32_32x32x16_bf16 a[112:127], a[172:175], v[216:219], a[112:127]
    ds_read_b128 a[152:155], v14 offset:40960
    v_add_f32 v243, v243, v167
    v_cvt_pk_bf16_f32 v235, v166, v167
    v_mfma_f32_32x32x16_bf16 a[0:15], a[176:179], v[212:215], a[0:15]
    ds_read_b128 a[156:159], v15 offset:40960
    v_exp_f32 v170, v170
    v_exp_f32 v171, v171
    v_add_f32 v242, v242, v168
    v_mfma_f32_32x32x16_bf16 a[16:31], a[176:179], v[220:223], a[16:31]
    v_add_f32 v243, v243, v169
    v_cvt_pk_bf16_f32 v236, v168, v169
    v_exp_f32 v172, v172
    v_mfma_f32_32x32x16_bf16 a[32:47], a[180:183], v[212:215], a[32:47]
    v_exp_f32 v173, v173
    v_add_f32 v242, v242, v170
    v_add_f32 v243, v243, v171
    v_mfma_f32_32x32x16_bf16 a[48:63], a[180:183], v[220:223], a[48:63]
    v_cvt_pk_bf16_f32 v237, v170, v171
    v_exp_f32 v174, v174
    v_mfma_f32_32x32x16_bf16 a[64:79], a[184:187], v[212:215], a[64:79]
    v_exp_f32 v175, v175
    v_add_f32 v242, v242, v172
    v_add_f32 v243, v243, v173
    v_mfma_f32_32x32x16_bf16 a[80:95], a[184:187], v[220:223], a[80:95]
    v_cvt_pk_bf16_f32 v238, v172, v173
    s_nop 0
    v_add_f32 v242, v242, v174
    v_mfma_f32_32x32x16_bf16 a[96:111], a[188:191], v[212:215], a[96:111]
    v_add_f32 v243, v243, v175
    v_cvt_pk_bf16_f32 v239, v174, v175
    v_mfma_f32_32x32x16_bf16 a[112:127], a[188:191], v[220:223], a[112:127]
    s_waitcnt lgkmcnt(0)
    s_waitcnt vmcnt(13)
    s_barrier
    v_mfma_f32_32x32x16_bf16 v[144:159], a[128:131], v[48:51], v[176:191]
    ds_read_b64_tr_b16 a[160:161], v16 offset:24576
    ds_read_b64_tr_b16 a[162:163], v16 offset:26624
    v_exp_f32 v112, v112
    v_exp_f32 v113, v113
    v_mfma_f32_32x32x16_bf16 v[160:175], a[128:131], v[52:55], v[192:207]
    ds_read_b64_tr_b16 a[164:165], v17 offset:24576
    ds_read_b64_tr_b16 a[166:167], v17 offset:26624
    v_exp_f32 v114, v114
    v_exp_f32 v115, v115
    v_mfma_f32_32x32x16_bf16 v[144:159], a[132:135], v[56:59], v[144:159]
    ds_read_b64_tr_b16 a[168:169], v18 offset:24576
    v_add_f32 v240, v240, v112
    v_add_f32 v241, v241, v113
    v_cvt_pk_bf16_f32 v208, v112, v113
    v_exp_f32 v116, v116
    v_mfma_f32_32x32x16_bf16 v[160:175], a[132:135], v[60:63], v[160:175]
    ds_read_b64_tr_b16 a[170:171], v18 offset:26624
    ds_read_b64_tr_b16 a[172:173], v19 offset:24576
    v_exp_f32 v117, v117
    v_add_f32 v240, v240, v114
    v_mfma_f32_32x32x16_bf16 v[144:159], a[136:139], v[64:67], v[144:159]
    ds_read_b64_tr_b16 a[174:175], v19 offset:26624
    v_add_f32 v241, v241, v115
    v_cvt_pk_bf16_f32 v209, v114, v115
    v_exp_f32 v118, v118
    v_mfma_f32_32x32x16_bf16 v[160:175], a[136:139], v[68:71], v[160:175]
    ds_read_b64_tr_b16 a[176:177], v16 offset:28672
    ds_read_b64_tr_b16 a[178:179], v16 offset:30720
    v_exp_f32 v119, v119
    v_add_f32 v240, v240, v116
    v_mfma_f32_32x32x16_bf16 v[144:159], a[140:143], v[72:75], v[144:159]
    ds_read_b64_tr_b16 a[180:181], v17 offset:28672
    ds_read_b64_tr_b16 a[182:183], v17 offset:30720
    v_add_f32 v241, v241, v117
    v_cvt_pk_bf16_f32 v210, v116, v117
    v_exp_f32 v120, v120
    v_mfma_f32_32x32x16_bf16 v[160:175], a[140:143], v[76:79], v[160:175]
    ds_read_b64_tr_b16 a[184:185], v18 offset:28672
    v_exp_f32 v121, v121
    v_add_f32 v240, v240, v118
    v_mfma_f32_32x32x16_bf16 v[144:159], a[144:147], v[80:83], v[144:159]
    ds_read_b64_tr_b16 a[186:187], v18 offset:30720
    ds_read_b64_tr_b16 a[188:189], v19 offset:28672
    v_add_f32 v241, v241, v119
    v_cvt_pk_bf16_f32 v211, v118, v119
    v_exp_f32 v122, v122
    v_mfma_f32_32x32x16_bf16 v[160:175], a[144:147], v[84:87], v[160:175]
    ds_read_b64_tr_b16 a[190:191], v19 offset:30720
    v_exp_f32 v123, v123
    v_add_f32 v240, v240, v120
    v_mfma_f32_32x32x16_bf16 v[144:159], a[148:151], v[88:91], v[144:159]
    v_add_f32 v241, v241, v121
    v_cvt_pk_bf16_f32 v212, v120, v121
    v_exp_f32 v124, v124
    v_mfma_f32_32x32x16_bf16 v[160:175], a[148:151], v[92:95], v[160:175]
    v_exp_f32 v125, v125
    v_add_f32 v240, v240, v122
    v_mfma_f32_32x32x16_bf16 v[144:159], a[152:155], v[96:99], v[144:159]
    v_add_f32 v241, v241, v123
    v_cvt_pk_bf16_f32 v213, v122, v123
    v_exp_f32 v126, v126
    v_mfma_f32_32x32x16_bf16 v[160:175], a[152:155], v[100:103], v[160:175]
    v_exp_f32 v127, v127
    v_add_f32 v240, v240, v124
    v_mfma_f32_32x32x16_bf16 v[144:159], a[156:159], v[104:107], v[144:159]
    v_add_f32 v241, v241, v125
    v_cvt_pk_bf16_f32 v214, v124, v125
    v_exp_f32 v128, v128
    v_mfma_f32_32x32x16_bf16 v[160:175], a[156:159], v[108:111], v[160:175]
    v_exp_f32 v129, v129
    v_add_f32 v240, v240, v126
    s_waitcnt lgkmcnt(0)
    v_mfma_f32_32x32x16_bf16 a[0:15], a[160:163], v[224:227], a[0:15]
    ds_read_b128 a[128:131], v8 offset:49152
    s_add_u32 m0, s68, 32768
    s_add_u32 s86, s68, 98304
    buffer_load_dwordx4 v20, s[16:19], s86 offen offset:0 lds
    v_add_f32 v241, v241, v127
    v_cvt_pk_bf16_f32 v215, v126, v127
    v_mfma_f32_32x32x16_bf16 a[16:31], a[160:163], v[232:235], a[16:31]
    ds_read_b128 a[132:135], v9 offset:49152
    v_exp_f32 v130, v130
    v_exp_f32 v131, v131
    v_add_f32 v242, v242, v128
    v_mfma_f32_32x32x16_bf16 a[32:47], a[164:167], v[224:227], a[32:47]
    ds_read_b128 a[136:139], v10 offset:49152
    buffer_load_dwordx4 v21, s[16:19], s86 offen offset:1024 lds
    v_add_f32 v243, v243, v129
    v_cvt_pk_bf16_f32 v216, v128, v129
    v_exp_f32 v132, v132
    v_mfma_f32_32x32x16_bf16 a[48:63], a[164:167], v[232:235], a[48:63]
    ds_read_b128 a[140:143], v11 offset:49152
    v_exp_f32 v133, v133
    v_add_f32 v242, v242, v130
    v_add_f32 v243, v243, v131
    v_mfma_f32_32x32x16_bf16 a[64:79], a[168:171], v[224:227], a[64:79]
    buffer_load_dwordx4 v22, s[16:19], s86 offen offset:2048 lds
    v_cvt_pk_bf16_f32 v217, v130, v131
    v_exp_f32 v134, v134
    v_exp_f32 v135, v135
    v_mfma_f32_32x32x16_bf16 a[80:95], a[168:171], v[232:235], a[80:95]
    ds_read_b128 a[144:147], v12 offset:49152
    v_add_f32 v242, v242, v132
    v_add_f32 v243, v243, v133
    v_cvt_pk_bf16_f32 v218, v132, v133
    v_mfma_f32_32x32x16_bf16 a[96:111], a[172:175], v[224:227], a[96:111]
    ds_read_b128 a[148:151], v13 offset:49152
    buffer_load_dwordx4 v23, s[16:19], s86 offen offset:3072 lds
    v_exp_f32 v136, v136
    v_exp_f32 v137, v137
    v_add_f32 v242, v242, v134
    v_mfma_f32_32x32x16_bf16 a[112:127], a[172:175], v[232:235], a[112:127]
    ds_read_b128 a[152:155], v14 offset:49152
    v_add_f32 v243, v243, v135
    v_cvt_pk_bf16_f32 v219, v134, v135
    v_mfma_f32_32x32x16_bf16 a[0:15], a[176:179], v[228:231], a[0:15]
    ds_read_b128 a[156:159], v15 offset:49152
    s_add_u32 m0, s68, 65536
    s_add_u32 s86, s68, 65536
    buffer_load_dwordx4 v24, s[20:23], s86 offen offset:0 lds
    v_exp_f32 v138, v138
    v_mfma_f32_32x32x16_bf16 a[16:31], a[176:179], v[236:239], a[16:31]
    v_exp_f32 v139, v139
    v_add_f32 v242, v242, v136
    v_add_f32 v243, v243, v137
    v_cvt_pk_bf16_f32 v220, v136, v137
    v_exp_f32 v140, v140
    v_mfma_f32_32x32x16_bf16 a[32:47], a[180:183], v[228:231], a[32:47]
    buffer_load_dwordx4 v24, s[20:23], s86 offen offset:1024 lds
    v_exp_f32 v141, v141
    v_add_f32 v242, v242, v138
    v_add_f32 v243, v243, v139
    v_mfma_f32_32x32x16_bf16 a[48:63], a[180:183], v[236:239], a[48:63]
    v_cvt_pk_bf16_f32 v221, v138, v139
    v_exp_f32 v142, v142
    v_mfma_f32_32x32x16_bf16 a[64:79], a[184:187], v[228:231], a[64:79]
    buffer_load_dwordx4 v24, s[20:23], s86 offen offset:2048 lds
    v_exp_f32 v143, v143
    v_add_f32 v242, v242, v140
    v_add_f32 v243, v243, v141
    v_mfma_f32_32x32x16_bf16 a[80:95], a[184:187], v[236:239], a[80:95]
    v_cvt_pk_bf16_f32 v222, v140, v141
    s_nop 0
    v_add_f32 v242, v242, v142
    v_mfma_f32_32x32x16_bf16 a[96:111], a[188:191], v[228:231], a[96:111]
    buffer_load_dwordx4 v24, s[20:23], s86 offen offset:3072 lds
    v_add_f32 v243, v243, v143
    v_cvt_pk_bf16_f32 v223, v142, v143
    v_mfma_f32_32x32x16_bf16 a[112:127], a[188:191], v[236:239], a[112:127]
    s_waitcnt lgkmcnt(0)
    v_mfma_f32_32x32x16_bf16 v[112:127], a[128:131], v[48:51], v[176:191]
    ds_read_b64_tr_b16 a[160:161], v16 offset:32768
    ds_read_b64_tr_b16 a[162:163], v16 offset:34816
    v_exp_f32 v144, v144
    v_exp_f32 v145, v145
    v_mfma_f32_32x32x16_bf16 v[128:143], a[128:131], v[52:55], v[192:207]
    ds_read_b64_tr_b16 a[164:165], v17 offset:32768
    ds_read_b64_tr_b16 a[166:167], v17 offset:34816
    v_exp_f32 v146, v146
    v_exp_f32 v147, v147
    v_mfma_f32_32x32x16_bf16 v[112:127], a[132:135], v[56:59], v[112:127]
    ds_read_b64_tr_b16 a[168:169], v18 offset:32768
    v_add_f32 v240, v240, v144
    v_add_f32 v241, v241, v145
    v_cvt_pk_bf16_f32 v224, v144, v145
    v_exp_f32 v148, v148
    v_mfma_f32_32x32x16_bf16 v[128:143], a[132:135], v[60:63], v[128:143]
    ds_read_b64_tr_b16 a[170:171], v18 offset:34816
    ds_read_b64_tr_b16 a[172:173], v19 offset:32768
    v_exp_f32 v149, v149
    v_add_f32 v240, v240, v146
    v_mfma_f32_32x32x16_bf16 v[112:127], a[136:139], v[64:67], v[112:127]
    ds_read_b64_tr_b16 a[174:175], v19 offset:34816
    v_add_f32 v241, v241, v147
    v_cvt_pk_bf16_f32 v225, v146, v147
    v_exp_f32 v150, v150
    v_mfma_f32_32x32x16_bf16 v[128:143], a[136:139], v[68:71], v[128:143]
    ds_read_b64_tr_b16 a[176:177], v16 offset:36864
    ds_read_b64_tr_b16 a[178:179], v16 offset:38912
    v_exp_f32 v151, v151
    v_add_f32 v240, v240, v148
    v_mfma_f32_32x32x16_bf16 v[112:127], a[140:143], v[72:75], v[112:127]
    ds_read_b64_tr_b16 a[180:181], v17 offset:36864
    ds_read_b64_tr_b16 a[182:183], v17 offset:38912
    v_add_f32 v241, v241, v149
    v_cvt_pk_bf16_f32 v226, v148, v149
    v_exp_f32 v152, v152
    v_mfma_f32_32x32x16_bf16 v[128:143], a[140:143], v[76:79], v[128:143]
    ds_read_b64_tr_b16 a[184:185], v18 offset:36864
    v_exp_f32 v153, v153
    v_add_f32 v240, v240, v150
    v_mfma_f32_32x32x16_bf16 v[112:127], a[144:147], v[80:83], v[112:127]
    ds_read_b64_tr_b16 a[186:187], v18 offset:38912
    ds_read_b64_tr_b16 a[188:189], v19 offset:36864
    v_add_f32 v241, v241, v151
    v_cvt_pk_bf16_f32 v227, v150, v151
    v_exp_f32 v154, v154
    v_mfma_f32_32x32x16_bf16 v[128:143], a[144:147], v[84:87], v[128:143]
    ds_read_b64_tr_b16 a[190:191], v19 offset:38912
    v_exp_f32 v155, v155
    v_add_f32 v240, v240, v152
    v_mfma_f32_32x32x16_bf16 v[112:127], a[148:151], v[88:91], v[112:127]
    v_add_f32 v241, v241, v153
    v_cvt_pk_bf16_f32 v228, v152, v153
    v_exp_f32 v156, v156
    v_mfma_f32_32x32x16_bf16 v[128:143], a[148:151], v[92:95], v[128:143]
    v_exp_f32 v157, v157
    v_add_f32 v240, v240, v154
    v_mfma_f32_32x32x16_bf16 v[112:127], a[152:155], v[96:99], v[112:127]
    v_add_f32 v241, v241, v155
    v_cvt_pk_bf16_f32 v229, v154, v155
    v_exp_f32 v158, v158
    v_mfma_f32_32x32x16_bf16 v[128:143], a[152:155], v[100:103], v[128:143]
    v_exp_f32 v159, v159
    v_add_f32 v240, v240, v156
    v_mfma_f32_32x32x16_bf16 v[112:127], a[156:159], v[104:107], v[112:127]
    v_add_f32 v241, v241, v157
    v_cvt_pk_bf16_f32 v230, v156, v157
    v_exp_f32 v160, v160
    v_mfma_f32_32x32x16_bf16 v[128:143], a[156:159], v[108:111], v[128:143]
    v_exp_f32 v161, v161
    v_add_f32 v240, v240, v158
    s_waitcnt lgkmcnt(0)
    v_mfma_f32_32x32x16_bf16 a[0:15], a[160:163], v[208:211], a[0:15]
    ds_read_b128 a[128:131], v8 offset:57344
    buffer_load_dwordx4 v[248:251], v26, s[36:39], 0 offen sc1
    v_add_f32 v241, v241, v159
    v_cvt_pk_bf16_f32 v231, v158, v159
    v_exp_f32 v162, v162
    v_mfma_f32_32x32x16_bf16 a[16:31], a[160:163], v[216:219], a[16:31]
    ds_read_b128 a[132:135], v9 offset:57344
    v_exp_f32 v163, v163
    v_add_f32 v242, v242, v160
    v_add_f32 v243, v243, v161
    v_mfma_f32_32x32x16_bf16 a[32:47], a[164:167], v[208:211], a[32:47]
    ds_read_b128 a[136:139], v10 offset:57344
    v_cvt_pk_bf16_f32 v232, v160, v161
    v_exp_f32 v164, v164
    v_exp_f32 v165, v165
    v_mfma_f32_32x32x16_bf16 a[48:63], a[164:167], v[216:219], a[48:63]
    ds_read_b128 a[140:143], v11 offset:57344
    v_add_f32 v242, v242, v162
    v_add_f32 v243, v243, v163
    v_mfma_f32_32x32x16_bf16 a[64:79], a[168:171], v[208:211], a[64:79]
    v_cvt_pk_bf16_f32 v233, v162, v163
    v_exp_f32 v166, v166
    v_exp_f32 v167, v167
    v_mfma_f32_32x32x16_bf16 a[80:95], a[168:171], v[216:219], a[80:95]
    ds_read_b128 a[144:147], v12 offset:57344
    buffer_load_dwordx4 v[252:255], v26, s[36:39], 0 offen offset:1024 sc1
    v_add_f32 v242, v242, v164
    v_add_f32 v243, v243, v165
    v_cvt_pk_bf16_f32 v234, v164, v165
    v_mfma_f32_32x32x16_bf16 a[96:111], a[172:175], v[208:211], a[96:111]
    ds_read_b128 a[148:151], v13 offset:57344
    v_exp_f32 v168, v168
    v_exp_f32 v169, v169
    v_add_f32 v242, v242, v166
    v_mfma_f32_32x32x16_bf16 a[112:127], a[172:175], v[216:219], a[112:127]
    ds_read_b128 a[152:155], v14 offset:57344
    v_add_f32 v243, v243, v167
    v_cvt_pk_bf16_f32 v235, v166, v167
    v_mfma_f32_32x32x16_bf16 a[0:15], a[176:179], v[212:215], a[0:15]
    ds_read_b128 a[156:159], v15 offset:57344
    v_exp_f32 v170, v170
    v_exp_f32 v171, v171
    v_add_f32 v242, v242, v168
    v_mfma_f32_32x32x16_bf16 a[16:31], a[176:179], v[220:223], a[16:31]
    v_add_f32 v243, v243, v169
    v_cvt_pk_bf16_f32 v236, v168, v169
    v_exp_f32 v172, v172
    v_mfma_f32_32x32x16_bf16 a[32:47], a[180:183], v[212:215], a[32:47]
    s_mov_b32 s28, s48
    s_mov_b32 s29, s49
    s_mov_b32 s30, 0x400000
    s_mov_b32 s31, 0x00020000
    s_xor_b32 s87, s71, 3
    s_lshl_b32 s87, s87, 5
    s_add_u32 s87, s87, s81
    v_mfma_f32_32x32x16_bf16 a[48:63], a[180:183], v[220:223], a[48:63]
    s_lshl_b32 s87, s87, 2
    s_and_b32 s85, s2, 3
    s_add_u32 s87, s87, s85
    s_mul_i32 s87, s87, 8192
    s_add_u32 s87, s87, 0
    v_and_b32 v30, 31, v1
    v_mfma_f32_32x32x16_bf16 a[64:79], a[184:187], v[212:215], a[64:79]
    v_min_u32 v30, 31, v30
    v_lshlrev_b32 v30, 7, v30
    v_lshrrev_b32 v29, 5, v1
    v_mul_u32_u24 v29, 4096, v29
    v_add_u32 v30, v30, v29
    buffer_load_dword v31, v30, s[28:31], s87 offen
    v_mfma_f32_32x32x16_bf16 a[80:95], a[184:187], v[220:223], a[80:95]
    v_exp_f32 v173, v173
    v_add_f32 v242, v242, v170
    v_add_f32 v243, v243, v171
    v_cvt_pk_bf16_f32 v237, v170, v171
    v_mfma_f32_32x32x16_bf16 a[96:111], a[188:191], v[212:215], a[96:111]
    v_exp_f32 v174, v174
    v_exp_f32 v175, v175
    v_add_f32 v242, v242, v172
    v_add_f32 v243, v243, v173
    v_cvt_pk_bf16_f32 v238, v172, v173
    v_mfma_f32_32x32x16_bf16 a[112:127], a[188:191], v[220:223], a[112:127]
    s_nop 0
    v_add_f32 v242, v242, v174
    v_add_f32 v243, v243, v175
    v_cvt_pk_bf16_f32 v239, v174, v175
    s_waitcnt lgkmcnt(0)
    s_waitcnt vmcnt(15)
    s_barrier
    v_mfma_f32_32x32x16_bf16 v[144:159], a[128:131], v[48:51], v[176:191]
    ds_read_b64_tr_b16 a[160:161], v16 offset:40960
    ds_read_b64_tr_b16 a[162:163], v16 offset:43008
    v_exp_f32 v112, v112
    v_exp_f32 v113, v113
    v_mfma_f32_32x32x16_bf16 v[160:175], a[128:131], v[52:55], v[192:207]
    ds_read_b64_tr_b16 a[164:165], v17 offset:40960
    ds_read_b64_tr_b16 a[166:167], v17 offset:43008
    v_exp_f32 v114, v114
    v_exp_f32 v115, v115
    v_mfma_f32_32x32x16_bf16 v[144:159], a[132:135], v[56:59], v[144:159]
    ds_read_b64_tr_b16 a[168:169], v18 offset:40960
    v_add_f32 v240, v240, v112
    v_add_f32 v241, v241, v113
    v_cvt_pk_bf16_f32 v208, v112, v113
    v_exp_f32 v116, v116
    v_mfma_f32_32x32x16_bf16 v[160:175], a[132:135], v[60:63], v[160:175]
    ds_read_b64_tr_b16 a[170:171], v18 offset:43008
    ds_read_b64_tr_b16 a[172:173], v19 offset:40960
    v_exp_f32 v117, v117
    v_add_f32 v240, v240, v114
    v_mfma_f32_32x32x16_bf16 v[144:159], a[136:139], v[64:67], v[144:159]
    ds_read_b64_tr_b16 a[174:175], v19 offset:43008
    v_add_f32 v241, v241, v115
    v_cvt_pk_bf16_f32 v209, v114, v115
    v_exp_f32 v118, v118
    v_mfma_f32_32x32x16_bf16 v[160:175], a[136:139], v[68:71], v[160:175]
    ds_read_b64_tr_b16 a[176:177], v16 offset:45056
    ds_read_b64_tr_b16 a[178:179], v16 offset:47104
    v_exp_f32 v119, v119
    v_add_f32 v240, v240, v116
    v_mfma_f32_32x32x16_bf16 v[144:159], a[140:143], v[72:75], v[144:159]
    ds_read_b64_tr_b16 a[180:181], v17 offset:45056
    ds_read_b64_tr_b16 a[182:183], v17 offset:47104
    v_add_f32 v241, v241, v117
    v_cvt_pk_bf16_f32 v210, v116, v117
    v_exp_f32 v120, v120
    v_mfma_f32_32x32x16_bf16 v[160:175], a[140:143], v[76:79], v[160:175]
    ds_read_b64_tr_b16 a[184:185], v18 offset:45056
    v_exp_f32 v121, v121
    v_add_f32 v240, v240, v118
    v_mfma_f32_32x32x16_bf16 v[144:159], a[144:147], v[80:83], v[144:159]
    ds_read_b64_tr_b16 a[186:187], v18 offset:47104
    ds_read_b64_tr_b16 a[188:189], v19 offset:45056
    v_add_f32 v241, v241, v119
    v_cvt_pk_bf16_f32 v211, v118, v119
    v_exp_f32 v122, v122
    v_mfma_f32_32x32x16_bf16 v[160:175], a[144:147], v[84:87], v[160:175]
    ds_read_b64_tr_b16 a[190:191], v19 offset:47104
    v_exp_f32 v123, v123
    v_add_f32 v240, v240, v120
    v_mfma_f32_32x32x16_bf16 v[144:159], a[148:151], v[88:91], v[144:159]
    v_add_f32 v241, v241, v121
    v_cvt_pk_bf16_f32 v212, v120, v121
    v_exp_f32 v124, v124
    v_mfma_f32_32x32x16_bf16 v[160:175], a[148:151], v[92:95], v[160:175]
    v_exp_f32 v125, v125
    v_add_f32 v240, v240, v122
    v_mfma_f32_32x32x16_bf16 v[144:159], a[152:155], v[96:99], v[144:159]
    v_add_f32 v241, v241, v123
    v_cvt_pk_bf16_f32 v213, v122, v123
    v_exp_f32 v126, v126
    v_mfma_f32_32x32x16_bf16 v[160:175], a[152:155], v[100:103], v[160:175]
    v_exp_f32 v127, v127
    v_add_f32 v240, v240, v124
    v_mfma_f32_32x32x16_bf16 v[144:159], a[156:159], v[104:107], v[144:159]
    v_add_f32 v241, v241, v125
    v_cvt_pk_bf16_f32 v214, v124, v125
    v_exp_f32 v128, v128
    v_mfma_f32_32x32x16_bf16 v[160:175], a[156:159], v[108:111], v[160:175]
    v_exp_f32 v129, v129
    v_add_f32 v240, v240, v126
    s_waitcnt lgkmcnt(0)
    v_mfma_f32_32x32x16_bf16 a[0:15], a[160:163], v[224:227], a[0:15]
    ds_read_b128 a[128:131], v8 offset:0
    s_add_u32 m0, s68, 49152
    s_add_u32 s86, s68, 114688
    buffer_load_dwordx4 v20, s[16:19], s86 offen offset:0 lds
    v_add_f32 v241, v241, v127
    v_cvt_pk_bf16_f32 v215, v126, v127
    v_mfma_f32_32x32x16_bf16 a[16:31], a[160:163], v[232:235], a[16:31]
    ds_read_b128 a[132:135], v9 offset:0
    v_exp_f32 v130, v130
    v_exp_f32 v131, v131
    v_add_f32 v242, v242, v128
    v_mfma_f32_32x32x16_bf16 a[32:47], a[164:167], v[224:227], a[32:47]
    ds_read_b128 a[136:139], v10 offset:0
    buffer_load_dwordx4 v21, s[16:19], s86 offen offset:1024 lds
    v_add_f32 v243, v243, v129
    v_cvt_pk_bf16_f32 v216, v128, v129
    v_exp_f32 v132, v132
    v_mfma_f32_32x32x16_bf16 a[48:63], a[164:167], v[232:235], a[48:63]
    ds_read_b128 a[140:143], v11 offset:0
    v_exp_f32 v133, v133
    v_add_f32 v242, v242, v130
    v_add_f32 v243, v243, v131
    v_mfma_f32_32x32x16_bf16 a[64:79], a[168:171], v[224:227], a[64:79]
    buffer_load_dwordx4 v22, s[16:19], s86 offen offset:2048 lds
    v_cvt_pk_bf16_f32 v217, v130, v131
    v_exp_f32 v134, v134
    v_exp_f32 v135, v135
    v_mfma_f32_32x32x16_bf16 a[80:95], a[168:171], v[232:235], a[80:95]
    ds_read_b128 a[144:147], v12 offset:0
    v_add_f32 v242, v242, v132
    v_add_f32 v243, v243, v133
    v_cvt_pk_bf16_f32 v218, v132, v133
    v_mfma_f32_32x32x16_bf16 a[96:111], a[172:175], v[224:227], a[96:111]
    ds_read_b128 a[148:151], v13 offset:0
    buffer_load_dwordx4 v23, s[16:19], s86 offen offset:3072 lds
    v_exp_f32 v136, v136
    v_exp_f32 v137, v137
    v_add_f32 v242, v242, v134
    v_mfma_f32_32x32x16_bf16 a[112:127], a[172:175], v[232:235], a[112:127]
    ds_read_b128 a[152:155], v14 offset:0
    v_add_f32 v243, v243, v135
    v_cvt_pk_bf16_f32 v219, v134, v135
    v_mfma_f32_32x32x16_bf16 a[0:15], a[176:179], v[228:231], a[0:15]
    ds_read_b128 a[156:159], v15 offset:0
    s_add_u32 m0, s68, 81920
    s_add_u32 s86, s68, 81920
    buffer_load_dwordx4 v24, s[20:23], s86 offen offset:0 lds
    v_exp_f32 v138, v138
    v_mfma_f32_32x32x16_bf16 a[16:31], a[176:179], v[236:239], a[16:31]
    v_exp_f32 v139, v139
    v_add_f32 v242, v242, v136
    v_add_f32 v243, v243, v137
    v_cvt_pk_bf16_f32 v220, v136, v137
    v_exp_f32 v140, v140
    v_mfma_f32_32x32x16_bf16 a[32:47], a[180:183], v[228:231], a[32:47]
    buffer_load_dwordx4 v24, s[20:23], s86 offen offset:1024 lds
    v_exp_f32 v141, v141
    v_add_f32 v242, v242, v138
    v_add_f32 v243, v243, v139
    v_mfma_f32_32x32x16_bf16 a[48:63], a[180:183], v[236:239], a[48:63]
    v_cvt_pk_bf16_f32 v221, v138, v139
    v_exp_f32 v142, v142
    v_mfma_f32_32x32x16_bf16 a[64:79], a[184:187], v[228:231], a[64:79]
    buffer_load_dwordx4 v24, s[20:23], s86 offen offset:2048 lds
    v_exp_f32 v143, v143
    v_add_f32 v242, v242, v140
    v_add_f32 v243, v243, v141
    v_mfma_f32_32x32x16_bf16 a[80:95], a[184:187], v[236:239], a[80:95]
    v_cvt_pk_bf16_f32 v222, v140, v141
    s_nop 0
    v_add_f32 v242, v242, v142
    v_mfma_f32_32x32x16_bf16 a[96:111], a[188:191], v[228:231], a[96:111]
    buffer_load_dwordx4 v24, s[20:23], s86 offen offset:3072 lds
    v_add_f32 v243, v243, v143
    v_cvt_pk_bf16_f32 v223, v142, v143
    v_mfma_f32_32x32x16_bf16 a[112:127], a[188:191], v[236:239], a[112:127]
    s_waitcnt lgkmcnt(0)
    v_mfma_f32_32x32x16_bf16 v[112:127], a[128:131], v[48:51], v[176:191]
    ds_read_b64_tr_b16 a[160:161], v16 offset:49152
    ds_read_b64_tr_b16 a[162:163], v16 offset:51200
    v_exp_f32 v144, v144
    v_exp_f32 v145, v145
    v_mfma_f32_32x32x16_bf16 v[128:143], a[128:131], v[52:55], v[192:207]
    ds_read_b64_tr_b16 a[164:165], v17 offset:49152
    ds_read_b64_tr_b16 a[166:167], v17 offset:51200
    v_exp_f32 v146, v146
    v_exp_f32 v147, v147
    v_mfma_f32_32x32x16_bf16 v[112:127], a[132:135], v[56:59], v[112:127]
    ds_read_b64_tr_b16 a[168:169], v18 offset:49152
    v_add_f32 v240, v240, v144
    v_add_f32 v241, v241, v145
    v_cvt_pk_bf16_f32 v224, v144, v145
    v_exp_f32 v148, v148
    v_mfma_f32_32x32x16_bf16 v[128:143], a[132:135], v[60:63], v[128:143]
    ds_read_b64_tr_b16 a[170:171], v18 offset:51200
    ds_read_b64_tr_b16 a[172:173], v19 offset:49152
    v_exp_f32 v149, v149
    v_add_f32 v240, v240, v146
    v_mfma_f32_32x32x16_bf16 v[112:127], a[136:139], v[64:67], v[112:127]
    ds_read_b64_tr_b16 a[174:175], v19 offset:51200
    v_add_f32 v241, v241, v147
    v_cvt_pk_bf16_f32 v225, v146, v147
    v_exp_f32 v150, v150
    v_mfma_f32_32x32x16_bf16 v[128:143], a[136:139], v[68:71], v[128:143]
    ds_read_b64_tr_b16 a[176:177], v16 offset:53248
    ds_read_b64_tr_b16 a[178:179], v16 offset:55296
    v_exp_f32 v151, v151
    v_add_f32 v240, v240, v148
    v_mfma_f32_32x32x16_bf16 v[112:127], a[140:143], v[72:75], v[112:127]
    ds_read_b64_tr_b16 a[180:181], v17 offset:53248
    ds_read_b64_tr_b16 a[182:183], v17 offset:55296
    v_add_f32 v241, v241, v149
    v_cvt_pk_bf16_f32 v226, v148, v149
    v_exp_f32 v152, v152
    v_mfma_f32_32x32x16_bf16 v[128:143], a[140:143], v[76:79], v[128:143]
    ds_read_b64_tr_b16 a[184:185], v18 offset:53248
    v_exp_f32 v153, v153
    v_add_f32 v240, v240, v150
    v_mfma_f32_32x32x16_bf16 v[112:127], a[144:147], v[80:83], v[112:127]
    ds_read_b64_tr_b16 a[186:187], v18 offset:55296
    ds_read_b64_tr_b16 a[188:189], v19 offset:53248
    v_add_f32 v241, v241, v151
    v_cvt_pk_bf16_f32 v227, v150, v151
    v_exp_f32 v154, v154
    v_mfma_f32_32x32x16_bf16 v[128:143], a[144:147], v[84:87], v[128:143]
    ds_read_b64_tr_b16 a[190:191], v19 offset:55296
    v_exp_f32 v155, v155
    v_add_f32 v240, v240, v152
    v_mfma_f32_32x32x16_bf16 v[112:127], a[148:151], v[88:91], v[112:127]
    v_add_f32 v241, v241, v153
    v_cvt_pk_bf16_f32 v228, v152, v153
    v_exp_f32 v156, v156
    v_mfma_f32_32x32x16_bf16 v[128:143], a[148:151], v[92:95], v[128:143]
    v_exp_f32 v157, v157
    v_add_f32 v240, v240, v154
    v_mfma_f32_32x32x16_bf16 v[112:127], a[152:155], v[96:99], v[112:127]
    v_add_f32 v241, v241, v155
    v_cvt_pk_bf16_f32 v229, v154, v155
    v_exp_f32 v158, v158
    v_mfma_f32_32x32x16_bf16 v[128:143], a[152:155], v[100:103], v[128:143]
    v_exp_f32 v159, v159
    v_add_f32 v240, v240, v156
    v_mfma_f32_32x32x16_bf16 v[112:127], a[156:159], v[104:107], v[112:127]
    v_add_f32 v241, v241, v157
    v_cvt_pk_bf16_f32 v230, v156, v157
    v_exp_f32 v160, v160
    v_mfma_f32_32x32x16_bf16 v[128:143], a[156:159], v[108:111], v[128:143]
    v_exp_f32 v161, v161
    v_add_f32 v240, v240, v158
    s_waitcnt lgkmcnt(0)
    v_mfma_f32_32x32x16_bf16 a[0:15], a[160:163], v[208:211], a[0:15]
    ds_read_b128 a[128:131], v8 offset:8192
    v_add_f32 v241, v241, v159
    v_cvt_pk_bf16_f32 v231, v158, v159
    v_exp_f32 v162, v162
    v_mfma_f32_32x32x16_bf16 a[16:31], a[160:163], v[216:219], a[16:31]
    ds_read_b128 a[132:135], v9 offset:8192
    v_exp_f32 v163, v163
    v_add_f32 v242, v242, v160
    v_add_f32 v243, v243, v161
    v_mfma_f32_32x32x16_bf16 a[32:47], a[164:167], v[208:211], a[32:47]
    ds_read_b128 a[136:139], v10 offset:8192
    v_cvt_pk_bf16_f32 v232, v160, v161
    v_exp_f32 v164, v164
    v_exp_f32 v165, v165
    v_mfma_f32_32x32x16_bf16 a[48:63], a[164:167], v[216:219], a[48:63]
    ds_read_b128 a[140:143], v11 offset:8192
    v_add_f32 v242, v242, v162
    v_add_f32 v243, v243, v163
    v_mfma_f32_32x32x16_bf16 a[64:79], a[168:171], v[208:211], a[64:79]
    v_cvt_pk_bf16_f32 v233, v162, v163
    v_exp_f32 v166, v166
    v_exp_f32 v167, v167
    v_mfma_f32_32x32x16_bf16 a[80:95], a[168:171], v[216:219], a[80:95]
    ds_read_b128 a[144:147], v12 offset:8192
    v_add_f32 v242, v242, v164
    v_add_f32 v243, v243, v165
    v_cvt_pk_bf16_f32 v234, v164, v165
    v_mfma_f32_32x32x16_bf16 a[96:111], a[172:175], v[208:211], a[96:111]
    ds_read_b128 a[148:151], v13 offset:8192
    v_exp_f32 v168, v168
    v_exp_f32 v169, v169
    v_add_f32 v242, v242, v166
    v_mfma_f32_32x32x16_bf16 a[112:127], a[172:175], v[216:219], a[112:127]
    ds_read_b128 a[152:155], v14 offset:8192
    v_add_f32 v243, v243, v167
    v_cvt_pk_bf16_f32 v235, v166, v167
    v_mfma_f32_32x32x16_bf16 a[0:15], a[176:179], v[212:215], a[0:15]
    ds_read_b128 a[156:159], v15 offset:8192
    v_exp_f32 v170, v170
    v_exp_f32 v171, v171
    v_add_f32 v242, v242, v168
    v_mfma_f32_32x32x16_bf16 a[16:31], a[176:179], v[220:223], a[16:31]
    v_add_f32 v243, v243, v169
    v_cvt_pk_bf16_f32 v236, v168, v169
    v_exp_f32 v172, v172
    v_mfma_f32_32x32x16_bf16 a[32:47], a[180:183], v[212:215], a[32:47]
    v_exp_f32 v173, v173
    v_add_f32 v242, v242, v170
    v_add_f32 v243, v243, v171
    v_mfma_f32_32x32x16_bf16 a[48:63], a[180:183], v[220:223], a[48:63]
    v_cvt_pk_bf16_f32 v237, v170, v171
    v_exp_f32 v174, v174
    v_mfma_f32_32x32x16_bf16 a[64:79], a[184:187], v[212:215], a[64:79]
    v_exp_f32 v175, v175
    v_add_f32 v242, v242, v172
    v_add_f32 v243, v243, v173
    v_mfma_f32_32x32x16_bf16 a[80:95], a[184:187], v[220:223], a[80:95]
    v_cvt_pk_bf16_f32 v238, v172, v173
    s_nop 0
    v_add_f32 v242, v242, v174
    v_mfma_f32_32x32x16_bf16 a[96:111], a[188:191], v[212:215], a[96:111]
    v_add_f32 v243, v243, v175
    v_cvt_pk_bf16_f32 v239, v174, v175
    v_mfma_f32_32x32x16_bf16 a[112:127], a[188:191], v[220:223], a[112:127]
    s_waitcnt lgkmcnt(0)
    s_waitcnt vmcnt(11)
    s_barrier
    v_mfma_f32_32x32x16_bf16 v[144:159], a[128:131], v[48:51], v[176:191]
    ds_read_b64_tr_b16 a[160:161], v16 offset:57344
    ds_read_b64_tr_b16 a[162:163], v16 offset:59392
    v_exp_f32 v112, v112
    v_exp_f32 v113, v113
    v_mfma_f32_32x32x16_bf16 v[160:175], a[128:131], v[52:55], v[192:207]
    ds_read_b64_tr_b16 a[164:165], v17 offset:57344
    ds_read_b64_tr_b16 a[166:167], v17 offset:59392
    v_exp_f32 v114, v114
    v_exp_f32 v115, v115
    v_mfma_f32_32x32x16_bf16 v[144:159], a[132:135], v[56:59], v[144:159]
    ds_read_b64_tr_b16 a[168:169], v18 offset:57344
    v_add_f32 v240, v240, v112
    v_add_f32 v241, v241, v113
    v_cvt_pk_bf16_f32 v208, v112, v113
    v_exp_f32 v116, v116
    v_mfma_f32_32x32x16_bf16 v[160:175], a[132:135], v[60:63], v[160:175]
    ds_read_b64_tr_b16 a[170:171], v18 offset:59392
    ds_read_b64_tr_b16 a[172:173], v19 offset:57344
    v_exp_f32 v117, v117
    v_add_f32 v240, v240, v114
    v_mfma_f32_32x32x16_bf16 v[144:159], a[136:139], v[64:67], v[144:159]
    ds_read_b64_tr_b16 a[174:175], v19 offset:59392
    v_add_f32 v241, v241, v115
    v_cvt_pk_bf16_f32 v209, v114, v115
    v_exp_f32 v118, v118
    v_mfma_f32_32x32x16_bf16 v[160:175], a[136:139], v[68:71], v[160:175]
    ds_read_b64_tr_b16 a[176:177], v16 offset:61440
    ds_read_b64_tr_b16 a[178:179], v16 offset:63488
    v_exp_f32 v119, v119
    v_add_f32 v240, v240, v116
    v_mfma_f32_32x32x16_bf16 v[144:159], a[140:143], v[72:75], v[144:159]
    ds_read_b64_tr_b16 a[180:181], v17 offset:61440
    ds_read_b64_tr_b16 a[182:183], v17 offset:63488
    v_add_f32 v241, v241, v117
    v_cvt_pk_bf16_f32 v210, v116, v117
    v_exp_f32 v120, v120
    v_mfma_f32_32x32x16_bf16 v[160:175], a[140:143], v[76:79], v[160:175]
    ds_read_b64_tr_b16 a[184:185], v18 offset:61440
    v_exp_f32 v121, v121
    v_add_f32 v240, v240, v118
    v_mfma_f32_32x32x16_bf16 v[144:159], a[144:147], v[80:83], v[144:159]
    ds_read_b64_tr_b16 a[186:187], v18 offset:63488
    ds_read_b64_tr_b16 a[188:189], v19 offset:61440
    v_add_f32 v241, v241, v119
    v_cvt_pk_bf16_f32 v211, v118, v119
    v_exp_f32 v122, v122
    v_mfma_f32_32x32x16_bf16 v[160:175], a[144:147], v[84:87], v[160:175]
    ds_read_b64_tr_b16 a[190:191], v19 offset:63488
    v_exp_f32 v123, v123
    v_add_f32 v240, v240, v120
    v_mfma_f32_32x32x16_bf16 v[144:159], a[148:151], v[88:91], v[144:159]
    v_add_f32 v241, v241, v121
    v_cvt_pk_bf16_f32 v212, v120, v121
    v_exp_f32 v124, v124
    v_mfma_f32_32x32x16_bf16 v[160:175], a[148:151], v[92:95], v[160:175]
    v_exp_f32 v125, v125
    v_add_f32 v240, v240, v122
    v_mfma_f32_32x32x16_bf16 v[144:159], a[152:155], v[96:99], v[144:159]
    v_add_f32 v241, v241, v123
    v_cvt_pk_bf16_f32 v213, v122, v123
    v_exp_f32 v126, v126
    v_mfma_f32_32x32x16_bf16 v[160:175], a[152:155], v[100:103], v[160:175]
    v_exp_f32 v127, v127
    v_add_f32 v240, v240, v124
    v_mfma_f32_32x32x16_bf16 v[144:159], a[156:159], v[104:107], v[144:159]
    v_add_f32 v241, v241, v125
    v_cvt_pk_bf16_f32 v214, v124, v125
    v_exp_f32 v128, v128
    v_mfma_f32_32x32x16_bf16 v[160:175], a[156:159], v[108:111], v[160:175]
    v_exp_f32 v129, v129
    v_add_f32 v240, v240, v126
    s_waitcnt lgkmcnt(0)
    v_mfma_f32_32x32x16_bf16 a[0:15], a[160:163], v[224:227], a[0:15]
    ds_read_b128 a[128:131], v8 offset:16384
    s_add_u32 m0, s68, 98304
    s_add_u32 s86, s68, 98304
    buffer_load_dwordx4 v24, s[20:23], s86 offen offset:0 lds
    v_add_f32 v241, v241, v127
    v_cvt_pk_bf16_f32 v215, v126, v127
    v_mfma_f32_32x32x16_bf16 a[16:31], a[160:163], v[232:235], a[16:31]
    ds_read_b128 a[132:135], v9 offset:16384
    v_exp_f32 v130, v130
    v_exp_f32 v131, v131
    v_add_f32 v242, v242, v128
    v_mfma_f32_32x32x16_bf16 a[32:47], a[164:167], v[224:227], a[32:47]
    ds_read_b128 a[136:139], v10 offset:16384
    v_add_f32 v243, v243, v129
    v_cvt_pk_bf16_f32 v216, v128, v129
    v_exp_f32 v132, v132
    v_mfma_f32_32x32x16_bf16 a[48:63], a[164:167], v[232:235], a[48:63]
    ds_read_b128 a[140:143], v11 offset:16384
    buffer_load_dwordx4 v24, s[20:23], s86 offen offset:1024 lds
    v_exp_f32 v133, v133
    v_add_f32 v242, v242, v130
    v_add_f32 v243, v243, v131
    v_mfma_f32_32x32x16_bf16 a[64:79], a[168:171], v[224:227], a[64:79]
    v_cvt_pk_bf16_f32 v217, v130, v131
    v_exp_f32 v134, v134
    v_exp_f32 v135, v135
    v_mfma_f32_32x32x16_bf16 a[80:95], a[168:171], v[232:235], a[80:95]
    ds_read_b128 a[144:147], v12 offset:16384
    v_add_f32 v242, v242, v132
    v_add_f32 v243, v243, v133
    v_cvt_pk_bf16_f32 v218, v132, v133
    v_mfma_f32_32x32x16_bf16 a[96:111], a[172:175], v[224:227], a[96:111]
    ds_read_b128 a[148:151], v13 offset:16384
    buffer_load_dwordx4 v24, s[20:23], s86 offen offset:2048 lds
    v_exp_f32 v136, v136
    v_exp_f32 v137, v137
    v_add_f32 v242, v242, v134
    v_mfma_f32_32x32x16_bf16 a[112:127], a[172:175], v[232:235], a[112:127]
    ds_read_b128 a[152:155], v14 offset:16384
    v_add_f32 v243, v243, v135
    v_cvt_pk_bf16_f32 v219, v134, v135
    v_mfma_f32_32x32x16_bf16 a[0:15], a[176:179], v[228:231], a[0:15]
    ds_read_b128 a[156:159], v15 offset:16384
    v_exp_f32 v138, v138
    v_exp_f32 v139, v139
    v_add_f32 v242, v242, v136
    v_mfma_f32_32x32x16_bf16 a[16:31], a[176:179], v[236:239], a[16:31]
    buffer_load_dwordx4 v24, s[20:23], s86 offen offset:3072 lds
    v_add_f32 v243, v243, v137
    v_cvt_pk_bf16_f32 v220, v136, v137
    v_exp_f32 v140, v140
    v_mfma_f32_32x32x16_bf16 a[32:47], a[180:183], v[228:231], a[32:47]
    v_exp_f32 v141, v141
    v_add_f32 v242, v242, v138
    v_add_f32 v243, v243, v139
    v_mfma_f32_32x32x16_bf16 a[48:63], a[180:183], v[236:239], a[48:63]
    v_cvt_pk_bf16_f32 v221, v138, v139
    v_exp_f32 v142, v142
    v_mfma_f32_32x32x16_bf16 a[64:79], a[184:187], v[228:231], a[64:79]
    s_mov_b32 s28, s40
    s_mov_b32 s29, s41
    s_mov_b32 s30, 0x400000
    s_mov_b32 s31, 0x00020000
    s_xor_b32 s87, s71, 3
    s_lshl_b32 s87, s87, 5
    s_add_u32 s87, s87, s81
    v_mfma_f32_32x32x16_bf16 a[80:95], a[184:187], v[236:239], a[80:95]
    s_lshl_b32 s87, s87, 2
    s_and_b32 s85, s2, 3
    s_add_u32 s87, s87, s85
    s_mul_i32 s87, s87, 8192
    s_add_u32 s87, s87, 0
    v_and_b32 v30, 31, v1
    v_mfma_f32_32x32x16_bf16 a[96:111], a[188:191], v[228:231], a[96:111]
    v_min_u32 v30, 31, v30
    v_lshlrev_b32 v30, 7, v30
    v_lshrrev_b32 v29, 5, v1
    v_mul_u32_u24 v29, 4096, v29
    v_add_u32 v30, v30, v29
    buffer_load_dword v31, v30, s[28:31], s87 offen
    v_mfma_f32_32x32x16_bf16 a[112:127], a[188:191], v[236:239], a[112:127]
    v_exp_f32 v143, v143
    v_add_f32 v242, v242, v140
    v_add_f32 v243, v243, v141
    v_cvt_pk_bf16_f32 v222, v140, v141
    s_nop 0
    v_add_f32 v242, v242, v142
    v_add_f32 v243, v243, v143
    v_cvt_pk_bf16_f32 v223, v142, v143
    s_waitcnt lgkmcnt(0)
    v_mfma_f32_32x32x16_bf16 v[112:127], a[128:131], v[48:51], v[176:191]
    ds_read_b64_tr_b16 a[160:161], v16 offset:0
    ds_read_b64_tr_b16 a[162:163], v16 offset:2048
    v_exp_f32 v144, v144
    v_exp_f32 v145, v145
    v_mfma_f32_32x32x16_bf16 v[128:143], a[128:131], v[52:55], v[192:207]
    ds_read_b64_tr_b16 a[164:165], v17 offset:0
    ds_read_b64_tr_b16 a[166:167], v17 offset:2048
    v_exp_f32 v146, v146
    v_exp_f32 v147, v147
    v_mfma_f32_32x32x16_bf16 v[112:127], a[132:135], v[56:59], v[112:127]
    ds_read_b64_tr_b16 a[168:169], v18 offset:0
    v_add_f32 v240, v240, v144
    v_add_f32 v241, v241, v145
    v_cvt_pk_bf16_f32 v224, v144, v145
    v_exp_f32 v148, v148
    v_mfma_f32_32x32x16_bf16 v[128:143], a[132:135], v[60:63], v[128:143]
    ds_read_b64_tr_b16 a[170:171], v18 offset:2048
    ds_read_b64_tr_b16 a[172:173], v19 offset:0
    v_exp_f32 v149, v149
    v_add_f32 v240, v240, v146
    v_mfma_f32_32x32x16_bf16 v[112:127], a[136:139], v[64:67], v[112:127]
    ds_read_b64_tr_b16 a[174:175], v19 offset:2048
    v_add_f32 v241, v241, v147
    v_cvt_pk_bf16_f32 v225, v146, v147
    v_exp_f32 v150, v150
    v_mfma_f32_32x32x16_bf16 v[128:143], a[136:139], v[68:71], v[128:143]
    ds_read_b64_tr_b16 a[176:177], v16 offset:4096
    ds_read_b64_tr_b16 a[178:179], v16 offset:6144
    v_exp_f32 v151, v151
    v_add_f32 v240, v240, v148
    v_mfma_f32_32x32x16_bf16 v[112:127], a[140:143], v[72:75], v[112:127]
    ds_read_b64_tr_b16 a[180:181], v17 offset:4096
    ds_read_b64_tr_b16 a[182:183], v17 offset:6144
    v_add_f32 v241, v241, v149
    v_cvt_pk_bf16_f32 v226, v148, v149
    v_exp_f32 v152, v152
    v_mfma_f32_32x32x16_bf16 v[128:143], a[140:143], v[76:79], v[128:143]
    ds_read_b64_tr_b16 a[184:185], v18 offset:4096
    v_exp_f32 v153, v153
    v_add_f32 v240, v240, v150
    v_mfma_f32_32x32x16_bf16 v[112:127], a[144:147], v[80:83], v[112:127]
    ds_read_b64_tr_b16 a[186:187], v18 offset:6144
    ds_read_b64_tr_b16 a[188:189], v19 offset:4096
    v_add_f32 v241, v241, v151
    v_cvt_pk_bf16_f32 v227, v150, v151
    v_exp_f32 v154, v154
    v_mfma_f32_32x32x16_bf16 v[128:143], a[144:147], v[84:87], v[128:143]
    ds_read_b64_tr_b16 a[190:191], v19 offset:6144
    v_exp_f32 v155, v155
    v_add_f32 v240, v240, v152
    v_mfma_f32_32x32x16_bf16 v[112:127], a[148:151], v[88:91], v[112:127]
    v_add_f32 v241, v241, v153
    v_cvt_pk_bf16_f32 v228, v152, v153
    v_exp_f32 v156, v156
    v_mfma_f32_32x32x16_bf16 v[128:143], a[148:151], v[92:95], v[128:143]
    v_exp_f32 v157, v157
    v_add_f32 v240, v240, v154
    v_mfma_f32_32x32x16_bf16 v[112:127], a[152:155], v[96:99], v[112:127]
    v_add_f32 v241, v241, v155
    v_cvt_pk_bf16_f32 v229, v154, v155
    v_exp_f32 v158, v158
    v_mfma_f32_32x32x16_bf16 v[128:143], a[152:155], v[100:103], v[128:143]
    v_exp_f32 v159, v159
    v_add_f32 v240, v240, v156
    v_mfma_f32_32x32x16_bf16 v[112:127], a[156:159], v[104:107], v[112:127]
    v_add_f32 v241, v241, v157
    v_cvt_pk_bf16_f32 v230, v156, v157
    v_exp_f32 v160, v160
    v_mfma_f32_32x32x16_bf16 v[128:143], a[156:159], v[108:111], v[128:143]
    v_exp_f32 v161, v161
    v_add_f32 v240, v240, v158
    s_waitcnt lgkmcnt(0)
    v_mfma_f32_32x32x16_bf16 a[0:15], a[160:163], v[208:211], a[0:15]
    ds_read_b128 a[128:131], v8 offset:24576
    v_add_f32 v241, v241, v159
    v_cvt_pk_bf16_f32 v231, v158, v159
    v_exp_f32 v162, v162
    v_mfma_f32_32x32x16_bf16 a[16:31], a[160:163], v[216:219], a[16:31]
    ds_read_b128 a[132:135], v9 offset:24576
    v_exp_f32 v163, v163
    v_add_f32 v242, v242, v160
    v_add_f32 v243, v243, v161
    v_mfma_f32_32x32x16_bf16 a[32:47], a[164:167], v[208:211], a[32:47]
    ds_read_b128 a[136:139], v10 offset:24576
    v_cvt_pk_bf16_f32 v232, v160, v161
    v_exp_f32 v164, v164
    v_exp_f32 v165, v165
    v_mfma_f32_32x32x16_bf16 a[48:63], a[164:167], v[216:219], a[48:63]
    ds_read_b128 a[140:143], v11 offset:24576
    v_add_f32 v242, v242, v162
    v_add_f32 v243, v243, v163
    v_mfma_f32_32x32x16_bf16 a[64:79], a[168:171], v[208:211], a[64:79]
    v_cvt_pk_bf16_f32 v233, v162, v163
    v_exp_f32 v166, v166
    v_exp_f32 v167, v167
    v_mfma_f32_32x32x16_bf16 a[80:95], a[168:171], v[216:219], a[80:95]
    ds_read_b128 a[144:147], v12 offset:24576
    v_add_f32 v242, v242, v164
    v_add_f32 v243, v243, v165
    v_cvt_pk_bf16_f32 v234, v164, v165
    v_mfma_f32_32x32x16_bf16 a[96:111], a[172:175], v[208:211], a[96:111]
    ds_read_b128 a[148:151], v13 offset:24576
    v_exp_f32 v168, v168
    v_exp_f32 v169, v169
    v_add_f32 v242, v242, v166
    v_mfma_f32_32x32x16_bf16 a[112:127], a[172:175], v[216:219], a[112:127]
    ds_read_b128 a[152:155], v14 offset:24576
    v_add_f32 v243, v243, v167
    v_cvt_pk_bf16_f32 v235, v166, v167
    v_mfma_f32_32x32x16_bf16 a[0:15], a[176:179], v[212:215], a[0:15]
    ds_read_b128 a[156:159], v15 offset:24576
    v_exp_f32 v170, v170
    v_exp_f32 v171, v171
    v_add_f32 v242, v242, v168
    v_mfma_f32_32x32x16_bf16 a[16:31], a[176:179], v[220:223], a[16:31]
    v_add_f32 v243, v243, v169
    v_cvt_pk_bf16_f32 v236, v168, v169
    v_exp_f32 v172, v172
    v_mfma_f32_32x32x16_bf16 a[32:47], a[180:183], v[212:215], a[32:47]
    v_exp_f32 v173, v173
    v_add_f32 v242, v242, v170
    v_add_f32 v243, v243, v171
    v_mfma_f32_32x32x16_bf16 a[48:63], a[180:183], v[220:223], a[48:63]
    v_cvt_pk_bf16_f32 v237, v170, v171
    v_exp_f32 v174, v174
    v_mfma_f32_32x32x16_bf16 a[64:79], a[184:187], v[212:215], a[64:79]
    v_exp_f32 v175, v175
    v_add_f32 v242, v242, v172
    v_add_f32 v243, v243, v173
    v_mfma_f32_32x32x16_bf16 a[80:95], a[184:187], v[220:223], a[80:95]
    v_cvt_pk_bf16_f32 v238, v172, v173
    s_nop 0
    v_add_f32 v242, v242, v174
    v_mfma_f32_32x32x16_bf16 a[96:111], a[188:191], v[212:215], a[96:111]
    v_add_f32 v243, v243, v175
    v_cvt_pk_bf16_f32 v239, v174, v175
    v_mfma_f32_32x32x16_bf16 a[112:127], a[188:191], v[220:223], a[112:127]
    s_waitcnt lgkmcnt(0)
    s_waitcnt vmcnt(5)
    s_barrier
    s_mov_b32 s83, 0
km_ph_chk:
    v_cmp_ne_u64 vcc, s[50:51], v[248:249]
    v_cmp_ne_u64 s[84:85], s[50:51], v[250:251]
    s_or_b64 vcc, vcc, s[84:85]
    v_cmp_ne_u64 s[84:85], s[50:51], v[252:253]
    s_or_b64 vcc, vcc, s[84:85]
    v_cmp_ne_u64 s[84:85], s[50:51], v[254:255]
    s_or_b64 vcc, vcc, s[84:85]
    s_add_u32 s83, s83, 1
    s_cbranch_vccz km_ph_ok
    s_cmp_gt_u32 s83, 0x20000
    s_cbranch_scc1 km_ph_ok
    s_sleep 2
    buffer_load_dwordx4 v[248:251], v26, s[36:39], 0 offen sc1
    buffer_load_dwordx4 v[252:255], v26, s[36:39], 0 offen offset:1024 sc1
    s_waitcnt vmcnt(0)
    s_branch km_ph_chk
km_ph_ok:
    v_mfma_f32_32x32x16_bf16 v[144:159], a[128:131], v[48:51], v[176:191]
    ds_read_b64_tr_b16 a[160:161], v16 offset:8192
    ds_read_b64_tr_b16 a[162:163], v16 offset:10240
    v_exp_f32 v112, v112
    v_exp_f32 v113, v113
    v_mfma_f32_32x32x16_bf16 v[160:175], a[128:131], v[52:55], v[192:207]
    ds_read_b64_tr_b16 a[164:165], v17 offset:8192
    ds_read_b64_tr_b16 a[166:167], v17 offset:10240
    v_exp_f32 v114, v114
    v_exp_f32 v115, v115
    v_mfma_f32_32x32x16_bf16 v[144:159], a[132:135], v[56:59], v[144:159]
    ds_read_b64_tr_b16 a[168:169], v18 offset:8192
    v_add_f32 v240, v240, v112
    v_add_f32 v241, v241, v113
    v_cvt_pk_bf16_f32 v208, v112, v113
    v_exp_f32 v116, v116
    v_mfma_f32_32x32x16_bf16 v[160:175], a[132:135], v[60:63], v[160:175]
    ds_read_b64_tr_b16 a[170:171], v18 offset:10240
    ds_read_b64_tr_b16 a[172:173], v19 offset:8192
    v_exp_f32 v117, v117
    v_add_f32 v240, v240, v114
    v_mfma_f32_32x32x16_bf16 v[144:159], a[136:139], v[64:67], v[144:159]
    ds_read_b64_tr_b16 a[174:175], v19 offset:10240
    v_add_f32 v241, v241, v115
    v_cvt_pk_bf16_f32 v209, v114, v115
    v_exp_f32 v118, v118
    v_mfma_f32_32x32x16_bf16 v[160:175], a[136:139], v[68:71], v[160:175]
    ds_read_b64_tr_b16 a[176:177], v16 offset:12288
    ds_read_b64_tr_b16 a[178:179], v16 offset:14336
    v_exp_f32 v119, v119
    v_add_f32 v240, v240, v116
    v_mfma_f32_32x32x16_bf16 v[144:159], a[140:143], v[72:75], v[144:159]
    ds_read_b64_tr_b16 a[180:181], v17 offset:12288
    ds_read_b64_tr_b16 a[182:183], v17 offset:14336
    v_add_f32 v241, v241, v117
    v_cvt_pk_bf16_f32 v210, v116, v117
    v_exp_f32 v120, v120
    v_mfma_f32_32x32x16_bf16 v[160:175], a[140:143], v[76:79], v[160:175]
    ds_read_b64_tr_b16 a[184:185], v18 offset:12288
    v_exp_f32 v121, v121
    v_add_f32 v240, v240, v118
    v_mfma_f32_32x32x16_bf16 v[144:159], a[144:147], v[80:83], v[144:159]
    ds_read_b64_tr_b16 a[186:187], v18 offset:14336
    ds_read_b64_tr_b16 a[188:189], v19 offset:12288
    v_add_f32 v241, v241, v119
    v_cvt_pk_bf16_f32 v211, v118, v119
    v_exp_f32 v122, v122
    v_mfma_f32_32x32x16_bf16 v[160:175], a[144:147], v[84:87], v[160:175]
    ds_read_b64_tr_b16 a[190:191], v19 offset:14336
    v_exp_f32 v123, v123
    v_add_f32 v240, v240, v120
    v_mfma_f32_32x32x16_bf16 v[144:159], a[148:151], v[88:91], v[144:159]
    v_add_f32 v241, v241, v121
    v_cvt_pk_bf16_f32 v212, v120, v121
    v_exp_f32 v124, v124
    v_mfma_f32_32x32x16_bf16 v[160:175], a[148:151], v[92:95], v[160:175]
    v_exp_f32 v125, v125
    v_add_f32 v240, v240, v122
    v_mfma_f32_32x32x16_bf16 v[144:159], a[152:155], v[96:99], v[144:159]
    v_add_f32 v241, v241, v123
    v_cvt_pk_bf16_f32 v213, v122, v123
    v_exp_f32 v126, v126
    v_mfma_f32_32x32x16_bf16 v[160:175], a[152:155], v[100:103], v[160:175]
    v_exp_f32 v127, v127
    v_add_f32 v240, v240, v124
    v_mfma_f32_32x32x16_bf16 v[144:159], a[156:159], v[104:107], v[144:159]
    v_add_f32 v241, v241, v125
    v_cvt_pk_bf16_f32 v214, v124, v125
    v_exp_f32 v128, v128
    v_mfma_f32_32x32x16_bf16 v[160:175], a[156:159], v[108:111], v[160:175]
    v_exp_f32 v129, v129
    v_add_f32 v240, v240, v126
    s_waitcnt lgkmcnt(0)
    v_mfma_f32_32x32x16_bf16 a[0:15], a[160:163], v[224:227], a[0:15]
    ds_read_b128 a[128:131], v8 offset:32768
    s_add_u32 m0, s68, 114688
    s_add_u32 s86, s68, 114688
    buffer_load_dwordx4 v24, s[20:23], s86 offen offset:0 lds
    v_add_f32 v241, v241, v127
    v_cvt_pk_bf16_f32 v215, v126, v127
    v_mfma_f32_32x32x16_bf16 a[16:31], a[160:163], v[232:235], a[16:31]
    ds_read_b128 a[132:135], v9 offset:32768
    v_exp_f32 v130, v130
    v_exp_f32 v131, v131
    v_add_f32 v242, v242, v128
    v_mfma_f32_32x32x16_bf16 a[32:47], a[164:167], v[224:227], a[32:47]
    ds_read_b128 a[136:139], v10 offset:32768
    v_add_f32 v243, v243, v129
    v_cvt_pk_bf16_f32 v216, v128, v129
    v_exp_f32 v132, v132
    v_mfma_f32_32x32x16_bf16 a[48:63], a[164:167], v[232:235], a[48:63]
    ds_read_b128 a[140:143], v11 offset:32768
    v_exp_f32 v133, v133
    v_add_f32 v242, v242, v130
    v_add_f32 v243, v243, v131
    v_mfma_f32_32x32x16_bf16 a[64:79], a[168:171], v[224:227], a[64:79]
    buffer_load_dwordx4 v24, s[20:23], s86 offen offset:1024 lds
    v_cvt_pk_bf16_f32 v217, v130, v131
    v_exp_f32 v134, v134
    v_exp_f32 v135, v135
    v_mfma_f32_32x32x16_bf16 a[80:95], a[168:171], v[232:235], a[80:95]
    ds_read_b128 a[144:147], v12 offset:32768
    v_add_f32 v242, v242, v132
    v_add_f32 v243, v243, v133
    v_cvt_pk_bf16_f32 v218, v132, v133
    v_mfma_f32_32x32x16_bf16 a[96:111], a[172:175], v[224:227], a[96:111]
    ds_read_b128 a[148:151], v13 offset:32768
    v_exp_f32 v136, v136
    v_exp_f32 v137, v137
    v_add_f32 v242, v242, v134
    v_mfma_f32_32x32x16_bf16 a[112:127], a[172:175], v[232:235], a[112:127]
    ds_read_b128 a[152:155], v14 offset:32768
    v_add_f32 v243, v243, v135
    v_cvt_pk_bf16_f32 v219, v134, v135
    v_mfma_f32_32x32x16_bf16 a[0:15], a[176:179], v[228:231], a[0:15]
    ds_read_b128 a[156:159], v15 offset:32768
    buffer_load_dwordx4 v24, s[20:23], s86 offen offset:2048 lds
    v_exp_f32 v138, v138
    v_exp_f32 v139, v139
    v_add_f32 v242, v242, v136
    v_mfma_f32_32x32x16_bf16 a[16:31], a[176:179], v[236:239], a[16:31]
    v_add_f32 v243, v243, v137
    v_cvt_pk_bf16_f32 v220, v136, v137
    v_exp_f32 v140, v140
    v_mfma_f32_32x32x16_bf16 a[32:47], a[180:183], v[228:231], a[32:47]
    v_exp_f32 v141, v141
    v_add_f32 v242, v242, v138
    v_add_f32 v243, v243, v139
    v_mfma_f32_32x32x16_bf16 a[48:63], a[180:183], v[236:239], a[48:63]
    v_cvt_pk_bf16_f32 v221, v138, v139
    v_exp_f32 v142, v142
    v_mfma_f32_32x32x16_bf16 a[64:79], a[184:187], v[228:231], a[64:79]
    buffer_load_dwordx4 v24, s[20:23], s86 offen offset:3072 lds
    v_exp_f32 v143, v143
    v_add_f32 v242, v242, v140
    v_add_f32 v243, v243, v141
    v_mfma_f32_32x32x16_bf16 a[80:95], a[184:187], v[236:239], a[80:95]
    v_cvt_pk_bf16_f32 v222, v140, v141
    s_nop 0
    v_add_f32 v242, v242, v142
    v_mfma_f32_32x32x16_bf16 a[96:111], a[188:191], v[228:231], a[96:111]
    v_add_f32 v243, v243, v143
    v_cvt_pk_bf16_f32 v223, v142, v143
    v_mfma_f32_32x32x16_bf16 a[112:127], a[188:191], v[236:239], a[112:127]
    s_waitcnt lgkmcnt(0)
    v_mfma_f32_32x32x16_bf16 v[112:127], a[128:131], v[48:51], v[176:191]
    ds_read_b64_tr_b16 a[160:161], v16 offset:16384
    ds_read_b64_tr_b16 a[162:163], v16 offset:18432
    v_exp_f32 v144, v144
    v_exp_f32 v145, v145
    v_mfma_f32_32x32x16_bf16 v[128:143], a[128:131], v[52:55], v[192:207]
    ds_read_b64_tr_b16 a[164:165], v17 offset:16384
    ds_read_b64_tr_b16 a[166:167], v17 offset:18432
    v_exp_f32 v146, v146
    v_exp_f32 v147, v147
    v_mfma_f32_32x32x16_bf16 v[112:127], a[132:135], v[56:59], v[112:127]
    ds_read_b64_tr_b16 a[168:169], v18 offset:16384
    v_add_f32 v240, v240, v144
    v_add_f32 v241, v241, v145
    v_cvt_pk_bf16_f32 v224, v144, v145
    v_exp_f32 v148, v148
    v_mfma_f32_32x32x16_bf16 v[128:143], a[132:135], v[60:63], v[128:143]
    ds_read_b64_tr_b16 a[170:171], v18 offset:18432
    ds_read_b64_tr_b16 a[172:173], v19 offset:16384
    v_exp_f32 v149, v149
    v_add_f32 v240, v240, v146
    v_mfma_f32_32x32x16_bf16 v[112:127], a[136:139], v[64:67], v[112:127]
    ds_read_b64_tr_b16 a[174:175], v19 offset:18432
    v_add_f32 v241, v241, v147
    v_cvt_pk_bf16_f32 v225, v146, v147
    v_exp_f32 v150, v150
    v_mfma_f32_32x32x16_bf16 v[128:143], a[136:139], v[68:71], v[128:143]
    ds_read_b64_tr_b16 a[176:177], v16 offset:20480
    ds_read_b64_tr_b16 a[178:179], v16 offset:22528
    v_exp_f32 v151, v151
    v_add_f32 v240, v240, v148
    v_mfma_f32_32x32x16_bf16 v[112:127], a[140:143], v[72:75], v[112:127]
    ds_read_b64_tr_b16 a[180:181], v17 offset:20480
    ds_read_b64_tr_b16 a[182:183], v17 offset:22528
    v_add_f32 v241, v241, v149
    v_cvt_pk_bf16_f32 v226, v148, v149
    v_exp_f32 v152, v152
    v_mfma_f32_32x32x16_bf16 v[128:143], a[140:143], v[76:79], v[128:143]
    ds_read_b64_tr_b16 a[184:185], v18 offset:20480
    v_exp_f32 v153, v153
    v_add_f32 v240, v240, v150
    v_mfma_f32_32x32x16_bf16 v[112:127], a[144:147], v[80:83], v[112:127]
    ds_read_b64_tr_b16 a[186:187], v18 offset:22528
    ds_read_b64_tr_b16 a[188:189], v19 offset:20480
    v_add_f32 v241, v241, v151
    v_cvt_pk_bf16_f32 v227, v150, v151
    v_exp_f32 v154, v154
    v_mfma_f32_32x32x16_bf16 v[128:143], a[144:147], v[84:87], v[128:143]
    ds_read_b64_tr_b16 a[190:191], v19 offset:22528
    v_exp_f32 v155, v155
    v_add_f32 v240, v240, v152
    v_mfma_f32_32x32x16_bf16 v[112:127], a[148:151], v[88:91], v[112:127]
    v_add_f32 v241, v241, v153
    v_cvt_pk_bf16_f32 v228, v152, v153
    v_exp_f32 v156, v156
    v_mfma_f32_32x32x16_bf16 v[128:143], a[148:151], v[92:95], v[128:143]
    v_exp_f32 v157, v157
    v_add_f32 v240, v240, v154
    v_mfma_f32_32x32x16_bf16 v[112:127], a[152:155], v[96:99], v[112:127]
    v_add_f32 v241, v241, v155
    v_cvt_pk_bf16_f32 v229, v154, v155
    v_exp_f32 v158, v158
    v_mfma_f32_32x32x16_bf16 v[128:143], a[152:155], v[100:103], v[128:143]
    v_exp_f32 v159, v159
    v_add_f32 v240, v240, v156
    v_mfma_f32_32x32x16_bf16 v[112:127], a[156:159], v[104:107], v[112:127]
    v_add_f32 v241, v241, v157
    v_cvt_pk_bf16_f32 v230, v156, v157
    v_exp_f32 v160, v160
    v_mfma_f32_32x32x16_bf16 v[128:143], a[156:159], v[108:111], v[128:143]
    v_exp_f32 v161, v161
    v_add_f32 v240, v240, v158
    s_waitcnt lgkmcnt(0)
    v_mfma_f32_32x32x16_bf16 a[0:15], a[160:163], v[208:211], a[0:15]
    ds_read_b128 a[128:131], v8 offset:40960
    s_add_u32 m0, s69, 131072
    s_add_u32 s66, s66, 802816
    buffer_load_dwordx4 v2, s[8:11], s66 offen offset:0 lds
    v_add_f32 v241, v241, v159
    v_cvt_pk_bf16_f32 v231, v158, v159
    v_mfma_f32_32x32x16_bf16 a[16:31], a[160:163], v[216:219], a[16:31]
    ds_read_b128 a[132:135], v9 offset:40960
    v_exp_f32 v162, v162
    v_exp_f32 v163, v163
    v_add_f32 v242, v242, v160
    v_mfma_f32_32x32x16_bf16 a[32:47], a[164:167], v[208:211], a[32:47]
    ds_read_b128 a[136:139], v10 offset:40960
    buffer_load_dwordx4 v3, s[8:11], s66 offen offset:1024 lds
    v_add_f32 v243, v243, v161
    v_cvt_pk_bf16_f32 v232, v160, v161
    v_exp_f32 v164, v164
    v_mfma_f32_32x32x16_bf16 a[48:63], a[164:167], v[216:219], a[48:63]
    ds_read_b128 a[140:143], v11 offset:40960
    v_exp_f32 v165, v165
    v_add_f32 v242, v242, v162
    v_add_f32 v243, v243, v163
    v_mfma_f32_32x32x16_bf16 a[64:79], a[168:171], v[208:211], a[64:79]
    buffer_load_dwordx4 v4, s[8:11], s66 offen offset:2048 lds
    v_cvt_pk_bf16_f32 v233, v162, v163
    v_exp_f32 v166, v166
    v_exp_f32 v167, v167
    v_mfma_f32_32x32x16_bf16 a[80:95], a[168:171], v[216:219], a[80:95]
    ds_read_b128 a[144:147], v12 offset:40960
    v_add_f32 v242, v242, v164
    v_add_f32 v243, v243, v165
    v_cvt_pk_bf16_f32 v234, v164, v165
    v_mfma_f32_32x32x16_bf16 a[96:111], a[172:175], v[208:211], a[96:111]
    ds_read_b128 a[148:151], v13 offset:40960
    buffer_load_dwordx4 v5, s[8:11], s66 offen offset:3072 lds
    v_exp_f32 v168, v168
    v_exp_f32 v169, v169
    v_add_f32 v242, v242, v166
    v_mfma_f32_32x32x16_bf16 a[112:127], a[172:175], v[216:219], a[112:127]
    ds_read_b128 a[152:155], v14 offset:40960
    v_add_f32 v243, v243, v167
    v_cvt_pk_bf16_f32 v235, v166, v167
    v_mfma_f32_32x32x16_bf16 a[0:15], a[176:179], v[212:215], a[0:15]
    ds_read_b128 a[156:159], v15 offset:40960
    buffer_load_dwordx4 a[192:195], v6, s[12:15], s67 offen offset:0 sc1
    v_exp_f32 v170, v170
    v_exp_f32 v171, v171
    v_add_f32 v242, v242, v168
    v_mfma_f32_32x32x16_bf16 a[16:31], a[176:179], v[220:223], a[16:31]
    v_add_f32 v243, v243, v169
    v_cvt_pk_bf16_f32 v236, v168, v169
    v_exp_f32 v172, v172
    v_mfma_f32_32x32x16_bf16 a[32:47], a[180:183], v[212:215], a[32:47]
    buffer_load_dwordx4 a[196:199], v6, s[12:15], s67 offen offset:1024 sc1
    v_exp_f32 v173, v173
    v_add_f32 v242, v242, v170
    v_add_f32 v243, v243, v171
    v_mfma_f32_32x32x16_bf16 a[48:63], a[180:183], v[220:223], a[48:63]
    v_cvt_pk_bf16_f32 v237, v170, v171
    v_exp_f32 v174, v174
    v_mfma_f32_32x32x16_bf16 a[64:79], a[184:187], v[212:215], a[64:79]
    buffer_load_dwordx4 a[200:203], v6, s[12:15], s67 offen offset:2048 sc1
    v_exp_f32 v175, v175
    v_add_f32 v242, v242, v172
    v_add_f32 v243, v243, v173
    v_mfma_f32_32x32x16_bf16 a[80:95], a[184:187], v[220:223], a[80:95]
    v_cvt_pk_bf16_f32 v238, v172, v173
    s_nop 0
    v_add_f32 v242, v242, v174
    v_mfma_f32_32x32x16_bf16 a[96:111], a[188:191], v[212:215], a[96:111]
    buffer_load_dwordx4 a[204:207], v6, s[12:15], s67 offen offset:3072 sc1
    v_add_f32 v243, v243, v175
    v_cvt_pk_bf16_f32 v239, v174, v175
    v_mfma_f32_32x32x16_bf16 a[112:127], a[188:191], v[220:223], a[112:127]
    s_add_u32 s67, s67, 65536
    s_waitcnt lgkmcnt(0)
    s_waitcnt vmcnt(13)
    s_barrier
    v_mfma_f32_32x32x16_bf16 v[144:159], a[128:131], v[48:51], v[176:191]
    ds_read_b64_tr_b16 a[160:161], v16 offset:24576
    ds_read_b64_tr_b16 a[162:163], v16 offset:26624
    v_exp_f32 v112, v112
    v_exp_f32 v113, v113
    v_mfma_f32_32x32x16_bf16 v[160:175], a[128:131], v[52:55], v[192:207]
    ds_read_b64_tr_b16 a[164:165], v17 offset:24576
    ds_read_b64_tr_b16 a[166:167], v17 offset:26624
    v_exp_f32 v114, v114
    v_exp_f32 v115, v115
    v_mfma_f32_32x32x16_bf16 v[144:159], a[132:135], v[56:59], v[144:159]
    ds_read_b64_tr_b16 a[168:169], v18 offset:24576
    v_add_f32 v240, v240, v112
    v_add_f32 v241, v241, v113
    v_cvt_pk_bf16_f32 v208, v112, v113
    v_exp_f32 v116, v116
    v_mfma_f32_32x32x16_bf16 v[160:175], a[132:135], v[60:63], v[160:175]
    ds_read_b64_tr_b16 a[170:171], v18 offset:26624
    ds_read_b64_tr_b16 a[172:173], v19 offset:24576
    v_exp_f32 v117, v117
    v_add_f32 v240, v240, v114
    v_mfma_f32_32x32x16_bf16 v[144:159], a[136:139], v[64:67], v[144:159]
    ds_read_b64_tr_b16 a[174:175], v19 offset:26624
    v_add_f32 v241, v241, v115
    v_cvt_pk_bf16_f32 v209, v114, v115
    v_exp_f32 v118, v118
    v_mfma_f32_32x32x16_bf16 v[160:175], a[136:139], v[68:71], v[160:175]
    ds_read_b64_tr_b16 a[176:177], v16 offset:28672
    ds_read_b64_tr_b16 a[178:179], v16 offset:30720
    v_exp_f32 v119, v119
    v_add_f32 v240, v240, v116
    v_mfma_f32_32x32x16_bf16 v[144:159], a[140:143], v[72:75], v[144:159]
    ds_read_b64_tr_b16 a[180:181], v17 offset:28672
    ds_read_b64_tr_b16 a[182:183], v17 offset:30720
    v_add_f32 v241, v241, v117
    v_cvt_pk_bf16_f32 v210, v116, v117
    v_exp_f32 v120, v120
    v_mfma_f32_32x32x16_bf16 v[160:175], a[140:143], v[76:79], v[160:175]
    ds_read_b64_tr_b16 a[184:185], v18 offset:28672
    v_exp_f32 v121, v121
    v_add_f32 v240, v240, v118
    v_mfma_f32_32x32x16_bf16 v[144:159], a[144:147], v[80:83], v[144:159]
    ds_read_b64_tr_b16 a[186:187], v18 offset:30720
    ds_read_b64_tr_b16 a[188:189], v19 offset:28672
    v_add_f32 v241, v241, v119
    v_cvt_pk_bf16_f32 v211, v118, v119
    v_exp_f32 v122, v122
    v_mfma_f32_32x32x16_bf16 v[160:175], a[144:147], v[84:87], v[160:175]
    ds_read_b64_tr_b16 a[190:191], v19 offset:30720
    v_exp_f32 v123, v123
    v_add_f32 v240, v240, v120
    v_mfma_f32_32x32x16_bf16 v[144:159], a[148:151], v[88:91], v[144:159]
    v_add_f32 v241, v241, v121
    v_cvt_pk_bf16_f32 v212, v120, v121
    v_exp_f32 v124, v124
    v_mfma_f32_32x32x16_bf16 v[160:175], a[148:151], v[92:95], v[160:175]
    v_exp_f32 v125, v125
    v_add_f32 v240, v240, v122
    v_mfma_f32_32x32x16_bf16 v[144:159], a[152:155], v[96:99], v[144:159]
    v_add_f32 v241, v241, v123
    v_cvt_pk_bf16_f32 v213, v122, v123
    v_exp_f32 v126, v126
    v_mfma_f32_32x32x16_bf16 v[160:175], a[152:155], v[100:103], v[160:175]
    v_exp_f32 v127, v127
    v_add_f32 v240, v240, v124
    v_mfma_f32_32x32x16_bf16 v[144:159], a[156:159], v[104:107], v[144:159]
    v_add_f32 v241, v241, v125
    v_cvt_pk_bf16_f32 v214, v124, v125
    v_exp_f32 v128, v128
    v_mfma_f32_32x32x16_bf16 v[160:175], a[156:159], v[108:111], v[160:175]
    v_exp_f32 v129, v129
    v_add_f32 v240, v240, v126
    s_waitcnt lgkmcnt(0)
    v_mfma_f32_32x32x16_bf16 a[0:15], a[160:163], v[224:227], a[0:15]
    ds_read_b128 a[128:131], v8 offset:49152
    s_add_u32 m0, s69, 135168
    s_add_u32 s66, s66, 114688
    buffer_load_dwordx4 v2, s[8:11], s66 offen offset:0 lds
    v_add_f32 v241, v241, v127
    v_cvt_pk_bf16_f32 v215, v126, v127
    v_mfma_f32_32x32x16_bf16 a[16:31], a[160:163], v[232:235], a[16:31]
    ds_read_b128 a[132:135], v9 offset:49152
    v_exp_f32 v130, v130
    v_exp_f32 v131, v131
    v_add_f32 v242, v242, v128
    v_mfma_f32_32x32x16_bf16 a[32:47], a[164:167], v[224:227], a[32:47]
    ds_read_b128 a[136:139], v10 offset:49152
    buffer_load_dwordx4 v3, s[8:11], s66 offen offset:1024 lds
    v_add_f32 v243, v243, v129
    v_cvt_pk_bf16_f32 v216, v128, v129
    v_exp_f32 v132, v132
    v_mfma_f32_32x32x16_bf16 a[48:63], a[164:167], v[232:235], a[48:63]
    ds_read_b128 a[140:143], v11 offset:49152
    v_exp_f32 v133, v133
    v_add_f32 v242, v242, v130
    v_add_f32 v243, v243, v131
    v_mfma_f32_32x32x16_bf16 a[64:79], a[168:171], v[224:227], a[64:79]
    buffer_load_dwordx4 v4, s[8:11], s66 offen offset:2048 lds
    v_cvt_pk_bf16_f32 v217, v130, v131
    v_exp_f32 v134, v134
    v_exp_f32 v135, v135
    v_mfma_f32_32x32x16_bf16 a[80:95], a[168:171], v[232:235], a[80:95]
    ds_read_b128 a[144:147], v12 offset:49152
    v_add_f32 v242, v242, v132
    v_add_f32 v243, v243, v133
    v_cvt_pk_bf16_f32 v218, v132, v133
    v_mfma_f32_32x32x16_bf16 a[96:111], a[172:175], v[224:227], a[96:111]
    ds_read_b128 a[148:151], v13 offset:49152
    buffer_load_dwordx4 v5, s[8:11], s66 offen offset:3072 lds
    v_exp_f32 v136, v136
    v_exp_f32 v137, v137
    v_add_f32 v242, v242, v134
    v_mfma_f32_32x32x16_bf16 a[112:127], a[172:175], v[232:235], a[112:127]
    ds_read_b128 a[152:155], v14 offset:49152
    v_add_f32 v243, v243, v135
    v_cvt_pk_bf16_f32 v219, v134, v135
    v_mfma_f32_32x32x16_bf16 a[0:15], a[176:179], v[228:231], a[0:15]
    ds_read_b128 a[156:159], v15 offset:49152
    buffer_load_dwordx4 a[208:211], v6, s[12:15], s67 offen offset:0 sc1
    v_exp_f32 v138, v138
    v_exp_f32 v139, v139
    v_add_f32 v242, v242, v136
    v_mfma_f32_32x32x16_bf16 a[16:31], a[176:179], v[236:239], a[16:31]
    v_add_f32 v243, v243, v137
    v_cvt_pk_bf16_f32 v220, v136, v137
    v_exp_f32 v140, v140
    v_mfma_f32_32x32x16_bf16 a[32:47], a[180:183], v[228:231], a[32:47]
    buffer_load_dwordx4 a[212:215], v6, s[12:15], s67 offen offset:1024 sc1
    v_exp_f32 v141, v141
    v_add_f32 v242, v242, v138
    v_add_f32 v243, v243, v139
    v_mfma_f32_32x32x16_bf16 a[48:63], a[180:183], v[236:239], a[48:63]
    v_cvt_pk_bf16_f32 v221, v138, v139
    v_exp_f32 v142, v142
    v_mfma_f32_32x32x16_bf16 a[64:79], a[184:187], v[228:231], a[64:79]
    buffer_load_dwordx4 a[216:219], v6, s[12:15], s67 offen offset:2048 sc1
    v_exp_f32 v143, v143
    v_add_f32 v242, v242, v140
    v_add_f32 v243, v243, v141
    v_mfma_f32_32x32x16_bf16 a[80:95], a[184:187], v[236:239], a[80:95]
    v_cvt_pk_bf16_f32 v222, v140, v141
    s_nop 0
    v_add_f32 v242, v242, v142
    v_mfma_f32_32x32x16_bf16 a[96:111], a[188:191], v[228:231], a[96:111]
    buffer_load_dwordx4 a[220:223], v6, s[12:15], s67 offen offset:3072 sc1
    v_add_f32 v243, v243, v143
    v_cvt_pk_bf16_f32 v223, v142, v143
    v_mfma_f32_32x32x16_bf16 a[112:127], a[188:191], v[236:239], a[112:127]
    s_add_u32 s67, s67, 196608
    s_waitcnt lgkmcnt(0)
    v_mfma_f32_32x32x16_bf16 v[112:127], a[128:131], v[48:51], v[176:191]
    ds_read_b64_tr_b16 a[160:161], v16 offset:32768
    ds_read_b64_tr_b16 a[162:163], v16 offset:34816
    v_exp_f32 v144, v144
    v_exp_f32 v145, v145
    v_mfma_f32_32x32x16_bf16 v[128:143], a[128:131], v[52:55], v[192:207]
    ds_read_b64_tr_b16 a[164:165], v17 offset:32768
    ds_read_b64_tr_b16 a[166:167], v17 offset:34816
    v_exp_f32 v146, v146
    v_exp_f32 v147, v147
    v_mfma_f32_32x32x16_bf16 v[112:127], a[132:135], v[56:59], v[112:127]
    ds_read_b64_tr_b16 a[168:169], v18 offset:32768
    v_add_f32 v240, v240, v144
    v_add_f32 v241, v241, v145
    v_cvt_pk_bf16_f32 v224, v144, v145
    v_exp_f32 v148, v148
    v_mfma_f32_32x32x16_bf16 v[128:143], a[132:135], v[60:63], v[128:143]
    ds_read_b64_tr_b16 a[170:171], v18 offset:34816
    ds_read_b64_tr_b16 a[172:173], v19 offset:32768
    v_exp_f32 v149, v149
    v_add_f32 v240, v240, v146
    v_mfma_f32_32x32x16_bf16 v[112:127], a[136:139], v[64:67], v[112:127]
    ds_read_b64_tr_b16 a[174:175], v19 offset:34816
    v_add_f32 v241, v241, v147
    v_cvt_pk_bf16_f32 v225, v146, v147
    v_exp_f32 v150, v150
    v_mfma_f32_32x32x16_bf16 v[128:143], a[136:139], v[68:71], v[128:143]
    ds_read_b64_tr_b16 a[176:177], v16 offset:36864
    ds_read_b64_tr_b16 a[178:179], v16 offset:38912
    v_exp_f32 v151, v151
    v_add_f32 v240, v240, v148
    v_mfma_f32_32x32x16_bf16 v[112:127], a[140:143], v[72:75], v[112:127]
    ds_read_b64_tr_b16 a[180:181], v17 offset:36864
    ds_read_b64_tr_b16 a[182:183], v17 offset:38912
    v_add_f32 v241, v241, v149
    v_cvt_pk_bf16_f32 v226, v148, v149
    v_exp_f32 v152, v152
    v_mfma_f32_32x32x16_bf16 v[128:143], a[140:143], v[76:79], v[128:143]
    ds_read_b64_tr_b16 a[184:185], v18 offset:36864
    v_exp_f32 v153, v153
    v_add_f32 v240, v240, v150
    v_mfma_f32_32x32x16_bf16 v[112:127], a[144:147], v[80:83], v[112:127]
    ds_read_b64_tr_b16 a[186:187], v18 offset:38912
    ds_read_b64_tr_b16 a[188:189], v19 offset:36864
    v_add_f32 v241, v241, v151
    v_cvt_pk_bf16_f32 v227, v150, v151
    v_exp_f32 v154, v154
    v_mfma_f32_32x32x16_bf16 v[128:143], a[144:147], v[84:87], v[128:143]
    ds_read_b64_tr_b16 a[190:191], v19 offset:38912
    v_exp_f32 v155, v155
    v_add_f32 v240, v240, v152
    v_mfma_f32_32x32x16_bf16 v[112:127], a[148:151], v[88:91], v[112:127]
    v_add_f32 v241, v241, v153
    v_cvt_pk_bf16_f32 v228, v152, v153
    v_exp_f32 v156, v156
    v_mfma_f32_32x32x16_bf16 v[128:143], a[148:151], v[92:95], v[128:143]
    v_exp_f32 v157, v157
    v_add_f32 v240, v240, v154
    v_mfma_f32_32x32x16_bf16 v[112:127], a[152:155], v[96:99], v[112:127]
    v_add_f32 v241, v241, v155
    v_cvt_pk_bf16_f32 v229, v154, v155
    v_exp_f32 v158, v158
    v_mfma_f32_32x32x16_bf16 v[128:143], a[152:155], v[100:103], v[128:143]
    v_exp_f32 v159, v159
    v_add_f32 v240, v240, v156
    v_mfma_f32_32x32x16_bf16 v[112:127], a[156:159], v[104:107], v[112:127]
    v_add_f32 v241, v241, v157
    v_cvt_pk_bf16_f32 v230, v156, v157
    v_exp_f32 v160, v160
    v_mfma_f32_32x32x16_bf16 v[128:143], a[156:159], v[108:111], v[128:143]
    v_exp_f32 v161, v161
    v_add_f32 v240, v240, v158
    s_waitcnt lgkmcnt(0)
    v_mfma_f32_32x32x16_bf16 a[0:15], a[160:163], v[208:211], a[0:15]
    ds_read_b128 a[128:131], v8 offset:57344
    s_add_u32 m0, s69, 0
    s_add_u32 s66, s66, 802816
    buffer_load_dwordx4 v2, s[8:11], s66 offen offset:0 lds
    v_add_f32 v241, v241, v159
    v_cvt_pk_bf16_f32 v231, v158, v159
    v_mfma_f32_32x32x16_bf16 a[16:31], a[160:163], v[216:219], a[16:31]
    ds_read_b128 a[132:135], v9 offset:57344
    v_exp_f32 v162, v162
    v_exp_f32 v163, v163
    v_add_f32 v242, v242, v160
    v_mfma_f32_32x32x16_bf16 a[32:47], a[164:167], v[208:211], a[32:47]
    ds_read_b128 a[136:139], v10 offset:57344
    buffer_load_dwordx4 v3, s[8:11], s66 offen offset:1024 lds
    v_add_f32 v243, v243, v161
    v_cvt_pk_bf16_f32 v232, v160, v161
    v_exp_f32 v164, v164
    v_mfma_f32_32x32x16_bf16 a[48:63], a[164:167], v[216:219], a[48:63]
    ds_read_b128 a[140:143], v11 offset:57344
    v_exp_f32 v165, v165
    v_add_f32 v242, v242, v162
    v_add_f32 v243, v243, v163
    v_mfma_f32_32x32x16_bf16 a[64:79], a[168:171], v[208:211], a[64:79]
    buffer_load_dwordx4 v4, s[8:11], s66 offen offset:2048 lds
    v_cvt_pk_bf16_f32 v233, v162, v163
    v_exp_f32 v166, v166
    v_exp_f32 v167, v167
    v_mfma_f32_32x32x16_bf16 a[80:95], a[168:171], v[216:219], a[80:95]
    ds_read_b128 a[144:147], v12 offset:57344
    v_add_f32 v242, v242, v164
    v_add_f32 v243, v243, v165
    v_cvt_pk_bf16_f32 v234, v164, v165
    v_mfma_f32_32x32x16_bf16 a[96:111], a[172:175], v[208:211], a[96:111]
    ds_read_b128 a[148:151], v13 offset:57344
    buffer_load_dwordx4 v5, s[8:11], s66 offen offset:3072 lds
    v_exp_f32 v168, v168
    v_exp_f32 v169, v169
    v_add_f32 v242, v242, v166
    v_mfma_f32_32x32x16_bf16 a[112:127], a[172:175], v[216:219], a[112:127]
    ds_read_b128 a[152:155], v14 offset:57344
    v_add_f32 v243, v243, v167
    v_cvt_pk_bf16_f32 v235, v166, v167
    v_mfma_f32_32x32x16_bf16 a[0:15], a[176:179], v[212:215], a[0:15]
    ds_read_b128 a[156:159], v15 offset:57344
    buffer_load_dwordx4 a[224:227], v6, s[12:15], s67 offen offset:0 sc1
    v_exp_f32 v170, v170
    v_exp_f32 v171, v171
    v_add_f32 v242, v242, v168
    v_mfma_f32_32x32x16_bf16 a[16:31], a[176:179], v[220:223], a[16:31]
    v_add_f32 v243, v243, v169
    v_cvt_pk_bf16_f32 v236, v168, v169
    v_exp_f32 v172, v172
    v_mfma_f32_32x32x16_bf16 a[32:47], a[180:183], v[212:215], a[32:47]
    buffer_load_dwordx4 a[228:231], v6, s[12:15], s67 offen offset:1024 sc1
    v_exp_f32 v173, v173
    v_add_f32 v242, v242, v170
    v_add_f32 v243, v243, v171
    v_mfma_f32_32x32x16_bf16 a[48:63], a[180:183], v[220:223], a[48:63]
    v_cvt_pk_bf16_f32 v237, v170, v171
    v_exp_f32 v174, v174
    v_mfma_f32_32x32x16_bf16 a[64:79], a[184:187], v[212:215], a[64:79]
    buffer_load_dwordx4 a[232:235], v6, s[12:15], s67 offen offset:2048 sc1
    v_exp_f32 v175, v175
    v_add_f32 v242, v242, v172
    v_add_f32 v243, v243, v173
    v_mfma_f32_32x32x16_bf16 a[80:95], a[184:187], v[220:223], a[80:95]
    v_cvt_pk_bf16_f32 v238, v172, v173
    s_nop 0
    v_add_f32 v242, v242, v174
    v_mfma_f32_32x32x16_bf16 a[96:111], a[188:191], v[212:215], a[96:111]
    buffer_load_dwordx4 a[236:239], v6, s[12:15], s67 offen offset:3072 sc1
    v_add_f32 v243, v243, v175
    v_cvt_pk_bf16_f32 v239, v174, v175
    v_mfma_f32_32x32x16_bf16 a[112:127], a[188:191], v[220:223], a[112:127]
    s_add_u32 s67, s67, 65536
    s_waitcnt lgkmcnt(0)
    s_waitcnt vmcnt(24)
    s_barrier
    v_mfma_f32_32x32x16_bf16 v[144:159], a[128:131], v[48:51], v[176:191]
    ds_read_b64_tr_b16 a[160:161], v16 offset:40960
    ds_read_b64_tr_b16 a[162:163], v16 offset:43008
    v_exp_f32 v112, v112
    v_exp_f32 v113, v113
    v_mfma_f32_32x32x16_bf16 v[160:175], a[128:131], v[52:55], v[192:207]
    ds_read_b64_tr_b16 a[164:165], v17 offset:40960
    ds_read_b64_tr_b16 a[166:167], v17 offset:43008
    v_exp_f32 v114, v114
    v_exp_f32 v115, v115
    v_mfma_f32_32x32x16_bf16 v[144:159], a[132:135], v[56:59], v[144:159]
    ds_read_b64_tr_b16 a[168:169], v18 offset:40960
    v_add_f32 v240, v240, v112
    v_add_f32 v241, v241, v113
    v_cvt_pk_bf16_f32 v208, v112, v113
    v_exp_f32 v116, v116
    v_mfma_f32_32x32x16_bf16 v[160:175], a[132:135], v[60:63], v[160:175]
    ds_read_b64_tr_b16 a[170:171], v18 offset:43008
    ds_read_b64_tr_b16 a[172:173], v19 offset:40960
    v_exp_f32 v117, v117
    v_add_f32 v240, v240, v114
    v_mfma_f32_32x32x16_bf16 v[144:159], a[136:139], v[64:67], v[144:159]
    ds_read_b64_tr_b16 a[174:175], v19 offset:43008
    v_add_f32 v241, v241, v115
    v_cvt_pk_bf16_f32 v209, v114, v115
    v_exp_f32 v118, v118
    v_mfma_f32_32x32x16_bf16 v[160:175], a[136:139], v[68:71], v[160:175]
    ds_read_b64_tr_b16 a[176:177], v16 offset:45056
    ds_read_b64_tr_b16 a[178:179], v16 offset:47104
    v_exp_f32 v119, v119
    v_add_f32 v240, v240, v116
    v_mfma_f32_32x32x16_bf16 v[144:159], a[140:143], v[72:75], v[144:159]
    ds_read_b64_tr_b16 a[180:181], v17 offset:45056
    ds_read_b64_tr_b16 a[182:183], v17 offset:47104
    v_add_f32 v241, v241, v117
    v_cvt_pk_bf16_f32 v210, v116, v117
    v_exp_f32 v120, v120
    v_mfma_f32_32x32x16_bf16 v[160:175], a[140:143], v[76:79], v[160:175]
    ds_read_b64_tr_b16 a[184:185], v18 offset:45056
    v_exp_f32 v121, v121
    v_add_f32 v240, v240, v118
    v_mfma_f32_32x32x16_bf16 v[144:159], a[144:147], v[80:83], v[144:159]
    ds_read_b64_tr_b16 a[186:187], v18 offset:47104
    ds_read_b64_tr_b16 a[188:189], v19 offset:45056
    v_add_f32 v241, v241, v119
    v_cvt_pk_bf16_f32 v211, v118, v119
    v_exp_f32 v122, v122
    v_mfma_f32_32x32x16_bf16 v[160:175], a[144:147], v[84:87], v[160:175]
    ds_read_b64_tr_b16 a[190:191], v19 offset:47104
    v_exp_f32 v123, v123
    v_add_f32 v240, v240, v120
    v_mfma_f32_32x32x16_bf16 v[144:159], a[148:151], v[88:91], v[144:159]
    v_add_f32 v241, v241, v121
    v_cvt_pk_bf16_f32 v212, v120, v121
    v_exp_f32 v124, v124
    v_mfma_f32_32x32x16_bf16 v[160:175], a[148:151], v[92:95], v[160:175]
    v_exp_f32 v125, v125
    v_add_f32 v240, v240, v122
    v_mfma_f32_32x32x16_bf16 v[144:159], a[152:155], v[96:99], v[144:159]
    v_add_f32 v241, v241, v123
    v_cvt_pk_bf16_f32 v213, v122, v123
    v_exp_f32 v126, v126
    v_mfma_f32_32x32x16_bf16 v[160:175], a[152:155], v[100:103], v[160:175]
    v_exp_f32 v127, v127
    v_add_f32 v240, v240, v124
    v_mfma_f32_32x32x16_bf16 v[144:159], a[156:159], v[104:107], v[144:159]
    v_add_f32 v241, v241, v125
    v_cvt_pk_bf16_f32 v214, v124, v125
    v_exp_f32 v128, v128
    v_mfma_f32_32x32x16_bf16 v[160:175], a[156:159], v[108:111], v[160:175]
    v_exp_f32 v129, v129
    v_add_f32 v240, v240, v126
    s_waitcnt lgkmcnt(0)
    v_mfma_f32_32x32x16_bf16 a[0:15], a[160:163], v[224:227], a[0:15]
    s_add_u32 m0, s69, 4096
    s_add_u32 s66, s66, 114688
    buffer_load_dwordx4 v2, s[8:11], s66 offen offset:0 lds
    v_add_f32 v241, v241, v127
    v_cvt_pk_bf16_f32 v215, v126, v127
    v_mfma_f32_32x32x16_bf16 a[16:31], a[160:163], v[232:235], a[16:31]
    v_exp_f32 v130, v130
    v_exp_f32 v131, v131
    v_add_f32 v242, v242, v128
    v_add_f32 v243, v243, v129
    v_mfma_f32_32x32x16_bf16 a[32:47], a[164:167], v[224:227], a[32:47]
    buffer_load_dwordx4 v3, s[8:11], s66 offen offset:1024 lds
    v_cvt_pk_bf16_f32 v216, v128, v129
    v_exp_f32 v132, v132
    v_exp_f32 v133, v133
    v_mfma_f32_32x32x16_bf16 a[48:63], a[164:167], v[232:235], a[48:63]
    v_add_f32 v242, v242, v130
    v_add_f32 v243, v243, v131
    v_mfma_f32_32x32x16_bf16 a[64:79], a[168:171], v[224:227], a[64:79]
    buffer_load_dwordx4 v4, s[8:11], s66 offen offset:2048 lds
    v_cvt_pk_bf16_f32 v217, v130, v131
    v_exp_f32 v134, v134
    v_exp_f32 v135, v135
    v_mfma_f32_32x32x16_bf16 a[80:95], a[168:171], v[232:235], a[80:95]
    v_add_f32 v242, v242, v132
    v_add_f32 v243, v243, v133
    v_cvt_pk_bf16_f32 v218, v132, v133
    v_mfma_f32_32x32x16_bf16 a[96:111], a[172:175], v[224:227], a[96:111]
    buffer_load_dwordx4 v5, s[8:11], s66 offen offset:3072 lds
    v_exp_f32 v136, v136
    v_exp_f32 v137, v137
    v_add_f32 v242, v242, v134
    v_mfma_f32_32x32x16_bf16 a[112:127], a[172:175], v[232:235], a[112:127]
    v_add_f32 v243, v243, v135
    v_cvt_pk_bf16_f32 v219, v134, v135
    v_mfma_f32_32x32x16_bf16 a[0:15], a[176:179], v[228:231], a[0:15]
    buffer_load_dwordx4 a[240:243], v6, s[12:15], s67 offen offset:0 sc1
    v_exp_f32 v138, v138
    v_exp_f32 v139, v139
    v_add_f32 v242, v242, v136
    v_mfma_f32_32x32x16_bf16 a[16:31], a[176:179], v[236:239], a[16:31]
    v_add_f32 v243, v243, v137
    v_cvt_pk_bf16_f32 v220, v136, v137
    v_exp_f32 v140, v140
    v_mfma_f32_32x32x16_bf16 a[32:47], a[180:183], v[228:231], a[32:47]
    buffer_load_dwordx4 a[244:247], v6, s[12:15], s67 offen offset:1024 sc1
    v_exp_f32 v141, v141
    v_add_f32 v242, v242, v138
    v_add_f32 v243, v243, v139
    v_mfma_f32_32x32x16_bf16 a[48:63], a[180:183], v[236:239], a[48:63]
    v_cvt_pk_bf16_f32 v221, v138, v139
    v_exp_f32 v142, v142
    v_mfma_f32_32x32x16_bf16 a[64:79], a[184:187], v[228:231], a[64:79]
    buffer_load_dwordx4 a[248:251], v6, s[12:15], s67 offen offset:2048 sc1
    v_exp_f32 v143, v143
    v_add_f32 v242, v242, v140
    v_add_f32 v243, v243, v141
    v_mfma_f32_32x32x16_bf16 a[80:95], a[184:187], v[236:239], a[80:95]
    v_cvt_pk_bf16_f32 v222, v140, v141
    s_nop 0
    v_add_f32 v242, v242, v142
    v_mfma_f32_32x32x16_bf16 a[96:111], a[188:191], v[228:231], a[96:111]
    buffer_load_dwordx4 a[252:255], v6, s[12:15], s67 offen offset:3072 sc1
    v_add_f32 v243, v243, v143
    v_cvt_pk_bf16_f32 v223, v142, v143
    v_mfma_f32_32x32x16_bf16 a[112:127], a[188:191], v[236:239], a[112:127]
    s_add_u32 s67, s67, 196608
    ds_read_b64_tr_b16 a[160:161], v16 offset:49152
    ds_read_b64_tr_b16 a[162:163], v16 offset:51200
    ds_read_b64_tr_b16 a[164:165], v17 offset:49152
    ds_read_b64_tr_b16 a[166:167], v17 offset:51200
    ds_read_b64_tr_b16 a[168:169], v18 offset:49152
    ds_read_b64_tr_b16 a[170:171], v18 offset:51200
    ds_read_b64_tr_b16 a[172:173], v19 offset:49152
    ds_read_b64_tr_b16 a[174:175], v19 offset:51200
    ds_read_b64_tr_b16 a[176:177], v16 offset:53248
    ds_read_b64_tr_b16 a[178:179], v16 offset:55296
    ds_read_b64_tr_b16 a[180:181], v17 offset:53248
    ds_read_b64_tr_b16 a[182:183], v17 offset:55296
    ds_read_b64_tr_b16 a[184:185], v18 offset:53248
    ds_read_b64_tr_b16 a[186:187], v18 offset:55296
    ds_read_b64_tr_b16 a[188:189], v19 offset:53248
    ds_read_b64_tr_b16 a[190:191], v19 offset:55296
    v_exp_f32 v144, v144
    v_exp_f32 v145, v145
    v_exp_f32 v146, v146
    v_exp_f32 v147, v147
    v_add_f32 v240, v240, v144
    v_add_f32 v241, v241, v145
    v_cvt_pk_bf16_f32 v224, v144, v145
    v_exp_f32 v148, v148
    s_waitcnt lgkmcnt(0)
    v_mfma_f32_32x32x16_bf16 a[0:15], a[160:163], v[208:211], a[0:15]
    s_add_u32 m0, s69, 32768
    s_add_u32 s66, s66, 802816
    buffer_load_dwordx4 v2, s[8:11], s66 offen offset:0 lds
    v_exp_f32 v149, v149
    v_add_f32 v240, v240, v146
    v_mfma_f32_32x32x16_bf16 a[16:31], a[160:163], v[216:219], a[16:31]
    buffer_load_dwordx4 v3, s[8:11], s66 offen offset:1024 lds
    v_add_f32 v241, v241, v147
    v_cvt_pk_bf16_f32 v225, v146, v147
    v_exp_f32 v150, v150
    v_mfma_f32_32x32x16_bf16 a[32:47], a[164:167], v[208:211], a[32:47]
    buffer_load_dwordx4 v4, s[8:11], s66 offen offset:2048 lds
    v_exp_f32 v151, v151
    v_add_f32 v240, v240, v148
    v_add_f32 v241, v241, v149
    v_cvt_pk_bf16_f32 v226, v148, v149
    v_mfma_f32_32x32x16_bf16 a[48:63], a[164:167], v[216:219], a[48:63]
    buffer_load_dwordx4 v5, s[8:11], s66 offen offset:3072 lds
    v_exp_f32 v152, v152
    v_exp_f32 v153, v153
    v_add_f32 v240, v240, v150
    v_add_f32 v241, v241, v151
    v_mfma_f32_32x32x16_bf16 a[64:79], a[168:171], v[208:211], a[64:79]
    buffer_load_dwordx4 a[128:131], v6, s[12:15], s67 offen offset:0 sc1
    v_cvt_pk_bf16_f32 v227, v150, v151
    v_exp_f32 v154, v154
    v_exp_f32 v155, v155
    v_mfma_f32_32x32x16_bf16 a[80:95], a[168:171], v[216:219], a[80:95]
    buffer_load_dwordx4 a[132:135], v6, s[12:15], s67 offen offset:1024 sc1
    v_add_f32 v240, v240, v152
    v_add_f32 v241, v241, v153
    v_cvt_pk_bf16_f32 v228, v152, v153
    v_exp_f32 v156, v156
    v_mfma_f32_32x32x16_bf16 a[96:111], a[172:175], v[208:211], a[96:111]
    buffer_load_dwordx4 a[136:139], v6, s[12:15], s67 offen offset:2048 sc1
    v_exp_f32 v157, v157
    v_add_f32 v240, v240, v154
    v_add_f32 v241, v241, v155
    v_cvt_pk_bf16_f32 v229, v154, v155
    v_mfma_f32_32x32x16_bf16 a[112:127], a[172:175], v[216:219], a[112:127]
    buffer_load_dwordx4 a[140:143], v6, s[12:15], s67 offen offset:3072 sc1
    v_exp_f32 v158, v158
    v_exp_f32 v159, v159
    v_add_f32 v240, v240, v156
    v_mfma_f32_32x32x16_bf16 a[0:15], a[176:179], v[212:215], a[0:15]
    s_add_u32 s67, s67, 65536
    s_add_u32 m0, s69, 36864
    s_add_u32 s66, s66, 114688
    buffer_load_dwordx4 v2, s[8:11], s66 offen offset:0 lds
    v_add_f32 v241, v241, v157
    v_cvt_pk_bf16_f32 v230, v156, v157
    v_mfma_f32_32x32x16_bf16 a[16:31], a[176:179], v[220:223], a[16:31]
    buffer_load_dwordx4 v3, s[8:11], s66 offen offset:1024 lds
    v_exp_f32 v160, v160
    v_exp_f32 v161, v161
    v_add_f32 v240, v240, v158
    v_mfma_f32_32x32x16_bf16 a[32:47], a[180:183], v[212:215], a[32:47]
    buffer_load_dwordx4 v4, s[8:11], s66 offen offset:2048 lds
    v_add_f32 v241, v241, v159
    v_cvt_pk_bf16_f32 v231, v158, v159
    v_exp_f32 v162, v162
    v_mfma_f32_32x32x16_bf16 a[48:63], a[180:183], v[220:223], a[48:63]
    buffer_load_dwordx4 v5, s[8:11], s66 offen offset:3072 lds
    v_exp_f32 v163, v163
    v_add_f32 v242, v242, v160
    v_add_f32 v243, v243, v161
    v_cvt_pk_bf16_f32 v232, v160, v161
    v_mfma_f32_32x32x16_bf16 a[64:79], a[184:187], v[212:215], a[64:79]
    buffer_load_dwordx4 a[144:147], v6, s[12:15], s67 offen offset:0 sc1
    v_exp_f32 v164, v164
    v_exp_f32 v165, v165
    v_add_f32 v242, v242, v162
    v_add_f32 v243, v243, v163
    v_mfma_f32_32x32x16_bf16 a[80:95], a[184:187], v[220:223], a[80:95]
    buffer_load_dwordx4 a[148:151], v6, s[12:15], s67 offen offset:1024 sc1
    v_cvt_pk_bf16_f32 v233, v162, v163
    v_exp_f32 v166, v166
    v_exp_f32 v167, v167
    v_mfma_f32_32x32x16_bf16 a[96:111], a[188:191], v[212:215], a[96:111]
    buffer_load_dwordx4 a[152:155], v6, s[12:15], s67 offen offset:2048 sc1
    v_add_f32 v242, v242, v164
    v_add_f32 v243, v243, v165
    v_cvt_pk_bf16_f32 v234, v164, v165
    v_exp_f32 v168, v168
    v_mfma_f32_32x32x16_bf16 a[112:127], a[188:191], v[220:223], a[112:127]
    buffer_load_dwordx4 a[156:159], v6, s[12:15], s67 offen offset:3072 sc1
    v_exp_f32 v169, v169
    v_add_f32 v242, v242, v166
    v_add_f32 v243, v243, v167
    v_cvt_pk_bf16_f32 v235, v166, v167
    s_add_u32 s67, s67, 196608
    v_exp_f32 v170, v170
    v_exp_f32 v171, v171
    v_add_f32 v242, v242, v168
    v_add_f32 v243, v243, v169
    v_cvt_pk_bf16_f32 v236, v168, v169
    v_exp_f32 v172, v172
    v_exp_f32 v173, v173
    v_add_f32 v242, v242, v170
    v_add_f32 v243, v243, v171
    v_cvt_pk_bf16_f32 v237, v170, v171
    v_exp_f32 v174, v174
    v_exp_f32 v175, v175
    v_add_f32 v242, v242, v172
    v_add_f32 v243, v243, v173
    v_cvt_pk_bf16_f32 v238, v172, v173
    s_nop 0
    v_add_f32 v242, v242, v174
    v_add_f32 v243, v243, v175
    v_cvt_pk_bf16_f32 v239, v174, v175
    s_waitcnt vmcnt(32)
    s_barrier
    v_add_f32 v246, v240, v241
    v_add_f32 v247, v242, v243
    s_mov_b32 s84, 0x53800000
    v_add_f32 v246, v246, v247
    v_cmp_nge_f32 vcc, s84, v246
    s_cbranch_vccnz km_fallback
    ds_read_b64_tr_b16 a[160:161], v16 offset:57344
    ds_read_b64_tr_b16 a[162:163], v16 offset:59392
    ds_read_b64_tr_b16 a[164:165], v17 offset:57344
    ds_read_b64_tr_b16 a[166:167], v17 offset:59392
    ds_read_b64_tr_b16 a[168:169], v18 offset:57344
    ds_read_b64_tr_b16 a[170:171], v18 offset:59392
    ds_read_b64_tr_b16 a[172:173], v19 offset:57344
    ds_read_b64_tr_b16 a[174:175], v19 offset:59392
    ds_read_b64_tr_b16 a[176:177], v16 offset:61440
    ds_read_b64_tr_b16 a[178:179], v16 offset:63488
    ds_read_b64_tr_b16 a[180:181], v17 offset:61440
    ds_read_b64_tr_b16 a[182:183], v17 offset:63488
    ds_read_b64_tr_b16 a[184:185], v18 offset:61440
    ds_read_b64_tr_b16 a[186:187], v18 offset:63488
    ds_read_b64_tr_b16 a[188:189], v19 offset:61440
    ds_read_b64_tr_b16 a[190:191], v19 offset:63488
    s_waitcnt lgkmcnt(0)
    v_mfma_f32_32x32x16_bf16 a[0:15], a[160:163], v[224:227], a[0:15]
    ds_read_b64_tr_b16 v[48:49], v40 offset:32768
    ds_read_b64_tr_b16 v[50:51], v40 offset:36864
    v_mfma_f32_32x32x16_bf16 a[16:31], a[160:163], v[232:235], a[16:31]
    ds_read_b64_tr_b16 v[52:53], v41 offset:32768
    ds_read_b64_tr_b16 v[54:55], v41 offset:36864
    v_mfma_f32_32x32x16_bf16 a[32:47], a[164:167], v[224:227], a[32:47]
    ds_read_b64_tr_b16 v[56:57], v42 offset:32768
    v_mfma_f32_32x32x16_bf16 a[48:63], a[164:167], v[232:235], a[48:63]
    ds_read_b64_tr_b16 v[58:59], v42 offset:36864
    ds_read_b64_tr_b16 v[60:61], v43 offset:32768
    v_mfma_f32_32x32x16_bf16 a[64:79], a[168:171], v[224:227], a[64:79]
    ds_read_b64_tr_b16 v[62:63], v43 offset:36864
    v_mfma_f32_32x32x16_bf16 a[80:95], a[168:171], v[232:235], a[80:95]
    ds_read_b64_tr_b16 v[64:65], v44 offset:32768
    ds_read_b64_tr_b16 v[66:67], v44 offset:36864
    v_mfma_f32_32x32x16_bf16 a[96:111], a[172:175], v[224:227], a[96:111]
    ds_read_b64_tr_b16 v[68:69], v45 offset:32768
    ds_read_b64_tr_b16 v[70:71], v45 offset:36864
    v_mfma_f32_32x32x16_bf16 a[112:127], a[172:175], v[232:235], a[112:127]
    ds_read_b64_tr_b16 v[72:73], v46 offset:32768
    v_mfma_f32_32x32x16_bf16 a[0:15], a[176:179], v[228:231], a[0:15]
    ds_read_b64_tr_b16 v[74:75], v46 offset:36864
    ds_read_b64_tr_b16 v[76:77], v47 offset:32768
    v_mfma_f32_32x32x16_bf16 a[16:31], a[176:179], v[236:239], a[16:31]
    ds_read_b64_tr_b16 v[78:79], v47 offset:36864
    v_mfma_f32_32x32x16_bf16 a[32:47], a[180:183], v[228:231], a[32:47]
    v_mfma_f32_32x32x16_bf16 a[48:63], a[180:183], v[236:239], a[48:63]
    v_mfma_f32_32x32x16_bf16 a[64:79], a[184:187], v[228:231], a[64:79]
    v_mfma_f32_32x32x16_bf16 a[80:95], a[184:187], v[236:239], a[80:95]
    v_mfma_f32_32x32x16_bf16 a[96:111], a[188:191], v[228:231], a[96:111]
    v_mfma_f32_32x32x16_bf16 a[112:127], a[188:191], v[236:239], a[112:127]
    s_waitcnt lgkmcnt(0)
kms_aend:
    v_add_f32 v240, v240, v241
    v_add_f32 v242, v242, v243
    s_nop 0
    v_mov_b32 v241, v240
    v_mov_b32 v243, v242
    s_nop 1
    v_permlane32_swap_b32 v240, v241
    v_permlane32_swap_b32 v242, v243
    s_nop 0
    v_add_f32 v240, v240, v241
    v_add_f32 v242, v242, v243
    v_rcp_f32 v241, v240
    v_rcp_f32 v243, v242
    s_lshl_b32 s4, s75, 19
    v_bfe_u32 v22, v25, 7, 3
    v_xor_b32 v22, 3, v22
    v_min_u32 v22, 1, v22
    v_add_u32 v22, -1, v22
    v_and_b32 v22, 0x3fffe80, v22
    v_add_u32 v23, v25, v22
    s_barrier
    s_add_u32 m0, s69, 98304
    s_add_u32 s66, s66, 802816
    buffer_load_dwordx4 v2, s[8:11], s66 offen offset:0 lds
    buffer_load_dwordx4 v3, s[8:11], s66 offen offset:1024 lds
    buffer_load_dwordx4 v4, s[8:11], s66 offen offset:2048 lds
    buffer_load_dwordx4 v5, s[8:11], s66 offen offset:3072 lds
    buffer_load_dwordx4 a[160:163], v6, s[12:15], s67 offen offset:0 sc1
    buffer_load_dwordx4 a[164:167], v6, s[12:15], s67 offen offset:1024 sc1
    buffer_load_dwordx4 a[168:171], v6, s[12:15], s67 offen offset:2048 sc1
    buffer_load_dwordx4 a[172:175], v6, s[12:15], s67 offen offset:3072 sc1
    s_add_u32 s67, s67, 65536
    v_mfma_f32_16x16x32_bf16 v[112:115], v[48:51], a[192:195], 0
    ds_read_b64_tr_b16 v[80:81], v40 offset:40960
    v_accvgpr_read_b32 v244, a0
    v_mfma_f32_16x16x32_bf16 v[116:119], v[48:51], a[196:199], 0
    ds_read_b64_tr_b16 v[82:83], v40 offset:45056
    s_add_u32 m0, s69, 102400
    v_mfma_f32_16x16x32_bf16 v[120:123], v[48:51], a[200:203], 0
    ds_read_b64_tr_b16 v[84:85], v41 offset:40960
    s_add_u32 s66, s66, 114688
    v_mfma_f32_16x16x32_bf16 v[124:127], v[48:51], a[204:207], 0
    ds_read_b64_tr_b16 v[86:87], v41 offset:45056
    buffer_load_dwordx4 v2, s[8:11], s66 offen offset:0 lds
    v_mfma_f32_16x16x32_bf16 v[128:131], v[52:55], a[192:195], 0
    buffer_load_dwordx4 v3, s[8:11], s66 offen offset:1024 lds
    v_accvgpr_read_b32 v245, a1
    v_mfma_f32_16x16x32_bf16 v[132:135], v[52:55], a[196:199], 0
    ds_read_b64_tr_b16 v[88:89], v42 offset:40960
    v_accvgpr_read_b32 v246, a2
    v_mfma_f32_16x16x32_bf16 v[136:139], v[52:55], a[200:203], 0
    ds_read_b64_tr_b16 v[90:91], v42 offset:45056
    v_accvgpr_read_b32 v247, a3
    v_mfma_f32_16x16x32_bf16 v[140:143], v[52:55], a[204:207], 0
    ds_read_b64_tr_b16 v[92:93], v43 offset:40960
    v_accvgpr_read_b32 v248, a8
    v_mfma_f32_16x16x32_bf16 v[144:147], v[56:59], a[192:195], 0
    ds_read_b64_tr_b16 v[94:95], v43 offset:45056
    buffer_load_dwordx4 v4, s[8:11], s66 offen offset:2048 lds
    v_mfma_f32_16x16x32_bf16 v[148:151], v[56:59], a[196:199], 0
    v_accvgpr_read_b32 v249, a9
    v_accvgpr_read_b32 v250, a10
    v_mfma_f32_16x16x32_bf16 v[152:155], v[56:59], a[200:203], 0
    ds_read_b64_tr_b16 v[96:97], v44 offset:40960
    v_accvgpr_read_b32 v251, a11
    v_mfma_f32_16x16x32_bf16 v[156:159], v[56:59], a[204:207], 0
    ds_read_b64_tr_b16 v[98:99], v44 offset:45056
    v_mul_f32 v244, v244, v241
    v_mfma_f32_16x16x32_bf16 v[160:163], v[60:63], a[192:195], 0
    ds_read_b64_tr_b16 v[100:101], v45 offset:40960
    buffer_load_dwordx4 v5, s[8:11], s66 offen offset:3072 lds
    v_mfma_f32_16x16x32_bf16 v[164:167], v[60:63], a[196:199], 0
    ds_read_b64_tr_b16 v[102:103], v45 offset:45056
    v_mul_f32 v245, v245, v241
    v_mfma_f32_16x16x32_bf16 v[168:171], v[60:63], a[200:203], 0
    v_mul_f32 v246, v246, v241
    v_mul_f32 v247, v247, v241
    v_mfma_f32_16x16x32_bf16 v[172:175], v[60:63], a[204:207], 0
    ds_read_b64_tr_b16 v[104:105], v46 offset:40960
    v_mul_f32 v248, v248, v241
    v_mfma_f32_16x16x32_bf16 v[176:179], v[64:67], a[192:195], 0
    ds_read_b64_tr_b16 v[106:107], v46 offset:45056
    buffer_load_dwordx4 a[176:179], v6, s[12:15], s67 offen offset:0 sc1
    v_mfma_f32_16x16x32_bf16 v[180:183], v[64:67], a[196:199], 0
    ds_read_b64_tr_b16 v[108:109], v47 offset:40960
    v_mul_f32 v249, v249, v241
    v_mfma_f32_16x16x32_bf16 v[184:187], v[64:67], a[200:203], 0
    ds_read_b64_tr_b16 v[110:111], v47 offset:45056
    v_mul_f32 v250, v250, v241
    v_mfma_f32_16x16x32_bf16 v[188:191], v[64:67], a[204:207], 0
    v_mul_f32 v251, v251, v241
    v_cvt_pk_bf16_f32 v252, v244, v245
    v_mfma_f32_16x16x32_bf16 v[192:195], v[68:71], a[192:195], 0
    buffer_load_dwordx4 a[180:183], v6, s[12:15], s67 offen offset:1024 sc1
    v_cvt_pk_bf16_f32 v253, v246, v247
    v_mfma_f32_16x16x32_bf16 v[196:199], v[68:71], a[196:199], 0
    v_cvt_pk_bf16_f32 v254, v248, v249
    v_cvt_pk_bf16_f32 v255, v250, v251
    v_mfma_f32_16x16x32_bf16 v[200:203], v[68:71], a[200:203], 0
    buffer_store_dwordx4 v[252:255], v23, s[24:27], s4 offen offset:0 sc1
    v_accvgpr_read_b32 v244, a4
    v_mfma_f32_16x16x32_bf16 v[204:207], v[68:71], a[204:207], 0
    v_accvgpr_read_b32 v245, a5
    v_accvgpr_read_b32 v246, a6
    v_mfma_f32_16x16x32_bf16 v[208:211], v[72:75], a[192:195], 0
    buffer_load_dwordx4 a[184:187], v6, s[12:15], s67 offen offset:2048 sc1
    v_accvgpr_read_b32 v247, a7
    v_mfma_f32_16x16x32_bf16 v[212:215], v[72:75], a[196:199], 0
    v_accvgpr_read_b32 v248, a12
    v_accvgpr_read_b32 v249, a13
    v_mfma_f32_16x16x32_bf16 v[216:219], v[72:75], a[200:203], 0
    v_accvgpr_read_b32 v250, a14
    v_accvgpr_read_b32 v251, a15
    v_mfma_f32_16x16x32_bf16 v[220:223], v[72:75], a[204:207], 0
    v_mul_f32 v244, v244, v241
    v_mul_f32 v245, v245, v241
    v_mfma_f32_16x16x32_bf16 v[224:227], v[76:79], a[192:195], 0
    buffer_load_dwordx4 a[188:191], v6, s[12:15], s67 offen offset:3072 sc1
    v_mul_f32 v246, v246, v241
    v_mfma_f32_16x16x32_bf16 v[228:231], v[76:79], a[196:199], 0
    v_mul_f32 v247, v247, v241
    v_mul_f32 v248, v248, v241
    v_mfma_f32_16x16x32_bf16 v[232:235], v[76:79], a[200:203], 0
    v_mul_f32 v249, v249, v241
    v_mul_f32 v250, v250, v241
    v_mfma_f32_16x16x32_bf16 v[236:239], v[76:79], a[204:207], 0
    v_mul_f32 v251, v251, v241
    v_cvt_pk_bf16_f32 v252, v244, v245
    s_add_u32 s67, s67, 196608
    v_cvt_pk_bf16_f32 v253, v246, v247
    v_cvt_pk_bf16_f32 v254, v248, v249
    v_cvt_pk_bf16_f32 v255, v250, v251
    buffer_store_dwordx4 v[252:255], v25, s[24:27], s4 offen offset:512 sc1
    v_accvgpr_read_b32 v244, a16
    v_accvgpr_read_b32 v245, a17
    v_accvgpr_read_b32 v246, a18
    v_accvgpr_read_b32 v247, a19
    v_accvgpr_read_b32 v248, a24
    v_accvgpr_read_b32 v249, a25
    v_accvgpr_read_b32 v250, a26
    v_accvgpr_read_b32 v251, a27
    v_mul_f32 v244, v244, v243
    v_mul_f32 v245, v245, v243
    v_mul_f32 v246, v246, v243
    v_mul_f32 v247, v247, v243
    v_mul_f32 v248, v248, v243
    v_mul_f32 v249, v249, v243
    v_mul_f32 v250, v250, v243
    v_mul_f32 v251, v251, v243
    v_cvt_pk_bf16_f32 v252, v244, v245
    v_cvt_pk_bf16_f32 v253, v246, v247
    v_cvt_pk_bf16_f32 v254, v248, v249
    v_cvt_pk_bf16_f32 v255, v250, v251
    buffer_store_dwordx4 v[252:255], v23, s[24:27], s4 offen offset:2048 sc1
    v_accvgpr_read_b32 v244, a20
    v_accvgpr_read_b32 v245, a21
    v_accvgpr_read_b32 v246, a22
    v_accvgpr_read_b32 v247, a23
    v_accvgpr_read_b32 v248, a28
    v_accvgpr_read_b32 v249, a29
    v_accvgpr_read_b32 v250, a30
    v_accvgpr_read_b32 v251, a31
    v_mul_f32 v244, v244, v243
    v_mul_f32 v245, v245, v243
    v_mul_f32 v246, v246, v243
    v_mul_f32 v247, v247, v243
    v_mul_f32 v248, v248, v243
    v_mul_f32 v249, v249, v243
    v_mul_f32 v250, v250, v243
    v_mul_f32 v251, v251, v243
    v_cvt_pk_bf16_f32 v252, v244, v245
    v_cvt_pk_bf16_f32 v253, v246, v247
    v_cvt_pk_bf16_f32 v254, v248, v249
    v_cvt_pk_bf16_f32 v255, v250, v251
    buffer_store_dwordx4 v[252:255], v25, s[24:27], s4 offen offset:2560 sc1
    s_add_u32 s4, s4, 131072
    s_waitcnt vmcnt(36) lgkmcnt(0)
    s_barrier
    v_mfma_f32_16x16x32_bf16 v[112:115], v[80:83], a[208:211], v[112:115]
    ds_read_b64_tr_b16 v[48:49], v32 offset:0
    v_accvgpr_read_b32 v244, a32
    v_mfma_f32_16x16x32_bf16 v[116:119], v[80:83], a[212:215], v[116:119]
    ds_read_b64_tr_b16 v[50:51], v32 offset:4096
    s_add_u32 m0, s69, 131072
    v_mfma_f32_16x16x32_bf16 v[120:123], v[80:83], a[216:219], v[120:123]
    ds_read_b64_tr_b16 v[52:53], v33 offset:0
    s_add_u32 s66, s66, 802816
    v_mfma_f32_16x16x32_bf16 v[124:127], v[80:83], a[220:223], v[124:127]
    ds_read_b64_tr_b16 v[54:55], v33 offset:4096
    buffer_load_dwordx4 v2, s[8:11], s66 offen offset:0 lds
    v_mfma_f32_16x16x32_bf16 v[128:131], v[84:87], a[208:211], v[128:131]
    buffer_load_dwordx4 v3, s[8:11], s66 offen offset:1024 lds
    v_accvgpr_read_b32 v245, a33
    v_mfma_f32_16x16x32_bf16 v[132:135], v[84:87], a[212:215], v[132:135]
    ds_read_b64_tr_b16 v[56:57], v34 offset:0
    v_accvgpr_read_b32 v246, a34
    v_mfma_f32_16x16x32_bf16 v[136:139], v[84:87], a[216:219], v[136:139]
    ds_read_b64_tr_b16 v[58:59], v34 offset:4096
    v_accvgpr_read_b32 v247, a35
    v_mfma_f32_16x16x32_bf16 v[140:143], v[84:87], a[220:223], v[140:143]
    ds_read_b64_tr_b16 v[60:61], v35 offset:0
    v_accvgpr_read_b32 v248, a40
    v_mfma_f32_16x16x32_bf16 v[144:147], v[88:91], a[208:211], v[144:147]
    ds_read_b64_tr_b16 v[62:63], v35 offset:4096
    buffer_load_dwordx4 v4, s[8:11], s66 offen offset:2048 lds
    v_mfma_f32_16x16x32_bf16 v[148:151], v[88:91], a[212:215], v[148:151]
    v_accvgpr_read_b32 v249, a41
    v_accvgpr_read_b32 v250, a42
    v_mfma_f32_16x16x32_bf16 v[152:155], v[88:91], a[216:219], v[152:155]
    ds_read_b64_tr_b16 v[64:65], v36 offset:0
    v_accvgpr_read_b32 v251, a43
    v_mfma_f32_16x16x32_bf16 v[156:159], v[88:91], a[220:223], v[156:159]
    ds_read_b64_tr_b16 v[66:67], v36 offset:4096
    v_mul_f32 v244, v244, v241
    v_mfma_f32_16x16x32_bf16 v[160:163], v[92:95], a[208:211], v[160:163]
    ds_read_b64_tr_b16 v[68:69], v37 offset:0
    buffer_load_dwordx4 v5, s[8:11], s66 offen offset:3072 lds
    v_mfma_f32_16x16x32_bf16 v[164:167], v[92:95], a[212:215], v[164:167]
    ds_read_b64_tr_b16 v[70:71], v37 offset:4096
    v_mul_f32 v245, v245, v241
    v_mfma_f32_16x16x32_bf16 v[168:171], v[92:95], a[216:219], v[168:171]
    v_mul_f32 v246, v246, v241
    v_mul_f32 v247, v247, v241
    v_mfma_f32_16x16x32_bf16 v[172:175], v[92:95], a[220:223], v[172:175]
    ds_read_b64_tr_b16 v[72:73], v38 offset:0
    v_mul_f32 v248, v248, v241
    v_mfma_f32_16x16x32_bf16 v[176:179], v[96:99], a[208:211], v[176:179]
    ds_read_b64_tr_b16 v[74:75], v38 offset:4096
    buffer_load_dwordx4 a[192:195], v6, s[12:15], s67 offen offset:0 sc1
    v_mfma_f32_16x16x32_bf16 v[180:183], v[96:99], a[212:215], v[180:183]
    ds_read_b64_tr_b16 v[76:77], v39 offset:0
    v_mul_f32 v249, v249, v241
    v_mfma_f32_16x16x32_bf16 v[184:187], v[96:99], a[216:219], v[184:187]
    ds_read_b64_tr_b16 v[78:79], v39 offset:4096
    v_mul_f32 v250, v250, v241
    v_mfma_f32_16x16x32_bf16 v[188:191], v[96:99], a[220:223], v[188:191]
    v_mul_f32 v251, v251, v241
    v_cvt_pk_bf16_f32 v252, v244, v245
    v_mfma_f32_16x16x32_bf16 v[192:195], v[100:103], a[208:211], v[192:195]
    buffer_load_dwordx4 a[196:199], v6, s[12:15], s67 offen offset:1024 sc1
    v_cvt_pk_bf16_f32 v253, v246, v247
    v_mfma_f32_16x16x32_bf16 v[196:199], v[100:103], a[212:215], v[196:199]
    v_cvt_pk_bf16_f32 v254, v248, v249
    v_cvt_pk_bf16_f32 v255, v250, v251
    v_mfma_f32_16x16x32_bf16 v[200:203], v[100:103], a[216:219], v[200:203]
    buffer_store_dwordx4 v[252:255], v23, s[24:27], s4 offen offset:0 sc1
    v_accvgpr_read_b32 v244, a36
    v_mfma_f32_16x16x32_bf16 v[204:207], v[100:103], a[220:223], v[204:207]
    v_accvgpr_read_b32 v245, a37
    v_accvgpr_read_b32 v246, a38
    v_mfma_f32_16x16x32_bf16 v[208:211], v[104:107], a[208:211], v[208:211]
    buffer_load_dwordx4 a[200:203], v6, s[12:15], s67 offen offset:2048 sc1
    v_accvgpr_read_b32 v247, a39
    v_mfma_f32_16x16x32_bf16 v[212:215], v[104:107], a[212:215], v[212:215]
    v_accvgpr_read_b32 v248, a44
    v_accvgpr_read_b32 v249, a45
    v_mfma_f32_16x16x32_bf16 v[216:219], v[104:107], a[216:219], v[216:219]
    v_accvgpr_read_b32 v250, a46
    v_accvgpr_read_b32 v251, a47
    v_mfma_f32_16x16x32_bf16 v[220:223], v[104:107], a[220:223], v[220:223]
    v_mul_f32 v244, v244, v241
    v_mul_f32 v245, v245, v241
    v_mfma_f32_16x16x32_bf16 v[224:227], v[108:111], a[208:211], v[224:227]
    buffer_load_dwordx4 a[204:207], v6, s[12:15], s67 offen offset:3072 sc1
    v_mul_f32 v246, v246, v241
    v_mfma_f32_16x16x32_bf16 v[228:231], v[108:111], a[212:215], v[228:231]
    v_mul_f32 v247, v247, v241
    v_mul_f32 v248, v248, v241
    v_mfma_f32_16x16x32_bf16 v[232:235], v[108:111], a[216:219], v[232:235]
    v_mul_f32 v249, v249, v241
    v_mul_f32 v250, v250, v241
    v_mfma_f32_16x16x32_bf16 v[236:239], v[108:111], a[220:223], v[236:239]
    v_mul_f32 v251, v251, v241
    v_cvt_pk_bf16_f32 v252, v244, v245
    s_add_u32 s67, s67, 65536
    v_cvt_pk_bf16_f32 v253, v246, v247
    v_cvt_pk_bf16_f32 v254, v248, v249
    v_cvt_pk_bf16_f32 v255, v250, v251
    buffer_store_dwordx4 v[252:255], v25, s[24:27], s4 offen offset:512 sc1
    v_accvgpr_read_b32 v244, a48
    v_accvgpr_read_b32 v245, a49
    v_accvgpr_read_b32 v246, a50
    v_accvgpr_read_b32 v247, a51
    v_accvgpr_read_b32 v248, a56
    v_accvgpr_read_b32 v249, a57
    v_accvgpr_read_b32 v250, a58
    v_accvgpr_read_b32 v251, a59
    v_mul_f32 v244, v244, v243
    v_mul_f32 v245, v245, v243
    v_mul_f32 v246, v246, v243
    v_mul_f32 v247, v247, v243
    v_mul_f32 v248, v248, v243
    v_mul_f32 v249, v249, v243
    v_mul_f32 v250, v250, v243
    v_mul_f32 v251, v251, v243
    v_cvt_pk_bf16_f32 v252, v244, v245
    v_cvt_pk_bf16_f32 v253, v246, v247
    v_cvt_pk_bf16_f32 v254, v248, v249
    v_cvt_pk_bf16_f32 v255, v250, v251
    buffer_store_dwordx4 v[252:255], v23, s[24:27], s4 offen offset:2048 sc1
    v_accvgpr_read_b32 v244, a52
    v_accvgpr_read_b32 v245, a53
    v_accvgpr_read_b32 v246, a54
    v_accvgpr_read_b32 v247, a55
    v_accvgpr_read_b32 v248, a60
    v_accvgpr_read_b32 v249, a61
    v_accvgpr_read_b32 v250, a62
    v_accvgpr_read_b32 v251, a63
    v_mul_f32 v244, v244, v243
    v_mul_f32 v245, v245, v243
    v_mul_f32 v246, v246, v243
    v_mul_f32 v247, v247, v243
    v_mul_f32 v248, v248, v243
    v_mul_f32 v249, v249, v243
    v_mul_f32 v250, v250, v243
    v_mul_f32 v251, v251, v243
    v_cvt_pk_bf16_f32 v252, v244, v245
    v_cvt_pk_bf16_f32 v253, v246, v247
    v_cvt_pk_bf16_f32 v254, v248, v249
    v_cvt_pk_bf16_f32 v255, v250, v251
    buffer_store_dwordx4 v[252:255], v25, s[24:27], s4 offen offset:2560 sc1
    s_add_u32 s4, s4, 131072
    s_waitcnt lgkmcnt(0)
    v_mfma_f32_16x16x32_bf16 v[112:115], v[48:51], a[224:227], v[112:115]
    ds_read_b64_tr_b16 v[80:81], v32 offset:8192
    v_accvgpr_read_b32 v244, a64
    v_mfma_f32_16x16x32_bf16 v[116:119], v[48:51], a[228:231], v[116:119]
    ds_read_b64_tr_b16 v[82:83], v32 offset:12288
    s_add_u32 m0, s69, 135168
    v_mfma_f32_16x16x32_bf16 v[120:123], v[48:51], a[232:235], v[120:123]
    ds_read_b64_tr_b16 v[84:85], v33 offset:8192
    s_add_u32 s66, s66, 114688
    v_mfma_f32_16x16x32_bf16 v[124:127], v[48:51], a[236:239], v[124:127]
    ds_read_b64_tr_b16 v[86:87], v33 offset:12288
    buffer_load_dwordx4 v2, s[8:11], s66 offen offset:0 lds
    v_mfma_f32_16x16x32_bf16 v[128:131], v[52:55], a[224:227], v[128:131]
    buffer_load_dwordx4 v3, s[8:11], s66 offen offset:1024 lds
    v_accvgpr_read_b32 v245, a65
    v_mfma_f32_16x16x32_bf16 v[132:135], v[52:55], a[228:231], v[132:135]
    ds_read_b64_tr_b16 v[88:89], v34 offset:8192
    v_accvgpr_read_b32 v246, a66
    v_mfma_f32_16x16x32_bf16 v[136:139], v[52:55], a[232:235], v[136:139]
    ds_read_b64_tr_b16 v[90:91], v34 offset:12288
    v_accvgpr_read_b32 v247, a67
    v_mfma_f32_16x16x32_bf16 v[140:143], v[52:55], a[236:239], v[140:143]
    ds_read_b64_tr_b16 v[92:93], v35 offset:8192
    v_accvgpr_read_b32 v248, a72
    v_mfma_f32_16x16x32_bf16 v[144:147], v[56:59], a[224:227], v[144:147]
    ds_read_b64_tr_b16 v[94:95], v35 offset:12288
    buffer_load_dwordx4 v4, s[8:11], s66 offen offset:2048 lds
    v_mfma_f32_16x16x32_bf16 v[148:151], v[56:59], a[228:231], v[148:151]
    v_accvgpr_read_b32 v249, a73
    v_accvgpr_read_b32 v250, a74
    v_mfma_f32_16x16x32_bf16 v[152:155], v[56:59], a[232:235], v[152:155]
    ds_read_b64_tr_b16 v[96:97], v36 offset:8192
    v_accvgpr_read_b32 v251, a75
    v_mfma_f32_16x16x32_bf16 v[156:159], v[56:59], a[236:239], v[156:159]
    ds_read_b64_tr_b16 v[98:99], v36 offset:12288
    v_mul_f32 v244, v244, v241
    v_mfma_f32_16x16x32_bf16 v[160:163], v[60:63], a[224:227], v[160:163]
    ds_read_b64_tr_b16 v[100:101], v37 offset:8192
    buffer_load_dwordx4 v5, s[8:11], s66 offen offset:3072 lds
    v_mfma_f32_16x16x32_bf16 v[164:167], v[60:63], a[228:231], v[164:167]
    ds_read_b64_tr_b16 v[102:103], v37 offset:12288
    v_mul_f32 v245, v245, v241
    v_mfma_f32_16x16x32_bf16 v[168:171], v[60:63], a[232:235], v[168:171]
    v_mul_f32 v246, v246, v241
    v_mul_f32 v247, v247, v241
    v_mfma_f32_16x16x32_bf16 v[172:175], v[60:63], a[236:239], v[172:175]
    ds_read_b64_tr_b16 v[104:105], v38 offset:8192
    v_mul_f32 v248, v248, v241
    v_mfma_f32_16x16x32_bf16 v[176:179], v[64:67], a[224:227], v[176:179]
    ds_read_b64_tr_b16 v[106:107], v38 offset:12288
    buffer_load_dwordx4 a[208:211], v6, s[12:15], s67 offen offset:0 sc1
    v_mfma_f32_16x16x32_bf16 v[180:183], v[64:67], a[228:231], v[180:183]
    ds_read_b64_tr_b16 v[108:109], v39 offset:8192
    v_mul_f32 v249, v249, v241
    v_mfma_f32_16x16x32_bf16 v[184:187], v[64:67], a[232:235], v[184:187]
    ds_read_b64_tr_b16 v[110:111], v39 offset:12288
    v_mul_f32 v250, v250, v241
    v_mfma_f32_16x16x32_bf16 v[188:191], v[64:67], a[236:239], v[188:191]
    v_mul_f32 v251, v251, v241
    v_cvt_pk_bf16_f32 v252, v244, v245
    v_mfma_f32_16x16x32_bf16 v[192:195], v[68:71], a[224:227], v[192:195]
    buffer_load_dwordx4 a[212:215], v6, s[12:15], s67 offen offset:1024 sc1
    v_cvt_pk_bf16_f32 v253, v246, v247
    v_mfma_f32_16x16x32_bf16 v[196:199], v[68:71], a[228:231], v[196:199]
    v_cvt_pk_bf16_f32 v254, v248, v249
    v_cvt_pk_bf16_f32 v255, v250, v251
    v_mfma_f32_16x16x32_bf16 v[200:203], v[68:71], a[232:235], v[200:203]
    buffer_store_dwordx4 v[252:255], v23, s[24:27], s4 offen offset:0 sc1
    v_accvgpr_read_b32 v244, a68
    v_mfma_f32_16x16x32_bf16 v[204:207], v[68:71], a[236:239], v[204:207]
    v_accvgpr_read_b32 v245, a69
    v_accvgpr_read_b32 v246, a70
    v_mfma_f32_16x16x32_bf16 v[208:211], v[72:75], a[224:227], v[208:211]
    buffer_load_dwordx4 a[216:219], v6, s[12:15], s67 offen offset:2048 sc1
    v_accvgpr_read_b32 v247, a71
    v_mfma_f32_16x16x32_bf16 v[212:215], v[72:75], a[228:231], v[212:215]
    v_accvgpr_read_b32 v248, a76
    v_accvgpr_read_b32 v249, a77
    v_mfma_f32_16x16x32_bf16 v[216:219], v[72:75], a[232:235], v[216:219]
    v_accvgpr_read_b32 v250, a78
    v_accvgpr_read_b32 v251, a79
    v_mfma_f32_16x16x32_bf16 v[220:223], v[72:75], a[236:239], v[220:223]
    v_mul_f32 v244, v244, v241
    v_mul_f32 v245, v245, v241
    v_mfma_f32_16x16x32_bf16 v[224:227], v[76:79], a[224:227], v[224:227]
    buffer_load_dwordx4 a[220:223], v6, s[12:15], s67 offen offset:3072 sc1
    v_mul_f32 v246, v246, v241
    v_mfma_f32_16x16x32_bf16 v[228:231], v[76:79], a[228:231], v[228:231]
    v_mul_f32 v247, v247, v241
    v_mul_f32 v248, v248, v241
    v_mfma_f32_16x16x32_bf16 v[232:235], v[76:79], a[232:235], v[232:235]
    v_mul_f32 v249, v249, v241
    v_mul_f32 v250, v250, v241
    v_mfma_f32_16x16x32_bf16 v[236:239], v[76:79], a[236:239], v[236:239]
    v_mul_f32 v251, v251, v241
    v_cvt_pk_bf16_f32 v252, v244, v245
    s_add_u32 s67, s67, 196608
    v_cvt_pk_bf16_f32 v253, v246, v247
    v_cvt_pk_bf16_f32 v254, v248, v249
    v_cvt_pk_bf16_f32 v255, v250, v251
    buffer_store_dwordx4 v[252:255], v25, s[24:27], s4 offen offset:512 sc1
    v_accvgpr_read_b32 v244, a80
    v_accvgpr_read_b32 v245, a81
    v_accvgpr_read_b32 v246, a82
    v_accvgpr_read_b32 v247, a83
    v_accvgpr_read_b32 v248, a88
    v_accvgpr_read_b32 v249, a89
    v_accvgpr_read_b32 v250, a90
    v_accvgpr_read_b32 v251, a91
    v_mul_f32 v244, v244, v243
    v_mul_f32 v245, v245, v243
    v_mul_f32 v246, v246, v243
    v_mul_f32 v247, v247, v243
    v_mul_f32 v248, v248, v243
    v_mul_f32 v249, v249, v243
    v_mul_f32 v250, v250, v243
    v_mul_f32 v251, v251, v243
    v_cvt_pk_bf16_f32 v252, v244, v245
    v_cvt_pk_bf16_f32 v253, v246, v247
    v_cvt_pk_bf16_f32 v254, v248, v249
    v_cvt_pk_bf16_f32 v255, v250, v251
    buffer_store_dwordx4 v[252:255], v23, s[24:27], s4 offen offset:2048 sc1
    v_accvgpr_read_b32 v244, a84
    v_accvgpr_read_b32 v245, a85
    v_accvgpr_read_b32 v246, a86
    v_accvgpr_read_b32 v247, a87
    v_accvgpr_read_b32 v248, a92
    v_accvgpr_read_b32 v249, a93
    v_accvgpr_read_b32 v250, a94
    v_accvgpr_read_b32 v251, a95
    v_mul_f32 v244, v244, v243
    v_mul_f32 v245, v245, v243
    v_mul_f32 v246, v246, v243
    v_mul_f32 v247, v247, v243
    v_mul_f32 v248, v248, v243
    v_mul_f32 v249, v249, v243
    v_mul_f32 v250, v250, v243
    v_mul_f32 v251, v251, v243
    v_cvt_pk_bf16_f32 v252, v244, v245
    v_cvt_pk_bf16_f32 v253, v246, v247
    v_cvt_pk_bf16_f32 v254, v248, v249
    v_cvt_pk_bf16_f32 v255, v250, v251
    buffer_store_dwordx4 v[252:255], v25, s[24:27], s4 offen offset:2560 sc1
    s_add_u32 s4, s4, 131072
    s_waitcnt vmcnt(44) lgkmcnt(0)
    s_barrier
    v_mfma_f32_16x16x32_bf16 v[112:115], v[80:83], a[240:243], v[112:115]
    ds_read_b64_tr_b16 v[48:49], v32 offset:32768
    v_accvgpr_read_b32 v244, a96
    v_mfma_f32_16x16x32_bf16 v[116:119], v[80:83], a[244:247], v[116:119]
    ds_read_b64_tr_b16 v[50:51], v32 offset:36864
    s_add_u32 m0, s69, 0
    v_mfma_f32_16x16x32_bf16 v[120:123], v[80:83], a[248:251], v[120:123]
    ds_read_b64_tr_b16 v[52:53], v33 offset:32768
    s_add_u32 s66, s66, 802816
    v_mfma_f32_16x16x32_bf16 v[124:127], v[80:83], a[252:255], v[124:127]
    ds_read_b64_tr_b16 v[54:55], v33 offset:36864
    buffer_load_dwordx4 v2, s[8:11], s66 offen offset:0 lds
    v_mfma_f32_16x16x32_bf16 v[128:131], v[84:87], a[240:243], v[128:131]
    buffer_load_dwordx4 v3, s[8:11], s66 offen offset:1024 lds
    v_accvgpr_read_b32 v245, a97
    v_mfma_f32_16x16x32_bf16 v[132:135], v[84:87], a[244:247], v[132:135]
    ds_read_b64_tr_b16 v[56:57], v34 offset:32768
    v_accvgpr_read_b32 v246, a98
    v_mfma_f32_16x16x32_bf16 v[136:139], v[84:87], a[248:251], v[136:139]
    ds_read_b64_tr_b16 v[58:59], v34 offset:36864
    v_accvgpr_read_b32 v247, a99
    v_mfma_f32_16x16x32_bf16 v[140:143], v[84:87], a[252:255], v[140:143]
    ds_read_b64_tr_b16 v[60:61], v35 offset:32768
    v_accvgpr_read_b32 v248, a104
    v_mfma_f32_16x16x32_bf16 v[144:147], v[88:91], a[240:243], v[144:147]
    ds_read_b64_tr_b16 v[62:63], v35 offset:36864
    buffer_load_dwordx4 v4, s[8:11], s66 offen offset:2048 lds
    v_mfma_f32_16x16x32_bf16 v[148:151], v[88:91], a[244:247], v[148:151]
    v_accvgpr_read_b32 v249, a105
    v_accvgpr_read_b32 v250, a106
    v_mfma_f32_16x16x32_bf16 v[152:155], v[88:91], a[248:251], v[152:155]
    ds_read_b64_tr_b16 v[64:65], v36 offset:32768
    v_accvgpr_read_b32 v251, a107
    v_mfma_f32_16x16x32_bf16 v[156:159], v[88:91], a[252:255], v[156:159]
    ds_read_b64_tr_b16 v[66:67], v36 offset:36864
    v_mul_f32 v244, v244, v241
    v_mfma_f32_16x16x32_bf16 v[160:163], v[92:95], a[240:243], v[160:163]
    ds_read_b64_tr_b16 v[68:69], v37 offset:32768
    buffer_load_dwordx4 v5, s[8:11], s66 offen offset:3072 lds
    v_mfma_f32_16x16x32_bf16 v[164:167], v[92:95], a[244:247], v[164:167]
    ds_read_b64_tr_b16 v[70:71], v37 offset:36864
    v_mul_f32 v245, v245, v241
    v_mfma_f32_16x16x32_bf16 v[168:171], v[92:95], a[248:251], v[168:171]
    v_mul_f32 v246, v246, v241
    v_mul_f32 v247, v247, v241
    v_mfma_f32_16x16x32_bf16 v[172:175], v[92:95], a[252:255], v[172:175]
    ds_read_b64_tr_b16 v[72:73], v38 offset:32768
    v_mul_f32 v248, v248, v241
    v_mfma_f32_16x16x32_bf16 v[176:179], v[96:99], a[240:243], v[176:179]
    ds_read_b64_tr_b16 v[74:75], v38 offset:36864
    buffer_load_dwordx4 a[224:227], v6, s[12:15], s67 offen offset:0 sc1
    v_mfma_f32_16x16x32_bf16 v[180:183], v[96:99], a[244:247], v[180:183]
    ds_read_b64_tr_b16 v[76:77], v39 offset:32768
    v_mul_f32 v249, v249, v241
    v_mfma_f32_16x16x32_bf16 v[184:187], v[96:99], a[248:251], v[184:187]
    ds_read_b64_tr_b16 v[78:79], v39 offset:36864
    v_mul_f32 v250, v250, v241
    v_mfma_f32_16x16x32_bf16 v[188:191], v[96:99], a[252:255], v[188:191]
    v_mul_f32 v251, v251, v241
    v_cvt_pk_bf16_f32 v252, v244, v245
    v_mfma_f32_16x16x32_bf16 v[192:195], v[100:103], a[240:243], v[192:195]
    buffer_load_dwordx4 a[228:231], v6, s[12:15], s67 offen offset:1024 sc1
    v_cvt_pk_bf16_f32 v253, v246, v247
    v_mfma_f32_16x16x32_bf16 v[196:199], v[100:103], a[244:247], v[196:199]
    v_cvt_pk_bf16_f32 v254, v248, v249
    v_cvt_pk_bf16_f32 v255, v250, v251
    v_mfma_f32_16x16x32_bf16 v[200:203], v[100:103], a[248:251], v[200:203]
    buffer_store_dwordx4 v[252:255], v23, s[24:27], s4 offen offset:0 sc1
    v_accvgpr_read_b32 v244, a100
    v_mfma_f32_16x16x32_bf16 v[204:207], v[100:103], a[252:255], v[204:207]
    v_accvgpr_read_b32 v245, a101
    v_accvgpr_read_b32 v246, a102
    v_mfma_f32_16x16x32_bf16 v[208:211], v[104:107], a[240:243], v[208:211]
    buffer_load_dwordx4 a[232:235], v6, s[12:15], s67 offen offset:2048 sc1
    v_accvgpr_read_b32 v247, a103
    v_mfma_f32_16x16x32_bf16 v[212:215], v[104:107], a[244:247], v[212:215]
    v_accvgpr_read_b32 v248, a108
    v_accvgpr_read_b32 v249, a109
    v_mfma_f32_16x16x32_bf16 v[216:219], v[104:107], a[248:251], v[216:219]
    v_accvgpr_read_b32 v250, a110
    v_accvgpr_read_b32 v251, a111
    v_mfma_f32_16x16x32_bf16 v[220:223], v[104:107], a[252:255], v[220:223]
    v_mul_f32 v244, v244, v241
    v_mul_f32 v245, v245, v241
    v_mfma_f32_16x16x32_bf16 v[224:227], v[108:111], a[240:243], v[224:227]
    buffer_load_dwordx4 a[236:239], v6, s[12:15], s67 offen offset:3072 sc1
    v_mul_f32 v246, v246, v241
    v_mfma_f32_16x16x32_bf16 v[228:231], v[108:111], a[244:247], v[228:231]
    v_mul_f32 v247, v247, v241
    v_mul_f32 v248, v248, v241
    v_mfma_f32_16x16x32_bf16 v[232:235], v[108:111], a[248:251], v[232:235]
    v_mul_f32 v249, v249, v241
    v_mul_f32 v250, v250, v241
    v_mfma_f32_16x16x32_bf16 v[236:239], v[108:111], a[252:255], v[236:239]
    v_mul_f32 v251, v251, v241
    v_cvt_pk_bf16_f32 v252, v244, v245
    s_add_u32 s67, s67, 65536
    v_cvt_pk_bf16_f32 v253, v246, v247
    v_cvt_pk_bf16_f32 v254, v248, v249
    v_cvt_pk_bf16_f32 v255, v250, v251
    buffer_store_dwordx4 v[252:255], v25, s[24:27], s4 offen offset:512 sc1
    v_accvgpr_read_b32 v244, a112
    v_accvgpr_read_b32 v245, a113
    v_accvgpr_read_b32 v246, a114
    v_accvgpr_read_b32 v247, a115
    v_accvgpr_read_b32 v248, a120
    v_accvgpr_read_b32 v249, a121
    v_accvgpr_read_b32 v250, a122
    v_accvgpr_read_b32 v251, a123
    v_mul_f32 v244, v244, v243
    v_mul_f32 v245, v245, v243
    v_mul_f32 v246, v246, v243
    v_mul_f32 v247, v247, v243
    v_mul_f32 v248, v248, v243
    v_mul_f32 v249, v249, v243
    v_mul_f32 v250, v250, v243
    v_mul_f32 v251, v251, v243
    v_cvt_pk_bf16_f32 v252, v244, v245
    v_cvt_pk_bf16_f32 v253, v246, v247
    v_cvt_pk_bf16_f32 v254, v248, v249
    v_cvt_pk_bf16_f32 v255, v250, v251
    buffer_store_dwordx4 v[252:255], v23, s[24:27], s4 offen offset:2048 sc1
    v_accvgpr_read_b32 v244, a116
    v_accvgpr_read_b32 v245, a117
    v_accvgpr_read_b32 v246, a118
    v_accvgpr_read_b32 v247, a119
    v_accvgpr_read_b32 v248, a124
    v_accvgpr_read_b32 v249, a125
    v_accvgpr_read_b32 v250, a126
    v_accvgpr_read_b32 v251, a127
    v_mul_f32 v244, v244, v243
    v_mul_f32 v245, v245, v243
    v_mul_f32 v246, v246, v243
    v_mul_f32 v247, v247, v243
    v_mul_f32 v248, v248, v243
    v_mul_f32 v249, v249, v243
    v_mul_f32 v250, v250, v243
    v_mul_f32 v251, v251, v243
    v_cvt_pk_bf16_f32 v252, v244, v245
    v_cvt_pk_bf16_f32 v253, v246, v247
    v_cvt_pk_bf16_f32 v254, v248, v249
    v_cvt_pk_bf16_f32 v255, v250, v251
    buffer_store_dwordx4 v[252:255], v25, s[24:27], s4 offen offset:2560 sc1
    s_waitcnt lgkmcnt(0)
    v_mfma_f32_16x16x32_bf16 v[112:115], v[48:51], a[128:131], v[112:115]
    ds_read_b64_tr_b16 v[80:81], v32 offset:40960
    s_mov_b32 s32, s54
    v_mfma_f32_16x16x32_bf16 v[116:119], v[48:51], a[132:135], v[116:119]
    ds_read_b64_tr_b16 v[82:83], v32 offset:45056
    s_add_u32 m0, s69, 4096
    v_mfma_f32_16x16x32_bf16 v[120:123], v[48:51], a[136:139], v[120:123]
    ds_read_b64_tr_b16 v[84:85], v33 offset:40960
    s_add_u32 s66, s66, 114688
    v_mfma_f32_16x16x32_bf16 v[124:127], v[48:51], a[140:143], v[124:127]
    ds_read_b64_tr_b16 v[86:87], v33 offset:45056
    buffer_load_dwordx4 v2, s[8:11], s66 offen offset:0 lds
    v_mfma_f32_16x16x32_bf16 v[128:131], v[52:55], a[128:131], v[128:131]
    buffer_load_dwordx4 v3, s[8:11], s66 offen offset:1024 lds
    s_mov_b32 s33, s55
    v_mfma_f32_16x16x32_bf16 v[132:135], v[52:55], a[132:135], v[132:135]
    ds_read_b64_tr_b16 v[88:89], v34 offset:40960
    s_mov_b32 s34, 0x1c00
    v_mfma_f32_16x16x32_bf16 v[136:139], v[52:55], a[136:139], v[136:139]
    ds_read_b64_tr_b16 v[90:91], v34 offset:45056
    s_mov_b32 s35, 0x00020000
    v_mfma_f32_16x16x32_bf16 v[140:143], v[52:55], a[140:143], v[140:143]
    ds_read_b64_tr_b16 v[92:93], v35 offset:40960
    v_lshrrev_b32 v252, 4, v1
    v_mfma_f32_16x16x32_bf16 v[144:147], v[56:59], a[128:131], v[144:147]
    ds_read_b64_tr_b16 v[94:95], v35 offset:45056
    buffer_load_dwordx4 v4, s[8:11], s66 offen offset:2048 lds
    v_mfma_f32_16x16x32_bf16 v[148:151], v[56:59], a[132:135], v[148:151]
    v_lshlrev_b32 v252, 3, v252
    s_lshl_b32 s86, s76, 1
    v_mfma_f32_16x16x32_bf16 v[152:155], v[56:59], a[136:139], v[152:155]
    ds_read_b64_tr_b16 v[96:97], v36 offset:40960
    s_add_u32 s86, s86, s72
    v_mfma_f32_16x16x32_bf16 v[156:159], v[56:59], a[140:143], v[156:159]
    ds_read_b64_tr_b16 v[98:99], v36 offset:45056
    s_lshl_b32 s86, s86, 7
    v_mfma_f32_16x16x32_bf16 v[160:163], v[60:63], a[128:131], v[160:163]
    ds_read_b64_tr_b16 v[100:101], v37 offset:40960
    buffer_load_dwordx4 v5, s[8:11], s66 offen offset:3072 lds
    v_mfma_f32_16x16x32_bf16 v[164:167], v[60:63], a[132:135], v[164:167]
    ds_read_b64_tr_b16 v[102:103], v37 offset:45056
    buffer_load_dwordx2 v[8:9], v252, s[32:35], s86 offen offset:0
    v_mfma_f32_16x16x32_bf16 v[168:171], v[60:63], a[136:139], v[168:171]
    buffer_load_dwordx2 v[10:11], v252, s[32:35], s86 offen offset:32
    buffer_load_dwordx2 v[12:13], v252, s[32:35], s86 offen offset:64
    v_mfma_f32_16x16x32_bf16 v[172:175], v[60:63], a[140:143], v[172:175]
    ds_read_b64_tr_b16 v[104:105], v38 offset:40960
    buffer_load_dwordx2 v[14:15], v252, s[32:35], s86 offen offset:96
    v_mfma_f32_16x16x32_bf16 v[176:179], v[64:67], a[128:131], v[176:179]
    ds_read_b64_tr_b16 v[106:107], v38 offset:45056
    buffer_load_dwordx4 a[240:243], v6, s[12:15], s67 offen offset:0 sc1
    v_mfma_f32_16x16x32_bf16 v[180:183], v[64:67], a[132:135], v[180:183]
    ds_read_b64_tr_b16 v[108:109], v39 offset:40960
    v_accvgpr_write_b32 a0, 0
    v_mfma_f32_16x16x32_bf16 v[184:187], v[64:67], a[136:139], v[184:187]
    ds_read_b64_tr_b16 v[110:111], v39 offset:45056
    v_accvgpr_write_b32 a1, 0
    v_mfma_f32_16x16x32_bf16 v[188:191], v[64:67], a[140:143], v[188:191]
    v_accvgpr_write_b32 a2, 0
    v_accvgpr_write_b32 a3, 0
    v_mfma_f32_16x16x32_bf16 v[192:195], v[68:71], a[128:131], v[192:195]
    buffer_load_dwordx4 a[244:247], v6, s[12:15], s67 offen offset:1024 sc1
    v_accvgpr_write_b32 a4, 0
    v_mfma_f32_16x16x32_bf16 v[196:199], v[68:71], a[132:135], v[196:199]
    v_accvgpr_write_b32 a5, 0
    v_accvgpr_write_b32 a6, 0
    v_mfma_f32_16x16x32_bf16 v[200:203], v[68:71], a[136:139], v[200:203]
    v_accvgpr_write_b32 a7, 0
    v_accvgpr_write_b32 a8, 0
    v_mfma_f32_16x16x32_bf16 v[204:207], v[68:71], a[140:143], v[204:207]
    v_accvgpr_write_b32 a9, 0
    v_accvgpr_write_b32 a10, 0
    v_mfma_f32_16x16x32_bf16 v[208:211], v[72:75], a[128:131], v[208:211]
    buffer_load_dwordx4 a[248:251], v6, s[12:15], s67 offen offset:2048 sc1
    v_accvgpr_write_b32 a11, 0
    v_mfma_f32_16x16x32_bf16 v[212:215], v[72:75], a[132:135], v[212:215]
    v_accvgpr_write_b32 a12, 0
    v_accvgpr_write_b32 a13, 0
    v_mfma_f32_16x16x32_bf16 v[216:219], v[72:75], a[136:139], v[216:219]
    v_accvgpr_write_b32 a14, 0
    v_accvgpr_write_b32 a15, 0
    v_mfma_f32_16x16x32_bf16 v[220:223], v[72:75], a[140:143], v[220:223]
    v_accvgpr_write_b32 a16, 0
    v_accvgpr_write_b32 a17, 0
    v_mfma_f32_16x16x32_bf16 v[224:227], v[76:79], a[128:131], v[224:227]
    buffer_load_dwordx4 a[252:255], v6, s[12:15], s67 offen offset:3072 sc1
    v_accvgpr_write_b32 a18, 0
    v_mfma_f32_16x16x32_bf16 v[228:231], v[76:79], a[132:135], v[228:231]
    v_accvgpr_write_b32 a19, 0
    v_accvgpr_write_b32 a20, 0
    v_mfma_f32_16x16x32_bf16 v[232:235], v[76:79], a[136:139], v[232:235]
    v_accvgpr_write_b32 a21, 0
    v_accvgpr_write_b32 a22, 0
    v_mfma_f32_16x16x32_bf16 v[236:239], v[76:79], a[140:143], v[236:239]
    s_add_u32 s67, s67, 196608
    s_waitcnt vmcnt(51) lgkmcnt(0)
    s_barrier
    v_mfma_f32_16x16x32_bf16 v[112:115], v[80:83], a[144:147], v[112:115]
    ds_read_b64_tr_b16 v[48:49], v40 offset:0
    v_accvgpr_write_b32 a23, 0
    v_mfma_f32_16x16x32_bf16 v[116:119], v[80:83], a[148:151], v[116:119]
    ds_read_b64_tr_b16 v[50:51], v40 offset:4096
    s_add_u32 m0, s69, 32768
    v_mfma_f32_16x16x32_bf16 v[120:123], v[80:83], a[152:155], v[120:123]
    ds_read_b64_tr_b16 v[52:53], v41 offset:0
    s_add_u32 s66, s66, 802816
    v_mfma_f32_16x16x32_bf16 v[124:127], v[80:83], a[156:159], v[124:127]
    ds_read_b64_tr_b16 v[54:55], v41 offset:4096
    buffer_load_dwordx4 v2, s[8:11], s66 offen offset:0 lds
    v_mfma_f32_16x16x32_bf16 v[128:131], v[84:87], a[144:147], v[128:131]
    buffer_load_dwordx4 v3, s[8:11], s66 offen offset:1024 lds
    v_accvgpr_write_b32 a24, 0
    v_mfma_f32_16x16x32_bf16 v[132:135], v[84:87], a[148:151], v[132:135]
    ds_read_b64_tr_b16 v[56:57], v42 offset:0
    v_accvgpr_write_b32 a25, 0
    v_mfma_f32_16x16x32_bf16 v[136:139], v[84:87], a[152:155], v[136:139]
    ds_read_b64_tr_b16 v[58:59], v42 offset:4096
    v_accvgpr_write_b32 a26, 0
    v_mfma_f32_16x16x32_bf16 v[140:143], v[84:87], a[156:159], v[140:143]
    ds_read_b64_tr_b16 v[60:61], v43 offset:0
    v_accvgpr_write_b32 a27, 0
    v_mfma_f32_16x16x32_bf16 v[144:147], v[88:91], a[144:147], v[144:147]
    ds_read_b64_tr_b16 v[62:63], v43 offset:4096
    buffer_load_dwordx4 v4, s[8:11], s66 offen offset:2048 lds
    v_mfma_f32_16x16x32_bf16 v[148:151], v[88:91], a[148:151], v[148:151]
    v_accvgpr_write_b32 a28, 0
    v_accvgpr_write_b32 a29, 0
    v_mfma_f32_16x16x32_bf16 v[152:155], v[88:91], a[152:155], v[152:155]
    ds_read_b64_tr_b16 v[64:65], v44 offset:0
    v_accvgpr_write_b32 a30, 0
    v_mfma_f32_16x16x32_bf16 v[156:159], v[88:91], a[156:159], v[156:159]
    ds_read_b64_tr_b16 v[66:67], v44 offset:4096
    v_accvgpr_write_b32 a31, 0
    v_mfma_f32_16x16x32_bf16 v[160:163], v[92:95], a[144:147], v[160:163]
    ds_read_b64_tr_b16 v[68:69], v45 offset:0
    buffer_load_dwordx4 v5, s[8:11], s66 offen offset:3072 lds
    v_mfma_f32_16x16x32_bf16 v[164:167], v[92:95], a[148:151], v[164:167]
    ds_read_b64_tr_b16 v[70:71], v45 offset:4096
    v_accvgpr_write_b32 a32, 0
    v_mfma_f32_16x16x32_bf16 v[168:171], v[92:95], a[152:155], v[168:171]
    v_accvgpr_write_b32 a33, 0
    v_accvgpr_write_b32 a34, 0
    v_mfma_f32_16x16x32_bf16 v[172:175], v[92:95], a[156:159], v[172:175]
    ds_read_b64_tr_b16 v[72:73], v46 offset:0
    v_accvgpr_write_b32 a35, 0
    v_mfma_f32_16x16x32_bf16 v[176:179], v[96:99], a[144:147], v[176:179]
    ds_read_b64_tr_b16 v[74:75], v46 offset:4096
    buffer_load_dwordx4 a[128:131], v6, s[12:15], s67 offen offset:0 sc1
    v_mfma_f32_16x16x32_bf16 v[180:183], v[96:99], a[148:151], v[180:183]
    ds_read_b64_tr_b16 v[76:77], v47 offset:0
    v_accvgpr_write_b32 a36, 0
    v_mfma_f32_16x16x32_bf16 v[184:187], v[96:99], a[152:155], v[184:187]
    ds_read_b64_tr_b16 v[78:79], v47 offset:4096
    v_accvgpr_write_b32 a37, 0
    v_mfma_f32_16x16x32_bf16 v[188:191], v[96:99], a[156:159], v[188:191]
    v_accvgpr_write_b32 a38, 0
    v_accvgpr_write_b32 a39, 0
    v_mfma_f32_16x16x32_bf16 v[192:195], v[100:103], a[144:147], v[192:195]
    buffer_load_dwordx4 a[132:135], v6, s[12:15], s67 offen offset:1024 sc1
    v_accvgpr_write_b32 a40, 0
    v_mfma_f32_16x16x32_bf16 v[196:199], v[100:103], a[148:151], v[196:199]
    v_accvgpr_write_b32 a41, 0
    v_accvgpr_write_b32 a42, 0
    v_mfma_f32_16x16x32_bf16 v[200:203], v[100:103], a[152:155], v[200:203]
    v_accvgpr_write_b32 a43, 0
    v_accvgpr_write_b32 a44, 0
    v_mfma_f32_16x16x32_bf16 v[204:207], v[100:103], a[156:159], v[204:207]
    v_accvgpr_write_b32 a45, 0
    v_accvgpr_write_b32 a46, 0
    v_mfma_f32_16x16x32_bf16 v[208:211], v[104:107], a[144:147], v[208:211]
    buffer_load_dwordx4 a[136:139], v6, s[12:15], s67 offen offset:2048 sc1
    v_accvgpr_write_b32 a47, 0
    v_mfma_f32_16x16x32_bf16 v[212:215], v[104:107], a[148:151], v[212:215]
    v_accvgpr_write_b32 a48, 0
    v_accvgpr_write_b32 a49, 0
    v_mfma_f32_16x16x32_bf16 v[216:219], v[104:107], a[152:155], v[216:219]
    v_accvgpr_write_b32 a50, 0
    v_accvgpr_write_b32 a51, 0
    v_mfma_f32_16x16x32_bf16 v[220:223], v[104:107], a[156:159], v[220:223]
    v_accvgpr_write_b32 a52, 0
    v_accvgpr_write_b32 a53, 0
    v_mfma_f32_16x16x32_bf16 v[224:227], v[108:111], a[144:147], v[224:227]
    buffer_load_dwordx4 a[140:143], v6, s[12:15], s67 offen offset:3072 sc1
    v_accvgpr_write_b32 a54, 0
    v_mfma_f32_16x16x32_bf16 v[228:231], v[108:111], a[148:151], v[228:231]
    v_accvgpr_write_b32 a55, 0
    v_accvgpr_write_b32 a56, 0
    v_mfma_f32_16x16x32_bf16 v[232:235], v[108:111], a[152:155], v[232:235]
    v_accvgpr_write_b32 a57, 0
    v_accvgpr_write_b32 a58, 0
    v_mfma_f32_16x16x32_bf16 v[236:239], v[108:111], a[156:159], v[236:239]
    s_add_u32 s67, s67, 65536
    s_waitcnt lgkmcnt(0)
    v_mfma_f32_16x16x32_bf16 v[112:115], v[48:51], a[160:163], v[112:115]
    ds_read_b64_tr_b16 v[80:81], v40 offset:8192
    v_accvgpr_write_b32 a59, 0
    v_mfma_f32_16x16x32_bf16 v[116:119], v[48:51], a[164:167], v[116:119]
    ds_read_b64_tr_b16 v[82:83], v40 offset:12288
    s_add_u32 m0, s69, 36864
    v_mfma_f32_16x16x32_bf16 v[120:123], v[48:51], a[168:171], v[120:123]
    ds_read_b64_tr_b16 v[84:85], v41 offset:8192
    s_add_u32 s66, s66, 114688
    v_mfma_f32_16x16x32_bf16 v[124:127], v[48:51], a[172:175], v[124:127]
    ds_read_b64_tr_b16 v[86:87], v41 offset:12288
    buffer_load_dwordx4 v2, s[8:11], s66 offen offset:0 lds
    v_mfma_f32_16x16x32_bf16 v[128:131], v[52:55], a[160:163], v[128:131]
    buffer_load_dwordx4 v3, s[8:11], s66 offen offset:1024 lds
    v_accvgpr_write_b32 a60, 0
    v_mfma_f32_16x16x32_bf16 v[132:135], v[52:55], a[164:167], v[132:135]
    ds_read_b64_tr_b16 v[88:89], v42 offset:8192
    v_accvgpr_write_b32 a61, 0
    v_mfma_f32_16x16x32_bf16 v[136:139], v[52:55], a[168:171], v[136:139]
    ds_read_b64_tr_b16 v[90:91], v42 offset:12288
    v_accvgpr_write_b32 a62, 0
    v_mfma_f32_16x16x32_bf16 v[140:143], v[52:55], a[172:175], v[140:143]
    ds_read_b64_tr_b16 v[92:93], v43 offset:8192
    v_accvgpr_write_b32 a63, 0
    v_mfma_f32_16x16x32_bf16 v[144:147], v[56:59], a[160:163], v[144:147]
    ds_read_b64_tr_b16 v[94:95], v43 offset:12288
    buffer_load_dwordx4 v4, s[8:11], s66 offen offset:2048 lds
    v_mfma_f32_16x16x32_bf16 v[148:151], v[56:59], a[164:167], v[148:151]
    v_accvgpr_write_b32 a64, 0
    v_accvgpr_write_b32 a65, 0
    v_mfma_f32_16x16x32_bf16 v[152:155], v[56:59], a[168:171], v[152:155]
    ds_read_b64_tr_b16 v[96:97], v44 offset:8192
    v_accvgpr_write_b32 a66, 0
    v_mfma_f32_16x16x32_bf16 v[156:159], v[56:59], a[172:175], v[156:159]
    ds_read_b64_tr_b16 v[98:99], v44 offset:12288
    v_accvgpr_write_b32 a67, 0
    v_mfma_f32_16x16x32_bf16 v[160:163], v[60:63], a[160:163], v[160:163]
    ds_read_b64_tr_b16 v[100:101], v45 offset:8192
    buffer_load_dwordx4 v5, s[8:11], s66 offen offset:3072 lds
    v_mfma_f32_16x16x32_bf16 v[164:167], v[60:63], a[164:167], v[164:167]
    ds_read_b64_tr_b16 v[102:103], v45 offset:12288
    v_accvgpr_write_b32 a68, 0
    v_mfma_f32_16x16x32_bf16 v[168:171], v[60:63], a[168:171], v[168:171]
    v_accvgpr_write_b32 a69, 0
    v_accvgpr_write_b32 a70, 0
    v_mfma_f32_16x16x32_bf16 v[172:175], v[60:63], a[172:175], v[172:175]
    ds_read_b64_tr_b16 v[104:105], v46 offset:8192
    v_accvgpr_write_b32 a71, 0
    v_mfma_f32_16x16x32_bf16 v[176:179], v[64:67], a[160:163], v[176:179]
    ds_read_b64_tr_b16 v[106:107], v46 offset:12288
    buffer_load_dwordx4 a[144:147], v6, s[12:15], s67 offen offset:0 sc1
    v_mfma_f32_16x16x32_bf16 v[180:183], v[64:67], a[164:167], v[180:183]
    ds_read_b64_tr_b16 v[108:109], v47 offset:8192
    v_accvgpr_write_b32 a72, 0
    v_mfma_f32_16x16x32_bf16 v[184:187], v[64:67], a[168:171], v[184:187]
    ds_read_b64_tr_b16 v[110:111], v47 offset:12288
    v_accvgpr_write_b32 a73, 0
    v_mfma_f32_16x16x32_bf16 v[188:191], v[64:67], a[172:175], v[188:191]
    v_accvgpr_write_b32 a74, 0
    v_accvgpr_write_b32 a75, 0
    v_mfma_f32_16x16x32_bf16 v[192:195], v[68:71], a[160:163], v[192:195]
    buffer_load_dwordx4 a[148:151], v6, s[12:15], s67 offen offset:1024 sc1
    v_accvgpr_write_b32 a76, 0
    v_mfma_f32_16x16x32_bf16 v[196:199], v[68:71], a[164:167], v[196:199]
    v_accvgpr_write_b32 a77, 0
    v_accvgpr_write_b32 a78, 0
    v_mfma_f32_16x16x32_bf16 v[200:203], v[68:71], a[168:171], v[200:203]
    v_accvgpr_write_b32 a79, 0
    v_accvgpr_write_b32 a80, 0
    v_mfma_f32_16x16x32_bf16 v[204:207], v[68:71], a[172:175], v[204:207]
    v_accvgpr_write_b32 a81, 0
    v_accvgpr_write_b32 a82, 0
    v_mfma_f32_16x16x32_bf16 v[208:211], v[72:75], a[160:163], v[208:211]
    buffer_load_dwordx4 a[152:155], v6, s[12:15], s67 offen offset:2048 sc1
    v_accvgpr_write_b32 a83, 0
    v_mfma_f32_16x16x32_bf16 v[212:215], v[72:75], a[164:167], v[212:215]
    v_accvgpr_write_b32 a84, 0
    v_accvgpr_write_b32 a85, 0
    v_mfma_f32_16x16x32_bf16 v[216:219], v[72:75], a[168:171], v[216:219]
    v_accvgpr_write_b32 a86, 0
    v_accvgpr_write_b32 a87, 0
    v_mfma_f32_16x16x32_bf16 v[220:223], v[72:75], a[172:175], v[220:223]
    v_accvgpr_write_b32 a88, 0
    v_accvgpr_write_b32 a89, 0
    v_mfma_f32_16x16x32_bf16 v[224:227], v[76:79], a[160:163], v[224:227]
    buffer_load_dwordx4 a[156:159], v6, s[12:15], s67 offen offset:3072 sc1
    v_accvgpr_write_b32 a90, 0
    v_mfma_f32_16x16x32_bf16 v[228:231], v[76:79], a[164:167], v[228:231]
    v_accvgpr_write_b32 a91, 0
    v_accvgpr_write_b32 a92, 0
    v_mfma_f32_16x16x32_bf16 v[232:235], v[76:79], a[168:171], v[232:235]
    v_accvgpr_write_b32 a93, 0
    v_accvgpr_write_b32 a94, 0
    v_mfma_f32_16x16x32_bf16 v[236:239], v[76:79], a[172:175], v[236:239]
    s_add_u32 s67, s67, 196608
    s_waitcnt vmcnt(28) lgkmcnt(0)
    s_barrier
    v_mfma_f32_16x16x32_bf16 v[112:115], v[80:83], a[176:179], v[112:115]
    ds_read_b64_tr_b16 v[48:49], v40 offset:32768
    v_accvgpr_write_b32 a95, 0
    v_mfma_f32_16x16x32_bf16 v[116:119], v[80:83], a[180:183], v[116:119]
    ds_read_b64_tr_b16 v[50:51], v40 offset:36864
    s_add_u32 m0, s69, 98304
    v_mfma_f32_16x16x32_bf16 v[120:123], v[80:83], a[184:187], v[120:123]
    ds_read_b64_tr_b16 v[52:53], v41 offset:32768
    s_add_u32 s66, s66, 802816
    v_mfma_f32_16x16x32_bf16 v[124:127], v[80:83], a[188:191], v[124:127]
    ds_read_b64_tr_b16 v[54:55], v41 offset:36864
    buffer_load_dwordx4 v2, s[8:11], s66 offen offset:0 lds
    v_mfma_f32_16x16x32_bf16 v[128:131], v[84:87], a[176:179], v[128:131]
    buffer_load_dwordx4 v3, s[8:11], s66 offen offset:1024 lds
    v_accvgpr_write_b32 a96, 0
    v_mfma_f32_16x16x32_bf16 v[132:135], v[84:87], a[180:183], v[132:135]
    ds_read_b64_tr_b16 v[56:57], v42 offset:32768
    v_accvgpr_write_b32 a97, 0
    v_mfma_f32_16x16x32_bf16 v[136:139], v[84:87], a[184:187], v[136:139]
    ds_read_b64_tr_b16 v[58:59], v42 offset:36864
    v_accvgpr_write_b32 a98, 0
    v_mfma_f32_16x16x32_bf16 v[140:143], v[84:87], a[188:191], v[140:143]
    ds_read_b64_tr_b16 v[60:61], v43 offset:32768
    v_accvgpr_write_b32 a99, 0
    v_mfma_f32_16x16x32_bf16 v[144:147], v[88:91], a[176:179], v[144:147]
    ds_read_b64_tr_b16 v[62:63], v43 offset:36864
    buffer_load_dwordx4 v4, s[8:11], s66 offen offset:2048 lds
    v_mfma_f32_16x16x32_bf16 v[148:151], v[88:91], a[180:183], v[148:151]
    v_accvgpr_write_b32 a100, 0
    v_accvgpr_write_b32 a101, 0
    v_mfma_f32_16x16x32_bf16 v[152:155], v[88:91], a[184:187], v[152:155]
    ds_read_b64_tr_b16 v[64:65], v44 offset:32768
    v_accvgpr_write_b32 a102, 0
    v_mfma_f32_16x16x32_bf16 v[156:159], v[88:91], a[188:191], v[156:159]
    ds_read_b64_tr_b16 v[66:67], v44 offset:36864
    v_accvgpr_write_b32 a103, 0
    v_mfma_f32_16x16x32_bf16 v[160:163], v[92:95], a[176:179], v[160:163]
    ds_read_b64_tr_b16 v[68:69], v45 offset:32768
    buffer_load_dwordx4 v5, s[8:11], s66 offen offset:3072 lds
    v_mfma_f32_16x16x32_bf16 v[164:167], v[92:95], a[180:183], v[164:167]
    ds_read_b64_tr_b16 v[70:71], v45 offset:36864
    v_accvgpr_write_b32 a104, 0
    v_mfma_f32_16x16x32_bf16 v[168:171], v[92:95], a[184:187], v[168:171]
    v_accvgpr_write_b32 a105, 0
    v_accvgpr_write_b32 a106, 0
    v_mfma_f32_16x16x32_bf16 v[172:175], v[92:95], a[188:191], v[172:175]
    ds_read_b64_tr_b16 v[72:73], v46 offset:32768
    v_accvgpr_write_b32 a107, 0
    v_mfma_f32_16x16x32_bf16 v[176:179], v[96:99], a[176:179], v[176:179]
    ds_read_b64_tr_b16 v[74:75], v46 offset:36864
    buffer_load_dwordx4 a[160:163], v6, s[12:15], s67 offen offset:0 sc1
    v_mfma_f32_16x16x32_bf16 v[180:183], v[96:99], a[180:183], v[180:183]
    ds_read_b64_tr_b16 v[76:77], v47 offset:32768
    v_accvgpr_write_b32 a108, 0
    v_mfma_f32_16x16x32_bf16 v[184:187], v[96:99], a[184:187], v[184:187]
    ds_read_b64_tr_b16 v[78:79], v47 offset:36864
    v_accvgpr_write_b32 a109, 0
    v_mfma_f32_16x16x32_bf16 v[188:191], v[96:99], a[188:191], v[188:191]
    v_accvgpr_write_b32 a110, 0
    v_accvgpr_write_b32 a111, 0
    v_mfma_f32_16x16x32_bf16 v[192:195], v[100:103], a[176:179], v[192:195]
    buffer_load_dwordx4 a[164:167], v6, s[12:15], s67 offen offset:1024 sc1
    v_accvgpr_write_b32 a112, 0
    v_mfma_f32_16x16x32_bf16 v[196:199], v[100:103], a[180:183], v[196:199]
    v_accvgpr_write_b32 a113, 0
    v_accvgpr_write_b32 a114, 0
    v_mfma_f32_16x16x32_bf16 v[200:203], v[100:103], a[184:187], v[200:203]
    v_accvgpr_write_b32 a115, 0
    v_accvgpr_write_b32 a116, 0
    v_mfma_f32_16x16x32_bf16 v[204:207], v[100:103], a[188:191], v[204:207]
    v_accvgpr_write_b32 a117, 0
    v_accvgpr_write_b32 a118, 0
    v_mfma_f32_16x16x32_bf16 v[208:211], v[104:107], a[176:179], v[208:211]
    buffer_load_dwordx4 a[168:171], v6, s[12:15], s67 offen offset:2048 sc1
    v_accvgpr_write_b32 a119, 0
    v_mfma_f32_16x16x32_bf16 v[212:215], v[104:107], a[180:183], v[212:215]
    v_accvgpr_write_b32 a120, 0
    v_accvgpr_write_b32 a121, 0
    v_mfma_f32_16x16x32_bf16 v[216:219], v[104:107], a[184:187], v[216:219]
    v_accvgpr_write_b32 a122, 0
    v_accvgpr_write_b32 a123, 0
    v_mfma_f32_16x16x32_bf16 v[220:223], v[104:107], a[188:191], v[220:223]
    v_accvgpr_write_b32 a124, 0
    v_accvgpr_write_b32 a125, 0
    v_mfma_f32_16x16x32_bf16 v[224:227], v[108:111], a[176:179], v[224:227]
    buffer_load_dwordx4 a[172:175], v6, s[12:15], s67 offen offset:3072 sc1
    v_accvgpr_write_b32 a126, 0
    v_mfma_f32_16x16x32_bf16 v[228:231], v[108:111], a[180:183], v[228:231]
    v_accvgpr_write_b32 a127, 0
    v_mfma_f32_16x16x32_bf16 v[232:235], v[108:111], a[184:187], v[232:235]
    v_mfma_f32_16x16x32_bf16 v[236:239], v[108:111], a[188:191], v[236:239]
    s_add_u32 s67, s67, 65536
    s_waitcnt lgkmcnt(0)
    s_lshl_b32 s82, s74, 5
    s_add_u32 s82, s82, s75
    s_lshl_b32 s82, s82, 3
    s_add_u32 s82, s82, 16384
    v_mov_b32 v248, s50
    v_mov_b32 v249, s51
    v_lshlrev_b32 v250, 11, v0
    v_cmp_gt_u32 vcc, 1, v0
    s_and_saveexec_b64 s[84:85], vcc
    s_cbranch_execz 1f
    buffer_store_dwordx2 v[248:249], v250, s[36:39], s82 offen sc1
1:
    s_mov_b64 exec, s[84:85]
    s_mov_b32 s70, 2
.p2align 6
km_su_loop:
    v_mfma_f32_16x16x32_bf16 v[112:115], v[48:51], a[192:195], v[112:115]
    ds_read_b64_tr_b16 v[80:81], v40 offset:40960
    v_mfma_f32_16x16x32_bf16 v[116:119], v[48:51], a[196:199], v[116:119]
    ds_read_b64_tr_b16 v[82:83], v40 offset:45056
    s_add_u32 m0, s69, 102400
    s_add_u32 s66, s66, 114688
    v_mfma_f32_16x16x32_bf16 v[120:123], v[48:51], a[200:203], v[120:123]
    ds_read_b64_tr_b16 v[84:85], v41 offset:40960
    buffer_load_dwordx4 v2, s[8:11], s66 offen offset:0 lds
    v_mfma_f32_16x16x32_bf16 v[124:127], v[48:51], a[204:207], v[124:127]
    ds_read_b64_tr_b16 v[86:87], v41 offset:45056
    v_mfma_f32_16x16x32_bf16 v[128:131], v[52:55], a[192:195], v[128:131]
    buffer_load_dwordx4 v3, s[8:11], s66 offen offset:1024 lds
    v_mfma_f32_16x16x32_bf16 v[132:135], v[52:55], a[196:199], v[132:135]
    ds_read_b64_tr_b16 v[88:89], v42 offset:40960
    v_mfma_f32_16x16x32_bf16 v[136:139], v[52:55], a[200:203], v[136:139]
    ds_read_b64_tr_b16 v[90:91], v42 offset:45056
    v_mfma_f32_16x16x32_bf16 v[140:143], v[52:55], a[204:207], v[140:143]
    ds_read_b64_tr_b16 v[92:93], v43 offset:40960
    v_mfma_f32_16x16x32_bf16 v[144:147], v[56:59], a[192:195], v[144:147]
    ds_read_b64_tr_b16 v[94:95], v43 offset:45056
    buffer_load_dwordx4 v4, s[8:11], s66 offen offset:2048 lds
    v_mfma_f32_16x16x32_bf16 v[148:151], v[56:59], a[196:199], v[148:151]
    v_mfma_f32_16x16x32_bf16 v[152:155], v[56:59], a[200:203], v[152:155]
    ds_read_b64_tr_b16 v[96:97], v44 offset:40960
    v_mfma_f32_16x16x32_bf16 v[156:159], v[56:59], a[204:207], v[156:159]
    ds_read_b64_tr_b16 v[98:99], v44 offset:45056
    v_mfma_f32_16x16x32_bf16 v[160:163], v[60:63], a[192:195], v[160:163]
    ds_read_b64_tr_b16 v[100:101], v45 offset:40960
    buffer_load_dwordx4 v5, s[8:11], s66 offen offset:3072 lds
    v_mfma_f32_16x16x32_bf16 v[164:167], v[60:63], a[196:199], v[164:167]
    ds_read_b64_tr_b16 v[102:103], v45 offset:45056
    v_mfma_f32_16x16x32_bf16 v[168:171], v[60:63], a[200:203], v[168:171]
    v_mfma_f32_16x16x32_bf16 v[172:175], v[60:63], a[204:207], v[172:175]
    ds_read_b64_tr_b16 v[104:105], v46 offset:40960
    v_mfma_f32_16x16x32_bf16 v[176:179], v[64:67], a[192:195], v[176:179]
    ds_read_b64_tr_b16 v[106:107], v46 offset:45056
    buffer_load_dwordx4 a[176:179], v6, s[12:15], s67 offen offset:0 sc1
    v_mfma_f32_16x16x32_bf16 v[180:183], v[64:67], a[196:199], v[180:183]
    ds_read_b64_tr_b16 v[108:109], v47 offset:40960
    v_mfma_f32_16x16x32_bf16 v[184:187], v[64:67], a[200:203], v[184:187]
    ds_read_b64_tr_b16 v[110:111], v47 offset:45056
    v_mfma_f32_16x16x32_bf16 v[188:191], v[64:67], a[204:207], v[188:191]
    v_mfma_f32_16x16x32_bf16 v[192:195], v[68:71], a[192:195], v[192:195]
    buffer_load_dwordx4 a[180:183], v6, s[12:15], s67 offen offset:1024 sc1
    v_mfma_f32_16x16x32_bf16 v[196:199], v[68:71], a[196:199], v[196:199]
    v_mfma_f32_16x16x32_bf16 v[200:203], v[68:71], a[200:203], v[200:203]
    v_mfma_f32_16x16x32_bf16 v[204:207], v[68:71], a[204:207], v[204:207]
    v_mfma_f32_16x16x32_bf16 v[208:211], v[72:75], a[192:195], v[208:211]
    buffer_load_dwordx4 a[184:187], v6, s[12:15], s67 offen offset:2048 sc1
    v_mfma_f32_16x16x32_bf16 v[212:215], v[72:75], a[196:199], v[212:215]
    v_mfma_f32_16x16x32_bf16 v[216:219], v[72:75], a[200:203], v[216:219]
    v_mfma_f32_16x16x32_bf16 v[220:223], v[72:75], a[204:207], v[220:223]
    v_mfma_f32_16x16x32_bf16 v[224:227], v[76:79], a[192:195], v[224:227]
    buffer_load_dwordx4 a[188:191], v6, s[12:15], s67 offen offset:3072 sc1
    v_mfma_f32_16x16x32_bf16 v[228:231], v[76:79], a[196:199], v[228:231]
    v_mfma_f32_16x16x32_bf16 v[232:235], v[76:79], a[200:203], v[232:235]
    v_mfma_f32_16x16x32_bf16 v[236:239], v[76:79], a[204:207], v[236:239]
    s_add_u32 s67, s67, 196608
    s_waitcnt vmcnt(32) lgkmcnt(0)
    s_barrier
    v_mfma_f32_16x16x32_bf16 v[112:115], v[80:83], a[208:211], v[112:115]
    ds_read_b64_tr_b16 v[48:49], v32 offset:0
    v_mfma_f32_16x16x32_bf16 v[116:119], v[80:83], a[212:215], v[116:119]
    ds_read_b64_tr_b16 v[50:51], v32 offset:4096
    s_add_u32 m0, s69, 131072
    s_add_u32 s66, s66, 802816
    v_mfma_f32_16x16x32_bf16 v[120:123], v[80:83], a[216:219], v[120:123]
    ds_read_b64_tr_b16 v[52:53], v33 offset:0
    buffer_load_dwordx4 v2, s[8:11], s66 offen offset:0 lds
    v_mfma_f32_16x16x32_bf16 v[124:127], v[80:83], a[220:223], v[124:127]
    ds_read_b64_tr_b16 v[54:55], v33 offset:4096
    v_mfma_f32_16x16x32_bf16 v[128:131], v[84:87], a[208:211], v[128:131]
    buffer_load_dwordx4 v3, s[8:11], s66 offen offset:1024 lds
    v_mfma_f32_16x16x32_bf16 v[132:135], v[84:87], a[212:215], v[132:135]
    ds_read_b64_tr_b16 v[56:57], v34 offset:0
    v_mfma_f32_16x16x32_bf16 v[136:139], v[84:87], a[216:219], v[136:139]
    ds_read_b64_tr_b16 v[58:59], v34 offset:4096
    v_mfma_f32_16x16x32_bf16 v[140:143], v[84:87], a[220:223], v[140:143]
    ds_read_b64_tr_b16 v[60:61], v35 offset:0
    v_mfma_f32_16x16x32_bf16 v[144:147], v[88:91], a[208:211], v[144:147]
    ds_read_b64_tr_b16 v[62:63], v35 offset:4096
    buffer_load_dwordx4 v4, s[8:11], s66 offen offset:2048 lds
    v_mfma_f32_16x16x32_bf16 v[148:151], v[88:91], a[212:215], v[148:151]
    v_mfma_f32_16x16x32_bf16 v[152:155], v[88:91], a[216:219], v[152:155]
    ds_read_b64_tr_b16 v[64:65], v36 offset:0
    v_mfma_f32_16x16x32_bf16 v[156:159], v[88:91], a[220:223], v[156:159]
    ds_read_b64_tr_b16 v[66:67], v36 offset:4096
    v_mfma_f32_16x16x32_bf16 v[160:163], v[92:95], a[208:211], v[160:163]
    ds_read_b64_tr_b16 v[68:69], v37 offset:0
    buffer_load_dwordx4 v5, s[8:11], s66 offen offset:3072 lds
    v_mfma_f32_16x16x32_bf16 v[164:167], v[92:95], a[212:215], v[164:167]
    ds_read_b64_tr_b16 v[70:71], v37 offset:4096
    v_mfma_f32_16x16x32_bf16 v[168:171], v[92:95], a[216:219], v[168:171]
    v_mfma_f32_16x16x32_bf16 v[172:175], v[92:95], a[220:223], v[172:175]
    ds_read_b64_tr_b16 v[72:73], v38 offset:0
    v_mfma_f32_16x16x32_bf16 v[176:179], v[96:99], a[208:211], v[176:179]
    ds_read_b64_tr_b16 v[74:75], v38 offset:4096
    buffer_load_dwordx4 a[192:195], v6, s[12:15], s67 offen offset:0 sc1
    v_mfma_f32_16x16x32_bf16 v[180:183], v[96:99], a[212:215], v[180:183]
    ds_read_b64_tr_b16 v[76:77], v39 offset:0
    v_mfma_f32_16x16x32_bf16 v[184:187], v[96:99], a[216:219], v[184:187]
    ds_read_b64_tr_b16 v[78:79], v39 offset:4096
    v_mfma_f32_16x16x32_bf16 v[188:191], v[96:99], a[220:223], v[188:191]
    v_mfma_f32_16x16x32_bf16 v[192:195], v[100:103], a[208:211], v[192:195]
    buffer_load_dwordx4 a[196:199], v6, s[12:15], s67 offen offset:1024 sc1
    v_mfma_f32_16x16x32_bf16 v[196:199], v[100:103], a[212:215], v[196:199]
    v_mfma_f32_16x16x32_bf16 v[200:203], v[100:103], a[216:219], v[200:203]
    v_mfma_f32_16x16x32_bf16 v[204:207], v[100:103], a[220:223], v[204:207]
    v_mfma_f32_16x16x32_bf16 v[208:211], v[104:107], a[208:211], v[208:211]
    buffer_load_dwordx4 a[200:203], v6, s[12:15], s67 offen offset:2048 sc1
    v_mfma_f32_16x16x32_bf16 v[212:215], v[104:107], a[212:215], v[212:215]
    v_mfma_f32_16x16x32_bf16 v[216:219], v[104:107], a[216:219], v[216:219]
    v_mfma_f32_16x16x32_bf16 v[220:223], v[104:107], a[220:223], v[220:223]
    v_mfma_f32_16x16x32_bf16 v[224:227], v[108:111], a[208:211], v[224:227]
    buffer_load_dwordx4 a[204:207], v6, s[12:15], s67 offen offset:3072 sc1
    v_mfma_f32_16x16x32_bf16 v[228:231], v[108:111], a[212:215], v[228:231]
    v_mfma_f32_16x16x32_bf16 v[232:235], v[108:111], a[216:219], v[232:235]
    v_mfma_f32_16x16x32_bf16 v[236:239], v[108:111], a[220:223], v[236:239]
    s_add_u32 s67, s67, 65536
    s_waitcnt lgkmcnt(0)
    v_mfma_f32_16x16x32_bf16 v[112:115], v[48:51], a[224:227], v[112:115]
    ds_read_b64_tr_b16 v[80:81], v32 offset:8192
    v_mfma_f32_16x16x32_bf16 v[116:119], v[48:51], a[228:231], v[116:119]
    ds_read_b64_tr_b16 v[82:83], v32 offset:12288
    s_add_u32 m0, s69, 135168
    s_add_u32 s66, s66, 114688
    v_mfma_f32_16x16x32_bf16 v[120:123], v[48:51], a[232:235], v[120:123]
    ds_read_b64_tr_b16 v[84:85], v33 offset:8192
    buffer_load_dwordx4 v2, s[8:11], s66 offen offset:0 lds
    v_mfma_f32_16x16x32_bf16 v[124:127], v[48:51], a[236:239], v[124:127]
    ds_read_b64_tr_b16 v[86:87], v33 offset:12288
    v_mfma_f32_16x16x32_bf16 v[128:131], v[52:55], a[224:227], v[128:131]
    buffer_load_dwordx4 v3, s[8:11], s66 offen offset:1024 lds
    v_mfma_f32_16x16x32_bf16 v[132:135], v[52:55], a[228:231], v[132:135]
    ds_read_b64_tr_b16 v[88:89], v34 offset:8192
    v_mfma_f32_16x16x32_bf16 v[136:139], v[52:55], a[232:235], v[136:139]
    ds_read_b64_tr_b16 v[90:91], v34 offset:12288
    v_mfma_f32_16x16x32_bf16 v[140:143], v[52:55], a[236:239], v[140:143]
    ds_read_b64_tr_b16 v[92:93], v35 offset:8192
    v_mfma_f32_16x16x32_bf16 v[144:147], v[56:59], a[224:227], v[144:147]
    ds_read_b64_tr_b16 v[94:95], v35 offset:12288
    buffer_load_dwordx4 v4, s[8:11], s66 offen offset:2048 lds
    v_mfma_f32_16x16x32_bf16 v[148:151], v[56:59], a[228:231], v[148:151]
    v_mfma_f32_16x16x32_bf16 v[152:155], v[56:59], a[232:235], v[152:155]
    ds_read_b64_tr_b16 v[96:97], v36 offset:8192
    v_mfma_f32_16x16x32_bf16 v[156:159], v[56:59], a[236:239], v[156:159]
    ds_read_b64_tr_b16 v[98:99], v36 offset:12288
    v_mfma_f32_16x16x32_bf16 v[160:163], v[60:63], a[224:227], v[160:163]
    ds_read_b64_tr_b16 v[100:101], v37 offset:8192
    buffer_load_dwordx4 v5, s[8:11], s66 offen offset:3072 lds
    v_mfma_f32_16x16x32_bf16 v[164:167], v[60:63], a[228:231], v[164:167]
    ds_read_b64_tr_b16 v[102:103], v37 offset:12288
    v_mfma_f32_16x16x32_bf16 v[168:171], v[60:63], a[232:235], v[168:171]
    v_mfma_f32_16x16x32_bf16 v[172:175], v[60:63], a[236:239], v[172:175]
    ds_read_b64_tr_b16 v[104:105], v38 offset:8192
    v_mfma_f32_16x16x32_bf16 v[176:179], v[64:67], a[224:227], v[176:179]
    ds_read_b64_tr_b16 v[106:107], v38 offset:12288
    buffer_load_dwordx4 a[208:211], v6, s[12:15], s67 offen offset:0 sc1
    v_mfma_f32_16x16x32_bf16 v[180:183], v[64:67], a[228:231], v[180:183]
    ds_read_b64_tr_b16 v[108:109], v39 offset:8192
    v_mfma_f32_16x16x32_bf16 v[184:187], v[64:67], a[232:235], v[184:187]
    ds_read_b64_tr_b16 v[110:111], v39 offset:12288
    v_mfma_f32_16x16x32_bf16 v[188:191], v[64:67], a[236:239], v[188:191]
    v_mfma_f32_16x16x32_bf16 v[192:195], v[68:71], a[224:227], v[192:195]
    buffer_load_dwordx4 a[212:215], v6, s[12:15], s67 offen offset:1024 sc1
    v_mfma_f32_16x16x32_bf16 v[196:199], v[68:71], a[228:231], v[196:199]
    v_mfma_f32_16x16x32_bf16 v[200:203], v[68:71], a[232:235], v[200:203]
    v_mfma_f32_16x16x32_bf16 v[204:207], v[68:71], a[236:239], v[204:207]
    v_mfma_f32_16x16x32_bf16 v[208:211], v[72:75], a[224:227], v[208:211]
    buffer_load_dwordx4 a[216:219], v6, s[12:15], s67 offen offset:2048 sc1
    v_mfma_f32_16x16x32_bf16 v[212:215], v[72:75], a[228:231], v[212:215]
    v_mfma_f32_16x16x32_bf16 v[216:219], v[72:75], a[232:235], v[216:219]
    v_mfma_f32_16x16x32_bf16 v[220:223], v[72:75], a[236:239], v[220:223]
    v_mfma_f32_16x16x32_bf16 v[224:227], v[76:79], a[224:227], v[224:227]
    buffer_load_dwordx4 a[220:223], v6, s[12:15], s67 offen offset:3072 sc1
    v_mfma_f32_16x16x32_bf16 v[228:231], v[76:79], a[228:231], v[228:231]
    v_mfma_f32_16x16x32_bf16 v[232:235], v[76:79], a[232:235], v[232:235]
    v_mfma_f32_16x16x32_bf16 v[236:239], v[76:79], a[236:239], v[236:239]
    s_add_u32 s67, s67, 196608
    s_waitcnt vmcnt(32) lgkmcnt(0)
    s_barrier
    v_mfma_f32_16x16x32_bf16 v[112:115], v[80:83], a[240:243], v[112:115]
    ds_read_b64_tr_b16 v[48:49], v32 offset:32768
    v_mfma_f32_16x16x32_bf16 v[116:119], v[80:83], a[244:247], v[116:119]
    ds_read_b64_tr_b16 v[50:51], v32 offset:36864
    s_add_u32 m0, s69, 0
    s_add_u32 s66, s66, 802816
    v_mfma_f32_16x16x32_bf16 v[120:123], v[80:83], a[248:251], v[120:123]
    ds_read_b64_tr_b16 v[52:53], v33 offset:32768
    buffer_load_dwordx4 v2, s[8:11], s66 offen offset:0 lds
    v_mfma_f32_16x16x32_bf16 v[124:127], v[80:83], a[252:255], v[124:127]
    ds_read_b64_tr_b16 v[54:55], v33 offset:36864
    v_mfma_f32_16x16x32_bf16 v[128:131], v[84:87], a[240:243], v[128:131]
    buffer_load_dwordx4 v3, s[8:11], s66 offen offset:1024 lds
    v_mfma_f32_16x16x32_bf16 v[132:135], v[84:87], a[244:247], v[132:135]
    ds_read_b64_tr_b16 v[56:57], v34 offset:32768
    v_mfma_f32_16x16x32_bf16 v[136:139], v[84:87], a[248:251], v[136:139]
    ds_read_b64_tr_b16 v[58:59], v34 offset:36864
    v_mfma_f32_16x16x32_bf16 v[140:143], v[84:87], a[252:255], v[140:143]
    ds_read_b64_tr_b16 v[60:61], v35 offset:32768
    v_mfma_f32_16x16x32_bf16 v[144:147], v[88:91], a[240:243], v[144:147]
    ds_read_b64_tr_b16 v[62:63], v35 offset:36864
    buffer_load_dwordx4 v4, s[8:11], s66 offen offset:2048 lds
    v_mfma_f32_16x16x32_bf16 v[148:151], v[88:91], a[244:247], v[148:151]
    v_mfma_f32_16x16x32_bf16 v[152:155], v[88:91], a[248:251], v[152:155]
    ds_read_b64_tr_b16 v[64:65], v36 offset:32768
    v_mfma_f32_16x16x32_bf16 v[156:159], v[88:91], a[252:255], v[156:159]
    ds_read_b64_tr_b16 v[66:67], v36 offset:36864
    v_mfma_f32_16x16x32_bf16 v[160:163], v[92:95], a[240:243], v[160:163]
    ds_read_b64_tr_b16 v[68:69], v37 offset:32768
    buffer_load_dwordx4 v5, s[8:11], s66 offen offset:3072 lds
    v_mfma_f32_16x16x32_bf16 v[164:167], v[92:95], a[244:247], v[164:167]
    ds_read_b64_tr_b16 v[70:71], v37 offset:36864
    v_mfma_f32_16x16x32_bf16 v[168:171], v[92:95], a[248:251], v[168:171]
    v_mfma_f32_16x16x32_bf16 v[172:175], v[92:95], a[252:255], v[172:175]
    ds_read_b64_tr_b16 v[72:73], v38 offset:32768
    v_mfma_f32_16x16x32_bf16 v[176:179], v[96:99], a[240:243], v[176:179]
    ds_read_b64_tr_b16 v[74:75], v38 offset:36864
    buffer_load_dwordx4 a[224:227], v6, s[12:15], s67 offen offset:0 sc1
    v_mfma_f32_16x16x32_bf16 v[180:183], v[96:99], a[244:247], v[180:183]
    ds_read_b64_tr_b16 v[76:77], v39 offset:32768
    v_mfma_f32_16x16x32_bf16 v[184:187], v[96:99], a[248:251], v[184:187]
    ds_read_b64_tr_b16 v[78:79], v39 offset:36864
    v_mfma_f32_16x16x32_bf16 v[188:191], v[96:99], a[252:255], v[188:191]
    v_mfma_f32_16x16x32_bf16 v[192:195], v[100:103], a[240:243], v[192:195]
    buffer_load_dwordx4 a[228:231], v6, s[12:15], s67 offen offset:1024 sc1
    v_mfma_f32_16x16x32_bf16 v[196:199], v[100:103], a[244:247], v[196:199]
    v_mfma_f32_16x16x32_bf16 v[200:203], v[100:103], a[248:251], v[200:203]
    v_mfma_f32_16x16x32_bf16 v[204:207], v[100:103], a[252:255], v[204:207]
    v_mfma_f32_16x16x32_bf16 v[208:211], v[104:107], a[240:243], v[208:211]
    buffer_load_dwordx4 a[232:235], v6, s[12:15], s67 offen offset:2048 sc1
    v_mfma_f32_16x16x32_bf16 v[212:215], v[104:107], a[244:247], v[212:215]
    v_mfma_f32_16x16x32_bf16 v[216:219], v[104:107], a[248:251], v[216:219]
    v_mfma_f32_16x16x32_bf16 v[220:223], v[104:107], a[252:255], v[220:223]
    v_mfma_f32_16x16x32_bf16 v[224:227], v[108:111], a[240:243], v[224:227]
    buffer_load_dwordx4 a[236:239], v6, s[12:15], s67 offen offset:3072 sc1
    v_mfma_f32_16x16x32_bf16 v[228:231], v[108:111], a[244:247], v[228:231]
    v_mfma_f32_16x16x32_bf16 v[232:235], v[108:111], a[248:251], v[232:235]
    v_mfma_f32_16x16x32_bf16 v[236:239], v[108:111], a[252:255], v[236:239]
    s_add_u32 s67, s67, 65536
    s_waitcnt lgkmcnt(0)
    v_mfma_f32_16x16x32_bf16 v[112:115], v[48:51], a[128:131], v[112:115]
    ds_read_b64_tr_b16 v[80:81], v32 offset:40960
    v_mfma_f32_16x16x32_bf16 v[116:119], v[48:51], a[132:135], v[116:119]
    ds_read_b64_tr_b16 v[82:83], v32 offset:45056
    s_add_u32 m0, s69, 4096
    s_add_u32 s66, s66, 114688
    v_mfma_f32_16x16x32_bf16 v[120:123], v[48:51], a[136:139], v[120:123]
    ds_read_b64_tr_b16 v[84:85], v33 offset:40960
    buffer_load_dwordx4 v2, s[8:11], s66 offen offset:0 lds
    v_mfma_f32_16x16x32_bf16 v[124:127], v[48:51], a[140:143], v[124:127]
    ds_read_b64_tr_b16 v[86:87], v33 offset:45056
    v_mfma_f32_16x16x32_bf16 v[128:131], v[52:55], a[128:131], v[128:131]
    buffer_load_dwordx4 v3, s[8:11], s66 offen offset:1024 lds
    v_mfma_f32_16x16x32_bf16 v[132:135], v[52:55], a[132:135], v[132:135]
    ds_read_b64_tr_b16 v[88:89], v34 offset:40960
    v_mfma_f32_16x16x32_bf16 v[136:139], v[52:55], a[136:139], v[136:139]
    ds_read_b64_tr_b16 v[90:91], v34 offset:45056
    v_mfma_f32_16x16x32_bf16 v[140:143], v[52:55], a[140:143], v[140:143]
    ds_read_b64_tr_b16 v[92:93], v35 offset:40960
    v_mfma_f32_16x16x32_bf16 v[144:147], v[56:59], a[128:131], v[144:147]
    ds_read_b64_tr_b16 v[94:95], v35 offset:45056
    buffer_load_dwordx4 v4, s[8:11], s66 offen offset:2048 lds
    v_mfma_f32_16x16x32_bf16 v[148:151], v[56:59], a[132:135], v[148:151]
    v_mfma_f32_16x16x32_bf16 v[152:155], v[56:59], a[136:139], v[152:155]
    ds_read_b64_tr_b16 v[96:97], v36 offset:40960
    v_mfma_f32_16x16x32_bf16 v[156:159], v[56:59], a[140:143], v[156:159]
    ds_read_b64_tr_b16 v[98:99], v36 offset:45056
    v_mfma_f32_16x16x32_bf16 v[160:163], v[60:63], a[128:131], v[160:163]
    ds_read_b64_tr_b16 v[100:101], v37 offset:40960
    buffer_load_dwordx4 v5, s[8:11], s66 offen offset:3072 lds
    v_mfma_f32_16x16x32_bf16 v[164:167], v[60:63], a[132:135], v[164:167]
    ds_read_b64_tr_b16 v[102:103], v37 offset:45056
    v_mfma_f32_16x16x32_bf16 v[168:171], v[60:63], a[136:139], v[168:171]
    v_mfma_f32_16x16x32_bf16 v[172:175], v[60:63], a[140:143], v[172:175]
    ds_read_b64_tr_b16 v[104:105], v38 offset:40960
    v_mfma_f32_16x16x32_bf16 v[176:179], v[64:67], a[128:131], v[176:179]
    ds_read_b64_tr_b16 v[106:107], v38 offset:45056
    buffer_load_dwordx4 a[240:243], v6, s[12:15], s67 offen offset:0 sc1
    v_mfma_f32_16x16x32_bf16 v[180:183], v[64:67], a[132:135], v[180:183]
    ds_read_b64_tr_b16 v[108:109], v39 offset:40960
    v_mfma_f32_16x16x32_bf16 v[184:187], v[64:67], a[136:139], v[184:187]
    ds_read_b64_tr_b16 v[110:111], v39 offset:45056
    v_mfma_f32_16x16x32_bf16 v[188:191], v[64:67], a[140:143], v[188:191]
    v_mfma_f32_16x16x32_bf16 v[192:195], v[68:71], a[128:131], v[192:195]
    buffer_load_dwordx4 a[244:247], v6, s[12:15], s67 offen offset:1024 sc1
    v_mfma_f32_16x16x32_bf16 v[196:199], v[68:71], a[132:135], v[196:199]
    v_mfma_f32_16x16x32_bf16 v[200:203], v[68:71], a[136:139], v[200:203]
    v_mfma_f32_16x16x32_bf16 v[204:207], v[68:71], a[140:143], v[204:207]
    v_mfma_f32_16x16x32_bf16 v[208:211], v[72:75], a[128:131], v[208:211]
    buffer_load_dwordx4 a[248:251], v6, s[12:15], s67 offen offset:2048 sc1
    v_mfma_f32_16x16x32_bf16 v[212:215], v[72:75], a[132:135], v[212:215]
    v_mfma_f32_16x16x32_bf16 v[216:219], v[72:75], a[136:139], v[216:219]
    v_mfma_f32_16x16x32_bf16 v[220:223], v[72:75], a[140:143], v[220:223]
    v_mfma_f32_16x16x32_bf16 v[224:227], v[76:79], a[128:131], v[224:227]
    buffer_load_dwordx4 a[252:255], v6, s[12:15], s67 offen offset:3072 sc1
    v_mfma_f32_16x16x32_bf16 v[228:231], v[76:79], a[132:135], v[228:231]
    v_mfma_f32_16x16x32_bf16 v[232:235], v[76:79], a[136:139], v[232:235]
    v_mfma_f32_16x16x32_bf16 v[236:239], v[76:79], a[140:143], v[236:239]
    s_add_u32 s67, s67, 196608
    s_waitcnt vmcnt(32) lgkmcnt(0)
    s_barrier
    v_mfma_f32_16x16x32_bf16 v[112:115], v[80:83], a[144:147], v[112:115]
    ds_read_b64_tr_b16 v[48:49], v40 offset:0
    v_mfma_f32_16x16x32_bf16 v[116:119], v[80:83], a[148:151], v[116:119]
    ds_read_b64_tr_b16 v[50:51], v40 offset:4096
    s_add_u32 m0, s69, 32768
    s_add_u32 s66, s66, 802816
    v_mfma_f32_16x16x32_bf16 v[120:123], v[80:83], a[152:155], v[120:123]
    ds_read_b64_tr_b16 v[52:53], v41 offset:0
    buffer_load_dwordx4 v2, s[8:11], s66 offen offset:0 lds
    v_mfma_f32_16x16x32_bf16 v[124:127], v[80:83], a[156:159], v[124:127]
    ds_read_b64_tr_b16 v[54:55], v41 offset:4096
    v_mfma_f32_16x16x32_bf16 v[128:131], v[84:87], a[144:147], v[128:131]
    buffer_load_dwordx4 v3, s[8:11], s66 offen offset:1024 lds
    v_mfma_f32_16x16x32_bf16 v[132:135], v[84:87], a[148:151], v[132:135]
    ds_read_b64_tr_b16 v[56:57], v42 offset:0
    v_mfma_f32_16x16x32_bf16 v[136:139], v[84:87], a[152:155], v[136:139]
    ds_read_b64_tr_b16 v[58:59], v42 offset:4096
    v_mfma_f32_16x16x32_bf16 v[140:143], v[84:87], a[156:159], v[140:143]
    ds_read_b64_tr_b16 v[60:61], v43 offset:0
    v_mfma_f32_16x16x32_bf16 v[144:147], v[88:91], a[144:147], v[144:147]
    ds_read_b64_tr_b16 v[62:63], v43 offset:4096
    buffer_load_dwordx4 v4, s[8:11], s66 offen offset:2048 lds
    v_mfma_f32_16x16x32_bf16 v[148:151], v[88:91], a[148:151], v[148:151]
    v_mfma_f32_16x16x32_bf16 v[152:155], v[88:91], a[152:155], v[152:155]
    ds_read_b64_tr_b16 v[64:65], v44 offset:0
    v_mfma_f32_16x16x32_bf16 v[156:159], v[88:91], a[156:159], v[156:159]
    ds_read_b64_tr_b16 v[66:67], v44 offset:4096
    v_mfma_f32_16x16x32_bf16 v[160:163], v[92:95], a[144:147], v[160:163]
    ds_read_b64_tr_b16 v[68:69], v45 offset:0
    buffer_load_dwordx4 v5, s[8:11], s66 offen offset:3072 lds
    v_mfma_f32_16x16x32_bf16 v[164:167], v[92:95], a[148:151], v[164:167]
    ds_read_b64_tr_b16 v[70:71], v45 offset:4096
    v_mfma_f32_16x16x32_bf16 v[168:171], v[92:95], a[152:155], v[168:171]
    v_mfma_f32_16x16x32_bf16 v[172:175], v[92:95], a[156:159], v[172:175]
    ds_read_b64_tr_b16 v[72:73], v46 offset:0
    v_mfma_f32_16x16x32_bf16 v[176:179], v[96:99], a[144:147], v[176:179]
    ds_read_b64_tr_b16 v[74:75], v46 offset:4096
    buffer_load_dwordx4 a[128:131], v6, s[12:15], s67 offen offset:0 sc1
    v_mfma_f32_16x16x32_bf16 v[180:183], v[96:99], a[148:151], v[180:183]
    ds_read_b64_tr_b16 v[76:77], v47 offset:0
    v_mfma_f32_16x16x32_bf16 v[184:187], v[96:99], a[152:155], v[184:187]
    ds_read_b64_tr_b16 v[78:79], v47 offset:4096
    v_mfma_f32_16x16x32_bf16 v[188:191], v[96:99], a[156:159], v[188:191]
    v_mfma_f32_16x16x32_bf16 v[192:195], v[100:103], a[144:147], v[192:195]
    buffer_load_dwordx4 a[132:135], v6, s[12:15], s67 offen offset:1024 sc1
    v_mfma_f32_16x16x32_bf16 v[196:199], v[100:103], a[148:151], v[196:199]
    v_mfma_f32_16x16x32_bf16 v[200:203], v[100:103], a[152:155], v[200:203]
    v_mfma_f32_16x16x32_bf16 v[204:207], v[100:103], a[156:159], v[204:207]
    v_mfma_f32_16x16x32_bf16 v[208:211], v[104:107], a[144:147], v[208:211]
    buffer_load_dwordx4 a[136:139], v6, s[12:15], s67 offen offset:2048 sc1
    v_mfma_f32_16x16x32_bf16 v[212:215], v[104:107], a[148:151], v[212:215]
    v_mfma_f32_16x16x32_bf16 v[216:219], v[104:107], a[152:155], v[216:219]
    v_mfma_f32_16x16x32_bf16 v[220:223], v[104:107], a[156:159], v[220:223]
    v_mfma_f32_16x16x32_bf16 v[224:227], v[108:111], a[144:147], v[224:227]
    buffer_load_dwordx4 a[140:143], v6, s[12:15], s67 offen offset:3072 sc1
    v_mfma_f32_16x16x32_bf16 v[228:231], v[108:111], a[148:151], v[228:231]
    v_mfma_f32_16x16x32_bf16 v[232:235], v[108:111], a[152:155], v[232:235]
    v_mfma_f32_16x16x32_bf16 v[236:239], v[108:111], a[156:159], v[236:239]
    s_add_u32 s67, s67, 65536
    s_waitcnt lgkmcnt(0)
    v_mfma_f32_16x16x32_bf16 v[112:115], v[48:51], a[160:163], v[112:115]
    ds_read_b64_tr_b16 v[80:81], v40 offset:8192
    v_mfma_f32_16x16x32_bf16 v[116:119], v[48:51], a[164:167], v[116:119]
    ds_read_b64_tr_b16 v[82:83], v40 offset:12288
    s_add_u32 m0, s69, 36864
    s_add_u32 s66, s66, 114688
    v_mfma_f32_16x16x32_bf16 v[120:123], v[48:51], a[168:171], v[120:123]
    ds_read_b64_tr_b16 v[84:85], v41 offset:8192
    buffer_load_dwordx4 v2, s[8:11], s66 offen offset:0 lds
    v_mfma_f32_16x16x32_bf16 v[124:127], v[48:51], a[172:175], v[124:127]
    ds_read_b64_tr_b16 v[86:87], v41 offset:12288
    v_mfma_f32_16x16x32_bf16 v[128:131], v[52:55], a[160:163], v[128:131]
    buffer_load_dwordx4 v3, s[8:11], s66 offen offset:1024 lds
    v_mfma_f32_16x16x32_bf16 v[132:135], v[52:55], a[164:167], v[132:135]
    ds_read_b64_tr_b16 v[88:89], v42 offset:8192
    v_mfma_f32_16x16x32_bf16 v[136:139], v[52:55], a[168:171], v[136:139]
    ds_read_b64_tr_b16 v[90:91], v42 offset:12288
    v_mfma_f32_16x16x32_bf16 v[140:143], v[52:55], a[172:175], v[140:143]
    ds_read_b64_tr_b16 v[92:93], v43 offset:8192
    v_mfma_f32_16x16x32_bf16 v[144:147], v[56:59], a[160:163], v[144:147]
    ds_read_b64_tr_b16 v[94:95], v43 offset:12288
    buffer_load_dwordx4 v4, s[8:11], s66 offen offset:2048 lds
    v_mfma_f32_16x16x32_bf16 v[148:151], v[56:59], a[164:167], v[148:151]
    v_mfma_f32_16x16x32_bf16 v[152:155], v[56:59], a[168:171], v[152:155]
    ds_read_b64_tr_b16 v[96:97], v44 offset:8192
    v_mfma_f32_16x16x32_bf16 v[156:159], v[56:59], a[172:175], v[156:159]
    ds_read_b64_tr_b16 v[98:99], v44 offset:12288
    v_mfma_f32_16x16x32_bf16 v[160:163], v[60:63], a[160:163], v[160:163]
    ds_read_b64_tr_b16 v[100:101], v45 offset:8192
    buffer_load_dwordx4 v5, s[8:11], s66 offen offset:3072 lds
    v_mfma_f32_16x16x32_bf16 v[164:167], v[60:63], a[164:167], v[164:167]
    ds_read_b64_tr_b16 v[102:103], v45 offset:12288
    v_mfma_f32_16x16x32_bf16 v[168:171], v[60:63], a[168:171], v[168:171]
    v_mfma_f32_16x16x32_bf16 v[172:175], v[60:63], a[172:175], v[172:175]
    ds_read_b64_tr_b16 v[104:105], v46 offset:8192
    v_mfma_f32_16x16x32_bf16 v[176:179], v[64:67], a[160:163], v[176:179]
    ds_read_b64_tr_b16 v[106:107], v46 offset:12288
    buffer_load_dwordx4 a[144:147], v6, s[12:15], s67 offen offset:0 sc1
    v_mfma_f32_16x16x32_bf16 v[180:183], v[64:67], a[164:167], v[180:183]
    ds_read_b64_tr_b16 v[108:109], v47 offset:8192
    v_mfma_f32_16x16x32_bf16 v[184:187], v[64:67], a[168:171], v[184:187]
    ds_read_b64_tr_b16 v[110:111], v47 offset:12288
    v_mfma_f32_16x16x32_bf16 v[188:191], v[64:67], a[172:175], v[188:191]
    v_mfma_f32_16x16x32_bf16 v[192:195], v[68:71], a[160:163], v[192:195]
    buffer_load_dwordx4 a[148:151], v6, s[12:15], s67 offen offset:1024 sc1
    v_mfma_f32_16x16x32_bf16 v[196:199], v[68:71], a[164:167], v[196:199]
    v_mfma_f32_16x16x32_bf16 v[200:203], v[68:71], a[168:171], v[200:203]
    v_mfma_f32_16x16x32_bf16 v[204:207], v[68:71], a[172:175], v[204:207]
    v_mfma_f32_16x16x32_bf16 v[208:211], v[72:75], a[160:163], v[208:211]
    buffer_load_dwordx4 a[152:155], v6, s[12:15], s67 offen offset:2048 sc1
    v_mfma_f32_16x16x32_bf16 v[212:215], v[72:75], a[164:167], v[212:215]
    v_mfma_f32_16x16x32_bf16 v[216:219], v[72:75], a[168:171], v[216:219]
    v_mfma_f32_16x16x32_bf16 v[220:223], v[72:75], a[172:175], v[220:223]
    v_mfma_f32_16x16x32_bf16 v[224:227], v[76:79], a[160:163], v[224:227]
    buffer_load_dwordx4 a[156:159], v6, s[12:15], s67 offen offset:3072 sc1
    v_mfma_f32_16x16x32_bf16 v[228:231], v[76:79], a[164:167], v[228:231]
    v_mfma_f32_16x16x32_bf16 v[232:235], v[76:79], a[168:171], v[232:235]
    v_mfma_f32_16x16x32_bf16 v[236:239], v[76:79], a[172:175], v[236:239]
    s_add_u32 s67, s67, 196608
    s_waitcnt vmcnt(32) lgkmcnt(0)
    s_barrier
    v_mfma_f32_16x16x32_bf16 v[112:115], v[80:83], a[176:179], v[112:115]
    ds_read_b64_tr_b16 v[48:49], v40 offset:32768
    v_mfma_f32_16x16x32_bf16 v[116:119], v[80:83], a[180:183], v[116:119]
    ds_read_b64_tr_b16 v[50:51], v40 offset:36864
    s_add_u32 m0, s69, 98304
    s_add_u32 s66, s66, 802816
    v_mfma_f32_16x16x32_bf16 v[120:123], v[80:83], a[184:187], v[120:123]
    ds_read_b64_tr_b16 v[52:53], v41 offset:32768
    buffer_load_dwordx4 v2, s[8:11], s66 offen offset:0 lds
    v_mfma_f32_16x16x32_bf16 v[124:127], v[80:83], a[188:191], v[124:127]
    ds_read_b64_tr_b16 v[54:55], v41 offset:36864
    v_mfma_f32_16x16x32_bf16 v[128:131], v[84:87], a[176:179], v[128:131]
    buffer_load_dwordx4 v3, s[8:11], s66 offen offset:1024 lds
    v_mfma_f32_16x16x32_bf16 v[132:135], v[84:87], a[180:183], v[132:135]
    ds_read_b64_tr_b16 v[56:57], v42 offset:32768
    v_mfma_f32_16x16x32_bf16 v[136:139], v[84:87], a[184:187], v[136:139]
    ds_read_b64_tr_b16 v[58:59], v42 offset:36864
    v_mfma_f32_16x16x32_bf16 v[140:143], v[84:87], a[188:191], v[140:143]
    ds_read_b64_tr_b16 v[60:61], v43 offset:32768
    v_mfma_f32_16x16x32_bf16 v[144:147], v[88:91], a[176:179], v[144:147]
    ds_read_b64_tr_b16 v[62:63], v43 offset:36864
    buffer_load_dwordx4 v4, s[8:11], s66 offen offset:2048 lds
    v_mfma_f32_16x16x32_bf16 v[148:151], v[88:91], a[180:183], v[148:151]
    v_mfma_f32_16x16x32_bf16 v[152:155], v[88:91], a[184:187], v[152:155]
    ds_read_b64_tr_b16 v[64:65], v44 offset:32768
    v_mfma_f32_16x16x32_bf16 v[156:159], v[88:91], a[188:191], v[156:159]
    ds_read_b64_tr_b16 v[66:67], v44 offset:36864
    v_mfma_f32_16x16x32_bf16 v[160:163], v[92:95], a[176:179], v[160:163]
    ds_read_b64_tr_b16 v[68:69], v45 offset:32768
    buffer_load_dwordx4 v5, s[8:11], s66 offen offset:3072 lds
    v_mfma_f32_16x16x32_bf16 v[164:167], v[92:95], a[180:183], v[164:167]
    ds_read_b64_tr_b16 v[70:71], v45 offset:36864
    v_mfma_f32_16x16x32_bf16 v[168:171], v[92:95], a[184:187], v[168:171]
    v_mfma_f32_16x16x32_bf16 v[172:175], v[92:95], a[188:191], v[172:175]
    ds_read_b64_tr_b16 v[72:73], v46 offset:32768
    v_mfma_f32_16x16x32_bf16 v[176:179], v[96:99], a[176:179], v[176:179]
    ds_read_b64_tr_b16 v[74:75], v46 offset:36864
    buffer_load_dwordx4 a[160:163], v6, s[12:15], s67 offen offset:0 sc1
    v_mfma_f32_16x16x32_bf16 v[180:183], v[96:99], a[180:183], v[180:183]
    ds_read_b64_tr_b16 v[76:77], v47 offset:32768
    v_mfma_f32_16x16x32_bf16 v[184:187], v[96:99], a[184:187], v[184:187]
    ds_read_b64_tr_b16 v[78:79], v47 offset:36864
    v_mfma_f32_16x16x32_bf16 v[188:191], v[96:99], a[188:191], v[188:191]
    v_mfma_f32_16x16x32_bf16 v[192:195], v[100:103], a[176:179], v[192:195]
    buffer_load_dwordx4 a[164:167], v6, s[12:15], s67 offen offset:1024 sc1
    v_mfma_f32_16x16x32_bf16 v[196:199], v[100:103], a[180:183], v[196:199]
    v_mfma_f32_16x16x32_bf16 v[200:203], v[100:103], a[184:187], v[200:203]
    v_mfma_f32_16x16x32_bf16 v[204:207], v[100:103], a[188:191], v[204:207]
    v_mfma_f32_16x16x32_bf16 v[208:211], v[104:107], a[176:179], v[208:211]
    buffer_load_dwordx4 a[168:171], v6, s[12:15], s67 offen offset:2048 sc1
    v_mfma_f32_16x16x32_bf16 v[212:215], v[104:107], a[180:183], v[212:215]
    v_mfma_f32_16x16x32_bf16 v[216:219], v[104:107], a[184:187], v[216:219]
    v_mfma_f32_16x16x32_bf16 v[220:223], v[104:107], a[188:191], v[220:223]
    v_mfma_f32_16x16x32_bf16 v[224:227], v[108:111], a[176:179], v[224:227]
    buffer_load_dwordx4 a[172:175], v6, s[12:15], s67 offen offset:3072 sc1
    v_mfma_f32_16x16x32_bf16 v[228:231], v[108:111], a[180:183], v[228:231]
    v_mfma_f32_16x16x32_bf16 v[232:235], v[108:111], a[184:187], v[232:235]
    v_mfma_f32_16x16x32_bf16 v[236:239], v[108:111], a[188:191], v[236:239]
    s_add_u32 s67, s67, 65536
    s_sub_u32 s70, s70, 1
    s_cmp_eq_u32 s70, 0
    s_waitcnt lgkmcnt(0)
    s_cbranch_scc0 km_su_loop
    v_mfma_f32_16x16x32_bf16 v[112:115], v[48:51], a[192:195], v[112:115]
    ds_read_b64_tr_b16 v[80:81], v40 offset:40960
    s_lshl_b32 s84, s79, 8
    v_mfma_f32_16x16x32_bf16 v[116:119], v[48:51], a[196:199], v[116:119]
    ds_read_b64_tr_b16 v[82:83], v40 offset:45056
    s_add_u32 m0, s69, 102400
    v_mfma_f32_16x16x32_bf16 v[120:123], v[48:51], a[200:203], v[120:123]
    ds_read_b64_tr_b16 v[84:85], v41 offset:40960
    s_add_u32 s66, s66, 114688
    v_mfma_f32_16x16x32_bf16 v[124:127], v[48:51], a[204:207], v[124:127]
    ds_read_b64_tr_b16 v[86:87], v41 offset:45056
    buffer_load_dwordx4 v2, s[8:11], s66 offen offset:0 lds
    v_mfma_f32_16x16x32_bf16 v[128:131], v[52:55], a[192:195], v[128:131]
    buffer_load_dwordx4 v3, s[8:11], s66 offen offset:1024 lds
    buffer_load_dwordx4 v4, s[8:11], s66 offen offset:2048 lds
    v_mfma_f32_16x16x32_bf16 v[132:135], v[52:55], a[196:199], v[132:135]
    ds_read_b64_tr_b16 v[88:89], v42 offset:40960
    v_lshrrev_b32 v246, 4, v1
    v_mfma_f32_16x16x32_bf16 v[136:139], v[52:55], a[200:203], v[136:139]
    ds_read_b64_tr_b16 v[90:91], v42 offset:45056
    buffer_load_dwordx4 v5, s[8:11], s66 offen offset:3072 lds
    v_mfma_f32_16x16x32_bf16 v[140:143], v[52:55], a[204:207], v[140:143]
    ds_read_b64_tr_b16 v[92:93], v43 offset:40960
    v_and_b32 v247, 15, v1
    v_mfma_f32_16x16x32_bf16 v[144:147], v[56:59], a[192:195], v[144:147]
    ds_read_b64_tr_b16 v[94:95], v43 offset:45056
    buffer_load_dwordx4 a[176:179], v6, s[12:15], s67 offen offset:0 sc1
    v_mfma_f32_16x16x32_bf16 v[148:151], v[56:59], a[196:199], v[148:151]
    v_add_u32 v248, 0, v246
    v_lshlrev_b32 v248, 1, v248
    v_mfma_f32_16x16x32_bf16 v[152:155], v[56:59], a[200:203], v[152:155]
    ds_read_b64_tr_b16 v[96:97], v44 offset:40960
    buffer_load_dwordx4 a[180:183], v6, s[12:15], s67 offen offset:1024 sc1
    v_mfma_f32_16x16x32_bf16 v[156:159], v[56:59], a[204:207], v[156:159]
    ds_read_b64_tr_b16 v[98:99], v44 offset:45056
    v_xor_b32 v248, v248, v247
    v_mfma_f32_16x16x32_bf16 v[160:163], v[60:63], a[192:195], v[160:163]
    ds_read_b64_tr_b16 v[100:101], v45 offset:40960
    buffer_load_dwordx4 a[184:187], v6, s[12:15], s67 offen offset:2048 sc1
    v_mfma_f32_16x16x32_bf16 v[164:167], v[60:63], a[196:199], v[164:167]
    ds_read_b64_tr_b16 v[102:103], v45 offset:45056
    v_lshlrev_b32 v248, 4, v248
    v_mfma_f32_16x16x32_bf16 v[168:171], v[60:63], a[200:203], v[168:171]
    buffer_load_dwordx4 a[188:191], v6, s[12:15], s67 offen offset:3072 sc1
    v_add_u32 v249, 0, v246
    v_mfma_f32_16x16x32_bf16 v[172:175], v[60:63], a[204:207], v[172:175]
    ds_read_b64_tr_b16 v[104:105], v46 offset:40960
    v_mul_u32_u24 v249, 2048, v249
    v_mfma_f32_16x16x32_bf16 v[176:179], v[64:67], a[192:195], v[176:179]
    ds_read_b64_tr_b16 v[106:107], v46 offset:45056
    s_add_u32 s67, s67, 196608
    v_mfma_f32_16x16x32_bf16 v[180:183], v[64:67], a[196:199], v[180:183]
    ds_read_b64_tr_b16 v[108:109], v47 offset:40960
    s_xor_b32 s88, s72, 1
    v_mfma_f32_16x16x32_bf16 v[184:187], v[64:67], a[200:203], v[184:187]
    ds_read_b64_tr_b16 v[110:111], v47 offset:45056
    s_mul_i32 s88, s88, 131072
    v_mfma_f32_16x16x32_bf16 v[188:191], v[64:67], a[204:207], v[188:191]
    s_add_u32 s88, s88, 3932160
    buffer_load_dwordx4 a[0:3], v6, s[12:15], s88 offen offset:0 sc1
    v_mfma_f32_16x16x32_bf16 v[192:195], v[68:71], a[192:195], v[192:195]
    buffer_load_dwordx4 a[4:7], v6, s[12:15], s88 offen offset:1024 sc1
    buffer_load_dwordx4 a[8:11], v6, s[12:15], s88 offen offset:2048 sc1
    v_mfma_f32_16x16x32_bf16 v[196:199], v[68:71], a[196:199], v[196:199]
    v_add3_u32 v24, v248, v249, s84
    v_add_u32 v248, 4, v246
    v_mfma_f32_16x16x32_bf16 v[200:203], v[68:71], a[200:203], v[200:203]
    buffer_load_dwordx4 a[12:15], v6, s[12:15], s88 offen offset:3072 sc1
    v_lshlrev_b32 v248, 1, v248
    v_mfma_f32_16x16x32_bf16 v[204:207], v[68:71], a[204:207], v[204:207]
    v_xor_b32 v248, v248, v247
    v_lshlrev_b32 v248, 4, v248
    v_mfma_f32_16x16x32_bf16 v[208:211], v[72:75], a[192:195], v[208:211]
    s_xor_b32 s88, s72, 1
    s_mul_i32 s88, s88, 131072
    v_mfma_f32_16x16x32_bf16 v[212:215], v[72:75], a[196:199], v[212:215]
    s_add_u32 s88, s88, 3997696
    buffer_load_dwordx4 a[16:19], v6, s[12:15], s88 offen offset:0 sc1
    v_mfma_f32_16x16x32_bf16 v[216:219], v[72:75], a[200:203], v[216:219]
    buffer_load_dwordx4 a[20:23], v6, s[12:15], s88 offen offset:1024 sc1
    v_add_u32 v249, 4, v246
    v_mfma_f32_16x16x32_bf16 v[220:223], v[72:75], a[204:207], v[220:223]
    v_mul_u32_u24 v249, 2048, v249
    v_add3_u32 v25, v248, v249, s84
    v_mfma_f32_16x16x32_bf16 v[224:227], v[76:79], a[192:195], v[224:227]
    buffer_load_dwordx4 a[24:27], v6, s[12:15], s88 offen offset:2048 sc1
    v_subrev_u32 v25, 1024, v25
    v_mfma_f32_16x16x32_bf16 v[228:231], v[76:79], a[196:199], v[228:231]
    v_add_u32 v248, 0, v246
    v_lshlrev_b32 v248, 1, v248
    v_mfma_f32_16x16x32_bf16 v[232:235], v[76:79], a[200:203], v[232:235]
    buffer_load_dwordx4 a[28:31], v6, s[12:15], s88 offen offset:3072 sc1
    v_xor_b32 v248, v248, v247
    v_mfma_f32_16x16x32_bf16 v[236:239], v[76:79], a[204:207], v[236:239]
    v_lshlrev_b32 v248, 4, v248
    v_add_u32 v249, 8, v246
    v_mul_u32_u24 v249, 2048, v249
    v_add3_u32 v26, v248, v249, s84
    v_subrev_u32 v26, 2048, v26
    v_add_u32 v248, 4, v246
    v_lshlrev_b32 v248, 1, v248
    v_xor_b32 v248, v248, v247
    v_lshlrev_b32 v248, 4, v248
    v_add_u32 v249, 12, v246
    v_mul_u32_u24 v249, 2048, v249
    v_add3_u32 v27, v248, v249, s84
    v_subrev_u32 v27, 3072, v27
    s_lshl_b32 s84, s78, 1
    s_add_u32 s84, s84, s73
    s_lshl_b32 s84, s84, 12
    v_add_u32 v20, s84, v7
    s_lshr_b32 s84, s78, 1
    s_lshl_b32 s84, s84, 8
    s_add_u32 s84, s84, 16384
    v_and_b32 v22, 15, v1
    v_lshlrev_b32 v22, 3, v22
    v_add_u32 v22, s84, v22
    v_add_u32 v23, 128, v22
    v_bfe_u32 v246, v20, 7, 3
    v_xor_b32 v246, 3, v246
    v_min_u32 v246, 1, v246
    v_add_u32 v246, -1, v246
    v_and_b32 v246, 0x3fffe80, v246
    v_add_u32 v20, v20, v246
    v_mul_u32_u24 v28, 2048, v0
    s_and_b32 s84, s81, 3
    s_sub_u32 s85, s79, s84
    s_lshl_b32 s85, s85, 8
    s_add_u32 s85, s85, 256
    s_lshr_b32 s3, s81, 2
    s_mul_i32 s3, s3, 3
    s_max_u32 s99, s84, 1
    s_add_u32 s3, s3, s99
    s_sub_u32 s3, s3, 1
    s_cmp_eq_u32 s84, 1
    s_cselect_b32 s3, 99, s3
    s_mul_i32 s99, s3, 524288
    s_add_u32 s99, s99, s85
    s_cmp_lt_u32 s3, 4
    s_cselect_b32 s100, s99, 0x7f000000
    s_lshr_b32 s3, s3, 1
    s_sub_u32 s3, 10, s3
    s_mul_i32 s66, s71, 65536
    s_add_u32 s66, s66, 0xfffc8000
    s_mul_i32 s67, s72, 262144
    s_mov_b32 s8, s48
    s_mov_b32 s9, s49
    s_mov_b32 s10, 0x800000
    s_mov_b32 s11, 0x00020000
    s_add_u32 s12, s64, 0x1000000
    s_addc_u32 s13, s65, 0
    s_mov_b32 s14, 0x5000000
    s_mov_b32 s15, 0x00020000
    s_waitcnt vmcnt(40) lgkmcnt(0)
    s_barrier
    v_mfma_f32_16x16x32_bf16 v[112:115], v[80:83], a[208:211], v[112:115]
    ds_read_b64_tr_b16 v[48:49], v32 offset:0
    v_mfma_f32_16x16x32_bf16 v[116:119], v[80:83], a[212:215], v[116:119]
    ds_read_b64_tr_b16 v[50:51], v32 offset:4096
    buffer_load_dwordx2 v[16:17], v22, s[36:39], 0 offen sc1
    v_mfma_f32_16x16x32_bf16 v[120:123], v[80:83], a[216:219], v[120:123]
    ds_read_b64_tr_b16 v[52:53], v33 offset:0
    v_mfma_f32_16x16x32_bf16 v[124:127], v[80:83], a[220:223], v[124:127]
    ds_read_b64_tr_b16 v[54:55], v33 offset:4096
    v_mfma_f32_16x16x32_bf16 v[128:131], v[84:87], a[208:211], v[128:131]
    v_mfma_f32_16x16x32_bf16 v[132:135], v[84:87], a[212:215], v[132:135]
    ds_read_b64_tr_b16 v[56:57], v34 offset:0
    buffer_load_dword v31, v28, s[8:11], s100 offen
    v_mfma_f32_16x16x32_bf16 v[136:139], v[84:87], a[216:219], v[136:139]
    ds_read_b64_tr_b16 v[58:59], v34 offset:4096
    v_mfma_f32_16x16x32_bf16 v[140:143], v[84:87], a[220:223], v[140:143]
    ds_read_b64_tr_b16 v[60:61], v35 offset:0
    v_mfma_f32_16x16x32_bf16 v[144:147], v[88:91], a[208:211], v[144:147]
    ds_read_b64_tr_b16 v[62:63], v35 offset:4096
    v_mfma_f32_16x16x32_bf16 v[148:151], v[88:91], a[212:215], v[148:151]
    buffer_load_dword v31, v28, s[8:11], s100 offen offset:128
    v_mfma_f32_16x16x32_bf16 v[152:155], v[88:91], a[216:219], v[152:155]
    ds_read_b64_tr_b16 v[64:65], v36 offset:0
    v_mfma_f32_16x16x32_bf16 v[156:159], v[88:91], a[220:223], v[156:159]
    ds_read_b64_tr_b16 v[66:67], v36 offset:4096
    v_mfma_f32_16x16x32_bf16 v[160:163], v[92:95], a[208:211], v[160:163]
    ds_read_b64_tr_b16 v[68:69], v37 offset:0
    v_mfma_f32_16x16x32_bf16 v[164:167], v[92:95], a[212:215], v[164:167]
    ds_read_b64_tr_b16 v[70:71], v37 offset:4096
    v_mfma_f32_16x16x32_bf16 v[168:171], v[92:95], a[216:219], v[168:171]
    s_add_u32 m0, s69, 131072
    s_add_u32 s66, s66, 229376
    buffer_load_dwordx4 v24, s[8:11], s66 offen offset:0 lds
    v_mfma_f32_16x16x32_bf16 v[172:175], v[92:95], a[220:223], v[172:175]
    ds_read_b64_tr_b16 v[72:73], v38 offset:0
    v_mfma_f32_16x16x32_bf16 v[176:179], v[96:99], a[208:211], v[176:179]
    ds_read_b64_tr_b16 v[74:75], v38 offset:4096
    v_mfma_f32_16x16x32_bf16 v[180:183], v[96:99], a[212:215], v[180:183]
    ds_read_b64_tr_b16 v[76:77], v39 offset:0
    v_mfma_f32_16x16x32_bf16 v[184:187], v[96:99], a[216:219], v[184:187]
    ds_read_b64_tr_b16 v[78:79], v39 offset:4096
    buffer_load_dwordx4 v25, s[8:11], s66 offen offset:1024 lds
    v_mfma_f32_16x16x32_bf16 v[188:191], v[96:99], a[220:223], v[188:191]
    v_mfma_f32_16x16x32_bf16 v[192:195], v[100:103], a[208:211], v[192:195]
    v_mfma_f32_16x16x32_bf16 v[196:199], v[100:103], a[212:215], v[196:199]
    v_mfma_f32_16x16x32_bf16 v[200:203], v[100:103], a[216:219], v[200:203]
    v_mfma_f32_16x16x32_bf16 v[204:207], v[100:103], a[220:223], v[204:207]
    buffer_load_dwordx4 v26, s[8:11], s66 offen offset:2048 lds
    v_mfma_f32_16x16x32_bf16 v[208:211], v[104:107], a[208:211], v[208:211]
    v_mfma_f32_16x16x32_bf16 v[212:215], v[104:107], a[212:215], v[212:215]
    v_mfma_f32_16x16x32_bf16 v[216:219], v[104:107], a[216:219], v[216:219]
    v_mfma_f32_16x16x32_bf16 v[220:223], v[104:107], a[220:223], v[220:223]
    buffer_load_dwordx4 v27, s[8:11], s66 offen offset:3072 lds
    v_mfma_f32_16x16x32_bf16 v[224:227], v[108:111], a[208:211], v[224:227]
    v_mfma_f32_16x16x32_bf16 v[228:231], v[108:111], a[212:215], v[228:231]
    v_mfma_f32_16x16x32_bf16 v[232:235], v[108:111], a[216:219], v[232:235]
    v_mfma_f32_16x16x32_bf16 v[236:239], v[108:111], a[220:223], v[236:239]
    s_waitcnt lgkmcnt(0)
    v_mfma_f32_16x16x32_bf16 v[112:115], v[48:51], a[224:227], v[112:115]
    ds_read_b64_tr_b16 v[80:81], v32 offset:8192
    v_and_b32 v246, 15, v1
    v_mfma_f32_16x16x32_bf16 v[116:119], v[48:51], a[228:231], v[116:119]
    ds_read_b64_tr_b16 v[82:83], v32 offset:12288
    s_add_u32 m0, s69, 135168
    v_mfma_f32_16x16x32_bf16 v[120:123], v[48:51], a[232:235], v[120:123]
    ds_read_b64_tr_b16 v[84:85], v33 offset:8192
    s_add_u32 s66, s66, 32768
    v_mfma_f32_16x16x32_bf16 v[124:127], v[48:51], a[236:239], v[124:127]
    ds_read_b64_tr_b16 v[86:87], v33 offset:12288
    buffer_load_dwordx4 v24, s[8:11], s66 offen offset:0 lds
    v_mfma_f32_16x16x32_bf16 v[128:131], v[52:55], a[224:227], v[128:131]
    v_lshlrev_b32 v246, 11, v246
    v_lshrrev_b32 v247, 4, v1
    v_mfma_f32_16x16x32_bf16 v[132:135], v[52:55], a[228:231], v[132:135]
    ds_read_b64_tr_b16 v[88:89], v34 offset:8192
    v_and_b32 v248, 1, v247
    v_mfma_f32_16x16x32_bf16 v[136:139], v[52:55], a[232:235], v[136:139]
    ds_read_b64_tr_b16 v[90:91], v34 offset:12288
    v_lshl_add_u32 v246, v248, 5, v246
    v_mfma_f32_16x16x32_bf16 v[140:143], v[52:55], a[236:239], v[140:143]
    ds_read_b64_tr_b16 v[92:93], v35 offset:8192
    v_lshrrev_b32 v248, 1, v247
    v_mfma_f32_16x16x32_bf16 v[144:147], v[56:59], a[224:227], v[144:147]
    ds_read_b64_tr_b16 v[94:95], v35 offset:12288
    buffer_load_dwordx4 v25, s[8:11], s66 offen offset:1024 lds
    v_mfma_f32_16x16x32_bf16 v[148:151], v[56:59], a[228:231], v[148:151]
    v_lshl_add_u32 v246, v248, 4, v246
    s_lshl_b32 s84, s78, 1
    v_mfma_f32_16x16x32_bf16 v[152:155], v[56:59], a[232:235], v[152:155]
    ds_read_b64_tr_b16 v[96:97], v36 offset:8192
    s_add_u32 s84, s84, s73
    v_mfma_f32_16x16x32_bf16 v[156:159], v[56:59], a[236:239], v[156:159]
    ds_read_b64_tr_b16 v[98:99], v36 offset:12288
    s_lshl_b32 s84, s84, 17
    v_mfma_f32_16x16x32_bf16 v[160:163], v[60:63], a[224:227], v[160:163]
    ds_read_b64_tr_b16 v[100:101], v37 offset:8192
    s_lshl_b32 s85, s79, 1
    v_mfma_f32_16x16x32_bf16 v[164:167], v[60:63], a[228:231], v[164:167]
    ds_read_b64_tr_b16 v[102:103], v37 offset:12288
    s_add_u32 s85, s85, s72
    v_mfma_f32_16x16x32_bf16 v[168:171], v[60:63], a[232:235], v[168:171]
    s_lshl_b32 s85, s85, 7
    s_add_u32 s84, s84, s85
    v_mfma_f32_16x16x32_bf16 v[172:175], v[60:63], a[236:239], v[172:175]
    ds_read_b64_tr_b16 v[104:105], v38 offset:8192
    v_add_u32 v21, s84, v246
    v_mfma_f32_16x16x32_bf16 v[176:179], v[64:67], a[224:227], v[176:179]
    ds_read_b64_tr_b16 v[106:107], v38 offset:12288
    buffer_load_dwordx4 v26, s[8:11], s66 offen offset:2048 lds
    v_mfma_f32_16x16x32_bf16 v[180:183], v[64:67], a[228:231], v[180:183]
    ds_read_b64_tr_b16 v[108:109], v39 offset:8192
    s_mov_b32 s4, 0
    v_mfma_f32_16x16x32_bf16 v[184:187], v[64:67], a[232:235], v[184:187]
    ds_read_b64_tr_b16 v[110:111], v39 offset:12288
    s_mov_b32 s5, 32768
    v_mfma_f32_16x16x32_bf16 v[188:191], v[64:67], a[236:239], v[188:191]
    s_mov_b32 s6, 65536
    s_mov_b32 s7, 98304
    v_mfma_f32_16x16x32_bf16 v[192:195], v[68:71], a[224:227], v[192:195]
    s_mov_b32 s28, s40
    s_mov_b32 s29, s41
    v_mfma_f32_16x16x32_bf16 v[196:199], v[68:71], a[228:231], v[196:199]
    s_mov_b32 s30, 0x400000
    s_mov_b32 s31, 0x00020000
    v_mfma_f32_16x16x32_bf16 v[200:203], v[68:71], a[232:235], v[200:203]
    v_xor_b32 v240, 0x4000, v40
    v_xor_b32 v241, 0x4000, v41
    v_mfma_f32_16x16x32_bf16 v[204:207], v[68:71], a[236:239], v[204:207]
    v_xor_b32 v242, 0x4000, v42
    v_xor_b32 v243, 0x4000, v43
    v_mfma_f32_16x16x32_bf16 v[208:211], v[72:75], a[224:227], v[208:211]
    buffer_load_dwordx4 v27, s[8:11], s66 offen offset:3072 lds
    s_lshl_b32 s85, s71, 14
    v_mfma_f32_16x16x32_bf16 v[212:215], v[72:75], a[228:231], v[212:215]
    s_add_u32 s85, s85, 32768
    v_add_u32 v244, s85, v7
    v_mfma_f32_16x16x32_bf16 v[216:219], v[72:75], a[232:235], v[216:219]
    v_mfma_f32_16x16x32_bf16 v[220:223], v[72:75], a[236:239], v[220:223]
    v_mfma_f32_16x16x32_bf16 v[224:227], v[76:79], a[224:227], v[224:227]
    v_mfma_f32_16x16x32_bf16 v[228:231], v[76:79], a[228:231], v[228:231]
    v_mfma_f32_16x16x32_bf16 v[232:235], v[76:79], a[232:235], v[232:235]
    v_mfma_f32_16x16x32_bf16 v[236:239], v[76:79], a[236:239], v[236:239]
    s_waitcnt vmcnt(10)
    s_mov_b32 s83, 0
km_po_chk:
    v_cmp_ne_u64 vcc, s[50:51], v[16:17]
    s_add_u32 s83, s83, 1
    s_cbranch_vccz km_po_ok
    s_cmp_gt_u32 s83, 0x20000
    s_cbranch_scc1 km_po_ok
    s_sleep 2
    buffer_load_dwordx2 v[16:17], v22, s[36:39], 0 offen sc1
    s_waitcnt vmcnt(0)
    s_branch km_po_chk
km_po_ok:
    s_waitcnt vmcnt(35) lgkmcnt(0)
    s_barrier
    v_mfma_f32_16x16x32_bf16 v[112:115], v[80:83], a[240:243], v[112:115]
    ds_read_b64_tr_b16 v[48:49], v32 offset:32768
    s_xor_b32 s85, s71, 2
    v_mfma_f32_16x16x32_bf16 v[116:119], v[80:83], a[244:247], v[116:119]
    ds_read_b64_tr_b16 v[50:51], v32 offset:36864
    s_add_u32 m0, s69, 0
    v_mfma_f32_16x16x32_bf16 v[120:123], v[80:83], a[248:251], v[120:123]
    ds_read_b64_tr_b16 v[52:53], v33 offset:32768
    s_add_u32 s66, s66, 229376
    v_mfma_f32_16x16x32_bf16 v[124:127], v[80:83], a[252:255], v[124:127]
    ds_read_b64_tr_b16 v[54:55], v33 offset:36864
    buffer_load_dwordx4 v24, s[8:11], s66 offen offset:0 lds
    v_mfma_f32_16x16x32_bf16 v[128:131], v[84:87], a[240:243], v[128:131]
    buffer_load_dwordx4 v25, s[8:11], s66 offen offset:1024 lds
    s_lshl_b32 s85, s85, 14
    v_mfma_f32_16x16x32_bf16 v[132:135], v[84:87], a[244:247], v[132:135]
    ds_read_b64_tr_b16 v[56:57], v34 offset:32768
    s_add_u32 s85, s85, 32768
    v_mfma_f32_16x16x32_bf16 v[136:139], v[84:87], a[248:251], v[136:139]
    ds_read_b64_tr_b16 v[58:59], v34 offset:36864
    buffer_load_dwordx4 v26, s[8:11], s66 offen offset:2048 lds
    v_mfma_f32_16x16x32_bf16 v[140:143], v[84:87], a[252:255], v[140:143]
    ds_read_b64_tr_b16 v[60:61], v35 offset:32768
    v_add_u32 v245, s85, v7
    v_mfma_f32_16x16x32_bf16 v[144:147], v[88:91], a[240:243], v[144:147]
    ds_read_b64_tr_b16 v[62:63], v35 offset:36864
    buffer_load_dwordx4 v27, s[8:11], s66 offen offset:3072 lds
    v_mfma_f32_16x16x32_bf16 v[148:151], v[88:91], a[244:247], v[148:151]
    v_mfma_f32_16x16x32_bf16 v[152:155], v[88:91], a[248:251], v[152:155]
    ds_read_b64_tr_b16 v[64:65], v36 offset:32768
    v_mfma_f32_16x16x32_bf16 v[156:159], v[88:91], a[252:255], v[156:159]
    ds_read_b64_tr_b16 v[66:67], v36 offset:36864
    buffer_load_dwordx4 a[192:195], v20, s[12:15], s67 offen offset:0 sc1
    v_mfma_f32_16x16x32_bf16 v[160:163], v[92:95], a[240:243], v[160:163]
    ds_read_b64_tr_b16 v[68:69], v37 offset:32768
    v_mfma_f32_16x16x32_bf16 v[164:167], v[92:95], a[244:247], v[164:167]
    ds_read_b64_tr_b16 v[70:71], v37 offset:36864
    buffer_load_dwordx4 a[196:199], v20, s[12:15], s67 offen offset:1024 sc1
    v_mfma_f32_16x16x32_bf16 v[168:171], v[92:95], a[248:251], v[168:171]
    v_mfma_f32_16x16x32_bf16 v[172:175], v[92:95], a[252:255], v[172:175]
    ds_read_b64_tr_b16 v[72:73], v38 offset:32768
    v_mfma_f32_16x16x32_bf16 v[176:179], v[96:99], a[240:243], v[176:179]
    ds_read_b64_tr_b16 v[74:75], v38 offset:36864
    buffer_load_dwordx4 a[200:203], v20, s[12:15], s67 offen offset:2048 sc1
    v_mfma_f32_16x16x32_bf16 v[180:183], v[96:99], a[244:247], v[180:183]
    ds_read_b64_tr_b16 v[76:77], v39 offset:32768
    v_mfma_f32_16x16x32_bf16 v[184:187], v[96:99], a[248:251], v[184:187]
    ds_read_b64_tr_b16 v[78:79], v39 offset:36864
    v_mfma_f32_16x16x32_bf16 v[188:191], v[96:99], a[252:255], v[188:191]
    buffer_load_dwordx4 a[204:207], v20, s[12:15], s67 offen offset:3072 sc1
    v_mfma_f32_16x16x32_bf16 v[192:195], v[100:103], a[240:243], v[192:195]
    v_mfma_f32_16x16x32_bf16 v[196:199], v[100:103], a[244:247], v[196:199]
    s_add_u32 s67, s67, 131072
    buffer_load_dwordx4 a[208:211], v20, s[12:15], s67 offen offset:0 sc1
    v_mfma_f32_16x16x32_bf16 v[200:203], v[100:103], a[248:251], v[200:203]
    v_mfma_f32_16x16x32_bf16 v[204:207], v[100:103], a[252:255], v[204:207]
    v_mfma_f32_16x16x32_bf16 v[208:211], v[104:107], a[240:243], v[208:211]
    buffer_load_dwordx4 a[212:215], v20, s[12:15], s67 offen offset:1024 sc1
    v_mfma_f32_16x16x32_bf16 v[212:215], v[104:107], a[244:247], v[212:215]
    v_mfma_f32_16x16x32_bf16 v[216:219], v[104:107], a[248:251], v[216:219]
    buffer_load_dwordx4 a[216:219], v20, s[12:15], s67 offen offset:2048 sc1
    v_mfma_f32_16x16x32_bf16 v[220:223], v[104:107], a[252:255], v[220:223]
    v_mfma_f32_16x16x32_bf16 v[224:227], v[108:111], a[240:243], v[224:227]
    v_mfma_f32_16x16x32_bf16 v[228:231], v[108:111], a[244:247], v[228:231]
    buffer_load_dwordx4 a[220:223], v20, s[12:15], s67 offen offset:3072 sc1
    v_mfma_f32_16x16x32_bf16 v[232:235], v[108:111], a[248:251], v[232:235]
    v_mfma_f32_16x16x32_bf16 v[236:239], v[108:111], a[252:255], v[236:239]
    s_add_u32 s67, s67, 393216
    s_waitcnt lgkmcnt(0)
    v_mfma_f32_16x16x32_bf16 v[112:115], v[48:51], a[128:131], v[112:115]
    ds_read_b64_tr_b16 v[80:81], v32 offset:40960
    v_mfma_f32_16x16x32_bf16 v[116:119], v[48:51], a[132:135], v[116:119]
    ds_read_b64_tr_b16 v[82:83], v32 offset:45056
    s_add_u32 m0, s69, 4096
    s_add_u32 s66, s66, 32768
    v_mfma_f32_16x16x32_bf16 v[120:123], v[48:51], a[136:139], v[120:123]
    ds_read_b64_tr_b16 v[84:85], v33 offset:40960
    buffer_load_dwordx4 v24, s[8:11], s66 offen offset:0 lds
    v_mfma_f32_16x16x32_bf16 v[124:127], v[48:51], a[140:143], v[124:127]
    ds_read_b64_tr_b16 v[86:87], v33 offset:45056
    v_mfma_f32_16x16x32_bf16 v[128:131], v[52:55], a[128:131], v[128:131]
    buffer_load_dwordx4 v25, s[8:11], s66 offen offset:1024 lds
    v_mfma_f32_16x16x32_bf16 v[132:135], v[52:55], a[132:135], v[132:135]
    ds_read_b64_tr_b16 v[88:89], v34 offset:40960
    v_mfma_f32_16x16x32_bf16 v[136:139], v[52:55], a[136:139], v[136:139]
    ds_read_b64_tr_b16 v[90:91], v34 offset:45056
    v_mfma_f32_16x16x32_bf16 v[140:143], v[52:55], a[140:143], v[140:143]
    ds_read_b64_tr_b16 v[92:93], v35 offset:40960
    v_mfma_f32_16x16x32_bf16 v[144:147], v[56:59], a[128:131], v[144:147]
    ds_read_b64_tr_b16 v[94:95], v35 offset:45056
    buffer_load_dwordx4 v26, s[8:11], s66 offen offset:2048 lds
    v_mfma_f32_16x16x32_bf16 v[148:151], v[56:59], a[132:135], v[148:151]
    v_mfma_f32_16x16x32_bf16 v[152:155], v[56:59], a[136:139], v[152:155]
    ds_read_b64_tr_b16 v[96:97], v36 offset:40960
    v_mfma_f32_16x16x32_bf16 v[156:159], v[56:59], a[140:143], v[156:159]
    ds_read_b64_tr_b16 v[98:99], v36 offset:45056
    v_mfma_f32_16x16x32_bf16 v[160:163], v[60:63], a[128:131], v[160:163]
    ds_read_b64_tr_b16 v[100:101], v37 offset:40960
    buffer_load_dwordx4 v27, s[8:11], s66 offen offset:3072 lds
    v_mfma_f32_16x16x32_bf16 v[164:167], v[60:63], a[132:135], v[164:167]
    ds_read_b64_tr_b16 v[102:103], v37 offset:45056
    v_mfma_f32_16x16x32_bf16 v[168:171], v[60:63], a[136:139], v[168:171]
    v_mfma_f32_16x16x32_bf16 v[172:175], v[60:63], a[140:143], v[172:175]
    ds_read_b64_tr_b16 v[104:105], v38 offset:40960
    v_mfma_f32_16x16x32_bf16 v[176:179], v[64:67], a[128:131], v[176:179]
    ds_read_b64_tr_b16 v[106:107], v38 offset:45056
    buffer_load_dwordx4 a[224:227], v20, s[12:15], s67 offen offset:0 sc1
    v_mfma_f32_16x16x32_bf16 v[180:183], v[64:67], a[132:135], v[180:183]
    ds_read_b64_tr_b16 v[108:109], v39 offset:40960
    v_mfma_f32_16x16x32_bf16 v[184:187], v[64:67], a[136:139], v[184:187]
    ds_read_b64_tr_b16 v[110:111], v39 offset:45056
    v_mfma_f32_16x16x32_bf16 v[188:191], v[64:67], a[140:143], v[188:191]
    v_mfma_f32_16x16x32_bf16 v[192:195], v[68:71], a[128:131], v[192:195]
    buffer_load_dwordx4 a[228:231], v20, s[12:15], s67 offen offset:1024 sc1
    v_mfma_f32_16x16x32_bf16 v[196:199], v[68:71], a[132:135], v[196:199]
    v_mfma_f32_16x16x32_bf16 v[200:203], v[68:71], a[136:139], v[200:203]
    v_mfma_f32_16x16x32_bf16 v[204:207], v[68:71], a[140:143], v[204:207]
    v_mfma_f32_16x16x32_bf16 v[208:211], v[72:75], a[128:131], v[208:211]
    buffer_load_dwordx4 a[232:235], v20, s[12:15], s67 offen offset:2048 sc1
    v_mfma_f32_16x16x32_bf16 v[212:215], v[72:75], a[132:135], v[212:215]
    v_mfma_f32_16x16x32_bf16 v[216:219], v[72:75], a[136:139], v[216:219]
    v_mfma_f32_16x16x32_bf16 v[220:223], v[72:75], a[140:143], v[220:223]
    v_mfma_f32_16x16x32_bf16 v[224:227], v[76:79], a[128:131], v[224:227]
    buffer_load_dwordx4 a[236:239], v20, s[12:15], s67 offen offset:3072 sc1
    v_mfma_f32_16x16x32_bf16 v[228:231], v[76:79], a[132:135], v[228:231]
    v_mfma_f32_16x16x32_bf16 v[232:235], v[76:79], a[136:139], v[232:235]
    v_mfma_f32_16x16x32_bf16 v[236:239], v[76:79], a[140:143], v[236:239]
    s_add_u32 s67, s67, 131072
    s_waitcnt vmcnt(39) lgkmcnt(0)
    s_barrier
    v_mfma_f32_16x16x32_bf16 v[112:115], v[80:83], a[144:147], v[112:115]
    ds_read_b64_tr_b16 v[48:49], v40 offset:0
    v_mfma_f32_16x16x32_bf16 v[116:119], v[80:83], a[148:151], v[116:119]
    ds_read_b64_tr_b16 v[50:51], v40 offset:4096
    buffer_load_dwordx4 a[240:243], v20, s[12:15], s67 offen offset:0 sc1
    v_mfma_f32_16x16x32_bf16 v[120:123], v[80:83], a[152:155], v[120:123]
    ds_read_b64_tr_b16 v[52:53], v41 offset:0
    v_mfma_f32_16x16x32_bf16 v[124:127], v[80:83], a[156:159], v[124:127]
    ds_read_b64_tr_b16 v[54:55], v41 offset:4096
    v_mfma_f32_16x16x32_bf16 v[128:131], v[84:87], a[144:147], v[128:131]
    buffer_load_dwordx4 a[244:247], v20, s[12:15], s67 offen offset:1024 sc1
    v_mfma_f32_16x16x32_bf16 v[132:135], v[84:87], a[148:151], v[132:135]
    ds_read_b64_tr_b16 v[56:57], v42 offset:0
    v_mfma_f32_16x16x32_bf16 v[136:139], v[84:87], a[152:155], v[136:139]
    ds_read_b64_tr_b16 v[58:59], v42 offset:4096
    v_mfma_f32_16x16x32_bf16 v[140:143], v[84:87], a[156:159], v[140:143]
    ds_read_b64_tr_b16 v[60:61], v43 offset:0
    v_mfma_f32_16x16x32_bf16 v[144:147], v[88:91], a[144:147], v[144:147]
    ds_read_b64_tr_b16 v[62:63], v43 offset:4096
    buffer_load_dwordx4 a[248:251], v20, s[12:15], s67 offen offset:2048 sc1
    v_mfma_f32_16x16x32_bf16 v[148:151], v[88:91], a[148:151], v[148:151]
    v_mfma_f32_16x16x32_bf16 v[152:155], v[88:91], a[152:155], v[152:155]
    ds_read_b64_tr_b16 v[64:65], v40 offset:8192
    v_mfma_f32_16x16x32_bf16 v[156:159], v[88:91], a[156:159], v[156:159]
    ds_read_b64_tr_b16 v[66:67], v40 offset:12288
    v_mfma_f32_16x16x32_bf16 v[160:163], v[92:95], a[144:147], v[160:163]
    ds_read_b64_tr_b16 v[68:69], v41 offset:8192
    buffer_load_dwordx4 a[252:255], v20, s[12:15], s67 offen offset:3072 sc1
    v_mfma_f32_16x16x32_bf16 v[164:167], v[92:95], a[148:151], v[164:167]
    ds_read_b64_tr_b16 v[70:71], v41 offset:12288
    v_mfma_f32_16x16x32_bf16 v[168:171], v[92:95], a[152:155], v[168:171]
    v_mfma_f32_16x16x32_bf16 v[172:175], v[92:95], a[156:159], v[172:175]
    ds_read_b64_tr_b16 v[72:73], v42 offset:8192
    v_mfma_f32_16x16x32_bf16 v[176:179], v[96:99], a[144:147], v[176:179]
    ds_read_b64_tr_b16 v[74:75], v42 offset:12288
    s_add_u32 s67, s67, 393216
    buffer_load_dwordx4 a[128:131], v20, s[12:15], s67 offen offset:0 sc1
    v_mfma_f32_16x16x32_bf16 v[180:183], v[96:99], a[148:151], v[180:183]
    ds_read_b64_tr_b16 v[76:77], v43 offset:8192
    v_mfma_f32_16x16x32_bf16 v[184:187], v[96:99], a[152:155], v[184:187]
    ds_read_b64_tr_b16 v[78:79], v43 offset:12288
    v_mfma_f32_16x16x32_bf16 v[188:191], v[96:99], a[156:159], v[188:191]
    v_mfma_f32_16x16x32_bf16 v[192:195], v[100:103], a[144:147], v[192:195]
    buffer_load_dwordx4 a[132:135], v20, s[12:15], s67 offen offset:1024 sc1
    v_mfma_f32_16x16x32_bf16 v[196:199], v[100:103], a[148:151], v[196:199]
    v_mfma_f32_16x16x32_bf16 v[200:203], v[100:103], a[152:155], v[200:203]
    v_mfma_f32_16x16x32_bf16 v[204:207], v[100:103], a[156:159], v[204:207]
    v_mfma_f32_16x16x32_bf16 v[208:211], v[104:107], a[144:147], v[208:211]
    buffer_load_dwordx4 a[136:139], v20, s[12:15], s67 offen offset:2048 sc1
    v_mfma_f32_16x16x32_bf16 v[212:215], v[104:107], a[148:151], v[212:215]
    v_mfma_f32_16x16x32_bf16 v[216:219], v[104:107], a[152:155], v[216:219]
    v_mfma_f32_16x16x32_bf16 v[220:223], v[104:107], a[156:159], v[220:223]
    v_mfma_f32_16x16x32_bf16 v[224:227], v[108:111], a[144:147], v[224:227]
    buffer_load_dwordx4 a[140:143], v20, s[12:15], s67 offen offset:3072 sc1
    v_mfma_f32_16x16x32_bf16 v[228:231], v[108:111], a[148:151], v[228:231]
    v_mfma_f32_16x16x32_bf16 v[232:235], v[108:111], a[152:155], v[232:235]
    v_mfma_f32_16x16x32_bf16 v[236:239], v[108:111], a[156:159], v[236:239]
    s_add_u32 s67, s67, 131072
    s_waitcnt lgkmcnt(0)
    v_mfma_f32_16x16x32_bf16 v[112:115], v[48:51], a[160:163], v[112:115]
    ds_read_b64_tr_b16 v[80:81], v240 offset:0
    v_mfma_f32_16x16x32_bf16 v[116:119], v[48:51], a[164:167], v[116:119]
    ds_write_b128 v244, v[176:179] offset:0
    ds_read_b64_tr_b16 v[82:83], v240 offset:4096
    buffer_load_dwordx4 a[144:147], v20, s[12:15], s67 offen offset:0 sc1
    v_mfma_f32_16x16x32_bf16 v[120:123], v[48:51], a[168:171], v[120:123]
    ds_write_b128 v244, v[180:183] offset:1024
    v_mfma_f32_16x16x32_bf16 v[124:127], v[48:51], a[172:175], v[124:127]
    ds_write_b128 v244, v[184:187] offset:2048
    ds_read_b64_tr_b16 v[84:85], v241 offset:0
    v_mfma_f32_16x16x32_bf16 v[128:131], v[52:55], a[160:163], v[128:131]
    ds_read_b64_tr_b16 v[86:87], v241 offset:4096
    v_mfma_f32_16x16x32_bf16 v[132:135], v[52:55], a[164:167], v[132:135]
    ds_write_b128 v244, v[188:191] offset:3072
    v_mfma_f32_16x16x32_bf16 v[136:139], v[52:55], a[168:171], v[136:139]
    ds_write_b128 v244, v[192:195] offset:4096
    ds_read_b64_tr_b16 v[88:89], v242 offset:0
    v_mfma_f32_16x16x32_bf16 v[140:143], v[52:55], a[172:175], v[140:143]
    ds_read_b64_tr_b16 v[90:91], v242 offset:4096
    v_mfma_f32_16x16x32_bf16 v[144:147], v[56:59], a[160:163], v[144:147]
    ds_write_b128 v244, v[196:199] offset:5120
    buffer_load_dwordx4 a[148:151], v20, s[12:15], s67 offen offset:1024 sc1
    v_mfma_f32_16x16x32_bf16 v[148:151], v[56:59], a[164:167], v[148:151]
    ds_write_b128 v244, v[200:203] offset:6144
    ds_read_b64_tr_b16 v[92:93], v243 offset:0
    v_mfma_f32_16x16x32_bf16 v[152:155], v[56:59], a[168:171], v[152:155]
    ds_read_b64_tr_b16 v[94:95], v243 offset:4096
    v_mfma_f32_16x16x32_bf16 v[156:159], v[56:59], a[172:175], v[156:159]
    ds_write_b128 v244, v[204:207] offset:7168
    v_mfma_f32_16x16x32_bf16 v[160:163], v[60:63], a[160:163], v[160:163]
    ds_write_b128 v244, v[208:211] offset:8192
    ds_read_b64_tr_b16 v[96:97], v240 offset:8192
    v_mfma_f32_16x16x32_bf16 v[164:167], v[60:63], a[164:167], v[164:167]
    ds_write_b128 v244, v[212:215] offset:9216
    ds_read_b64_tr_b16 v[98:99], v240 offset:12288
    v_mfma_f32_16x16x32_bf16 v[168:171], v[60:63], a[168:171], v[168:171]
    v_mfma_f32_16x16x32_bf16 v[172:175], v[60:63], a[172:175], v[172:175]
    ds_write_b128 v244, v[216:219] offset:10240
    ds_read_b64_tr_b16 v[100:101], v241 offset:8192
    v_mfma_f32_16x16x32_bf16 v[112:115], v[64:67], a[176:179], v[112:115]
    ds_write_b128 v244, v[220:223] offset:11264
    ds_read_b64_tr_b16 v[102:103], v241 offset:12288
    buffer_load_dwordx4 a[152:155], v20, s[12:15], s67 offen offset:2048 sc1
    v_mfma_f32_16x16x32_bf16 v[116:119], v[64:67], a[180:183], v[116:119]
    v_mfma_f32_16x16x32_bf16 v[120:123], v[64:67], a[184:187], v[120:123]
    ds_write_b128 v244, v[224:227] offset:12288
    ds_read_b64_tr_b16 v[104:105], v242 offset:8192
    v_mfma_f32_16x16x32_bf16 v[124:127], v[64:67], a[188:191], v[124:127]
    ds_write_b128 v244, v[228:231] offset:13312
    ds_read_b64_tr_b16 v[106:107], v242 offset:12288
    v_mfma_f32_16x16x32_bf16 v[128:131], v[68:71], a[176:179], v[128:131]
    v_mfma_f32_16x16x32_bf16 v[132:135], v[68:71], a[180:183], v[132:135]
    ds_write_b128 v244, v[232:235] offset:14336
    ds_read_b64_tr_b16 v[108:109], v243 offset:8192
    v_mfma_f32_16x16x32_bf16 v[136:139], v[68:71], a[184:187], v[136:139]
    ds_write_b128 v244, v[236:239] offset:15360
    ds_read_b64_tr_b16 v[110:111], v243 offset:12288
    v_mfma_f32_16x16x32_bf16 v[140:143], v[68:71], a[188:191], v[140:143]
    v_mfma_f32_16x16x32_bf16 v[144:147], v[72:75], a[176:179], v[144:147]
    buffer_load_dwordx4 a[156:159], v20, s[12:15], s67 offen offset:3072 sc1
    v_mfma_f32_16x16x32_bf16 v[148:151], v[72:75], a[180:183], v[148:151]
    v_mfma_f32_16x16x32_bf16 v[152:155], v[72:75], a[184:187], v[152:155]
    v_mfma_f32_16x16x32_bf16 v[156:159], v[72:75], a[188:191], v[156:159]
    v_mfma_f32_16x16x32_bf16 v[160:163], v[76:79], a[176:179], v[160:163]
    v_mfma_f32_16x16x32_bf16 v[164:167], v[76:79], a[180:183], v[164:167]
    v_mfma_f32_16x16x32_bf16 v[168:171], v[76:79], a[184:187], v[168:171]
    v_mfma_f32_16x16x32_bf16 v[172:175], v[76:79], a[188:191], v[172:175]
    s_add_u32 s67, s67, 393216
    s_waitcnt vmcnt(20) lgkmcnt(0)
    s_barrier
    v_mfma_f32_16x16x32_bf16 v[112:115], v[80:83], a[0:3], v[112:115]
    ds_read_b128 v[176:179], v245 offset:0
    v_mfma_f32_16x16x32_bf16 v[116:119], v[80:83], a[4:7], v[116:119]
    ds_read_b128 v[180:183], v245 offset:1024
    buffer_load_dwordx4 a[160:163], v20, s[12:15], s67 offen offset:0 sc1
    v_mfma_f32_16x16x32_bf16 v[120:123], v[80:83], a[8:11], v[120:123]
    ds_read_b128 v[184:187], v245 offset:2048
    v_mfma_f32_16x16x32_bf16 v[124:127], v[80:83], a[12:15], v[124:127]
    ds_read_b128 v[188:191], v245 offset:3072
    v_mfma_f32_16x16x32_bf16 v[128:131], v[84:87], a[0:3], v[128:131]
    v_mfma_f32_16x16x32_bf16 v[132:135], v[84:87], a[4:7], v[132:135]
    ds_read_b128 v[192:195], v245 offset:4096
    v_mfma_f32_16x16x32_bf16 v[136:139], v[84:87], a[8:11], v[136:139]
    ds_read_b128 v[196:199], v245 offset:5120
    v_mfma_f32_16x16x32_bf16 v[140:143], v[84:87], a[12:15], v[140:143]
    ds_read_b128 v[200:203], v245 offset:6144
    v_mfma_f32_16x16x32_bf16 v[144:147], v[88:91], a[0:3], v[144:147]
    ds_read_b128 v[204:207], v245 offset:7168
    buffer_load_dwordx4 a[164:167], v20, s[12:15], s67 offen offset:1024 sc1
    v_mfma_f32_16x16x32_bf16 v[148:151], v[88:91], a[4:7], v[148:151]
    v_mfma_f32_16x16x32_bf16 v[152:155], v[88:91], a[8:11], v[152:155]
    ds_read_b128 v[208:211], v245 offset:8192
    v_mfma_f32_16x16x32_bf16 v[156:159], v[88:91], a[12:15], v[156:159]
    ds_read_b128 v[212:215], v245 offset:9216
    v_mfma_f32_16x16x32_bf16 v[160:163], v[92:95], a[0:3], v[160:163]
    ds_read_b128 v[216:219], v245 offset:10240
    v_mfma_f32_16x16x32_bf16 v[164:167], v[92:95], a[4:7], v[164:167]
    ds_read_b128 v[220:223], v245 offset:11264
    v_mfma_f32_16x16x32_bf16 v[168:171], v[92:95], a[8:11], v[168:171]
    v_mfma_f32_16x16x32_bf16 v[172:175], v[92:95], a[12:15], v[172:175]
    ds_read_b128 v[224:227], v245 offset:12288
    v_mfma_f32_16x16x32_bf16 v[112:115], v[96:99], a[16:19], v[112:115]
    ds_read_b128 v[228:231], v245 offset:13312
    buffer_load_dwordx4 a[168:171], v20, s[12:15], s67 offen offset:2048 sc1
    v_mfma_f32_16x16x32_bf16 v[116:119], v[96:99], a[20:23], v[116:119]
    ds_read_b128 v[232:235], v245 offset:14336
    v_mfma_f32_16x16x32_bf16 v[120:123], v[96:99], a[24:27], v[120:123]
    ds_read_b128 v[236:239], v245 offset:15360
    v_mfma_f32_16x16x32_bf16 v[124:127], v[96:99], a[28:31], v[124:127]
    v_mfma_f32_16x16x32_bf16 v[128:131], v[100:103], a[16:19], v[128:131]
    v_mfma_f32_16x16x32_bf16 v[132:135], v[100:103], a[20:23], v[132:135]
    v_mfma_f32_16x16x32_bf16 v[136:139], v[100:103], a[24:27], v[136:139]
    v_mfma_f32_16x16x32_bf16 v[140:143], v[100:103], a[28:31], v[140:143]
    v_mfma_f32_16x16x32_bf16 v[144:147], v[104:107], a[16:19], v[144:147]
    buffer_load_dwordx4 a[172:175], v20, s[12:15], s67 offen offset:3072 sc1
    v_mfma_f32_16x16x32_bf16 v[148:151], v[104:107], a[20:23], v[148:151]
    v_mfma_f32_16x16x32_bf16 v[152:155], v[104:107], a[24:27], v[152:155]
    v_mfma_f32_16x16x32_bf16 v[156:159], v[104:107], a[28:31], v[156:159]
    v_mfma_f32_16x16x32_bf16 v[160:163], v[108:111], a[16:19], v[160:163]
    v_mfma_f32_16x16x32_bf16 v[164:167], v[108:111], a[20:23], v[164:167]
    v_mfma_f32_16x16x32_bf16 v[168:171], v[108:111], a[24:27], v[168:171]
    v_mfma_f32_16x16x32_bf16 v[172:175], v[108:111], a[28:31], v[172:175]
    s_add_u32 s67, s67, 131072
    s_waitcnt lgkmcnt(0)
    s_barrier
    s_add_u32 m0, s69, 32768
    s_add_u32 s66, s66, 229376
    buffer_load_dwordx4 v24, s[8:11], s66 offen offset:0 lds
    buffer_load_dwordx4 v25, s[8:11], s66 offen offset:1024 lds
    buffer_load_dwordx4 v26, s[8:11], s66 offen offset:2048 lds
    buffer_load_dwordx4 v27, s[8:11], s66 offen offset:3072 lds
    s_add_u32 m0, s69, 36864
    s_add_u32 s66, s66, 32768
    buffer_load_dwordx4 v24, s[8:11], s66 offen offset:0 lds
    buffer_load_dwordx4 v25, s[8:11], s66 offen offset:1024 lds
    buffer_load_dwordx4 v26, s[8:11], s66 offen offset:2048 lds
    buffer_load_dwordx4 v27, s[8:11], s66 offen offset:3072 lds
    s_add_u32 m0, s69, 98304
    s_add_u32 s66, s66, 229376
    buffer_load_dwordx4 v24, s[8:11], s66 offen offset:0 lds
    buffer_load_dwordx4 v25, s[8:11], s66 offen offset:1024 lds
    buffer_load_dwordx4 v26, s[8:11], s66 offen offset:2048 lds
    buffer_load_dwordx4 v27, s[8:11], s66 offen offset:3072 lds
    v_accvgpr_write_b32 a0, 0
    v_accvgpr_write_b32 a1, 0
    v_accvgpr_write_b32 a2, 0
    v_accvgpr_write_b32 a3, 0
    v_accvgpr_write_b32 a4, 0
    v_accvgpr_write_b32 a5, 0
    v_accvgpr_write_b32 a6, 0
    v_accvgpr_write_b32 a7, 0
    v_accvgpr_write_b32 a8, 0
    v_accvgpr_write_b32 a9, 0
    v_accvgpr_write_b32 a10, 0
    v_accvgpr_write_b32 a11, 0
    v_accvgpr_write_b32 a12, 0
    v_accvgpr_write_b32 a13, 0
    v_accvgpr_write_b32 a14, 0
    v_accvgpr_write_b32 a15, 0
    v_accvgpr_write_b32 a16, 0
    v_accvgpr_write_b32 a17, 0
    v_accvgpr_write_b32 a18, 0
    v_accvgpr_write_b32 a19, 0
    v_accvgpr_write_b32 a20, 0
    v_accvgpr_write_b32 a21, 0
    v_accvgpr_write_b32 a22, 0
    v_accvgpr_write_b32 a23, 0
    v_accvgpr_write_b32 a24, 0
    v_accvgpr_write_b32 a25, 0
    v_accvgpr_write_b32 a26, 0
    v_accvgpr_write_b32 a27, 0
    v_accvgpr_write_b32 a28, 0
    v_accvgpr_write_b32 a29, 0
    v_accvgpr_write_b32 a30, 0
    v_accvgpr_write_b32 a31, 0
    s_add_u32 s32, s64, 0x800000
    s_addc_u32 s33, s65, 0
    s_mov_b32 s34, 0x4700000
    s_mov_b32 s35, 0x00020000
    s_lshl_b32 s84, s76, 1
    s_add_u32 s84, s84, s72
    s_lshl_b32 s84, s84, 17
    s_lshl_b32 s85, s77, 1
    s_add_u32 s85, s85, s73
    s_lshl_b32 s85, s85, 12
    s_add_u32 s84, s84, s85
    s_add_u32 s85, s84, 65536
    s_mov_b32 s86, 0xbdd2d3e8
    s_mov_b32 s87, 0xbdd2d3e8
    v_mov_b32 v88, 0xc0135761
    v_mov_b32 v89, 0xc0135761
    v_mov_b32 v90, 1.0
    v_mov_b32 v91, 1.0
    v_bfe_u32 v109, v7, 7, 3
    v_xor_b32 v109, 3, v109
    v_min_u32 v109, 1, v109
    v_add_u32 v109, -1, v109
    v_and_b32 v109, 0x3fffe80, v109
    v_add_u32 v108, v7, v109
    v_lshlrev_b32 v64, 16, v8
    v_and_b32 v65, 0xffff0000, v8
    v_lshlrev_b32 v66, 16, v9
    v_and_b32 v67, 0xffff0000, v9
    v_lshlrev_b32 v68, 16, v10
    v_and_b32 v69, 0xffff0000, v10
    v_lshlrev_b32 v70, 16, v11
    v_and_b32 v71, 0xffff0000, v11
    v_lshlrev_b32 v72, 16, v12
    v_and_b32 v73, 0xffff0000, v12
    v_lshlrev_b32 v74, 16, v13
    v_and_b32 v75, 0xffff0000, v13
    v_lshlrev_b32 v76, 16, v14
    v_and_b32 v77, 0xffff0000, v14
    v_lshlrev_b32 v78, 16, v15
    v_and_b32 v79, 0xffff0000, v15
    v_pk_add_f32 v[112:113], v[112:113], v[64:65]
    v_pk_add_f32 v[114:115], v[114:115], v[66:67]
    v_pk_add_f32 v[116:117], v[116:117], v[64:65]
    v_pk_add_f32 v[118:119], v[118:119], v[66:67]
    v_pk_add_f32 v[120:121], v[120:121], v[64:65]
    v_pk_add_f32 v[122:123], v[122:123], v[66:67]
    v_pk_add_f32 v[124:125], v[124:125], v[64:65]
    v_pk_add_f32 v[126:127], v[126:127], v[66:67]
    v_pk_add_f32 v[128:129], v[128:129], v[68:69]
    v_pk_add_f32 v[130:131], v[130:131], v[70:71]
    v_pk_add_f32 v[132:133], v[132:133], v[68:69]
    v_pk_add_f32 v[134:135], v[134:135], v[70:71]
    v_pk_add_f32 v[136:137], v[136:137], v[68:69]
    v_pk_add_f32 v[138:139], v[138:139], v[70:71]
    v_pk_add_f32 v[140:141], v[140:141], v[68:69]
    v_pk_add_f32 v[142:143], v[142:143], v[70:71]
    v_pk_add_f32 v[144:145], v[144:145], v[72:73]
    v_pk_add_f32 v[146:147], v[146:147], v[74:75]
    v_pk_add_f32 v[148:149], v[148:149], v[72:73]
    v_pk_add_f32 v[150:151], v[150:151], v[74:75]
    v_pk_add_f32 v[152:153], v[152:153], v[72:73]
    v_pk_add_f32 v[154:155], v[154:155], v[74:75]
    v_pk_add_f32 v[156:157], v[156:157], v[72:73]
    v_pk_add_f32 v[158:159], v[158:159], v[74:75]
    v_pk_add_f32 v[160:161], v[160:161], v[76:77]
    v_pk_add_f32 v[162:163], v[162:163], v[78:79]
    v_pk_add_f32 v[164:165], v[164:165], v[76:77]
    v_pk_add_f32 v[166:167], v[166:167], v[78:79]
    v_pk_add_f32 v[168:169], v[168:169], v[76:77]
    v_pk_add_f32 v[170:171], v[170:171], v[78:79]
    v_pk_add_f32 v[172:173], v[172:173], v[76:77]
    v_pk_add_f32 v[174:175], v[174:175], v[78:79]
    v_pk_add_f32 v[112:113], v[112:113], v[176:177]
    v_pk_add_f32 v[114:115], v[114:115], v[178:179]
    v_pk_add_f32 v[128:129], v[128:129], v[192:193]
    v_pk_add_f32 v[130:131], v[130:131], v[194:195]
    v_pk_mul_f32 v[48:49], v[112:113], v[112:113]
    v_pk_mul_f32 v[50:51], v[114:115], v[114:115]
    v_pk_mul_f32 v[52:53], v[128:129], v[128:129]
    v_pk_mul_f32 v[54:55], v[130:131], v[130:131]
    v_pk_fma_f32 v[48:49], v[48:49], s[86:87], v[88:89]
    v_pk_fma_f32 v[50:51], v[50:51], s[86:87], v[88:89]
    v_pk_fma_f32 v[52:53], v[52:53], s[86:87], v[88:89]
    v_pk_fma_f32 v[54:55], v[54:55], s[86:87], v[88:89]
    v_pk_mul_f32 v[48:49], v[48:49], v[112:113]
    v_pk_mul_f32 v[50:51], v[50:51], v[114:115]
    v_pk_mul_f32 v[52:53], v[52:53], v[128:129]
    v_pk_mul_f32 v[54:55], v[54:55], v[130:131]
    v_exp_f32 v48, v48
    v_exp_f32 v49, v49
    v_exp_f32 v50, v50
    v_exp_f32 v51, v51
    v_exp_f32 v52, v52
    v_exp_f32 v53, v53
    v_exp_f32 v54, v54
    v_exp_f32 v55, v55
    v_pk_add_f32 v[48:49], v[48:49], v[90:91]
    v_pk_add_f32 v[50:51], v[50:51], v[90:91]
    v_pk_add_f32 v[52:53], v[52:53], v[90:91]
    v_pk_add_f32 v[54:55], v[54:55], v[90:91]
    v_rcp_f32 v48, v48
    v_rcp_f32 v49, v49
    v_rcp_f32 v50, v50
    v_rcp_f32 v51, v51
    v_rcp_f32 v52, v52
    v_rcp_f32 v53, v53
    v_rcp_f32 v54, v54
    v_rcp_f32 v55, v55
    v_pk_mul_f32 v[48:49], v[48:49], v[112:113]
    v_pk_mul_f32 v[50:51], v[50:51], v[114:115]
    v_pk_mul_f32 v[52:53], v[52:53], v[128:129]
    v_pk_mul_f32 v[54:55], v[54:55], v[130:131]
    v_cvt_pk_bf16_f32 v92, v48, v49
    v_cvt_pk_bf16_f32 v93, v50, v51
    v_cvt_pk_bf16_f32 v94, v52, v53
    v_cvt_pk_bf16_f32 v95, v54, v55
    buffer_store_dwordx4 v[92:95], v108, s[32:35], s84 offen offset:0 sc1
    v_pk_add_f32 v[116:117], v[116:117], v[180:181]
    v_pk_add_f32 v[118:119], v[118:119], v[182:183]
    v_pk_add_f32 v[132:133], v[132:133], v[196:197]
    v_pk_add_f32 v[134:135], v[134:135], v[198:199]
    v_pk_mul_f32 v[48:49], v[116:117], v[116:117]
    v_pk_mul_f32 v[50:51], v[118:119], v[118:119]
    v_pk_mul_f32 v[52:53], v[132:133], v[132:133]
    v_pk_mul_f32 v[54:55], v[134:135], v[134:135]
    v_pk_fma_f32 v[48:49], v[48:49], s[86:87], v[88:89]
    v_pk_fma_f32 v[50:51], v[50:51], s[86:87], v[88:89]
    v_pk_fma_f32 v[52:53], v[52:53], s[86:87], v[88:89]
    v_pk_fma_f32 v[54:55], v[54:55], s[86:87], v[88:89]
    v_pk_mul_f32 v[48:49], v[48:49], v[116:117]
    v_pk_mul_f32 v[50:51], v[50:51], v[118:119]
    v_pk_mul_f32 v[52:53], v[52:53], v[132:133]
    v_pk_mul_f32 v[54:55], v[54:55], v[134:135]
    v_exp_f32 v48, v48
    v_exp_f32 v49, v49
    v_exp_f32 v50, v50
    v_exp_f32 v51, v51
    v_exp_f32 v52, v52
    v_exp_f32 v53, v53
    v_exp_f32 v54, v54
    v_exp_f32 v55, v55
    v_pk_add_f32 v[48:49], v[48:49], v[90:91]
    v_pk_add_f32 v[50:51], v[50:51], v[90:91]
    v_pk_add_f32 v[52:53], v[52:53], v[90:91]
    v_pk_add_f32 v[54:55], v[54:55], v[90:91]
    v_rcp_f32 v48, v48
    v_rcp_f32 v49, v49
    v_rcp_f32 v50, v50
    v_rcp_f32 v51, v51
    v_rcp_f32 v52, v52
    v_rcp_f32 v53, v53
    v_rcp_f32 v54, v54
    v_rcp_f32 v55, v55
    v_pk_mul_f32 v[48:49], v[48:49], v[116:117]
    v_pk_mul_f32 v[50:51], v[50:51], v[118:119]
    v_pk_mul_f32 v[52:53], v[52:53], v[132:133]
    v_pk_mul_f32 v[54:55], v[54:55], v[134:135]
    v_cvt_pk_bf16_f32 v96, v48, v49
    v_cvt_pk_bf16_f32 v97, v50, v51
    v_cvt_pk_bf16_f32 v98, v52, v53
    v_cvt_pk_bf16_f32 v99, v54, v55
    buffer_store_dwordx4 v[96:99], v108, s[32:35], s84 offen offset:1024 sc1
    v_pk_add_f32 v[120:121], v[120:121], v[184:185]
    v_pk_add_f32 v[122:123], v[122:123], v[186:187]
    v_pk_add_f32 v[136:137], v[136:137], v[200:201]
    v_pk_add_f32 v[138:139], v[138:139], v[202:203]
    v_pk_mul_f32 v[48:49], v[120:121], v[120:121]
    v_pk_mul_f32 v[50:51], v[122:123], v[122:123]
    v_pk_mul_f32 v[52:53], v[136:137], v[136:137]
    v_pk_mul_f32 v[54:55], v[138:139], v[138:139]
    v_pk_fma_f32 v[48:49], v[48:49], s[86:87], v[88:89]
    v_pk_fma_f32 v[50:51], v[50:51], s[86:87], v[88:89]
    v_pk_fma_f32 v[52:53], v[52:53], s[86:87], v[88:89]
    v_pk_fma_f32 v[54:55], v[54:55], s[86:87], v[88:89]
    v_pk_mul_f32 v[48:49], v[48:49], v[120:121]
    v_pk_mul_f32 v[50:51], v[50:51], v[122:123]
    v_pk_mul_f32 v[52:53], v[52:53], v[136:137]
    v_pk_mul_f32 v[54:55], v[54:55], v[138:139]
    v_exp_f32 v48, v48
    v_exp_f32 v49, v49
    v_exp_f32 v50, v50
    v_exp_f32 v51, v51
    v_exp_f32 v52, v52
    v_exp_f32 v53, v53
    v_exp_f32 v54, v54
    v_exp_f32 v55, v55
    v_pk_add_f32 v[48:49], v[48:49], v[90:91]
    v_pk_add_f32 v[50:51], v[50:51], v[90:91]
    v_pk_add_f32 v[52:53], v[52:53], v[90:91]
    v_pk_add_f32 v[54:55], v[54:55], v[90:91]
    v_rcp_f32 v48, v48
    v_rcp_f32 v49, v49
    v_rcp_f32 v50, v50
    v_rcp_f32 v51, v51
    v_rcp_f32 v52, v52
    v_rcp_f32 v53, v53
    v_rcp_f32 v54, v54
    v_rcp_f32 v55, v55
    v_pk_mul_f32 v[48:49], v[48:49], v[120:121]
    v_pk_mul_f32 v[50:51], v[50:51], v[122:123]
    v_pk_mul_f32 v[52:53], v[52:53], v[136:137]
    v_pk_mul_f32 v[54:55], v[54:55], v[138:139]
    v_cvt_pk_bf16_f32 v100, v48, v49
    v_cvt_pk_bf16_f32 v101, v50, v51
    v_cvt_pk_bf16_f32 v102, v52, v53
    v_cvt_pk_bf16_f32 v103, v54, v55
    buffer_store_dwordx4 v[100:103], v108, s[32:35], s84 offen offset:2048 sc1
    v_pk_add_f32 v[124:125], v[124:125], v[188:189]
    v_pk_add_f32 v[126:127], v[126:127], v[190:191]
    v_pk_add_f32 v[140:141], v[140:141], v[204:205]
    v_pk_add_f32 v[142:143], v[142:143], v[206:207]
    v_pk_mul_f32 v[48:49], v[124:125], v[124:125]
    v_pk_mul_f32 v[50:51], v[126:127], v[126:127]
    v_pk_mul_f32 v[52:53], v[140:141], v[140:141]
    v_pk_mul_f32 v[54:55], v[142:143], v[142:143]
    v_pk_fma_f32 v[48:49], v[48:49], s[86:87], v[88:89]
    v_pk_fma_f32 v[50:51], v[50:51], s[86:87], v[88:89]
    v_pk_fma_f32 v[52:53], v[52:53], s[86:87], v[88:89]
    v_pk_fma_f32 v[54:55], v[54:55], s[86:87], v[88:89]
    v_pk_mul_f32 v[48:49], v[48:49], v[124:125]
    v_pk_mul_f32 v[50:51], v[50:51], v[126:127]
    v_pk_mul_f32 v[52:53], v[52:53], v[140:141]
    v_pk_mul_f32 v[54:55], v[54:55], v[142:143]
    v_exp_f32 v48, v48
    v_exp_f32 v49, v49
    v_exp_f32 v50, v50
    v_exp_f32 v51, v51
    v_exp_f32 v52, v52
    v_exp_f32 v53, v53
    v_exp_f32 v54, v54
    v_exp_f32 v55, v55
    v_pk_add_f32 v[48:49], v[48:49], v[90:91]
    v_pk_add_f32 v[50:51], v[50:51], v[90:91]
    v_pk_add_f32 v[52:53], v[52:53], v[90:91]
    v_pk_add_f32 v[54:55], v[54:55], v[90:91]
    v_rcp_f32 v48, v48
    v_rcp_f32 v49, v49
    v_rcp_f32 v50, v50
    v_rcp_f32 v51, v51
    v_rcp_f32 v52, v52
    v_rcp_f32 v53, v53
    v_rcp_f32 v54, v54
    v_rcp_f32 v55, v55
    v_pk_mul_f32 v[48:49], v[48:49], v[124:125]
    v_pk_mul_f32 v[50:51], v[50:51], v[126:127]
    v_pk_mul_f32 v[52:53], v[52:53], v[140:141]
    v_pk_mul_f32 v[54:55], v[54:55], v[142:143]
    v_cvt_pk_bf16_f32 v104, v48, v49
    v_cvt_pk_bf16_f32 v105, v50, v51
    v_cvt_pk_bf16_f32 v106, v52, v53
    v_cvt_pk_bf16_f32 v107, v54, v55
    buffer_store_dwordx4 v[104:107], v108, s[32:35], s84 offen offset:3072 sc1
    v_pk_add_f32 v[144:145], v[144:145], v[208:209]
    v_pk_add_f32 v[146:147], v[146:147], v[210:211]
    v_pk_add_f32 v[160:161], v[160:161], v[224:225]
    v_pk_add_f32 v[162:163], v[162:163], v[226:227]
    v_pk_mul_f32 v[48:49], v[144:145], v[144:145]
    v_pk_mul_f32 v[50:51], v[146:147], v[146:147]
    v_pk_mul_f32 v[52:53], v[160:161], v[160:161]
    v_pk_mul_f32 v[54:55], v[162:163], v[162:163]
    v_pk_fma_f32 v[48:49], v[48:49], s[86:87], v[88:89]
    v_pk_fma_f32 v[50:51], v[50:51], s[86:87], v[88:89]
    v_pk_fma_f32 v[52:53], v[52:53], s[86:87], v[88:89]
    v_pk_fma_f32 v[54:55], v[54:55], s[86:87], v[88:89]
    v_pk_mul_f32 v[48:49], v[48:49], v[144:145]
    v_pk_mul_f32 v[50:51], v[50:51], v[146:147]
    v_pk_mul_f32 v[52:53], v[52:53], v[160:161]
    v_pk_mul_f32 v[54:55], v[54:55], v[162:163]
    v_exp_f32 v48, v48
    v_exp_f32 v49, v49
    v_exp_f32 v50, v50
    v_exp_f32 v51, v51
    v_exp_f32 v52, v52
    v_exp_f32 v53, v53
    v_exp_f32 v54, v54
    v_exp_f32 v55, v55
    v_pk_add_f32 v[48:49], v[48:49], v[90:91]
    v_pk_add_f32 v[50:51], v[50:51], v[90:91]
    v_pk_add_f32 v[52:53], v[52:53], v[90:91]
    v_pk_add_f32 v[54:55], v[54:55], v[90:91]
    v_rcp_f32 v48, v48
    v_rcp_f32 v49, v49
    v_rcp_f32 v50, v50
    v_rcp_f32 v51, v51
    v_rcp_f32 v52, v52
    v_rcp_f32 v53, v53
    v_rcp_f32 v54, v54
    v_rcp_f32 v55, v55
    v_pk_mul_f32 v[48:49], v[48:49], v[144:145]
    v_pk_mul_f32 v[50:51], v[50:51], v[146:147]
    v_pk_mul_f32 v[52:53], v[52:53], v[160:161]
    v_pk_mul_f32 v[54:55], v[54:55], v[162:163]
    v_cvt_pk_bf16_f32 v92, v48, v49
    v_cvt_pk_bf16_f32 v93, v50, v51
    v_cvt_pk_bf16_f32 v94, v52, v53
    v_cvt_pk_bf16_f32 v95, v54, v55
    buffer_store_dwordx4 v[92:95], v108, s[32:35], s85 offen offset:0 sc1
    v_pk_add_f32 v[148:149], v[148:149], v[212:213]
    v_pk_add_f32 v[150:151], v[150:151], v[214:215]
    v_pk_add_f32 v[164:165], v[164:165], v[228:229]
    v_pk_add_f32 v[166:167], v[166:167], v[230:231]
    v_pk_mul_f32 v[48:49], v[148:149], v[148:149]
    v_pk_mul_f32 v[50:51], v[150:151], v[150:151]
    v_pk_mul_f32 v[52:53], v[164:165], v[164:165]
    v_pk_mul_f32 v[54:55], v[166:167], v[166:167]
    v_pk_fma_f32 v[48:49], v[48:49], s[86:87], v[88:89]
    v_pk_fma_f32 v[50:51], v[50:51], s[86:87], v[88:89]
    v_pk_fma_f32 v[52:53], v[52:53], s[86:87], v[88:89]
    v_pk_fma_f32 v[54:55], v[54:55], s[86:87], v[88:89]
    v_pk_mul_f32 v[48:49], v[48:49], v[148:149]
    v_pk_mul_f32 v[50:51], v[50:51], v[150:151]
    v_pk_mul_f32 v[52:53], v[52:53], v[164:165]
    v_pk_mul_f32 v[54:55], v[54:55], v[166:167]
    v_exp_f32 v48, v48
    v_exp_f32 v49, v49
    v_exp_f32 v50, v50
    v_exp_f32 v51, v51
    v_exp_f32 v52, v52
    v_exp_f32 v53, v53
    v_exp_f32 v54, v54
    v_exp_f32 v55, v55
    v_pk_add_f32 v[48:49], v[48:49], v[90:91]
    v_pk_add_f32 v[50:51], v[50:51], v[90:91]
    v_pk_add_f32 v[52:53], v[52:53], v[90:91]
    v_pk_add_f32 v[54:55], v[54:55], v[90:91]
    v_rcp_f32 v48, v48
    v_rcp_f32 v49, v49
    v_rcp_f32 v50, v50
    v_rcp_f32 v51, v51
    v_rcp_f32 v52, v52
    v_rcp_f32 v53, v53
    v_rcp_f32 v54, v54
    v_rcp_f32 v55, v55
    v_pk_mul_f32 v[48:49], v[48:49], v[148:149]
    v_pk_mul_f32 v[50:51], v[50:51], v[150:151]
    v_pk_mul_f32 v[52:53], v[52:53], v[164:165]
    v_pk_mul_f32 v[54:55], v[54:55], v[166:167]
    v_cvt_pk_bf16_f32 v96, v48, v49
    v_cvt_pk_bf16_f32 v97, v50, v51
    v_cvt_pk_bf16_f32 v98, v52, v53
    v_cvt_pk_bf16_f32 v99, v54, v55
    buffer_store_dwordx4 v[96:99], v108, s[32:35], s85 offen offset:1024 sc1
    v_pk_add_f32 v[152:153], v[152:153], v[216:217]
    v_pk_add_f32 v[154:155], v[154:155], v[218:219]
    v_pk_add_f32 v[168:169], v[168:169], v[232:233]
    v_pk_add_f32 v[170:171], v[170:171], v[234:235]
    v_pk_mul_f32 v[48:49], v[152:153], v[152:153]
    v_pk_mul_f32 v[50:51], v[154:155], v[154:155]
    v_pk_mul_f32 v[52:53], v[168:169], v[168:169]
    v_pk_mul_f32 v[54:55], v[170:171], v[170:171]
    v_pk_fma_f32 v[48:49], v[48:49], s[86:87], v[88:89]
    v_pk_fma_f32 v[50:51], v[50:51], s[86:87], v[88:89]
    v_pk_fma_f32 v[52:53], v[52:53], s[86:87], v[88:89]
    v_pk_fma_f32 v[54:55], v[54:55], s[86:87], v[88:89]
    v_pk_mul_f32 v[48:49], v[48:49], v[152:153]
    v_pk_mul_f32 v[50:51], v[50:51], v[154:155]
    v_pk_mul_f32 v[52:53], v[52:53], v[168:169]
    v_pk_mul_f32 v[54:55], v[54:55], v[170:171]
    v_exp_f32 v48, v48
    v_exp_f32 v49, v49
    v_exp_f32 v50, v50
    v_exp_f32 v51, v51
    v_exp_f32 v52, v52
    v_exp_f32 v53, v53
    v_exp_f32 v54, v54
    v_exp_f32 v55, v55
    v_pk_add_f32 v[48:49], v[48:49], v[90:91]
    v_pk_add_f32 v[50:51], v[50:51], v[90:91]
    v_pk_add_f32 v[52:53], v[52:53], v[90:91]
    v_pk_add_f32 v[54:55], v[54:55], v[90:91]
    v_rcp_f32 v48, v48
    v_rcp_f32 v49, v49
    v_rcp_f32 v50, v50
    v_rcp_f32 v51, v51
    v_rcp_f32 v52, v52
    v_rcp_f32 v53, v53
    v_rcp_f32 v54, v54
    v_rcp_f32 v55, v55
    v_pk_mul_f32 v[48:49], v[48:49], v[152:153]
    v_pk_mul_f32 v[50:51], v[50:51], v[154:155]
    v_pk_mul_f32 v[52:53], v[52:53], v[168:169]
    v_pk_mul_f32 v[54:55], v[54:55], v[170:171]
    v_cvt_pk_bf16_f32 v100, v48, v49
    v_cvt_pk_bf16_f32 v101, v50, v51
    v_cvt_pk_bf16_f32 v102, v52, v53
    v_cvt_pk_bf16_f32 v103, v54, v55
    buffer_store_dwordx4 v[100:103], v108, s[32:35], s85 offen offset:2048 sc1
    v_pk_add_f32 v[156:157], v[156:157], v[220:221]
    v_pk_add_f32 v[158:159], v[158:159], v[222:223]
    v_pk_add_f32 v[172:173], v[172:173], v[236:237]
    v_pk_add_f32 v[174:175], v[174:175], v[238:239]
    v_pk_mul_f32 v[48:49], v[156:157], v[156:157]
    v_pk_mul_f32 v[50:51], v[158:159], v[158:159]
    v_pk_mul_f32 v[52:53], v[172:173], v[172:173]
    v_pk_mul_f32 v[54:55], v[174:175], v[174:175]
    v_pk_fma_f32 v[48:49], v[48:49], s[86:87], v[88:89]
    v_pk_fma_f32 v[50:51], v[50:51], s[86:87], v[88:89]
    v_pk_fma_f32 v[52:53], v[52:53], s[86:87], v[88:89]
    v_pk_fma_f32 v[54:55], v[54:55], s[86:87], v[88:89]
    v_pk_mul_f32 v[48:49], v[48:49], v[156:157]
    v_pk_mul_f32 v[50:51], v[50:51], v[158:159]
    v_pk_mul_f32 v[52:53], v[52:53], v[172:173]
    v_pk_mul_f32 v[54:55], v[54:55], v[174:175]
    v_exp_f32 v48, v48
    v_exp_f32 v49, v49
    v_exp_f32 v50, v50
    v_exp_f32 v51, v51
    v_exp_f32 v52, v52
    v_exp_f32 v53, v53
    v_exp_f32 v54, v54
    v_exp_f32 v55, v55
    v_pk_add_f32 v[48:49], v[48:49], v[90:91]
    v_pk_add_f32 v[50:51], v[50:51], v[90:91]
    v_pk_add_f32 v[52:53], v[52:53], v[90:91]
    v_pk_add_f32 v[54:55], v[54:55], v[90:91]
    v_rcp_f32 v48, v48
    v_rcp_f32 v49, v49
    v_rcp_f32 v50, v50
    v_rcp_f32 v51, v51
    v_rcp_f32 v52, v52
    v_rcp_f32 v53, v53
    v_rcp_f32 v54, v54
    v_rcp_f32 v55, v55
    v_pk_mul_f32 v[48:49], v[48:49], v[156:157]
    v_pk_mul_f32 v[50:51], v[50:51], v[158:159]
    v_pk_mul_f32 v[52:53], v[52:53], v[172:173]
    v_pk_mul_f32 v[54:55], v[54:55], v[174:175]
    v_cvt_pk_bf16_f32 v104, v48, v49
    v_cvt_pk_bf16_f32 v105, v50, v51
    v_cvt_pk_bf16_f32 v106, v52, v53
    v_cvt_pk_bf16_f32 v107, v54, v55
    buffer_store_dwordx4 v[104:107], v108, s[32:35], s85 offen offset:3072 sc1
    ds_read_b64_tr_b16 v[48:49], v40 offset:32768
    ds_read_b64_tr_b16 v[50:51], v40 offset:36864
    ds_read_b64_tr_b16 v[52:53], v41 offset:32768
    ds_read_b64_tr_b16 v[54:55], v41 offset:36864
    ds_read_b64_tr_b16 v[56:57], v42 offset:32768
    ds_read_b64_tr_b16 v[58:59], v42 offset:36864
    ds_read_b64_tr_b16 v[60:61], v43 offset:32768
    ds_read_b64_tr_b16 v[62:63], v43 offset:36864
    ds_read_b64_tr_b16 v[64:65], v44 offset:32768
    ds_read_b64_tr_b16 v[66:67], v44 offset:36864
    ds_read_b64_tr_b16 v[68:69], v45 offset:32768
    ds_read_b64_tr_b16 v[70:71], v45 offset:36864
    ds_read_b64_tr_b16 v[72:73], v46 offset:32768
    ds_read_b64_tr_b16 v[74:75], v46 offset:36864
    ds_read_b64_tr_b16 v[76:77], v47 offset:32768
    ds_read_b64_tr_b16 v[78:79], v47 offset:36864
    buffer_load_dwordx4 v[112:115], v21, s[28:31], s4 offen offset:0
    buffer_load_dwordx4 v[116:119], v21, s[28:31], s5 offen offset:0
    buffer_load_dwordx4 v[120:123], v21, s[28:31], s6 offen offset:0
    buffer_load_dwordx4 v[124:127], v21, s[28:31], s7 offen offset:0
    buffer_load_dwordx4 v[128:131], v21, s[28:31], s4 offen offset:64
    buffer_load_dwordx4 v[132:135], v21, s[28:31], s5 offen offset:64
    buffer_load_dwordx4 v[136:139], v21, s[28:31], s6 offen offset:64
    buffer_load_dwordx4 v[140:143], v21, s[28:31], s7 offen offset:64
    s_waitcnt lgkmcnt(0)
    s_mov_b32 s101, 0
    s_mov_b32 s70, 8
.p2align 6
km_s_loop:
    v_mfma_f32_16x16x32_bf16 a[0:3], v[48:51], a[192:195], a[0:3]
    ds_read_b64_tr_b16 v[80:81], v40 offset:40960
    v_mfma_f32_16x16x32_bf16 a[4:7], v[48:51], a[196:199], a[4:7]
    ds_read_b64_tr_b16 v[82:83], v40 offset:45056
    s_add_u32 m0, s69, 102400
    s_add_u32 s66, s66, 32768
    v_mfma_f32_16x16x32_bf16 a[8:11], v[48:51], a[200:203], a[8:11]
    ds_read_b64_tr_b16 v[84:85], v41 offset:40960
    buffer_load_dwordx4 v24, s[8:11], s66 offen offset:0 lds
    v_mfma_f32_16x16x32_bf16 a[12:15], v[48:51], a[204:207], a[12:15]
    ds_read_b64_tr_b16 v[86:87], v41 offset:45056
    v_mfma_f32_16x16x32_bf16 a[16:19], v[52:55], a[192:195], a[16:19]
    buffer_load_dwordx4 v25, s[8:11], s66 offen offset:1024 lds
    v_mfma_f32_16x16x32_bf16 a[20:23], v[52:55], a[196:199], a[20:23]
    ds_read_b64_tr_b16 v[88:89], v42 offset:40960
    v_mfma_f32_16x16x32_bf16 a[24:27], v[52:55], a[200:203], a[24:27]
    ds_read_b64_tr_b16 v[90:91], v42 offset:45056
    v_mfma_f32_16x16x32_bf16 a[28:31], v[52:55], a[204:207], a[28:31]
    ds_read_b64_tr_b16 v[92:93], v43 offset:40960
    v_mfma_f32_16x16x32_bf16 a[32:35], v[56:59], a[192:195], a[32:35]
    ds_read_b64_tr_b16 v[94:95], v43 offset:45056
    buffer_load_dwordx4 v26, s[8:11], s66 offen offset:2048 lds
    v_mfma_f32_16x16x32_bf16 a[36:39], v[56:59], a[196:199], a[36:39]
    v_mfma_f32_16x16x32_bf16 a[40:43], v[56:59], a[200:203], a[40:43]
    ds_read_b64_tr_b16 v[96:97], v44 offset:40960
    v_mfma_f32_16x16x32_bf16 a[44:47], v[56:59], a[204:207], a[44:47]
    ds_read_b64_tr_b16 v[98:99], v44 offset:45056
    v_mfma_f32_16x16x32_bf16 a[48:51], v[60:63], a[192:195], a[48:51]
    ds_read_b64_tr_b16 v[100:101], v45 offset:40960
    buffer_load_dwordx4 v27, s[8:11], s66 offen offset:3072 lds
    v_mfma_f32_16x16x32_bf16 a[52:55], v[60:63], a[196:199], a[52:55]
    ds_read_b64_tr_b16 v[102:103], v45 offset:45056
    v_mfma_f32_16x16x32_bf16 a[56:59], v[60:63], a[200:203], a[56:59]
    v_mfma_f32_16x16x32_bf16 a[60:63], v[60:63], a[204:207], a[60:63]
    ds_read_b64_tr_b16 v[104:105], v46 offset:40960
    v_mfma_f32_16x16x32_bf16 a[64:67], v[64:67], a[192:195], a[64:67]
    ds_read_b64_tr_b16 v[106:107], v46 offset:45056
    buffer_load_dwordx4 a[176:179], v20, s[12:15], s67 offen offset:0 sc1
    v_mfma_f32_16x16x32_bf16 a[68:71], v[64:67], a[196:199], a[68:71]
    ds_read_b64_tr_b16 v[108:109], v47 offset:40960
    v_mfma_f32_16x16x32_bf16 a[72:75], v[64:67], a[200:203], a[72:75]
    ds_read_b64_tr_b16 v[110:111], v47 offset:45056
    v_mfma_f32_16x16x32_bf16 a[76:79], v[64:67], a[204:207], a[76:79]
    v_mfma_f32_16x16x32_bf16 a[80:83], v[68:71], a[192:195], a[80:83]
    buffer_load_dwordx4 a[180:183], v20, s[12:15], s67 offen offset:1024 sc1
    v_mfma_f32_16x16x32_bf16 a[84:87], v[68:71], a[196:199], a[84:87]
    v_mfma_f32_16x16x32_bf16 a[88:91], v[68:71], a[200:203], a[88:91]
    v_mfma_f32_16x16x32_bf16 a[92:95], v[68:71], a[204:207], a[92:95]
    v_mfma_f32_16x16x32_bf16 a[96:99], v[72:75], a[192:195], a[96:99]
    buffer_load_dwordx4 a[184:187], v20, s[12:15], s67 offen offset:2048 sc1
    v_mfma_f32_16x16x32_bf16 a[100:103], v[72:75], a[196:199], a[100:103]
    v_mfma_f32_16x16x32_bf16 a[104:107], v[72:75], a[200:203], a[104:107]
    v_mfma_f32_16x16x32_bf16 a[108:111], v[72:75], a[204:207], a[108:111]
    v_mfma_f32_16x16x32_bf16 a[112:115], v[76:79], a[192:195], a[112:115]
    buffer_load_dwordx4 a[188:191], v20, s[12:15], s67 offen offset:3072 sc1
    v_mfma_f32_16x16x32_bf16 a[116:119], v[76:79], a[196:199], a[116:119]
    v_mfma_f32_16x16x32_bf16 a[120:123], v[76:79], a[200:203], a[120:123]
    v_mfma_f32_16x16x32_bf16 a[124:127], v[76:79], a[204:207], a[124:127]
    s_add_u32 s67, s67, 393216
    s_waitcnt vmcnt(32) lgkmcnt(0)
    s_barrier
    s_cmp_eq_u32 s70, 6
    s_cbranch_scc1 km_spi
km_spi_ret:
    s_cmp_eq_u32 s70, 5
    s_cbranch_scc1 km_spc
km_spc_ret:
    v_mfma_f32_16x16x32_bf16 a[0:3], v[80:83], a[208:211], a[0:3]
    ds_read_b64_tr_b16 v[48:49], v32 offset:0
    v_mfma_f32_16x16x32_bf16 a[4:7], v[80:83], a[212:215], a[4:7]
    ds_read_b64_tr_b16 v[50:51], v32 offset:4096
    s_add_u32 m0, s69, 131072
    s_add_u32 s66, s66, 229376
    v_mfma_f32_16x16x32_bf16 a[8:11], v[80:83], a[216:219], a[8:11]
    ds_read_b64_tr_b16 v[52:53], v33 offset:0
    buffer_load_dwordx4 v24, s[8:11], s66 offen offset:0 lds
    v_mfma_f32_16x16x32_bf16 a[12:15], v[80:83], a[220:223], a[12:15]
    ds_read_b64_tr_b16 v[54:55], v33 offset:4096
    v_mfma_f32_16x16x32_bf16 a[16:19], v[84:87], a[208:211], a[16:19]
    buffer_load_dwordx4 v25, s[8:11], s66 offen offset:1024 lds
    v_mfma_f32_16x16x32_bf16 a[20:23], v[84:87], a[212:215], a[20:23]
    ds_read_b64_tr_b16 v[56:57], v34 offset:0
    v_mfma_f32_16x16x32_bf16 a[24:27], v[84:87], a[216:219], a[24:27]
    ds_read_b64_tr_b16 v[58:59], v34 offset:4096
    v_mfma_f32_16x16x32_bf16 a[28:31], v[84:87], a[220:223], a[28:31]
    ds_read_b64_tr_b16 v[60:61], v35 offset:0
    buffer_load_dwordx4 v26, s[8:11], s66 offen offset:2048 lds
    v_mfma_f32_16x16x32_bf16 a[32:35], v[88:91], a[208:211], a[32:35]
    ds_read_b64_tr_b16 v[62:63], v35 offset:4096
    v_mfma_f32_16x16x32_bf16 a[36:39], v[88:91], a[212:215], a[36:39]
    v_mfma_f32_16x16x32_bf16 a[40:43], v[88:91], a[216:219], a[40:43]
    ds_read_b64_tr_b16 v[64:65], v36 offset:0
    buffer_load_dwordx4 v27, s[8:11], s66 offen offset:3072 lds
    v_mfma_f32_16x16x32_bf16 a[44:47], v[88:91], a[220:223], a[44:47]
    ds_read_b64_tr_b16 v[66:67], v36 offset:4096
    v_mfma_f32_16x16x32_bf16 a[48:51], v[92:95], a[208:211], a[48:51]
    ds_read_b64_tr_b16 v[68:69], v37 offset:0
    v_mfma_f32_16x16x32_bf16 a[52:55], v[92:95], a[212:215], a[52:55]
    ds_read_b64_tr_b16 v[70:71], v37 offset:4096
    buffer_load_dwordx4 a[192:195], v20, s[12:15], s67 offen offset:0 sc1
    v_mfma_f32_16x16x32_bf16 a[56:59], v[92:95], a[216:219], a[56:59]
    v_mfma_f32_16x16x32_bf16 a[60:63], v[92:95], a[220:223], a[60:63]
    ds_read_b64_tr_b16 v[72:73], v38 offset:0
    v_mfma_f32_16x16x32_bf16 a[64:67], v[96:99], a[208:211], a[64:67]
    ds_read_b64_tr_b16 v[74:75], v38 offset:4096
    buffer_load_dwordx4 a[196:199], v20, s[12:15], s67 offen offset:1024 sc1
    v_mfma_f32_16x16x32_bf16 a[68:71], v[96:99], a[212:215], a[68:71]
    ds_read_b64_tr_b16 v[76:77], v39 offset:0
    v_mfma_f32_16x16x32_bf16 a[72:75], v[96:99], a[216:219], a[72:75]
    ds_read_b64_tr_b16 v[78:79], v39 offset:4096
    v_mfma_f32_16x16x32_bf16 a[76:79], v[96:99], a[220:223], a[76:79]
    buffer_load_dwordx4 a[200:203], v20, s[12:15], s67 offen offset:2048 sc1
    v_mfma_f32_16x16x32_bf16 a[80:83], v[100:103], a[208:211], a[80:83]
    v_mfma_f32_16x16x32_bf16 a[84:87], v[100:103], a[212:215], a[84:87]
    v_mfma_f32_16x16x32_bf16 a[88:91], v[100:103], a[216:219], a[88:91]
    buffer_load_dwordx4 a[204:207], v20, s[12:15], s67 offen offset:3072 sc1
    v_mfma_f32_16x16x32_bf16 a[92:95], v[100:103], a[220:223], a[92:95]
    v_mfma_f32_16x16x32_bf16 a[96:99], v[104:107], a[208:211], a[96:99]
    v_mfma_f32_16x16x32_bf16 a[100:103], v[104:107], a[212:215], a[100:103]
    s_add_u32 s67, s67, 131072
    s_cmp_eq_u32 s3, s70
    s_cselect_b32 s89, s99, 0x7f000000
    v_mfma_f32_16x16x32_bf16 a[104:107], v[104:107], a[216:219], a[104:107]
    buffer_load_dword v31, v28, s[8:11], s89 offen
    v_mfma_f32_16x16x32_bf16 a[108:111], v[104:107], a[220:223], a[108:111]
    v_mfma_f32_16x16x32_bf16 a[112:115], v[108:111], a[208:211], a[112:115]
    buffer_load_dword v31, v28, s[8:11], s89 offen offset:128
    v_mfma_f32_16x16x32_bf16 a[116:119], v[108:111], a[212:215], a[116:119]
    v_mfma_f32_16x16x32_bf16 a[120:123], v[108:111], a[216:219], a[120:123]
    v_mfma_f32_16x16x32_bf16 a[124:127], v[108:111], a[220:223], a[124:127]
    s_waitcnt lgkmcnt(0)
    v_mfma_f32_16x16x32_bf16 a[0:3], v[48:51], a[224:227], a[0:3]
    ds_read_b64_tr_b16 v[80:81], v32 offset:8192
    v_mfma_f32_16x16x32_bf16 a[4:7], v[48:51], a[228:231], a[4:7]
    ds_read_b64_tr_b16 v[82:83], v32 offset:12288
    s_add_u32 m0, s69, 135168
    s_add_u32 s66, s66, 32768
    v_mfma_f32_16x16x32_bf16 a[8:11], v[48:51], a[232:235], a[8:11]
    ds_read_b64_tr_b16 v[84:85], v33 offset:8192
    buffer_load_dwordx4 v24, s[8:11], s66 offen offset:0 lds
    v_mfma_f32_16x16x32_bf16 a[12:15], v[48:51], a[236:239], a[12:15]
    ds_read_b64_tr_b16 v[86:87], v33 offset:12288
    v_mfma_f32_16x16x32_bf16 a[16:19], v[52:55], a[224:227], a[16:19]
    buffer_load_dwordx4 v25, s[8:11], s66 offen offset:1024 lds
    v_mfma_f32_16x16x32_bf16 a[20:23], v[52:55], a[228:231], a[20:23]
    ds_read_b64_tr_b16 v[88:89], v34 offset:8192
    v_mfma_f32_16x16x32_bf16 a[24:27], v[52:55], a[232:235], a[24:27]
    ds_read_b64_tr_b16 v[90:91], v34 offset:12288
    v_mfma_f32_16x16x32_bf16 a[28:31], v[52:55], a[236:239], a[28:31]
    ds_read_b64_tr_b16 v[92:93], v35 offset:8192
    v_mfma_f32_16x16x32_bf16 a[32:35], v[56:59], a[224:227], a[32:35]
    ds_read_b64_tr_b16 v[94:95], v35 offset:12288
    buffer_load_dwordx4 v26, s[8:11], s66 offen offset:2048 lds
    v_mfma_f32_16x16x32_bf16 a[36:39], v[56:59], a[228:231], a[36:39]
    v_mfma_f32_16x16x32_bf16 a[40:43], v[56:59], a[232:235], a[40:43]
    ds_read_b64_tr_b16 v[96:97], v36 offset:8192
    v_mfma_f32_16x16x32_bf16 a[44:47], v[56:59], a[236:239], a[44:47]
    ds_read_b64_tr_b16 v[98:99], v36 offset:12288
    v_mfma_f32_16x16x32_bf16 a[48:51], v[60:63], a[224:227], a[48:51]
    ds_read_b64_tr_b16 v[100:101], v37 offset:8192
    buffer_load_dwordx4 v27, s[8:11], s66 offen offset:3072 lds
    v_mfma_f32_16x16x32_bf16 a[52:55], v[60:63], a[228:231], a[52:55]
    ds_read_b64_tr_b16 v[102:103], v37 offset:12288
    v_mfma_f32_16x16x32_bf16 a[56:59], v[60:63], a[232:235], a[56:59]
    v_mfma_f32_16x16x32_bf16 a[60:63], v[60:63], a[236:239], a[60:63]
    ds_read_b64_tr_b16 v[104:105], v38 offset:8192
    v_mfma_f32_16x16x32_bf16 a[64:67], v[64:67], a[224:227], a[64:67]
    ds_read_b64_tr_b16 v[106:107], v38 offset:12288
    buffer_load_dwordx4 a[208:211], v20, s[12:15], s67 offen offset:0 sc1
    v_mfma_f32_16x16x32_bf16 a[68:71], v[64:67], a[228:231], a[68:71]
    ds_read_b64_tr_b16 v[108:109], v39 offset:8192
    v_mfma_f32_16x16x32_bf16 a[72:75], v[64:67], a[232:235], a[72:75]
    ds_read_b64_tr_b16 v[110:111], v39 offset:12288
    v_mfma_f32_16x16x32_bf16 a[76:79], v[64:67], a[236:239], a[76:79]
    v_mfma_f32_16x16x32_bf16 a[80:83], v[68:71], a[224:227], a[80:83]
    buffer_load_dwordx4 a[212:215], v20, s[12:15], s67 offen offset:1024 sc1
    v_mfma_f32_16x16x32_bf16 a[84:87], v[68:71], a[228:231], a[84:87]
    v_mfma_f32_16x16x32_bf16 a[88:91], v[68:71], a[232:235], a[88:91]
    v_mfma_f32_16x16x32_bf16 a[92:95], v[68:71], a[236:239], a[92:95]
    v_mfma_f32_16x16x32_bf16 a[96:99], v[72:75], a[224:227], a[96:99]
    buffer_load_dwordx4 a[216:219], v20, s[12:15], s67 offen offset:2048 sc1
    v_mfma_f32_16x16x32_bf16 a[100:103], v[72:75], a[228:231], a[100:103]
    v_mfma_f32_16x16x32_bf16 a[104:107], v[72:75], a[232:235], a[104:107]
    v_mfma_f32_16x16x32_bf16 a[108:111], v[72:75], a[236:239], a[108:111]
    v_mfma_f32_16x16x32_bf16 a[112:115], v[76:79], a[224:227], a[112:115]
    buffer_load_dwordx4 a[220:223], v20, s[12:15], s67 offen offset:3072 sc1
    v_mfma_f32_16x16x32_bf16 a[116:119], v[76:79], a[228:231], a[116:119]
    v_mfma_f32_16x16x32_bf16 a[120:123], v[76:79], a[232:235], a[120:123]
    v_mfma_f32_16x16x32_bf16 a[124:127], v[76:79], a[236:239], a[124:127]
    s_add_u32 s67, s67, 393216
    s_waitcnt vmcnt(32) lgkmcnt(0)
    s_barrier
    s_cmp_eq_u32 s70, 8
    s_cbranch_scc1 km_sigu
km_sigu_ret:
    v_mfma_f32_16x16x32_bf16 a[0:3], v[80:83], a[240:243], a[0:3]
    ds_read_b64_tr_b16 v[48:49], v32 offset:32768
    v_mfma_f32_16x16x32_bf16 a[4:7], v[80:83], a[244:247], a[4:7]
    ds_read_b64_tr_b16 v[50:51], v32 offset:36864
    s_add_u32 m0, s69, 0
    s_add_u32 s66, s66, 229376
    v_mfma_f32_16x16x32_bf16 a[8:11], v[80:83], a[248:251], a[8:11]
    ds_read_b64_tr_b16 v[52:53], v33 offset:32768
    buffer_load_dwordx4 v24, s[8:11], s66 offen offset:0 lds
    v_mfma_f32_16x16x32_bf16 a[12:15], v[80:83], a[252:255], a[12:15]
    ds_read_b64_tr_b16 v[54:55], v33 offset:36864
    v_mfma_f32_16x16x32_bf16 a[16:19], v[84:87], a[240:243], a[16:19]
    buffer_load_dwordx4 v25, s[8:11], s66 offen offset:1024 lds
    v_mfma_f32_16x16x32_bf16 a[20:23], v[84:87], a[244:247], a[20:23]
    ds_read_b64_tr_b16 v[56:57], v34 offset:32768
    v_mfma_f32_16x16x32_bf16 a[24:27], v[84:87], a[248:251], a[24:27]
    ds_read_b64_tr_b16 v[58:59], v34 offset:36864
    v_mfma_f32_16x16x32_bf16 a[28:31], v[84:87], a[252:255], a[28:31]
    ds_read_b64_tr_b16 v[60:61], v35 offset:32768
    v_mfma_f32_16x16x32_bf16 a[32:35], v[88:91], a[240:243], a[32:35]
    ds_read_b64_tr_b16 v[62:63], v35 offset:36864
    buffer_load_dwordx4 v26, s[8:11], s66 offen offset:2048 lds
    v_mfma_f32_16x16x32_bf16 a[36:39], v[88:91], a[244:247], a[36:39]
    v_mfma_f32_16x16x32_bf16 a[40:43], v[88:91], a[248:251], a[40:43]
    ds_read_b64_tr_b16 v[64:65], v36 offset:32768
    v_mfma_f32_16x16x32_bf16 a[44:47], v[88:91], a[252:255], a[44:47]
    ds_read_b64_tr_b16 v[66:67], v36 offset:36864
    v_mfma_f32_16x16x32_bf16 a[48:51], v[92:95], a[240:243], a[48:51]
    ds_read_b64_tr_b16 v[68:69], v37 offset:32768
    buffer_load_dwordx4 v27, s[8:11], s66 offen offset:3072 lds
    v_mfma_f32_16x16x32_bf16 a[52:55], v[92:95], a[244:247], a[52:55]
    ds_read_b64_tr_b16 v[70:71], v37 offset:36864
    v_mfma_f32_16x16x32_bf16 a[56:59], v[92:95], a[248:251], a[56:59]
    v_mfma_f32_16x16x32_bf16 a[60:63], v[92:95], a[252:255], a[60:63]
    ds_read_b64_tr_b16 v[72:73], v38 offset:32768
    v_mfma_f32_16x16x32_bf16 a[64:67], v[96:99], a[240:243], a[64:67]
    ds_read_b64_tr_b16 v[74:75], v38 offset:36864
    buffer_load_dwordx4 a[224:227], v20, s[12:15], s67 offen offset:0 sc1
    v_mfma_f32_16x16x32_bf16 a[68:71], v[96:99], a[244:247], a[68:71]
    ds_read_b64_tr_b16 v[76:77], v39 offset:32768
    v_mfma_f32_16x16x32_bf16 a[72:75], v[96:99], a[248:251], a[72:75]
    ds_read_b64_tr_b16 v[78:79], v39 offset:36864
    v_mfma_f32_16x16x32_bf16 a[76:79], v[96:99], a[252:255], a[76:79]
    v_mfma_f32_16x16x32_bf16 a[80:83], v[100:103], a[240:243], a[80:83]
    buffer_load_dwordx4 a[228:231], v20, s[12:15], s67 offen offset:1024 sc1
    v_mfma_f32_16x16x32_bf16 a[84:87], v[100:103], a[244:247], a[84:87]
    v_mfma_f32_16x16x32_bf16 a[88:91], v[100:103], a[248:251], a[88:91]
    v_mfma_f32_16x16x32_bf16 a[92:95], v[100:103], a[252:255], a[92:95]
    v_mfma_f32_16x16x32_bf16 a[96:99], v[104:107], a[240:243], a[96:99]
    buffer_load_dwordx4 a[232:235], v20, s[12:15], s67 offen offset:2048 sc1
    v_mfma_f32_16x16x32_bf16 a[100:103], v[104:107], a[244:247], a[100:103]
    v_mfma_f32_16x16x32_bf16 a[104:107], v[104:107], a[248:251], a[104:107]
    v_mfma_f32_16x16x32_bf16 a[108:111], v[104:107], a[252:255], a[108:111]
    v_mfma_f32_16x16x32_bf16 a[112:115], v[108:111], a[240:243], a[112:115]
    buffer_load_dwordx4 a[236:239], v20, s[12:15], s67 offen offset:3072 sc1
    v_mfma_f32_16x16x32_bf16 a[116:119], v[108:111], a[244:247], a[116:119]
    v_mfma_f32_16x16x32_bf16 a[120:123], v[108:111], a[248:251], a[120:123]
    v_mfma_f32_16x16x32_bf16 a[124:127], v[108:111], a[252:255], a[124:127]
    s_add_u32 s67, s67, 131072
    s_waitcnt lgkmcnt(0)
    v_mfma_f32_16x16x32_bf16 a[0:3], v[48:51], a[128:131], a[0:3]
    ds_read_b64_tr_b16 v[80:81], v32 offset:40960
    v_mfma_f32_16x16x32_bf16 a[4:7], v[48:51], a[132:135], a[4:7]
    ds_read_b64_tr_b16 v[82:83], v32 offset:45056
    s_add_u32 m0, s69, 4096
    s_add_u32 s66, s66, 32768
    v_mfma_f32_16x16x32_bf16 a[8:11], v[48:51], a[136:139], a[8:11]
    ds_read_b64_tr_b16 v[84:85], v33 offset:40960
    buffer_load_dwordx4 v24, s[8:11], s66 offen offset:0 lds
    v_mfma_f32_16x16x32_bf16 a[12:15], v[48:51], a[140:143], a[12:15]
    ds_read_b64_tr_b16 v[86:87], v33 offset:45056
    v_mfma_f32_16x16x32_bf16 a[16:19], v[52:55], a[128:131], a[16:19]
    buffer_load_dwordx4 v25, s[8:11], s66 offen offset:1024 lds
    v_mfma_f32_16x16x32_bf16 a[20:23], v[52:55], a[132:135], a[20:23]
    ds_read_b64_tr_b16 v[88:89], v34 offset:40960
    v_mfma_f32_16x16x32_bf16 a[24:27], v[52:55], a[136:139], a[24:27]
    ds_read_b64_tr_b16 v[90:91], v34 offset:45056
    v_mfma_f32_16x16x32_bf16 a[28:31], v[52:55], a[140:143], a[28:31]
    ds_read_b64_tr_b16 v[92:93], v35 offset:40960
    v_mfma_f32_16x16x32_bf16 a[32:35], v[56:59], a[128:131], a[32:35]
    ds_read_b64_tr_b16 v[94:95], v35 offset:45056
    buffer_load_dwordx4 v26, s[8:11], s66 offen offset:2048 lds
    v_mfma_f32_16x16x32_bf16 a[36:39], v[56:59], a[132:135], a[36:39]
    v_mfma_f32_16x16x32_bf16 a[40:43], v[56:59], a[136:139], a[40:43]
    ds_read_b64_tr_b16 v[96:97], v36 offset:40960
    v_mfma_f32_16x16x32_bf16 a[44:47], v[56:59], a[140:143], a[44:47]
    ds_read_b64_tr_b16 v[98:99], v36 offset:45056
    v_mfma_f32_16x16x32_bf16 a[48:51], v[60:63], a[128:131], a[48:51]
    ds_read_b64_tr_b16 v[100:101], v37 offset:40960
    buffer_load_dwordx4 v27, s[8:11], s66 offen offset:3072 lds
    v_mfma_f32_16x16x32_bf16 a[52:55], v[60:63], a[132:135], a[52:55]
    ds_read_b64_tr_b16 v[102:103], v37 offset:45056
    v_mfma_f32_16x16x32_bf16 a[56:59], v[60:63], a[136:139], a[56:59]
    v_mfma_f32_16x16x32_bf16 a[60:63], v[60:63], a[140:143], a[60:63]
    ds_read_b64_tr_b16 v[104:105], v38 offset:40960
    v_mfma_f32_16x16x32_bf16 a[64:67], v[64:67], a[128:131], a[64:67]
    ds_read_b64_tr_b16 v[106:107], v38 offset:45056
    buffer_load_dwordx4 a[240:243], v20, s[12:15], s67 offen offset:0 sc1
    v_mfma_f32_16x16x32_bf16 a[68:71], v[64:67], a[132:135], a[68:71]
    ds_read_b64_tr_b16 v[108:109], v39 offset:40960
    v_mfma_f32_16x16x32_bf16 a[72:75], v[64:67], a[136:139], a[72:75]
    ds_read_b64_tr_b16 v[110:111], v39 offset:45056
    v_mfma_f32_16x16x32_bf16 a[76:79], v[64:67], a[140:143], a[76:79]
    v_mfma_f32_16x16x32_bf16 a[80:83], v[68:71], a[128:131], a[80:83]
    buffer_load_dwordx4 a[244:247], v20, s[12:15], s67 offen offset:1024 sc1
    v_mfma_f32_16x16x32_bf16 a[84:87], v[68:71], a[132:135], a[84:87]
    v_mfma_f32_16x16x32_bf16 a[88:91], v[68:71], a[136:139], a[88:91]
    v_mfma_f32_16x16x32_bf16 a[92:95], v[68:71], a[140:143], a[92:95]
    v_mfma_f32_16x16x32_bf16 a[96:99], v[72:75], a[128:131], a[96:99]
    buffer_load_dwordx4 a[248:251], v20, s[12:15], s67 offen offset:2048 sc1
    v_mfma_f32_16x16x32_bf16 a[100:103], v[72:75], a[132:135], a[100:103]
    v_mfma_f32_16x16x32_bf16 a[104:107], v[72:75], a[136:139], a[104:107]
    v_mfma_f32_16x16x32_bf16 a[108:111], v[72:75], a[140:143], a[108:111]
    v_mfma_f32_16x16x32_bf16 a[112:115], v[76:79], a[128:131], a[112:115]
    buffer_load_dwordx4 a[252:255], v20, s[12:15], s67 offen offset:3072 sc1
    v_mfma_f32_16x16x32_bf16 a[116:119], v[76:79], a[132:135], a[116:119]
    v_mfma_f32_16x16x32_bf16 a[120:123], v[76:79], a[136:139], a[120:123]
    v_mfma_f32_16x16x32_bf16 a[124:127], v[76:79], a[140:143], a[124:127]
    s_add_u32 s67, s67, 393216
    s_waitcnt vmcnt(32) lgkmcnt(0)
    s_barrier
    v_mfma_f32_16x16x32_bf16 a[0:3], v[80:83], a[144:147], a[0:3]
    ds_read_b64_tr_b16 v[48:49], v40 offset:0
    v_mfma_f32_16x16x32_bf16 a[4:7], v[80:83], a[148:151], a[4:7]
    ds_read_b64_tr_b16 v[50:51], v40 offset:4096
    s_add_u32 m0, s69, 32768
    s_add_u32 s66, s66, 229376
    v_mfma_f32_16x16x32_bf16 a[8:11], v[80:83], a[152:155], a[8:11]
    ds_read_b64_tr_b16 v[52:53], v41 offset:0
    buffer_load_dwordx4 v24, s[8:11], s66 offen offset:0 lds
    v_mfma_f32_16x16x32_bf16 a[12:15], v[80:83], a[156:159], a[12:15]
    ds_read_b64_tr_b16 v[54:55], v41 offset:4096
    v_mfma_f32_16x16x32_bf16 a[16:19], v[84:87], a[144:147], a[16:19]
    buffer_load_dwordx4 v25, s[8:11], s66 offen offset:1024 lds
    v_mfma_f32_16x16x32_bf16 a[20:23], v[84:87], a[148:151], a[20:23]
    ds_read_b64_tr_b16 v[56:57], v42 offset:0
    v_mfma_f32_16x16x32_bf16 a[24:27], v[84:87], a[152:155], a[24:27]
    ds_read_b64_tr_b16 v[58:59], v42 offset:4096
    v_mfma_f32_16x16x32_bf16 a[28:31], v[84:87], a[156:159], a[28:31]
    ds_read_b64_tr_b16 v[60:61], v43 offset:0
    v_mfma_f32_16x16x32_bf16 a[32:35], v[88:91], a[144:147], a[32:35]
    ds_read_b64_tr_b16 v[62:63], v43 offset:4096
    buffer_load_dwordx4 v26, s[8:11], s66 offen offset:2048 lds
    v_mfma_f32_16x16x32_bf16 a[36:39], v[88:91], a[148:151], a[36:39]
    v_mfma_f32_16x16x32_bf16 a[40:43], v[88:91], a[152:155], a[40:43]
    ds_read_b64_tr_b16 v[64:65], v44 offset:0
    v_mfma_f32_16x16x32_bf16 a[44:47], v[88:91], a[156:159], a[44:47]
    ds_read_b64_tr_b16 v[66:67], v44 offset:4096
    v_mfma_f32_16x16x32_bf16 a[48:51], v[92:95], a[144:147], a[48:51]
    ds_read_b64_tr_b16 v[68:69], v45 offset:0
    buffer_load_dwordx4 v27, s[8:11], s66 offen offset:3072 lds
    v_mfma_f32_16x16x32_bf16 a[52:55], v[92:95], a[148:151], a[52:55]
    ds_read_b64_tr_b16 v[70:71], v45 offset:4096
    v_mfma_f32_16x16x32_bf16 a[56:59], v[92:95], a[152:155], a[56:59]
    v_mfma_f32_16x16x32_bf16 a[60:63], v[92:95], a[156:159], a[60:63]
    ds_read_b64_tr_b16 v[72:73], v46 offset:0
    v_mfma_f32_16x16x32_bf16 a[64:67], v[96:99], a[144:147], a[64:67]
    ds_read_b64_tr_b16 v[74:75], v46 offset:4096
    buffer_load_dwordx4 a[128:131], v20, s[12:15], s67 offen offset:0 sc1
    v_mfma_f32_16x16x32_bf16 a[68:71], v[96:99], a[148:151], a[68:71]
    ds_read_b64_tr_b16 v[76:77], v47 offset:0
    v_mfma_f32_16x16x32_bf16 a[72:75], v[96:99], a[152:155], a[72:75]
    ds_read_b64_tr_b16 v[78:79], v47 offset:4096
    v_mfma_f32_16x16x32_bf16 a[76:79], v[96:99], a[156:159], a[76:79]
    v_mfma_f32_16x16x32_bf16 a[80:83], v[100:103], a[144:147], a[80:83]
    buffer_load_dwordx4 a[132:135], v20, s[12:15], s67 offen offset:1024 sc1
    v_mfma_f32_16x16x32_bf16 a[84:87], v[100:103], a[148:151], a[84:87]
    v_mfma_f32_16x16x32_bf16 a[88:91], v[100:103], a[152:155], a[88:91]
    v_mfma_f32_16x16x32_bf16 a[92:95], v[100:103], a[156:159], a[92:95]
    v_mfma_f32_16x16x32_bf16 a[96:99], v[104:107], a[144:147], a[96:99]
    buffer_load_dwordx4 a[136:139], v20, s[12:15], s67 offen offset:2048 sc1
    v_mfma_f32_16x16x32_bf16 a[100:103], v[104:107], a[148:151], a[100:103]
    v_mfma_f32_16x16x32_bf16 a[104:107], v[104:107], a[152:155], a[104:107]
    v_mfma_f32_16x16x32_bf16 a[108:111], v[104:107], a[156:159], a[108:111]
    v_mfma_f32_16x16x32_bf16 a[112:115], v[108:111], a[144:147], a[112:115]
    buffer_load_dwordx4 a[140:143], v20, s[12:15], s67 offen offset:3072 sc1
    v_mfma_f32_16x16x32_bf16 a[116:119], v[108:111], a[148:151], a[116:119]
    v_mfma_f32_16x16x32_bf16 a[120:123], v[108:111], a[152:155], a[120:123]
    v_mfma_f32_16x16x32_bf16 a[124:127], v[108:111], a[156:159], a[124:127]
    s_add_u32 s67, s67, 131072
    s_waitcnt lgkmcnt(0)
    v_mfma_f32_16x16x32_bf16 a[0:3], v[48:51], a[160:163], a[0:3]
    ds_read_b64_tr_b16 v[80:81], v40 offset:8192
    v_mfma_f32_16x16x32_bf16 a[4:7], v[48:51], a[164:167], a[4:7]
    ds_read_b64_tr_b16 v[82:83], v40 offset:12288
    s_add_u32 m0, s69, 36864
    s_add_u32 s66, s66, 32768
    v_mfma_f32_16x16x32_bf16 a[8:11], v[48:51], a[168:171], a[8:11]
    ds_read_b64_tr_b16 v[84:85], v41 offset:8192
    buffer_load_dwordx4 v24, s[8:11], s66 offen offset:0 lds
    v_mfma_f32_16x16x32_bf16 a[12:15], v[48:51], a[172:175], a[12:15]
    ds_read_b64_tr_b16 v[86:87], v41 offset:12288
    v_mfma_f32_16x16x32_bf16 a[16:19], v[52:55], a[160:163], a[16:19]
    buffer_load_dwordx4 v25, s[8:11], s66 offen offset:1024 lds
    v_mfma_f32_16x16x32_bf16 a[20:23], v[52:55], a[164:167], a[20:23]
    ds_read_b64_tr_b16 v[88:89], v42 offset:8192
    v_mfma_f32_16x16x32_bf16 a[24:27], v[52:55], a[168:171], a[24:27]
    ds_read_b64_tr_b16 v[90:91], v42 offset:12288
    v_mfma_f32_16x16x32_bf16 a[28:31], v[52:55], a[172:175], a[28:31]
    ds_read_b64_tr_b16 v[92:93], v43 offset:8192
    v_mfma_f32_16x16x32_bf16 a[32:35], v[56:59], a[160:163], a[32:35]
    ds_read_b64_tr_b16 v[94:95], v43 offset:12288
    buffer_load_dwordx4 v26, s[8:11], s66 offen offset:2048 lds
    v_mfma_f32_16x16x32_bf16 a[36:39], v[56:59], a[164:167], a[36:39]
    v_mfma_f32_16x16x32_bf16 a[40:43], v[56:59], a[168:171], a[40:43]
    ds_read_b64_tr_b16 v[96:97], v44 offset:8192
    v_mfma_f32_16x16x32_bf16 a[44:47], v[56:59], a[172:175], a[44:47]
    ds_read_b64_tr_b16 v[98:99], v44 offset:12288
    v_mfma_f32_16x16x32_bf16 a[48:51], v[60:63], a[160:163], a[48:51]
    ds_read_b64_tr_b16 v[100:101], v45 offset:8192
    buffer_load_dwordx4 v27, s[8:11], s66 offen offset:3072 lds
    v_mfma_f32_16x16x32_bf16 a[52:55], v[60:63], a[164:167], a[52:55]
    ds_read_b64_tr_b16 v[102:103], v45 offset:12288
    v_mfma_f32_16x16x32_bf16 a[56:59], v[60:63], a[168:171], a[56:59]
    v_mfma_f32_16x16x32_bf16 a[60:63], v[60:63], a[172:175], a[60:63]
    ds_read_b64_tr_b16 v[104:105], v46 offset:8192
    v_mfma_f32_16x16x32_bf16 a[64:67], v[64:67], a[160:163], a[64:67]
    ds_read_b64_tr_b16 v[106:107], v46 offset:12288
    buffer_load_dwordx4 a[144:147], v20, s[12:15], s67 offen offset:0 sc1
    v_mfma_f32_16x16x32_bf16 a[68:71], v[64:67], a[164:167], a[68:71]
    ds_read_b64_tr_b16 v[108:109], v47 offset:8192
    v_mfma_f32_16x16x32_bf16 a[72:75], v[64:67], a[168:171], a[72:75]
    ds_read_b64_tr_b16 v[110:111], v47 offset:12288
    v_mfma_f32_16x16x32_bf16 a[76:79], v[64:67], a[172:175], a[76:79]
    v_mfma_f32_16x16x32_bf16 a[80:83], v[68:71], a[160:163], a[80:83]
    buffer_load_dwordx4 a[148:151], v20, s[12:15], s67 offen offset:1024 sc1
    v_mfma_f32_16x16x32_bf16 a[84:87], v[68:71], a[164:167], a[84:87]
    v_mfma_f32_16x16x32_bf16 a[88:91], v[68:71], a[168:171], a[88:91]
    v_mfma_f32_16x16x32_bf16 a[92:95], v[68:71], a[172:175], a[92:95]
    v_mfma_f32_16x16x32_bf16 a[96:99], v[72:75], a[160:163], a[96:99]
    buffer_load_dwordx4 a[152:155], v20, s[12:15], s67 offen offset:2048 sc1
    v_mfma_f32_16x16x32_bf16 a[100:103], v[72:75], a[164:167], a[100:103]
    v_mfma_f32_16x16x32_bf16 a[104:107], v[72:75], a[168:171], a[104:107]
    v_mfma_f32_16x16x32_bf16 a[108:111], v[72:75], a[172:175], a[108:111]
    v_mfma_f32_16x16x32_bf16 a[112:115], v[76:79], a[160:163], a[112:115]
    buffer_load_dwordx4 a[156:159], v20, s[12:15], s67 offen offset:3072 sc1
    v_mfma_f32_16x16x32_bf16 a[116:119], v[76:79], a[164:167], a[116:119]
    v_mfma_f32_16x16x32_bf16 a[120:123], v[76:79], a[168:171], a[120:123]
    v_mfma_f32_16x16x32_bf16 a[124:127], v[76:79], a[172:175], a[124:127]
    s_add_u32 s67, s67, 393216
    s_waitcnt vmcnt(32) lgkmcnt(0)
    s_barrier
    v_mfma_f32_16x16x32_bf16 a[0:3], v[80:83], a[176:179], a[0:3]
    ds_read_b64_tr_b16 v[48:49], v40 offset:32768
    v_mfma_f32_16x16x32_bf16 a[4:7], v[80:83], a[180:183], a[4:7]
    ds_read_b64_tr_b16 v[50:51], v40 offset:36864
    s_add_u32 m0, s69, 98304
    s_add_u32 s66, s66, 229376
    v_mfma_f32_16x16x32_bf16 a[8:11], v[80:83], a[184:187], a[8:11]
    ds_read_b64_tr_b16 v[52:53], v41 offset:32768
    buffer_load_dwordx4 v24, s[8:11], s66 offen offset:0 lds
    v_mfma_f32_16x16x32_bf16 a[12:15], v[80:83], a[188:191], a[12:15]
    ds_read_b64_tr_b16 v[54:55], v41 offset:36864
    v_mfma_f32_16x16x32_bf16 a[16:19], v[84:87], a[176:179], a[16:19]
    buffer_load_dwordx4 v25, s[8:11], s66 offen offset:1024 lds
    v_mfma_f32_16x16x32_bf16 a[20:23], v[84:87], a[180:183], a[20:23]
    ds_read_b64_tr_b16 v[56:57], v42 offset:32768
    v_mfma_f32_16x16x32_bf16 a[24:27], v[84:87], a[184:187], a[24:27]
    ds_read_b64_tr_b16 v[58:59], v42 offset:36864
    v_mfma_f32_16x16x32_bf16 a[28:31], v[84:87], a[188:191], a[28:31]
    ds_read_b64_tr_b16 v[60:61], v43 offset:32768
    v_mfma_f32_16x16x32_bf16 a[32:35], v[88:91], a[176:179], a[32:35]
    ds_read_b64_tr_b16 v[62:63], v43 offset:36864
    buffer_load_dwordx4 v26, s[8:11], s66 offen offset:2048 lds
    v_mfma_f32_16x16x32_bf16 a[36:39], v[88:91], a[180:183], a[36:39]
    v_mfma_f32_16x16x32_bf16 a[40:43], v[88:91], a[184:187], a[40:43]
    ds_read_b64_tr_b16 v[64:65], v44 offset:32768
    v_mfma_f32_16x16x32_bf16 a[44:47], v[88:91], a[188:191], a[44:47]
    ds_read_b64_tr_b16 v[66:67], v44 offset:36864
    v_mfma_f32_16x16x32_bf16 a[48:51], v[92:95], a[176:179], a[48:51]
    ds_read_b64_tr_b16 v[68:69], v45 offset:32768
    buffer_load_dwordx4 v27, s[8:11], s66 offen offset:3072 lds
    v_mfma_f32_16x16x32_bf16 a[52:55], v[92:95], a[180:183], a[52:55]
    ds_read_b64_tr_b16 v[70:71], v45 offset:36864
    v_mfma_f32_16x16x32_bf16 a[56:59], v[92:95], a[184:187], a[56:59]
    v_mfma_f32_16x16x32_bf16 a[60:63], v[92:95], a[188:191], a[60:63]
    ds_read_b64_tr_b16 v[72:73], v46 offset:32768
    v_mfma_f32_16x16x32_bf16 a[64:67], v[96:99], a[176:179], a[64:67]
    ds_read_b64_tr_b16 v[74:75], v46 offset:36864
    buffer_load_dwordx4 a[160:163], v20, s[12:15], s67 offen offset:0 sc1
    v_mfma_f32_16x16x32_bf16 a[68:71], v[96:99], a[180:183], a[68:71]
    ds_read_b64_tr_b16 v[76:77], v47 offset:32768
    v_mfma_f32_16x16x32_bf16 a[72:75], v[96:99], a[184:187], a[72:75]
    ds_read_b64_tr_b16 v[78:79], v47 offset:36864
    v_mfma_f32_16x16x32_bf16 a[76:79], v[96:99], a[188:191], a[76:79]
    v_mfma_f32_16x16x32_bf16 a[80:83], v[100:103], a[176:179], a[80:83]
    buffer_load_dwordx4 a[164:167], v20, s[12:15], s67 offen offset:1024 sc1
    v_mfma_f32_16x16x32_bf16 a[84:87], v[100:103], a[180:183], a[84:87]
    v_mfma_f32_16x16x32_bf16 a[88:91], v[100:103], a[184:187], a[88:91]
    v_mfma_f32_16x16x32_bf16 a[92:95], v[100:103], a[188:191], a[92:95]
    v_mfma_f32_16x16x32_bf16 a[96:99], v[104:107], a[176:179], a[96:99]
    buffer_load_dwordx4 a[168:171], v20, s[12:15], s67 offen offset:2048 sc1
    v_mfma_f32_16x16x32_bf16 a[100:103], v[104:107], a[180:183], a[100:103]
    v_mfma_f32_16x16x32_bf16 a[104:107], v[104:107], a[184:187], a[104:107]
    v_mfma_f32_16x16x32_bf16 a[108:111], v[104:107], a[188:191], a[108:111]
    v_mfma_f32_16x16x32_bf16 a[112:115], v[108:111], a[176:179], a[112:115]
    buffer_load_dwordx4 a[172:175], v20, s[12:15], s67 offen offset:3072 sc1
    v_mfma_f32_16x16x32_bf16 a[116:119], v[108:111], a[180:183], a[116:119]
    v_mfma_f32_16x16x32_bf16 a[120:123], v[108:111], a[184:187], a[120:123]
    v_mfma_f32_16x16x32_bf16 a[124:127], v[108:111], a[188:191], a[124:127]
    s_add_u32 s67, s67, 131072
    s_sub_u32 s70, s70, 1
    s_cmp_eq_u32 s70, 1
    s_waitcnt lgkmcnt(0)
    s_cbranch_scc0 km_s_loop
    v_mfma_f32_16x16x32_bf16 a[0:3], v[48:51], a[192:195], a[0:3]
    ds_read_b64_tr_b16 v[80:81], v40 offset:40960
    s_lshl_b32 s84, s80, 6
    v_mfma_f32_16x16x32_bf16 a[4:7], v[48:51], a[196:199], a[4:7]
    ds_read_b64_tr_b16 v[82:83], v40 offset:45056
    s_add_u32 m0, s69, 102400
    v_mfma_f32_16x16x32_bf16 a[8:11], v[48:51], a[200:203], a[8:11]
    ds_read_b64_tr_b16 v[84:85], v41 offset:40960
    s_add_u32 s66, s66, 32768
    v_mfma_f32_16x16x32_bf16 a[12:15], v[48:51], a[204:207], a[12:15]
    ds_read_b64_tr_b16 v[86:87], v41 offset:45056
    buffer_load_dwordx4 v24, s[8:11], s66 offen offset:0 lds
    v_mfma_f32_16x16x32_bf16 a[16:19], v[52:55], a[192:195], a[16:19]
    buffer_load_dwordx4 v25, s[8:11], s66 offen offset:1024 lds
    s_add_u32 s84, s84, 20480
    v_mfma_f32_16x16x32_bf16 a[20:23], v[52:55], a[196:199], a[20:23]
    ds_read_b64_tr_b16 v[88:89], v42 offset:40960
    v_mov_b32 v22, s84
    v_mfma_f32_16x16x32_bf16 a[24:27], v[52:55], a[200:203], a[24:27]
    ds_read_b64_tr_b16 v[90:91], v42 offset:45056
    s_mov_b32 s28, s60
    v_mfma_f32_16x16x32_bf16 a[28:31], v[52:55], a[204:207], a[28:31]
    ds_read_b64_tr_b16 v[92:93], v43 offset:40960
    s_mov_b32 s29, s61
    v_mfma_f32_16x16x32_bf16 a[32:35], v[56:59], a[192:195], a[32:35]
    ds_read_b64_tr_b16 v[94:95], v43 offset:45056
    buffer_load_dwordx4 v26, s[8:11], s66 offen offset:2048 lds
    v_mfma_f32_16x16x32_bf16 a[36:39], v[56:59], a[196:199], a[36:39]
    s_mov_b32 s30, 0x400000
    s_mov_b32 s31, 0x00020000
    v_mfma_f32_16x16x32_bf16 a[40:43], v[56:59], a[200:203], a[40:43]
    ds_read_b64_tr_b16 v[96:97], v44 offset:40960
    v_xor_b32 v240, 0x4000, v40
    v_mfma_f32_16x16x32_bf16 a[44:47], v[56:59], a[204:207], a[44:47]
    ds_read_b64_tr_b16 v[98:99], v44 offset:45056
    v_xor_b32 v241, 0x4000, v41
    v_mfma_f32_16x16x32_bf16 a[48:51], v[60:63], a[192:195], a[48:51]
    ds_read_b64_tr_b16 v[100:101], v45 offset:40960
    buffer_load_dwordx4 v27, s[8:11], s66 offen offset:3072 lds
    v_mfma_f32_16x16x32_bf16 a[52:55], v[60:63], a[196:199], a[52:55]
    ds_read_b64_tr_b16 v[102:103], v45 offset:45056
    v_xor_b32 v242, 0x4000, v42
    v_mfma_f32_16x16x32_bf16 a[56:59], v[60:63], a[200:203], a[56:59]
    v_xor_b32 v243, 0x4000, v43
    s_lshl_b32 s85, s71, 14
    v_mfma_f32_16x16x32_bf16 a[60:63], v[60:63], a[204:207], a[60:63]
    ds_read_b64_tr_b16 v[104:105], v46 offset:40960
    s_add_u32 s85, s85, 0
    v_mfma_f32_16x16x32_bf16 a[64:67], v[64:67], a[192:195], a[64:67]
    ds_read_b64_tr_b16 v[106:107], v46 offset:45056
    buffer_load_dwordx4 a[176:179], v20, s[12:15], s67 offen offset:0 sc1
    v_mfma_f32_16x16x32_bf16 a[68:71], v[64:67], a[196:199], a[68:71]
    ds_read_b64_tr_b16 v[108:109], v47 offset:40960
    v_add_u32 v244, s85, v7
    v_mfma_f32_16x16x32_bf16 a[72:75], v[64:67], a[200:203], a[72:75]
    ds_read_b64_tr_b16 v[110:111], v47 offset:45056
    s_xor_b32 s85, s71, 2
    v_mfma_f32_16x16x32_bf16 a[76:79], v[64:67], a[204:207], a[76:79]
    s_lshl_b32 s85, s85, 14
    s_add_u32 s85, s85, 0
    v_mfma_f32_16x16x32_bf16 a[80:83], v[68:71], a[192:195], a[80:83]
    buffer_load_dwordx4 a[180:183], v20, s[12:15], s67 offen offset:1024 sc1
    v_add_u32 v245, s85, v7
    v_mfma_f32_16x16x32_bf16 a[84:87], v[68:71], a[196:199], a[84:87]
    v_permlane16_swap_b32 v112, v114
    v_permlane16_swap_b32 v113, v115
    v_mfma_f32_16x16x32_bf16 a[88:91], v[68:71], a[200:203], a[88:91]
    v_permlane16_swap_b32 v116, v118
    v_permlane16_swap_b32 v117, v119
    v_mfma_f32_16x16x32_bf16 a[92:95], v[68:71], a[204:207], a[92:95]
    v_permlane16_swap_b32 v120, v122
    v_permlane16_swap_b32 v121, v123
    v_mfma_f32_16x16x32_bf16 a[96:99], v[72:75], a[192:195], a[96:99]
    buffer_load_dwordx4 a[184:187], v20, s[12:15], s67 offen offset:2048 sc1
    v_permlane16_swap_b32 v124, v126
    v_mfma_f32_16x16x32_bf16 a[100:103], v[72:75], a[196:199], a[100:103]
    v_permlane16_swap_b32 v125, v127
    v_permlane16_swap_b32 v128, v130
    v_mfma_f32_16x16x32_bf16 a[104:107], v[72:75], a[200:203], a[104:107]
    v_permlane16_swap_b32 v129, v131
    v_permlane16_swap_b32 v132, v134
    v_mfma_f32_16x16x32_bf16 a[108:111], v[72:75], a[204:207], a[108:111]
    v_permlane16_swap_b32 v133, v135
    v_mfma_f32_16x16x32_bf16 a[112:115], v[76:79], a[192:195], a[112:115]
    buffer_load_dwordx4 a[188:191], v20, s[12:15], s67 offen offset:3072 sc1
    v_mfma_f32_16x16x32_bf16 a[116:119], v[76:79], a[196:199], a[116:119]
    v_mfma_f32_16x16x32_bf16 a[120:123], v[76:79], a[200:203], a[120:123]
    v_mfma_f32_16x16x32_bf16 a[124:127], v[76:79], a[204:207], a[124:127]
    s_add_u32 s67, s67, 393216
    s_waitcnt vmcnt(32) lgkmcnt(0)
    s_barrier
    v_mfma_f32_16x16x32_bf16 a[0:3], v[80:83], a[208:211], a[0:3]
    ds_read_b64_tr_b16 v[48:49], v32 offset:0
    v_permlane16_swap_b32 v136, v138
    v_mfma_f32_16x16x32_bf16 a[4:7], v[80:83], a[212:215], a[4:7]
    ds_read_b64_tr_b16 v[50:51], v32 offset:4096
    s_xor_b32 s88, s72, 1
    v_mfma_f32_16x16x32_bf16 a[8:11], v[80:83], a[216:219], a[8:11]
    ds_read_b64_tr_b16 v[52:53], v33 offset:0
    s_mul_i32 s88, s88, 262144
    v_mfma_f32_16x16x32_bf16 a[12:15], v[80:83], a[220:223], a[12:15]
    ds_read_b64_tr_b16 v[54:55], v33 offset:4096
    s_add_u32 s88, s88, 16252928
    v_mfma_f32_16x16x32_bf16 a[16:19], v[84:87], a[208:211], a[16:19]
    buffer_load_dwordx4 a[192:195], v20, s[12:15], s88 offen offset:0 sc1
    v_permlane16_swap_b32 v137, v139
    v_mfma_f32_16x16x32_bf16 a[20:23], v[84:87], a[212:215], a[20:23]
    ds_read_b64_tr_b16 v[56:57], v34 offset:0
    v_permlane16_swap_b32 v140, v142
    v_mfma_f32_16x16x32_bf16 a[24:27], v[84:87], a[216:219], a[24:27]
    ds_read_b64_tr_b16 v[58:59], v34 offset:4096
    v_permlane16_swap_b32 v141, v143
    v_mfma_f32_16x16x32_bf16 a[28:31], v[84:87], a[220:223], a[28:31]
    ds_read_b64_tr_b16 v[60:61], v35 offset:0
    v_mfma_f32_16x16x32_bf16 a[32:35], v[88:91], a[208:211], a[32:35]
    ds_read_b64_tr_b16 v[62:63], v35 offset:4096
    buffer_load_dwordx4 a[196:199], v20, s[12:15], s88 offen offset:1024 sc1
    v_mfma_f32_16x16x32_bf16 a[36:39], v[88:91], a[212:215], a[36:39]
    v_mfma_f32_16x16x32_bf16 a[40:43], v[88:91], a[216:219], a[40:43]
    ds_read_b64_tr_b16 v[64:65], v36 offset:0
    v_mfma_f32_16x16x32_bf16 a[44:47], v[88:91], a[220:223], a[44:47]
    ds_read_b64_tr_b16 v[66:67], v36 offset:4096
    v_mfma_f32_16x16x32_bf16 a[48:51], v[92:95], a[208:211], a[48:51]
    ds_read_b64_tr_b16 v[68:69], v37 offset:0
    v_mfma_f32_16x16x32_bf16 a[52:55], v[92:95], a[212:215], a[52:55]
    ds_read_b64_tr_b16 v[70:71], v37 offset:4096
    v_mfma_f32_16x16x32_bf16 a[56:59], v[92:95], a[216:219], a[56:59]
    v_mfma_f32_16x16x32_bf16 a[60:63], v[92:95], a[220:223], a[60:63]
    ds_read_b64_tr_b16 v[72:73], v38 offset:0
    v_mfma_f32_16x16x32_bf16 a[64:67], v[96:99], a[208:211], a[64:67]
    ds_read_b64_tr_b16 v[74:75], v38 offset:4096
    buffer_load_dwordx4 a[200:203], v20, s[12:15], s88 offen offset:2048 sc1
    v_mfma_f32_16x16x32_bf16 a[68:71], v[96:99], a[212:215], a[68:71]
    ds_read_b64_tr_b16 v[76:77], v39 offset:0
    v_mfma_f32_16x16x32_bf16 a[72:75], v[96:99], a[216:219], a[72:75]
    ds_read_b64_tr_b16 v[78:79], v39 offset:4096
    v_mfma_f32_16x16x32_bf16 a[76:79], v[96:99], a[220:223], a[76:79]
    v_mfma_f32_16x16x32_bf16 a[80:83], v[100:103], a[208:211], a[80:83]
    v_mfma_f32_16x16x32_bf16 a[84:87], v[100:103], a[212:215], a[84:87]
    v_mfma_f32_16x16x32_bf16 a[88:91], v[100:103], a[216:219], a[88:91]
    v_mfma_f32_16x16x32_bf16 a[92:95], v[100:103], a[220:223], a[92:95]
    v_mfma_f32_16x16x32_bf16 a[96:99], v[104:107], a[208:211], a[96:99]
    buffer_load_dwordx4 a[204:207], v20, s[12:15], s88 offen offset:3072 sc1
    v_mfma_f32_16x16x32_bf16 a[100:103], v[104:107], a[212:215], a[100:103]
    v_mfma_f32_16x16x32_bf16 a[104:107], v[104:107], a[216:219], a[104:107]
    v_mfma_f32_16x16x32_bf16 a[108:111], v[104:107], a[220:223], a[108:111]
    v_mfma_f32_16x16x32_bf16 a[112:115], v[108:111], a[208:211], a[112:115]
    v_mfma_f32_16x16x32_bf16 a[116:119], v[108:111], a[212:215], a[116:119]
    v_mfma_f32_16x16x32_bf16 a[120:123], v[108:111], a[216:219], a[120:123]
    v_mfma_f32_16x16x32_bf16 a[124:127], v[108:111], a[220:223], a[124:127]
    s_waitcnt lgkmcnt(0)
    v_mfma_f32_16x16x32_bf16 a[0:3], v[48:51], a[224:227], a[0:3]
    ds_read_b64_tr_b16 v[80:81], v32 offset:8192
    v_mfma_f32_16x16x32_bf16 a[4:7], v[48:51], a[228:231], a[4:7]
    ds_read_b64_tr_b16 v[82:83], v32 offset:12288
    s_xor_b32 s88, s72, 1
    s_mul_i32 s88, s88, 262144
    v_mfma_f32_16x16x32_bf16 a[8:11], v[48:51], a[232:235], a[8:11]
    ds_read_b64_tr_b16 v[84:85], v33 offset:8192
    s_add_u32 s88, s88, 16384000
    v_mfma_f32_16x16x32_bf16 a[12:15], v[48:51], a[236:239], a[12:15]
    ds_read_b64_tr_b16 v[86:87], v33 offset:12288
    buffer_load_dwordx4 a[208:211], v20, s[12:15], s88 offen offset:0 sc1
    v_mfma_f32_16x16x32_bf16 a[16:19], v[52:55], a[224:227], a[16:19]
    v_mfma_f32_16x16x32_bf16 a[20:23], v[52:55], a[228:231], a[20:23]
    ds_read_b64_tr_b16 v[88:89], v34 offset:8192
    v_mfma_f32_16x16x32_bf16 a[24:27], v[52:55], a[232:235], a[24:27]
    ds_read_b64_tr_b16 v[90:91], v34 offset:12288
    v_mfma_f32_16x16x32_bf16 a[28:31], v[52:55], a[236:239], a[28:31]
    ds_read_b64_tr_b16 v[92:93], v35 offset:8192
    v_mfma_f32_16x16x32_bf16 a[32:35], v[56:59], a[224:227], a[32:35]
    ds_read_b64_tr_b16 v[94:95], v35 offset:12288
    buffer_load_dwordx4 a[212:215], v20, s[12:15], s88 offen offset:1024 sc1
    v_mfma_f32_16x16x32_bf16 a[36:39], v[56:59], a[228:231], a[36:39]
    v_mfma_f32_16x16x32_bf16 a[40:43], v[56:59], a[232:235], a[40:43]
    ds_read_b64_tr_b16 v[96:97], v36 offset:8192
    v_mfma_f32_16x16x32_bf16 a[44:47], v[56:59], a[236:239], a[44:47]
    ds_read_b64_tr_b16 v[98:99], v36 offset:12288
    v_mfma_f32_16x16x32_bf16 a[48:51], v[60:63], a[224:227], a[48:51]
    ds_read_b64_tr_b16 v[100:101], v37 offset:8192
    v_mfma_f32_16x16x32_bf16 a[52:55], v[60:63], a[228:231], a[52:55]
    ds_read_b64_tr_b16 v[102:103], v37 offset:12288
    v_mfma_f32_16x16x32_bf16 a[56:59], v[60:63], a[232:235], a[56:59]
    v_mfma_f32_16x16x32_bf16 a[60:63], v[60:63], a[236:239], a[60:63]
    ds_read_b64_tr_b16 v[104:105], v38 offset:8192
    v_mfma_f32_16x16x32_bf16 a[64:67], v[64:67], a[224:227], a[64:67]
    ds_read_b64_tr_b16 v[106:107], v38 offset:12288
    buffer_load_dwordx4 a[216:219], v20, s[12:15], s88 offen offset:2048 sc1
    v_mfma_f32_16x16x32_bf16 a[68:71], v[64:67], a[228:231], a[68:71]
    ds_read_b64_tr_b16 v[108:109], v39 offset:8192
    v_mfma_f32_16x16x32_bf16 a[72:75], v[64:67], a[232:235], a[72:75]
    ds_read_b64_tr_b16 v[110:111], v39 offset:12288
    v_mfma_f32_16x16x32_bf16 a[76:79], v[64:67], a[236:239], a[76:79]
    v_mfma_f32_16x16x32_bf16 a[80:83], v[68:71], a[224:227], a[80:83]
    v_mfma_f32_16x16x32_bf16 a[84:87], v[68:71], a[228:231], a[84:87]
    v_mfma_f32_16x16x32_bf16 a[88:91], v[68:71], a[232:235], a[88:91]
    v_mfma_f32_16x16x32_bf16 a[92:95], v[68:71], a[236:239], a[92:95]
    v_mfma_f32_16x16x32_bf16 a[96:99], v[72:75], a[224:227], a[96:99]
    buffer_load_dwordx4 a[220:223], v20, s[12:15], s88 offen offset:3072 sc1
    v_mfma_f32_16x16x32_bf16 a[100:103], v[72:75], a[228:231], a[100:103]
    v_mfma_f32_16x16x32_bf16 a[104:107], v[72:75], a[232:235], a[104:107]
    v_mfma_f32_16x16x32_bf16 a[108:111], v[72:75], a[236:239], a[108:111]
    v_mfma_f32_16x16x32_bf16 a[112:115], v[76:79], a[224:227], a[112:115]
    v_mfma_f32_16x16x32_bf16 a[116:119], v[76:79], a[228:231], a[116:119]
    v_mfma_f32_16x16x32_bf16 a[120:123], v[76:79], a[232:235], a[120:123]
    v_mfma_f32_16x16x32_bf16 a[124:127], v[76:79], a[236:239], a[124:127]
    s_waitcnt vmcnt(24) lgkmcnt(0)
    s_barrier
    v_mfma_f32_16x16x32_bf16 a[0:3], v[80:83], a[240:243], a[0:3]
    ds_read_b64_tr_b16 v[48:49], v32 offset:32768
    v_mfma_f32_16x16x32_bf16 a[4:7], v[80:83], a[244:247], a[4:7]
    ds_read_b64_tr_b16 v[50:51], v32 offset:36864
    v_mfma_f32_16x16x32_bf16 a[8:11], v[80:83], a[248:251], a[8:11]
    ds_read_b64_tr_b16 v[52:53], v33 offset:32768
    v_mfma_f32_16x16x32_bf16 a[12:15], v[80:83], a[252:255], a[12:15]
    ds_read_b64_tr_b16 v[54:55], v33 offset:36864
    v_mfma_f32_16x16x32_bf16 a[16:19], v[84:87], a[240:243], a[16:19]
    v_mfma_f32_16x16x32_bf16 a[20:23], v[84:87], a[244:247], a[20:23]
    ds_read_b64_tr_b16 v[56:57], v34 offset:32768
    v_mfma_f32_16x16x32_bf16 a[24:27], v[84:87], a[248:251], a[24:27]
    ds_read_b64_tr_b16 v[58:59], v34 offset:36864
    v_mfma_f32_16x16x32_bf16 a[28:31], v[84:87], a[252:255], a[28:31]
    ds_read_b64_tr_b16 v[60:61], v35 offset:32768
    v_mfma_f32_16x16x32_bf16 a[32:35], v[88:91], a[240:243], a[32:35]
    ds_read_b64_tr_b16 v[62:63], v35 offset:36864
    v_mfma_f32_16x16x32_bf16 a[36:39], v[88:91], a[244:247], a[36:39]
    v_mfma_f32_16x16x32_bf16 a[40:43], v[88:91], a[248:251], a[40:43]
    ds_read_b64_tr_b16 v[64:65], v36 offset:32768
    v_mfma_f32_16x16x32_bf16 a[44:47], v[88:91], a[252:255], a[44:47]
    ds_read_b64_tr_b16 v[66:67], v36 offset:36864
    v_mfma_f32_16x16x32_bf16 a[48:51], v[92:95], a[240:243], a[48:51]
    ds_read_b64_tr_b16 v[68:69], v37 offset:32768
    v_mfma_f32_16x16x32_bf16 a[52:55], v[92:95], a[244:247], a[52:55]
    ds_read_b64_tr_b16 v[70:71], v37 offset:36864
    v_mfma_f32_16x16x32_bf16 a[56:59], v[92:95], a[248:251], a[56:59]
    v_mfma_f32_16x16x32_bf16 a[60:63], v[92:95], a[252:255], a[60:63]
    ds_read_b64_tr_b16 v[72:73], v38 offset:32768
    v_mfma_f32_16x16x32_bf16 a[64:67], v[96:99], a[240:243], a[64:67]
    ds_read_b64_tr_b16 v[74:75], v38 offset:36864
    v_mfma_f32_16x16x32_bf16 a[68:71], v[96:99], a[244:247], a[68:71]
    ds_read_b64_tr_b16 v[76:77], v39 offset:32768
    v_mfma_f32_16x16x32_bf16 a[72:75], v[96:99], a[248:251], a[72:75]
    ds_read_b64_tr_b16 v[78:79], v39 offset:36864
    v_mfma_f32_16x16x32_bf16 a[76:79], v[96:99], a[252:255], a[76:79]
    v_mfma_f32_16x16x32_bf16 a[80:83], v[100:103], a[240:243], a[80:83]
    v_mfma_f32_16x16x32_bf16 a[84:87], v[100:103], a[244:247], a[84:87]
    v_mfma_f32_16x16x32_bf16 a[88:91], v[100:103], a[248:251], a[88:91]
    v_mfma_f32_16x16x32_bf16 a[92:95], v[100:103], a[252:255], a[92:95]
    v_mfma_f32_16x16x32_bf16 a[96:99], v[104:107], a[240:243], a[96:99]
    v_mfma_f32_16x16x32_bf16 a[100:103], v[104:107], a[244:247], a[100:103]
    v_mfma_f32_16x16x32_bf16 a[104:107], v[104:107], a[248:251], a[104:107]
    v_mfma_f32_16x16x32_bf16 a[108:111], v[104:107], a[252:255], a[108:111]
    v_mfma_f32_16x16x32_bf16 a[112:115], v[108:111], a[240:243], a[112:115]
    v_mfma_f32_16x16x32_bf16 a[116:119], v[108:111], a[244:247], a[116:119]
    v_mfma_f32_16x16x32_bf16 a[120:123], v[108:111], a[248:251], a[120:123]
    v_mfma_f32_16x16x32_bf16 a[124:127], v[108:111], a[252:255], a[124:127]
    s_waitcnt lgkmcnt(0)
    buffer_load_dwordx2 v[16:17], v22, s[36:39], 0 offen sc1
    v_mfma_f32_16x16x32_bf16 a[0:3], v[48:51], a[128:131], a[0:3]
    ds_read_b64_tr_b16 v[80:81], v32 offset:40960
    v_mfma_f32_16x16x32_bf16 a[4:7], v[48:51], a[132:135], a[4:7]
    ds_read_b64_tr_b16 v[82:83], v32 offset:45056
    v_mfma_f32_16x16x32_bf16 a[8:11], v[48:51], a[136:139], a[8:11]
    ds_read_b64_tr_b16 v[84:85], v33 offset:40960
    v_mfma_f32_16x16x32_bf16 a[12:15], v[48:51], a[140:143], a[12:15]
    ds_read_b64_tr_b16 v[86:87], v33 offset:45056
    v_mfma_f32_16x16x32_bf16 a[16:19], v[52:55], a[128:131], a[16:19]
    v_mfma_f32_16x16x32_bf16 a[20:23], v[52:55], a[132:135], a[20:23]
    ds_read_b64_tr_b16 v[88:89], v34 offset:40960
    v_mfma_f32_16x16x32_bf16 a[24:27], v[52:55], a[136:139], a[24:27]
    ds_read_b64_tr_b16 v[90:91], v34 offset:45056
    v_mfma_f32_16x16x32_bf16 a[28:31], v[52:55], a[140:143], a[28:31]
    ds_read_b64_tr_b16 v[92:93], v35 offset:40960
    v_mfma_f32_16x16x32_bf16 a[32:35], v[56:59], a[128:131], a[32:35]
    ds_read_b64_tr_b16 v[94:95], v35 offset:45056
    v_mfma_f32_16x16x32_bf16 a[36:39], v[56:59], a[132:135], a[36:39]
    v_mfma_f32_16x16x32_bf16 a[40:43], v[56:59], a[136:139], a[40:43]
    ds_read_b64_tr_b16 v[96:97], v36 offset:40960
    v_mfma_f32_16x16x32_bf16 a[44:47], v[56:59], a[140:143], a[44:47]
    ds_read_b64_tr_b16 v[98:99], v36 offset:45056
    v_mfma_f32_16x16x32_bf16 a[48:51], v[60:63], a[128:131], a[48:51]
    ds_read_b64_tr_b16 v[100:101], v37 offset:40960
    v_mfma_f32_16x16x32_bf16 a[52:55], v[60:63], a[132:135], a[52:55]
    ds_read_b64_tr_b16 v[102:103], v37 offset:45056
    v_mfma_f32_16x16x32_bf16 a[56:59], v[60:63], a[136:139], a[56:59]
    v_mfma_f32_16x16x32_bf16 a[60:63], v[60:63], a[140:143], a[60:63]
    ds_read_b64_tr_b16 v[104:105], v38 offset:40960
    v_mfma_f32_16x16x32_bf16 a[64:67], v[64:67], a[128:131], a[64:67]
    ds_read_b64_tr_b16 v[106:107], v38 offset:45056
    v_mfma_f32_16x16x32_bf16 a[68:71], v[64:67], a[132:135], a[68:71]
    ds_read_b64_tr_b16 v[108:109], v39 offset:40960
    v_mfma_f32_16x16x32_bf16 a[72:75], v[64:67], a[136:139], a[72:75]
    ds_read_b64_tr_b16 v[110:111], v39 offset:45056
    v_mfma_f32_16x16x32_bf16 a[76:79], v[64:67], a[140:143], a[76:79]
    v_mfma_f32_16x16x32_bf16 a[80:83], v[68:71], a[128:131], a[80:83]
    v_mfma_f32_16x16x32_bf16 a[84:87], v[68:71], a[132:135], a[84:87]
    v_mfma_f32_16x16x32_bf16 a[88:91], v[68:71], a[136:139], a[88:91]
    v_mfma_f32_16x16x32_bf16 a[92:95], v[68:71], a[140:143], a[92:95]
    v_mfma_f32_16x16x32_bf16 a[96:99], v[72:75], a[128:131], a[96:99]
    v_mfma_f32_16x16x32_bf16 a[100:103], v[72:75], a[132:135], a[100:103]
    v_mfma_f32_16x16x32_bf16 a[104:107], v[72:75], a[136:139], a[104:107]
    v_mfma_f32_16x16x32_bf16 a[108:111], v[72:75], a[140:143], a[108:111]
    v_mfma_f32_16x16x32_bf16 a[112:115], v[76:79], a[128:131], a[112:115]
    v_mfma_f32_16x16x32_bf16 a[116:119], v[76:79], a[132:135], a[116:119]
    v_mfma_f32_16x16x32_bf16 a[120:123], v[76:79], a[136:139], a[120:123]
    v_mfma_f32_16x16x32_bf16 a[124:127], v[76:79], a[140:143], a[124:127]
    s_waitcnt vmcnt(0)
    v_cmp_ne_u64 vcc, s[50:51], v[16:17]
    s_cbranch_vccnz km_sg1
    s_mov_b32 s101, 1
    s_add_u32 s32, s64, 0x2000000
    s_addc_u32 s33, s65, 0
    s_mov_b32 s34, 0x400000
    s_mov_b32 s35, 0x00020000
    s_lshl_b32 s84, s80, 15
    s_lshl_b32 s85, s72, 14
    s_add_u32 s84, s84, s85
    s_lshl_b32 s85, s73, 12
    s_add_u32 s84, s84, s85
    s_add_u32 s85, s84, 8192
    buffer_load_dwordx4 v[208:211], v7, s[32:35], s84 offen offset:0 sc1
    buffer_load_dwordx4 v[212:215], v7, s[32:35], s84 offen offset:1024 sc1
    buffer_load_dwordx4 v[216:219], v7, s[32:35], s84 offen offset:2048 sc1
    buffer_load_dwordx4 v[220:223], v7, s[32:35], s84 offen offset:3072 sc1
    buffer_load_dwordx4 v[224:227], v7, s[32:35], s85 offen offset:0 sc1
    buffer_load_dwordx4 v[228:231], v7, s[32:35], s85 offen offset:1024 sc1
    buffer_load_dwordx4 v[232:235], v7, s[32:35], s85 offen offset:2048 sc1
    buffer_load_dwordx4 v[236:239], v7, s[32:35], s85 offen offset:3072 sc1
km_sg1:
    s_waitcnt vmcnt(63) lgkmcnt(0)
    s_barrier
    v_mfma_f32_16x16x32_bf16 a[0:3], v[80:83], a[144:147], a[0:3]
    ds_read_b64_tr_b16 v[48:49], v40 offset:0
    v_mfma_f32_16x16x32_bf16 a[4:7], v[80:83], a[148:151], a[4:7]
    ds_read_b64_tr_b16 v[50:51], v40 offset:4096
    v_mfma_f32_16x16x32_bf16 a[8:11], v[80:83], a[152:155], a[8:11]
    ds_read_b64_tr_b16 v[52:53], v41 offset:0
    v_mfma_f32_16x16x32_bf16 a[12:15], v[80:83], a[156:159], a[12:15]
    ds_read_b64_tr_b16 v[54:55], v41 offset:4096
    v_mfma_f32_16x16x32_bf16 a[16:19], v[84:87], a[144:147], a[16:19]
    v_mfma_f32_16x16x32_bf16 a[20:23], v[84:87], a[148:151], a[20:23]
    ds_read_b64_tr_b16 v[56:57], v42 offset:0
    v_mfma_f32_16x16x32_bf16 a[24:27], v[84:87], a[152:155], a[24:27]
    ds_read_b64_tr_b16 v[58:59], v42 offset:4096
    v_mfma_f32_16x16x32_bf16 a[28:31], v[84:87], a[156:159], a[28:31]
    ds_read_b64_tr_b16 v[60:61], v43 offset:0
    v_mfma_f32_16x16x32_bf16 a[32:35], v[88:91], a[144:147], a[32:35]
    ds_read_b64_tr_b16 v[62:63], v43 offset:4096
    v_mfma_f32_16x16x32_bf16 a[36:39], v[88:91], a[148:151], a[36:39]
    v_mfma_f32_16x16x32_bf16 a[40:43], v[88:91], a[152:155], a[40:43]
    ds_read_b64_tr_b16 v[64:65], v40 offset:8192
    v_mfma_f32_16x16x32_bf16 a[44:47], v[88:91], a[156:159], a[44:47]
    ds_read_b64_tr_b16 v[66:67], v40 offset:12288
    v_mfma_f32_16x16x32_bf16 a[48:51], v[92:95], a[144:147], a[48:51]
    ds_read_b64_tr_b16 v[68:69], v41 offset:8192
    v_mfma_f32_16x16x32_bf16 a[52:55], v[92:95], a[148:151], a[52:55]
    ds_read_b64_tr_b16 v[70:71], v41 offset:12288
    v_mfma_f32_16x16x32_bf16 a[56:59], v[92:95], a[152:155], a[56:59]
    v_mfma_f32_16x16x32_bf16 a[60:63], v[92:95], a[156:159], a[60:63]
    ds_read_b64_tr_b16 v[72:73], v42 offset:8192
    v_mfma_f32_16x16x32_bf16 a[64:67], v[96:99], a[144:147], a[64:67]
    ds_read_b64_tr_b16 v[74:75], v42 offset:12288
    v_mfma_f32_16x16x32_bf16 a[68:71], v[96:99], a[148:151], a[68:71]
    ds_read_b64_tr_b16 v[76:77], v43 offset:8192
    v_mfma_f32_16x16x32_bf16 a[72:75], v[96:99], a[152:155], a[72:75]
    ds_read_b64_tr_b16 v[78:79], v43 offset:12288
    v_mfma_f32_16x16x32_bf16 a[76:79], v[96:99], a[156:159], a[76:79]
    v_mfma_f32_16x16x32_bf16 a[80:83], v[100:103], a[144:147], a[80:83]
    v_mfma_f32_16x16x32_bf16 a[84:87], v[100:103], a[148:151], a[84:87]
    v_mfma_f32_16x16x32_bf16 a[88:91], v[100:103], a[152:155], a[88:91]
    v_mfma_f32_16x16x32_bf16 a[92:95], v[100:103], a[156:159], a[92:95]
    v_mfma_f32_16x16x32_bf16 a[96:99], v[104:107], a[144:147], a[96:99]
    v_mfma_f32_16x16x32_bf16 a[100:103], v[104:107], a[148:151], a[100:103]
    v_mfma_f32_16x16x32_bf16 a[104:107], v[104:107], a[152:155], a[104:107]
    v_mfma_f32_16x16x32_bf16 a[108:111], v[104:107], a[156:159], a[108:111]
    v_mfma_f32_16x16x32_bf16 a[112:115], v[108:111], a[144:147], a[112:115]
    v_mfma_f32_16x16x32_bf16 a[116:119], v[108:111], a[148:151], a[116:119]
    v_mfma_f32_16x16x32_bf16 a[120:123], v[108:111], a[152:155], a[120:123]
    v_mfma_f32_16x16x32_bf16 a[124:127], v[108:111], a[156:159], a[124:127]
    s_waitcnt lgkmcnt(0)
    buffer_load_dwordx2 v[16:17], v22, s[36:39], 0 offen sc1
    v_mfma_f32_16x16x32_bf16 a[0:3], v[48:51], a[160:163], a[0:3]
    ds_read_b64_tr_b16 v[80:81], v240 offset:0
    v_mfma_f32_16x16x32_bf16 a[4:7], v[48:51], a[164:167], a[4:7]
    ds_write_b128 v244, a[64:67] offset:0
    ds_read_b64_tr_b16 v[82:83], v240 offset:4096
    v_mfma_f32_16x16x32_bf16 a[8:11], v[48:51], a[168:171], a[8:11]
    ds_write_b128 v244, a[68:71] offset:1024
    v_mfma_f32_16x16x32_bf16 a[12:15], v[48:51], a[172:175], a[12:15]
    ds_write_b128 v244, a[72:75] offset:2048
    ds_read_b64_tr_b16 v[84:85], v241 offset:0
    v_mfma_f32_16x16x32_bf16 a[16:19], v[52:55], a[160:163], a[16:19]
    ds_read_b64_tr_b16 v[86:87], v241 offset:4096
    v_mfma_f32_16x16x32_bf16 a[20:23], v[52:55], a[164:167], a[20:23]
    ds_write_b128 v244, a[76:79] offset:3072
    v_mfma_f32_16x16x32_bf16 a[24:27], v[52:55], a[168:171], a[24:27]
    ds_write_b128 v244, a[80:83] offset:4096
    ds_read_b64_tr_b16 v[88:89], v242 offset:0
    v_mfma_f32_16x16x32_bf16 a[28:31], v[52:55], a[172:175], a[28:31]
    ds_read_b64_tr_b16 v[90:91], v242 offset:4096
    v_mfma_f32_16x16x32_bf16 a[32:35], v[56:59], a[160:163], a[32:35]
    ds_write_b128 v244, a[84:87] offset:5120
    v_mfma_f32_16x16x32_bf16 a[36:39], v[56:59], a[164:167], a[36:39]
    ds_write_b128 v244, a[88:91] offset:6144
    ds_read_b64_tr_b16 v[92:93], v243 offset:0
    v_mfma_f32_16x16x32_bf16 a[40:43], v[56:59], a[168:171], a[40:43]
    ds_read_b64_tr_b16 v[94:95], v243 offset:4096
    v_mfma_f32_16x16x32_bf16 a[44:47], v[56:59], a[172:175], a[44:47]
    ds_write_b128 v244, a[92:95] offset:7168
    v_mfma_f32_16x16x32_bf16 a[48:51], v[60:63], a[160:163], a[48:51]
    ds_write_b128 v244, a[96:99] offset:8192
    ds_read_b64_tr_b16 v[96:97], v240 offset:8192
    v_mfma_f32_16x16x32_bf16 a[52:55], v[60:63], a[164:167], a[52:55]
    ds_write_b128 v244, a[100:103] offset:9216
    ds_read_b64_tr_b16 v[98:99], v240 offset:12288
    v_mfma_f32_16x16x32_bf16 a[56:59], v[60:63], a[168:171], a[56:59]
    v_mfma_f32_16x16x32_bf16 a[60:63], v[60:63], a[172:175], a[60:63]
    ds_write_b128 v244, a[104:107] offset:10240
    ds_read_b64_tr_b16 v[100:101], v241 offset:8192
    v_mfma_f32_16x16x32_bf16 a[0:3], v[64:67], a[176:179], a[0:3]
    ds_write_b128 v244, a[108:111] offset:11264
    ds_read_b64_tr_b16 v[102:103], v241 offset:12288
    v_mfma_f32_16x16x32_bf16 a[4:7], v[64:67], a[180:183], a[4:7]
    v_mfma_f32_16x16x32_bf16 a[8:11], v[64:67], a[184:187], a[8:11]
    ds_write_b128 v244, a[112:115] offset:12288
    ds_read_b64_tr_b16 v[104:105], v242 offset:8192
    v_mfma_f32_16x16x32_bf16 a[12:15], v[64:67], a[188:191], a[12:15]
    ds_write_b128 v244, a[116:119] offset:13312
    ds_read_b64_tr_b16 v[106:107], v242 offset:12288
    v_mfma_f32_16x16x32_bf16 a[16:19], v[68:71], a[176:179], a[16:19]
    v_mfma_f32_16x16x32_bf16 a[20:23], v[68:71], a[180:183], a[20:23]
    ds_write_b128 v244, a[120:123] offset:14336
    ds_read_b64_tr_b16 v[108:109], v243 offset:8192
    v_mfma_f32_16x16x32_bf16 a[24:27], v[68:71], a[184:187], a[24:27]
    ds_write_b128 v244, a[124:127] offset:15360
    ds_read_b64_tr_b16 v[110:111], v243 offset:12288
    v_mfma_f32_16x16x32_bf16 a[28:31], v[68:71], a[188:191], a[28:31]
    v_mfma_f32_16x16x32_bf16 a[32:35], v[72:75], a[176:179], a[32:35]
    v_mfma_f32_16x16x32_bf16 a[36:39], v[72:75], a[180:183], a[36:39]
    v_mfma_f32_16x16x32_bf16 a[40:43], v[72:75], a[184:187], a[40:43]
    v_mfma_f32_16x16x32_bf16 a[44:47], v[72:75], a[188:191], a[44:47]
    v_mfma_f32_16x16x32_bf16 a[48:51], v[76:79], a[176:179], a[48:51]
    v_mfma_f32_16x16x32_bf16 a[52:55], v[76:79], a[180:183], a[52:55]
    v_mfma_f32_16x16x32_bf16 a[56:59], v[76:79], a[184:187], a[56:59]
    v_mfma_f32_16x16x32_bf16 a[60:63], v[76:79], a[188:191], a[60:63]
    s_waitcnt vmcnt(63) lgkmcnt(0)
    s_barrier
    v_mfma_f32_16x16x32_bf16 a[0:3], v[80:83], a[192:195], a[0:3]
    ds_read_b128 v[144:147], v245 offset:0
    v_mfma_f32_16x16x32_bf16 a[4:7], v[80:83], a[196:199], a[4:7]
    ds_read_b128 v[148:151], v245 offset:1024
    v_mfma_f32_16x16x32_bf16 a[8:11], v[80:83], a[200:203], a[8:11]
    ds_read_b128 v[152:155], v245 offset:2048
    v_mfma_f32_16x16x32_bf16 a[12:15], v[80:83], a[204:207], a[12:15]
    ds_read_b128 v[156:159], v245 offset:3072
    v_mfma_f32_16x16x32_bf16 a[16:19], v[84:87], a[192:195], a[16:19]
    v_mfma_f32_16x16x32_bf16 a[20:23], v[84:87], a[196:199], a[20:23]
    ds_read_b128 v[160:163], v245 offset:4096
    v_mfma_f32_16x16x32_bf16 a[24:27], v[84:87], a[200:203], a[24:27]
    ds_read_b128 v[164:167], v245 offset:5120
    v_mfma_f32_16x16x32_bf16 a[28:31], v[84:87], a[204:207], a[28:31]
    ds_read_b128 v[168:171], v245 offset:6144
    v_mfma_f32_16x16x32_bf16 a[32:35], v[88:91], a[192:195], a[32:35]
    ds_read_b128 v[172:175], v245 offset:7168
    v_mfma_f32_16x16x32_bf16 a[36:39], v[88:91], a[196:199], a[36:39]
    v_mfma_f32_16x16x32_bf16 a[40:43], v[88:91], a[200:203], a[40:43]
    ds_read_b128 v[176:179], v245 offset:8192
    v_mfma_f32_16x16x32_bf16 a[44:47], v[88:91], a[204:207], a[44:47]
    ds_read_b128 v[180:183], v245 offset:9216
    v_mfma_f32_16x16x32_bf16 a[48:51], v[92:95], a[192:195], a[48:51]
    ds_read_b128 v[184:187], v245 offset:10240
    v_mfma_f32_16x16x32_bf16 a[52:55], v[92:95], a[196:199], a[52:55]
    ds_read_b128 v[188:191], v245 offset:11264
    v_mfma_f32_16x16x32_bf16 a[56:59], v[92:95], a[200:203], a[56:59]
    v_mfma_f32_16x16x32_bf16 a[60:63], v[92:95], a[204:207], a[60:63]
    ds_read_b128 v[192:195], v245 offset:12288
    v_mfma_f32_16x16x32_bf16 a[0:3], v[96:99], a[208:211], a[0:3]
    ds_read_b128 v[196:199], v245 offset:13312
    v_mfma_f32_16x16x32_bf16 a[4:7], v[96:99], a[212:215], a[4:7]
    ds_read_b128 v[200:203], v245 offset:14336
    v_mfma_f32_16x16x32_bf16 a[8:11], v[96:99], a[216:219], a[8:11]
    ds_read_b128 v[204:207], v245 offset:15360
    v_mfma_f32_16x16x32_bf16 a[12:15], v[96:99], a[220:223], a[12:15]
    v_mfma_f32_16x16x32_bf16 a[16:19], v[100:103], a[208:211], a[16:19]
    v_mfma_f32_16x16x32_bf16 a[20:23], v[100:103], a[212:215], a[20:23]
    v_mfma_f32_16x16x32_bf16 a[24:27], v[100:103], a[216:219], a[24:27]
    v_mfma_f32_16x16x32_bf16 a[28:31], v[100:103], a[220:223], a[28:31]
    v_mfma_f32_16x16x32_bf16 a[32:35], v[104:107], a[208:211], a[32:35]
    v_mfma_f32_16x16x32_bf16 a[36:39], v[104:107], a[212:215], a[36:39]
    v_mfma_f32_16x16x32_bf16 a[40:43], v[104:107], a[216:219], a[40:43]
    v_mfma_f32_16x16x32_bf16 a[44:47], v[104:107], a[220:223], a[44:47]
    v_mfma_f32_16x16x32_bf16 a[48:51], v[108:111], a[208:211], a[48:51]
    v_mfma_f32_16x16x32_bf16 a[52:55], v[108:111], a[212:215], a[52:55]
    v_mfma_f32_16x16x32_bf16 a[56:59], v[108:111], a[216:219], a[56:59]
    v_mfma_f32_16x16x32_bf16 a[60:63], v[108:111], a[220:223], a[60:63]
    s_waitcnt lgkmcnt(0)
    s_cmp_eq_u32 s101, 1
    s_cbranch_scc1 km_gok
    s_waitcnt vmcnt(0)
    s_mov_b32 s83, 0
km_pg_chk:
    v_cmp_ne_u64 vcc, s[50:51], v[16:17]
    s_add_u32 s83, s83, 1
    s_cbranch_vccz km_pg_ok
    s_cmp_gt_u32 s83, 0x20000
    s_cbranch_scc1 km_pg_ok
    s_sleep 1
    buffer_load_dwordx2 v[16:17], v22, s[36:39], 0 offen sc1
    s_waitcnt vmcnt(0)
    s_branch km_pg_chk
km_pg_ok:
    s_add_u32 s32, s64, 0x2000000
    s_addc_u32 s33, s65, 0
    s_mov_b32 s34, 0x400000
    s_mov_b32 s35, 0x00020000
    s_lshl_b32 s84, s80, 15
    s_lshl_b32 s85, s72, 14
    s_add_u32 s84, s84, s85
    s_lshl_b32 s85, s73, 12
    s_add_u32 s84, s84, s85
    s_add_u32 s85, s84, 8192
    buffer_load_dwordx4 v[208:211], v7, s[32:35], s84 offen offset:0 sc1
    buffer_load_dwordx4 v[212:215], v7, s[32:35], s84 offen offset:1024 sc1
    buffer_load_dwordx4 v[216:219], v7, s[32:35], s84 offen offset:2048 sc1
    buffer_load_dwordx4 v[220:223], v7, s[32:35], s84 offen offset:3072 sc1
    buffer_load_dwordx4 v[224:227], v7, s[32:35], s85 offen offset:0 sc1
    buffer_load_dwordx4 v[228:231], v7, s[32:35], s85 offen offset:1024 sc1
    buffer_load_dwordx4 v[232:235], v7, s[32:35], s85 offen offset:2048 sc1
    buffer_load_dwordx4 v[236:239], v7, s[32:35], s85 offen offset:3072 sc1
km_gok:
    s_nop 4
    v_accvgpr_read_b32 v48, a0
    v_accvgpr_read_b32 v49, a1
    v_accvgpr_read_b32 v50, a2
    v_accvgpr_read_b32 v51, a3
    v_accvgpr_read_b32 v52, a4
    v_accvgpr_read_b32 v53, a5
    v_accvgpr_read_b32 v54, a6
    v_accvgpr_read_b32 v55, a7
    v_accvgpr_read_b32 v56, a8
    v_accvgpr_read_b32 v57, a9
    v_accvgpr_read_b32 v58, a10
    v_accvgpr_read_b32 v59, a11
    v_accvgpr_read_b32 v60, a12
    v_accvgpr_read_b32 v61, a13
    v_accvgpr_read_b32 v62, a14
    v_accvgpr_read_b32 v63, a15
    v_accvgpr_read_b32 v64, a16
    v_accvgpr_read_b32 v65, a17
    v_accvgpr_read_b32 v66, a18
    v_accvgpr_read_b32 v67, a19
    v_accvgpr_read_b32 v68, a20
    v_accvgpr_read_b32 v69, a21
    v_accvgpr_read_b32 v70, a22
    v_accvgpr_read_b32 v71, a23
    v_accvgpr_read_b32 v72, a24
    v_accvgpr_read_b32 v73, a25
    v_accvgpr_read_b32 v74, a26
    v_accvgpr_read_b32 v75, a27
    v_accvgpr_read_b32 v76, a28
    v_accvgpr_read_b32 v77, a29
    v_accvgpr_read_b32 v78, a30
    v_accvgpr_read_b32 v79, a31
    v_accvgpr_read_b32 v80, a32
    v_accvgpr_read_b32 v81, a33
    v_accvgpr_read_b32 v82, a34
    v_accvgpr_read_b32 v83, a35
    v_accvgpr_read_b32 v84, a36
    v_accvgpr_read_b32 v85, a37
    v_accvgpr_read_b32 v86, a38
    v_accvgpr_read_b32 v87, a39
    v_accvgpr_read_b32 v88, a40
    v_accvgpr_read_b32 v89, a41
    v_accvgpr_read_b32 v90, a42
    v_accvgpr_read_b32 v91, a43
    v_accvgpr_read_b32 v92, a44
    v_accvgpr_read_b32 v93, a45
    v_accvgpr_read_b32 v94, a46
    v_accvgpr_read_b32 v95, a47
    v_accvgpr_read_b32 v96, a48
    v_accvgpr_read_b32 v97, a49
    v_accvgpr_read_b32 v98, a50
    v_accvgpr_read_b32 v99, a51
    v_accvgpr_read_b32 v100, a52
    v_accvgpr_read_b32 v101, a53
    v_accvgpr_read_b32 v102, a54
    v_accvgpr_read_b32 v103, a55
    v_accvgpr_read_b32 v104, a56
    v_accvgpr_read_b32 v105, a57
    v_accvgpr_read_b32 v106, a58
    v_accvgpr_read_b32 v107, a59
    v_accvgpr_read_b32 v108, a60
    v_accvgpr_read_b32 v109, a61
    v_accvgpr_read_b32 v110, a62
    v_accvgpr_read_b32 v111, a63
    v_pk_add_f32 v[48:49], v[48:49], v[144:145]
    v_pk_add_f32 v[50:51], v[50:51], v[146:147]
    v_pk_add_f32 v[52:53], v[52:53], v[148:149]
    v_pk_add_f32 v[54:55], v[54:55], v[150:151]
    v_pk_add_f32 v[56:57], v[56:57], v[152:153]
    v_pk_add_f32 v[58:59], v[58:59], v[154:155]
    v_pk_add_f32 v[60:61], v[60:61], v[156:157]
    v_pk_add_f32 v[62:63], v[62:63], v[158:159]
    v_pk_add_f32 v[64:65], v[64:65], v[160:161]
    v_pk_add_f32 v[66:67], v[66:67], v[162:163]
    v_pk_add_f32 v[68:69], v[68:69], v[164:165]
    v_pk_add_f32 v[70:71], v[70:71], v[166:167]
    v_pk_add_f32 v[72:73], v[72:73], v[168:169]
    v_pk_add_f32 v[74:75], v[74:75], v[170:171]
    v_pk_add_f32 v[76:77], v[76:77], v[172:173]
    v_pk_add_f32 v[78:79], v[78:79], v[174:175]
    v_pk_add_f32 v[80:81], v[80:81], v[176:177]
    v_pk_add_f32 v[82:83], v[82:83], v[178:179]
    v_pk_add_f32 v[84:85], v[84:85], v[180:181]
    v_pk_add_f32 v[86:87], v[86:87], v[182:183]
    v_pk_add_f32 v[88:89], v[88:89], v[184:185]
    v_pk_add_f32 v[90:91], v[90:91], v[186:187]
    v_pk_add_f32 v[92:93], v[92:93], v[188:189]
    v_pk_add_f32 v[94:95], v[94:95], v[190:191]
    v_pk_add_f32 v[96:97], v[96:97], v[192:193]
    v_pk_add_f32 v[98:99], v[98:99], v[194:195]
    v_pk_add_f32 v[100:101], v[100:101], v[196:197]
    v_pk_add_f32 v[102:103], v[102:103], v[198:199]
    v_pk_add_f32 v[104:105], v[104:105], v[200:201]
    v_pk_add_f32 v[106:107], v[106:107], v[202:203]
    v_pk_add_f32 v[108:109], v[108:109], v[204:205]
    v_pk_add_f32 v[110:111], v[110:111], v[206:207]
    s_waitcnt vmcnt(0)
    v_lshlrev_b32 v144, 16, v208
    v_and_b32 v145, 0xffff0000, v208
    v_lshlrev_b32 v146, 16, v112
    v_and_b32 v147, 0xffff0000, v112
    v_pk_fma_f32 v[146:147], v[48:49], v[144:145], v[146:147]
    v_cvt_pk_bf16_f32 v160, v146, v147
    v_lshlrev_b32 v148, 16, v209
    v_and_b32 v149, 0xffff0000, v209
    v_lshlrev_b32 v150, 16, v113
    v_and_b32 v151, 0xffff0000, v113
    v_pk_fma_f32 v[150:151], v[50:51], v[148:149], v[150:151]
    v_cvt_pk_bf16_f32 v161, v150, v151
    v_lshlrev_b32 v152, 16, v210
    v_and_b32 v153, 0xffff0000, v210
    v_lshlrev_b32 v154, 16, v114
    v_and_b32 v155, 0xffff0000, v114
    v_pk_fma_f32 v[154:155], v[64:65], v[152:153], v[154:155]
    v_cvt_pk_bf16_f32 v162, v154, v155
    v_lshlrev_b32 v156, 16, v211
    v_and_b32 v157, 0xffff0000, v211
    v_lshlrev_b32 v158, 16, v115
    v_and_b32 v159, 0xffff0000, v115
    v_pk_fma_f32 v[158:159], v[66:67], v[156:157], v[158:159]
    v_cvt_pk_bf16_f32 v163, v158, v159
    s_nop 1
    v_permlane16_swap_b32 v160, v162
    v_permlane16_swap_b32 v161, v163
    s_nop 0
    buffer_store_dwordx4 v[160:163], v21, s[28:31], s4 offen offset:0
    v_lshlrev_b32 v144, 16, v212
    v_and_b32 v145, 0xffff0000, v212
    v_lshlrev_b32 v146, 16, v116
    v_and_b32 v147, 0xffff0000, v116
    v_pk_fma_f32 v[146:147], v[52:53], v[144:145], v[146:147]
    v_cvt_pk_bf16_f32 v164, v146, v147
    v_lshlrev_b32 v148, 16, v213
    v_and_b32 v149, 0xffff0000, v213
    v_lshlrev_b32 v150, 16, v117
    v_and_b32 v151, 0xffff0000, v117
    v_pk_fma_f32 v[150:151], v[54:55], v[148:149], v[150:151]
    v_cvt_pk_bf16_f32 v165, v150, v151
    v_lshlrev_b32 v152, 16, v214
    v_and_b32 v153, 0xffff0000, v214
    v_lshlrev_b32 v154, 16, v118
    v_and_b32 v155, 0xffff0000, v118
    v_pk_fma_f32 v[154:155], v[68:69], v[152:153], v[154:155]
    v_cvt_pk_bf16_f32 v166, v154, v155
    v_lshlrev_b32 v156, 16, v215
    v_and_b32 v157, 0xffff0000, v215
    v_lshlrev_b32 v158, 16, v119
    v_and_b32 v159, 0xffff0000, v119
    v_pk_fma_f32 v[158:159], v[70:71], v[156:157], v[158:159]
    v_cvt_pk_bf16_f32 v167, v158, v159
    s_nop 1
    v_permlane16_swap_b32 v164, v166
    v_permlane16_swap_b32 v165, v167
    s_nop 0
    buffer_store_dwordx4 v[164:167], v21, s[28:31], s5 offen offset:0
    v_lshlrev_b32 v144, 16, v216
    v_and_b32 v145, 0xffff0000, v216
    v_lshlrev_b32 v146, 16, v120
    v_and_b32 v147, 0xffff0000, v120
    v_pk_fma_f32 v[146:147], v[56:57], v[144:145], v[146:147]
    v_cvt_pk_bf16_f32 v160, v146, v147
    v_lshlrev_b32 v148, 16, v217
    v_and_b32 v149, 0xffff0000, v217
    v_lshlrev_b32 v150, 16, v121
    v_and_b32 v151, 0xffff0000, v121
    v_pk_fma_f32 v[150:151], v[58:59], v[148:149], v[150:151]
    v_cvt_pk_bf16_f32 v161, v150, v151
    v_lshlrev_b32 v152, 16, v218
    v_and_b32 v153, 0xffff0000, v218
    v_lshlrev_b32 v154, 16, v122
    v_and_b32 v155, 0xffff0000, v122
    v_pk_fma_f32 v[154:155], v[72:73], v[152:153], v[154:155]
    v_cvt_pk_bf16_f32 v162, v154, v155
    v_lshlrev_b32 v156, 16, v219
    v_and_b32 v157, 0xffff0000, v219
    v_lshlrev_b32 v158, 16, v123
    v_and_b32 v159, 0xffff0000, v123
    v_pk_fma_f32 v[158:159], v[74:75], v[156:157], v[158:159]
    v_cvt_pk_bf16_f32 v163, v158, v159
    s_nop 1
    v_permlane16_swap_b32 v160, v162
    v_permlane16_swap_b32 v161, v163
    s_nop 0
    buffer_store_dwordx4 v[160:163], v21, s[28:31], s6 offen offset:0
    v_lshlrev_b32 v144, 16, v220
    v_and_b32 v145, 0xffff0000, v220
    v_lshlrev_b32 v146, 16, v124
    v_and_b32 v147, 0xffff0000, v124
    v_pk_fma_f32 v[146:147], v[60:61], v[144:145], v[146:147]
    v_cvt_pk_bf16_f32 v164, v146, v147
    v_lshlrev_b32 v148, 16, v221
    v_and_b32 v149, 0xffff0000, v221
    v_lshlrev_b32 v150, 16, v125
    v_and_b32 v151, 0xffff0000, v125
    v_pk_fma_f32 v[150:151], v[62:63], v[148:149], v[150:151]
    v_cvt_pk_bf16_f32 v165, v150, v151
    v_lshlrev_b32 v152, 16, v222
    v_and_b32 v153, 0xffff0000, v222
    v_lshlrev_b32 v154, 16, v126
    v_and_b32 v155, 0xffff0000, v126
    v_pk_fma_f32 v[154:155], v[76:77], v[152:153], v[154:155]
    v_cvt_pk_bf16_f32 v166, v154, v155
    v_lshlrev_b32 v156, 16, v223
    v_and_b32 v157, 0xffff0000, v223
    v_lshlrev_b32 v158, 16, v127
    v_and_b32 v159, 0xffff0000, v127
    v_pk_fma_f32 v[158:159], v[78:79], v[156:157], v[158:159]
    v_cvt_pk_bf16_f32 v167, v158, v159
    s_nop 1
    v_permlane16_swap_b32 v164, v166
    v_permlane16_swap_b32 v165, v167
    s_nop 0
    buffer_store_dwordx4 v[164:167], v21, s[28:31], s7 offen offset:0
    v_lshlrev_b32 v144, 16, v224
    v_and_b32 v145, 0xffff0000, v224
    v_lshlrev_b32 v146, 16, v128
    v_and_b32 v147, 0xffff0000, v128
    v_pk_fma_f32 v[146:147], v[80:81], v[144:145], v[146:147]
    v_cvt_pk_bf16_f32 v160, v146, v147
    v_lshlrev_b32 v148, 16, v225
    v_and_b32 v149, 0xffff0000, v225
    v_lshlrev_b32 v150, 16, v129
    v_and_b32 v151, 0xffff0000, v129
    v_pk_fma_f32 v[150:151], v[82:83], v[148:149], v[150:151]
    v_cvt_pk_bf16_f32 v161, v150, v151
    v_lshlrev_b32 v152, 16, v226
    v_and_b32 v153, 0xffff0000, v226
    v_lshlrev_b32 v154, 16, v130
    v_and_b32 v155, 0xffff0000, v130
    v_pk_fma_f32 v[154:155], v[96:97], v[152:153], v[154:155]
    v_cvt_pk_bf16_f32 v162, v154, v155
    v_lshlrev_b32 v156, 16, v227
    v_and_b32 v157, 0xffff0000, v227
    v_lshlrev_b32 v158, 16, v131
    v_and_b32 v159, 0xffff0000, v131
    v_pk_fma_f32 v[158:159], v[98:99], v[156:157], v[158:159]
    v_cvt_pk_bf16_f32 v163, v158, v159
    s_nop 1
    v_permlane16_swap_b32 v160, v162
    v_permlane16_swap_b32 v161, v163
    s_nop 0
    buffer_store_dwordx4 v[160:163], v21, s[28:31], s4 offen offset:64
    v_lshlrev_b32 v144, 16, v228
    v_and_b32 v145, 0xffff0000, v228
    v_lshlrev_b32 v146, 16, v132
    v_and_b32 v147, 0xffff0000, v132
    v_pk_fma_f32 v[146:147], v[84:85], v[144:145], v[146:147]
    v_cvt_pk_bf16_f32 v164, v146, v147
    v_lshlrev_b32 v148, 16, v229
    v_and_b32 v149, 0xffff0000, v229
    v_lshlrev_b32 v150, 16, v133
    v_and_b32 v151, 0xffff0000, v133
    v_pk_fma_f32 v[150:151], v[86:87], v[148:149], v[150:151]
    v_cvt_pk_bf16_f32 v165, v150, v151
    v_lshlrev_b32 v152, 16, v230
    v_and_b32 v153, 0xffff0000, v230
    v_lshlrev_b32 v154, 16, v134
    v_and_b32 v155, 0xffff0000, v134
    v_pk_fma_f32 v[154:155], v[100:101], v[152:153], v[154:155]
    v_cvt_pk_bf16_f32 v166, v154, v155
    v_lshlrev_b32 v156, 16, v231
    v_and_b32 v157, 0xffff0000, v231
    v_lshlrev_b32 v158, 16, v135
    v_and_b32 v159, 0xffff0000, v135
    v_pk_fma_f32 v[158:159], v[102:103], v[156:157], v[158:159]
    v_cvt_pk_bf16_f32 v167, v158, v159
    s_nop 1
    v_permlane16_swap_b32 v164, v166
    v_permlane16_swap_b32 v165, v167
    s_nop 0
    buffer_store_dwordx4 v[164:167], v21, s[28:31], s5 offen offset:64
    v_lshlrev_b32 v144, 16, v232
    v_and_b32 v145, 0xffff0000, v232
    v_lshlrev_b32 v146, 16, v136
    v_and_b32 v147, 0xffff0000, v136
    v_pk_fma_f32 v[146:147], v[88:89], v[144:145], v[146:147]
    v_cvt_pk_bf16_f32 v160, v146, v147
    v_lshlrev_b32 v148, 16, v233
    v_and_b32 v149, 0xffff0000, v233
    v_lshlrev_b32 v150, 16, v137
    v_and_b32 v151, 0xffff0000, v137
    v_pk_fma_f32 v[150:151], v[90:91], v[148:149], v[150:151]
    v_cvt_pk_bf16_f32 v161, v150, v151
    v_lshlrev_b32 v152, 16, v234
    v_and_b32 v153, 0xffff0000, v234
    v_lshlrev_b32 v154, 16, v138
    v_and_b32 v155, 0xffff0000, v138
    v_pk_fma_f32 v[154:155], v[104:105], v[152:153], v[154:155]
    v_cvt_pk_bf16_f32 v162, v154, v155
    v_lshlrev_b32 v156, 16, v235
    v_and_b32 v157, 0xffff0000, v235
    v_lshlrev_b32 v158, 16, v139
    v_and_b32 v159, 0xffff0000, v139
    v_pk_fma_f32 v[158:159], v[106:107], v[156:157], v[158:159]
    v_cvt_pk_bf16_f32 v163, v158, v159
    s_nop 1
    v_permlane16_swap_b32 v160, v162
    v_permlane16_swap_b32 v161, v163
    s_nop 0
    buffer_store_dwordx4 v[160:163], v21, s[28:31], s6 offen offset:64
    v_lshlrev_b32 v144, 16, v236
    v_and_b32 v145, 0xffff0000, v236
    v_lshlrev_b32 v146, 16, v140
    v_and_b32 v147, 0xffff0000, v140
    v_pk_fma_f32 v[146:147], v[92:93], v[144:145], v[146:147]
    v_cvt_pk_bf16_f32 v164, v146, v147
    v_lshlrev_b32 v148, 16, v237
    v_and_b32 v149, 0xffff0000, v237
    v_lshlrev_b32 v150, 16, v141
    v_and_b32 v151, 0xffff0000, v141
    v_pk_fma_f32 v[150:151], v[94:95], v[148:149], v[150:151]
    v_cvt_pk_bf16_f32 v165, v150, v151
    v_lshlrev_b32 v152, 16, v238
    v_and_b32 v153, 0xffff0000, v238
    v_lshlrev_b32 v154, 16, v142
    v_and_b32 v155, 0xffff0000, v142
    v_pk_fma_f32 v[154:155], v[108:109], v[152:153], v[154:155]
    v_cvt_pk_bf16_f32 v166, v154, v155
    v_lshlrev_b32 v156, 16, v239
    v_and_b32 v157, 0xffff0000, v239
    v_lshlrev_b32 v158, 16, v143
    v_and_b32 v159, 0xffff0000, v143
    v_pk_fma_f32 v[158:159], v[110:111], v[156:157], v[158:159]
    v_cvt_pk_bf16_f32 v167, v158, v159
    s_nop 1
    v_permlane16_swap_b32 v164, v166
    v_permlane16_swap_b32 v165, v167
    s_nop 0
    buffer_store_dwordx4 v[164:167], v21, s[28:31], s7 offen offset:64
    s_endpgm
km_sigu:
    s_lshl_b32 s82, s77, 5
    s_add_u32 s82, s82, s76
    s_lshl_b32 s82, s82, 3
    s_add_u32 s82, s82, 18432
    v_mov_b32 v248, s50
    v_mov_b32 v249, s51
    v_lshlrev_b32 v250, 11, v0
    v_cmp_gt_u32 vcc, 1, v0
    s_and_saveexec_b64 s[84:85], vcc
    s_cbranch_execz 1f
    buffer_store_dwordx2 v[248:249], v250, s[36:39], s82 offen sc1
1:
    s_mov_b64 exec, s[84:85]
    s_branch km_sigu_ret
km_spi:
    buffer_load_dwordx2 v[16:17], v23, s[36:39], 0 offen sc1
    s_branch km_spi_ret
km_spc:
    s_mov_b32 s83, 0
km_pob_chk:
    v_cmp_ne_u64 vcc, s[50:51], v[16:17]
    s_add_u32 s83, s83, 1
    s_cbranch_vccz km_pob_ok
    s_cmp_gt_u32 s83, 0x20000
    s_cbranch_scc1 km_pob_ok
    s_sleep 2
    buffer_load_dwordx2 v[16:17], v23, s[36:39], 0 offen sc1
    s_waitcnt vmcnt(0)
    s_branch km_pob_chk
km_pob_ok:
    s_branch km_spc_ret
km_yprog:
    s_mov_b32 s28, s46
    s_mov_b32 s29, s47
    s_mov_b32 s30, 0x400000
    s_mov_b32 s31, 0x00020000
    s_xor_b32 s87, s71, 3
    s_lshl_b32 s87, s87, 5
    s_add_u32 s87, s87, s81
    s_lshl_b32 s87, s87, 2
    s_and_b32 s85, s2, 3
    s_add_u32 s87, s87, s85
    s_mul_i32 s87, s87, 16384
    s_add_u32 s87, s87, 1572864
    v_and_b32 v30, 31, v1
    v_min_u32 v30, 31, v30
    v_lshlrev_b32 v30, 7, v30
    v_lshrrev_b32 v162, 5, v1
    v_mul_u32_u24 v162, 8192, v162
    v_add_u32 v30, v30, v162
    buffer_load_dword v31, v30, s[28:31], s87 offen
    s_mov_b32 s28, s52
    s_mov_b32 s29, s53
    s_mov_b32 s30, 0x700000
    s_mov_b32 s31, 0x00020000
    s_xor_b32 s87, s71, 3
    s_lshl_b32 s87, s87, 5
    s_add_u32 s87, s87, s81
    s_lshl_b32 s87, s87, 2
    s_and_b32 s85, s2, 3
    s_add_u32 s87, s87, s85
    s_mul_i32 s87, s87, 14336
    s_add_u32 s87, s87, 1839104
    v_and_b32 v30, 31, v1
    v_min_u32 v30, 23, v30
    v_lshlrev_b32 v30, 7, v30
    v_lshrrev_b32 v162, 5, v1
    v_mul_u32_u24 v162, 7168, v162
    v_add_u32 v30, v30, v162
    buffer_load_dword v31, v30, s[28:31], s87 offen
    v_lshrrev_b32 v154, 4, v1
    v_and_b32 v155, 15, v1
    v_lshrrev_b32 v156, 2, v155
    v_and_b32 v157, 3, v155
    v_mov_b32 v26, 0
    v_mov_b32 v27, 0
    v_lshl_add_u32 v149, v154, 2, v156
    v_and_b32 v150, 7, v149
    s_lshl_b32 s84, s72, 2
    v_xor_b32 v150, s84, v150
    v_lshlrev_b32 v149, 8, v149
    v_lshl_add_u32 v149, v157, 3, v149
    s_lshl_b32 s84, s72, 14
    v_add_u32 v149, s84, v149
    v_xor_b32 v151, 0, v150
    v_lshl_add_u32 v32, v151, 5, v149
    v_add_u32 v40, 98304, v32
    v_xor_b32 v151, 1, v150
    v_lshl_add_u32 v33, v151, 5, v149
    v_add_u32 v41, 98304, v33
    v_xor_b32 v151, 2, v150
    v_lshl_add_u32 v34, v151, 5, v149
    v_add_u32 v42, 98304, v34
    v_xor_b32 v151, 3, v150
    v_lshl_add_u32 v35, v151, 5, v149
    v_add_u32 v43, 98304, v35
    v_xor_b32 v151, 4, v150
    v_lshl_add_u32 v36, v151, 5, v149
    v_add_u32 v44, 98304, v36
    v_xor_b32 v151, 5, v150
    v_lshl_add_u32 v37, v151, 5, v149
    v_add_u32 v45, 98304, v37
    v_xor_b32 v151, 6, v150
    v_lshl_add_u32 v38, v151, 5, v149
    v_add_u32 v46, 98304, v38
    v_xor_b32 v151, 7, v150
    v_lshl_add_u32 v39, v151, 5, v149
    v_add_u32 v47, 98304, v39
    s_waitcnt vmcnt(2)
    s_barrier
    s_lshl_b32 s82, s2, 3
    s_add_u32 s82, s82, 8192
    v_mov_b32 v248, s50
    v_mov_b32 v249, s51
    v_lshlrev_b32 v250, 11, v0
    v_cmp_gt_u32 vcc, 4, v0
    s_and_saveexec_b64 s[84:85], vcc
    s_cbranch_execz 1f
    buffer_store_dwordx2 v[248:249], v250, s[36:39], s82 offen sc1
1:
    s_mov_b64 exec, s[84:85]
    s_add_u32 s24, s64, 0x1000000
    s_addc_u32 s25, s65, 0
    s_mov_b32 s26, 0x5000000
    s_mov_b32 s27, 0x00020000
    s_and_b32 s84, s81, 3
    s_lshl_b32 s84, s84, 11
    s_add_u32 s84, s84, 8192
    v_add_u32 v30, s84, v7
    s_cmp_eq_u32 s3, 1
    s_cbranch_scc0 km_spare
    s_add_u32 m0, s69, 4096
    s_add_u32 s66, s66, 114688
    buffer_load_dwordx4 v8, s[8:11], s66 offen offset:0 lds
    buffer_load_dwordx4 v9, s[8:11], s66 offen offset:1024 lds
    buffer_load_dwordx4 v10, s[8:11], s66 offen offset:2048 lds
    buffer_load_dwordx4 v11, s[8:11], s66 offen offset:3072 lds
    s_add_u32 m0, s69, 32768
    s_add_u32 s66, s66, 802816
    buffer_load_dwordx4 v8, s[8:11], s66 offen offset:0 lds
    buffer_load_dwordx4 v9, s[8:11], s66 offen offset:1024 lds
    buffer_load_dwordx4 v10, s[8:11], s66 offen offset:2048 lds
    buffer_load_dwordx4 v11, s[8:11], s66 offen offset:3072 lds
    s_add_u32 m0, s69, 36864
    s_add_u32 s66, s66, 114688
    buffer_load_dwordx4 v8, s[8:11], s66 offen offset:0 lds
    buffer_load_dwordx4 v9, s[8:11], s66 offen offset:1024 lds
    buffer_load_dwordx4 v10, s[8:11], s66 offen offset:2048 lds
    buffer_load_dwordx4 v11, s[8:11], s66 offen offset:3072 lds
    s_add_u32 m0, s69, 98304
    s_add_u32 s66, s66, 802816
    buffer_load_dwordx4 v8, s[8:11], s66 offen offset:0 lds
    buffer_load_dwordx4 v9, s[8:11], s66 offen offset:1024 lds
    buffer_load_dwordx4 v10, s[8:11], s66 offen offset:2048 lds
    buffer_load_dwordx4 v11, s[8:11], s66 offen offset:3072 lds
    s_mov_b32 s32, s54
    s_mov_b32 s33, s55
    s_mov_b32 s34, 0x1c00
    s_mov_b32 s35, 0x00020000
    v_lshrrev_b32 v13, 4, v1
    v_lshlrev_b32 v13, 3, v13
    s_lshl_b32 s86, s76, 1
    s_add_u32 s86, s86, s72
    s_lshl_b32 s86, s86, 7
    buffer_load_dwordx2 v[144:145], v13, s[32:35], s86 offen offset:0
    buffer_load_dwordx2 v[146:147], v13, s[32:35], s86 offen offset:32
    buffer_load_dwordx2 v[148:149], v13, s[32:35], s86 offen offset:64
    buffer_load_dwordx2 v[150:151], v13, s[32:35], s86 offen offset:96
    s_cmp_lg_u32 s71, 0
    s_cbranch_scc1 km_py0
    buffer_load_dwordx4 v[248:251], v30, s[36:39], 0 offen sc1
    buffer_load_dwordx4 v[252:255], v30, s[36:39], 0 offen offset:1024 sc1
km_py0:
    s_mul_i32 s67, s72, 131072
    s_add_u32 s12, s64, 0x400000
    s_addc_u32 s13, s65, 0
    s_mov_b32 s14, 0x4400000
    s_mov_b32 s15, 0x00020000
    ds_read_b64_tr_b16 v[48:49], v40 offset:32768
    ds_read_b64_tr_b16 v[50:51], v40 offset:36864
    ds_read_b64_tr_b16 v[52:53], v41 offset:32768
    ds_read_b64_tr_b16 v[54:55], v41 offset:36864
    ds_read_b64_tr_b16 v[56:57], v42 offset:32768
    ds_read_b64_tr_b16 v[58:59], v42 offset:36864
    ds_read_b64_tr_b16 v[60:61], v43 offset:32768
    ds_read_b64_tr_b16 v[62:63], v43 offset:36864
    ds_read_b64_tr_b16 v[64:65], v44 offset:32768
    ds_read_b64_tr_b16 v[66:67], v44 offset:36864
    ds_read_b64_tr_b16 v[68:69], v45 offset:32768
    ds_read_b64_tr_b16 v[70:71], v45 offset:36864
    ds_read_b64_tr_b16 v[72:73], v46 offset:32768
    ds_read_b64_tr_b16 v[74:75], v46 offset:36864
    ds_read_b64_tr_b16 v[76:77], v47 offset:32768
    ds_read_b64_tr_b16 v[78:79], v47 offset:36864
    s_cmp_lg_u32 s71, 0
    s_cbranch_scc1 km_py_ok
    s_waitcnt vmcnt(0)
    s_mov_b32 s83, 0
km_py_chk:
    v_cmp_ne_u64 vcc, s[50:51], v[248:249]
    v_cmp_ne_u64 s[84:85], s[50:51], v[250:251]
    s_or_b64 vcc, vcc, s[84:85]
    v_cmp_ne_u64 s[84:85], s[50:51], v[252:253]
    s_or_b64 vcc, vcc, s[84:85]
    v_cmp_ne_u64 s[84:85], s[50:51], v[254:255]
    s_or_b64 vcc, vcc, s[84:85]
    s_add_u32 s83, s83, 1
    s_cbranch_vccz km_py_ok
    s_cmp_gt_u32 s83, 0x20000
    s_cbranch_scc1 km_py_ok
    s_sleep 1
    buffer_load_dwordx4 v[248:251], v30, s[36:39], 0 offen sc1
    buffer_load_dwordx4 v[252:255], v30, s[36:39], 0 offen offset:1024 sc1
    s_waitcnt vmcnt(0)
    s_branch km_py_chk
km_py_ok:
    s_barrier
    buffer_load_dwordx4 a[192:195], v12, s[12:15], s67 offen offset:0 sc1
    buffer_load_dwordx4 a[196:199], v12, s[12:15], s67 offen offset:1024 sc1
    buffer_load_dwordx4 a[200:203], v12, s[12:15], s67 offen offset:2048 sc1
    buffer_load_dwordx4 a[204:207], v12, s[12:15], s67 offen offset:3072 sc1
    s_add_u32 s67, s67, 65536
    buffer_load_dwordx4 a[208:211], v12, s[12:15], s67 offen offset:0 sc1
    buffer_load_dwordx4 a[212:215], v12, s[12:15], s67 offen offset:1024 sc1
    buffer_load_dwordx4 a[216:219], v12, s[12:15], s67 offen offset:2048 sc1
    buffer_load_dwordx4 a[220:223], v12, s[12:15], s67 offen offset:3072 sc1
    s_add_u32 s67, s67, 196608
    buffer_load_dwordx4 a[224:227], v12, s[12:15], s67 offen offset:0 sc1
    buffer_load_dwordx4 a[228:231], v12, s[12:15], s67 offen offset:1024 sc1
    buffer_load_dwordx4 a[232:235], v12, s[12:15], s67 offen offset:2048 sc1
    buffer_load_dwordx4 a[236:239], v12, s[12:15], s67 offen offset:3072 sc1
    s_add_u32 s67, s67, 65536
    buffer_load_dwordx4 a[240:243], v12, s[12:15], s67 offen offset:0 sc1
    buffer_load_dwordx4 a[244:247], v12, s[12:15], s67 offen offset:1024 sc1
    buffer_load_dwordx4 a[248:251], v12, s[12:15], s67 offen offset:2048 sc1
    buffer_load_dwordx4 a[252:255], v12, s[12:15], s67 offen offset:3072 sc1
    s_add_u32 s67, s67, 196608
    buffer_load_dwordx4 a[128:131], v12, s[12:15], s67 offen offset:0 sc1
    buffer_load_dwordx4 a[132:135], v12, s[12:15], s67 offen offset:1024 sc1
    buffer_load_dwordx4 a[136:139], v12, s[12:15], s67 offen offset:2048 sc1
    buffer_load_dwordx4 a[140:143], v12, s[12:15], s67 offen offset:3072 sc1
    s_add_u32 s67, s67, 65536
    buffer_load_dwordx4 a[144:147], v12, s[12:15], s67 offen offset:0 sc1
    buffer_load_dwordx4 a[148:151], v12, s[12:15], s67 offen offset:1024 sc1
    buffer_load_dwordx4 a[152:155], v12, s[12:15], s67 offen offset:2048 sc1
    buffer_load_dwordx4 a[156:159], v12, s[12:15], s67 offen offset:3072 sc1
    s_add_u32 s67, s67, 196608
    buffer_load_dwordx4 a[160:163], v12, s[12:15], s67 offen offset:0 sc1
    buffer_load_dwordx4 a[164:167], v12, s[12:15], s67 offen offset:1024 sc1
    buffer_load_dwordx4 a[168:171], v12, s[12:15], s67 offen offset:2048 sc1
    buffer_load_dwordx4 a[172:175], v12, s[12:15], s67 offen offset:3072 sc1
    s_add_u32 s67, s67, 65536
    s_waitcnt vmcnt(20) lgkmcnt(0)
    v_mfma_f32_16x16x32_bf16 a[0:3], v[48:51], a[192:195], 0
    ds_read_b64_tr_b16 v[80:81], v40 offset:40960
    v_mfma_f32_16x16x32_bf16 a[4:7], v[48:51], a[196:199], 0
    ds_read_b64_tr_b16 v[82:83], v40 offset:45056
    s_add_u32 m0, s69, 102400
    s_add_u32 s66, s66, 114688
    v_mfma_f32_16x16x32_bf16 a[8:11], v[48:51], a[200:203], 0
    ds_read_b64_tr_b16 v[84:85], v41 offset:40960
    buffer_load_dwordx4 v8, s[8:11], s66 offen offset:0 lds
    v_mfma_f32_16x16x32_bf16 a[12:15], v[48:51], a[204:207], 0
    ds_read_b64_tr_b16 v[86:87], v41 offset:45056
    v_mfma_f32_16x16x32_bf16 a[16:19], v[52:55], a[192:195], 0
    buffer_load_dwordx4 v9, s[8:11], s66 offen offset:1024 lds
    v_mfma_f32_16x16x32_bf16 a[20:23], v[52:55], a[196:199], 0
    ds_read_b64_tr_b16 v[88:89], v42 offset:40960
    v_mfma_f32_16x16x32_bf16 a[24:27], v[52:55], a[200:203], 0
    ds_read_b64_tr_b16 v[90:91], v42 offset:45056
    v_mfma_f32_16x16x32_bf16 a[28:31], v[52:55], a[204:207], 0
    ds_read_b64_tr_b16 v[92:93], v43 offset:40960
    v_mfma_f32_16x16x32_bf16 a[32:35], v[56:59], a[192:195], 0
    ds_read_b64_tr_b16 v[94:95], v43 offset:45056
    buffer_load_dwordx4 v10, s[8:11], s66 offen offset:2048 lds
    v_mfma_f32_16x16x32_bf16 a[36:39], v[56:59], a[196:199], 0
    v_mfma_f32_16x16x32_bf16 a[40:43], v[56:59], a[200:203], 0
    ds_read_b64_tr_b16 v[96:97], v44 offset:40960
    v_mfma_f32_16x16x32_bf16 a[44:47], v[56:59], a[204:207], 0
    ds_read_b64_tr_b16 v[98:99], v44 offset:45056
    v_mfma_f32_16x16x32_bf16 a[48:51], v[60:63], a[192:195], 0
    ds_read_b64_tr_b16 v[100:101], v45 offset:40960
    buffer_load_dwordx4 v11, s[8:11], s66 offen offset:3072 lds
    v_mfma_f32_16x16x32_bf16 a[52:55], v[60:63], a[196:199], 0
    ds_read_b64_tr_b16 v[102:103], v45 offset:45056
    v_mfma_f32_16x16x32_bf16 a[56:59], v[60:63], a[200:203], 0
    v_mfma_f32_16x16x32_bf16 a[60:63], v[60:63], a[204:207], 0
    ds_read_b64_tr_b16 v[104:105], v46 offset:40960
    v_mfma_f32_16x16x32_bf16 a[64:67], v[64:67], a[192:195], 0
    ds_read_b64_tr_b16 v[106:107], v46 offset:45056
    buffer_load_dwordx4 a[176:179], v12, s[12:15], s67 offen offset:0 sc1
    v_mfma_f32_16x16x32_bf16 a[68:71], v[64:67], a[196:199], 0
    ds_read_b64_tr_b16 v[108:109], v47 offset:40960
    v_mfma_f32_16x16x32_bf16 a[72:75], v[64:67], a[200:203], 0
    ds_read_b64_tr_b16 v[110:111], v47 offset:45056
    v_mfma_f32_16x16x32_bf16 a[76:79], v[64:67], a[204:207], 0
    v_mfma_f32_16x16x32_bf16 a[80:83], v[68:71], a[192:195], 0
    buffer_load_dwordx4 a[180:183], v12, s[12:15], s67 offen offset:1024 sc1
    v_mfma_f32_16x16x32_bf16 a[84:87], v[68:71], a[196:199], 0
    v_mfma_f32_16x16x32_bf16 a[88:91], v[68:71], a[200:203], 0
    v_mfma_f32_16x16x32_bf16 a[92:95], v[68:71], a[204:207], 0
    v_mfma_f32_16x16x32_bf16 a[96:99], v[72:75], a[192:195], 0
    buffer_load_dwordx4 a[184:187], v12, s[12:15], s67 offen offset:2048 sc1
    v_mfma_f32_16x16x32_bf16 a[100:103], v[72:75], a[196:199], 0
    v_mfma_f32_16x16x32_bf16 a[104:107], v[72:75], a[200:203], 0
    v_mfma_f32_16x16x32_bf16 a[108:111], v[72:75], a[204:207], 0
    v_mfma_f32_16x16x32_bf16 a[112:115], v[76:79], a[192:195], 0
    buffer_load_dwordx4 a[188:191], v12, s[12:15], s67 offen offset:3072 sc1
    v_mfma_f32_16x16x32_bf16 a[116:119], v[76:79], a[196:199], 0
    v_mfma_f32_16x16x32_bf16 a[120:123], v[76:79], a[200:203], 0
    v_mfma_f32_16x16x32_bf16 a[124:127], v[76:79], a[204:207], 0
    s_add_u32 s67, s67, 196608
    s_waitcnt vmcnt(20) lgkmcnt(0)
    s_barrier
    v_mfma_f32_16x16x32_bf16 a[0:3], v[80:83], a[208:211], a[0:3]
    ds_read_b64_tr_b16 v[48:49], v32 offset:0
    v_mfma_f32_16x16x32_bf16 a[4:7], v[80:83], a[212:215], a[4:7]
    ds_read_b64_tr_b16 v[50:51], v32 offset:4096
    s_add_u32 m0, s69, 131072
    s_add_u32 s66, s66, 802816
    v_mfma_f32_16x16x32_bf16 a[8:11], v[80:83], a[216:219], a[8:11]
    ds_read_b64_tr_b16 v[52:53], v33 offset:0
    buffer_load_dwordx4 v8, s[8:11], s66 offen offset:0 lds
    v_mfma_f32_16x16x32_bf16 a[12:15], v[80:83], a[220:223], a[12:15]
    ds_read_b64_tr_b16 v[54:55], v33 offset:4096
    v_mfma_f32_16x16x32_bf16 a[16:19], v[84:87], a[208:211], a[16:19]
    buffer_load_dwordx4 v9, s[8:11], s66 offen offset:1024 lds
    v_mfma_f32_16x16x32_bf16 a[20:23], v[84:87], a[212:215], a[20:23]
    ds_read_b64_tr_b16 v[56:57], v34 offset:0
    v_mfma_f32_16x16x32_bf16 a[24:27], v[84:87], a[216:219], a[24:27]
    ds_read_b64_tr_b16 v[58:59], v34 offset:4096
    v_mfma_f32_16x16x32_bf16 a[28:31], v[84:87], a[220:223], a[28:31]
    ds_read_b64_tr_b16 v[60:61], v35 offset:0
    v_mfma_f32_16x16x32_bf16 a[32:35], v[88:91], a[208:211], a[32:35]
    ds_read_b64_tr_b16 v[62:63], v35 offset:4096
    buffer_load_dwordx4 v10, s[8:11], s66 offen offset:2048 lds
    v_mfma_f32_16x16x32_bf16 a[36:39], v[88:91], a[212:215], a[36:39]
    v_mfma_f32_16x16x32_bf16 a[40:43], v[88:91], a[216:219], a[40:43]
    ds_read_b64_tr_b16 v[64:65], v36 offset:0
    v_mfma_f32_16x16x32_bf16 a[44:47], v[88:91], a[220:223], a[44:47]
    ds_read_b64_tr_b16 v[66:67], v36 offset:4096
    v_mfma_f32_16x16x32_bf16 a[48:51], v[92:95], a[208:211], a[48:51]
    ds_read_b64_tr_b16 v[68:69], v37 offset:0
    buffer_load_dwordx4 v11, s[8:11], s66 offen offset:3072 lds
    v_mfma_f32_16x16x32_bf16 a[52:55], v[92:95], a[212:215], a[52:55]
    ds_read_b64_tr_b16 v[70:71], v37 offset:4096
    v_mfma_f32_16x16x32_bf16 a[56:59], v[92:95], a[216:219], a[56:59]
    v_mfma_f32_16x16x32_bf16 a[60:63], v[92:95], a[220:223], a[60:63]
    ds_read_b64_tr_b16 v[72:73], v38 offset:0
    v_mfma_f32_16x16x32_bf16 a[64:67], v[96:99], a[208:211], a[64:67]
    ds_read_b64_tr_b16 v[74:75], v38 offset:4096
    buffer_load_dwordx4 a[192:195], v12, s[12:15], s67 offen offset:0 sc1
    v_mfma_f32_16x16x32_bf16 a[68:71], v[96:99], a[212:215], a[68:71]
    ds_read_b64_tr_b16 v[76:77], v39 offset:0
    v_mfma_f32_16x16x32_bf16 a[72:75], v[96:99], a[216:219], a[72:75]
    ds_read_b64_tr_b16 v[78:79], v39 offset:4096
    v_mfma_f32_16x16x32_bf16 a[76:79], v[96:99], a[220:223], a[76:79]
    v_mfma_f32_16x16x32_bf16 a[80:83], v[100:103], a[208:211], a[80:83]
    buffer_load_dwordx4 a[196:199], v12, s[12:15], s67 offen offset:1024 sc1
    v_mfma_f32_16x16x32_bf16 a[84:87], v[100:103], a[212:215], a[84:87]
    v_mfma_f32_16x16x32_bf16 a[88:91], v[100:103], a[216:219], a[88:91]
    v_mfma_f32_16x16x32_bf16 a[92:95], v[100:103], a[220:223], a[92:95]
    v_mfma_f32_16x16x32_bf16 a[96:99], v[104:107], a[208:211], a[96:99]
    buffer_load_dwordx4 a[200:203], v12, s[12:15], s67 offen offset:2048 sc1
    v_mfma_f32_16x16x32_bf16 a[100:103], v[104:107], a[212:215], a[100:103]
    v_mfma_f32_16x16x32_bf16 a[104:107], v[104:107], a[216:219], a[104:107]
    v_mfma_f32_16x16x32_bf16 a[108:111], v[104:107], a[220:223], a[108:111]
    v_mfma_f32_16x16x32_bf16 a[112:115], v[108:111], a[208:211], a[112:115]
    buffer_load_dwordx4 a[204:207], v12, s[12:15], s67 offen offset:3072 sc1
    v_mfma_f32_16x16x32_bf16 a[116:119], v[108:111], a[212:215], a[116:119]
    v_mfma_f32_16x16x32_bf16 a[120:123], v[108:111], a[216:219], a[120:123]
    v_mfma_f32_16x16x32_bf16 a[124:127], v[108:111], a[220:223], a[124:127]
    s_add_u32 s67, s67, 65536
    s_waitcnt lgkmcnt(0)
    v_mfma_f32_16x16x32_bf16 a[0:3], v[48:51], a[224:227], a[0:3]
    ds_read_b64_tr_b16 v[80:81], v32 offset:8192
    v_mfma_f32_16x16x32_bf16 a[4:7], v[48:51], a[228:231], a[4:7]
    ds_read_b64_tr_b16 v[82:83], v32 offset:12288
    s_add_u32 m0, s69, 135168
    s_add_u32 s66, s66, 114688
    v_mfma_f32_16x16x32_bf16 a[8:11], v[48:51], a[232:235], a[8:11]
    ds_read_b64_tr_b16 v[84:85], v33 offset:8192
    buffer_load_dwordx4 v8, s[8:11], s66 offen offset:0 lds
    v_mfma_f32_16x16x32_bf16 a[12:15], v[48:51], a[236:239], a[12:15]
    ds_read_b64_tr_b16 v[86:87], v33 offset:12288
    v_mfma_f32_16x16x32_bf16 a[16:19], v[52:55], a[224:227], a[16:19]
    buffer_load_dwordx4 v9, s[8:11], s66 offen offset:1024 lds
    v_mfma_f32_16x16x32_bf16 a[20:23], v[52:55], a[228:231], a[20:23]
    ds_read_b64_tr_b16 v[88:89], v34 offset:8192
    v_mfma_f32_16x16x32_bf16 a[24:27], v[52:55], a[232:235], a[24:27]
    ds_read_b64_tr_b16 v[90:91], v34 offset:12288
    v_mfma_f32_16x16x32_bf16 a[28:31], v[52:55], a[236:239], a[28:31]
    ds_read_b64_tr_b16 v[92:93], v35 offset:8192
    v_mfma_f32_16x16x32_bf16 a[32:35], v[56:59], a[224:227], a[32:35]
    ds_read_b64_tr_b16 v[94:95], v35 offset:12288
    buffer_load_dwordx4 v10, s[8:11], s66 offen offset:2048 lds
    v_mfma_f32_16x16x32_bf16 a[36:39], v[56:59], a[228:231], a[36:39]
    v_mfma_f32_16x16x32_bf16 a[40:43], v[56:59], a[232:235], a[40:43]
    ds_read_b64_tr_b16 v[96:97], v36 offset:8192
    v_mfma_f32_16x16x32_bf16 a[44:47], v[56:59], a[236:239], a[44:47]
    ds_read_b64_tr_b16 v[98:99], v36 offset:12288
    v_mfma_f32_16x16x32_bf16 a[48:51], v[60:63], a[224:227], a[48:51]
    ds_read_b64_tr_b16 v[100:101], v37 offset:8192
    buffer_load_dwordx4 v11, s[8:11], s66 offen offset:3072 lds
    v_mfma_f32_16x16x32_bf16 a[52:55], v[60:63], a[228:231], a[52:55]
    ds_read_b64_tr_b16 v[102:103], v37 offset:12288
    v_mfma_f32_16x16x32_bf16 a[56:59], v[60:63], a[232:235], a[56:59]
    v_mfma_f32_16x16x32_bf16 a[60:63], v[60:63], a[236:239], a[60:63]
    ds_read_b64_tr_b16 v[104:105], v38 offset:8192
    v_mfma_f32_16x16x32_bf16 a[64:67], v[64:67], a[224:227], a[64:67]
    ds_read_b64_tr_b16 v[106:107], v38 offset:12288
    buffer_load_dwordx4 a[208:211], v12, s[12:15], s67 offen offset:0 sc1
    v_mfma_f32_16x16x32_bf16 a[68:71], v[64:67], a[228:231], a[68:71]
    ds_read_b64_tr_b16 v[108:109], v39 offset:8192
    v_mfma_f32_16x16x32_bf16 a[72:75], v[64:67], a[232:235], a[72:75]
    ds_read_b64_tr_b16 v[110:111], v39 offset:12288
    v_mfma_f32_16x16x32_bf16 a[76:79], v[64:67], a[236:239], a[76:79]
    v_mfma_f32_16x16x32_bf16 a[80:83], v[68:71], a[224:227], a[80:83]
    buffer_load_dwordx4 a[212:215], v12, s[12:15], s67 offen offset:1024 sc1
    v_mfma_f32_16x16x32_bf16 a[84:87], v[68:71], a[228:231], a[84:87]
    v_mfma_f32_16x16x32_bf16 a[88:91], v[68:71], a[232:235], a[88:91]
    v_mfma_f32_16x16x32_bf16 a[92:95], v[68:71], a[236:239], a[92:95]
    v_mfma_f32_16x16x32_bf16 a[96:99], v[72:75], a[224:227], a[96:99]
    buffer_load_dwordx4 a[216:219], v12, s[12:15], s67 offen offset:2048 sc1
    v_mfma_f32_16x16x32_bf16 a[100:103], v[72:75], a[228:231], a[100:103]
    v_mfma_f32_16x16x32_bf16 a[104:107], v[72:75], a[232:235], a[104:107]
    v_mfma_f32_16x16x32_bf16 a[108:111], v[72:75], a[236:239], a[108:111]
    v_mfma_f32_16x16x32_bf16 a[112:115], v[76:79], a[224:227], a[112:115]
    buffer_load_dwordx4 a[220:223], v12, s[12:15], s67 offen offset:3072 sc1
    v_mfma_f32_16x16x32_bf16 a[116:119], v[76:79], a[228:231], a[116:119]
    v_mfma_f32_16x16x32_bf16 a[120:123], v[76:79], a[232:235], a[120:123]
    v_mfma_f32_16x16x32_bf16 a[124:127], v[76:79], a[236:239], a[124:127]
    s_add_u32 s67, s67, 196608
    s_waitcnt vmcnt(28) lgkmcnt(0)
    s_barrier
    v_mfma_f32_16x16x32_bf16 a[0:3], v[80:83], a[240:243], a[0:3]
    ds_read_b64_tr_b16 v[48:49], v32 offset:32768
    v_mfma_f32_16x16x32_bf16 a[4:7], v[80:83], a[244:247], a[4:7]
    ds_read_b64_tr_b16 v[50:51], v32 offset:36864
    s_add_u32 m0, s69, 0
    s_add_u32 s66, s66, 802816
    v_mfma_f32_16x16x32_bf16 a[8:11], v[80:83], a[248:251], a[8:11]
    ds_read_b64_tr_b16 v[52:53], v33 offset:32768
    buffer_load_dwordx4 v8, s[8:11], s66 offen offset:0 lds
    v_mfma_f32_16x16x32_bf16 a[12:15], v[80:83], a[252:255], a[12:15]
    ds_read_b64_tr_b16 v[54:55], v33 offset:36864
    v_mfma_f32_16x16x32_bf16 a[16:19], v[84:87], a[240:243], a[16:19]
    buffer_load_dwordx4 v9, s[8:11], s66 offen offset:1024 lds
    v_mfma_f32_16x16x32_bf16 a[20:23], v[84:87], a[244:247], a[20:23]
    ds_read_b64_tr_b16 v[56:57], v34 offset:32768
    v_mfma_f32_16x16x32_bf16 a[24:27], v[84:87], a[248:251], a[24:27]
    ds_read_b64_tr_b16 v[58:59], v34 offset:36864
    v_mfma_f32_16x16x32_bf16 a[28:31], v[84:87], a[252:255], a[28:31]
    ds_read_b64_tr_b16 v[60:61], v35 offset:32768
    v_mfma_f32_16x16x32_bf16 a[32:35], v[88:91], a[240:243], a[32:35]
    ds_read_b64_tr_b16 v[62:63], v35 offset:36864
    buffer_load_dwordx4 v10, s[8:11], s66 offen offset:2048 lds
    v_mfma_f32_16x16x32_bf16 a[36:39], v[88:91], a[244:247], a[36:39]
    v_mfma_f32_16x16x32_bf16 a[40:43], v[88:91], a[248:251], a[40:43]
    ds_read_b64_tr_b16 v[64:65], v36 offset:32768
    v_mfma_f32_16x16x32_bf16 a[44:47], v[88:91], a[252:255], a[44:47]
    ds_read_b64_tr_b16 v[66:67], v36 offset:36864
    v_mfma_f32_16x16x32_bf16 a[48:51], v[92:95], a[240:243], a[48:51]
    ds_read_b64_tr_b16 v[68:69], v37 offset:32768
    buffer_load_dwordx4 v11, s[8:11], s66 offen offset:3072 lds
    v_mfma_f32_16x16x32_bf16 a[52:55], v[92:95], a[244:247], a[52:55]
    ds_read_b64_tr_b16 v[70:71], v37 offset:36864
    v_mfma_f32_16x16x32_bf16 a[56:59], v[92:95], a[248:251], a[56:59]
    v_mfma_f32_16x16x32_bf16 a[60:63], v[92:95], a[252:255], a[60:63]
    ds_read_b64_tr_b16 v[72:73], v38 offset:32768
    v_mfma_f32_16x16x32_bf16 a[64:67], v[96:99], a[240:243], a[64:67]
    ds_read_b64_tr_b16 v[74:75], v38 offset:36864
    buffer_load_dwordx4 a[224:227], v12, s[12:15], s67 offen offset:0 sc1
    v_mfma_f32_16x16x32_bf16 a[68:71], v[96:99], a[244:247], a[68:71]
    ds_read_b64_tr_b16 v[76:77], v39 offset:32768
    v_mfma_f32_16x16x32_bf16 a[72:75], v[96:99], a[248:251], a[72:75]
    ds_read_b64_tr_b16 v[78:79], v39 offset:36864
    v_mfma_f32_16x16x32_bf16 a[76:79], v[96:99], a[252:255], a[76:79]
    v_mfma_f32_16x16x32_bf16 a[80:83], v[100:103], a[240:243], a[80:83]
    buffer_load_dwordx4 a[228:231], v12, s[12:15], s67 offen offset:1024 sc1
    v_mfma_f32_16x16x32_bf16 a[84:87], v[100:103], a[244:247], a[84:87]
    v_mfma_f32_16x16x32_bf16 a[88:91], v[100:103], a[248:251], a[88:91]
    v_mfma_f32_16x16x32_bf16 a[92:95], v[100:103], a[252:255], a[92:95]
    v_mfma_f32_16x16x32_bf16 a[96:99], v[104:107], a[240:243], a[96:99]
    buffer_load_dwordx4 a[232:235], v12, s[12:15], s67 offen offset:2048 sc1
    v_mfma_f32_16x16x32_bf16 a[100:103], v[104:107], a[244:247], a[100:103]
    v_mfma_f32_16x16x32_bf16 a[104:107], v[104:107], a[248:251], a[104:107]
    v_mfma_f32_16x16x32_bf16 a[108:111], v[104:107], a[252:255], a[108:111]
    v_mfma_f32_16x16x32_bf16 a[112:115], v[108:111], a[240:243], a[112:115]
    buffer_load_dwordx4 a[236:239], v12, s[12:15], s67 offen offset:3072 sc1
    v_mfma_f32_16x16x32_bf16 a[116:119], v[108:111], a[244:247], a[116:119]
    v_mfma_f32_16x16x32_bf16 a[120:123], v[108:111], a[248:251], a[120:123]
    v_mfma_f32_16x16x32_bf16 a[124:127], v[108:111], a[252:255], a[124:127]
    s_add_u32 s67, s67, 65536
    s_waitcnt lgkmcnt(0)
    v_mfma_f32_16x16x32_bf16 a[0:3], v[48:51], a[128:131], a[0:3]
    ds_read_b64_tr_b16 v[80:81], v32 offset:40960
    v_mfma_f32_16x16x32_bf16 a[4:7], v[48:51], a[132:135], a[4:7]
    ds_read_b64_tr_b16 v[82:83], v32 offset:45056
    s_add_u32 m0, s69, 4096
    s_add_u32 s66, s66, 114688
    v_mfma_f32_16x16x32_bf16 a[8:11], v[48:51], a[136:139], a[8:11]
    ds_read_b64_tr_b16 v[84:85], v33 offset:40960
    buffer_load_dwordx4 v8, s[8:11], s66 offen offset:0 lds
    v_mfma_f32_16x16x32_bf16 a[12:15], v[48:51], a[140:143], a[12:15]
    ds_read_b64_tr_b16 v[86:87], v33 offset:45056
    v_mfma_f32_16x16x32_bf16 a[16:19], v[52:55], a[128:131], a[16:19]
    buffer_load_dwordx4 v9, s[8:11], s66 offen offset:1024 lds
    v_mfma_f32_16x16x32_bf16 a[20:23], v[52:55], a[132:135], a[20:23]
    ds_read_b64_tr_b16 v[88:89], v34 offset:40960
    v_mfma_f32_16x16x32_bf16 a[24:27], v[52:55], a[136:139], a[24:27]
    ds_read_b64_tr_b16 v[90:91], v34 offset:45056
    v_mfma_f32_16x16x32_bf16 a[28:31], v[52:55], a[140:143], a[28:31]
    ds_read_b64_tr_b16 v[92:93], v35 offset:40960
    v_mfma_f32_16x16x32_bf16 a[32:35], v[56:59], a[128:131], a[32:35]
    ds_read_b64_tr_b16 v[94:95], v35 offset:45056
    buffer_load_dwordx4 v10, s[8:11], s66 offen offset:2048 lds
    v_mfma_f32_16x16x32_bf16 a[36:39], v[56:59], a[132:135], a[36:39]
    v_mfma_f32_16x16x32_bf16 a[40:43], v[56:59], a[136:139], a[40:43]
    ds_read_b64_tr_b16 v[96:97], v36 offset:40960
    v_mfma_f32_16x16x32_bf16 a[44:47], v[56:59], a[140:143], a[44:47]
    ds_read_b64_tr_b16 v[98:99], v36 offset:45056
    v_mfma_f32_16x16x32_bf16 a[48:51], v[60:63], a[128:131], a[48:51]
    ds_read_b64_tr_b16 v[100:101], v37 offset:40960
    buffer_load_dwordx4 v11, s[8:11], s66 offen offset:3072 lds
    v_mfma_f32_16x16x32_bf16 a[52:55], v[60:63], a[132:135], a[52:55]
    ds_read_b64_tr_b16 v[102:103], v37 offset:45056
    v_mfma_f32_16x16x32_bf16 a[56:59], v[60:63], a[136:139], a[56:59]
    v_mfma_f32_16x16x32_bf16 a[60:63], v[60:63], a[140:143], a[60:63]
    ds_read_b64_tr_b16 v[104:105], v38 offset:40960
    v_mfma_f32_16x16x32_bf16 a[64:67], v[64:67], a[128:131], a[64:67]
    ds_read_b64_tr_b16 v[106:107], v38 offset:45056
    buffer_load_dwordx4 a[240:243], v12, s[12:15], s67 offen offset:0 sc1
    v_mfma_f32_16x16x32_bf16 a[68:71], v[64:67], a[132:135], a[68:71]
    ds_read_b64_tr_b16 v[108:109], v39 offset:40960
    v_mfma_f32_16x16x32_bf16 a[72:75], v[64:67], a[136:139], a[72:75]
    ds_read_b64_tr_b16 v[110:111], v39 offset:45056
    v_mfma_f32_16x16x32_bf16 a[76:79], v[64:67], a[140:143], a[76:79]
    v_mfma_f32_16x16x32_bf16 a[80:83], v[68:71], a[128:131], a[80:83]
    buffer_load_dwordx4 a[244:247], v12, s[12:15], s67 offen offset:1024 sc1
    v_mfma_f32_16x16x32_bf16 a[84:87], v[68:71], a[132:135], a[84:87]
    v_mfma_f32_16x16x32_bf16 a[88:91], v[68:71], a[136:139], a[88:91]
    v_mfma_f32_16x16x32_bf16 a[92:95], v[68:71], a[140:143], a[92:95]
    v_mfma_f32_16x16x32_bf16 a[96:99], v[72:75], a[128:131], a[96:99]
    buffer_load_dwordx4 a[248:251], v12, s[12:15], s67 offen offset:2048 sc1
    v_mfma_f32_16x16x32_bf16 a[100:103], v[72:75], a[132:135], a[100:103]
    v_mfma_f32_16x16x32_bf16 a[104:107], v[72:75], a[136:139], a[104:107]
    v_mfma_f32_16x16x32_bf16 a[108:111], v[72:75], a[140:143], a[108:111]
    v_mfma_f32_16x16x32_bf16 a[112:115], v[76:79], a[128:131], a[112:115]
    buffer_load_dwordx4 a[252:255], v12, s[12:15], s67 offen offset:3072 sc1
    v_mfma_f32_16x16x32_bf16 a[116:119], v[76:79], a[132:135], a[116:119]
    v_mfma_f32_16x16x32_bf16 a[120:123], v[76:79], a[136:139], a[120:123]
    v_mfma_f32_16x16x32_bf16 a[124:127], v[76:79], a[140:143], a[124:127]
    s_add_u32 s67, s67, 196608
    s_waitcnt vmcnt(32) lgkmcnt(0)
    s_barrier
    v_mfma_f32_16x16x32_bf16 a[0:3], v[80:83], a[144:147], a[0:3]
    ds_read_b64_tr_b16 v[48:49], v40 offset:0
    v_mfma_f32_16x16x32_bf16 a[4:7], v[80:83], a[148:151], a[4:7]
    ds_read_b64_tr_b16 v[50:51], v40 offset:4096
    s_add_u32 m0, s69, 32768
    s_add_u32 s66, s66, 802816
    v_mfma_f32_16x16x32_bf16 a[8:11], v[80:83], a[152:155], a[8:11]
    ds_read_b64_tr_b16 v[52:53], v41 offset:0
    buffer_load_dwordx4 v8, s[8:11], s66 offen offset:0 lds
    v_mfma_f32_16x16x32_bf16 a[12:15], v[80:83], a[156:159], a[12:15]
    ds_read_b64_tr_b16 v[54:55], v41 offset:4096
    v_mfma_f32_16x16x32_bf16 a[16:19], v[84:87], a[144:147], a[16:19]
    buffer_load_dwordx4 v9, s[8:11], s66 offen offset:1024 lds
    v_mfma_f32_16x16x32_bf16 a[20:23], v[84:87], a[148:151], a[20:23]
    ds_read_b64_tr_b16 v[56:57], v42 offset:0
    v_mfma_f32_16x16x32_bf16 a[24:27], v[84:87], a[152:155], a[24:27]
    ds_read_b64_tr_b16 v[58:59], v42 offset:4096
    v_mfma_f32_16x16x32_bf16 a[28:31], v[84:87], a[156:159], a[28:31]
    ds_read_b64_tr_b16 v[60:61], v43 offset:0
    v_mfma_f32_16x16x32_bf16 a[32:35], v[88:91], a[144:147], a[32:35]
    ds_read_b64_tr_b16 v[62:63], v43 offset:4096
    buffer_load_dwordx4 v10, s[8:11], s66 offen offset:2048 lds
    v_mfma_f32_16x16x32_bf16 a[36:39], v[88:91], a[148:151], a[36:39]
    v_mfma_f32_16x16x32_bf16 a[40:43], v[88:91], a[152:155], a[40:43]
    ds_read_b64_tr_b16 v[64:65], v44 offset:0
    v_mfma_f32_16x16x32_bf16 a[44:47], v[88:91], a[156:159], a[44:47]
    ds_read_b64_tr_b16 v[66:67], v44 offset:4096
    v_mfma_f32_16x16x32_bf16 a[48:51], v[92:95], a[144:147], a[48:51]
    ds_read_b64_tr_b16 v[68:69], v45 offset:0
    buffer_load_dwordx4 v11, s[8:11], s66 offen offset:3072 lds
    v_mfma_f32_16x16x32_bf16 a[52:55], v[92:95], a[148:151], a[52:55]
    ds_read_b64_tr_b16 v[70:71], v45 offset:4096
    v_mfma_f32_16x16x32_bf16 a[56:59], v[92:95], a[152:155], a[56:59]
    v_mfma_f32_16x16x32_bf16 a[60:63], v[92:95], a[156:159], a[60:63]
    ds_read_b64_tr_b16 v[72:73], v46 offset:0
    v_mfma_f32_16x16x32_bf16 a[64:67], v[96:99], a[144:147], a[64:67]
    ds_read_b64_tr_b16 v[74:75], v46 offset:4096
    buffer_load_dwordx4 a[128:131], v12, s[12:15], s67 offen offset:0 sc1
    v_mfma_f32_16x16x32_bf16 a[68:71], v[96:99], a[148:151], a[68:71]
    ds_read_b64_tr_b16 v[76:77], v47 offset:0
    v_mfma_f32_16x16x32_bf16 a[72:75], v[96:99], a[152:155], a[72:75]
    ds_read_b64_tr_b16 v[78:79], v47 offset:4096
    v_mfma_f32_16x16x32_bf16 a[76:79], v[96:99], a[156:159], a[76:79]
    v_mfma_f32_16x16x32_bf16 a[80:83], v[100:103], a[144:147], a[80:83]
    buffer_load_dwordx4 a[132:135], v12, s[12:15], s67 offen offset:1024 sc1
    v_mfma_f32_16x16x32_bf16 a[84:87], v[100:103], a[148:151], a[84:87]
    v_mfma_f32_16x16x32_bf16 a[88:91], v[100:103], a[152:155], a[88:91]
    v_mfma_f32_16x16x32_bf16 a[92:95], v[100:103], a[156:159], a[92:95]
    v_mfma_f32_16x16x32_bf16 a[96:99], v[104:107], a[144:147], a[96:99]
    buffer_load_dwordx4 a[136:139], v12, s[12:15], s67 offen offset:2048 sc1
    v_mfma_f32_16x16x32_bf16 a[100:103], v[104:107], a[148:151], a[100:103]
    v_mfma_f32_16x16x32_bf16 a[104:107], v[104:107], a[152:155], a[104:107]
    v_mfma_f32_16x16x32_bf16 a[108:111], v[104:107], a[156:159], a[108:111]
    v_mfma_f32_16x16x32_bf16 a[112:115], v[108:111], a[144:147], a[112:115]
    buffer_load_dwordx4 a[140:143], v12, s[12:15], s67 offen offset:3072 sc1
    v_mfma_f32_16x16x32_bf16 a[116:119], v[108:111], a[148:151], a[116:119]
    v_mfma_f32_16x16x32_bf16 a[120:123], v[108:111], a[152:155], a[120:123]
    v_mfma_f32_16x16x32_bf16 a[124:127], v[108:111], a[156:159], a[124:127]
    s_add_u32 s67, s67, 65536
    s_waitcnt lgkmcnt(0)
    v_mfma_f32_16x16x32_bf16 a[0:3], v[48:51], a[160:163], a[0:3]
    ds_read_b64_tr_b16 v[80:81], v40 offset:8192
    v_mfma_f32_16x16x32_bf16 a[4:7], v[48:51], a[164:167], a[4:7]
    ds_read_b64_tr_b16 v[82:83], v40 offset:12288
    s_add_u32 m0, s69, 36864
    s_add_u32 s66, s66, 114688
    v_mfma_f32_16x16x32_bf16 a[8:11], v[48:51], a[168:171], a[8:11]
    ds_read_b64_tr_b16 v[84:85], v41 offset:8192
    buffer_load_dwordx4 v8, s[8:11], s66 offen offset:0 lds
    v_mfma_f32_16x16x32_bf16 a[12:15], v[48:51], a[172:175], a[12:15]
    ds_read_b64_tr_b16 v[86:87], v41 offset:12288
    v_mfma_f32_16x16x32_bf16 a[16:19], v[52:55], a[160:163], a[16:19]
    buffer_load_dwordx4 v9, s[8:11], s66 offen offset:1024 lds
    v_mfma_f32_16x16x32_bf16 a[20:23], v[52:55], a[164:167], a[20:23]
    ds_read_b64_tr_b16 v[88:89], v42 offset:8192
    v_mfma_f32_16x16x32_bf16 a[24:27], v[52:55], a[168:171], a[24:27]
    ds_read_b64_tr_b16 v[90:91], v42 offset:12288
    v_mfma_f32_16x16x32_bf16 a[28:31], v[52:55], a[172:175], a[28:31]
    ds_read_b64_tr_b16 v[92:93], v43 offset:8192
    v_mfma_f32_16x16x32_bf16 a[32:35], v[56:59], a[160:163], a[32:35]
    ds_read_b64_tr_b16 v[94:95], v43 offset:12288
    buffer_load_dwordx4 v10, s[8:11], s66 offen offset:2048 lds
    v_mfma_f32_16x16x32_bf16 a[36:39], v[56:59], a[164:167], a[36:39]
    v_mfma_f32_16x16x32_bf16 a[40:43], v[56:59], a[168:171], a[40:43]
    ds_read_b64_tr_b16 v[96:97], v44 offset:8192
    v_mfma_f32_16x16x32_bf16 a[44:47], v[56:59], a[172:175], a[44:47]
    ds_read_b64_tr_b16 v[98:99], v44 offset:12288
    v_mfma_f32_16x16x32_bf16 a[48:51], v[60:63], a[160:163], a[48:51]
    ds_read_b64_tr_b16 v[100:101], v45 offset:8192
    buffer_load_dwordx4 v11, s[8:11], s66 offen offset:3072 lds
    v_mfma_f32_16x16x32_bf16 a[52:55], v[60:63], a[164:167], a[52:55]
    ds_read_b64_tr_b16 v[102:103], v45 offset:12288
    v_mfma_f32_16x16x32_bf16 a[56:59], v[60:63], a[168:171], a[56:59]
    v_mfma_f32_16x16x32_bf16 a[60:63], v[60:63], a[172:175], a[60:63]
    ds_read_b64_tr_b16 v[104:105], v46 offset:8192
    v_mfma_f32_16x16x32_bf16 a[64:67], v[64:67], a[160:163], a[64:67]
    ds_read_b64_tr_b16 v[106:107], v46 offset:12288
    buffer_load_dwordx4 a[144:147], v12, s[12:15], s67 offen offset:0 sc1
    v_mfma_f32_16x16x32_bf16 a[68:71], v[64:67], a[164:167], a[68:71]
    ds_read_b64_tr_b16 v[108:109], v47 offset:8192
    v_mfma_f32_16x16x32_bf16 a[72:75], v[64:67], a[168:171], a[72:75]
    ds_read_b64_tr_b16 v[110:111], v47 offset:12288
    v_mfma_f32_16x16x32_bf16 a[76:79], v[64:67], a[172:175], a[76:79]
    v_mfma_f32_16x16x32_bf16 a[80:83], v[68:71], a[160:163], a[80:83]
    buffer_load_dwordx4 a[148:151], v12, s[12:15], s67 offen offset:1024 sc1
    v_mfma_f32_16x16x32_bf16 a[84:87], v[68:71], a[164:167], a[84:87]
    v_mfma_f32_16x16x32_bf16 a[88:91], v[68:71], a[168:171], a[88:91]
    v_mfma_f32_16x16x32_bf16 a[92:95], v[68:71], a[172:175], a[92:95]
    v_mfma_f32_16x16x32_bf16 a[96:99], v[72:75], a[160:163], a[96:99]
    buffer_load_dwordx4 a[152:155], v12, s[12:15], s67 offen offset:2048 sc1
    v_mfma_f32_16x16x32_bf16 a[100:103], v[72:75], a[164:167], a[100:103]
    v_mfma_f32_16x16x32_bf16 a[104:107], v[72:75], a[168:171], a[104:107]
    v_mfma_f32_16x16x32_bf16 a[108:111], v[72:75], a[172:175], a[108:111]
    v_mfma_f32_16x16x32_bf16 a[112:115], v[76:79], a[160:163], a[112:115]
    buffer_load_dwordx4 a[156:159], v12, s[12:15], s67 offen offset:3072 sc1
    v_mfma_f32_16x16x32_bf16 a[116:119], v[76:79], a[164:167], a[116:119]
    v_mfma_f32_16x16x32_bf16 a[120:123], v[76:79], a[168:171], a[120:123]
    v_mfma_f32_16x16x32_bf16 a[124:127], v[76:79], a[172:175], a[124:127]
    s_add_u32 s67, s67, 196608
    s_waitcnt vmcnt(32) lgkmcnt(0)
    s_barrier
    v_mfma_f32_16x16x32_bf16 a[0:3], v[80:83], a[176:179], a[0:3]
    ds_read_b64_tr_b16 v[48:49], v40 offset:32768
    v_mfma_f32_16x16x32_bf16 a[4:7], v[80:83], a[180:183], a[4:7]
    ds_read_b64_tr_b16 v[50:51], v40 offset:36864
    s_add_u32 m0, s69, 98304
    s_add_u32 s66, s66, 802816
    v_mfma_f32_16x16x32_bf16 a[8:11], v[80:83], a[184:187], a[8:11]
    ds_read_b64_tr_b16 v[52:53], v41 offset:32768
    buffer_load_dwordx4 v8, s[8:11], s66 offen offset:0 lds
    v_mfma_f32_16x16x32_bf16 a[12:15], v[80:83], a[188:191], a[12:15]
    ds_read_b64_tr_b16 v[54:55], v41 offset:36864
    v_mfma_f32_16x16x32_bf16 a[16:19], v[84:87], a[176:179], a[16:19]
    buffer_load_dwordx4 v9, s[8:11], s66 offen offset:1024 lds
    v_mfma_f32_16x16x32_bf16 a[20:23], v[84:87], a[180:183], a[20:23]
    ds_read_b64_tr_b16 v[56:57], v42 offset:32768
    v_mfma_f32_16x16x32_bf16 a[24:27], v[84:87], a[184:187], a[24:27]
    ds_read_b64_tr_b16 v[58:59], v42 offset:36864
    v_mfma_f32_16x16x32_bf16 a[28:31], v[84:87], a[188:191], a[28:31]
    ds_read_b64_tr_b16 v[60:61], v43 offset:32768
    v_mfma_f32_16x16x32_bf16 a[32:35], v[88:91], a[176:179], a[32:35]
    ds_read_b64_tr_b16 v[62:63], v43 offset:36864
    buffer_load_dwordx4 v10, s[8:11], s66 offen offset:2048 lds
    v_mfma_f32_16x16x32_bf16 a[36:39], v[88:91], a[180:183], a[36:39]
    v_mfma_f32_16x16x32_bf16 a[40:43], v[88:91], a[184:187], a[40:43]
    ds_read_b64_tr_b16 v[64:65], v44 offset:32768
    v_mfma_f32_16x16x32_bf16 a[44:47], v[88:91], a[188:191], a[44:47]
    ds_read_b64_tr_b16 v[66:67], v44 offset:36864
    v_mfma_f32_16x16x32_bf16 a[48:51], v[92:95], a[176:179], a[48:51]
    ds_read_b64_tr_b16 v[68:69], v45 offset:32768
    buffer_load_dwordx4 v11, s[8:11], s66 offen offset:3072 lds
    v_mfma_f32_16x16x32_bf16 a[52:55], v[92:95], a[180:183], a[52:55]
    ds_read_b64_tr_b16 v[70:71], v45 offset:36864
    v_mfma_f32_16x16x32_bf16 a[56:59], v[92:95], a[184:187], a[56:59]
    v_mfma_f32_16x16x32_bf16 a[60:63], v[92:95], a[188:191], a[60:63]
    ds_read_b64_tr_b16 v[72:73], v46 offset:32768
    v_mfma_f32_16x16x32_bf16 a[64:67], v[96:99], a[176:179], a[64:67]
    ds_read_b64_tr_b16 v[74:75], v46 offset:36864
    buffer_load_dwordx4 a[160:163], v12, s[12:15], s67 offen offset:0 sc1
    v_mfma_f32_16x16x32_bf16 a[68:71], v[96:99], a[180:183], a[68:71]
    ds_read_b64_tr_b16 v[76:77], v47 offset:32768
    v_mfma_f32_16x16x32_bf16 a[72:75], v[96:99], a[184:187], a[72:75]
    ds_read_b64_tr_b16 v[78:79], v47 offset:36864
    v_mfma_f32_16x16x32_bf16 a[76:79], v[96:99], a[188:191], a[76:79]
    v_mfma_f32_16x16x32_bf16 a[80:83], v[100:103], a[176:179], a[80:83]
    buffer_load_dwordx4 a[164:167], v12, s[12:15], s67 offen offset:1024 sc1
    v_mfma_f32_16x16x32_bf16 a[84:87], v[100:103], a[180:183], a[84:87]
    v_mfma_f32_16x16x32_bf16 a[88:91], v[100:103], a[184:187], a[88:91]
    v_mfma_f32_16x16x32_bf16 a[92:95], v[100:103], a[188:191], a[92:95]
    v_mfma_f32_16x16x32_bf16 a[96:99], v[104:107], a[176:179], a[96:99]
    buffer_load_dwordx4 a[168:171], v12, s[12:15], s67 offen offset:2048 sc1
    v_mfma_f32_16x16x32_bf16 a[100:103], v[104:107], a[180:183], a[100:103]
    v_mfma_f32_16x16x32_bf16 a[104:107], v[104:107], a[184:187], a[104:107]
    v_mfma_f32_16x16x32_bf16 a[108:111], v[104:107], a[188:191], a[108:111]
    v_mfma_f32_16x16x32_bf16 a[112:115], v[108:111], a[176:179], a[112:115]
    buffer_load_dwordx4 a[172:175], v12, s[12:15], s67 offen offset:3072 sc1
    v_mfma_f32_16x16x32_bf16 a[116:119], v[108:111], a[180:183], a[116:119]
    v_mfma_f32_16x16x32_bf16 a[120:123], v[108:111], a[184:187], a[120:123]
    v_mfma_f32_16x16x32_bf16 a[124:127], v[108:111], a[188:191], a[124:127]
    s_add_u32 s67, s67, 65536
    s_waitcnt lgkmcnt(0)
    s_mov_b32 s70, 2
.p2align 6
km_yu_loop:
    v_mfma_f32_16x16x32_bf16 a[0:3], v[48:51], a[192:195], a[0:3]
    ds_read_b64_tr_b16 v[80:81], v40 offset:40960
    v_mfma_f32_16x16x32_bf16 a[4:7], v[48:51], a[196:199], a[4:7]
    ds_read_b64_tr_b16 v[82:83], v40 offset:45056
    s_add_u32 m0, s69, 102400
    s_add_u32 s66, s66, 114688
    v_mfma_f32_16x16x32_bf16 a[8:11], v[48:51], a[200:203], a[8:11]
    ds_read_b64_tr_b16 v[84:85], v41 offset:40960
    buffer_load_dwordx4 v8, s[8:11], s66 offen offset:0 lds
    v_mfma_f32_16x16x32_bf16 a[12:15], v[48:51], a[204:207], a[12:15]
    ds_read_b64_tr_b16 v[86:87], v41 offset:45056
    v_mfma_f32_16x16x32_bf16 a[16:19], v[52:55], a[192:195], a[16:19]
    buffer_load_dwordx4 v9, s[8:11], s66 offen offset:1024 lds
    v_mfma_f32_16x16x32_bf16 a[20:23], v[52:55], a[196:199], a[20:23]
    ds_read_b64_tr_b16 v[88:89], v42 offset:40960
    v_mfma_f32_16x16x32_bf16 a[24:27], v[52:55], a[200:203], a[24:27]
    ds_read_b64_tr_b16 v[90:91], v42 offset:45056
    v_mfma_f32_16x16x32_bf16 a[28:31], v[52:55], a[204:207], a[28:31]
    ds_read_b64_tr_b16 v[92:93], v43 offset:40960
    v_mfma_f32_16x16x32_bf16 a[32:35], v[56:59], a[192:195], a[32:35]
    ds_read_b64_tr_b16 v[94:95], v43 offset:45056
    buffer_load_dwordx4 v10, s[8:11], s66 offen offset:2048 lds
    v_mfma_f32_16x16x32_bf16 a[36:39], v[56:59], a[196:199], a[36:39]
    v_mfma_f32_16x16x32_bf16 a[40:43], v[56:59], a[200:203], a[40:43]
    ds_read_b64_tr_b16 v[96:97], v44 offset:40960
    v_mfma_f32_16x16x32_bf16 a[44:47], v[56:59], a[204:207], a[44:47]
    ds_read_b64_tr_b16 v[98:99], v44 offset:45056
    v_mfma_f32_16x16x32_bf16 a[48:51], v[60:63], a[192:195], a[48:51]
    ds_read_b64_tr_b16 v[100:101], v45 offset:40960
    buffer_load_dwordx4 v11, s[8:11], s66 offen offset:3072 lds
    v_mfma_f32_16x16x32_bf16 a[52:55], v[60:63], a[196:199], a[52:55]
    ds_read_b64_tr_b16 v[102:103], v45 offset:45056
    v_mfma_f32_16x16x32_bf16 a[56:59], v[60:63], a[200:203], a[56:59]
    v_mfma_f32_16x16x32_bf16 a[60:63], v[60:63], a[204:207], a[60:63]
    ds_read_b64_tr_b16 v[104:105], v46 offset:40960
    v_mfma_f32_16x16x32_bf16 a[64:67], v[64:67], a[192:195], a[64:67]
    ds_read_b64_tr_b16 v[106:107], v46 offset:45056
    buffer_load_dwordx4 a[176:179], v12, s[12:15], s67 offen offset:0 sc1
    v_mfma_f32_16x16x32_bf16 a[68:71], v[64:67], a[196:199], a[68:71]
    ds_read_b64_tr_b16 v[108:109], v47 offset:40960
    v_mfma_f32_16x16x32_bf16 a[72:75], v[64:67], a[200:203], a[72:75]
    ds_read_b64_tr_b16 v[110:111], v47 offset:45056
    v_mfma_f32_16x16x32_bf16 a[76:79], v[64:67], a[204:207], a[76:79]
    v_mfma_f32_16x16x32_bf16 a[80:83], v[68:71], a[192:195], a[80:83]
    buffer_load_dwordx4 a[180:183], v12, s[12:15], s67 offen offset:1024 sc1
    v_mfma_f32_16x16x32_bf16 a[84:87], v[68:71], a[196:199], a[84:87]
    v_mfma_f32_16x16x32_bf16 a[88:91], v[68:71], a[200:203], a[88:91]
    v_mfma_f32_16x16x32_bf16 a[92:95], v[68:71], a[204:207], a[92:95]
    v_mfma_f32_16x16x32_bf16 a[96:99], v[72:75], a[192:195], a[96:99]
    buffer_load_dwordx4 a[184:187], v12, s[12:15], s67 offen offset:2048 sc1
    v_mfma_f32_16x16x32_bf16 a[100:103], v[72:75], a[196:199], a[100:103]
    v_mfma_f32_16x16x32_bf16 a[104:107], v[72:75], a[200:203], a[104:107]
    v_mfma_f32_16x16x32_bf16 a[108:111], v[72:75], a[204:207], a[108:111]
    v_mfma_f32_16x16x32_bf16 a[112:115], v[76:79], a[192:195], a[112:115]
    buffer_load_dwordx4 a[188:191], v12, s[12:15], s67 offen offset:3072 sc1
    v_mfma_f32_16x16x32_bf16 a[116:119], v[76:79], a[196:199], a[116:119]
    v_mfma_f32_16x16x32_bf16 a[120:123], v[76:79], a[200:203], a[120:123]
    v_mfma_f32_16x16x32_bf16 a[124:127], v[76:79], a[204:207], a[124:127]
    s_add_u32 s67, s67, 196608
    s_waitcnt vmcnt(32) lgkmcnt(0)
    s_barrier
    v_mfma_f32_16x16x32_bf16 a[0:3], v[80:83], a[208:211], a[0:3]
    ds_read_b64_tr_b16 v[48:49], v32 offset:0
    v_mfma_f32_16x16x32_bf16 a[4:7], v[80:83], a[212:215], a[4:7]
    ds_read_b64_tr_b16 v[50:51], v32 offset:4096
    s_add_u32 m0, s69, 131072
    s_add_u32 s66, s66, 802816
    v_mfma_f32_16x16x32_bf16 a[8:11], v[80:83], a[216:219], a[8:11]
    ds_read_b64_tr_b16 v[52:53], v33 offset:0
    buffer_load_dwordx4 v8, s[8:11], s66 offen offset:0 lds
    v_mfma_f32_16x16x32_bf16 a[12:15], v[80:83], a[220:223], a[12:15]
    ds_read_b64_tr_b16 v[54:55], v33 offset:4096
    v_mfma_f32_16x16x32_bf16 a[16:19], v[84:87], a[208:211], a[16:19]
    buffer_load_dwordx4 v9, s[8:11], s66 offen offset:1024 lds
    v_mfma_f32_16x16x32_bf16 a[20:23], v[84:87], a[212:215], a[20:23]
    ds_read_b64_tr_b16 v[56:57], v34 offset:0
    v_mfma_f32_16x16x32_bf16 a[24:27], v[84:87], a[216:219], a[24:27]
    ds_read_b64_tr_b16 v[58:59], v34 offset:4096
    v_mfma_f32_16x16x32_bf16 a[28:31], v[84:87], a[220:223], a[28:31]
    ds_read_b64_tr_b16 v[60:61], v35 offset:0
    v_mfma_f32_16x16x32_bf16 a[32:35], v[88:91], a[208:211], a[32:35]
    ds_read_b64_tr_b16 v[62:63], v35 offset:4096
    buffer_load_dwordx4 v10, s[8:11], s66 offen offset:2048 lds
    v_mfma_f32_16x16x32_bf16 a[36:39], v[88:91], a[212:215], a[36:39]
    v_mfma_f32_16x16x32_bf16 a[40:43], v[88:91], a[216:219], a[40:43]
    ds_read_b64_tr_b16 v[64:65], v36 offset:0
    v_mfma_f32_16x16x32_bf16 a[44:47], v[88:91], a[220:223], a[44:47]
    ds_read_b64_tr_b16 v[66:67], v36 offset:4096
    v_mfma_f32_16x16x32_bf16 a[48:51], v[92:95], a[208:211], a[48:51]
    ds_read_b64_tr_b16 v[68:69], v37 offset:0
    buffer_load_dwordx4 v11, s[8:11], s66 offen offset:3072 lds
    v_mfma_f32_16x16x32_bf16 a[52:55], v[92:95], a[212:215], a[52:55]
    ds_read_b64_tr_b16 v[70:71], v37 offset:4096
    v_mfma_f32_16x16x32_bf16 a[56:59], v[92:95], a[216:219], a[56:59]
    v_mfma_f32_16x16x32_bf16 a[60:63], v[92:95], a[220:223], a[60:63]
    ds_read_b64_tr_b16 v[72:73], v38 offset:0
    v_mfma_f32_16x16x32_bf16 a[64:67], v[96:99], a[208:211], a[64:67]
    ds_read_b64_tr_b16 v[74:75], v38 offset:4096
    buffer_load_dwordx4 a[192:195], v12, s[12:15], s67 offen offset:0 sc1
    v_mfma_f32_16x16x32_bf16 a[68:71], v[96:99], a[212:215], a[68:71]
    ds_read_b64_tr_b16 v[76:77], v39 offset:0
    v_mfma_f32_16x16x32_bf16 a[72:75], v[96:99], a[216:219], a[72:75]
    ds_read_b64_tr_b16 v[78:79], v39 offset:4096
    v_mfma_f32_16x16x32_bf16 a[76:79], v[96:99], a[220:223], a[76:79]
    v_mfma_f32_16x16x32_bf16 a[80:83], v[100:103], a[208:211], a[80:83]
    buffer_load_dwordx4 a[196:199], v12, s[12:15], s67 offen offset:1024 sc1
    v_mfma_f32_16x16x32_bf16 a[84:87], v[100:103], a[212:215], a[84:87]
    v_mfma_f32_16x16x32_bf16 a[88:91], v[100:103], a[216:219], a[88:91]
    v_mfma_f32_16x16x32_bf16 a[92:95], v[100:103], a[220:223], a[92:95]
    v_mfma_f32_16x16x32_bf16 a[96:99], v[104:107], a[208:211], a[96:99]
    buffer_load_dwordx4 a[200:203], v12, s[12:15], s67 offen offset:2048 sc1
    v_mfma_f32_16x16x32_bf16 a[100:103], v[104:107], a[212:215], a[100:103]
    v_mfma_f32_16x16x32_bf16 a[104:107], v[104:107], a[216:219], a[104:107]
    v_mfma_f32_16x16x32_bf16 a[108:111], v[104:107], a[220:223], a[108:111]
    v_mfma_f32_16x16x32_bf16 a[112:115], v[108:111], a[208:211], a[112:115]
    buffer_load_dwordx4 a[204:207], v12, s[12:15], s67 offen offset:3072 sc1
    v_mfma_f32_16x16x32_bf16 a[116:119], v[108:111], a[212:215], a[116:119]
    v_mfma_f32_16x16x32_bf16 a[120:123], v[108:111], a[216:219], a[120:123]
    v_mfma_f32_16x16x32_bf16 a[124:127], v[108:111], a[220:223], a[124:127]
    s_add_u32 s67, s67, 65536
    s_waitcnt lgkmcnt(0)
    v_mfma_f32_16x16x32_bf16 a[0:3], v[48:51], a[224:227], a[0:3]
    ds_read_b64_tr_b16 v[80:81], v32 offset:8192
    v_mfma_f32_16x16x32_bf16 a[4:7], v[48:51], a[228:231], a[4:7]
    ds_read_b64_tr_b16 v[82:83], v32 offset:12288
    s_add_u32 m0, s69, 135168
    s_add_u32 s66, s66, 114688
    v_mfma_f32_16x16x32_bf16 a[8:11], v[48:51], a[232:235], a[8:11]
    ds_read_b64_tr_b16 v[84:85], v33 offset:8192
    buffer_load_dwordx4 v8, s[8:11], s66 offen offset:0 lds
    v_mfma_f32_16x16x32_bf16 a[12:15], v[48:51], a[236:239], a[12:15]
    ds_read_b64_tr_b16 v[86:87], v33 offset:12288
    v_mfma_f32_16x16x32_bf16 a[16:19], v[52:55], a[224:227], a[16:19]
    buffer_load_dwordx4 v9, s[8:11], s66 offen offset:1024 lds
    v_mfma_f32_16x16x32_bf16 a[20:23], v[52:55], a[228:231], a[20:23]
    ds_read_b64_tr_b16 v[88:89], v34 offset:8192
    v_mfma_f32_16x16x32_bf16 a[24:27], v[52:55], a[232:235], a[24:27]
    ds_read_b64_tr_b16 v[90:91], v34 offset:12288
    v_mfma_f32_16x16x32_bf16 a[28:31], v[52:55], a[236:239], a[28:31]
    ds_read_b64_tr_b16 v[92:93], v35 offset:8192
    v_mfma_f32_16x16x32_bf16 a[32:35], v[56:59], a[224:227], a[32:35]
    ds_read_b64_tr_b16 v[94:95], v35 offset:12288
    buffer_load_dwordx4 v10, s[8:11], s66 offen offset:2048 lds
    v_mfma_f32_16x16x32_bf16 a[36:39], v[56:59], a[228:231], a[36:39]
    v_mfma_f32_16x16x32_bf16 a[40:43], v[56:59], a[232:235], a[40:43]
    ds_read_b64_tr_b16 v[96:97], v36 offset:8192
    v_mfma_f32_16x16x32_bf16 a[44:47], v[56:59], a[236:239], a[44:47]
    ds_read_b64_tr_b16 v[98:99], v36 offset:12288
    v_mfma_f32_16x16x32_bf16 a[48:51], v[60:63], a[224:227], a[48:51]
    ds_read_b64_tr_b16 v[100:101], v37 offset:8192
    buffer_load_dwordx4 v11, s[8:11], s66 offen offset:3072 lds
    v_mfma_f32_16x16x32_bf16 a[52:55], v[60:63], a[228:231], a[52:55]
    ds_read_b64_tr_b16 v[102:103], v37 offset:12288
    v_mfma_f32_16x16x32_bf16 a[56:59], v[60:63], a[232:235], a[56:59]
    v_mfma_f32_16x16x32_bf16 a[60:63], v[60:63], a[236:239], a[60:63]
    ds_read_b64_tr_b16 v[104:105], v38 offset:8192
    v_mfma_f32_16x16x32_bf16 a[64:67], v[64:67], a[224:227], a[64:67]
    ds_read_b64_tr_b16 v[106:107], v38 offset:12288
    buffer_load_dwordx4 a[208:211], v12, s[12:15], s67 offen offset:0 sc1
    v_mfma_f32_16x16x32_bf16 a[68:71], v[64:67], a[228:231], a[68:71]
    ds_read_b64_tr_b16 v[108:109], v39 offset:8192
    v_mfma_f32_16x16x32_bf16 a[72:75], v[64:67], a[232:235], a[72:75]
    ds_read_b64_tr_b16 v[110:111], v39 offset:12288
    v_mfma_f32_16x16x32_bf16 a[76:79], v[64:67], a[236:239], a[76:79]
    v_mfma_f32_16x16x32_bf16 a[80:83], v[68:71], a[224:227], a[80:83]
    buffer_load_dwordx4 a[212:215], v12, s[12:15], s67 offen offset:1024 sc1
    v_mfma_f32_16x16x32_bf16 a[84:87], v[68:71], a[228:231], a[84:87]
    v_mfma_f32_16x16x32_bf16 a[88:91], v[68:71], a[232:235], a[88:91]
    v_mfma_f32_16x16x32_bf16 a[92:95], v[68:71], a[236:239], a[92:95]
    v_mfma_f32_16x16x32_bf16 a[96:99], v[72:75], a[224:227], a[96:99]
    buffer_load_dwordx4 a[216:219], v12, s[12:15], s67 offen offset:2048 sc1
    v_mfma_f32_16x16x32_bf16 a[100:103], v[72:75], a[228:231], a[100:103]
    v_mfma_f32_16x16x32_bf16 a[104:107], v[72:75], a[232:235], a[104:107]
    v_mfma_f32_16x16x32_bf16 a[108:111], v[72:75], a[236:239], a[108:111]
    v_mfma_f32_16x16x32_bf16 a[112:115], v[76:79], a[224:227], a[112:115]
    buffer_load_dwordx4 a[220:223], v12, s[12:15], s67 offen offset:3072 sc1
    v_mfma_f32_16x16x32_bf16 a[116:119], v[76:79], a[228:231], a[116:119]
    v_mfma_f32_16x16x32_bf16 a[120:123], v[76:79], a[232:235], a[120:123]
    v_mfma_f32_16x16x32_bf16 a[124:127], v[76:79], a[236:239], a[124:127]
    s_add_u32 s67, s67, 196608
    s_waitcnt vmcnt(32) lgkmcnt(0)
    s_barrier
    v_mfma_f32_16x16x32_bf16 a[0:3], v[80:83], a[240:243], a[0:3]
    ds_read_b64_tr_b16 v[48:49], v32 offset:32768
    v_mfma_f32_16x16x32_bf16 a[4:7], v[80:83], a[244:247], a[4:7]
    ds_read_b64_tr_b16 v[50:51], v32 offset:36864
    s_add_u32 m0, s69, 0
    s_add_u32 s66, s66, 802816
    v_mfma_f32_16x16x32_bf16 a[8:11], v[80:83], a[248:251], a[8:11]
    ds_read_b64_tr_b16 v[52:53], v33 offset:32768
    buffer_load_dwordx4 v8, s[8:11], s66 offen offset:0 lds
    v_mfma_f32_16x16x32_bf16 a[12:15], v[80:83], a[252:255], a[12:15]
    ds_read_b64_tr_b16 v[54:55], v33 offset:36864
    v_mfma_f32_16x16x32_bf16 a[16:19], v[84:87], a[240:243], a[16:19]
    buffer_load_dwordx4 v9, s[8:11], s66 offen offset:1024 lds
    v_mfma_f32_16x16x32_bf16 a[20:23], v[84:87], a[244:247], a[20:23]
    ds_read_b64_tr_b16 v[56:57], v34 offset:32768
    v_mfma_f32_16x16x32_bf16 a[24:27], v[84:87], a[248:251], a[24:27]
    ds_read_b64_tr_b16 v[58:59], v34 offset:36864
    v_mfma_f32_16x16x32_bf16 a[28:31], v[84:87], a[252:255], a[28:31]
    ds_read_b64_tr_b16 v[60:61], v35 offset:32768
    v_mfma_f32_16x16x32_bf16 a[32:35], v[88:91], a[240:243], a[32:35]
    ds_read_b64_tr_b16 v[62:63], v35 offset:36864
    buffer_load_dwordx4 v10, s[8:11], s66 offen offset:2048 lds
    v_mfma_f32_16x16x32_bf16 a[36:39], v[88:91], a[244:247], a[36:39]
    v_mfma_f32_16x16x32_bf16 a[40:43], v[88:91], a[248:251], a[40:43]
    ds_read_b64_tr_b16 v[64:65], v36 offset:32768
    v_mfma_f32_16x16x32_bf16 a[44:47], v[88:91], a[252:255], a[44:47]
    ds_read_b64_tr_b16 v[66:67], v36 offset:36864
    v_mfma_f32_16x16x32_bf16 a[48:51], v[92:95], a[240:243], a[48:51]
    ds_read_b64_tr_b16 v[68:69], v37 offset:32768
    buffer_load_dwordx4 v11, s[8:11], s66 offen offset:3072 lds
    v_mfma_f32_16x16x32_bf16 a[52:55], v[92:95], a[244:247], a[52:55]
    ds_read_b64_tr_b16 v[70:71], v37 offset:36864
    v_mfma_f32_16x16x32_bf16 a[56:59], v[92:95], a[248:251], a[56:59]
    v_mfma_f32_16x16x32_bf16 a[60:63], v[92:95], a[252:255], a[60:63]
    ds_read_b64_tr_b16 v[72:73], v38 offset:32768
    v_mfma_f32_16x16x32_bf16 a[64:67], v[96:99], a[240:243], a[64:67]
    ds_read_b64_tr_b16 v[74:75], v38 offset:36864
    buffer_load_dwordx4 a[224:227], v12, s[12:15], s67 offen offset:0 sc1
    v_mfma_f32_16x16x32_bf16 a[68:71], v[96:99], a[244:247], a[68:71]
    ds_read_b64_tr_b16 v[76:77], v39 offset:32768
    v_mfma_f32_16x16x32_bf16 a[72:75], v[96:99], a[248:251], a[72:75]
    ds_read_b64_tr_b16 v[78:79], v39 offset:36864
    v_mfma_f32_16x16x32_bf16 a[76:79], v[96:99], a[252:255], a[76:79]
    v_mfma_f32_16x16x32_bf16 a[80:83], v[100:103], a[240:243], a[80:83]
    buffer_load_dwordx4 a[228:231], v12, s[12:15], s67 offen offset:1024 sc1
    v_mfma_f32_16x16x32_bf16 a[84:87], v[100:103], a[244:247], a[84:87]
    v_mfma_f32_16x16x32_bf16 a[88:91], v[100:103], a[248:251], a[88:91]
    v_mfma_f32_16x16x32_bf16 a[92:95], v[100:103], a[252:255], a[92:95]
    v_mfma_f32_16x16x32_bf16 a[96:99], v[104:107], a[240:243], a[96:99]
    buffer_load_dwordx4 a[232:235], v12, s[12:15], s67 offen offset:2048 sc1
    v_mfma_f32_16x16x32_bf16 a[100:103], v[104:107], a[244:247], a[100:103]
    v_mfma_f32_16x16x32_bf16 a[104:107], v[104:107], a[248:251], a[104:107]
    v_mfma_f32_16x16x32_bf16 a[108:111], v[104:107], a[252:255], a[108:111]
    v_mfma_f32_16x16x32_bf16 a[112:115], v[108:111], a[240:243], a[112:115]
    buffer_load_dwordx4 a[236:239], v12, s[12:15], s67 offen offset:3072 sc1
    v_mfma_f32_16x16x32_bf16 a[116:119], v[108:111], a[244:247], a[116:119]
    v_mfma_f32_16x16x32_bf16 a[120:123], v[108:111], a[248:251], a[120:123]
    v_mfma_f32_16x16x32_bf16 a[124:127], v[108:111], a[252:255], a[124:127]
    s_add_u32 s67, s67, 65536
    s_waitcnt lgkmcnt(0)
    v_mfma_f32_16x16x32_bf16 a[0:3], v[48:51], a[128:131], a[0:3]
    ds_read_b64_tr_b16 v[80:81], v32 offset:40960
    v_mfma_f32_16x16x32_bf16 a[4:7], v[48:51], a[132:135], a[4:7]
    ds_read_b64_tr_b16 v[82:83], v32 offset:45056
    s_add_u32 m0, s69, 4096
    s_add_u32 s66, s66, 114688
    v_mfma_f32_16x16x32_bf16 a[8:11], v[48:51], a[136:139], a[8:11]
    ds_read_b64_tr_b16 v[84:85], v33 offset:40960
    buffer_load_dwordx4 v8, s[8:11], s66 offen offset:0 lds
    v_mfma_f32_16x16x32_bf16 a[12:15], v[48:51], a[140:143], a[12:15]
    ds_read_b64_tr_b16 v[86:87], v33 offset:45056
    v_mfma_f32_16x16x32_bf16 a[16:19], v[52:55], a[128:131], a[16:19]
    buffer_load_dwordx4 v9, s[8:11], s66 offen offset:1024 lds
    v_mfma_f32_16x16x32_bf16 a[20:23], v[52:55], a[132:135], a[20:23]
    ds_read_b64_tr_b16 v[88:89], v34 offset:40960
    v_mfma_f32_16x16x32_bf16 a[24:27], v[52:55], a[136:139], a[24:27]
    ds_read_b64_tr_b16 v[90:91], v34 offset:45056
    v_mfma_f32_16x16x32_bf16 a[28:31], v[52:55], a[140:143], a[28:31]
    ds_read_b64_tr_b16 v[92:93], v35 offset:40960
    v_mfma_f32_16x16x32_bf16 a[32:35], v[56:59], a[128:131], a[32:35]
    ds_read_b64_tr_b16 v[94:95], v35 offset:45056
    buffer_load_dwordx4 v10, s[8:11], s66 offen offset:2048 lds
    v_mfma_f32_16x16x32_bf16 a[36:39], v[56:59], a[132:135], a[36:39]
    v_mfma_f32_16x16x32_bf16 a[40:43], v[56:59], a[136:139], a[40:43]
    ds_read_b64_tr_b16 v[96:97], v36 offset:40960
    v_mfma_f32_16x16x32_bf16 a[44:47], v[56:59], a[140:143], a[44:47]
    ds_read_b64_tr_b16 v[98:99], v36 offset:45056
    v_mfma_f32_16x16x32_bf16 a[48:51], v[60:63], a[128:131], a[48:51]
    ds_read_b64_tr_b16 v[100:101], v37 offset:40960
    buffer_load_dwordx4 v11, s[8:11], s66 offen offset:3072 lds
    v_mfma_f32_16x16x32_bf16 a[52:55], v[60:63], a[132:135], a[52:55]
    ds_read_b64_tr_b16 v[102:103], v37 offset:45056
    v_mfma_f32_16x16x32_bf16 a[56:59], v[60:63], a[136:139], a[56:59]
    v_mfma_f32_16x16x32_bf16 a[60:63], v[60:63], a[140:143], a[60:63]
    ds_read_b64_tr_b16 v[104:105], v38 offset:40960
    v_mfma_f32_16x16x32_bf16 a[64:67], v[64:67], a[128:131], a[64:67]
    ds_read_b64_tr_b16 v[106:107], v38 offset:45056
    buffer_load_dwordx4 a[240:243], v12, s[12:15], s67 offen offset:0 sc1
    v_mfma_f32_16x16x32_bf16 a[68:71], v[64:67], a[132:135], a[68:71]
    ds_read_b64_tr_b16 v[108:109], v39 offset:40960
    v_mfma_f32_16x16x32_bf16 a[72:75], v[64:67], a[136:139], a[72:75]
    ds_read_b64_tr_b16 v[110:111], v39 offset:45056
    v_mfma_f32_16x16x32_bf16 a[76:79], v[64:67], a[140:143], a[76:79]
    v_mfma_f32_16x16x32_bf16 a[80:83], v[68:71], a[128:131], a[80:83]
    buffer_load_dwordx4 a[244:247], v12, s[12:15], s67 offen offset:1024 sc1
    v_mfma_f32_16x16x32_bf16 a[84:87], v[68:71], a[132:135], a[84:87]
    v_mfma_f32_16x16x32_bf16 a[88:91], v[68:71], a[136:139], a[88:91]
    v_mfma_f32_16x16x32_bf16 a[92:95], v[68:71], a[140:143], a[92:95]
    v_mfma_f32_16x16x32_bf16 a[96:99], v[72:75], a[128:131], a[96:99]
    buffer_load_dwordx4 a[248:251], v12, s[12:15], s67 offen offset:2048 sc1
    v_mfma_f32_16x16x32_bf16 a[100:103], v[72:75], a[132:135], a[100:103]
    v_mfma_f32_16x16x32_bf16 a[104:107], v[72:75], a[136:139], a[104:107]
    v_mfma_f32_16x16x32_bf16 a[108:111], v[72:75], a[140:143], a[108:111]
    v_mfma_f32_16x16x32_bf16 a[112:115], v[76:79], a[128:131], a[112:115]
    buffer_load_dwordx4 a[252:255], v12, s[12:15], s67 offen offset:3072 sc1
    v_mfma_f32_16x16x32_bf16 a[116:119], v[76:79], a[132:135], a[116:119]
    v_mfma_f32_16x16x32_bf16 a[120:123], v[76:79], a[136:139], a[120:123]
    v_mfma_f32_16x16x32_bf16 a[124:127], v[76:79], a[140:143], a[124:127]
    s_add_u32 s67, s67, 196608
    s_waitcnt vmcnt(32) lgkmcnt(0)
    s_barrier
    v_mfma_f32_16x16x32_bf16 a[0:3], v[80:83], a[144:147], a[0:3]
    ds_read_b64_tr_b16 v[48:49], v40 offset:0
    v_mfma_f32_16x16x32_bf16 a[4:7], v[80:83], a[148:151], a[4:7]
    ds_read_b64_tr_b16 v[50:51], v40 offset:4096
    s_add_u32 m0, s69, 32768
    s_add_u32 s66, s66, 802816
    v_mfma_f32_16x16x32_bf16 a[8:11], v[80:83], a[152:155], a[8:11]
    ds_read_b64_tr_b16 v[52:53], v41 offset:0
    buffer_load_dwordx4 v8, s[8:11], s66 offen offset:0 lds
    v_mfma_f32_16x16x32_bf16 a[12:15], v[80:83], a[156:159], a[12:15]
    ds_read_b64_tr_b16 v[54:55], v41 offset:4096
    v_mfma_f32_16x16x32_bf16 a[16:19], v[84:87], a[144:147], a[16:19]
    buffer_load_dwordx4 v9, s[8:11], s66 offen offset:1024 lds
    v_mfma_f32_16x16x32_bf16 a[20:23], v[84:87], a[148:151], a[20:23]
    ds_read_b64_tr_b16 v[56:57], v42 offset:0
    v_mfma_f32_16x16x32_bf16 a[24:27], v[84:87], a[152:155], a[24:27]
    ds_read_b64_tr_b16 v[58:59], v42 offset:4096
    v_mfma_f32_16x16x32_bf16 a[28:31], v[84:87], a[156:159], a[28:31]
    ds_read_b64_tr_b16 v[60:61], v43 offset:0
    v_mfma_f32_16x16x32_bf16 a[32:35], v[88:91], a[144:147], a[32:35]
    ds_read_b64_tr_b16 v[62:63], v43 offset:4096
    buffer_load_dwordx4 v10, s[8:11], s66 offen offset:2048 lds
    v_mfma_f32_16x16x32_bf16 a[36:39], v[88:91], a[148:151], a[36:39]
    v_mfma_f32_16x16x32_bf16 a[40:43], v[88:91], a[152:155], a[40:43]
    ds_read_b64_tr_b16 v[64:65], v44 offset:0
    v_mfma_f32_16x16x32_bf16 a[44:47], v[88:91], a[156:159], a[44:47]
    ds_read_b64_tr_b16 v[66:67], v44 offset:4096
    v_mfma_f32_16x16x32_bf16 a[48:51], v[92:95], a[144:147], a[48:51]
    ds_read_b64_tr_b16 v[68:69], v45 offset:0
    buffer_load_dwordx4 v11, s[8:11], s66 offen offset:3072 lds
    v_mfma_f32_16x16x32_bf16 a[52:55], v[92:95], a[148:151], a[52:55]
    ds_read_b64_tr_b16 v[70:71], v45 offset:4096
    v_mfma_f32_16x16x32_bf16 a[56:59], v[92:95], a[152:155], a[56:59]
    v_mfma_f32_16x16x32_bf16 a[60:63], v[92:95], a[156:159], a[60:63]
    ds_read_b64_tr_b16 v[72:73], v46 offset:0
    v_mfma_f32_16x16x32_bf16 a[64:67], v[96:99], a[144:147], a[64:67]
    ds_read_b64_tr_b16 v[74:75], v46 offset:4096
    buffer_load_dwordx4 a[128:131], v12, s[12:15], s67 offen offset:0 sc1
    v_mfma_f32_16x16x32_bf16 a[68:71], v[96:99], a[148:151], a[68:71]
    ds_read_b64_tr_b16 v[76:77], v47 offset:0
    v_mfma_f32_16x16x32_bf16 a[72:75], v[96:99], a[152:155], a[72:75]
    ds_read_b64_tr_b16 v[78:79], v47 offset:4096
    v_mfma_f32_16x16x32_bf16 a[76:79], v[96:99], a[156:159], a[76:79]
    v_mfma_f32_16x16x32_bf16 a[80:83], v[100:103], a[144:147], a[80:83]
    buffer_load_dwordx4 a[132:135], v12, s[12:15], s67 offen offset:1024 sc1
    v_mfma_f32_16x16x32_bf16 a[84:87], v[100:103], a[148:151], a[84:87]
    v_mfma_f32_16x16x32_bf16 a[88:91], v[100:103], a[152:155], a[88:91]
    v_mfma_f32_16x16x32_bf16 a[92:95], v[100:103], a[156:159], a[92:95]
    v_mfma_f32_16x16x32_bf16 a[96:99], v[104:107], a[144:147], a[96:99]
    buffer_load_dwordx4 a[136:139], v12, s[12:15], s67 offen offset:2048 sc1
    v_mfma_f32_16x16x32_bf16 a[100:103], v[104:107], a[148:151], a[100:103]
    v_mfma_f32_16x16x32_bf16 a[104:107], v[104:107], a[152:155], a[104:107]
    v_mfma_f32_16x16x32_bf16 a[108:111], v[104:107], a[156:159], a[108:111]
    v_mfma_f32_16x16x32_bf16 a[112:115], v[108:111], a[144:147], a[112:115]
    buffer_load_dwordx4 a[140:143], v12, s[12:15], s67 offen offset:3072 sc1
    v_mfma_f32_16x16x32_bf16 a[116:119], v[108:111], a[148:151], a[116:119]
    v_mfma_f32_16x16x32_bf16 a[120:123], v[108:111], a[152:155], a[120:123]
    v_mfma_f32_16x16x32_bf16 a[124:127], v[108:111], a[156:159], a[124:127]
    s_add_u32 s67, s67, 65536
    s_waitcnt lgkmcnt(0)
    v_mfma_f32_16x16x32_bf16 a[0:3], v[48:51], a[160:163], a[0:3]
    ds_read_b64_tr_b16 v[80:81], v40 offset:8192
    v_mfma_f32_16x16x32_bf16 a[4:7], v[48:51], a[164:167], a[4:7]
    ds_read_b64_tr_b16 v[82:83], v40 offset:12288
    s_add_u32 m0, s69, 36864
    s_add_u32 s66, s66, 114688
    v_mfma_f32_16x16x32_bf16 a[8:11], v[48:51], a[168:171], a[8:11]
    ds_read_b64_tr_b16 v[84:85], v41 offset:8192
    buffer_load_dwordx4 v8, s[8:11], s66 offen offset:0 lds
    v_mfma_f32_16x16x32_bf16 a[12:15], v[48:51], a[172:175], a[12:15]
    ds_read_b64_tr_b16 v[86:87], v41 offset:12288
    v_mfma_f32_16x16x32_bf16 a[16:19], v[52:55], a[160:163], a[16:19]
    buffer_load_dwordx4 v9, s[8:11], s66 offen offset:1024 lds
    v_mfma_f32_16x16x32_bf16 a[20:23], v[52:55], a[164:167], a[20:23]
    ds_read_b64_tr_b16 v[88:89], v42 offset:8192
    v_mfma_f32_16x16x32_bf16 a[24:27], v[52:55], a[168:171], a[24:27]
    ds_read_b64_tr_b16 v[90:91], v42 offset:12288
    v_mfma_f32_16x16x32_bf16 a[28:31], v[52:55], a[172:175], a[28:31]
    ds_read_b64_tr_b16 v[92:93], v43 offset:8192
    v_mfma_f32_16x16x32_bf16 a[32:35], v[56:59], a[160:163], a[32:35]
    ds_read_b64_tr_b16 v[94:95], v43 offset:12288
    buffer_load_dwordx4 v10, s[8:11], s66 offen offset:2048 lds
    v_mfma_f32_16x16x32_bf16 a[36:39], v[56:59], a[164:167], a[36:39]
    v_mfma_f32_16x16x32_bf16 a[40:43], v[56:59], a[168:171], a[40:43]
    ds_read_b64_tr_b16 v[96:97], v44 offset:8192
    v_mfma_f32_16x16x32_bf16 a[44:47], v[56:59], a[172:175], a[44:47]
    ds_read_b64_tr_b16 v[98:99], v44 offset:12288
    v_mfma_f32_16x16x32_bf16 a[48:51], v[60:63], a[160:163], a[48:51]
    ds_read_b64_tr_b16 v[100:101], v45 offset:8192
    buffer_load_dwordx4 v11, s[8:11], s66 offen offset:3072 lds
    v_mfma_f32_16x16x32_bf16 a[52:55], v[60:63], a[164:167], a[52:55]
    ds_read_b64_tr_b16 v[102:103], v45 offset:12288
    v_mfma_f32_16x16x32_bf16 a[56:59], v[60:63], a[168:171], a[56:59]
    v_mfma_f32_16x16x32_bf16 a[60:63], v[60:63], a[172:175], a[60:63]
    ds_read_b64_tr_b16 v[104:105], v46 offset:8192
    v_mfma_f32_16x16x32_bf16 a[64:67], v[64:67], a[160:163], a[64:67]
    ds_read_b64_tr_b16 v[106:107], v46 offset:12288
    buffer_load_dwordx4 a[144:147], v12, s[12:15], s67 offen offset:0 sc1
    v_mfma_f32_16x16x32_bf16 a[68:71], v[64:67], a[164:167], a[68:71]
    ds_read_b64_tr_b16 v[108:109], v47 offset:8192
    v_mfma_f32_16x16x32_bf16 a[72:75], v[64:67], a[168:171], a[72:75]
    ds_read_b64_tr_b16 v[110:111], v47 offset:12288
    v_mfma_f32_16x16x32_bf16 a[76:79], v[64:67], a[172:175], a[76:79]
    v_mfma_f32_16x16x32_bf16 a[80:83], v[68:71], a[160:163], a[80:83]
    buffer_load_dwordx4 a[148:151], v12, s[12:15], s67 offen offset:1024 sc1
    v_mfma_f32_16x16x32_bf16 a[84:87], v[68:71], a[164:167], a[84:87]
    v_mfma_f32_16x16x32_bf16 a[88:91], v[68:71], a[168:171], a[88:91]
    v_mfma_f32_16x16x32_bf16 a[92:95], v[68:71], a[172:175], a[92:95]
    v_mfma_f32_16x16x32_bf16 a[96:99], v[72:75], a[160:163], a[96:99]
    buffer_load_dwordx4 a[152:155], v12, s[12:15], s67 offen offset:2048 sc1
    v_mfma_f32_16x16x32_bf16 a[100:103], v[72:75], a[164:167], a[100:103]
    v_mfma_f32_16x16x32_bf16 a[104:107], v[72:75], a[168:171], a[104:107]
    v_mfma_f32_16x16x32_bf16 a[108:111], v[72:75], a[172:175], a[108:111]
    v_mfma_f32_16x16x32_bf16 a[112:115], v[76:79], a[160:163], a[112:115]
    buffer_load_dwordx4 a[156:159], v12, s[12:15], s67 offen offset:3072 sc1
    v_mfma_f32_16x16x32_bf16 a[116:119], v[76:79], a[164:167], a[116:119]
    v_mfma_f32_16x16x32_bf16 a[120:123], v[76:79], a[168:171], a[120:123]
    v_mfma_f32_16x16x32_bf16 a[124:127], v[76:79], a[172:175], a[124:127]
    s_add_u32 s67, s67, 196608
    s_waitcnt vmcnt(32) lgkmcnt(0)
    s_barrier
    v_mfma_f32_16x16x32_bf16 a[0:3], v[80:83], a[176:179], a[0:3]
    ds_read_b64_tr_b16 v[48:49], v40 offset:32768
    v_mfma_f32_16x16x32_bf16 a[4:7], v[80:83], a[180:183], a[4:7]
    ds_read_b64_tr_b16 v[50:51], v40 offset:36864
    s_add_u32 m0, s69, 98304
    s_add_u32 s66, s66, 802816
    v_mfma_f32_16x16x32_bf16 a[8:11], v[80:83], a[184:187], a[8:11]
    ds_read_b64_tr_b16 v[52:53], v41 offset:32768
    buffer_load_dwordx4 v8, s[8:11], s66 offen offset:0 lds
    v_mfma_f32_16x16x32_bf16 a[12:15], v[80:83], a[188:191], a[12:15]
    ds_read_b64_tr_b16 v[54:55], v41 offset:36864
    v_mfma_f32_16x16x32_bf16 a[16:19], v[84:87], a[176:179], a[16:19]
    buffer_load_dwordx4 v9, s[8:11], s66 offen offset:1024 lds
    v_mfma_f32_16x16x32_bf16 a[20:23], v[84:87], a[180:183], a[20:23]
    ds_read_b64_tr_b16 v[56:57], v42 offset:32768
    v_mfma_f32_16x16x32_bf16 a[24:27], v[84:87], a[184:187], a[24:27]
    ds_read_b64_tr_b16 v[58:59], v42 offset:36864
    v_mfma_f32_16x16x32_bf16 a[28:31], v[84:87], a[188:191], a[28:31]
    ds_read_b64_tr_b16 v[60:61], v43 offset:32768
    v_mfma_f32_16x16x32_bf16 a[32:35], v[88:91], a[176:179], a[32:35]
    ds_read_b64_tr_b16 v[62:63], v43 offset:36864
    buffer_load_dwordx4 v10, s[8:11], s66 offen offset:2048 lds
    v_mfma_f32_16x16x32_bf16 a[36:39], v[88:91], a[180:183], a[36:39]
    v_mfma_f32_16x16x32_bf16 a[40:43], v[88:91], a[184:187], a[40:43]
    ds_read_b64_tr_b16 v[64:65], v44 offset:32768
    v_mfma_f32_16x16x32_bf16 a[44:47], v[88:91], a[188:191], a[44:47]
    ds_read_b64_tr_b16 v[66:67], v44 offset:36864
    v_mfma_f32_16x16x32_bf16 a[48:51], v[92:95], a[176:179], a[48:51]
    ds_read_b64_tr_b16 v[68:69], v45 offset:32768
    buffer_load_dwordx4 v11, s[8:11], s66 offen offset:3072 lds
    v_mfma_f32_16x16x32_bf16 a[52:55], v[92:95], a[180:183], a[52:55]
    ds_read_b64_tr_b16 v[70:71], v45 offset:36864
    v_mfma_f32_16x16x32_bf16 a[56:59], v[92:95], a[184:187], a[56:59]
    v_mfma_f32_16x16x32_bf16 a[60:63], v[92:95], a[188:191], a[60:63]
    ds_read_b64_tr_b16 v[72:73], v46 offset:32768
    v_mfma_f32_16x16x32_bf16 a[64:67], v[96:99], a[176:179], a[64:67]
    ds_read_b64_tr_b16 v[74:75], v46 offset:36864
    buffer_load_dwordx4 a[160:163], v12, s[12:15], s67 offen offset:0 sc1
    v_mfma_f32_16x16x32_bf16 a[68:71], v[96:99], a[180:183], a[68:71]
    ds_read_b64_tr_b16 v[76:77], v47 offset:32768
    v_mfma_f32_16x16x32_bf16 a[72:75], v[96:99], a[184:187], a[72:75]
    ds_read_b64_tr_b16 v[78:79], v47 offset:36864
    v_mfma_f32_16x16x32_bf16 a[76:79], v[96:99], a[188:191], a[76:79]
    v_mfma_f32_16x16x32_bf16 a[80:83], v[100:103], a[176:179], a[80:83]
    buffer_load_dwordx4 a[164:167], v12, s[12:15], s67 offen offset:1024 sc1
    v_mfma_f32_16x16x32_bf16 a[84:87], v[100:103], a[180:183], a[84:87]
    v_mfma_f32_16x16x32_bf16 a[88:91], v[100:103], a[184:187], a[88:91]
    v_mfma_f32_16x16x32_bf16 a[92:95], v[100:103], a[188:191], a[92:95]
    v_mfma_f32_16x16x32_bf16 a[96:99], v[104:107], a[176:179], a[96:99]
    buffer_load_dwordx4 a[168:171], v12, s[12:15], s67 offen offset:2048 sc1
    v_mfma_f32_16x16x32_bf16 a[100:103], v[104:107], a[180:183], a[100:103]
    v_mfma_f32_16x16x32_bf16 a[104:107], v[104:107], a[184:187], a[104:107]
    v_mfma_f32_16x16x32_bf16 a[108:111], v[104:107], a[188:191], a[108:111]
    v_mfma_f32_16x16x32_bf16 a[112:115], v[108:111], a[176:179], a[112:115]
    buffer_load_dwordx4 a[172:175], v12, s[12:15], s67 offen offset:3072 sc1
    v_mfma_f32_16x16x32_bf16 a[116:119], v[108:111], a[180:183], a[116:119]
    v_mfma_f32_16x16x32_bf16 a[120:123], v[108:111], a[184:187], a[120:123]
    v_mfma_f32_16x16x32_bf16 a[124:127], v[108:111], a[188:191], a[124:127]
    s_add_u32 s67, s67, 65536
    s_sub_u32 s70, s70, 1
    s_cmp_eq_u32 s70, 0
    s_waitcnt lgkmcnt(0)
    s_cbranch_scc0 km_yu_loop
    v_mfma_f32_16x16x32_bf16 a[0:3], v[48:51], a[192:195], a[0:3]
    ds_read_b64_tr_b16 v[80:81], v40 offset:40960
    v_mfma_f32_16x16x32_bf16 a[4:7], v[48:51], a[196:199], a[4:7]
    ds_read_b64_tr_b16 v[82:83], v40 offset:45056
    s_add_u32 m0, s69, 102400
    s_add_u32 s66, s66, 114688
    v_mfma_f32_16x16x32_bf16 a[8:11], v[48:51], a[200:203], a[8:11]
    ds_read_b64_tr_b16 v[84:85], v41 offset:40960
    buffer_load_dwordx4 v8, s[8:11], s66 offen offset:0 lds
    v_mfma_f32_16x16x32_bf16 a[12:15], v[48:51], a[204:207], a[12:15]
    ds_read_b64_tr_b16 v[86:87], v41 offset:45056
    buffer_load_dwordx4 v9, s[8:11], s66 offen offset:1024 lds
    v_mfma_f32_16x16x32_bf16 a[16:19], v[52:55], a[192:195], a[16:19]
    buffer_load_dwordx4 v10, s[8:11], s66 offen offset:2048 lds
    v_mfma_f32_16x16x32_bf16 a[20:23], v[52:55], a[196:199], a[20:23]
    ds_read_b64_tr_b16 v[88:89], v42 offset:40960
    v_mfma_f32_16x16x32_bf16 a[24:27], v[52:55], a[200:203], a[24:27]
    ds_read_b64_tr_b16 v[90:91], v42 offset:45056
    buffer_load_dwordx4 v11, s[8:11], s66 offen offset:3072 lds
    v_mfma_f32_16x16x32_bf16 a[28:31], v[52:55], a[204:207], a[28:31]
    ds_read_b64_tr_b16 v[92:93], v43 offset:40960
    v_mfma_f32_16x16x32_bf16 a[32:35], v[56:59], a[192:195], a[32:35]
    ds_read_b64_tr_b16 v[94:95], v43 offset:45056
    buffer_load_dwordx4 a[176:179], v12, s[12:15], s67 offen offset:0 sc1
    v_mfma_f32_16x16x32_bf16 a[36:39], v[56:59], a[196:199], a[36:39]
    v_mfma_f32_16x16x32_bf16 a[40:43], v[56:59], a[200:203], a[40:43]
    ds_read_b64_tr_b16 v[96:97], v44 offset:40960
    buffer_load_dwordx4 a[180:183], v12, s[12:15], s67 offen offset:1024 sc1
    v_mfma_f32_16x16x32_bf16 a[44:47], v[56:59], a[204:207], a[44:47]
    ds_read_b64_tr_b16 v[98:99], v44 offset:45056
    v_mfma_f32_16x16x32_bf16 a[48:51], v[60:63], a[192:195], a[48:51]
    ds_read_b64_tr_b16 v[100:101], v45 offset:40960
    buffer_load_dwordx4 a[184:187], v12, s[12:15], s67 offen offset:2048 sc1
    v_mfma_f32_16x16x32_bf16 a[52:55], v[60:63], a[196:199], a[52:55]
    ds_read_b64_tr_b16 v[102:103], v45 offset:45056
    v_mfma_f32_16x16x32_bf16 a[56:59], v[60:63], a[200:203], a[56:59]
    buffer_load_dwordx4 a[188:191], v12, s[12:15], s67 offen offset:3072 sc1
    v_mfma_f32_16x16x32_bf16 a[60:63], v[60:63], a[204:207], a[60:63]
    ds_read_b64_tr_b16 v[104:105], v46 offset:40960
    v_mfma_f32_16x16x32_bf16 a[64:67], v[64:67], a[192:195], a[64:67]
    ds_read_b64_tr_b16 v[106:107], v46 offset:45056
    s_add_u32 s67, s67, 196608
    s_xor_b32 s88, s72, 1
    v_mfma_f32_16x16x32_bf16 a[68:71], v[64:67], a[196:199], a[68:71]
    ds_read_b64_tr_b16 v[108:109], v47 offset:40960
    s_mul_i32 s88, s88, 131072
    v_mfma_f32_16x16x32_bf16 a[72:75], v[64:67], a[200:203], a[72:75]
    ds_read_b64_tr_b16 v[110:111], v47 offset:45056
    s_add_u32 s88, s88, 3932160
    v_mfma_f32_16x16x32_bf16 a[76:79], v[64:67], a[204:207], a[76:79]
    buffer_load_dwordx4 v[112:115], v12, s[12:15], s88 offen offset:0 sc1
    buffer_load_dwordx4 v[116:119], v12, s[12:15], s88 offen offset:1024 sc1
    v_mfma_f32_16x16x32_bf16 a[80:83], v[68:71], a[192:195], a[80:83]
    buffer_load_dwordx4 v[120:123], v12, s[12:15], s88 offen offset:2048 sc1
    v_mfma_f32_16x16x32_bf16 a[84:87], v[68:71], a[196:199], a[84:87]
    v_mfma_f32_16x16x32_bf16 a[88:91], v[68:71], a[200:203], a[88:91]
    buffer_load_dwordx4 v[124:127], v12, s[12:15], s88 offen offset:3072 sc1
    v_mfma_f32_16x16x32_bf16 a[92:95], v[68:71], a[204:207], a[92:95]
    v_mfma_f32_16x16x32_bf16 a[96:99], v[72:75], a[192:195], a[96:99]
    s_xor_b32 s88, s72, 1
    s_mul_i32 s88, s88, 131072
    s_add_u32 s88, s88, 3997696
    v_mfma_f32_16x16x32_bf16 a[100:103], v[72:75], a[196:199], a[100:103]
    buffer_load_dwordx4 v[128:131], v12, s[12:15], s88 offen offset:0 sc1
    v_mfma_f32_16x16x32_bf16 a[104:107], v[72:75], a[200:203], a[104:107]
    buffer_load_dwordx4 v[132:135], v12, s[12:15], s88 offen offset:1024 sc1
    v_mfma_f32_16x16x32_bf16 a[108:111], v[72:75], a[204:207], a[108:111]
    v_mfma_f32_16x16x32_bf16 a[112:115], v[76:79], a[192:195], a[112:115]
    buffer_load_dwordx4 v[136:139], v12, s[12:15], s88 offen offset:2048 sc1
    v_mfma_f32_16x16x32_bf16 a[116:119], v[76:79], a[196:199], a[116:119]
    v_mfma_f32_16x16x32_bf16 a[120:123], v[76:79], a[200:203], a[120:123]
    buffer_load_dwordx4 v[140:143], v12, s[12:15], s88 offen offset:3072 sc1
    v_mfma_f32_16x16x32_bf16 a[124:127], v[76:79], a[204:207], a[124:127]
    s_mul_i32 s66, s71, 131072
    s_sub_u32 s66, s66, 524288
    s_mov_b32 s8, s46
    s_mov_b32 s9, s47
    s_mov_b32 s10, 0x800000
    s_mov_b32 s11, 0x00020000
    s_mov_b32 s67, 0
    s_mov_b32 s12, s64
    s_mov_b32 s13, s65
    s_mov_b32 s14, 0x4400000
    s_mov_b32 s15, 0x00020000
    s_waitcnt vmcnt(40) lgkmcnt(0)
    s_barrier
    v_mfma_f32_16x16x32_bf16 a[0:3], v[80:83], a[208:211], a[0:3]
    ds_read_b64_tr_b16 v[48:49], v32 offset:0
    v_mfma_f32_16x16x32_bf16 a[4:7], v[80:83], a[212:215], a[4:7]
    ds_read_b64_tr_b16 v[50:51], v32 offset:4096
    s_add_u32 m0, s68, 131072
    s_add_u32 s66, s66, 524288
    v_mfma_f32_16x16x32_bf16 a[8:11], v[80:83], a[216:219], a[8:11]
    ds_read_b64_tr_b16 v[52:53], v33 offset:0
    buffer_load_dwordx4 v2, s[8:11], s66 offen offset:0 lds
    v_mfma_f32_16x16x32_bf16 a[12:15], v[80:83], a[220:223], a[12:15]
    ds_read_b64_tr_b16 v[54:55], v33 offset:4096
    v_mfma_f32_16x16x32_bf16 a[16:19], v[84:87], a[208:211], a[16:19]
    buffer_load_dwordx4 v3, s[8:11], s66 offen offset:1024 lds
    v_mfma_f32_16x16x32_bf16 a[20:23], v[84:87], a[212:215], a[20:23]
    ds_read_b64_tr_b16 v[56:57], v34 offset:0
    v_mfma_f32_16x16x32_bf16 a[24:27], v[84:87], a[216:219], a[24:27]
    ds_read_b64_tr_b16 v[58:59], v34 offset:4096
    v_mfma_f32_16x16x32_bf16 a[28:31], v[84:87], a[220:223], a[28:31]
    ds_read_b64_tr_b16 v[60:61], v35 offset:0
    v_mfma_f32_16x16x32_bf16 a[32:35], v[88:91], a[208:211], a[32:35]
    ds_read_b64_tr_b16 v[62:63], v35 offset:4096
    buffer_load_dwordx4 v4, s[8:11], s66 offen offset:2048 lds
    v_mfma_f32_16x16x32_bf16 a[36:39], v[88:91], a[212:215], a[36:39]
    v_mfma_f32_16x16x32_bf16 a[40:43], v[88:91], a[216:219], a[40:43]
    ds_read_b64_tr_b16 v[64:65], v36 offset:0
    v_mfma_f32_16x16x32_bf16 a[44:47], v[88:91], a[220:223], a[44:47]
    ds_read_b64_tr_b16 v[66:67], v36 offset:4096
    v_mfma_f32_16x16x32_bf16 a[48:51], v[92:95], a[208:211], a[48:51]
    ds_read_b64_tr_b16 v[68:69], v37 offset:0
    buffer_load_dwordx4 v5, s[8:11], s66 offen offset:3072 lds
    v_mfma_f32_16x16x32_bf16 a[52:55], v[92:95], a[212:215], a[52:55]
    ds_read_b64_tr_b16 v[70:71], v37 offset:4096
    v_mfma_f32_16x16x32_bf16 a[56:59], v[92:95], a[216:219], a[56:59]
    v_mfma_f32_16x16x32_bf16 a[60:63], v[92:95], a[220:223], a[60:63]
    ds_read_b64_tr_b16 v[72:73], v38 offset:0
    v_mfma_f32_16x16x32_bf16 a[64:67], v[96:99], a[208:211], a[64:67]
    ds_read_b64_tr_b16 v[74:75], v38 offset:4096
    buffer_load_dwordx4 a[192:195], v6, s[12:15], s67 offen offset:0 sc1
    v_mfma_f32_16x16x32_bf16 a[68:71], v[96:99], a[212:215], a[68:71]
    ds_read_b64_tr_b16 v[76:77], v39 offset:0
    v_mfma_f32_16x16x32_bf16 a[72:75], v[96:99], a[216:219], a[72:75]
    ds_read_b64_tr_b16 v[78:79], v39 offset:4096
    v_mfma_f32_16x16x32_bf16 a[76:79], v[96:99], a[220:223], a[76:79]
    v_mfma_f32_16x16x32_bf16 a[80:83], v[100:103], a[208:211], a[80:83]
    buffer_load_dwordx4 a[196:199], v6, s[12:15], s67 offen offset:1024 sc1
    v_mfma_f32_16x16x32_bf16 a[84:87], v[100:103], a[212:215], a[84:87]
    v_mfma_f32_16x16x32_bf16 a[88:91], v[100:103], a[216:219], a[88:91]
    v_mfma_f32_16x16x32_bf16 a[92:95], v[100:103], a[220:223], a[92:95]
    v_mfma_f32_16x16x32_bf16 a[96:99], v[104:107], a[208:211], a[96:99]
    buffer_load_dwordx4 a[200:203], v6, s[12:15], s67 offen offset:2048 sc1
    v_mfma_f32_16x16x32_bf16 a[100:103], v[104:107], a[212:215], a[100:103]
    v_mfma_f32_16x16x32_bf16 a[104:107], v[104:107], a[216:219], a[104:107]
    v_mfma_f32_16x16x32_bf16 a[108:111], v[104:107], a[220:223], a[108:111]
    v_mfma_f32_16x16x32_bf16 a[112:115], v[108:111], a[208:211], a[112:115]
    buffer_load_dwordx4 a[204:207], v6, s[12:15], s67 offen offset:3072 sc1
    v_mfma_f32_16x16x32_bf16 a[116:119], v[108:111], a[212:215], a[116:119]
    v_mfma_f32_16x16x32_bf16 a[120:123], v[108:111], a[216:219], a[120:123]
    v_mfma_f32_16x16x32_bf16 a[124:127], v[108:111], a[220:223], a[124:127]
    s_add_u32 s67, s67, 131072
    s_waitcnt lgkmcnt(0)
    v_mfma_f32_16x16x32_bf16 a[0:3], v[48:51], a[224:227], a[0:3]
    ds_read_b64_tr_b16 v[80:81], v32 offset:8192
    v_lshrrev_b32 v208, 4, v1
    v_mfma_f32_16x16x32_bf16 a[4:7], v[48:51], a[228:231], a[4:7]
    ds_read_b64_tr_b16 v[82:83], v32 offset:12288
    s_add_u32 m0, s68, 147456
    v_mfma_f32_16x16x32_bf16 a[8:11], v[48:51], a[232:235], a[8:11]
    ds_read_b64_tr_b16 v[84:85], v33 offset:8192
    s_add_u32 s66, s66, 524288
    v_mfma_f32_16x16x32_bf16 a[12:15], v[48:51], a[236:239], a[12:15]
    ds_read_b64_tr_b16 v[86:87], v33 offset:12288
    buffer_load_dwordx4 v2, s[8:11], s66 offen offset:0 lds
    v_mfma_f32_16x16x32_bf16 a[16:19], v[52:55], a[224:227], a[16:19]
    buffer_load_dwordx4 v3, s[8:11], s66 offen offset:1024 lds
    v_and_b32 v209, 15, v1
    v_mfma_f32_16x16x32_bf16 a[20:23], v[52:55], a[228:231], a[20:23]
    ds_read_b64_tr_b16 v[88:89], v34 offset:8192
    v_lshrrev_b32 v210, 2, v209
    v_mfma_f32_16x16x32_bf16 a[24:27], v[52:55], a[232:235], a[24:27]
    ds_read_b64_tr_b16 v[90:91], v34 offset:12288
    v_and_b32 v211, 3, v209
    v_mfma_f32_16x16x32_bf16 a[28:31], v[52:55], a[236:239], a[28:31]
    ds_read_b64_tr_b16 v[92:93], v35 offset:8192
    v_lshrrev_b32 v212, 1, v208
    v_mfma_f32_16x16x32_bf16 a[32:35], v[56:59], a[224:227], a[32:35]
    ds_read_b64_tr_b16 v[94:95], v35 offset:12288
    buffer_load_dwordx4 v4, s[8:11], s66 offen offset:2048 lds
    v_mfma_f32_16x16x32_bf16 a[36:39], v[56:59], a[228:231], a[36:39]
    v_and_b32 v214, 1, v208
    v_lshl_add_u32 v213, v212, 2, v210
    v_mfma_f32_16x16x32_bf16 a[40:43], v[56:59], a[232:235], a[40:43]
    ds_read_b64_tr_b16 v[96:97], v36 offset:8192
    v_lshlrev_b32 v213, 8, v213
    v_mfma_f32_16x16x32_bf16 a[44:47], v[56:59], a[236:239], a[44:47]
    ds_read_b64_tr_b16 v[98:99], v36 offset:12288
    v_lshl_add_u32 v213, v214, 5, v213
    v_mfma_f32_16x16x32_bf16 a[48:51], v[60:63], a[224:227], a[48:51]
    ds_read_b64_tr_b16 v[100:101], v37 offset:8192
    buffer_load_dwordx4 v5, s[8:11], s66 offen offset:3072 lds
    v_mfma_f32_16x16x32_bf16 a[52:55], v[60:63], a[228:231], a[52:55]
    ds_read_b64_tr_b16 v[102:103], v37 offset:12288
    v_lshl_add_u32 v213, v211, 3, v213
    v_mfma_f32_16x16x32_bf16 a[56:59], v[60:63], a[232:235], a[56:59]
    v_add_u32 v213, 65536, v213
    v_xor_b32 v214, 0, v210
    v_mfma_f32_16x16x32_bf16 a[60:63], v[60:63], a[236:239], a[60:63]
    ds_read_b64_tr_b16 v[104:105], v38 offset:8192
    v_lshl_add_u32 v16, v214, 6, v213
    v_mfma_f32_16x16x32_bf16 a[64:67], v[64:67], a[224:227], a[64:67]
    ds_read_b64_tr_b16 v[106:107], v38 offset:12288
    buffer_load_dwordx4 a[208:211], v6, s[12:15], s67 offen offset:0 sc1
    v_mfma_f32_16x16x32_bf16 a[68:71], v[64:67], a[228:231], a[68:71]
    ds_read_b64_tr_b16 v[108:109], v39 offset:8192
    v_xor_b32 v214, 1, v210
    v_mfma_f32_16x16x32_bf16 a[72:75], v[64:67], a[232:235], a[72:75]
    ds_read_b64_tr_b16 v[110:111], v39 offset:12288
    v_lshl_add_u32 v17, v214, 6, v213
    v_mfma_f32_16x16x32_bf16 a[76:79], v[64:67], a[236:239], a[76:79]
    v_xor_b32 v214, 2, v210
    v_lshl_add_u32 v18, v214, 6, v213
    v_mfma_f32_16x16x32_bf16 a[80:83], v[68:71], a[224:227], a[80:83]
    buffer_load_dwordx4 a[212:215], v6, s[12:15], s67 offen offset:1024 sc1
    v_xor_b32 v214, 3, v210
    v_mfma_f32_16x16x32_bf16 a[84:87], v[68:71], a[228:231], a[84:87]
    v_lshl_add_u32 v19, v214, 6, v213
    v_add_u32 v214, 0, v208
    v_mfma_f32_16x16x32_bf16 a[88:91], v[68:71], a[232:235], a[88:91]
    v_xor_b32 v214, v214, v209
    v_lshlrev_b32 v214, 4, v214
    v_mfma_f32_16x16x32_bf16 a[92:95], v[68:71], a[236:239], a[92:95]
    v_lshl_add_u32 v20, v208, 8, v214
    v_add_u32 v214, 4, v208
    v_mfma_f32_16x16x32_bf16 a[96:99], v[72:75], a[224:227], a[96:99]
    buffer_load_dwordx4 a[216:219], v6, s[12:15], s67 offen offset:2048 sc1
    v_xor_b32 v214, v214, v209
    v_mfma_f32_16x16x32_bf16 a[100:103], v[72:75], a[228:231], a[100:103]
    v_lshlrev_b32 v214, 4, v214
    v_lshl_add_u32 v21, v208, 8, v214
    v_mfma_f32_16x16x32_bf16 a[104:107], v[72:75], a[232:235], a[104:107]
    v_add_u32 v214, 8, v208
    v_xor_b32 v214, v214, v209
    v_mfma_f32_16x16x32_bf16 a[108:111], v[72:75], a[236:239], a[108:111]
    v_lshlrev_b32 v214, 4, v214
    v_mfma_f32_16x16x32_bf16 a[112:115], v[76:79], a[224:227], a[112:115]
    buffer_load_dwordx4 a[220:223], v6, s[12:15], s67 offen offset:3072 sc1
    v_mfma_f32_16x16x32_bf16 a[116:119], v[76:79], a[228:231], a[116:119]
    v_mfma_f32_16x16x32_bf16 a[120:123], v[76:79], a[232:235], a[120:123]
    v_mfma_f32_16x16x32_bf16 a[124:127], v[76:79], a[236:239], a[124:127]
    s_add_u32 s67, s67, 131072
    s_waitcnt vmcnt(40) lgkmcnt(0)
    s_barrier
    v_mfma_f32_16x16x32_bf16 a[0:3], v[80:83], a[240:243], a[0:3]
    ds_read_b64_tr_b16 v[48:49], v32 offset:32768
    v_lshl_add_u32 v22, v208, 8, v214
    v_mfma_f32_16x16x32_bf16 a[4:7], v[80:83], a[244:247], a[4:7]
    ds_read_b64_tr_b16 v[50:51], v32 offset:36864
    buffer_load_dwordx4 a[224:227], v6, s[12:15], s67 offen offset:0 sc1
    v_mfma_f32_16x16x32_bf16 a[8:11], v[80:83], a[248:251], a[8:11]
    ds_read_b64_tr_b16 v[52:53], v33 offset:32768
    v_add_u32 v214, 12, v208
    v_mfma_f32_16x16x32_bf16 a[12:15], v[80:83], a[252:255], a[12:15]
    ds_read_b64_tr_b16 v[54:55], v33 offset:36864
    v_xor_b32 v214, v214, v209
    v_mfma_f32_16x16x32_bf16 a[16:19], v[84:87], a[240:243], a[16:19]
    v_lshlrev_b32 v214, 4, v214
    v_lshl_add_u32 v23, v208, 8, v214
    v_mfma_f32_16x16x32_bf16 a[20:23], v[84:87], a[244:247], a[20:23]
    ds_read_b64_tr_b16 v[56:57], v34 offset:32768
    v_and_b32 v213, 31, v1
    v_mfma_f32_16x16x32_bf16 a[24:27], v[84:87], a[248:251], a[24:27]
    ds_read_b64_tr_b16 v[58:59], v34 offset:36864
    v_lshlrev_b32 v214, 8, v213
    v_mfma_f32_16x16x32_bf16 a[28:31], v[84:87], a[252:255], a[28:31]
    ds_read_b64_tr_b16 v[60:61], v35 offset:32768
    v_xor_b32 v215, v212, v209
    v_mfma_f32_16x16x32_bf16 a[32:35], v[88:91], a[240:243], a[32:35]
    ds_read_b64_tr_b16 v[62:63], v35 offset:36864
    buffer_load_dwordx4 a[228:231], v6, s[12:15], s67 offen offset:1024 sc1
    v_mfma_f32_16x16x32_bf16 a[36:39], v[88:91], a[244:247], a[36:39]
    s_lshl_b32 s84, s72, 3
    v_xor_b32 v215, s84, v215
    v_mfma_f32_16x16x32_bf16 a[40:43], v[88:91], a[248:251], a[40:43]
    ds_read_b64_tr_b16 v[64:65], v36 offset:32768
    v_xor_b32 v216, 0, v215
    v_mfma_f32_16x16x32_bf16 a[44:47], v[88:91], a[252:255], a[44:47]
    ds_read_b64_tr_b16 v[66:67], v36 offset:36864
    v_lshl_add_u32 v8, v216, 4, v214
    v_mfma_f32_16x16x32_bf16 a[48:51], v[92:95], a[240:243], a[48:51]
    ds_read_b64_tr_b16 v[68:69], v37 offset:32768
    v_xor_b32 v216, 2, v215
    v_mfma_f32_16x16x32_bf16 a[52:55], v[92:95], a[244:247], a[52:55]
    ds_read_b64_tr_b16 v[70:71], v37 offset:36864
    v_lshl_add_u32 v9, v216, 4, v214
    v_mfma_f32_16x16x32_bf16 a[56:59], v[92:95], a[248:251], a[56:59]
    v_xor_b32 v216, 4, v215
    v_lshl_add_u32 v10, v216, 4, v214
    v_mfma_f32_16x16x32_bf16 a[60:63], v[92:95], a[252:255], a[60:63]
    ds_read_b64_tr_b16 v[72:73], v38 offset:32768
    v_xor_b32 v216, 6, v215
    v_mfma_f32_16x16x32_bf16 a[64:67], v[96:99], a[240:243], a[64:67]
    ds_read_b64_tr_b16 v[74:75], v38 offset:36864
    buffer_load_dwordx4 a[232:235], v6, s[12:15], s67 offen offset:2048 sc1
    v_mfma_f32_16x16x32_bf16 a[68:71], v[96:99], a[244:247], a[68:71]
    ds_read_b64_tr_b16 v[76:77], v39 offset:32768
    v_lshl_add_u32 v11, v216, 4, v214
    v_mfma_f32_16x16x32_bf16 a[72:75], v[96:99], a[248:251], a[72:75]
    ds_read_b64_tr_b16 v[78:79], v39 offset:36864
    v_xor_b32 v216, 8, v215
    v_mfma_f32_16x16x32_bf16 a[76:79], v[96:99], a[252:255], a[76:79]
    v_lshl_add_u32 v12, v216, 4, v214
    v_xor_b32 v216, 10, v215
    v_mfma_f32_16x16x32_bf16 a[80:83], v[100:103], a[240:243], a[80:83]
    v_lshl_add_u32 v13, v216, 4, v214
    v_xor_b32 v216, 12, v215
    v_mfma_f32_16x16x32_bf16 a[84:87], v[100:103], a[244:247], a[84:87]
    v_lshl_add_u32 v14, v216, 4, v214
    v_xor_b32 v216, 14, v215
    v_mfma_f32_16x16x32_bf16 a[88:91], v[100:103], a[248:251], a[88:91]
    v_lshl_add_u32 v15, v216, 4, v214
    v_bfe_u32 v214, v213, 2, 1
    v_mfma_f32_16x16x32_bf16 a[92:95], v[100:103], a[252:255], a[92:95]
    v_lshlrev_b32 v214, 10, v214
    v_lshl_add_u32 v214, v212, 8, v214
    v_mfma_f32_16x16x32_bf16 a[96:99], v[104:107], a[240:243], a[96:99]
    buffer_load_dwordx4 a[236:239], v6, s[12:15], s67 offen offset:3072 sc1
    v_lshrrev_b32 v215, 3, v213
    v_mfma_f32_16x16x32_bf16 a[100:103], v[104:107], a[244:247], a[100:103]
    v_mfma_f32_16x16x32_bf16 a[104:107], v[104:107], a[248:251], a[104:107]
    v_mfma_f32_16x16x32_bf16 a[108:111], v[104:107], a[252:255], a[108:111]
    v_mfma_f32_16x16x32_bf16 a[112:115], v[108:111], a[240:243], a[112:115]
    v_mfma_f32_16x16x32_bf16 a[116:119], v[108:111], a[244:247], a[116:119]
    v_mfma_f32_16x16x32_bf16 a[120:123], v[108:111], a[248:251], a[120:123]
    v_mfma_f32_16x16x32_bf16 a[124:127], v[108:111], a[252:255], a[124:127]
    s_add_u32 s67, s67, 131072
    s_waitcnt lgkmcnt(0)
    v_mfma_f32_16x16x32_bf16 a[0:3], v[48:51], a[128:131], a[0:3]
    ds_read_b64_tr_b16 v[80:81], v32 offset:40960
    v_lshl_add_u32 v214, v215, 6, v214
    v_mfma_f32_16x16x32_bf16 a[4:7], v[48:51], a[132:135], a[4:7]
    ds_read_b64_tr_b16 v[82:83], v32 offset:45056
    buffer_load_dwordx4 a[240:243], v6, s[12:15], s67 offen offset:0 sc1
    v_mfma_f32_16x16x32_bf16 a[8:11], v[48:51], a[136:139], a[8:11]
    ds_read_b64_tr_b16 v[84:85], v33 offset:40960
    v_and_b32 v215, 3, v213
    v_mfma_f32_16x16x32_bf16 a[12:15], v[48:51], a[140:143], a[12:15]
    ds_read_b64_tr_b16 v[86:87], v33 offset:45056
    v_lshl_add_u32 v214, v215, 4, v214
    v_mfma_f32_16x16x32_bf16 a[16:19], v[52:55], a[128:131], a[16:19]
    s_lshl_b32 s84, s74, 2
    s_add_u32 s84, s84, s71
    v_mfma_f32_16x16x32_bf16 a[20:23], v[52:55], a[132:135], a[20:23]
    ds_read_b64_tr_b16 v[88:89], v34 offset:40960
    s_lshl_b32 s84, s84, 12
    v_mfma_f32_16x16x32_bf16 a[24:27], v[52:55], a[136:139], a[24:27]
    ds_read_b64_tr_b16 v[90:91], v34 offset:45056
    v_add_u32 v25, s84, v214
    v_mfma_f32_16x16x32_bf16 a[28:31], v[52:55], a[140:143], a[28:31]
    ds_read_b64_tr_b16 v[92:93], v35 offset:40960
    v_xor_b32 v240, 0x4000, v40
    v_mfma_f32_16x16x32_bf16 a[32:35], v[56:59], a[128:131], a[32:35]
    ds_read_b64_tr_b16 v[94:95], v35 offset:45056
    buffer_load_dwordx4 a[244:247], v6, s[12:15], s67 offen offset:1024 sc1
    v_mfma_f32_16x16x32_bf16 a[36:39], v[56:59], a[132:135], a[36:39]
    v_xor_b32 v241, 0x4000, v41
    v_xor_b32 v242, 0x4000, v42
    v_mfma_f32_16x16x32_bf16 a[40:43], v[56:59], a[136:139], a[40:43]
    ds_read_b64_tr_b16 v[96:97], v36 offset:40960
    v_xor_b32 v243, 0x4000, v43
    v_mfma_f32_16x16x32_bf16 a[44:47], v[56:59], a[140:143], a[44:47]
    ds_read_b64_tr_b16 v[98:99], v36 offset:45056
    s_lshl_b32 s85, s71, 14
    v_mfma_f32_16x16x32_bf16 a[48:51], v[60:63], a[128:131], a[48:51]
    ds_read_b64_tr_b16 v[100:101], v37 offset:40960
    s_add_u32 s85, s85, 0
    v_mfma_f32_16x16x32_bf16 a[52:55], v[60:63], a[132:135], a[52:55]
    ds_read_b64_tr_b16 v[102:103], v37 offset:45056
    v_add_u32 v244, s85, v7
    v_mfma_f32_16x16x32_bf16 a[56:59], v[60:63], a[136:139], a[56:59]
    s_xor_b32 s85, s71, 2
    s_lshl_b32 s85, s85, 14
    v_mfma_f32_16x16x32_bf16 a[60:63], v[60:63], a[140:143], a[60:63]
    ds_read_b64_tr_b16 v[104:105], v38 offset:40960
    s_add_u32 s85, s85, 0
    v_mfma_f32_16x16x32_bf16 a[64:67], v[64:67], a[128:131], a[64:67]
    ds_read_b64_tr_b16 v[106:107], v38 offset:45056
    buffer_load_dwordx4 a[248:251], v6, s[12:15], s67 offen offset:2048 sc1
    v_mfma_f32_16x16x32_bf16 a[68:71], v[64:67], a[132:135], a[68:71]
    ds_read_b64_tr_b16 v[108:109], v39 offset:40960
    v_add_u32 v245, s85, v7
    v_mfma_f32_16x16x32_bf16 a[72:75], v[64:67], a[136:139], a[72:75]
    ds_read_b64_tr_b16 v[110:111], v39 offset:45056
    v_mfma_f32_16x16x32_bf16 a[76:79], v[64:67], a[140:143], a[76:79]
    v_mfma_f32_16x16x32_bf16 a[80:83], v[68:71], a[128:131], a[80:83]
    v_mfma_f32_16x16x32_bf16 a[84:87], v[68:71], a[132:135], a[84:87]
    v_mfma_f32_16x16x32_bf16 a[88:91], v[68:71], a[136:139], a[88:91]
    v_mfma_f32_16x16x32_bf16 a[92:95], v[68:71], a[140:143], a[92:95]
    v_mfma_f32_16x16x32_bf16 a[96:99], v[72:75], a[128:131], a[96:99]
    buffer_load_dwordx4 a[252:255], v6, s[12:15], s67 offen offset:3072 sc1
    v_mfma_f32_16x16x32_bf16 a[100:103], v[72:75], a[132:135], a[100:103]
    v_mfma_f32_16x16x32_bf16 a[104:107], v[72:75], a[136:139], a[104:107]
    v_mfma_f32_16x16x32_bf16 a[108:111], v[72:75], a[140:143], a[108:111]
    v_mfma_f32_16x16x32_bf16 a[112:115], v[76:79], a[128:131], a[112:115]
    v_mfma_f32_16x16x32_bf16 a[116:119], v[76:79], a[132:135], a[116:119]
    v_mfma_f32_16x16x32_bf16 a[120:123], v[76:79], a[136:139], a[120:123]
    v_mfma_f32_16x16x32_bf16 a[124:127], v[76:79], a[140:143], a[124:127]
    s_add_u32 s67, s67, 131072
    s_waitcnt vmcnt(32) lgkmcnt(0)
    s_barrier
    v_mfma_f32_16x16x32_bf16 a[0:3], v[80:83], a[144:147], a[0:3]
    ds_read_b64_tr_b16 v[48:49], v40 offset:0
    v_mfma_f32_16x16x32_bf16 a[4:7], v[80:83], a[148:151], a[4:7]
    ds_read_b64_tr_b16 v[50:51], v40 offset:4096
    buffer_load_dwordx4 a[128:131], v6, s[12:15], s67 offen offset:0 sc1
    v_mfma_f32_16x16x32_bf16 a[8:11], v[80:83], a[152:155], a[8:11]
    ds_read_b64_tr_b16 v[52:53], v41 offset:0
    v_mfma_f32_16x16x32_bf16 a[12:15], v[80:83], a[156:159], a[12:15]
    ds_read_b64_tr_b16 v[54:55], v41 offset:4096
    v_mfma_f32_16x16x32_bf16 a[16:19], v[84:87], a[144:147], a[16:19]
    v_mfma_f32_16x16x32_bf16 a[20:23], v[84:87], a[148:151], a[20:23]
    ds_read_b64_tr_b16 v[56:57], v42 offset:0
    v_mfma_f32_16x16x32_bf16 a[24:27], v[84:87], a[152:155], a[24:27]
    ds_read_b64_tr_b16 v[58:59], v42 offset:4096
    v_mfma_f32_16x16x32_bf16 a[28:31], v[84:87], a[156:159], a[28:31]
    ds_read_b64_tr_b16 v[60:61], v43 offset:0
    v_mfma_f32_16x16x32_bf16 a[32:35], v[88:91], a[144:147], a[32:35]
    ds_read_b64_tr_b16 v[62:63], v43 offset:4096
    buffer_load_dwordx4 a[132:135], v6, s[12:15], s67 offen offset:1024 sc1
    v_mfma_f32_16x16x32_bf16 a[36:39], v[88:91], a[148:151], a[36:39]
    v_mfma_f32_16x16x32_bf16 a[40:43], v[88:91], a[152:155], a[40:43]
    ds_read_b64_tr_b16 v[64:65], v40 offset:8192
    v_mfma_f32_16x16x32_bf16 a[44:47], v[88:91], a[156:159], a[44:47]
    ds_read_b64_tr_b16 v[66:67], v40 offset:12288
    v_mfma_f32_16x16x32_bf16 a[48:51], v[92:95], a[144:147], a[48:51]
    ds_read_b64_tr_b16 v[68:69], v41 offset:8192
    v_mfma_f32_16x16x32_bf16 a[52:55], v[92:95], a[148:151], a[52:55]
    ds_read_b64_tr_b16 v[70:71], v41 offset:12288
    v_mfma_f32_16x16x32_bf16 a[56:59], v[92:95], a[152:155], a[56:59]
    v_mfma_f32_16x16x32_bf16 a[60:63], v[92:95], a[156:159], a[60:63]
    ds_read_b64_tr_b16 v[72:73], v42 offset:8192
    v_mfma_f32_16x16x32_bf16 a[64:67], v[96:99], a[144:147], a[64:67]
    ds_read_b64_tr_b16 v[74:75], v42 offset:12288
    buffer_load_dwordx4 a[136:139], v6, s[12:15], s67 offen offset:2048 sc1
    v_mfma_f32_16x16x32_bf16 a[68:71], v[96:99], a[148:151], a[68:71]
    ds_read_b64_tr_b16 v[76:77], v43 offset:8192
    v_mfma_f32_16x16x32_bf16 a[72:75], v[96:99], a[152:155], a[72:75]
    ds_read_b64_tr_b16 v[78:79], v43 offset:12288
    v_mfma_f32_16x16x32_bf16 a[76:79], v[96:99], a[156:159], a[76:79]
    v_mfma_f32_16x16x32_bf16 a[80:83], v[100:103], a[144:147], a[80:83]
    v_mfma_f32_16x16x32_bf16 a[84:87], v[100:103], a[148:151], a[84:87]
    v_mfma_f32_16x16x32_bf16 a[88:91], v[100:103], a[152:155], a[88:91]
    v_mfma_f32_16x16x32_bf16 a[92:95], v[100:103], a[156:159], a[92:95]
    v_mfma_f32_16x16x32_bf16 a[96:99], v[104:107], a[144:147], a[96:99]
    buffer_load_dwordx4 a[140:143], v6, s[12:15], s67 offen offset:3072 sc1
    v_mfma_f32_16x16x32_bf16 a[100:103], v[104:107], a[148:151], a[100:103]
    v_mfma_f32_16x16x32_bf16 a[104:107], v[104:107], a[152:155], a[104:107]
    v_mfma_f32_16x16x32_bf16 a[108:111], v[104:107], a[156:159], a[108:111]
    v_mfma_f32_16x16x32_bf16 a[112:115], v[108:111], a[144:147], a[112:115]
    v_mfma_f32_16x16x32_bf16 a[116:119], v[108:111], a[148:151], a[116:119]
    v_mfma_f32_16x16x32_bf16 a[120:123], v[108:111], a[152:155], a[120:123]
    v_mfma_f32_16x16x32_bf16 a[124:127], v[108:111], a[156:159], a[124:127]
    s_add_u32 s67, s67, 131072
    s_waitcnt lgkmcnt(0)
    v_mfma_f32_16x16x32_bf16 a[0:3], v[48:51], a[160:163], a[0:3]
    ds_read_b64_tr_b16 v[80:81], v240 offset:0
    v_mfma_f32_16x16x32_bf16 a[4:7], v[48:51], a[164:167], a[4:7]
    ds_write_b128 v244, a[64:67] offset:0
    ds_read_b64_tr_b16 v[82:83], v240 offset:4096
    buffer_load_dwordx4 a[144:147], v6, s[12:15], s67 offen offset:0 sc1
    v_mfma_f32_16x16x32_bf16 a[8:11], v[48:51], a[168:171], a[8:11]
    ds_write_b128 v244, a[68:71] offset:1024
    v_mfma_f32_16x16x32_bf16 a[12:15], v[48:51], a[172:175], a[12:15]
    ds_write_b128 v244, a[72:75] offset:2048
    ds_read_b64_tr_b16 v[84:85], v241 offset:0
    v_mfma_f32_16x16x32_bf16 a[16:19], v[52:55], a[160:163], a[16:19]
    ds_read_b64_tr_b16 v[86:87], v241 offset:4096
    v_mfma_f32_16x16x32_bf16 a[20:23], v[52:55], a[164:167], a[20:23]
    ds_write_b128 v244, a[76:79] offset:3072
    v_mfma_f32_16x16x32_bf16 a[24:27], v[52:55], a[168:171], a[24:27]
    ds_write_b128 v244, a[80:83] offset:4096
    ds_read_b64_tr_b16 v[88:89], v242 offset:0
    v_mfma_f32_16x16x32_bf16 a[28:31], v[52:55], a[172:175], a[28:31]
    ds_read_b64_tr_b16 v[90:91], v242 offset:4096
    v_mfma_f32_16x16x32_bf16 a[32:35], v[56:59], a[160:163], a[32:35]
    ds_write_b128 v244, a[84:87] offset:5120
    buffer_load_dwordx4 a[148:151], v6, s[12:15], s67 offen offset:1024 sc1
    v_mfma_f32_16x16x32_bf16 a[36:39], v[56:59], a[164:167], a[36:39]
    ds_write_b128 v244, a[88:91] offset:6144
    ds_read_b64_tr_b16 v[92:93], v243 offset:0
    v_mfma_f32_16x16x32_bf16 a[40:43], v[56:59], a[168:171], a[40:43]
    ds_read_b64_tr_b16 v[94:95], v243 offset:4096
    v_mfma_f32_16x16x32_bf16 a[44:47], v[56:59], a[172:175], a[44:47]
    ds_write_b128 v244, a[92:95] offset:7168
    v_mfma_f32_16x16x32_bf16 a[48:51], v[60:63], a[160:163], a[48:51]
    ds_write_b128 v244, a[96:99] offset:8192
    ds_read_b64_tr_b16 v[96:97], v240 offset:8192
    v_mfma_f32_16x16x32_bf16 a[52:55], v[60:63], a[164:167], a[52:55]
    ds_write_b128 v244, a[100:103] offset:9216
    ds_read_b64_tr_b16 v[98:99], v240 offset:12288
    v_mfma_f32_16x16x32_bf16 a[56:59], v[60:63], a[168:171], a[56:59]
    v_mfma_f32_16x16x32_bf16 a[60:63], v[60:63], a[172:175], a[60:63]
    ds_write_b128 v244, a[104:107] offset:10240
    ds_read_b64_tr_b16 v[100:101], v241 offset:8192
    v_mfma_f32_16x16x32_bf16 a[0:3], v[64:67], a[176:179], a[0:3]
    ds_write_b128 v244, a[108:111] offset:11264
    ds_read_b64_tr_b16 v[102:103], v241 offset:12288
    buffer_load_dwordx4 a[152:155], v6, s[12:15], s67 offen offset:2048 sc1
    v_mfma_f32_16x16x32_bf16 a[4:7], v[64:67], a[180:183], a[4:7]
    v_mfma_f32_16x16x32_bf16 a[8:11], v[64:67], a[184:187], a[8:11]
    ds_write_b128 v244, a[112:115] offset:12288
    ds_read_b64_tr_b16 v[104:105], v242 offset:8192
    v_mfma_f32_16x16x32_bf16 a[12:15], v[64:67], a[188:191], a[12:15]
    ds_write_b128 v244, a[116:119] offset:13312
    ds_read_b64_tr_b16 v[106:107], v242 offset:12288
    v_mfma_f32_16x16x32_bf16 a[16:19], v[68:71], a[176:179], a[16:19]
    v_mfma_f32_16x16x32_bf16 a[20:23], v[68:71], a[180:183], a[20:23]
    ds_write_b128 v244, a[120:123] offset:14336
    ds_read_b64_tr_b16 v[108:109], v243 offset:8192
    v_mfma_f32_16x16x32_bf16 a[24:27], v[68:71], a[184:187], a[24:27]
    ds_write_b128 v244, a[124:127] offset:15360
    ds_read_b64_tr_b16 v[110:111], v243 offset:12288
    v_mfma_f32_16x16x32_bf16 a[28:31], v[68:71], a[188:191], a[28:31]
    v_mfma_f32_16x16x32_bf16 a[32:35], v[72:75], a[176:179], a[32:35]
    buffer_load_dwordx4 a[156:159], v6, s[12:15], s67 offen offset:3072 sc1
    v_mfma_f32_16x16x32_bf16 a[36:39], v[72:75], a[180:183], a[36:39]
    v_mfma_f32_16x16x32_bf16 a[40:43], v[72:75], a[184:187], a[40:43]
    v_mfma_f32_16x16x32_bf16 a[44:47], v[72:75], a[188:191], a[44:47]
    v_mfma_f32_16x16x32_bf16 a[48:51], v[76:79], a[176:179], a[48:51]
    v_mfma_f32_16x16x32_bf16 a[52:55], v[76:79], a[180:183], a[52:55]
    v_mfma_f32_16x16x32_bf16 a[56:59], v[76:79], a[184:187], a[56:59]
    v_mfma_f32_16x16x32_bf16 a[60:63], v[76:79], a[188:191], a[60:63]
    s_add_u32 s67, s67, 131072
    s_waitcnt vmcnt(8) lgkmcnt(0)
    s_barrier
    v_mfma_f32_16x16x32_bf16 a[0:3], v[80:83], v[112:115], a[0:3]
    ds_read_b128 v[176:179], v245 offset:0
    v_mfma_f32_16x16x32_bf16 a[4:7], v[80:83], v[116:119], a[4:7]
    ds_read_b128 v[180:183], v245 offset:1024
    s_add_u32 m0, s68, 114688
    s_add_u32 s66, s66, 524288
    v_mfma_f32_16x16x32_bf16 a[8:11], v[80:83], v[120:123], a[8:11]
    ds_read_b128 v[184:187], v245 offset:2048
    buffer_load_dwordx4 v2, s[8:11], s66 offen offset:0 lds
    v_mfma_f32_16x16x32_bf16 a[12:15], v[80:83], v[124:127], a[12:15]
    ds_read_b128 v[188:191], v245 offset:3072
    v_mfma_f32_16x16x32_bf16 a[16:19], v[84:87], v[112:115], a[16:19]
    v_mfma_f32_16x16x32_bf16 a[20:23], v[84:87], v[116:119], a[20:23]
    ds_read_b128 v[192:195], v245 offset:4096
    v_mfma_f32_16x16x32_bf16 a[24:27], v[84:87], v[120:123], a[24:27]
    ds_read_b128 v[196:199], v245 offset:5120
    v_mfma_f32_16x16x32_bf16 a[28:31], v[84:87], v[124:127], a[28:31]
    ds_read_b128 v[200:203], v245 offset:6144
    v_mfma_f32_16x16x32_bf16 a[32:35], v[88:91], v[112:115], a[32:35]
    ds_read_b128 v[204:207], v245 offset:7168
    buffer_load_dwordx4 v3, s[8:11], s66 offen offset:1024 lds
    v_mfma_f32_16x16x32_bf16 a[36:39], v[88:91], v[116:119], a[36:39]
    v_mfma_f32_16x16x32_bf16 a[40:43], v[88:91], v[120:123], a[40:43]
    ds_read_b128 v[208:211], v245 offset:8192
    v_mfma_f32_16x16x32_bf16 a[44:47], v[88:91], v[124:127], a[44:47]
    ds_read_b128 v[212:215], v245 offset:9216
    v_mfma_f32_16x16x32_bf16 a[48:51], v[92:95], v[112:115], a[48:51]
    ds_read_b128 v[216:219], v245 offset:10240
    v_mfma_f32_16x16x32_bf16 a[52:55], v[92:95], v[116:119], a[52:55]
    ds_read_b128 v[220:223], v245 offset:11264
    v_mfma_f32_16x16x32_bf16 a[56:59], v[92:95], v[120:123], a[56:59]
    v_mfma_f32_16x16x32_bf16 a[60:63], v[92:95], v[124:127], a[60:63]
    ds_read_b128 v[224:227], v245 offset:12288
    v_mfma_f32_16x16x32_bf16 a[0:3], v[96:99], v[128:131], a[0:3]
    ds_read_b128 v[228:231], v245 offset:13312
    buffer_load_dwordx4 v4, s[8:11], s66 offen offset:2048 lds
    v_mfma_f32_16x16x32_bf16 a[4:7], v[96:99], v[132:135], a[4:7]
    ds_read_b128 v[232:235], v245 offset:14336
    v_mfma_f32_16x16x32_bf16 a[8:11], v[96:99], v[136:139], a[8:11]
    ds_read_b128 v[236:239], v245 offset:15360
    v_mfma_f32_16x16x32_bf16 a[12:15], v[96:99], v[140:143], a[12:15]
    v_mfma_f32_16x16x32_bf16 a[16:19], v[100:103], v[128:131], a[16:19]
    v_mfma_f32_16x16x32_bf16 a[20:23], v[100:103], v[132:135], a[20:23]
    v_mfma_f32_16x16x32_bf16 a[24:27], v[100:103], v[136:139], a[24:27]
    v_mfma_f32_16x16x32_bf16 a[28:31], v[100:103], v[140:143], a[28:31]
    v_mfma_f32_16x16x32_bf16 a[32:35], v[104:107], v[128:131], a[32:35]
    buffer_load_dwordx4 v5, s[8:11], s66 offen offset:3072 lds
    v_mfma_f32_16x16x32_bf16 a[36:39], v[104:107], v[132:135], a[36:39]
    v_mfma_f32_16x16x32_bf16 a[40:43], v[104:107], v[136:139], a[40:43]
    v_mfma_f32_16x16x32_bf16 a[44:47], v[104:107], v[140:143], a[44:47]
    v_mfma_f32_16x16x32_bf16 a[48:51], v[108:111], v[128:131], a[48:51]
    v_mfma_f32_16x16x32_bf16 a[52:55], v[108:111], v[132:135], a[52:55]
    v_mfma_f32_16x16x32_bf16 a[56:59], v[108:111], v[136:139], a[56:59]
    v_mfma_f32_16x16x32_bf16 a[60:63], v[108:111], v[140:143], a[60:63]
    s_waitcnt lgkmcnt(0)
    s_nop 4
    s_add_u32 s32, s64, 0x800000
    s_addc_u32 s33, s65, 0
    s_mov_b32 s34, 0x4700000
    s_mov_b32 s35, 0x00020000
    s_lshl_b32 s84, s76, 1
    s_add_u32 s84, s84, s72
    s_lshl_b32 s84, s84, 17
    s_lshl_b32 s85, s77, 1
    s_add_u32 s85, s85, s73
    s_lshl_b32 s85, s85, 12
    s_add_u32 s84, s84, s85
    s_add_u32 s85, s84, 65536
    s_mov_b32 s86, 0xbdd2d3e8
    s_mov_b32 s87, 0xbdd2d3e8
    v_mov_b32 v88, 0xc0135761
    v_mov_b32 v89, 0xc0135761
    v_mov_b32 v90, 1.0
    v_mov_b32 v91, 1.0
    v_bfe_u32 v109, v7, 7, 3
    v_xor_b32 v109, 3, v109
    v_min_u32 v109, 1, v109
    v_add_u32 v109, -1, v109
    v_and_b32 v109, 0x3fffe80, v109
    v_add_u32 v108, v7, v109
    v_lshlrev_b32 v64, 16, v144
    v_and_b32 v65, 0xffff0000, v144
    v_lshlrev_b32 v66, 16, v145
    v_and_b32 v67, 0xffff0000, v145
    v_lshlrev_b32 v68, 16, v146
    v_and_b32 v69, 0xffff0000, v146
    v_lshlrev_b32 v70, 16, v147
    v_and_b32 v71, 0xffff0000, v147
    v_lshlrev_b32 v72, 16, v148
    v_and_b32 v73, 0xffff0000, v148
    v_lshlrev_b32 v74, 16, v149
    v_and_b32 v75, 0xffff0000, v149
    v_lshlrev_b32 v76, 16, v150
    v_and_b32 v77, 0xffff0000, v150
    v_lshlrev_b32 v78, 16, v151
    v_and_b32 v79, 0xffff0000, v151
    v_accvgpr_read_b32 v112, a0
    v_accvgpr_read_b32 v113, a1
    v_accvgpr_read_b32 v114, a2
    v_accvgpr_read_b32 v115, a3
    v_accvgpr_read_b32 v116, a4
    v_accvgpr_read_b32 v117, a5
    v_accvgpr_read_b32 v118, a6
    v_accvgpr_read_b32 v119, a7
    v_accvgpr_read_b32 v120, a8
    v_accvgpr_read_b32 v121, a9
    v_accvgpr_read_b32 v122, a10
    v_accvgpr_read_b32 v123, a11
    v_accvgpr_read_b32 v124, a12
    v_accvgpr_read_b32 v125, a13
    v_accvgpr_read_b32 v126, a14
    v_accvgpr_read_b32 v127, a15
    v_accvgpr_read_b32 v128, a16
    v_accvgpr_read_b32 v129, a17
    v_accvgpr_read_b32 v130, a18
    v_accvgpr_read_b32 v131, a19
    v_accvgpr_read_b32 v132, a20
    v_accvgpr_read_b32 v133, a21
    v_accvgpr_read_b32 v134, a22
    v_accvgpr_read_b32 v135, a23
    v_accvgpr_read_b32 v136, a24
    v_accvgpr_read_b32 v137, a25
    v_accvgpr_read_b32 v138, a26
    v_accvgpr_read_b32 v139, a27
    v_accvgpr_read_b32 v140, a28
    v_accvgpr_read_b32 v141, a29
    v_accvgpr_read_b32 v142, a30
    v_accvgpr_read_b32 v143, a31
    v_accvgpr_read_b32 v144, a32
    v_accvgpr_read_b32 v145, a33
    v_accvgpr_read_b32 v146, a34
    v_accvgpr_read_b32 v147, a35
    v_accvgpr_read_b32 v148, a36
    v_accvgpr_read_b32 v149, a37
    v_accvgpr_read_b32 v150, a38
    v_accvgpr_read_b32 v151, a39
    v_accvgpr_read_b32 v152, a40
    v_accvgpr_read_b32 v153, a41
    v_accvgpr_read_b32 v154, a42
    v_accvgpr_read_b32 v155, a43
    v_accvgpr_read_b32 v156, a44
    v_accvgpr_read_b32 v157, a45
    v_accvgpr_read_b32 v158, a46
    v_accvgpr_read_b32 v159, a47
    v_accvgpr_read_b32 v160, a48
    v_accvgpr_read_b32 v161, a49
    v_accvgpr_read_b32 v162, a50
    v_accvgpr_read_b32 v163, a51
    v_accvgpr_read_b32 v164, a52
    v_accvgpr_read_b32 v165, a53
    v_accvgpr_read_b32 v166, a54
    v_accvgpr_read_b32 v167, a55
    v_accvgpr_read_b32 v168, a56
    v_accvgpr_read_b32 v169, a57
    v_accvgpr_read_b32 v170, a58
    v_accvgpr_read_b32 v171, a59
    v_accvgpr_read_b32 v172, a60
    v_accvgpr_read_b32 v173, a61
    v_accvgpr_read_b32 v174, a62
    v_accvgpr_read_b32 v175, a63
    v_pk_add_f32 v[112:113], v[112:113], v[64:65]
    v_pk_add_f32 v[114:115], v[114:115], v[66:67]
    v_pk_add_f32 v[116:117], v[116:117], v[64:65]
    v_pk_add_f32 v[118:119], v[118:119], v[66:67]
    v_pk_add_f32 v[120:121], v[120:121], v[64:65]
    v_pk_add_f32 v[122:123], v[122:123], v[66:67]
    v_pk_add_f32 v[124:125], v[124:125], v[64:65]
    v_pk_add_f32 v[126:127], v[126:127], v[66:67]
    v_pk_add_f32 v[128:129], v[128:129], v[68:69]
    v_pk_add_f32 v[130:131], v[130:131], v[70:71]
    v_pk_add_f32 v[132:133], v[132:133], v[68:69]
    v_pk_add_f32 v[134:135], v[134:135], v[70:71]
    v_pk_add_f32 v[136:137], v[136:137], v[68:69]
    v_pk_add_f32 v[138:139], v[138:139], v[70:71]
    v_pk_add_f32 v[140:141], v[140:141], v[68:69]
    v_pk_add_f32 v[142:143], v[142:143], v[70:71]
    v_pk_add_f32 v[144:145], v[144:145], v[72:73]
    v_pk_add_f32 v[146:147], v[146:147], v[74:75]
    v_pk_add_f32 v[148:149], v[148:149], v[72:73]
    v_pk_add_f32 v[150:151], v[150:151], v[74:75]
    v_pk_add_f32 v[152:153], v[152:153], v[72:73]
    v_pk_add_f32 v[154:155], v[154:155], v[74:75]
    v_pk_add_f32 v[156:157], v[156:157], v[72:73]
    v_pk_add_f32 v[158:159], v[158:159], v[74:75]
    v_pk_add_f32 v[160:161], v[160:161], v[76:77]
    v_pk_add_f32 v[162:163], v[162:163], v[78:79]
    v_pk_add_f32 v[164:165], v[164:165], v[76:77]
    v_pk_add_f32 v[166:167], v[166:167], v[78:79]
    v_pk_add_f32 v[168:169], v[168:169], v[76:77]
    v_pk_add_f32 v[170:171], v[170:171], v[78:79]
    v_pk_add_f32 v[172:173], v[172:173], v[76:77]
    v_pk_add_f32 v[174:175], v[174:175], v[78:79]
    v_pk_add_f32 v[112:113], v[112:113], v[176:177]
    v_pk_add_f32 v[114:115], v[114:115], v[178:179]
    v_pk_add_f32 v[128:129], v[128:129], v[192:193]
    v_pk_add_f32 v[130:131], v[130:131], v[194:195]
    v_pk_mul_f32 v[48:49], v[112:113], v[112:113]
    v_pk_mul_f32 v[50:51], v[114:115], v[114:115]
    v_pk_mul_f32 v[52:53], v[128:129], v[128:129]
    v_pk_mul_f32 v[54:55], v[130:131], v[130:131]
    v_pk_fma_f32 v[48:49], v[48:49], s[86:87], v[88:89]
    v_pk_fma_f32 v[50:51], v[50:51], s[86:87], v[88:89]
    v_pk_fma_f32 v[52:53], v[52:53], s[86:87], v[88:89]
    v_pk_fma_f32 v[54:55], v[54:55], s[86:87], v[88:89]
    v_pk_mul_f32 v[48:49], v[48:49], v[112:113]
    v_pk_mul_f32 v[50:51], v[50:51], v[114:115]
    v_pk_mul_f32 v[52:53], v[52:53], v[128:129]
    v_pk_mul_f32 v[54:55], v[54:55], v[130:131]
    v_exp_f32 v48, v48
    v_exp_f32 v49, v49
    v_exp_f32 v50, v50
    v_exp_f32 v51, v51
    v_exp_f32 v52, v52
    v_exp_f32 v53, v53
    v_exp_f32 v54, v54
    v_exp_f32 v55, v55
    v_pk_add_f32 v[48:49], v[48:49], v[90:91]
    v_pk_add_f32 v[50:51], v[50:51], v[90:91]
    v_pk_add_f32 v[52:53], v[52:53], v[90:91]
    v_pk_add_f32 v[54:55], v[54:55], v[90:91]
    v_rcp_f32 v48, v48
    v_rcp_f32 v49, v49
    v_rcp_f32 v50, v50
    v_rcp_f32 v51, v51
    v_rcp_f32 v52, v52
    v_rcp_f32 v53, v53
    v_rcp_f32 v54, v54
    v_rcp_f32 v55, v55
    v_pk_mul_f32 v[48:49], v[48:49], v[112:113]
    v_pk_mul_f32 v[50:51], v[50:51], v[114:115]
    v_pk_mul_f32 v[52:53], v[52:53], v[128:129]
    v_pk_mul_f32 v[54:55], v[54:55], v[130:131]
    v_cvt_pk_bf16_f32 v92, v48, v49
    v_cvt_pk_bf16_f32 v93, v50, v51
    v_cvt_pk_bf16_f32 v94, v52, v53
    v_cvt_pk_bf16_f32 v95, v54, v55
    buffer_store_dwordx4 v[92:95], v108, s[32:35], s84 offen offset:0 sc1
    v_pk_add_f32 v[116:117], v[116:117], v[180:181]
    v_pk_add_f32 v[118:119], v[118:119], v[182:183]
    v_pk_add_f32 v[132:133], v[132:133], v[196:197]
    v_pk_add_f32 v[134:135], v[134:135], v[198:199]
    v_pk_mul_f32 v[48:49], v[116:117], v[116:117]
    v_pk_mul_f32 v[50:51], v[118:119], v[118:119]
    v_pk_mul_f32 v[52:53], v[132:133], v[132:133]
    v_pk_mul_f32 v[54:55], v[134:135], v[134:135]
    v_pk_fma_f32 v[48:49], v[48:49], s[86:87], v[88:89]
    v_pk_fma_f32 v[50:51], v[50:51], s[86:87], v[88:89]
    v_pk_fma_f32 v[52:53], v[52:53], s[86:87], v[88:89]
    v_pk_fma_f32 v[54:55], v[54:55], s[86:87], v[88:89]
    v_pk_mul_f32 v[48:49], v[48:49], v[116:117]
    v_pk_mul_f32 v[50:51], v[50:51], v[118:119]
    v_pk_mul_f32 v[52:53], v[52:53], v[132:133]
    v_pk_mul_f32 v[54:55], v[54:55], v[134:135]
    v_exp_f32 v48, v48
    v_exp_f32 v49, v49
    v_exp_f32 v50, v50
    v_exp_f32 v51, v51
    v_exp_f32 v52, v52
    v_exp_f32 v53, v53
    v_exp_f32 v54, v54
    v_exp_f32 v55, v55
    v_pk_add_f32 v[48:49], v[48:49], v[90:91]
    v_pk_add_f32 v[50:51], v[50:51], v[90:91]
    v_pk_add_f32 v[52:53], v[52:53], v[90:91]
    v_pk_add_f32 v[54:55], v[54:55], v[90:91]
    v_rcp_f32 v48, v48
    v_rcp_f32 v49, v49
    v_rcp_f32 v50, v50
    v_rcp_f32 v51, v51
    v_rcp_f32 v52, v52
    v_rcp_f32 v53, v53
    v_rcp_f32 v54, v54
    v_rcp_f32 v55, v55
    v_pk_mul_f32 v[48:49], v[48:49], v[116:117]
    v_pk_mul_f32 v[50:51], v[50:51], v[118:119]
    v_pk_mul_f32 v[52:53], v[52:53], v[132:133]
    v_pk_mul_f32 v[54:55], v[54:55], v[134:135]
    v_cvt_pk_bf16_f32 v96, v48, v49
    v_cvt_pk_bf16_f32 v97, v50, v51
    v_cvt_pk_bf16_f32 v98, v52, v53
    v_cvt_pk_bf16_f32 v99, v54, v55
    buffer_store_dwordx4 v[96:99], v108, s[32:35], s84 offen offset:1024 sc1
    v_pk_add_f32 v[120:121], v[120:121], v[184:185]
    v_pk_add_f32 v[122:123], v[122:123], v[186:187]
    v_pk_add_f32 v[136:137], v[136:137], v[200:201]
    v_pk_add_f32 v[138:139], v[138:139], v[202:203]
    v_pk_mul_f32 v[48:49], v[120:121], v[120:121]
    v_pk_mul_f32 v[50:51], v[122:123], v[122:123]
    v_pk_mul_f32 v[52:53], v[136:137], v[136:137]
    v_pk_mul_f32 v[54:55], v[138:139], v[138:139]
    v_pk_fma_f32 v[48:49], v[48:49], s[86:87], v[88:89]
    v_pk_fma_f32 v[50:51], v[50:51], s[86:87], v[88:89]
    v_pk_fma_f32 v[52:53], v[52:53], s[86:87], v[88:89]
    v_pk_fma_f32 v[54:55], v[54:55], s[86:87], v[88:89]
    v_pk_mul_f32 v[48:49], v[48:49], v[120:121]
    v_pk_mul_f32 v[50:51], v[50:51], v[122:123]
    v_pk_mul_f32 v[52:53], v[52:53], v[136:137]
    v_pk_mul_f32 v[54:55], v[54:55], v[138:139]
    v_exp_f32 v48, v48
    v_exp_f32 v49, v49
    v_exp_f32 v50, v50
    v_exp_f32 v51, v51
    v_exp_f32 v52, v52
    v_exp_f32 v53, v53
    v_exp_f32 v54, v54
    v_exp_f32 v55, v55
    v_pk_add_f32 v[48:49], v[48:49], v[90:91]
    v_pk_add_f32 v[50:51], v[50:51], v[90:91]
    v_pk_add_f32 v[52:53], v[52:53], v[90:91]
    v_pk_add_f32 v[54:55], v[54:55], v[90:91]
    v_rcp_f32 v48, v48
    v_rcp_f32 v49, v49
    v_rcp_f32 v50, v50
    v_rcp_f32 v51, v51
    v_rcp_f32 v52, v52
    v_rcp_f32 v53, v53
    v_rcp_f32 v54, v54
    v_rcp_f32 v55, v55
    v_pk_mul_f32 v[48:49], v[48:49], v[120:121]
    v_pk_mul_f32 v[50:51], v[50:51], v[122:123]
    v_pk_mul_f32 v[52:53], v[52:53], v[136:137]
    v_pk_mul_f32 v[54:55], v[54:55], v[138:139]
    v_cvt_pk_bf16_f32 v100, v48, v49
    v_cvt_pk_bf16_f32 v101, v50, v51
    v_cvt_pk_bf16_f32 v102, v52, v53
    v_cvt_pk_bf16_f32 v103, v54, v55
    buffer_store_dwordx4 v[100:103], v108, s[32:35], s84 offen offset:2048 sc1
    v_pk_add_f32 v[124:125], v[124:125], v[188:189]
    v_pk_add_f32 v[126:127], v[126:127], v[190:191]
    v_pk_add_f32 v[140:141], v[140:141], v[204:205]
    v_pk_add_f32 v[142:143], v[142:143], v[206:207]
    v_pk_mul_f32 v[48:49], v[124:125], v[124:125]
    v_pk_mul_f32 v[50:51], v[126:127], v[126:127]
    v_pk_mul_f32 v[52:53], v[140:141], v[140:141]
    v_pk_mul_f32 v[54:55], v[142:143], v[142:143]
    v_pk_fma_f32 v[48:49], v[48:49], s[86:87], v[88:89]
    v_pk_fma_f32 v[50:51], v[50:51], s[86:87], v[88:89]
    v_pk_fma_f32 v[52:53], v[52:53], s[86:87], v[88:89]
    v_pk_fma_f32 v[54:55], v[54:55], s[86:87], v[88:89]
    v_pk_mul_f32 v[48:49], v[48:49], v[124:125]
    v_pk_mul_f32 v[50:51], v[50:51], v[126:127]
    v_pk_mul_f32 v[52:53], v[52:53], v[140:141]
    v_pk_mul_f32 v[54:55], v[54:55], v[142:143]
    v_exp_f32 v48, v48
    v_exp_f32 v49, v49
    v_exp_f32 v50, v50
    v_exp_f32 v51, v51
    v_exp_f32 v52, v52
    v_exp_f32 v53, v53
    v_exp_f32 v54, v54
    v_exp_f32 v55, v55
    v_pk_add_f32 v[48:49], v[48:49], v[90:91]
    v_pk_add_f32 v[50:51], v[50:51], v[90:91]
    v_pk_add_f32 v[52:53], v[52:53], v[90:91]
    v_pk_add_f32 v[54:55], v[54:55], v[90:91]
    v_rcp_f32 v48, v48
    v_rcp_f32 v49, v49
    v_rcp_f32 v50, v50
    v_rcp_f32 v51, v51
    v_rcp_f32 v52, v52
    v_rcp_f32 v53, v53
    v_rcp_f32 v54, v54
    v_rcp_f32 v55, v55
    v_pk_mul_f32 v[48:49], v[48:49], v[124:125]
    v_pk_mul_f32 v[50:51], v[50:51], v[126:127]
    v_pk_mul_f32 v[52:53], v[52:53], v[140:141]
    v_pk_mul_f32 v[54:55], v[54:55], v[142:143]
    v_cvt_pk_bf16_f32 v104, v48, v49
    v_cvt_pk_bf16_f32 v105, v50, v51
    v_cvt_pk_bf16_f32 v106, v52, v53
    v_cvt_pk_bf16_f32 v107, v54, v55
    buffer_store_dwordx4 v[104:107], v108, s[32:35], s84 offen offset:3072 sc1
    v_pk_add_f32 v[144:145], v[144:145], v[208:209]
    v_pk_add_f32 v[146:147], v[146:147], v[210:211]
    v_pk_add_f32 v[160:161], v[160:161], v[224:225]
    v_pk_add_f32 v[162:163], v[162:163], v[226:227]
    v_pk_mul_f32 v[48:49], v[144:145], v[144:145]
    v_pk_mul_f32 v[50:51], v[146:147], v[146:147]
    v_pk_mul_f32 v[52:53], v[160:161], v[160:161]
    v_pk_mul_f32 v[54:55], v[162:163], v[162:163]
    v_pk_fma_f32 v[48:49], v[48:49], s[86:87], v[88:89]
    v_pk_fma_f32 v[50:51], v[50:51], s[86:87], v[88:89]
    v_pk_fma_f32 v[52:53], v[52:53], s[86:87], v[88:89]
    v_pk_fma_f32 v[54:55], v[54:55], s[86:87], v[88:89]
    v_pk_mul_f32 v[48:49], v[48:49], v[144:145]
    v_pk_mul_f32 v[50:51], v[50:51], v[146:147]
    v_pk_mul_f32 v[52:53], v[52:53], v[160:161]
    v_pk_mul_f32 v[54:55], v[54:55], v[162:163]
    v_exp_f32 v48, v48
    v_exp_f32 v49, v49
    v_exp_f32 v50, v50
    v_exp_f32 v51, v51
    v_exp_f32 v52, v52
    v_exp_f32 v53, v53
    v_exp_f32 v54, v54
    v_exp_f32 v55, v55
    v_pk_add_f32 v[48:49], v[48:49], v[90:91]
    v_pk_add_f32 v[50:51], v[50:51], v[90:91]
    v_pk_add_f32 v[52:53], v[52:53], v[90:91]
    v_pk_add_f32 v[54:55], v[54:55], v[90:91]
    v_rcp_f32 v48, v48
    v_rcp_f32 v49, v49
    v_rcp_f32 v50, v50
    v_rcp_f32 v51, v51
    v_rcp_f32 v52, v52
    v_rcp_f32 v53, v53
    v_rcp_f32 v54, v54
    v_rcp_f32 v55, v55
    v_pk_mul_f32 v[48:49], v[48:49], v[144:145]
    v_pk_mul_f32 v[50:51], v[50:51], v[146:147]
    v_pk_mul_f32 v[52:53], v[52:53], v[160:161]
    v_pk_mul_f32 v[54:55], v[54:55], v[162:163]
    v_cvt_pk_bf16_f32 v92, v48, v49
    v_cvt_pk_bf16_f32 v93, v50, v51
    v_cvt_pk_bf16_f32 v94, v52, v53
    v_cvt_pk_bf16_f32 v95, v54, v55
    buffer_store_dwordx4 v[92:95], v108, s[32:35], s85 offen offset:0 sc1
    v_pk_add_f32 v[148:149], v[148:149], v[212:213]
    v_pk_add_f32 v[150:151], v[150:151], v[214:215]
    v_pk_add_f32 v[164:165], v[164:165], v[228:229]
    v_pk_add_f32 v[166:167], v[166:167], v[230:231]
    v_pk_mul_f32 v[48:49], v[148:149], v[148:149]
    v_pk_mul_f32 v[50:51], v[150:151], v[150:151]
    v_pk_mul_f32 v[52:53], v[164:165], v[164:165]
    v_pk_mul_f32 v[54:55], v[166:167], v[166:167]
    v_pk_fma_f32 v[48:49], v[48:49], s[86:87], v[88:89]
    v_pk_fma_f32 v[50:51], v[50:51], s[86:87], v[88:89]
    v_pk_fma_f32 v[52:53], v[52:53], s[86:87], v[88:89]
    v_pk_fma_f32 v[54:55], v[54:55], s[86:87], v[88:89]
    v_pk_mul_f32 v[48:49], v[48:49], v[148:149]
    v_pk_mul_f32 v[50:51], v[50:51], v[150:151]
    v_pk_mul_f32 v[52:53], v[52:53], v[164:165]
    v_pk_mul_f32 v[54:55], v[54:55], v[166:167]
    v_exp_f32 v48, v48
    v_exp_f32 v49, v49
    v_exp_f32 v50, v50
    v_exp_f32 v51, v51
    v_exp_f32 v52, v52
    v_exp_f32 v53, v53
    v_exp_f32 v54, v54
    v_exp_f32 v55, v55
    v_pk_add_f32 v[48:49], v[48:49], v[90:91]
    v_pk_add_f32 v[50:51], v[50:51], v[90:91]
    v_pk_add_f32 v[52:53], v[52:53], v[90:91]
    v_pk_add_f32 v[54:55], v[54:55], v[90:91]
    v_rcp_f32 v48, v48
    v_rcp_f32 v49, v49
    v_rcp_f32 v50, v50
    v_rcp_f32 v51, v51
    v_rcp_f32 v52, v52
    v_rcp_f32 v53, v53
    v_rcp_f32 v54, v54
    v_rcp_f32 v55, v55
    v_pk_mul_f32 v[48:49], v[48:49], v[148:149]
    v_pk_mul_f32 v[50:51], v[50:51], v[150:151]
    v_pk_mul_f32 v[52:53], v[52:53], v[164:165]
    v_pk_mul_f32 v[54:55], v[54:55], v[166:167]
    v_cvt_pk_bf16_f32 v96, v48, v49
    v_cvt_pk_bf16_f32 v97, v50, v51
    v_cvt_pk_bf16_f32 v98, v52, v53
    v_cvt_pk_bf16_f32 v99, v54, v55
    buffer_store_dwordx4 v[96:99], v108, s[32:35], s85 offen offset:1024 sc1
    v_pk_add_f32 v[152:153], v[152:153], v[216:217]
    v_pk_add_f32 v[154:155], v[154:155], v[218:219]
    v_pk_add_f32 v[168:169], v[168:169], v[232:233]
    v_pk_add_f32 v[170:171], v[170:171], v[234:235]
    v_pk_mul_f32 v[48:49], v[152:153], v[152:153]
    v_pk_mul_f32 v[50:51], v[154:155], v[154:155]
    v_pk_mul_f32 v[52:53], v[168:169], v[168:169]
    v_pk_mul_f32 v[54:55], v[170:171], v[170:171]
    v_pk_fma_f32 v[48:49], v[48:49], s[86:87], v[88:89]
    v_pk_fma_f32 v[50:51], v[50:51], s[86:87], v[88:89]
    v_pk_fma_f32 v[52:53], v[52:53], s[86:87], v[88:89]
    v_pk_fma_f32 v[54:55], v[54:55], s[86:87], v[88:89]
    v_pk_mul_f32 v[48:49], v[48:49], v[152:153]
    v_pk_mul_f32 v[50:51], v[50:51], v[154:155]
    v_pk_mul_f32 v[52:53], v[52:53], v[168:169]
    v_pk_mul_f32 v[54:55], v[54:55], v[170:171]
    v_exp_f32 v48, v48
    v_exp_f32 v49, v49
    v_exp_f32 v50, v50
    v_exp_f32 v51, v51
    v_exp_f32 v52, v52
    v_exp_f32 v53, v53
    v_exp_f32 v54, v54
    v_exp_f32 v55, v55
    v_pk_add_f32 v[48:49], v[48:49], v[90:91]
    v_pk_add_f32 v[50:51], v[50:51], v[90:91]
    v_pk_add_f32 v[52:53], v[52:53], v[90:91]
    v_pk_add_f32 v[54:55], v[54:55], v[90:91]
    v_rcp_f32 v48, v48
    v_rcp_f32 v49, v49
    v_rcp_f32 v50, v50
    v_rcp_f32 v51, v51
    v_rcp_f32 v52, v52
    v_rcp_f32 v53, v53
    v_rcp_f32 v54, v54
    v_rcp_f32 v55, v55
    v_pk_mul_f32 v[48:49], v[48:49], v[152:153]
    v_pk_mul_f32 v[50:51], v[50:51], v[154:155]
    v_pk_mul_f32 v[52:53], v[52:53], v[168:169]
    v_pk_mul_f32 v[54:55], v[54:55], v[170:171]
    v_cvt_pk_bf16_f32 v100, v48, v49
    v_cvt_pk_bf16_f32 v101, v50, v51
    v_cvt_pk_bf16_f32 v102, v52, v53
    v_cvt_pk_bf16_f32 v103, v54, v55
    buffer_store_dwordx4 v[100:103], v108, s[32:35], s85 offen offset:2048 sc1
    v_pk_add_f32 v[156:157], v[156:157], v[220:221]
    v_pk_add_f32 v[158:159], v[158:159], v[222:223]
    v_pk_add_f32 v[172:173], v[172:173], v[236:237]
    v_pk_add_f32 v[174:175], v[174:175], v[238:239]
    v_pk_mul_f32 v[48:49], v[156:157], v[156:157]
    v_pk_mul_f32 v[50:51], v[158:159], v[158:159]
    v_pk_mul_f32 v[52:53], v[172:173], v[172:173]
    v_pk_mul_f32 v[54:55], v[174:175], v[174:175]
    v_pk_fma_f32 v[48:49], v[48:49], s[86:87], v[88:89]
    v_pk_fma_f32 v[50:51], v[50:51], s[86:87], v[88:89]
    v_pk_fma_f32 v[52:53], v[52:53], s[86:87], v[88:89]
    v_pk_fma_f32 v[54:55], v[54:55], s[86:87], v[88:89]
    v_pk_mul_f32 v[48:49], v[48:49], v[156:157]
    v_pk_mul_f32 v[50:51], v[50:51], v[158:159]
    v_pk_mul_f32 v[52:53], v[52:53], v[172:173]
    v_pk_mul_f32 v[54:55], v[54:55], v[174:175]
    v_exp_f32 v48, v48
    v_exp_f32 v49, v49
    v_exp_f32 v50, v50
    v_exp_f32 v51, v51
    v_exp_f32 v52, v52
    v_exp_f32 v53, v53
    v_exp_f32 v54, v54
    v_exp_f32 v55, v55
    v_pk_add_f32 v[48:49], v[48:49], v[90:91]
    v_pk_add_f32 v[50:51], v[50:51], v[90:91]
    v_pk_add_f32 v[52:53], v[52:53], v[90:91]
    v_pk_add_f32 v[54:55], v[54:55], v[90:91]
    v_rcp_f32 v48, v48
    v_rcp_f32 v49, v49
    v_rcp_f32 v50, v50
    v_rcp_f32 v51, v51
    v_rcp_f32 v52, v52
    v_rcp_f32 v53, v53
    v_rcp_f32 v54, v54
    v_rcp_f32 v55, v55
    v_pk_mul_f32 v[48:49], v[48:49], v[156:157]
    v_pk_mul_f32 v[50:51], v[50:51], v[158:159]
    v_pk_mul_f32 v[52:53], v[52:53], v[172:173]
    v_pk_mul_f32 v[54:55], v[54:55], v[174:175]
    v_cvt_pk_bf16_f32 v104, v48, v49
    v_cvt_pk_bf16_f32 v105, v50, v51
    v_cvt_pk_bf16_f32 v106, v52, v53
    v_cvt_pk_bf16_f32 v107, v54, v55
    buffer_store_dwordx4 v[104:107], v108, s[32:35], s85 offen offset:3072 sc1
    s_lshl_b32 s84, s72, 14
    v_subrev_u32 v40, s84, v40
    v_subrev_u32 v41, s84, v41
    v_subrev_u32 v42, s84, v42
    v_subrev_u32 v43, s84, v43
    v_subrev_u32 v44, s84, v44
    v_subrev_u32 v45, s84, v45
    v_subrev_u32 v46, s84, v46
    v_subrev_u32 v47, s84, v47
    ds_read_b64_tr_b16 v[48:49], v40 offset:32768
    ds_read_b64_tr_b16 v[50:51], v40 offset:36864
    ds_read_b64_tr_b16 v[52:53], v41 offset:32768
    ds_read_b64_tr_b16 v[54:55], v41 offset:36864
    ds_read_b64_tr_b16 v[56:57], v42 offset:32768
    ds_read_b64_tr_b16 v[58:59], v42 offset:36864
    ds_read_b64_tr_b16 v[60:61], v43 offset:32768
    ds_read_b64_tr_b16 v[62:63], v43 offset:36864
    ds_read_b64_tr_b16 v[64:65], v44 offset:32768
    ds_read_b64_tr_b16 v[66:67], v44 offset:36864
    ds_read_b64_tr_b16 v[68:69], v45 offset:32768
    ds_read_b64_tr_b16 v[70:71], v45 offset:36864
    ds_read_b64_tr_b16 v[72:73], v46 offset:32768
    ds_read_b64_tr_b16 v[74:75], v46 offset:36864
    ds_read_b64_tr_b16 v[76:77], v47 offset:32768
    ds_read_b64_tr_b16 v[78:79], v47 offset:36864
km_yq:
    v_mov_b32 v112, 0
    v_mov_b32 v113, 0
    v_mov_b64 v[114:115], v[112:113]
    v_mov_b64 v[116:117], v[112:113]
    v_mov_b64 v[118:119], v[112:113]
    v_mov_b64 v[120:121], v[112:113]
    v_mov_b64 v[122:123], v[112:113]
    v_mov_b64 v[124:125], v[112:113]
    v_mov_b64 v[126:127], v[112:113]
    v_mov_b64 v[128:129], v[112:113]
    v_mov_b64 v[130:131], v[112:113]
    v_mov_b64 v[132:133], v[112:113]
    v_mov_b64 v[134:135], v[112:113]
    v_mov_b64 v[136:137], v[112:113]
    v_mov_b64 v[138:139], v[112:113]
    v_mov_b64 v[140:141], v[112:113]
    v_mov_b64 v[142:143], v[112:113]
    v_mov_b64 v[144:145], v[112:113]
    v_mov_b64 v[146:147], v[112:113]
    v_mov_b64 v[148:149], v[112:113]
    v_mov_b64 v[150:151], v[112:113]
    v_mov_b64 v[152:153], v[112:113]
    v_mov_b64 v[154:155], v[112:113]
    v_mov_b64 v[156:157], v[112:113]
    v_mov_b64 v[158:159], v[112:113]
    v_mov_b64 v[160:161], v[112:113]
    v_mov_b64 v[162:163], v[112:113]
    v_mov_b64 v[164:165], v[112:113]
    v_mov_b64 v[166:167], v[112:113]
    v_mov_b64 v[168:169], v[112:113]
    v_mov_b64 v[170:171], v[112:113]
    v_mov_b64 v[172:173], v[112:113]
    v_mov_b64 v[174:175], v[112:113]
    v_mov_b64 v[176:177], v[112:113]
    v_mov_b64 v[178:179], v[112:113]
    v_mov_b64 v[180:181], v[112:113]
    v_mov_b64 v[182:183], v[112:113]
    v_mov_b64 v[184:185], v[112:113]
    v_mov_b64 v[186:187], v[112:113]
    v_mov_b64 v[188:189], v[112:113]
    v_mov_b64 v[190:191], v[112:113]
    v_mov_b64 v[192:193], v[112:113]
    v_mov_b64 v[194:195], v[112:113]
    v_mov_b64 v[196:197], v[112:113]
    v_mov_b64 v[198:199], v[112:113]
    v_mov_b64 v[200:201], v[112:113]
    v_mov_b64 v[202:203], v[112:113]
    v_mov_b64 v[204:205], v[112:113]
    v_mov_b64 v[206:207], v[112:113]
    v_mov_b64 v[208:209], v[112:113]
    v_mov_b64 v[210:211], v[112:113]
    v_mov_b64 v[212:213], v[112:113]
    v_mov_b64 v[214:215], v[112:113]
    v_mov_b64 v[216:217], v[112:113]
    v_mov_b64 v[218:219], v[112:113]
    v_mov_b64 v[220:221], v[112:113]
    v_mov_b64 v[222:223], v[112:113]
    v_mov_b64 v[224:225], v[112:113]
    v_mov_b64 v[226:227], v[112:113]
    v_mov_b64 v[228:229], v[112:113]
    v_mov_b64 v[230:231], v[112:113]
    v_mov_b64 v[232:233], v[112:113]
    v_mov_b64 v[234:235], v[112:113]
    v_mov_b64 v[236:237], v[112:113]
    v_mov_b64 v[238:239], v[112:113]
    s_waitcnt lgkmcnt(0)
    s_mov_b32 s70, 3
.p2align 6
kmy_qloop:
    v_mfma_f32_16x16x32_bf16 v[112:115], v[48:51], a[192:195], v[112:115]
    ds_read_b64_tr_b16 v[80:81], v40 offset:40960
    v_mfma_f32_16x16x32_bf16 v[116:119], v[48:51], a[196:199], v[116:119]
    ds_read_b64_tr_b16 v[82:83], v40 offset:45056
    s_add_u32 m0, s68, 98304
    s_add_u32 s66, s66, 524288
    v_mfma_f32_16x16x32_bf16 v[120:123], v[48:51], a[200:203], v[120:123]
    ds_read_b64_tr_b16 v[84:85], v41 offset:40960
    buffer_load_dwordx4 v2, s[8:11], s66 offen offset:0 lds
    v_mfma_f32_16x16x32_bf16 v[124:127], v[48:51], a[204:207], v[124:127]
    ds_read_b64_tr_b16 v[86:87], v41 offset:45056
    v_mfma_f32_16x16x32_bf16 v[128:131], v[52:55], a[192:195], v[128:131]
    buffer_load_dwordx4 v3, s[8:11], s66 offen offset:1024 lds
    v_mfma_f32_16x16x32_bf16 v[132:135], v[52:55], a[196:199], v[132:135]
    ds_read_b64_tr_b16 v[88:89], v42 offset:40960
    v_mfma_f32_16x16x32_bf16 v[136:139], v[52:55], a[200:203], v[136:139]
    ds_read_b64_tr_b16 v[90:91], v42 offset:45056
    v_mfma_f32_16x16x32_bf16 v[140:143], v[52:55], a[204:207], v[140:143]
    ds_read_b64_tr_b16 v[92:93], v43 offset:40960
    v_mfma_f32_16x16x32_bf16 v[144:147], v[56:59], a[192:195], v[144:147]
    ds_read_b64_tr_b16 v[94:95], v43 offset:45056
    buffer_load_dwordx4 v4, s[8:11], s66 offen offset:2048 lds
    v_mfma_f32_16x16x32_bf16 v[148:151], v[56:59], a[196:199], v[148:151]
    v_mfma_f32_16x16x32_bf16 v[152:155], v[56:59], a[200:203], v[152:155]
    ds_read_b64_tr_b16 v[96:97], v44 offset:40960
    v_mfma_f32_16x16x32_bf16 v[156:159], v[56:59], a[204:207], v[156:159]
    ds_read_b64_tr_b16 v[98:99], v44 offset:45056
    v_mfma_f32_16x16x32_bf16 v[160:163], v[60:63], a[192:195], v[160:163]
    ds_read_b64_tr_b16 v[100:101], v45 offset:40960
    buffer_load_dwordx4 v5, s[8:11], s66 offen offset:3072 lds
    v_mfma_f32_16x16x32_bf16 v[164:167], v[60:63], a[196:199], v[164:167]
    ds_read_b64_tr_b16 v[102:103], v45 offset:45056
    v_mfma_f32_16x16x32_bf16 v[168:171], v[60:63], a[200:203], v[168:171]
    v_mfma_f32_16x16x32_bf16 v[172:175], v[60:63], a[204:207], v[172:175]
    ds_read_b64_tr_b16 v[104:105], v46 offset:40960
    v_mfma_f32_16x16x32_bf16 v[176:179], v[64:67], a[192:195], v[176:179]
    ds_read_b64_tr_b16 v[106:107], v46 offset:45056
    buffer_load_dwordx4 a[160:163], v6, s[12:15], s67 offen offset:0 sc1
    v_mfma_f32_16x16x32_bf16 v[180:183], v[64:67], a[196:199], v[180:183]
    ds_read_b64_tr_b16 v[108:109], v47 offset:40960
    v_mfma_f32_16x16x32_bf16 v[184:187], v[64:67], a[200:203], v[184:187]
    ds_read_b64_tr_b16 v[110:111], v47 offset:45056
    v_mfma_f32_16x16x32_bf16 v[188:191], v[64:67], a[204:207], v[188:191]
    v_mfma_f32_16x16x32_bf16 v[192:195], v[68:71], a[192:195], v[192:195]
    buffer_load_dwordx4 a[164:167], v6, s[12:15], s67 offen offset:1024 sc1
    v_mfma_f32_16x16x32_bf16 v[196:199], v[68:71], a[196:199], v[196:199]
    v_mfma_f32_16x16x32_bf16 v[200:203], v[68:71], a[200:203], v[200:203]
    v_mfma_f32_16x16x32_bf16 v[204:207], v[68:71], a[204:207], v[204:207]
    v_mfma_f32_16x16x32_bf16 v[208:211], v[72:75], a[192:195], v[208:211]
    buffer_load_dwordx4 a[168:171], v6, s[12:15], s67 offen offset:2048 sc1
    v_mfma_f32_16x16x32_bf16 v[212:215], v[72:75], a[196:199], v[212:215]
    v_mfma_f32_16x16x32_bf16 v[216:219], v[72:75], a[200:203], v[216:219]
    v_mfma_f32_16x16x32_bf16 v[220:223], v[72:75], a[204:207], v[220:223]
    v_mfma_f32_16x16x32_bf16 v[224:227], v[76:79], a[192:195], v[224:227]
    buffer_load_dwordx4 a[172:175], v6, s[12:15], s67 offen offset:3072 sc1
    v_mfma_f32_16x16x32_bf16 v[228:231], v[76:79], a[196:199], v[228:231]
    v_mfma_f32_16x16x32_bf16 v[232:235], v[76:79], a[200:203], v[232:235]
    v_mfma_f32_16x16x32_bf16 v[236:239], v[76:79], a[204:207], v[236:239]
    s_add_u32 s67, s67, 131072
    s_waitcnt vmcnt(20) lgkmcnt(0)
    s_barrier
    v_mfma_f32_16x16x32_bf16 v[112:115], v[80:83], a[208:211], v[112:115]
    ds_read_b64_tr_b16 v[48:49], v40 offset:49152
    v_mfma_f32_16x16x32_bf16 v[116:119], v[80:83], a[212:215], v[116:119]
    ds_read_b64_tr_b16 v[50:51], v40 offset:53248
    buffer_load_dwordx4 a[176:179], v6, s[12:15], s67 offen offset:0 sc1
    v_mfma_f32_16x16x32_bf16 v[120:123], v[80:83], a[216:219], v[120:123]
    ds_read_b64_tr_b16 v[52:53], v41 offset:49152
    v_mfma_f32_16x16x32_bf16 v[124:127], v[80:83], a[220:223], v[124:127]
    ds_read_b64_tr_b16 v[54:55], v41 offset:53248
    v_mfma_f32_16x16x32_bf16 v[128:131], v[84:87], a[208:211], v[128:131]
    v_mfma_f32_16x16x32_bf16 v[132:135], v[84:87], a[212:215], v[132:135]
    ds_read_b64_tr_b16 v[56:57], v42 offset:49152
    v_mfma_f32_16x16x32_bf16 v[136:139], v[84:87], a[216:219], v[136:139]
    ds_read_b64_tr_b16 v[58:59], v42 offset:53248
    v_mfma_f32_16x16x32_bf16 v[140:143], v[84:87], a[220:223], v[140:143]
    ds_read_b64_tr_b16 v[60:61], v43 offset:49152
    v_mfma_f32_16x16x32_bf16 v[144:147], v[88:91], a[208:211], v[144:147]
    ds_read_b64_tr_b16 v[62:63], v43 offset:53248
    buffer_load_dwordx4 a[180:183], v6, s[12:15], s67 offen offset:1024 sc1
    v_mfma_f32_16x16x32_bf16 v[148:151], v[88:91], a[212:215], v[148:151]
    v_mfma_f32_16x16x32_bf16 v[152:155], v[88:91], a[216:219], v[152:155]
    ds_read_b64_tr_b16 v[64:65], v44 offset:49152
    v_mfma_f32_16x16x32_bf16 v[156:159], v[88:91], a[220:223], v[156:159]
    ds_read_b64_tr_b16 v[66:67], v44 offset:53248
    v_mfma_f32_16x16x32_bf16 v[160:163], v[92:95], a[208:211], v[160:163]
    ds_read_b64_tr_b16 v[68:69], v45 offset:49152
    v_mfma_f32_16x16x32_bf16 v[164:167], v[92:95], a[212:215], v[164:167]
    ds_read_b64_tr_b16 v[70:71], v45 offset:53248
    v_mfma_f32_16x16x32_bf16 v[168:171], v[92:95], a[216:219], v[168:171]
    v_mfma_f32_16x16x32_bf16 v[172:175], v[92:95], a[220:223], v[172:175]
    ds_read_b64_tr_b16 v[72:73], v46 offset:49152
    v_mfma_f32_16x16x32_bf16 v[176:179], v[96:99], a[208:211], v[176:179]
    ds_read_b64_tr_b16 v[74:75], v46 offset:53248
    buffer_load_dwordx4 a[184:187], v6, s[12:15], s67 offen offset:2048 sc1
    v_mfma_f32_16x16x32_bf16 v[180:183], v[96:99], a[212:215], v[180:183]
    ds_read_b64_tr_b16 v[76:77], v47 offset:49152
    v_mfma_f32_16x16x32_bf16 v[184:187], v[96:99], a[216:219], v[184:187]
    ds_read_b64_tr_b16 v[78:79], v47 offset:53248
    v_mfma_f32_16x16x32_bf16 v[188:191], v[96:99], a[220:223], v[188:191]
    v_mfma_f32_16x16x32_bf16 v[192:195], v[100:103], a[208:211], v[192:195]
    v_mfma_f32_16x16x32_bf16 v[196:199], v[100:103], a[212:215], v[196:199]
    v_mfma_f32_16x16x32_bf16 v[200:203], v[100:103], a[216:219], v[200:203]
    v_mfma_f32_16x16x32_bf16 v[204:207], v[100:103], a[220:223], v[204:207]
    v_mfma_f32_16x16x32_bf16 v[208:211], v[104:107], a[208:211], v[208:211]
    buffer_load_dwordx4 a[188:191], v6, s[12:15], s67 offen offset:3072 sc1
    v_mfma_f32_16x16x32_bf16 v[212:215], v[104:107], a[212:215], v[212:215]
    v_mfma_f32_16x16x32_bf16 v[216:219], v[104:107], a[216:219], v[216:219]
    v_mfma_f32_16x16x32_bf16 v[220:223], v[104:107], a[220:223], v[220:223]
    v_mfma_f32_16x16x32_bf16 v[224:227], v[108:111], a[208:211], v[224:227]
    v_mfma_f32_16x16x32_bf16 v[228:231], v[108:111], a[212:215], v[228:231]
    v_mfma_f32_16x16x32_bf16 v[232:235], v[108:111], a[216:219], v[232:235]
    v_mfma_f32_16x16x32_bf16 v[236:239], v[108:111], a[220:223], v[236:239]
    s_add_u32 s67, s67, 131072
    s_waitcnt lgkmcnt(0)
    v_mfma_f32_16x16x32_bf16 v[112:115], v[48:51], a[224:227], v[112:115]
    ds_read_b64_tr_b16 v[80:81], v40 offset:57344
    v_mfma_f32_16x16x32_bf16 v[116:119], v[48:51], a[228:231], v[116:119]
    ds_read_b64_tr_b16 v[82:83], v40 offset:61440
    s_add_u32 m0, s68, 131072
    s_add_u32 s66, s66, 524288
    v_mfma_f32_16x16x32_bf16 v[120:123], v[48:51], a[232:235], v[120:123]
    ds_read_b64_tr_b16 v[84:85], v41 offset:57344
    buffer_load_dwordx4 v2, s[8:11], s66 offen offset:0 lds
    v_mfma_f32_16x16x32_bf16 v[124:127], v[48:51], a[236:239], v[124:127]
    ds_read_b64_tr_b16 v[86:87], v41 offset:61440
    v_mfma_f32_16x16x32_bf16 v[128:131], v[52:55], a[224:227], v[128:131]
    buffer_load_dwordx4 v3, s[8:11], s66 offen offset:1024 lds
    v_mfma_f32_16x16x32_bf16 v[132:135], v[52:55], a[228:231], v[132:135]
    ds_read_b64_tr_b16 v[88:89], v42 offset:57344
    v_mfma_f32_16x16x32_bf16 v[136:139], v[52:55], a[232:235], v[136:139]
    ds_read_b64_tr_b16 v[90:91], v42 offset:61440
    v_mfma_f32_16x16x32_bf16 v[140:143], v[52:55], a[236:239], v[140:143]
    ds_read_b64_tr_b16 v[92:93], v43 offset:57344
    v_mfma_f32_16x16x32_bf16 v[144:147], v[56:59], a[224:227], v[144:147]
    ds_read_b64_tr_b16 v[94:95], v43 offset:61440
    buffer_load_dwordx4 v4, s[8:11], s66 offen offset:2048 lds
    v_mfma_f32_16x16x32_bf16 v[148:151], v[56:59], a[228:231], v[148:151]
    v_mfma_f32_16x16x32_bf16 v[152:155], v[56:59], a[232:235], v[152:155]
    ds_read_b64_tr_b16 v[96:97], v44 offset:57344
    v_mfma_f32_16x16x32_bf16 v[156:159], v[56:59], a[236:239], v[156:159]
    ds_read_b64_tr_b16 v[98:99], v44 offset:61440
    v_mfma_f32_16x16x32_bf16 v[160:163], v[60:63], a[224:227], v[160:163]
    ds_read_b64_tr_b16 v[100:101], v45 offset:57344
    buffer_load_dwordx4 v5, s[8:11], s66 offen offset:3072 lds
    v_mfma_f32_16x16x32_bf16 v[164:167], v[60:63], a[228:231], v[164:167]
    ds_read_b64_tr_b16 v[102:103], v45 offset:61440
    v_mfma_f32_16x16x32_bf16 v[168:171], v[60:63], a[232:235], v[168:171]
    v_mfma_f32_16x16x32_bf16 v[172:175], v[60:63], a[236:239], v[172:175]
    ds_read_b64_tr_b16 v[104:105], v46 offset:57344
    v_mfma_f32_16x16x32_bf16 v[176:179], v[64:67], a[224:227], v[176:179]
    ds_read_b64_tr_b16 v[106:107], v46 offset:61440
    buffer_load_dwordx4 a[192:195], v6, s[12:15], s67 offen offset:0 sc1
    v_mfma_f32_16x16x32_bf16 v[180:183], v[64:67], a[228:231], v[180:183]
    ds_read_b64_tr_b16 v[108:109], v47 offset:57344
    v_mfma_f32_16x16x32_bf16 v[184:187], v[64:67], a[232:235], v[184:187]
    ds_read_b64_tr_b16 v[110:111], v47 offset:61440
    v_mfma_f32_16x16x32_bf16 v[188:191], v[64:67], a[236:239], v[188:191]
    v_mfma_f32_16x16x32_bf16 v[192:195], v[68:71], a[224:227], v[192:195]
    buffer_load_dwordx4 a[196:199], v6, s[12:15], s67 offen offset:1024 sc1
    v_mfma_f32_16x16x32_bf16 v[196:199], v[68:71], a[228:231], v[196:199]
    v_mfma_f32_16x16x32_bf16 v[200:203], v[68:71], a[232:235], v[200:203]
    v_mfma_f32_16x16x32_bf16 v[204:207], v[68:71], a[236:239], v[204:207]
    v_mfma_f32_16x16x32_bf16 v[208:211], v[72:75], a[224:227], v[208:211]
    buffer_load_dwordx4 a[200:203], v6, s[12:15], s67 offen offset:2048 sc1
    v_mfma_f32_16x16x32_bf16 v[212:215], v[72:75], a[228:231], v[212:215]
    v_mfma_f32_16x16x32_bf16 v[216:219], v[72:75], a[232:235], v[216:219]
    v_mfma_f32_16x16x32_bf16 v[220:223], v[72:75], a[236:239], v[220:223]
    v_mfma_f32_16x16x32_bf16 v[224:227], v[76:79], a[224:227], v[224:227]
    buffer_load_dwordx4 a[204:207], v6, s[12:15], s67 offen offset:3072 sc1
    v_mfma_f32_16x16x32_bf16 v[228:231], v[76:79], a[228:231], v[228:231]
    v_mfma_f32_16x16x32_bf16 v[232:235], v[76:79], a[232:235], v[232:235]
    v_mfma_f32_16x16x32_bf16 v[236:239], v[76:79], a[236:239], v[236:239]
    s_add_u32 s67, s67, 131072
    s_waitcnt vmcnt(20) lgkmcnt(0)
    s_barrier
    s_cmp_eq_u32 s70, 3
    s_cbranch_scc1 km_yq1
km_yq1_ret:
    s_cmp_eq_u32 s70, 2
    s_cbranch_scc1 km_yq2
km_yq2_ret:
    v_mfma_f32_16x16x32_bf16 v[112:115], v[80:83], a[240:243], v[112:115]
    ds_read_b64_tr_b16 v[48:49], v40 offset:16384
    v_mfma_f32_16x16x32_bf16 v[116:119], v[80:83], a[244:247], v[116:119]
    ds_read_b64_tr_b16 v[50:51], v40 offset:20480
    buffer_load_dwordx4 a[208:211], v6, s[12:15], s67 offen offset:0 sc1
    v_mfma_f32_16x16x32_bf16 v[120:123], v[80:83], a[248:251], v[120:123]
    ds_read_b64_tr_b16 v[52:53], v41 offset:16384
    v_mfma_f32_16x16x32_bf16 v[124:127], v[80:83], a[252:255], v[124:127]
    ds_read_b64_tr_b16 v[54:55], v41 offset:20480
    v_mfma_f32_16x16x32_bf16 v[128:131], v[84:87], a[240:243], v[128:131]
    v_mfma_f32_16x16x32_bf16 v[132:135], v[84:87], a[244:247], v[132:135]
    ds_read_b64_tr_b16 v[56:57], v42 offset:16384
    v_mfma_f32_16x16x32_bf16 v[136:139], v[84:87], a[248:251], v[136:139]
    ds_read_b64_tr_b16 v[58:59], v42 offset:20480
    v_mfma_f32_16x16x32_bf16 v[140:143], v[84:87], a[252:255], v[140:143]
    ds_read_b64_tr_b16 v[60:61], v43 offset:16384
    v_mfma_f32_16x16x32_bf16 v[144:147], v[88:91], a[240:243], v[144:147]
    ds_read_b64_tr_b16 v[62:63], v43 offset:20480
    buffer_load_dwordx4 a[212:215], v6, s[12:15], s67 offen offset:1024 sc1
    v_mfma_f32_16x16x32_bf16 v[148:151], v[88:91], a[244:247], v[148:151]
    v_mfma_f32_16x16x32_bf16 v[152:155], v[88:91], a[248:251], v[152:155]
    ds_read_b64_tr_b16 v[64:65], v44 offset:16384
    v_mfma_f32_16x16x32_bf16 v[156:159], v[88:91], a[252:255], v[156:159]
    ds_read_b64_tr_b16 v[66:67], v44 offset:20480
    v_mfma_f32_16x16x32_bf16 v[160:163], v[92:95], a[240:243], v[160:163]
    ds_read_b64_tr_b16 v[68:69], v45 offset:16384
    v_mfma_f32_16x16x32_bf16 v[164:167], v[92:95], a[244:247], v[164:167]
    ds_read_b64_tr_b16 v[70:71], v45 offset:20480
    v_mfma_f32_16x16x32_bf16 v[168:171], v[92:95], a[248:251], v[168:171]
    v_mfma_f32_16x16x32_bf16 v[172:175], v[92:95], a[252:255], v[172:175]
    ds_read_b64_tr_b16 v[72:73], v46 offset:16384
    v_mfma_f32_16x16x32_bf16 v[176:179], v[96:99], a[240:243], v[176:179]
    ds_read_b64_tr_b16 v[74:75], v46 offset:20480
    buffer_load_dwordx4 a[216:219], v6, s[12:15], s67 offen offset:2048 sc1
    v_mfma_f32_16x16x32_bf16 v[180:183], v[96:99], a[244:247], v[180:183]
    ds_read_b64_tr_b16 v[76:77], v47 offset:16384
    v_mfma_f32_16x16x32_bf16 v[184:187], v[96:99], a[248:251], v[184:187]
    ds_read_b64_tr_b16 v[78:79], v47 offset:20480
    v_mfma_f32_16x16x32_bf16 v[188:191], v[96:99], a[252:255], v[188:191]
    v_mfma_f32_16x16x32_bf16 v[192:195], v[100:103], a[240:243], v[192:195]
    v_mfma_f32_16x16x32_bf16 v[196:199], v[100:103], a[244:247], v[196:199]
    v_mfma_f32_16x16x32_bf16 v[200:203], v[100:103], a[248:251], v[200:203]
    v_mfma_f32_16x16x32_bf16 v[204:207], v[100:103], a[252:255], v[204:207]
    v_mfma_f32_16x16x32_bf16 v[208:211], v[104:107], a[240:243], v[208:211]
    buffer_load_dwordx4 a[220:223], v6, s[12:15], s67 offen offset:3072 sc1
    v_mfma_f32_16x16x32_bf16 v[212:215], v[104:107], a[244:247], v[212:215]
    v_mfma_f32_16x16x32_bf16 v[216:219], v[104:107], a[248:251], v[216:219]
    v_mfma_f32_16x16x32_bf16 v[220:223], v[104:107], a[252:255], v[220:223]
    v_mfma_f32_16x16x32_bf16 v[224:227], v[108:111], a[240:243], v[224:227]
    v_mfma_f32_16x16x32_bf16 v[228:231], v[108:111], a[244:247], v[228:231]
    v_mfma_f32_16x16x32_bf16 v[232:235], v[108:111], a[248:251], v[232:235]
    v_mfma_f32_16x16x32_bf16 v[236:239], v[108:111], a[252:255], v[236:239]
    s_add_u32 s67, s67, 131072
    s_waitcnt lgkmcnt(0)
    v_mfma_f32_16x16x32_bf16 v[112:115], v[48:51], a[128:131], v[112:115]
    ds_read_b64_tr_b16 v[80:81], v40 offset:24576
    v_mfma_f32_16x16x32_bf16 v[116:119], v[48:51], a[132:135], v[116:119]
    ds_read_b64_tr_b16 v[82:83], v40 offset:28672
    s_add_u32 m0, s68, 147456
    s_add_u32 s66, s66, 524288
    v_mfma_f32_16x16x32_bf16 v[120:123], v[48:51], a[136:139], v[120:123]
    ds_read_b64_tr_b16 v[84:85], v41 offset:24576
    buffer_load_dwordx4 v2, s[8:11], s66 offen offset:0 lds
    v_mfma_f32_16x16x32_bf16 v[124:127], v[48:51], a[140:143], v[124:127]
    ds_read_b64_tr_b16 v[86:87], v41 offset:28672
    v_mfma_f32_16x16x32_bf16 v[128:131], v[52:55], a[128:131], v[128:131]
    buffer_load_dwordx4 v3, s[8:11], s66 offen offset:1024 lds
    v_mfma_f32_16x16x32_bf16 v[132:135], v[52:55], a[132:135], v[132:135]
    ds_read_b64_tr_b16 v[88:89], v42 offset:24576
    v_mfma_f32_16x16x32_bf16 v[136:139], v[52:55], a[136:139], v[136:139]
    ds_read_b64_tr_b16 v[90:91], v42 offset:28672
    v_mfma_f32_16x16x32_bf16 v[140:143], v[52:55], a[140:143], v[140:143]
    ds_read_b64_tr_b16 v[92:93], v43 offset:24576
    v_mfma_f32_16x16x32_bf16 v[144:147], v[56:59], a[128:131], v[144:147]
    ds_read_b64_tr_b16 v[94:95], v43 offset:28672
    buffer_load_dwordx4 v4, s[8:11], s66 offen offset:2048 lds
    v_mfma_f32_16x16x32_bf16 v[148:151], v[56:59], a[132:135], v[148:151]
    v_mfma_f32_16x16x32_bf16 v[152:155], v[56:59], a[136:139], v[152:155]
    ds_read_b64_tr_b16 v[96:97], v44 offset:24576
    v_mfma_f32_16x16x32_bf16 v[156:159], v[56:59], a[140:143], v[156:159]
    ds_read_b64_tr_b16 v[98:99], v44 offset:28672
    v_mfma_f32_16x16x32_bf16 v[160:163], v[60:63], a[128:131], v[160:163]
    ds_read_b64_tr_b16 v[100:101], v45 offset:24576
    buffer_load_dwordx4 v5, s[8:11], s66 offen offset:3072 lds
    v_mfma_f32_16x16x32_bf16 v[164:167], v[60:63], a[132:135], v[164:167]
    ds_read_b64_tr_b16 v[102:103], v45 offset:28672
    v_mfma_f32_16x16x32_bf16 v[168:171], v[60:63], a[136:139], v[168:171]
    v_mfma_f32_16x16x32_bf16 v[172:175], v[60:63], a[140:143], v[172:175]
    ds_read_b64_tr_b16 v[104:105], v46 offset:24576
    v_mfma_f32_16x16x32_bf16 v[176:179], v[64:67], a[128:131], v[176:179]
    ds_read_b64_tr_b16 v[106:107], v46 offset:28672
    buffer_load_dwordx4 a[224:227], v6, s[12:15], s67 offen offset:0 sc1
    v_mfma_f32_16x16x32_bf16 v[180:183], v[64:67], a[132:135], v[180:183]
    ds_read_b64_tr_b16 v[108:109], v47 offset:24576
    v_mfma_f32_16x16x32_bf16 v[184:187], v[64:67], a[136:139], v[184:187]
    ds_read_b64_tr_b16 v[110:111], v47 offset:28672
    v_mfma_f32_16x16x32_bf16 v[188:191], v[64:67], a[140:143], v[188:191]
    v_mfma_f32_16x16x32_bf16 v[192:195], v[68:71], a[128:131], v[192:195]
    buffer_load_dwordx4 a[228:231], v6, s[12:15], s67 offen offset:1024 sc1
    v_mfma_f32_16x16x32_bf16 v[196:199], v[68:71], a[132:135], v[196:199]
    v_mfma_f32_16x16x32_bf16 v[200:203], v[68:71], a[136:139], v[200:203]
    v_mfma_f32_16x16x32_bf16 v[204:207], v[68:71], a[140:143], v[204:207]
    v_mfma_f32_16x16x32_bf16 v[208:211], v[72:75], a[128:131], v[208:211]
    buffer_load_dwordx4 a[232:235], v6, s[12:15], s67 offen offset:2048 sc1
    v_mfma_f32_16x16x32_bf16 v[212:215], v[72:75], a[132:135], v[212:215]
    v_mfma_f32_16x16x32_bf16 v[216:219], v[72:75], a[136:139], v[216:219]
    v_mfma_f32_16x16x32_bf16 v[220:223], v[72:75], a[140:143], v[220:223]
    v_mfma_f32_16x16x32_bf16 v[224:227], v[76:79], a[128:131], v[224:227]
    buffer_load_dwordx4 a[236:239], v6, s[12:15], s67 offen offset:3072 sc1
    v_mfma_f32_16x16x32_bf16 v[228:231], v[76:79], a[132:135], v[228:231]
    v_mfma_f32_16x16x32_bf16 v[232:235], v[76:79], a[136:139], v[232:235]
    v_mfma_f32_16x16x32_bf16 v[236:239], v[76:79], a[140:143], v[236:239]
    s_add_u32 s67, s67, 131072
    s_waitcnt vmcnt(20) lgkmcnt(0)
    s_barrier
    v_mfma_f32_16x16x32_bf16 v[112:115], v[80:83], a[144:147], v[112:115]
    ds_read_b64_tr_b16 v[48:49], v40 offset:0
    v_mfma_f32_16x16x32_bf16 v[116:119], v[80:83], a[148:151], v[116:119]
    ds_read_b64_tr_b16 v[50:51], v40 offset:4096
    buffer_load_dwordx4 a[240:243], v6, s[12:15], s67 offen offset:0 sc1
    v_mfma_f32_16x16x32_bf16 v[120:123], v[80:83], a[152:155], v[120:123]
    ds_read_b64_tr_b16 v[52:53], v41 offset:0
    v_mfma_f32_16x16x32_bf16 v[124:127], v[80:83], a[156:159], v[124:127]
    ds_read_b64_tr_b16 v[54:55], v41 offset:4096
    v_mfma_f32_16x16x32_bf16 v[128:131], v[84:87], a[144:147], v[128:131]
    v_mfma_f32_16x16x32_bf16 v[132:135], v[84:87], a[148:151], v[132:135]
    ds_read_b64_tr_b16 v[56:57], v42 offset:0
    v_mfma_f32_16x16x32_bf16 v[136:139], v[84:87], a[152:155], v[136:139]
    ds_read_b64_tr_b16 v[58:59], v42 offset:4096
    v_mfma_f32_16x16x32_bf16 v[140:143], v[84:87], a[156:159], v[140:143]
    ds_read_b64_tr_b16 v[60:61], v43 offset:0
    v_mfma_f32_16x16x32_bf16 v[144:147], v[88:91], a[144:147], v[144:147]
    ds_read_b64_tr_b16 v[62:63], v43 offset:4096
    buffer_load_dwordx4 a[244:247], v6, s[12:15], s67 offen offset:1024 sc1
    v_mfma_f32_16x16x32_bf16 v[148:151], v[88:91], a[148:151], v[148:151]
    v_mfma_f32_16x16x32_bf16 v[152:155], v[88:91], a[152:155], v[152:155]
    ds_read_b64_tr_b16 v[64:65], v44 offset:0
    v_mfma_f32_16x16x32_bf16 v[156:159], v[88:91], a[156:159], v[156:159]
    ds_read_b64_tr_b16 v[66:67], v44 offset:4096
    v_mfma_f32_16x16x32_bf16 v[160:163], v[92:95], a[144:147], v[160:163]
    ds_read_b64_tr_b16 v[68:69], v45 offset:0
    v_mfma_f32_16x16x32_bf16 v[164:167], v[92:95], a[148:151], v[164:167]
    ds_read_b64_tr_b16 v[70:71], v45 offset:4096
    v_mfma_f32_16x16x32_bf16 v[168:171], v[92:95], a[152:155], v[168:171]
    v_mfma_f32_16x16x32_bf16 v[172:175], v[92:95], a[156:159], v[172:175]
    ds_read_b64_tr_b16 v[72:73], v46 offset:0
    v_mfma_f32_16x16x32_bf16 v[176:179], v[96:99], a[144:147], v[176:179]
    ds_read_b64_tr_b16 v[74:75], v46 offset:4096
    buffer_load_dwordx4 a[248:251], v6, s[12:15], s67 offen offset:2048 sc1
    v_mfma_f32_16x16x32_bf16 v[180:183], v[96:99], a[148:151], v[180:183]
    ds_read_b64_tr_b16 v[76:77], v47 offset:0
    v_mfma_f32_16x16x32_bf16 v[184:187], v[96:99], a[152:155], v[184:187]
    ds_read_b64_tr_b16 v[78:79], v47 offset:4096
    v_mfma_f32_16x16x32_bf16 v[188:191], v[96:99], a[156:159], v[188:191]
    v_mfma_f32_16x16x32_bf16 v[192:195], v[100:103], a[144:147], v[192:195]
    v_mfma_f32_16x16x32_bf16 v[196:199], v[100:103], a[148:151], v[196:199]
    v_mfma_f32_16x16x32_bf16 v[200:203], v[100:103], a[152:155], v[200:203]
    v_mfma_f32_16x16x32_bf16 v[204:207], v[100:103], a[156:159], v[204:207]
    v_mfma_f32_16x16x32_bf16 v[208:211], v[104:107], a[144:147], v[208:211]
    buffer_load_dwordx4 a[252:255], v6, s[12:15], s67 offen offset:3072 sc1
    v_mfma_f32_16x16x32_bf16 v[212:215], v[104:107], a[148:151], v[212:215]
    v_mfma_f32_16x16x32_bf16 v[216:219], v[104:107], a[152:155], v[216:219]
    v_mfma_f32_16x16x32_bf16 v[220:223], v[104:107], a[156:159], v[220:223]
    v_mfma_f32_16x16x32_bf16 v[224:227], v[108:111], a[144:147], v[224:227]
    v_mfma_f32_16x16x32_bf16 v[228:231], v[108:111], a[148:151], v[228:231]
    v_mfma_f32_16x16x32_bf16 v[232:235], v[108:111], a[152:155], v[232:235]
    v_mfma_f32_16x16x32_bf16 v[236:239], v[108:111], a[156:159], v[236:239]
    s_add_u32 s67, s67, 131072
    s_waitcnt lgkmcnt(0)
    v_mfma_f32_16x16x32_bf16 v[112:115], v[48:51], a[160:163], v[112:115]
    ds_read_b64_tr_b16 v[80:81], v40 offset:8192
    v_mfma_f32_16x16x32_bf16 v[116:119], v[48:51], a[164:167], v[116:119]
    ds_read_b64_tr_b16 v[82:83], v40 offset:12288
    s_add_u32 m0, s68, 114688
    s_add_u32 s66, s66, 524288
    v_mfma_f32_16x16x32_bf16 v[120:123], v[48:51], a[168:171], v[120:123]
    ds_read_b64_tr_b16 v[84:85], v41 offset:8192
    buffer_load_dwordx4 v2, s[8:11], s66 offen offset:0 lds
    v_mfma_f32_16x16x32_bf16 v[124:127], v[48:51], a[172:175], v[124:127]
    ds_read_b64_tr_b16 v[86:87], v41 offset:12288
    v_mfma_f32_16x16x32_bf16 v[128:131], v[52:55], a[160:163], v[128:131]
    buffer_load_dwordx4 v3, s[8:11], s66 offen offset:1024 lds
    v_mfma_f32_16x16x32_bf16 v[132:135], v[52:55], a[164:167], v[132:135]
    ds_read_b64_tr_b16 v[88:89], v42 offset:8192
    v_mfma_f32_16x16x32_bf16 v[136:139], v[52:55], a[168:171], v[136:139]
    ds_read_b64_tr_b16 v[90:91], v42 offset:12288
    v_mfma_f32_16x16x32_bf16 v[140:143], v[52:55], a[172:175], v[140:143]
    ds_read_b64_tr_b16 v[92:93], v43 offset:8192
    v_mfma_f32_16x16x32_bf16 v[144:147], v[56:59], a[160:163], v[144:147]
    ds_read_b64_tr_b16 v[94:95], v43 offset:12288
    buffer_load_dwordx4 v4, s[8:11], s66 offen offset:2048 lds
    v_mfma_f32_16x16x32_bf16 v[148:151], v[56:59], a[164:167], v[148:151]
    v_mfma_f32_16x16x32_bf16 v[152:155], v[56:59], a[168:171], v[152:155]
    ds_read_b64_tr_b16 v[96:97], v44 offset:8192
    v_mfma_f32_16x16x32_bf16 v[156:159], v[56:59], a[172:175], v[156:159]
    ds_read_b64_tr_b16 v[98:99], v44 offset:12288
    v_mfma_f32_16x16x32_bf16 v[160:163], v[60:63], a[160:163], v[160:163]
    ds_read_b64_tr_b16 v[100:101], v45 offset:8192
    buffer_load_dwordx4 v5, s[8:11], s66 offen offset:3072 lds
    v_mfma_f32_16x16x32_bf16 v[164:167], v[60:63], a[164:167], v[164:167]
    ds_read_b64_tr_b16 v[102:103], v45 offset:12288
    v_mfma_f32_16x16x32_bf16 v[168:171], v[60:63], a[168:171], v[168:171]
    v_mfma_f32_16x16x32_bf16 v[172:175], v[60:63], a[172:175], v[172:175]
    ds_read_b64_tr_b16 v[104:105], v46 offset:8192
    v_mfma_f32_16x16x32_bf16 v[176:179], v[64:67], a[160:163], v[176:179]
    ds_read_b64_tr_b16 v[106:107], v46 offset:12288
    buffer_load_dwordx4 a[128:131], v6, s[12:15], s67 offen offset:0 sc1
    v_mfma_f32_16x16x32_bf16 v[180:183], v[64:67], a[164:167], v[180:183]
    ds_read_b64_tr_b16 v[108:109], v47 offset:8192
    v_mfma_f32_16x16x32_bf16 v[184:187], v[64:67], a[168:171], v[184:187]
    ds_read_b64_tr_b16 v[110:111], v47 offset:12288
    v_mfma_f32_16x16x32_bf16 v[188:191], v[64:67], a[172:175], v[188:191]
    v_mfma_f32_16x16x32_bf16 v[192:195], v[68:71], a[160:163], v[192:195]
    buffer_load_dwordx4 a[132:135], v6, s[12:15], s67 offen offset:1024 sc1
    v_mfma_f32_16x16x32_bf16 v[196:199], v[68:71], a[164:167], v[196:199]
    v_mfma_f32_16x16x32_bf16 v[200:203], v[68:71], a[168:171], v[200:203]
    v_mfma_f32_16x16x32_bf16 v[204:207], v[68:71], a[172:175], v[204:207]
    v_mfma_f32_16x16x32_bf16 v[208:211], v[72:75], a[160:163], v[208:211]
    buffer_load_dwordx4 a[136:139], v6, s[12:15], s67 offen offset:2048 sc1
    v_mfma_f32_16x16x32_bf16 v[212:215], v[72:75], a[164:167], v[212:215]
    v_mfma_f32_16x16x32_bf16 v[216:219], v[72:75], a[168:171], v[216:219]
    v_mfma_f32_16x16x32_bf16 v[220:223], v[72:75], a[172:175], v[220:223]
    v_mfma_f32_16x16x32_bf16 v[224:227], v[76:79], a[160:163], v[224:227]
    buffer_load_dwordx4 a[140:143], v6, s[12:15], s67 offen offset:3072 sc1
    v_mfma_f32_16x16x32_bf16 v[228:231], v[76:79], a[164:167], v[228:231]
    v_mfma_f32_16x16x32_bf16 v[232:235], v[76:79], a[168:171], v[232:235]
    v_mfma_f32_16x16x32_bf16 v[236:239], v[76:79], a[172:175], v[236:239]
    s_add_u32 s67, s67, 131072
    s_waitcnt vmcnt(20) lgkmcnt(0)
    s_barrier
    v_mfma_f32_16x16x32_bf16 v[112:115], v[80:83], a[176:179], v[112:115]
    ds_read_b64_tr_b16 v[48:49], v40 offset:32768
    v_mfma_f32_16x16x32_bf16 v[116:119], v[80:83], a[180:183], v[116:119]
    ds_read_b64_tr_b16 v[50:51], v40 offset:36864
    buffer_load_dwordx4 a[144:147], v6, s[12:15], s67 offen offset:0 sc1
    v_mfma_f32_16x16x32_bf16 v[120:123], v[80:83], a[184:187], v[120:123]
    ds_read_b64_tr_b16 v[52:53], v41 offset:32768
    v_mfma_f32_16x16x32_bf16 v[124:127], v[80:83], a[188:191], v[124:127]
    ds_read_b64_tr_b16 v[54:55], v41 offset:36864
    v_mfma_f32_16x16x32_bf16 v[128:131], v[84:87], a[176:179], v[128:131]
    v_mfma_f32_16x16x32_bf16 v[132:135], v[84:87], a[180:183], v[132:135]
    ds_read_b64_tr_b16 v[56:57], v42 offset:32768
    v_mfma_f32_16x16x32_bf16 v[136:139], v[84:87], a[184:187], v[136:139]
    ds_read_b64_tr_b16 v[58:59], v42 offset:36864
    v_mfma_f32_16x16x32_bf16 v[140:143], v[84:87], a[188:191], v[140:143]
    ds_read_b64_tr_b16 v[60:61], v43 offset:32768
    v_mfma_f32_16x16x32_bf16 v[144:147], v[88:91], a[176:179], v[144:147]
    ds_read_b64_tr_b16 v[62:63], v43 offset:36864
    buffer_load_dwordx4 a[148:151], v6, s[12:15], s67 offen offset:1024 sc1
    v_mfma_f32_16x16x32_bf16 v[148:151], v[88:91], a[180:183], v[148:151]
    v_mfma_f32_16x16x32_bf16 v[152:155], v[88:91], a[184:187], v[152:155]
    ds_read_b64_tr_b16 v[64:65], v44 offset:32768
    v_mfma_f32_16x16x32_bf16 v[156:159], v[88:91], a[188:191], v[156:159]
    ds_read_b64_tr_b16 v[66:67], v44 offset:36864
    v_mfma_f32_16x16x32_bf16 v[160:163], v[92:95], a[176:179], v[160:163]
    ds_read_b64_tr_b16 v[68:69], v45 offset:32768
    v_mfma_f32_16x16x32_bf16 v[164:167], v[92:95], a[180:183], v[164:167]
    ds_read_b64_tr_b16 v[70:71], v45 offset:36864
    v_mfma_f32_16x16x32_bf16 v[168:171], v[92:95], a[184:187], v[168:171]
    v_mfma_f32_16x16x32_bf16 v[172:175], v[92:95], a[188:191], v[172:175]
    ds_read_b64_tr_b16 v[72:73], v46 offset:32768
    v_mfma_f32_16x16x32_bf16 v[176:179], v[96:99], a[176:179], v[176:179]
    ds_read_b64_tr_b16 v[74:75], v46 offset:36864
    buffer_load_dwordx4 a[152:155], v6, s[12:15], s67 offen offset:2048 sc1
    v_mfma_f32_16x16x32_bf16 v[180:183], v[96:99], a[180:183], v[180:183]
    ds_read_b64_tr_b16 v[76:77], v47 offset:32768
    v_mfma_f32_16x16x32_bf16 v[184:187], v[96:99], a[184:187], v[184:187]
    ds_read_b64_tr_b16 v[78:79], v47 offset:36864
    v_mfma_f32_16x16x32_bf16 v[188:191], v[96:99], a[188:191], v[188:191]
    v_mfma_f32_16x16x32_bf16 v[192:195], v[100:103], a[176:179], v[192:195]
    v_mfma_f32_16x16x32_bf16 v[196:199], v[100:103], a[180:183], v[196:199]
    v_mfma_f32_16x16x32_bf16 v[200:203], v[100:103], a[184:187], v[200:203]
    v_mfma_f32_16x16x32_bf16 v[204:207], v[100:103], a[188:191], v[204:207]
    v_mfma_f32_16x16x32_bf16 v[208:211], v[104:107], a[176:179], v[208:211]
    buffer_load_dwordx4 a[156:159], v6, s[12:15], s67 offen offset:3072 sc1
    v_mfma_f32_16x16x32_bf16 v[212:215], v[104:107], a[180:183], v[212:215]
    v_mfma_f32_16x16x32_bf16 v[216:219], v[104:107], a[184:187], v[216:219]
    v_mfma_f32_16x16x32_bf16 v[220:223], v[104:107], a[188:191], v[220:223]
    v_mfma_f32_16x16x32_bf16 v[224:227], v[108:111], a[176:179], v[224:227]
    v_mfma_f32_16x16x32_bf16 v[228:231], v[108:111], a[180:183], v[228:231]
    v_mfma_f32_16x16x32_bf16 v[232:235], v[108:111], a[184:187], v[232:235]
    v_mfma_f32_16x16x32_bf16 v[236:239], v[108:111], a[188:191], v[236:239]
    s_add_u32 s67, s67, 131072
    s_sub_u32 s70, s70, 1
    s_cmp_eq_u32 s70, 0
    s_waitcnt lgkmcnt(0)
    s_cbranch_scc0 kmy_qloop
    v_mfma_f32_16x16x32_bf16 v[112:115], v[48:51], a[192:195], v[112:115]
    ds_read_b64_tr_b16 v[80:81], v40 offset:40960
    v_mfma_f32_16x16x32_bf16 v[116:119], v[48:51], a[196:199], v[116:119]
    ds_read_b64_tr_b16 v[82:83], v40 offset:45056
    s_add_u32 m0, s68, 98304
    s_add_u32 s66, s66, 524288
    v_mfma_f32_16x16x32_bf16 v[120:123], v[48:51], a[200:203], v[120:123]
    ds_read_b64_tr_b16 v[84:85], v41 offset:40960
    buffer_load_dwordx4 v2, s[8:11], s66 offen offset:0 lds
    v_mfma_f32_16x16x32_bf16 v[124:127], v[48:51], a[204:207], v[124:127]
    ds_read_b64_tr_b16 v[86:87], v41 offset:45056
    v_mfma_f32_16x16x32_bf16 v[128:131], v[52:55], a[192:195], v[128:131]
    buffer_load_dwordx4 v3, s[8:11], s66 offen offset:1024 lds
    v_mfma_f32_16x16x32_bf16 v[132:135], v[52:55], a[196:199], v[132:135]
    ds_read_b64_tr_b16 v[88:89], v42 offset:40960
    v_mfma_f32_16x16x32_bf16 v[136:139], v[52:55], a[200:203], v[136:139]
    ds_read_b64_tr_b16 v[90:91], v42 offset:45056
    v_mfma_f32_16x16x32_bf16 v[140:143], v[52:55], a[204:207], v[140:143]
    ds_read_b64_tr_b16 v[92:93], v43 offset:40960
    v_mfma_f32_16x16x32_bf16 v[144:147], v[56:59], a[192:195], v[144:147]
    ds_read_b64_tr_b16 v[94:95], v43 offset:45056
    buffer_load_dwordx4 v4, s[8:11], s66 offen offset:2048 lds
    v_mfma_f32_16x16x32_bf16 v[148:151], v[56:59], a[196:199], v[148:151]
    v_mfma_f32_16x16x32_bf16 v[152:155], v[56:59], a[200:203], v[152:155]
    ds_read_b64_tr_b16 v[96:97], v44 offset:40960
    v_mfma_f32_16x16x32_bf16 v[156:159], v[56:59], a[204:207], v[156:159]
    ds_read_b64_tr_b16 v[98:99], v44 offset:45056
    v_mfma_f32_16x16x32_bf16 v[160:163], v[60:63], a[192:195], v[160:163]
    ds_read_b64_tr_b16 v[100:101], v45 offset:40960
    buffer_load_dwordx4 v5, s[8:11], s66 offen offset:3072 lds
    v_mfma_f32_16x16x32_bf16 v[164:167], v[60:63], a[196:199], v[164:167]
    ds_read_b64_tr_b16 v[102:103], v45 offset:45056
    v_mfma_f32_16x16x32_bf16 v[168:171], v[60:63], a[200:203], v[168:171]
    v_mfma_f32_16x16x32_bf16 v[172:175], v[60:63], a[204:207], v[172:175]
    ds_read_b64_tr_b16 v[104:105], v46 offset:40960
    v_mfma_f32_16x16x32_bf16 v[176:179], v[64:67], a[192:195], v[176:179]
    ds_read_b64_tr_b16 v[106:107], v46 offset:45056
    buffer_load_dwordx4 a[160:163], v6, s[12:15], s67 offen offset:0 sc1
    v_mfma_f32_16x16x32_bf16 v[180:183], v[64:67], a[196:199], v[180:183]
    ds_read_b64_tr_b16 v[108:109], v47 offset:40960
    v_mfma_f32_16x16x32_bf16 v[184:187], v[64:67], a[200:203], v[184:187]
    ds_read_b64_tr_b16 v[110:111], v47 offset:45056
    v_mfma_f32_16x16x32_bf16 v[188:191], v[64:67], a[204:207], v[188:191]
    v_mfma_f32_16x16x32_bf16 v[192:195], v[68:71], a[192:195], v[192:195]
    buffer_load_dwordx4 a[164:167], v6, s[12:15], s67 offen offset:1024 sc1
    v_mfma_f32_16x16x32_bf16 v[196:199], v[68:71], a[196:199], v[196:199]
    v_mfma_f32_16x16x32_bf16 v[200:203], v[68:71], a[200:203], v[200:203]
    v_mfma_f32_16x16x32_bf16 v[204:207], v[68:71], a[204:207], v[204:207]
    v_mfma_f32_16x16x32_bf16 v[208:211], v[72:75], a[192:195], v[208:211]
    buffer_load_dwordx4 a[168:171], v6, s[12:15], s67 offen offset:2048 sc1
    v_mfma_f32_16x16x32_bf16 v[212:215], v[72:75], a[196:199], v[212:215]
    v_mfma_f32_16x16x32_bf16 v[216:219], v[72:75], a[200:203], v[216:219]
    v_mfma_f32_16x16x32_bf16 v[220:223], v[72:75], a[204:207], v[220:223]
    v_mfma_f32_16x16x32_bf16 v[224:227], v[76:79], a[192:195], v[224:227]
    buffer_load_dwordx4 a[172:175], v6, s[12:15], s67 offen offset:3072 sc1
    v_mfma_f32_16x16x32_bf16 v[228:231], v[76:79], a[196:199], v[228:231]
    v_mfma_f32_16x16x32_bf16 v[232:235], v[76:79], a[200:203], v[232:235]
    v_mfma_f32_16x16x32_bf16 v[236:239], v[76:79], a[204:207], v[236:239]
    s_add_u32 s67, s67, 131072
    s_waitcnt vmcnt(20) lgkmcnt(0)
    s_barrier
    v_mfma_f32_16x16x32_bf16 v[112:115], v[80:83], a[208:211], v[112:115]
    ds_read_b64_tr_b16 v[48:49], v40 offset:49152
    v_mfma_f32_16x16x32_bf16 v[116:119], v[80:83], a[212:215], v[116:119]
    ds_read_b64_tr_b16 v[50:51], v40 offset:53248
    buffer_load_dwordx4 a[176:179], v6, s[12:15], s67 offen offset:0 sc1
    v_mfma_f32_16x16x32_bf16 v[120:123], v[80:83], a[216:219], v[120:123]
    ds_read_b64_tr_b16 v[52:53], v41 offset:49152
    v_mfma_f32_16x16x32_bf16 v[124:127], v[80:83], a[220:223], v[124:127]
    ds_read_b64_tr_b16 v[54:55], v41 offset:53248
    v_mfma_f32_16x16x32_bf16 v[128:131], v[84:87], a[208:211], v[128:131]
    v_mfma_f32_16x16x32_bf16 v[132:135], v[84:87], a[212:215], v[132:135]
    ds_read_b64_tr_b16 v[56:57], v42 offset:49152
    v_mfma_f32_16x16x32_bf16 v[136:139], v[84:87], a[216:219], v[136:139]
    ds_read_b64_tr_b16 v[58:59], v42 offset:53248
    v_mfma_f32_16x16x32_bf16 v[140:143], v[84:87], a[220:223], v[140:143]
    ds_read_b64_tr_b16 v[60:61], v43 offset:49152
    v_mfma_f32_16x16x32_bf16 v[144:147], v[88:91], a[208:211], v[144:147]
    ds_read_b64_tr_b16 v[62:63], v43 offset:53248
    buffer_load_dwordx4 a[180:183], v6, s[12:15], s67 offen offset:1024 sc1
    v_mfma_f32_16x16x32_bf16 v[148:151], v[88:91], a[212:215], v[148:151]
    v_mfma_f32_16x16x32_bf16 v[152:155], v[88:91], a[216:219], v[152:155]
    ds_read_b64_tr_b16 v[64:65], v44 offset:49152
    v_mfma_f32_16x16x32_bf16 v[156:159], v[88:91], a[220:223], v[156:159]
    ds_read_b64_tr_b16 v[66:67], v44 offset:53248
    v_mfma_f32_16x16x32_bf16 v[160:163], v[92:95], a[208:211], v[160:163]
    ds_read_b64_tr_b16 v[68:69], v45 offset:49152
    v_mfma_f32_16x16x32_bf16 v[164:167], v[92:95], a[212:215], v[164:167]
    ds_read_b64_tr_b16 v[70:71], v45 offset:53248
    v_mfma_f32_16x16x32_bf16 v[168:171], v[92:95], a[216:219], v[168:171]
    v_mfma_f32_16x16x32_bf16 v[172:175], v[92:95], a[220:223], v[172:175]
    ds_read_b64_tr_b16 v[72:73], v46 offset:49152
    v_mfma_f32_16x16x32_bf16 v[176:179], v[96:99], a[208:211], v[176:179]
    ds_read_b64_tr_b16 v[74:75], v46 offset:53248
    buffer_load_dwordx4 a[184:187], v6, s[12:15], s67 offen offset:2048 sc1
    v_mfma_f32_16x16x32_bf16 v[180:183], v[96:99], a[212:215], v[180:183]
    ds_read_b64_tr_b16 v[76:77], v47 offset:49152
    v_mfma_f32_16x16x32_bf16 v[184:187], v[96:99], a[216:219], v[184:187]
    ds_read_b64_tr_b16 v[78:79], v47 offset:53248
    v_mfma_f32_16x16x32_bf16 v[188:191], v[96:99], a[220:223], v[188:191]
    v_mfma_f32_16x16x32_bf16 v[192:195], v[100:103], a[208:211], v[192:195]
    v_mfma_f32_16x16x32_bf16 v[196:199], v[100:103], a[212:215], v[196:199]
    v_mfma_f32_16x16x32_bf16 v[200:203], v[100:103], a[216:219], v[200:203]
    v_mfma_f32_16x16x32_bf16 v[204:207], v[100:103], a[220:223], v[204:207]
    v_mfma_f32_16x16x32_bf16 v[208:211], v[104:107], a[208:211], v[208:211]
    buffer_load_dwordx4 a[188:191], v6, s[12:15], s67 offen offset:3072 sc1
    v_mfma_f32_16x16x32_bf16 v[212:215], v[104:107], a[212:215], v[212:215]
    v_mfma_f32_16x16x32_bf16 v[216:219], v[104:107], a[216:219], v[216:219]
    v_mfma_f32_16x16x32_bf16 v[220:223], v[104:107], a[220:223], v[220:223]
    v_mfma_f32_16x16x32_bf16 v[224:227], v[108:111], a[208:211], v[224:227]
    v_mfma_f32_16x16x32_bf16 v[228:231], v[108:111], a[212:215], v[228:231]
    v_mfma_f32_16x16x32_bf16 v[232:235], v[108:111], a[216:219], v[232:235]
    v_mfma_f32_16x16x32_bf16 v[236:239], v[108:111], a[220:223], v[236:239]
    s_add_u32 s67, s67, 131072
    s_waitcnt lgkmcnt(0)
    v_mfma_f32_16x16x32_bf16 v[112:115], v[48:51], a[224:227], v[112:115]
    ds_read_b64_tr_b16 v[80:81], v40 offset:57344
    v_mfma_f32_16x16x32_bf16 v[116:119], v[48:51], a[228:231], v[116:119]
    ds_read_b64_tr_b16 v[82:83], v40 offset:61440
    s_add_u32 m0, s68, 0
    s_add_u32 s86, s68, 0
    v_mfma_f32_16x16x32_bf16 v[120:123], v[48:51], a[232:235], v[120:123]
    ds_read_b64_tr_b16 v[84:85], v41 offset:57344
    buffer_load_dwordx4 v20, s[16:19], s86 offen offset:0 lds
    v_mfma_f32_16x16x32_bf16 v[124:127], v[48:51], a[236:239], v[124:127]
    ds_read_b64_tr_b16 v[86:87], v41 offset:61440
    v_mfma_f32_16x16x32_bf16 v[128:131], v[52:55], a[224:227], v[128:131]
    v_mfma_f32_16x16x32_bf16 v[132:135], v[52:55], a[228:231], v[132:135]
    ds_read_b64_tr_b16 v[88:89], v42 offset:57344
    v_mfma_f32_16x16x32_bf16 v[136:139], v[52:55], a[232:235], v[136:139]
    ds_read_b64_tr_b16 v[90:91], v42 offset:61440
    v_mfma_f32_16x16x32_bf16 v[140:143], v[52:55], a[236:239], v[140:143]
    ds_read_b64_tr_b16 v[92:93], v43 offset:57344
    v_mfma_f32_16x16x32_bf16 v[144:147], v[56:59], a[224:227], v[144:147]
    ds_read_b64_tr_b16 v[94:95], v43 offset:61440
    buffer_load_dwordx4 v21, s[16:19], s86 offen offset:1024 lds
    v_mfma_f32_16x16x32_bf16 v[148:151], v[56:59], a[228:231], v[148:151]
    v_mfma_f32_16x16x32_bf16 v[152:155], v[56:59], a[232:235], v[152:155]
    ds_read_b64_tr_b16 v[96:97], v44 offset:57344
    v_mfma_f32_16x16x32_bf16 v[156:159], v[56:59], a[236:239], v[156:159]
    ds_read_b64_tr_b16 v[98:99], v44 offset:61440
    v_mfma_f32_16x16x32_bf16 v[160:163], v[60:63], a[224:227], v[160:163]
    ds_read_b64_tr_b16 v[100:101], v45 offset:57344
    v_mfma_f32_16x16x32_bf16 v[164:167], v[60:63], a[228:231], v[164:167]
    ds_read_b64_tr_b16 v[102:103], v45 offset:61440
    v_mfma_f32_16x16x32_bf16 v[168:171], v[60:63], a[232:235], v[168:171]
    v_mfma_f32_16x16x32_bf16 v[172:175], v[60:63], a[236:239], v[172:175]
    ds_read_b64_tr_b16 v[104:105], v46 offset:57344
    v_mfma_f32_16x16x32_bf16 v[176:179], v[64:67], a[224:227], v[176:179]
    ds_read_b64_tr_b16 v[106:107], v46 offset:61440
    buffer_load_dwordx4 v22, s[16:19], s86 offen offset:2048 lds
    v_mfma_f32_16x16x32_bf16 v[180:183], v[64:67], a[228:231], v[180:183]
    ds_read_b64_tr_b16 v[108:109], v47 offset:57344
    v_mfma_f32_16x16x32_bf16 v[184:187], v[64:67], a[232:235], v[184:187]
    ds_read_b64_tr_b16 v[110:111], v47 offset:61440
    v_mfma_f32_16x16x32_bf16 v[188:191], v[64:67], a[236:239], v[188:191]
    v_mfma_f32_16x16x32_bf16 v[192:195], v[68:71], a[224:227], v[192:195]
    v_mfma_f32_16x16x32_bf16 v[196:199], v[68:71], a[228:231], v[196:199]
    v_mfma_f32_16x16x32_bf16 v[200:203], v[68:71], a[232:235], v[200:203]
    v_mfma_f32_16x16x32_bf16 v[204:207], v[68:71], a[236:239], v[204:207]
    v_mfma_f32_16x16x32_bf16 v[208:211], v[72:75], a[224:227], v[208:211]
    buffer_load_dwordx4 v23, s[16:19], s86 offen offset:3072 lds
    v_mfma_f32_16x16x32_bf16 v[212:215], v[72:75], a[228:231], v[212:215]
    v_mfma_f32_16x16x32_bf16 v[216:219], v[72:75], a[232:235], v[216:219]
    v_mfma_f32_16x16x32_bf16 v[220:223], v[72:75], a[236:239], v[220:223]
    v_mfma_f32_16x16x32_bf16 v[224:227], v[76:79], a[224:227], v[224:227]
    v_mfma_f32_16x16x32_bf16 v[228:231], v[76:79], a[228:231], v[228:231]
    v_mfma_f32_16x16x32_bf16 v[232:235], v[76:79], a[232:235], v[232:235]
    v_mfma_f32_16x16x32_bf16 v[236:239], v[76:79], a[236:239], v[236:239]
    s_waitcnt vmcnt(16) lgkmcnt(0)
    s_barrier
    v_mfma_f32_16x16x32_bf16 v[112:115], v[80:83], a[240:243], v[112:115]
    ds_read_b64_tr_b16 v[48:49], v40 offset:16384
    v_mfma_f32_16x16x32_bf16 v[116:119], v[80:83], a[244:247], v[116:119]
    ds_read_b64_tr_b16 v[50:51], v40 offset:20480
    s_add_u32 m0, s68, 16384
    s_add_u32 s86, s68, 16384
    v_mfma_f32_16x16x32_bf16 v[120:123], v[80:83], a[248:251], v[120:123]
    ds_read_b64_tr_b16 v[52:53], v41 offset:16384
    buffer_load_dwordx4 v20, s[16:19], s86 offen offset:0 lds
    v_mfma_f32_16x16x32_bf16 v[124:127], v[80:83], a[252:255], v[124:127]
    ds_read_b64_tr_b16 v[54:55], v41 offset:20480
    v_mfma_f32_16x16x32_bf16 v[128:131], v[84:87], a[240:243], v[128:131]
    v_mfma_f32_16x16x32_bf16 v[132:135], v[84:87], a[244:247], v[132:135]
    ds_read_b64_tr_b16 v[56:57], v42 offset:16384
    v_mfma_f32_16x16x32_bf16 v[136:139], v[84:87], a[248:251], v[136:139]
    ds_read_b64_tr_b16 v[58:59], v42 offset:20480
    v_mfma_f32_16x16x32_bf16 v[140:143], v[84:87], a[252:255], v[140:143]
    ds_read_b64_tr_b16 v[60:61], v43 offset:16384
    v_mfma_f32_16x16x32_bf16 v[144:147], v[88:91], a[240:243], v[144:147]
    ds_read_b64_tr_b16 v[62:63], v43 offset:20480
    buffer_load_dwordx4 v21, s[16:19], s86 offen offset:1024 lds
    v_mfma_f32_16x16x32_bf16 v[148:151], v[88:91], a[244:247], v[148:151]
    v_mfma_f32_16x16x32_bf16 v[152:155], v[88:91], a[248:251], v[152:155]
    ds_read_b64_tr_b16 v[64:65], v44 offset:16384
    v_mfma_f32_16x16x32_bf16 v[156:159], v[88:91], a[252:255], v[156:159]
    ds_read_b64_tr_b16 v[66:67], v44 offset:20480
    v_mfma_f32_16x16x32_bf16 v[160:163], v[92:95], a[240:243], v[160:163]
    ds_read_b64_tr_b16 v[68:69], v45 offset:16384
    v_mfma_f32_16x16x32_bf16 v[164:167], v[92:95], a[244:247], v[164:167]
    ds_read_b64_tr_b16 v[70:71], v45 offset:20480
    v_mfma_f32_16x16x32_bf16 v[168:171], v[92:95], a[248:251], v[168:171]
    v_mfma_f32_16x16x32_bf16 v[172:175], v[92:95], a[252:255], v[172:175]
    ds_read_b64_tr_b16 v[72:73], v46 offset:16384
    v_mfma_f32_16x16x32_bf16 v[176:179], v[96:99], a[240:243], v[176:179]
    ds_read_b64_tr_b16 v[74:75], v46 offset:20480
    buffer_load_dwordx4 v22, s[16:19], s86 offen offset:2048 lds
    v_mfma_f32_16x16x32_bf16 v[180:183], v[96:99], a[244:247], v[180:183]
    ds_read_b64_tr_b16 v[76:77], v47 offset:16384
    v_mfma_f32_16x16x32_bf16 v[184:187], v[96:99], a[248:251], v[184:187]
    ds_read_b64_tr_b16 v[78:79], v47 offset:20480
    v_mfma_f32_16x16x32_bf16 v[188:191], v[96:99], a[252:255], v[188:191]
    v_mfma_f32_16x16x32_bf16 v[192:195], v[100:103], a[240:243], v[192:195]
    v_mfma_f32_16x16x32_bf16 v[196:199], v[100:103], a[244:247], v[196:199]
    v_mfma_f32_16x16x32_bf16 v[200:203], v[100:103], a[248:251], v[200:203]
    v_mfma_f32_16x16x32_bf16 v[204:207], v[100:103], a[252:255], v[204:207]
    v_mfma_f32_16x16x32_bf16 v[208:211], v[104:107], a[240:243], v[208:211]
    buffer_load_dwordx4 v23, s[16:19], s86 offen offset:3072 lds
    v_mfma_f32_16x16x32_bf16 v[212:215], v[104:107], a[244:247], v[212:215]
    v_mfma_f32_16x16x32_bf16 v[216:219], v[104:107], a[248:251], v[216:219]
    v_mfma_f32_16x16x32_bf16 v[220:223], v[104:107], a[252:255], v[220:223]
    v_mfma_f32_16x16x32_bf16 v[224:227], v[108:111], a[240:243], v[224:227]
    v_mfma_f32_16x16x32_bf16 v[228:231], v[108:111], a[244:247], v[228:231]
    v_mfma_f32_16x16x32_bf16 v[232:235], v[108:111], a[248:251], v[232:235]
    v_mfma_f32_16x16x32_bf16 v[236:239], v[108:111], a[252:255], v[236:239]
    s_waitcnt lgkmcnt(0)
    v_mfma_f32_16x16x32_bf16 v[112:115], v[48:51], a[128:131], v[112:115]
    ds_read_b64_tr_b16 v[80:81], v40 offset:24576
    v_mfma_f32_16x16x32_bf16 v[116:119], v[48:51], a[132:135], v[116:119]
    ds_read_b64_tr_b16 v[82:83], v40 offset:28672
    s_add_u32 m0, s68, 65536
    s_add_u32 s86, s68, 0
    v_mfma_f32_16x16x32_bf16 v[120:123], v[48:51], a[136:139], v[120:123]
    ds_read_b64_tr_b16 v[84:85], v41 offset:24576
    buffer_load_dwordx4 v24, s[20:23], s86 offen offset:0 lds
    v_mfma_f32_16x16x32_bf16 v[124:127], v[48:51], a[140:143], v[124:127]
    ds_read_b64_tr_b16 v[86:87], v41 offset:28672
    v_mfma_f32_16x16x32_bf16 v[128:131], v[52:55], a[128:131], v[128:131]
    v_mfma_f32_16x16x32_bf16 v[132:135], v[52:55], a[132:135], v[132:135]
    ds_read_b64_tr_b16 v[88:89], v42 offset:24576
    v_mfma_f32_16x16x32_bf16 v[136:139], v[52:55], a[136:139], v[136:139]
    ds_read_b64_tr_b16 v[90:91], v42 offset:28672
    v_mfma_f32_16x16x32_bf16 v[140:143], v[52:55], a[140:143], v[140:143]
    ds_read_b64_tr_b16 v[92:93], v43 offset:24576
    v_mfma_f32_16x16x32_bf16 v[144:147], v[56:59], a[128:131], v[144:147]
    ds_read_b64_tr_b16 v[94:95], v43 offset:28672
    buffer_load_dwordx4 v24, s[20:23], s86 offen offset:1024 lds
    v_mfma_f32_16x16x32_bf16 v[148:151], v[56:59], a[132:135], v[148:151]
    v_mfma_f32_16x16x32_bf16 v[152:155], v[56:59], a[136:139], v[152:155]
    ds_read_b64_tr_b16 v[96:97], v44 offset:24576
    v_mfma_f32_16x16x32_bf16 v[156:159], v[56:59], a[140:143], v[156:159]
    ds_read_b64_tr_b16 v[98:99], v44 offset:28672
    v_mfma_f32_16x16x32_bf16 v[160:163], v[60:63], a[128:131], v[160:163]
    ds_read_b64_tr_b16 v[100:101], v45 offset:24576
    v_mfma_f32_16x16x32_bf16 v[164:167], v[60:63], a[132:135], v[164:167]
    ds_read_b64_tr_b16 v[102:103], v45 offset:28672
    v_mfma_f32_16x16x32_bf16 v[168:171], v[60:63], a[136:139], v[168:171]
    v_mfma_f32_16x16x32_bf16 v[172:175], v[60:63], a[140:143], v[172:175]
    ds_read_b64_tr_b16 v[104:105], v46 offset:24576
    v_mfma_f32_16x16x32_bf16 v[176:179], v[64:67], a[128:131], v[176:179]
    ds_read_b64_tr_b16 v[106:107], v46 offset:28672
    buffer_load_dwordx4 v24, s[20:23], s86 offen offset:2048 lds
    v_mfma_f32_16x16x32_bf16 v[180:183], v[64:67], a[132:135], v[180:183]
    ds_read_b64_tr_b16 v[108:109], v47 offset:24576
    v_mfma_f32_16x16x32_bf16 v[184:187], v[64:67], a[136:139], v[184:187]
    ds_read_b64_tr_b16 v[110:111], v47 offset:28672
    v_mfma_f32_16x16x32_bf16 v[188:191], v[64:67], a[140:143], v[188:191]
    v_mfma_f32_16x16x32_bf16 v[192:195], v[68:71], a[128:131], v[192:195]
    v_mfma_f32_16x16x32_bf16 v[196:199], v[68:71], a[132:135], v[196:199]
    v_mfma_f32_16x16x32_bf16 v[200:203], v[68:71], a[136:139], v[200:203]
    v_mfma_f32_16x16x32_bf16 v[204:207], v[68:71], a[140:143], v[204:207]
    v_mfma_f32_16x16x32_bf16 v[208:211], v[72:75], a[128:131], v[208:211]
    buffer_load_dwordx4 v24, s[20:23], s86 offen offset:3072 lds
    v_mfma_f32_16x16x32_bf16 v[212:215], v[72:75], a[132:135], v[212:215]
    v_mfma_f32_16x16x32_bf16 v[216:219], v[72:75], a[136:139], v[216:219]
    v_mfma_f32_16x16x32_bf16 v[220:223], v[72:75], a[140:143], v[220:223]
    v_mfma_f32_16x16x32_bf16 v[224:227], v[76:79], a[128:131], v[224:227]
    v_mfma_f32_16x16x32_bf16 v[228:231], v[76:79], a[132:135], v[228:231]
    v_mfma_f32_16x16x32_bf16 v[232:235], v[76:79], a[136:139], v[232:235]
    v_mfma_f32_16x16x32_bf16 v[236:239], v[76:79], a[140:143], v[236:239]
    s_waitcnt vmcnt(12) lgkmcnt(0)
    s_barrier
    v_mfma_f32_16x16x32_bf16 v[112:115], v[80:83], a[144:147], v[112:115]
    ds_read_b64_tr_b16 v[48:49], v40 offset:0
    v_mfma_f32_16x16x32_bf16 v[116:119], v[80:83], a[148:151], v[116:119]
    ds_read_b64_tr_b16 v[50:51], v40 offset:4096
    s_add_u32 m0, s68, 32768
    s_add_u32 s86, s68, 32768
    v_mfma_f32_16x16x32_bf16 v[120:123], v[80:83], a[152:155], v[120:123]
    ds_read_b64_tr_b16 v[52:53], v41 offset:0
    buffer_load_dwordx4 v20, s[16:19], s86 offen offset:0 lds
    v_mfma_f32_16x16x32_bf16 v[124:127], v[80:83], a[156:159], v[124:127]
    ds_read_b64_tr_b16 v[54:55], v41 offset:4096
    v_mfma_f32_16x16x32_bf16 v[128:131], v[84:87], a[144:147], v[128:131]
    v_mfma_f32_16x16x32_bf16 v[132:135], v[84:87], a[148:151], v[132:135]
    ds_read_b64_tr_b16 v[56:57], v42 offset:0
    v_mfma_f32_16x16x32_bf16 v[136:139], v[84:87], a[152:155], v[136:139]
    ds_read_b64_tr_b16 v[58:59], v42 offset:4096
    v_mfma_f32_16x16x32_bf16 v[140:143], v[84:87], a[156:159], v[140:143]
    ds_read_b64_tr_b16 v[60:61], v43 offset:0
    v_mfma_f32_16x16x32_bf16 v[144:147], v[88:91], a[144:147], v[144:147]
    ds_read_b64_tr_b16 v[62:63], v43 offset:4096
    buffer_load_dwordx4 v21, s[16:19], s86 offen offset:1024 lds
    v_mfma_f32_16x16x32_bf16 v[148:151], v[88:91], a[148:151], v[148:151]
    v_mfma_f32_16x16x32_bf16 v[152:155], v[88:91], a[152:155], v[152:155]
    ds_read_b64_tr_b16 v[64:65], v44 offset:0
    v_mfma_f32_16x16x32_bf16 v[156:159], v[88:91], a[156:159], v[156:159]
    ds_read_b64_tr_b16 v[66:67], v44 offset:4096
    v_mfma_f32_16x16x32_bf16 v[160:163], v[92:95], a[144:147], v[160:163]
    ds_read_b64_tr_b16 v[68:69], v45 offset:0
    v_mfma_f32_16x16x32_bf16 v[164:167], v[92:95], a[148:151], v[164:167]
    ds_read_b64_tr_b16 v[70:71], v45 offset:4096
    v_mfma_f32_16x16x32_bf16 v[168:171], v[92:95], a[152:155], v[168:171]
    v_mfma_f32_16x16x32_bf16 v[172:175], v[92:95], a[156:159], v[172:175]
    ds_read_b64_tr_b16 v[72:73], v46 offset:0
    v_mfma_f32_16x16x32_bf16 v[176:179], v[96:99], a[144:147], v[176:179]
    ds_read_b64_tr_b16 v[74:75], v46 offset:4096
    buffer_load_dwordx4 v22, s[16:19], s86 offen offset:2048 lds
    v_mfma_f32_16x16x32_bf16 v[180:183], v[96:99], a[148:151], v[180:183]
    ds_read_b64_tr_b16 v[76:77], v47 offset:0
    v_mfma_f32_16x16x32_bf16 v[184:187], v[96:99], a[152:155], v[184:187]
    ds_read_b64_tr_b16 v[78:79], v47 offset:4096
    v_mfma_f32_16x16x32_bf16 v[188:191], v[96:99], a[156:159], v[188:191]
    v_mfma_f32_16x16x32_bf16 v[192:195], v[100:103], a[144:147], v[192:195]
    v_mfma_f32_16x16x32_bf16 v[196:199], v[100:103], a[148:151], v[196:199]
    v_mfma_f32_16x16x32_bf16 v[200:203], v[100:103], a[152:155], v[200:203]
    v_mfma_f32_16x16x32_bf16 v[204:207], v[100:103], a[156:159], v[204:207]
    v_mfma_f32_16x16x32_bf16 v[208:211], v[104:107], a[144:147], v[208:211]
    buffer_load_dwordx4 v23, s[16:19], s86 offen offset:3072 lds
    v_mfma_f32_16x16x32_bf16 v[212:215], v[104:107], a[148:151], v[212:215]
    v_mfma_f32_16x16x32_bf16 v[216:219], v[104:107], a[152:155], v[216:219]
    v_mfma_f32_16x16x32_bf16 v[220:223], v[104:107], a[156:159], v[220:223]
    v_mfma_f32_16x16x32_bf16 v[224:227], v[108:111], a[144:147], v[224:227]
    v_mfma_f32_16x16x32_bf16 v[228:231], v[108:111], a[148:151], v[228:231]
    v_mfma_f32_16x16x32_bf16 v[232:235], v[108:111], a[152:155], v[232:235]
    v_mfma_f32_16x16x32_bf16 v[236:239], v[108:111], a[156:159], v[236:239]
    s_waitcnt lgkmcnt(0)
    v_mfma_f32_16x16x32_bf16 v[112:115], v[48:51], a[160:163], v[112:115]
    ds_read_b64_tr_b16 v[80:81], v40 offset:8192
    v_mfma_f32_16x16x32_bf16 v[116:119], v[48:51], a[164:167], v[116:119]
    ds_read_b64_tr_b16 v[82:83], v40 offset:12288
    s_add_u32 m0, s68, 81920
    s_add_u32 s86, s68, 16384
    v_mfma_f32_16x16x32_bf16 v[120:123], v[48:51], a[168:171], v[120:123]
    ds_read_b64_tr_b16 v[84:85], v41 offset:8192
    buffer_load_dwordx4 v24, s[20:23], s86 offen offset:0 lds
    v_mfma_f32_16x16x32_bf16 v[124:127], v[48:51], a[172:175], v[124:127]
    ds_read_b64_tr_b16 v[86:87], v41 offset:12288
    v_mfma_f32_16x16x32_bf16 v[128:131], v[52:55], a[160:163], v[128:131]
    v_mfma_f32_16x16x32_bf16 v[132:135], v[52:55], a[164:167], v[132:135]
    ds_read_b64_tr_b16 v[88:89], v42 offset:8192
    v_mfma_f32_16x16x32_bf16 v[136:139], v[52:55], a[168:171], v[136:139]
    ds_read_b64_tr_b16 v[90:91], v42 offset:12288
    v_mfma_f32_16x16x32_bf16 v[140:143], v[52:55], a[172:175], v[140:143]
    ds_read_b64_tr_b16 v[92:93], v43 offset:8192
    v_mfma_f32_16x16x32_bf16 v[144:147], v[56:59], a[160:163], v[144:147]
    ds_read_b64_tr_b16 v[94:95], v43 offset:12288
    buffer_load_dwordx4 v24, s[20:23], s86 offen offset:1024 lds
    v_mfma_f32_16x16x32_bf16 v[148:151], v[56:59], a[164:167], v[148:151]
    v_mfma_f32_16x16x32_bf16 v[152:155], v[56:59], a[168:171], v[152:155]
    ds_read_b64_tr_b16 v[96:97], v44 offset:8192
    v_mfma_f32_16x16x32_bf16 v[156:159], v[56:59], a[172:175], v[156:159]
    ds_read_b64_tr_b16 v[98:99], v44 offset:12288
    v_mfma_f32_16x16x32_bf16 v[160:163], v[60:63], a[160:163], v[160:163]
    ds_read_b64_tr_b16 v[100:101], v45 offset:8192
    v_mfma_f32_16x16x32_bf16 v[164:167], v[60:63], a[164:167], v[164:167]
    ds_read_b64_tr_b16 v[102:103], v45 offset:12288
    v_mfma_f32_16x16x32_bf16 v[168:171], v[60:63], a[168:171], v[168:171]
    v_mfma_f32_16x16x32_bf16 v[172:175], v[60:63], a[172:175], v[172:175]
    ds_read_b64_tr_b16 v[104:105], v46 offset:8192
    v_mfma_f32_16x16x32_bf16 v[176:179], v[64:67], a[160:163], v[176:179]
    ds_read_b64_tr_b16 v[106:107], v46 offset:12288
    buffer_load_dwordx4 v24, s[20:23], s86 offen offset:2048 lds
    v_mfma_f32_16x16x32_bf16 v[180:183], v[64:67], a[164:167], v[180:183]
    ds_read_b64_tr_b16 v[108:109], v47 offset:8192
    v_mfma_f32_16x16x32_bf16 v[184:187], v[64:67], a[168:171], v[184:187]
    ds_read_b64_tr_b16 v[110:111], v47 offset:12288
    v_mfma_f32_16x16x32_bf16 v[188:191], v[64:67], a[172:175], v[188:191]
    v_mfma_f32_16x16x32_bf16 v[192:195], v[68:71], a[160:163], v[192:195]
    v_mfma_f32_16x16x32_bf16 v[196:199], v[68:71], a[164:167], v[196:199]
    v_mfma_f32_16x16x32_bf16 v[200:203], v[68:71], a[168:171], v[200:203]
    v_mfma_f32_16x16x32_bf16 v[204:207], v[68:71], a[172:175], v[204:207]
    v_mfma_f32_16x16x32_bf16 v[208:211], v[72:75], a[160:163], v[208:211]
    buffer_load_dwordx4 v24, s[20:23], s86 offen offset:3072 lds
    v_mfma_f32_16x16x32_bf16 v[212:215], v[72:75], a[164:167], v[212:215]
    v_mfma_f32_16x16x32_bf16 v[216:219], v[72:75], a[168:171], v[216:219]
    v_mfma_f32_16x16x32_bf16 v[220:223], v[72:75], a[172:175], v[220:223]
    v_mfma_f32_16x16x32_bf16 v[224:227], v[76:79], a[160:163], v[224:227]
    v_mfma_f32_16x16x32_bf16 v[228:231], v[76:79], a[164:167], v[228:231]
    v_mfma_f32_16x16x32_bf16 v[232:235], v[76:79], a[168:171], v[232:235]
    v_mfma_f32_16x16x32_bf16 v[236:239], v[76:79], a[172:175], v[236:239]
    s_waitcnt vmcnt(8) lgkmcnt(0)
    s_barrier
    v_mfma_f32_16x16x32_bf16 v[112:115], v[80:83], a[176:179], v[112:115]
    v_mfma_f32_16x16x32_bf16 v[116:119], v[80:83], a[180:183], v[116:119]
    s_add_u32 m0, s68, 49152
    s_add_u32 s86, s68, 49152
    buffer_load_dwordx4 v20, s[16:19], s86 offen offset:0 lds
    v_mfma_f32_16x16x32_bf16 v[120:123], v[80:83], a[184:187], v[120:123]
    v_mfma_f32_16x16x32_bf16 v[124:127], v[80:83], a[188:191], v[124:127]
    v_mfma_f32_16x16x32_bf16 v[128:131], v[84:87], a[176:179], v[128:131]
    v_mfma_f32_16x16x32_bf16 v[132:135], v[84:87], a[180:183], v[132:135]
    v_mfma_f32_16x16x32_bf16 v[136:139], v[84:87], a[184:187], v[136:139]
    v_mfma_f32_16x16x32_bf16 v[140:143], v[84:87], a[188:191], v[140:143]
    v_mfma_f32_16x16x32_bf16 v[144:147], v[88:91], a[176:179], v[144:147]
    buffer_load_dwordx4 v21, s[16:19], s86 offen offset:1024 lds
    v_mfma_f32_16x16x32_bf16 v[148:151], v[88:91], a[180:183], v[148:151]
    v_mfma_f32_16x16x32_bf16 v[152:155], v[88:91], a[184:187], v[152:155]
    v_mfma_f32_16x16x32_bf16 v[156:159], v[88:91], a[188:191], v[156:159]
    v_mfma_f32_16x16x32_bf16 v[160:163], v[92:95], a[176:179], v[160:163]
    v_mfma_f32_16x16x32_bf16 v[164:167], v[92:95], a[180:183], v[164:167]
    v_mfma_f32_16x16x32_bf16 v[168:171], v[92:95], a[184:187], v[168:171]
    v_mfma_f32_16x16x32_bf16 v[172:175], v[92:95], a[188:191], v[172:175]
    v_mfma_f32_16x16x32_bf16 v[176:179], v[96:99], a[176:179], v[176:179]
    buffer_load_dwordx4 v22, s[16:19], s86 offen offset:2048 lds
    v_mfma_f32_16x16x32_bf16 v[180:183], v[96:99], a[180:183], v[180:183]
    v_mfma_f32_16x16x32_bf16 v[184:187], v[96:99], a[184:187], v[184:187]
    v_mfma_f32_16x16x32_bf16 v[188:191], v[96:99], a[188:191], v[188:191]
    v_mfma_f32_16x16x32_bf16 v[192:195], v[100:103], a[176:179], v[192:195]
    v_mfma_f32_16x16x32_bf16 v[196:199], v[100:103], a[180:183], v[196:199]
    v_mfma_f32_16x16x32_bf16 v[200:203], v[100:103], a[184:187], v[200:203]
    v_mfma_f32_16x16x32_bf16 v[204:207], v[100:103], a[188:191], v[204:207]
    v_mfma_f32_16x16x32_bf16 v[208:211], v[104:107], a[176:179], v[208:211]
    buffer_load_dwordx4 v23, s[16:19], s86 offen offset:3072 lds
    v_mfma_f32_16x16x32_bf16 v[212:215], v[104:107], a[180:183], v[212:215]
    v_mfma_f32_16x16x32_bf16 v[216:219], v[104:107], a[184:187], v[216:219]
    v_mfma_f32_16x16x32_bf16 v[220:223], v[104:107], a[188:191], v[220:223]
    v_mfma_f32_16x16x32_bf16 v[224:227], v[108:111], a[176:179], v[224:227]
    v_mfma_f32_16x16x32_bf16 v[228:231], v[108:111], a[180:183], v[228:231]
    v_mfma_f32_16x16x32_bf16 v[232:235], v[108:111], a[184:187], v[232:235]
    v_mfma_f32_16x16x32_bf16 v[236:239], v[108:111], a[188:191], v[236:239]
    ds_read_b128 a[128:131], v8 offset:0
    ds_read_b128 a[132:135], v9 offset:0
    ds_read_b128 a[136:139], v10 offset:0
    ds_read_b128 a[140:143], v11 offset:0
    ds_read_b128 a[144:147], v12 offset:0
    ds_read_b128 a[148:151], v13 offset:0
    ds_read_b128 a[152:155], v14 offset:0
    ds_read_b128 a[156:159], v15 offset:0
    s_add_u32 m0, s68, 98304
    s_add_u32 s86, s68, 32768
    buffer_load_dwordx4 v24, s[20:23], s86 offen offset:0 lds
    buffer_load_dwordx4 v24, s[20:23], s86 offen offset:1024 lds
    buffer_load_dwordx4 v24, s[20:23], s86 offen offset:2048 lds
    buffer_load_dwordx4 v24, s[20:23], s86 offen offset:3072 lds
    s_add_u32 m0, s68, 114688
    s_add_u32 s86, s68, 49152
    buffer_load_dwordx4 v24, s[20:23], s86 offen offset:0 lds
    buffer_load_dwordx4 v24, s[20:23], s86 offen offset:1024 lds
    buffer_load_dwordx4 v24, s[20:23], s86 offen offset:2048 lds
    buffer_load_dwordx4 v24, s[20:23], s86 offen offset:3072 lds
    s_mov_b32 s88, 0x3e0293ee
    s_mov_b32 s89, 0x3e0293ee
    v_mov_b32 v240, 0
    v_mov_b32 v241, 0
    v_mov_b32 v242, 0
    v_mov_b32 v243, 0
    v_pk_mul_f32 v[112:113], v[112:113], s[88:89]
    v_pk_mul_f32 v[114:115], v[114:115], s[88:89]
    v_pk_mul_f32 v[116:117], v[116:117], s[88:89]
    v_pk_mul_f32 v[118:119], v[118:119], s[88:89]
    v_cvt_pk_bf16_f32 v48, v112, v113
    v_cvt_pk_bf16_f32 v49, v114, v115
    v_cvt_pk_bf16_f32 v50, v116, v117
    v_cvt_pk_bf16_f32 v51, v118, v119
    v_pk_mul_f32 v[120:121], v[120:121], s[88:89]
    v_pk_mul_f32 v[122:123], v[122:123], s[88:89]
    v_pk_mul_f32 v[124:125], v[124:125], s[88:89]
    v_pk_mul_f32 v[126:127], v[126:127], s[88:89]
    v_permlane16_swap_b32 v48, v50
    v_permlane16_swap_b32 v49, v51
    v_cvt_pk_bf16_f32 v52, v120, v121
    v_cvt_pk_bf16_f32 v53, v122, v123
    v_cvt_pk_bf16_f32 v54, v124, v125
    v_cvt_pk_bf16_f32 v55, v126, v127
    v_pk_mul_f32 v[128:129], v[128:129], s[88:89]
    v_pk_mul_f32 v[130:131], v[130:131], s[88:89]
    v_pk_mul_f32 v[132:133], v[132:133], s[88:89]
    v_pk_mul_f32 v[134:135], v[134:135], s[88:89]
    v_permlane16_swap_b32 v52, v54
    v_permlane16_swap_b32 v53, v55
    v_cvt_pk_bf16_f32 v56, v128, v129
    v_cvt_pk_bf16_f32 v57, v130, v131
    v_cvt_pk_bf16_f32 v58, v132, v133
    v_cvt_pk_bf16_f32 v59, v134, v135
    v_pk_mul_f32 v[136:137], v[136:137], s[88:89]
    v_pk_mul_f32 v[138:139], v[138:139], s[88:89]
    v_pk_mul_f32 v[140:141], v[140:141], s[88:89]
    v_pk_mul_f32 v[142:143], v[142:143], s[88:89]
    v_permlane16_swap_b32 v56, v58
    v_permlane16_swap_b32 v57, v59
    v_cvt_pk_bf16_f32 v60, v136, v137
    v_cvt_pk_bf16_f32 v61, v138, v139
    v_cvt_pk_bf16_f32 v62, v140, v141
    v_cvt_pk_bf16_f32 v63, v142, v143
    v_pk_mul_f32 v[144:145], v[144:145], s[88:89]
    v_pk_mul_f32 v[146:147], v[146:147], s[88:89]
    v_pk_mul_f32 v[148:149], v[148:149], s[88:89]
    v_pk_mul_f32 v[150:151], v[150:151], s[88:89]
    v_permlane16_swap_b32 v60, v62
    v_permlane16_swap_b32 v61, v63
    v_cvt_pk_bf16_f32 v64, v144, v145
    v_cvt_pk_bf16_f32 v65, v146, v147
    v_cvt_pk_bf16_f32 v66, v148, v149
    v_cvt_pk_bf16_f32 v67, v150, v151
    v_pk_mul_f32 v[152:153], v[152:153], s[88:89]
    v_pk_mul_f32 v[154:155], v[154:155], s[88:89]
    v_pk_mul_f32 v[156:157], v[156:157], s[88:89]
    v_pk_mul_f32 v[158:159], v[158:159], s[88:89]
    v_permlane16_swap_b32 v64, v66
    v_permlane16_swap_b32 v65, v67
    v_cvt_pk_bf16_f32 v68, v152, v153
    v_cvt_pk_bf16_f32 v69, v154, v155
    v_cvt_pk_bf16_f32 v70, v156, v157
    v_cvt_pk_bf16_f32 v71, v158, v159
    v_pk_mul_f32 v[160:161], v[160:161], s[88:89]
    v_pk_mul_f32 v[162:163], v[162:163], s[88:89]
    v_pk_mul_f32 v[164:165], v[164:165], s[88:89]
    v_pk_mul_f32 v[166:167], v[166:167], s[88:89]
    v_permlane16_swap_b32 v68, v70
    v_permlane16_swap_b32 v69, v71
    v_cvt_pk_bf16_f32 v72, v160, v161
    v_cvt_pk_bf16_f32 v73, v162, v163
    v_cvt_pk_bf16_f32 v74, v164, v165
    v_cvt_pk_bf16_f32 v75, v166, v167
    v_pk_mul_f32 v[168:169], v[168:169], s[88:89]
    v_pk_mul_f32 v[170:171], v[170:171], s[88:89]
    v_pk_mul_f32 v[172:173], v[172:173], s[88:89]
    v_pk_mul_f32 v[174:175], v[174:175], s[88:89]
    v_permlane16_swap_b32 v72, v74
    v_permlane16_swap_b32 v73, v75
    v_cvt_pk_bf16_f32 v76, v168, v169
    v_cvt_pk_bf16_f32 v77, v170, v171
    v_cvt_pk_bf16_f32 v78, v172, v173
    v_cvt_pk_bf16_f32 v79, v174, v175
    v_pk_mul_f32 v[176:177], v[176:177], s[88:89]
    v_pk_mul_f32 v[178:179], v[178:179], s[88:89]
    v_pk_mul_f32 v[180:181], v[180:181], s[88:89]
    v_pk_mul_f32 v[182:183], v[182:183], s[88:89]
    v_permlane16_swap_b32 v76, v78
    v_permlane16_swap_b32 v77, v79
    v_cvt_pk_bf16_f32 v80, v176, v177
    v_cvt_pk_bf16_f32 v81, v178, v179
    v_cvt_pk_bf16_f32 v82, v180, v181
    v_cvt_pk_bf16_f32 v83, v182, v183
    v_pk_mul_f32 v[184:185], v[184:185], s[88:89]
    v_pk_mul_f32 v[186:187], v[186:187], s[88:89]
    v_pk_mul_f32 v[188:189], v[188:189], s[88:89]
    v_pk_mul_f32 v[190:191], v[190:191], s[88:89]
    v_permlane16_swap_b32 v80, v82
    v_permlane16_swap_b32 v81, v83
    v_cvt_pk_bf16_f32 v84, v184, v185
    v_cvt_pk_bf16_f32 v85, v186, v187
    v_cvt_pk_bf16_f32 v86, v188, v189
    v_cvt_pk_bf16_f32 v87, v190, v191
    v_pk_mul_f32 v[192:193], v[192:193], s[88:89]
    v_pk_mul_f32 v[194:195], v[194:195], s[88:89]
    v_pk_mul_f32 v[196:197], v[196:197], s[88:89]
    v_pk_mul_f32 v[198:199], v[198:199], s[88:89]
    v_permlane16_swap_b32 v84, v86
    v_permlane16_swap_b32 v85, v87
    v_cvt_pk_bf16_f32 v88, v192, v193
    v_cvt_pk_bf16_f32 v89, v194, v195
    v_cvt_pk_bf16_f32 v90, v196, v197
    v_cvt_pk_bf16_f32 v91, v198, v199
    v_pk_mul_f32 v[200:201], v[200:201], s[88:89]
    v_pk_mul_f32 v[202:203], v[202:203], s[88:89]
    v_pk_mul_f32 v[204:205], v[204:205], s[88:89]
    v_pk_mul_f32 v[206:207], v[206:207], s[88:89]
    v_permlane16_swap_b32 v88, v90
    v_permlane16_swap_b32 v89, v91
    v_cvt_pk_bf16_f32 v92, v200, v201
    v_cvt_pk_bf16_f32 v93, v202, v203
    v_cvt_pk_bf16_f32 v94, v204, v205
    v_cvt_pk_bf16_f32 v95, v206, v207
    v_pk_mul_f32 v[208:209], v[208:209], s[88:89]
    v_pk_mul_f32 v[210:211], v[210:211], s[88:89]
    v_pk_mul_f32 v[212:213], v[212:213], s[88:89]
    v_pk_mul_f32 v[214:215], v[214:215], s[88:89]
    v_permlane16_swap_b32 v92, v94
    v_permlane16_swap_b32 v93, v95
    v_cvt_pk_bf16_f32 v96, v208, v209
    v_cvt_pk_bf16_f32 v97, v210, v211
    v_cvt_pk_bf16_f32 v98, v212, v213
    v_cvt_pk_bf16_f32 v99, v214, v215
    v_pk_mul_f32 v[216:217], v[216:217], s[88:89]
    v_pk_mul_f32 v[218:219], v[218:219], s[88:89]
    v_pk_mul_f32 v[220:221], v[220:221], s[88:89]
    v_pk_mul_f32 v[222:223], v[222:223], s[88:89]
    v_permlane16_swap_b32 v96, v98
    v_permlane16_swap_b32 v97, v99
    v_cvt_pk_bf16_f32 v100, v216, v217
    v_cvt_pk_bf16_f32 v101, v218, v219
    v_cvt_pk_bf16_f32 v102, v220, v221
    v_cvt_pk_bf16_f32 v103, v222, v223
    v_pk_mul_f32 v[224:225], v[224:225], s[88:89]
    v_pk_mul_f32 v[226:227], v[226:227], s[88:89]
    v_pk_mul_f32 v[228:229], v[228:229], s[88:89]
    v_pk_mul_f32 v[230:231], v[230:231], s[88:89]
    v_permlane16_swap_b32 v100, v102
    v_permlane16_swap_b32 v101, v103
    v_cvt_pk_bf16_f32 v104, v224, v225
    v_cvt_pk_bf16_f32 v105, v226, v227
    v_cvt_pk_bf16_f32 v106, v228, v229
    v_cvt_pk_bf16_f32 v107, v230, v231
    v_pk_mul_f32 v[232:233], v[232:233], s[88:89]
    v_pk_mul_f32 v[234:235], v[234:235], s[88:89]
    v_pk_mul_f32 v[236:237], v[236:237], s[88:89]
    v_pk_mul_f32 v[238:239], v[238:239], s[88:89]
    v_permlane16_swap_b32 v104, v106
    v_permlane16_swap_b32 v105, v107
    v_cvt_pk_bf16_f32 v108, v232, v233
    v_cvt_pk_bf16_f32 v109, v234, v235
    v_cvt_pk_bf16_f32 v110, v236, v237
    v_cvt_pk_bf16_f32 v111, v238, v239
    s_nop 1
    v_permlane16_swap_b32 v108, v110
    v_permlane16_swap_b32 v109, v111
    s_waitcnt lgkmcnt(0)
    v_mfma_f32_32x32x16_bf16 v[112:127], a[128:131], v[48:51], 0
    s_lshl_b32 s84, s72, 14
    v_add_u32 v40, s84, v40
    v_add_u32 v41, s84, v41
    v_add_u32 v42, s84, v42
    v_add_u32 v43, s84, v43
    v_mfma_f32_32x32x16_bf16 v[128:143], a[128:131], v[52:55], 0
    v_add_u32 v44, s84, v44
    v_add_u32 v45, s84, v45
    v_add_u32 v46, s84, v46
    v_add_u32 v47, s84, v47
    s_lshl_b32 s84, s78, 8
    v_mfma_f32_32x32x16_bf16 v[112:127], a[132:135], v[56:59], v[112:127]
    v_lshrrev_b32 v246, 4, v1
    v_and_b32 v247, 15, v1
    v_add_u32 v248, 0, v246
    v_lshlrev_b32 v248, 1, v248
    v_xor_b32 v248, v248, v247
    v_mfma_f32_32x32x16_bf16 v[128:143], a[132:135], v[60:63], v[128:143]
    v_lshlrev_b32 v248, 4, v248
    v_add_u32 v249, 0, v246
    v_mul_u32_u24 v249, 4096, v249
    v_add3_u32 v2, v248, v249, s84
    v_add_u32 v248, 4, v246
    v_mfma_f32_32x32x16_bf16 v[112:127], a[136:139], v[64:67], v[112:127]
    v_lshlrev_b32 v248, 1, v248
    v_xor_b32 v248, v248, v247
    v_lshlrev_b32 v248, 4, v248
    v_add_u32 v249, 4, v246
    v_mul_u32_u24 v249, 4096, v249
    v_mfma_f32_32x32x16_bf16 v[128:143], a[136:139], v[68:71], v[128:143]
    v_add3_u32 v3, v248, v249, s84
    v_subrev_u32 v3, 1024, v3
    v_add_u32 v248, 0, v246
    v_lshlrev_b32 v248, 1, v248
    v_xor_b32 v248, v248, v247
    v_mfma_f32_32x32x16_bf16 v[112:127], a[140:143], v[72:75], v[112:127]
    v_lshlrev_b32 v248, 4, v248
    v_add_u32 v249, 8, v246
    v_mul_u32_u24 v249, 4096, v249
    v_add3_u32 v4, v248, v249, s84
    v_subrev_u32 v4, 2048, v4
    v_mfma_f32_32x32x16_bf16 v[128:143], a[140:143], v[76:79], v[128:143]
    v_add_u32 v248, 4, v246
    v_lshlrev_b32 v248, 1, v248
    v_xor_b32 v248, v248, v247
    v_lshlrev_b32 v248, 4, v248
    v_add_u32 v249, 12, v246
    v_mfma_f32_32x32x16_bf16 v[112:127], a[144:147], v[80:83], v[112:127]
    v_mul_u32_u24 v249, 4096, v249
    v_add3_u32 v5, v248, v249, s84
    v_subrev_u32 v5, 3072, v5
    s_lshl_b32 s84, s79, 1
    s_add_u32 s84, s84, s73
    v_mfma_f32_32x32x16_bf16 v[128:143], a[144:147], v[84:87], v[128:143]
    s_lshl_b32 s84, s84, 12
    v_add_u32 v6, s84, v7
    s_lshl_b32 s84, s79, 8
    s_add_u32 s84, s84, 18432
    v_and_b32 v27, 15, v1
    v_mfma_f32_32x32x16_bf16 v[112:127], a[148:151], v[88:91], v[112:127]
    v_min_u32 v26, 11, v27
    v_lshlrev_b32 v27, 3, v27
    v_add_u32 v27, s84, v27
    v_lshlrev_b32 v26, 3, v26
    s_add_u32 s84, s84, 128
    v_mfma_f32_32x32x16_bf16 v[128:143], a[148:151], v[92:95], v[128:143]
    v_add_u32 v26, s84, v26
    v_bfe_u32 v246, v6, 7, 3
    v_xor_b32 v246, 3, v246
    v_min_u32 v246, 1, v246
    v_add_u32 v246, -1, v246
    v_mfma_f32_32x32x16_bf16 v[112:127], a[152:155], v[96:99], v[112:127]
    v_and_b32 v246, 0x3fffe80, v246
    v_add_u32 v6, v6, v246
    s_mul_i32 s66, s71, 131072
    s_add_u32 s66, s66, 0x790000
    s_mul_i32 s67, s72, 131072
    v_mfma_f32_32x32x16_bf16 v[128:143], a[152:155], v[100:103], v[128:143]
    s_add_u32 s67, s67, 4194304
    s_mov_b32 s8, s56
    s_mov_b32 s9, s57
    s_mov_b32 s10, 0xe00000
    s_mov_b32 s11, 0x00020000
    v_mfma_f32_32x32x16_bf16 v[112:127], a[156:159], v[104:107], v[112:127]
    s_add_u32 s12, s64, 0x800000
    s_addc_u32 s13, s65, 0
    s_mov_b32 s14, 0x4700000
    s_mov_b32 s15, 0x00020000
    v_mfma_f32_32x32x16_bf16 v[128:143], a[156:159], v[108:111], v[128:143]
    ds_read_b128 a[128:131], v8 offset:8192
    ds_read_b128 a[132:135], v9 offset:8192
    ds_read_b128 a[136:139], v10 offset:8192
    ds_read_b128 a[140:143], v11 offset:8192
    ds_read_b128 a[144:147], v12 offset:8192
    ds_read_b128 a[148:151], v13 offset:8192
    ds_read_b128 a[152:155], v14 offset:8192
    ds_read_b128 a[156:159], v15 offset:8192
    s_nop 5
    v_max3_f32 v244, v112, v113, v114
    v_max3_f32 v244, v244, v115, v116
    v_max3_f32 v244, v244, v117, v118
    v_max3_f32 v244, v244, v119, v120
    v_max3_f32 v244, v244, v121, v122
    v_max3_f32 v244, v244, v123, v124
    v_max3_f32 v244, v244, v125, v126
    v_max_f32 v244, v244, v127
    v_max3_f32 v245, v128, v129, v130
    v_max3_f32 v245, v245, v131, v132
    v_max3_f32 v245, v245, v133, v134
    v_max3_f32 v245, v245, v135, v136
    v_max3_f32 v245, v245, v137, v138
    v_max3_f32 v245, v245, v139, v140
    v_max3_f32 v245, v245, v141, v142
    v_max_f32 v245, v245, v143
    v_mov_b32 v246, v244
    v_mov_b32 v247, v245
    s_nop 1
    v_permlane32_swap_b32 v244, v246
    v_permlane32_swap_b32 v245, v247
    s_nop 0
    v_max_f32 v244, v244, v246
    v_max_f32 v245, v245, v247
    v_sub_f32 v176, 0, v244
    v_sub_f32 v177, 0, v244
    v_sub_f32 v192, 0, v245
    v_sub_f32 v193, 0, v245
    v_mov_b64 v[178:179], v[176:177]
    v_mov_b64 v[180:181], v[176:177]
    v_mov_b64 v[182:183], v[176:177]
    v_mov_b64 v[184:185], v[176:177]
    v_mov_b64 v[186:187], v[176:177]
    v_mov_b64 v[188:189], v[176:177]
    v_mov_b64 v[190:191], v[176:177]
    v_mov_b64 v[194:195], v[192:193]
    v_mov_b64 v[196:197], v[192:193]
    v_mov_b64 v[198:199], v[192:193]
    v_mov_b64 v[200:201], v[192:193]
    v_mov_b64 v[202:203], v[192:193]
    v_mov_b64 v[204:205], v[192:193]
    v_mov_b64 v[206:207], v[192:193]
    v_pk_add_f32 v[112:113], v[112:113], v[176:177]
    v_pk_add_f32 v[114:115], v[114:115], v[176:177]
    v_pk_add_f32 v[116:117], v[116:117], v[176:177]
    v_pk_add_f32 v[118:119], v[118:119], v[176:177]
    v_pk_add_f32 v[120:121], v[120:121], v[176:177]
    v_pk_add_f32 v[122:123], v[122:123], v[176:177]
    v_pk_add_f32 v[124:125], v[124:125], v[176:177]
    v_pk_add_f32 v[126:127], v[126:127], v[176:177]
    v_pk_add_f32 v[128:129], v[128:129], v[192:193]
    v_pk_add_f32 v[130:131], v[130:131], v[192:193]
    v_pk_add_f32 v[132:133], v[132:133], v[192:193]
    v_pk_add_f32 v[134:135], v[134:135], v[192:193]
    v_pk_add_f32 v[136:137], v[136:137], v[192:193]
    v_pk_add_f32 v[138:139], v[138:139], v[192:193]
    v_pk_add_f32 v[140:141], v[140:141], v[192:193]
    v_pk_add_f32 v[142:143], v[142:143], v[192:193]
    s_waitcnt lgkmcnt(0)
    v_mfma_f32_32x32x16_bf16 v[144:159], a[128:131], v[48:51], v[176:191]
    v_exp_f32 v112, v112
    v_exp_f32 v113, v113
    v_exp_f32 v114, v114
    v_mfma_f32_32x32x16_bf16 v[160:175], a[128:131], v[52:55], v[192:207]
    v_exp_f32 v115, v115
    v_add_f32 v240, v240, v112
    v_mfma_f32_32x32x16_bf16 v[144:159], a[132:135], v[56:59], v[144:159]
    v_add_f32 v241, v241, v113
    v_cvt_pk_bf16_f32 v208, v112, v113
    v_exp_f32 v116, v116
    v_mfma_f32_32x32x16_bf16 v[160:175], a[132:135], v[60:63], v[160:175]
    v_exp_f32 v117, v117
    v_add_f32 v240, v240, v114
    v_mfma_f32_32x32x16_bf16 v[144:159], a[136:139], v[64:67], v[144:159]
    v_add_f32 v241, v241, v115
    v_cvt_pk_bf16_f32 v209, v114, v115
    v_exp_f32 v118, v118
    v_mfma_f32_32x32x16_bf16 v[160:175], a[136:139], v[68:71], v[160:175]
    v_exp_f32 v119, v119
    v_add_f32 v240, v240, v116
    v_mfma_f32_32x32x16_bf16 v[144:159], a[140:143], v[72:75], v[144:159]
    v_add_f32 v241, v241, v117
    v_cvt_pk_bf16_f32 v210, v116, v117
    v_exp_f32 v120, v120
    v_mfma_f32_32x32x16_bf16 v[160:175], a[140:143], v[76:79], v[160:175]
    v_exp_f32 v121, v121
    v_add_f32 v240, v240, v118
    v_mfma_f32_32x32x16_bf16 v[144:159], a[144:147], v[80:83], v[144:159]
    v_add_f32 v241, v241, v119
    v_cvt_pk_bf16_f32 v211, v118, v119
    v_exp_f32 v122, v122
    v_mfma_f32_32x32x16_bf16 v[160:175], a[144:147], v[84:87], v[160:175]
    v_exp_f32 v123, v123
    v_add_f32 v240, v240, v120
    v_mfma_f32_32x32x16_bf16 v[144:159], a[148:151], v[88:91], v[144:159]
    v_add_f32 v241, v241, v121
    v_cvt_pk_bf16_f32 v212, v120, v121
    v_exp_f32 v124, v124
    v_mfma_f32_32x32x16_bf16 v[160:175], a[148:151], v[92:95], v[160:175]
    v_exp_f32 v125, v125
    v_add_f32 v240, v240, v122
    v_mfma_f32_32x32x16_bf16 v[144:159], a[152:155], v[96:99], v[144:159]
    v_add_f32 v241, v241, v123
    v_cvt_pk_bf16_f32 v213, v122, v123
    v_exp_f32 v126, v126
    v_mfma_f32_32x32x16_bf16 v[160:175], a[152:155], v[100:103], v[160:175]
    v_exp_f32 v127, v127
    v_add_f32 v240, v240, v124
    v_mfma_f32_32x32x16_bf16 v[144:159], a[156:159], v[104:107], v[144:159]
    v_add_f32 v241, v241, v125
    v_cvt_pk_bf16_f32 v214, v124, v125
    v_exp_f32 v128, v128
    v_mfma_f32_32x32x16_bf16 v[160:175], a[156:159], v[108:111], v[160:175]
    v_exp_f32 v129, v129
    v_add_f32 v240, v240, v126
    ds_read_b128 a[128:131], v8 offset:16384
    ds_read_b128 a[132:135], v9 offset:16384
    ds_read_b128 a[136:139], v10 offset:16384
    ds_read_b128 a[140:143], v11 offset:16384
    ds_read_b128 a[144:147], v12 offset:16384
    ds_read_b128 a[148:151], v13 offset:16384
    ds_read_b128 a[152:155], v14 offset:16384
    ds_read_b128 a[156:159], v15 offset:16384
    v_add_f32 v241, v241, v127
    v_cvt_pk_bf16_f32 v215, v126, v127
    v_exp_f32 v130, v130
    v_exp_f32 v131, v131
    v_add_f32 v242, v242, v128
    v_add_f32 v243, v243, v129
    v_cvt_pk_bf16_f32 v216, v128, v129
    v_exp_f32 v132, v132
    v_exp_f32 v133, v133
    v_add_f32 v242, v242, v130
    v_add_f32 v243, v243, v131
    v_cvt_pk_bf16_f32 v217, v130, v131
    v_exp_f32 v134, v134
    v_exp_f32 v135, v135
    v_add_f32 v242, v242, v132
    v_add_f32 v243, v243, v133
    v_cvt_pk_bf16_f32 v218, v132, v133
    v_exp_f32 v136, v136
    v_exp_f32 v137, v137
    v_add_f32 v242, v242, v134
    v_add_f32 v243, v243, v135
    v_cvt_pk_bf16_f32 v219, v134, v135
    v_exp_f32 v138, v138
    v_exp_f32 v139, v139
    v_add_f32 v242, v242, v136
    v_add_f32 v243, v243, v137
    v_cvt_pk_bf16_f32 v220, v136, v137
    v_exp_f32 v140, v140
    v_exp_f32 v141, v141
    v_add_f32 v242, v242, v138
    v_add_f32 v243, v243, v139
    v_cvt_pk_bf16_f32 v221, v138, v139
    v_exp_f32 v142, v142
    v_exp_f32 v143, v143
    v_add_f32 v242, v242, v140
    v_add_f32 v243, v243, v141
    v_cvt_pk_bf16_f32 v222, v140, v141
    s_nop 0
    v_add_f32 v242, v242, v142
    v_add_f32 v243, v243, v143
    v_cvt_pk_bf16_f32 v223, v142, v143
    s_waitcnt lgkmcnt(0)
    v_mfma_f32_32x32x16_bf16 v[112:127], a[128:131], v[48:51], v[176:191]
    ds_read_b64_tr_b16 a[160:161], v16 offset:0
    ds_read_b64_tr_b16 a[162:163], v16 offset:2048
    v_exp_f32 v144, v144
    v_exp_f32 v145, v145
    v_mfma_f32_32x32x16_bf16 v[128:143], a[128:131], v[52:55], v[192:207]
    ds_read_b64_tr_b16 a[164:165], v17 offset:0
    ds_read_b64_tr_b16 a[166:167], v17 offset:2048
    v_exp_f32 v146, v146
    v_exp_f32 v147, v147
    v_mfma_f32_32x32x16_bf16 v[112:127], a[132:135], v[56:59], v[112:127]
    ds_read_b64_tr_b16 a[168:169], v18 offset:0
    v_add_f32 v240, v240, v144
    v_add_f32 v241, v241, v145
    v_cvt_pk_bf16_f32 v224, v144, v145
    v_exp_f32 v148, v148
    v_mfma_f32_32x32x16_bf16 v[128:143], a[132:135], v[60:63], v[128:143]
    ds_read_b64_tr_b16 a[170:171], v18 offset:2048
    ds_read_b64_tr_b16 a[172:173], v19 offset:0
    v_exp_f32 v149, v149
    v_add_f32 v240, v240, v146
    v_mfma_f32_32x32x16_bf16 v[112:127], a[136:139], v[64:67], v[112:127]
    ds_read_b64_tr_b16 a[174:175], v19 offset:2048
    v_add_f32 v241, v241, v147
    v_cvt_pk_bf16_f32 v225, v146, v147
    v_exp_f32 v150, v150
    v_mfma_f32_32x32x16_bf16 v[128:143], a[136:139], v[68:71], v[128:143]
    ds_read_b64_tr_b16 a[176:177], v16 offset:4096
    ds_read_b64_tr_b16 a[178:179], v16 offset:6144
    v_exp_f32 v151, v151
    v_add_f32 v240, v240, v148
    v_mfma_f32_32x32x16_bf16 v[112:127], a[140:143], v[72:75], v[112:127]
    ds_read_b64_tr_b16 a[180:181], v17 offset:4096
    ds_read_b64_tr_b16 a[182:183], v17 offset:6144
    v_add_f32 v241, v241, v149
    v_cvt_pk_bf16_f32 v226, v148, v149
    v_exp_f32 v152, v152
    v_mfma_f32_32x32x16_bf16 v[128:143], a[140:143], v[76:79], v[128:143]
    ds_read_b64_tr_b16 a[184:185], v18 offset:4096
    v_exp_f32 v153, v153
    v_add_f32 v240, v240, v150
    v_mfma_f32_32x32x16_bf16 v[112:127], a[144:147], v[80:83], v[112:127]
    ds_read_b64_tr_b16 a[186:187], v18 offset:6144
    ds_read_b64_tr_b16 a[188:189], v19 offset:4096
    v_add_f32 v241, v241, v151
    v_cvt_pk_bf16_f32 v227, v150, v151
    v_exp_f32 v154, v154
    v_mfma_f32_32x32x16_bf16 v[128:143], a[144:147], v[84:87], v[128:143]
    ds_read_b64_tr_b16 a[190:191], v19 offset:6144
    v_exp_f32 v155, v155
    v_add_f32 v240, v240, v152
    v_mfma_f32_32x32x16_bf16 v[112:127], a[148:151], v[88:91], v[112:127]
    v_add_f32 v241, v241, v153
    v_cvt_pk_bf16_f32 v228, v152, v153
    v_exp_f32 v156, v156
    v_mfma_f32_32x32x16_bf16 v[128:143], a[148:151], v[92:95], v[128:143]
    v_exp_f32 v157, v157
    v_add_f32 v240, v240, v154
    v_mfma_f32_32x32x16_bf16 v[112:127], a[152:155], v[96:99], v[112:127]
    v_add_f32 v241, v241, v155
    v_cvt_pk_bf16_f32 v229, v154, v155
    v_exp_f32 v158, v158
    v_mfma_f32_32x32x16_bf16 v[128:143], a[152:155], v[100:103], v[128:143]
    v_exp_f32 v159, v159
    v_add_f32 v240, v240, v156
    v_mfma_f32_32x32x16_bf16 v[112:127], a[156:159], v[104:107], v[112:127]
    v_add_f32 v241, v241, v157
    v_cvt_pk_bf16_f32 v230, v156, v157
    v_exp_f32 v160, v160
    v_mfma_f32_32x32x16_bf16 v[128:143], a[156:159], v[108:111], v[128:143]
    v_exp_f32 v161, v161
    v_add_f32 v240, v240, v158
    s_waitcnt lgkmcnt(0)
    v_mfma_f32_32x32x16_bf16 a[0:15], a[160:163], v[208:211], 0
    ds_read_b128 a[128:131], v8 offset:24576
    s_mov_b32 s28, s56
    s_mov_b32 s29, s57
    s_mov_b32 s30, 0xa00000
    s_mov_b32 s31, 0x00020000
    s_xor_b32 s87, s71, 3
    v_mfma_f32_32x32x16_bf16 a[16:31], a[160:163], v[216:219], 0
    ds_read_b128 a[132:135], v9 offset:24576
    s_lshl_b32 s87, s87, 5
    s_add_u32 s87, s87, s81
    s_lshl_b32 s87, s87, 2
    s_and_b32 s85, s2, 3
    s_add_u32 s87, s87, s85
    v_mfma_f32_32x32x16_bf16 a[32:47], a[164:167], v[208:211], 0
    ds_read_b128 a[136:139], v10 offset:24576
    s_mul_i32 s87, s87, 8192
    s_add_u32 s87, s87, 8388608
    v_and_b32 v30, 31, v1
    v_min_u32 v30, 31, v30
    v_lshlrev_b32 v30, 7, v30
    v_mfma_f32_32x32x16_bf16 a[48:63], a[164:167], v[216:219], 0
    ds_read_b128 a[140:143], v11 offset:24576
    v_lshrrev_b32 v29, 5, v1
    v_mul_u32_u24 v29, 4096, v29
    v_add_u32 v30, v30, v29
    buffer_load_dword v31, v30, s[28:31], s87 offen
    v_add_f32 v241, v241, v159
    v_mfma_f32_32x32x16_bf16 a[64:79], a[168:171], v[208:211], 0
    v_cvt_pk_bf16_f32 v231, v158, v159
    v_exp_f32 v162, v162
    v_exp_f32 v163, v163
    v_add_f32 v242, v242, v160
    v_mfma_f32_32x32x16_bf16 a[80:95], a[168:171], v[216:219], 0
    ds_read_b128 a[144:147], v12 offset:24576
    v_add_f32 v243, v243, v161
    v_cvt_pk_bf16_f32 v232, v160, v161
    v_exp_f32 v164, v164
    v_mfma_f32_32x32x16_bf16 a[96:111], a[172:175], v[208:211], 0
    ds_read_b128 a[148:151], v13 offset:24576
    v_exp_f32 v165, v165
    v_add_f32 v242, v242, v162
    v_add_f32 v243, v243, v163
    v_cvt_pk_bf16_f32 v233, v162, v163
    v_mfma_f32_32x32x16_bf16 a[112:127], a[172:175], v[216:219], 0
    ds_read_b128 a[152:155], v14 offset:24576
    v_exp_f32 v166, v166
    v_exp_f32 v167, v167
    v_add_f32 v242, v242, v164
    v_add_f32 v243, v243, v165
    v_mfma_f32_32x32x16_bf16 a[0:15], a[176:179], v[212:215], a[0:15]
    ds_read_b128 a[156:159], v15 offset:24576
    v_cvt_pk_bf16_f32 v234, v164, v165
    v_exp_f32 v168, v168
    v_exp_f32 v169, v169
    v_mfma_f32_32x32x16_bf16 a[16:31], a[176:179], v[220:223], a[16:31]
    v_add_f32 v242, v242, v166
    v_add_f32 v243, v243, v167
    v_cvt_pk_bf16_f32 v235, v166, v167
    v_exp_f32 v170, v170
    v_mfma_f32_32x32x16_bf16 a[32:47], a[180:183], v[212:215], a[32:47]
    v_exp_f32 v171, v171
    v_add_f32 v242, v242, v168
    v_add_f32 v243, v243, v169
    v_cvt_pk_bf16_f32 v236, v168, v169
    v_exp_f32 v172, v172
    v_mfma_f32_32x32x16_bf16 a[48:63], a[180:183], v[220:223], a[48:63]
    v_exp_f32 v173, v173
    v_add_f32 v242, v242, v170
    v_add_f32 v243, v243, v171
    v_cvt_pk_bf16_f32 v237, v170, v171
    v_mfma_f32_32x32x16_bf16 a[64:79], a[184:187], v[212:215], a[64:79]
    v_exp_f32 v174, v174
    v_exp_f32 v175, v175
    v_add_f32 v242, v242, v172
    v_add_f32 v243, v243, v173
    v_mfma_f32_32x32x16_bf16 a[80:95], a[184:187], v[220:223], a[80:95]
    v_cvt_pk_bf16_f32 v238, v172, v173
    s_nop 0
    v_add_f32 v242, v242, v174
    v_mfma_f32_32x32x16_bf16 a[96:111], a[188:191], v[212:215], a[96:111]
    v_add_f32 v243, v243, v175
    v_cvt_pk_bf16_f32 v239, v174, v175
    v_mfma_f32_32x32x16_bf16 a[112:127], a[188:191], v[220:223], a[112:127]
    s_waitcnt lgkmcnt(0)
    s_waitcnt vmcnt(13)
    s_barrier
    v_mfma_f32_32x32x16_bf16 v[144:159], a[128:131], v[48:51], v[176:191]
    ds_read_b64_tr_b16 a[160:161], v16 offset:8192
    ds_read_b64_tr_b16 a[162:163], v16 offset:10240
    v_exp_f32 v112, v112
    v_exp_f32 v113, v113
    v_mfma_f32_32x32x16_bf16 v[160:175], a[128:131], v[52:55], v[192:207]
    ds_read_b64_tr_b16 a[164:165], v17 offset:8192
    ds_read_b64_tr_b16 a[166:167], v17 offset:10240
    v_exp_f32 v114, v114
    v_exp_f32 v115, v115
    v_mfma_f32_32x32x16_bf16 v[144:159], a[132:135], v[56:59], v[144:159]
    ds_read_b64_tr_b16 a[168:169], v18 offset:8192
    v_add_f32 v240, v240, v112
    v_add_f32 v241, v241, v113
    v_cvt_pk_bf16_f32 v208, v112, v113
    v_exp_f32 v116, v116
    v_mfma_f32_32x32x16_bf16 v[160:175], a[132:135], v[60:63], v[160:175]
    ds_read_b64_tr_b16 a[170:171], v18 offset:10240
    ds_read_b64_tr_b16 a[172:173], v19 offset:8192
    v_exp_f32 v117, v117
    v_add_f32 v240, v240, v114
    v_mfma_f32_32x32x16_bf16 v[144:159], a[136:139], v[64:67], v[144:159]
    ds_read_b64_tr_b16 a[174:175], v19 offset:10240
    v_add_f32 v241, v241, v115
    v_cvt_pk_bf16_f32 v209, v114, v115
    v_exp_f32 v118, v118
    v_mfma_f32_32x32x16_bf16 v[160:175], a[136:139], v[68:71], v[160:175]
    ds_read_b64_tr_b16 a[176:177], v16 offset:12288
    ds_read_b64_tr_b16 a[178:179], v16 offset:14336
    v_exp_f32 v119, v119
    v_add_f32 v240, v240, v116
    v_mfma_f32_32x32x16_bf16 v[144:159], a[140:143], v[72:75], v[144:159]
    ds_read_b64_tr_b16 a[180:181], v17 offset:12288
    ds_read_b64_tr_b16 a[182:183], v17 offset:14336
    v_add_f32 v241, v241, v117
    v_cvt_pk_bf16_f32 v210, v116, v117
    v_exp_f32 v120, v120
    v_mfma_f32_32x32x16_bf16 v[160:175], a[140:143], v[76:79], v[160:175]
    ds_read_b64_tr_b16 a[184:185], v18 offset:12288
    v_exp_f32 v121, v121
    v_add_f32 v240, v240, v118
    v_mfma_f32_32x32x16_bf16 v[144:159], a[144:147], v[80:83], v[144:159]
    ds_read_b64_tr_b16 a[186:187], v18 offset:14336
    ds_read_b64_tr_b16 a[188:189], v19 offset:12288
    v_add_f32 v241, v241, v119
    v_cvt_pk_bf16_f32 v211, v118, v119
    v_exp_f32 v122, v122
    v_mfma_f32_32x32x16_bf16 v[160:175], a[144:147], v[84:87], v[160:175]
    ds_read_b64_tr_b16 a[190:191], v19 offset:14336
    v_exp_f32 v123, v123
    v_add_f32 v240, v240, v120
    v_mfma_f32_32x32x16_bf16 v[144:159], a[148:151], v[88:91], v[144:159]
    v_add_f32 v241, v241, v121
    v_cvt_pk_bf16_f32 v212, v120, v121
    v_exp_f32 v124, v124
    v_mfma_f32_32x32x16_bf16 v[160:175], a[148:151], v[92:95], v[160:175]
    v_exp_f32 v125, v125
    v_add_f32 v240, v240, v122
    v_mfma_f32_32x32x16_bf16 v[144:159], a[152:155], v[96:99], v[144:159]
    v_add_f32 v241, v241, v123
    v_cvt_pk_bf16_f32 v213, v122, v123
    v_exp_f32 v126, v126
    v_mfma_f32_32x32x16_bf16 v[160:175], a[152:155], v[100:103], v[160:175]
    v_exp_f32 v127, v127
    v_add_f32 v240, v240, v124
    v_mfma_f32_32x32x16_bf16 v[144:159], a[156:159], v[104:107], v[144:159]
    v_add_f32 v241, v241, v125
    v_cvt_pk_bf16_f32 v214, v124, v125
    v_exp_f32 v128, v128
    v_mfma_f32_32x32x16_bf16 v[160:175], a[156:159], v[108:111], v[160:175]
    v_exp_f32 v129, v129
    v_add_f32 v240, v240, v126
    s_waitcnt lgkmcnt(0)
    v_mfma_f32_32x32x16_bf16 a[0:15], a[160:163], v[224:227], a[0:15]
    ds_read_b128 a[128:131], v8 offset:32768
    s_add_u32 m0, s68, 0
    s_add_u32 s86, s68, 65536
    buffer_load_dwordx4 v20, s[16:19], s86 offen offset:0 lds
    v_add_f32 v241, v241, v127
    v_cvt_pk_bf16_f32 v215, v126, v127
    v_mfma_f32_32x32x16_bf16 a[16:31], a[160:163], v[232:235], a[16:31]
    ds_read_b128 a[132:135], v9 offset:32768
    buffer_load_dwordx4 v21, s[16:19], s86 offen offset:1024 lds
    v_exp_f32 v130, v130
    v_exp_f32 v131, v131
    v_mfma_f32_32x32x16_bf16 a[32:47], a[164:167], v[224:227], a[32:47]
    ds_read_b128 a[136:139], v10 offset:32768
    v_add_f32 v242, v242, v128
    v_add_f32 v243, v243, v129
    v_cvt_pk_bf16_f32 v216, v128, v129
    v_exp_f32 v132, v132
    v_mfma_f32_32x32x16_bf16 a[48:63], a[164:167], v[232:235], a[48:63]
    ds_read_b128 a[140:143], v11 offset:32768
    buffer_load_dwordx4 v22, s[16:19], s86 offen offset:2048 lds
    v_exp_f32 v133, v133
    v_add_f32 v242, v242, v130
    v_add_f32 v243, v243, v131
    v_mfma_f32_32x32x16_bf16 a[64:79], a[168:171], v[224:227], a[64:79]
    v_cvt_pk_bf16_f32 v217, v130, v131
    v_exp_f32 v134, v134
    v_exp_f32 v135, v135
    v_mfma_f32_32x32x16_bf16 a[80:95], a[168:171], v[232:235], a[80:95]
    ds_read_b128 a[144:147], v12 offset:32768
    buffer_load_dwordx4 v23, s[16:19], s86 offen offset:3072 lds
    v_add_f32 v242, v242, v132
    v_add_f32 v243, v243, v133
    v_cvt_pk_bf16_f32 v218, v132, v133
    v_mfma_f32_32x32x16_bf16 a[96:111], a[172:175], v[224:227], a[96:111]
    ds_read_b128 a[148:151], v13 offset:32768
    v_exp_f32 v136, v136
    v_exp_f32 v137, v137
    v_add_f32 v242, v242, v134
    v_mfma_f32_32x32x16_bf16 a[112:127], a[172:175], v[232:235], a[112:127]
    ds_read_b128 a[152:155], v14 offset:32768
    s_add_u32 m0, s68, 16384
    s_add_u32 s86, s68, 81920
    buffer_load_dwordx4 v20, s[16:19], s86 offen offset:0 lds
    v_add_f32 v243, v243, v135
    v_cvt_pk_bf16_f32 v219, v134, v135
    v_mfma_f32_32x32x16_bf16 a[0:15], a[176:179], v[228:231], a[0:15]
    ds_read_b128 a[156:159], v15 offset:32768
    buffer_load_dwordx4 v21, s[16:19], s86 offen offset:1024 lds
    v_exp_f32 v138, v138
    v_exp_f32 v139, v139
    v_add_f32 v242, v242, v136
    v_mfma_f32_32x32x16_bf16 a[16:31], a[176:179], v[236:239], a[16:31]
    v_add_f32 v243, v243, v137
    v_cvt_pk_bf16_f32 v220, v136, v137
    v_exp_f32 v140, v140
    v_mfma_f32_32x32x16_bf16 a[32:47], a[180:183], v[228:231], a[32:47]
    buffer_load_dwordx4 v22, s[16:19], s86 offen offset:2048 lds
    v_exp_f32 v141, v141
    v_add_f32 v242, v242, v138
    v_add_f32 v243, v243, v139
    v_mfma_f32_32x32x16_bf16 a[48:63], a[180:183], v[236:239], a[48:63]
    v_cvt_pk_bf16_f32 v221, v138, v139
    v_exp_f32 v142, v142
    v_mfma_f32_32x32x16_bf16 a[64:79], a[184:187], v[228:231], a[64:79]
    buffer_load_dwordx4 v23, s[16:19], s86 offen offset:3072 lds
    v_exp_f32 v143, v143
    v_add_f32 v242, v242, v140
    v_add_f32 v243, v243, v141
    v_mfma_f32_32x32x16_bf16 a[80:95], a[184:187], v[236:239], a[80:95]
    v_cvt_pk_bf16_f32 v222, v140, v141
    s_nop 0
    v_add_f32 v242, v242, v142
    v_mfma_f32_32x32x16_bf16 a[96:111], a[188:191], v[228:231], a[96:111]
    s_mov_b32 s28, s56
    s_mov_b32 s29, s57
    s_mov_b32 s30, 0xc00000
    s_mov_b32 s31, 0x00020000
    s_xor_b32 s87, s71, 3
    s_lshl_b32 s87, s87, 5
    s_add_u32 s87, s87, s81
    v_mfma_f32_32x32x16_bf16 a[112:127], a[188:191], v[236:239], a[112:127]
    s_lshl_b32 s87, s87, 2
    s_and_b32 s85, s2, 3
    s_add_u32 s87, s87, s85
    s_mul_i32 s87, s87, 8192
    s_add_u32 s87, s87, 10485760
    v_and_b32 v30, 31, v1
    v_min_u32 v30, 31, v30
    v_lshlrev_b32 v30, 7, v30
    v_lshrrev_b32 v29, 5, v1
    v_mul_u32_u24 v29, 4096, v29
    v_add_u32 v30, v30, v29
    buffer_load_dword v31, v30, s[28:31], s87 offen
    v_add_f32 v243, v243, v143
    v_cvt_pk_bf16_f32 v223, v142, v143
    s_waitcnt lgkmcnt(0)
    v_mfma_f32_32x32x16_bf16 v[112:127], a[128:131], v[48:51], v[176:191]
    ds_read_b64_tr_b16 a[160:161], v16 offset:16384
    ds_read_b64_tr_b16 a[162:163], v16 offset:18432
    v_exp_f32 v144, v144
    v_exp_f32 v145, v145
    v_mfma_f32_32x32x16_bf16 v[128:143], a[128:131], v[52:55], v[192:207]
    ds_read_b64_tr_b16 a[164:165], v17 offset:16384
    ds_read_b64_tr_b16 a[166:167], v17 offset:18432
    v_exp_f32 v146, v146
    v_exp_f32 v147, v147
    v_mfma_f32_32x32x16_bf16 v[112:127], a[132:135], v[56:59], v[112:127]
    ds_read_b64_tr_b16 a[168:169], v18 offset:16384
    v_add_f32 v240, v240, v144
    v_add_f32 v241, v241, v145
    v_cvt_pk_bf16_f32 v224, v144, v145
    v_exp_f32 v148, v148
    v_mfma_f32_32x32x16_bf16 v[128:143], a[132:135], v[60:63], v[128:143]
    ds_read_b64_tr_b16 a[170:171], v18 offset:18432
    ds_read_b64_tr_b16 a[172:173], v19 offset:16384
    v_exp_f32 v149, v149
    v_add_f32 v240, v240, v146
    v_mfma_f32_32x32x16_bf16 v[112:127], a[136:139], v[64:67], v[112:127]
    ds_read_b64_tr_b16 a[174:175], v19 offset:18432
    v_add_f32 v241, v241, v147
    v_cvt_pk_bf16_f32 v225, v146, v147
    v_exp_f32 v150, v150
    v_mfma_f32_32x32x16_bf16 v[128:143], a[136:139], v[68:71], v[128:143]
    ds_read_b64_tr_b16 a[176:177], v16 offset:20480
    ds_read_b64_tr_b16 a[178:179], v16 offset:22528
    v_exp_f32 v151, v151
    v_add_f32 v240, v240, v148
    v_mfma_f32_32x32x16_bf16 v[112:127], a[140:143], v[72:75], v[112:127]
    ds_read_b64_tr_b16 a[180:181], v17 offset:20480
    ds_read_b64_tr_b16 a[182:183], v17 offset:22528
    v_add_f32 v241, v241, v149
    v_cvt_pk_bf16_f32 v226, v148, v149
    v_exp_f32 v152, v152
    v_mfma_f32_32x32x16_bf16 v[128:143], a[140:143], v[76:79], v[128:143]
    ds_read_b64_tr_b16 a[184:185], v18 offset:20480
    v_exp_f32 v153, v153
    v_add_f32 v240, v240, v150
    v_mfma_f32_32x32x16_bf16 v[112:127], a[144:147], v[80:83], v[112:127]
    ds_read_b64_tr_b16 a[186:187], v18 offset:22528
    ds_read_b64_tr_b16 a[188:189], v19 offset:20480
    v_add_f32 v241, v241, v151
    v_cvt_pk_bf16_f32 v227, v150, v151
    v_exp_f32 v154, v154
    v_mfma_f32_32x32x16_bf16 v[128:143], a[144:147], v[84:87], v[128:143]
    ds_read_b64_tr_b16 a[190:191], v19 offset:22528
    v_exp_f32 v155, v155
    v_add_f32 v240, v240, v152
    v_mfma_f32_32x32x16_bf16 v[112:127], a[148:151], v[88:91], v[112:127]
    v_add_f32 v241, v241, v153
    v_cvt_pk_bf16_f32 v228, v152, v153
    v_exp_f32 v156, v156
    v_mfma_f32_32x32x16_bf16 v[128:143], a[148:151], v[92:95], v[128:143]
    v_exp_f32 v157, v157
    v_add_f32 v240, v240, v154
    v_mfma_f32_32x32x16_bf16 v[112:127], a[152:155], v[96:99], v[112:127]
    v_add_f32 v241, v241, v155
    v_cvt_pk_bf16_f32 v229, v154, v155
    v_exp_f32 v158, v158
    v_mfma_f32_32x32x16_bf16 v[128:143], a[152:155], v[100:103], v[128:143]
    v_exp_f32 v159, v159
    v_add_f32 v240, v240, v156
    v_mfma_f32_32x32x16_bf16 v[112:127], a[156:159], v[104:107], v[112:127]
    v_add_f32 v241, v241, v157
    v_cvt_pk_bf16_f32 v230, v156, v157
    v_exp_f32 v160, v160
    v_mfma_f32_32x32x16_bf16 v[128:143], a[156:159], v[108:111], v[128:143]
    v_exp_f32 v161, v161
    v_add_f32 v240, v240, v158
    s_waitcnt lgkmcnt(0)
    v_mfma_f32_32x32x16_bf16 a[0:15], a[160:163], v[208:211], a[0:15]
    ds_read_b128 a[128:131], v8 offset:40960
    s_mov_b32 s28, s56
    s_mov_b32 s29, s57
    s_mov_b32 s30, 0xe00000
    s_mov_b32 s31, 0x00020000
    s_xor_b32 s87, s71, 3
    v_mfma_f32_32x32x16_bf16 a[16:31], a[160:163], v[216:219], a[16:31]
    ds_read_b128 a[132:135], v9 offset:40960
    s_lshl_b32 s87, s87, 5
    s_add_u32 s87, s87, s81
    s_lshl_b32 s87, s87, 2
    s_and_b32 s85, s2, 3
    s_add_u32 s87, s87, s85
    v_mfma_f32_32x32x16_bf16 a[32:47], a[164:167], v[208:211], a[32:47]
    ds_read_b128 a[136:139], v10 offset:40960
    s_mul_i32 s87, s87, 8192
    s_add_u32 s87, s87, 12582912
    v_and_b32 v30, 31, v1
    v_min_u32 v30, 31, v30
    v_lshlrev_b32 v30, 7, v30
    v_mfma_f32_32x32x16_bf16 a[48:63], a[164:167], v[216:219], a[48:63]
    ds_read_b128 a[140:143], v11 offset:40960
    v_lshrrev_b32 v29, 5, v1
    v_mul_u32_u24 v29, 4096, v29
    v_add_u32 v30, v30, v29
    buffer_load_dword v31, v30, s[28:31], s87 offen
    v_add_f32 v241, v241, v159
    v_mfma_f32_32x32x16_bf16 a[64:79], a[168:171], v[208:211], a[64:79]
    v_cvt_pk_bf16_f32 v231, v158, v159
    v_exp_f32 v162, v162
    v_exp_f32 v163, v163
    v_add_f32 v242, v242, v160
    v_mfma_f32_32x32x16_bf16 a[80:95], a[168:171], v[216:219], a[80:95]
    ds_read_b128 a[144:147], v12 offset:40960
    v_add_f32 v243, v243, v161
    v_cvt_pk_bf16_f32 v232, v160, v161
    v_exp_f32 v164, v164
    v_mfma_f32_32x32x16_bf16 a[96:111], a[172:175], v[208:211], a[96:111]
    ds_read_b128 a[148:151], v13 offset:40960
    v_exp_f32 v165, v165
    v_add_f32 v242, v242, v162
    v_add_f32 v243, v243, v163
    v_cvt_pk_bf16_f32 v233, v162, v163
    v_mfma_f32_32x32x16_bf16 a[112:127], a[172:175], v[216:219], a[112:127]
    ds_read_b128 a[152:155], v14 offset:40960
    v_exp_f32 v166, v166
    v_exp_f32 v167, v167
    v_add_f32 v242, v242, v164
    v_add_f32 v243, v243, v165
    v_mfma_f32_32x32x16_bf16 a[0:15], a[176:179], v[212:215], a[0:15]
    ds_read_b128 a[156:159], v15 offset:40960
    v_cvt_pk_bf16_f32 v234, v164, v165
    v_exp_f32 v168, v168
    v_exp_f32 v169, v169
    v_mfma_f32_32x32x16_bf16 a[16:31], a[176:179], v[220:223], a[16:31]
    v_add_f32 v242, v242, v166
    v_add_f32 v243, v243, v167
    v_cvt_pk_bf16_f32 v235, v166, v167
    v_exp_f32 v170, v170
    v_mfma_f32_32x32x16_bf16 a[32:47], a[180:183], v[212:215], a[32:47]
    v_exp_f32 v171, v171
    v_add_f32 v242, v242, v168
    v_add_f32 v243, v243, v169
    v_cvt_pk_bf16_f32 v236, v168, v169
    v_exp_f32 v172, v172
    v_mfma_f32_32x32x16_bf16 a[48:63], a[180:183], v[220:223], a[48:63]
    v_exp_f32 v173, v173
    v_add_f32 v242, v242, v170
    v_add_f32 v243, v243, v171
    v_cvt_pk_bf16_f32 v237, v170, v171
    v_mfma_f32_32x32x16_bf16 a[64:79], a[184:187], v[212:215], a[64:79]
    v_exp_f32 v174, v174
    v_exp_f32 v175, v175
    v_add_f32 v242, v242, v172
    v_add_f32 v243, v243, v173
    v_mfma_f32_32x32x16_bf16 a[80:95], a[184:187], v[220:223], a[80:95]
    v_cvt_pk_bf16_f32 v238, v172, v173
    s_nop 0
    v_add_f32 v242, v242, v174
    v_mfma_f32_32x32x16_bf16 a[96:111], a[188:191], v[212:215], a[96:111]
    v_add_f32 v243, v243, v175
    v_cvt_pk_bf16_f32 v239, v174, v175
    v_mfma_f32_32x32x16_bf16 a[112:127], a[188:191], v[220:223], a[112:127]
    s_waitcnt lgkmcnt(0)
    s_waitcnt vmcnt(15)
    s_barrier
    v_mfma_f32_32x32x16_bf16 v[144:159], a[128:131], v[48:51], v[176:191]
    ds_read_b64_tr_b16 a[160:161], v16 offset:24576
    ds_read_b64_tr_b16 a[162:163], v16 offset:26624
    v_exp_f32 v112, v112
    v_exp_f32 v113, v113
    v_mfma_f32_32x32x16_bf16 v[160:175], a[128:131], v[52:55], v[192:207]
    ds_read_b64_tr_b16 a[164:165], v17 offset:24576
    ds_read_b64_tr_b16 a[166:167], v17 offset:26624
    v_exp_f32 v114, v114
    v_exp_f32 v115, v115
    v_mfma_f32_32x32x16_bf16 v[144:159], a[132:135], v[56:59], v[144:159]
    ds_read_b64_tr_b16 a[168:169], v18 offset:24576
    v_add_f32 v240, v240, v112
    v_add_f32 v241, v241, v113
    v_cvt_pk_bf16_f32 v208, v112, v113
    v_exp_f32 v116, v116
    v_mfma_f32_32x32x16_bf16 v[160:175], a[132:135], v[60:63], v[160:175]
    ds_read_b64_tr_b16 a[170:171], v18 offset:26624
    ds_read_b64_tr_b16 a[172:173], v19 offset:24576
    v_exp_f32 v117, v117
    v_add_f32 v240, v240, v114
    v_mfma_f32_32x32x16_bf16 v[144:159], a[136:139], v[64:67], v[144:159]
    ds_read_b64_tr_b16 a[174:175], v19 offset:26624
    v_add_f32 v241, v241, v115
    v_cvt_pk_bf16_f32 v209, v114, v115
    v_exp_f32 v118, v118
    v_mfma_f32_32x32x16_bf16 v[160:175], a[136:139], v[68:71], v[160:175]
    ds_read_b64_tr_b16 a[176:177], v16 offset:28672
    ds_read_b64_tr_b16 a[178:179], v16 offset:30720
    v_exp_f32 v119, v119
    v_add_f32 v240, v240, v116
    v_mfma_f32_32x32x16_bf16 v[144:159], a[140:143], v[72:75], v[144:159]
    ds_read_b64_tr_b16 a[180:181], v17 offset:28672
    ds_read_b64_tr_b16 a[182:183], v17 offset:30720
    v_add_f32 v241, v241, v117
    v_cvt_pk_bf16_f32 v210, v116, v117
    v_exp_f32 v120, v120
    v_mfma_f32_32x32x16_bf16 v[160:175], a[140:143], v[76:79], v[160:175]
    ds_read_b64_tr_b16 a[184:185], v18 offset:28672
    v_exp_f32 v121, v121
    v_add_f32 v240, v240, v118
    v_mfma_f32_32x32x16_bf16 v[144:159], a[144:147], v[80:83], v[144:159]
    ds_read_b64_tr_b16 a[186:187], v18 offset:30720
    ds_read_b64_tr_b16 a[188:189], v19 offset:28672
    v_add_f32 v241, v241, v119
    v_cvt_pk_bf16_f32 v211, v118, v119
    v_exp_f32 v122, v122
    v_mfma_f32_32x32x16_bf16 v[160:175], a[144:147], v[84:87], v[160:175]
    ds_read_b64_tr_b16 a[190:191], v19 offset:30720
    v_exp_f32 v123, v123
    v_add_f32 v240, v240, v120
    v_mfma_f32_32x32x16_bf16 v[144:159], a[148:151], v[88:91], v[144:159]
    v_add_f32 v241, v241, v121
    v_cvt_pk_bf16_f32 v212, v120, v121
    v_exp_f32 v124, v124
    v_mfma_f32_32x32x16_bf16 v[160:175], a[148:151], v[92:95], v[160:175]
    v_exp_f32 v125, v125
    v_add_f32 v240, v240, v122
    v_mfma_f32_32x32x16_bf16 v[144:159], a[152:155], v[96:99], v[144:159]
    v_add_f32 v241, v241, v123
    v_cvt_pk_bf16_f32 v213, v122, v123
    v_exp_f32 v126, v126
    v_mfma_f32_32x32x16_bf16 v[160:175], a[152:155], v[100:103], v[160:175]
    v_exp_f32 v127, v127
    v_add_f32 v240, v240, v124
    v_mfma_f32_32x32x16_bf16 v[144:159], a[156:159], v[104:107], v[144:159]
    v_add_f32 v241, v241, v125
    v_cvt_pk_bf16_f32 v214, v124, v125
    v_exp_f32 v128, v128
    v_mfma_f32_32x32x16_bf16 v[160:175], a[156:159], v[108:111], v[160:175]
    v_exp_f32 v129, v129
    v_add_f32 v240, v240, v126
    s_waitcnt lgkmcnt(0)
    v_mfma_f32_32x32x16_bf16 a[0:15], a[160:163], v[224:227], a[0:15]
    ds_read_b128 a[128:131], v8 offset:49152
    s_add_u32 m0, s68, 32768
    s_add_u32 s86, s68, 98304
    buffer_load_dwordx4 v20, s[16:19], s86 offen offset:0 lds
    v_add_f32 v241, v241, v127
    v_cvt_pk_bf16_f32 v215, v126, v127
    v_mfma_f32_32x32x16_bf16 a[16:31], a[160:163], v[232:235], a[16:31]
    ds_read_b128 a[132:135], v9 offset:49152
    buffer_load_dwordx4 v21, s[16:19], s86 offen offset:1024 lds
    v_exp_f32 v130, v130
    v_exp_f32 v131, v131
    v_mfma_f32_32x32x16_bf16 a[32:47], a[164:167], v[224:227], a[32:47]
    ds_read_b128 a[136:139], v10 offset:49152
    v_add_f32 v242, v242, v128
    v_add_f32 v243, v243, v129
    v_cvt_pk_bf16_f32 v216, v128, v129
    v_exp_f32 v132, v132
    v_mfma_f32_32x32x16_bf16 a[48:63], a[164:167], v[232:235], a[48:63]
    ds_read_b128 a[140:143], v11 offset:49152
    buffer_load_dwordx4 v22, s[16:19], s86 offen offset:2048 lds
    v_exp_f32 v133, v133
    v_add_f32 v242, v242, v130
    v_add_f32 v243, v243, v131
    v_mfma_f32_32x32x16_bf16 a[64:79], a[168:171], v[224:227], a[64:79]
    v_cvt_pk_bf16_f32 v217, v130, v131
    v_exp_f32 v134, v134
    v_exp_f32 v135, v135
    v_mfma_f32_32x32x16_bf16 a[80:95], a[168:171], v[232:235], a[80:95]
    ds_read_b128 a[144:147], v12 offset:49152
    buffer_load_dwordx4 v23, s[16:19], s86 offen offset:3072 lds
    v_add_f32 v242, v242, v132
    v_add_f32 v243, v243, v133
    v_cvt_pk_bf16_f32 v218, v132, v133
    v_mfma_f32_32x32x16_bf16 a[96:111], a[172:175], v[224:227], a[96:111]
    ds_read_b128 a[148:151], v13 offset:49152
    v_exp_f32 v136, v136
    v_exp_f32 v137, v137
    v_add_f32 v242, v242, v134
    v_mfma_f32_32x32x16_bf16 a[112:127], a[172:175], v[232:235], a[112:127]
    ds_read_b128 a[152:155], v14 offset:49152
    s_add_u32 m0, s68, 65536
    s_add_u32 s86, s68, 65536
    buffer_load_dwordx4 v24, s[20:23], s86 offen offset:0 lds
    v_add_f32 v243, v243, v135
    v_cvt_pk_bf16_f32 v219, v134, v135
    v_mfma_f32_32x32x16_bf16 a[0:15], a[176:179], v[228:231], a[0:15]
    ds_read_b128 a[156:159], v15 offset:49152
    buffer_load_dwordx4 v24, s[20:23], s86 offen offset:1024 lds
    v_exp_f32 v138, v138
    v_exp_f32 v139, v139
    v_add_f32 v242, v242, v136
    v_mfma_f32_32x32x16_bf16 a[16:31], a[176:179], v[236:239], a[16:31]
    v_add_f32 v243, v243, v137
    v_cvt_pk_bf16_f32 v220, v136, v137
    v_exp_f32 v140, v140
    v_mfma_f32_32x32x16_bf16 a[32:47], a[180:183], v[228:231], a[32:47]
    buffer_load_dwordx4 v24, s[20:23], s86 offen offset:2048 lds
    v_exp_f32 v141, v141
    v_add_f32 v242, v242, v138
    v_add_f32 v243, v243, v139
    v_mfma_f32_32x32x16_bf16 a[48:63], a[180:183], v[236:239], a[48:63]
    v_cvt_pk_bf16_f32 v221, v138, v139
    v_exp_f32 v142, v142
    v_mfma_f32_32x32x16_bf16 a[64:79], a[184:187], v[228:231], a[64:79]
    buffer_load_dwordx4 v24, s[20:23], s86 offen offset:3072 lds
    v_exp_f32 v143, v143
    v_add_f32 v242, v242, v140
    v_add_f32 v243, v243, v141
    v_mfma_f32_32x32x16_bf16 a[80:95], a[184:187], v[236:239], a[80:95]
    v_cvt_pk_bf16_f32 v222, v140, v141
    s_nop 0
    v_add_f32 v242, v242, v142
    v_mfma_f32_32x32x16_bf16 a[96:111], a[188:191], v[228:231], a[96:111]
    s_mov_b32 s28, s56
    s_mov_b32 s29, s57
    s_mov_b32 s30, 0x200000
    s_mov_b32 s31, 0x00020000
    s_xor_b32 s87, s71, 3
    s_lshl_b32 s87, s87, 5
    s_add_u32 s87, s87, s81
    v_mfma_f32_32x32x16_bf16 a[112:127], a[188:191], v[236:239], a[112:127]
    s_lshl_b32 s87, s87, 2
    s_and_b32 s85, s2, 3
    s_add_u32 s87, s87, s85
    s_mul_i32 s87, s87, 8192
    s_add_u32 s87, s87, 0
    v_and_b32 v30, 31, v1
    v_min_u32 v30, 31, v30
    v_lshlrev_b32 v30, 7, v30
    v_lshrrev_b32 v29, 5, v1
    v_mul_u32_u24 v29, 4096, v29
    v_add_u32 v30, v30, v29
    buffer_load_dword v31, v30, s[28:31], s87 offen
    v_add_f32 v243, v243, v143
    v_cvt_pk_bf16_f32 v223, v142, v143
    s_waitcnt lgkmcnt(0)
    v_mfma_f32_32x32x16_bf16 v[112:127], a[128:131], v[48:51], v[176:191]
    ds_read_b64_tr_b16 a[160:161], v16 offset:32768
    ds_read_b64_tr_b16 a[162:163], v16 offset:34816
    v_exp_f32 v144, v144
    v_exp_f32 v145, v145
    v_mfma_f32_32x32x16_bf16 v[128:143], a[128:131], v[52:55], v[192:207]
    ds_read_b64_tr_b16 a[164:165], v17 offset:32768
    ds_read_b64_tr_b16 a[166:167], v17 offset:34816
    v_exp_f32 v146, v146
    v_exp_f32 v147, v147
    v_mfma_f32_32x32x16_bf16 v[112:127], a[132:135], v[56:59], v[112:127]
    ds_read_b64_tr_b16 a[168:169], v18 offset:32768
    v_add_f32 v240, v240, v144
    v_add_f32 v241, v241, v145
    v_cvt_pk_bf16_f32 v224, v144, v145
    v_exp_f32 v148, v148
    v_mfma_f32_32x32x16_bf16 v[128:143], a[132:135], v[60:63], v[128:143]
    ds_read_b64_tr_b16 a[170:171], v18 offset:34816
    ds_read_b64_tr_b16 a[172:173], v19 offset:32768
    v_exp_f32 v149, v149
    v_add_f32 v240, v240, v146
    v_mfma_f32_32x32x16_bf16 v[112:127], a[136:139], v[64:67], v[112:127]
    ds_read_b64_tr_b16 a[174:175], v19 offset:34816
    v_add_f32 v241, v241, v147
    v_cvt_pk_bf16_f32 v225, v146, v147
    v_exp_f32 v150, v150
    v_mfma_f32_32x32x16_bf16 v[128:143], a[136:139], v[68:71], v[128:143]
    ds_read_b64_tr_b16 a[176:177], v16 offset:36864
    ds_read_b64_tr_b16 a[178:179], v16 offset:38912
    v_exp_f32 v151, v151
    v_add_f32 v240, v240, v148
    v_mfma_f32_32x32x16_bf16 v[112:127], a[140:143], v[72:75], v[112:127]
    ds_read_b64_tr_b16 a[180:181], v17 offset:36864
    ds_read_b64_tr_b16 a[182:183], v17 offset:38912
    v_add_f32 v241, v241, v149
    v_cvt_pk_bf16_f32 v226, v148, v149
    v_exp_f32 v152, v152
    v_mfma_f32_32x32x16_bf16 v[128:143], a[140:143], v[76:79], v[128:143]
    ds_read_b64_tr_b16 a[184:185], v18 offset:36864
    v_exp_f32 v153, v153
    v_add_f32 v240, v240, v150
    v_mfma_f32_32x32x16_bf16 v[112:127], a[144:147], v[80:83], v[112:127]
    ds_read_b64_tr_b16 a[186:187], v18 offset:38912
    ds_read_b64_tr_b16 a[188:189], v19 offset:36864
    v_add_f32 v241, v241, v151
    v_cvt_pk_bf16_f32 v227, v150, v151
    v_exp_f32 v154, v154
    v_mfma_f32_32x32x16_bf16 v[128:143], a[144:147], v[84:87], v[128:143]
    ds_read_b64_tr_b16 a[190:191], v19 offset:38912
    v_exp_f32 v155, v155
    v_add_f32 v240, v240, v152
    v_mfma_f32_32x32x16_bf16 v[112:127], a[148:151], v[88:91], v[112:127]
    v_add_f32 v241, v241, v153
    v_cvt_pk_bf16_f32 v228, v152, v153
    v_exp_f32 v156, v156
    v_mfma_f32_32x32x16_bf16 v[128:143], a[148:151], v[92:95], v[128:143]
    v_exp_f32 v157, v157
    v_add_f32 v240, v240, v154
    v_mfma_f32_32x32x16_bf16 v[112:127], a[152:155], v[96:99], v[112:127]
    v_add_f32 v241, v241, v155
    v_cvt_pk_bf16_f32 v229, v154, v155
    v_exp_f32 v158, v158
    v_mfma_f32_32x32x16_bf16 v[128:143], a[152:155], v[100:103], v[128:143]
    v_exp_f32 v159, v159
    v_add_f32 v240, v240, v156
    v_mfma_f32_32x32x16_bf16 v[112:127], a[156:159], v[104:107], v[112:127]
    v_add_f32 v241, v241, v157
    v_cvt_pk_bf16_f32 v230, v156, v157
    v_exp_f32 v160, v160
    v_mfma_f32_32x32x16_bf16 v[128:143], a[156:159], v[108:111], v[128:143]
    v_exp_f32 v161, v161
    v_add_f32 v240, v240, v158
    s_waitcnt lgkmcnt(0)
    v_mfma_f32_32x32x16_bf16 a[0:15], a[160:163], v[208:211], a[0:15]
    ds_read_b128 a[128:131], v8 offset:57344
    buffer_load_dwordx2 v[248:249], v26, s[36:39], 0 offen sc1
    v_add_f32 v241, v241, v159
    v_cvt_pk_bf16_f32 v231, v158, v159
    v_exp_f32 v162, v162
    v_mfma_f32_32x32x16_bf16 a[16:31], a[160:163], v[216:219], a[16:31]
    ds_read_b128 a[132:135], v9 offset:57344
    v_exp_f32 v163, v163
    v_add_f32 v242, v242, v160
    v_add_f32 v243, v243, v161
    v_mfma_f32_32x32x16_bf16 a[32:47], a[164:167], v[208:211], a[32:47]
    ds_read_b128 a[136:139], v10 offset:57344
    v_cvt_pk_bf16_f32 v232, v160, v161
    v_exp_f32 v164, v164
    v_exp_f32 v165, v165
    v_mfma_f32_32x32x16_bf16 a[48:63], a[164:167], v[216:219], a[48:63]
    ds_read_b128 a[140:143], v11 offset:57344
    v_add_f32 v242, v242, v162
    v_add_f32 v243, v243, v163
    v_mfma_f32_32x32x16_bf16 a[64:79], a[168:171], v[208:211], a[64:79]
    v_cvt_pk_bf16_f32 v233, v162, v163
    v_exp_f32 v166, v166
    v_exp_f32 v167, v167
    v_mfma_f32_32x32x16_bf16 a[80:95], a[168:171], v[216:219], a[80:95]
    ds_read_b128 a[144:147], v12 offset:57344
    v_add_f32 v242, v242, v164
    v_add_f32 v243, v243, v165
    v_cvt_pk_bf16_f32 v234, v164, v165
    v_mfma_f32_32x32x16_bf16 a[96:111], a[172:175], v[208:211], a[96:111]
    ds_read_b128 a[148:151], v13 offset:57344
    v_exp_f32 v168, v168
    v_exp_f32 v169, v169
    v_add_f32 v242, v242, v166
    v_mfma_f32_32x32x16_bf16 a[112:127], a[172:175], v[216:219], a[112:127]
    ds_read_b128 a[152:155], v14 offset:57344
    v_add_f32 v243, v243, v167
    v_cvt_pk_bf16_f32 v235, v166, v167
    v_mfma_f32_32x32x16_bf16 a[0:15], a[176:179], v[212:215], a[0:15]
    ds_read_b128 a[156:159], v15 offset:57344
    s_mov_b32 s28, s56
    s_mov_b32 s29, s57
    s_mov_b32 s30, 0x400000
    s_mov_b32 s31, 0x00020000
    s_xor_b32 s87, s71, 3
    s_lshl_b32 s87, s87, 5
    v_mfma_f32_32x32x16_bf16 a[16:31], a[176:179], v[220:223], a[16:31]
    s_add_u32 s87, s87, s81
    s_lshl_b32 s87, s87, 2
    s_and_b32 s85, s2, 3
    s_add_u32 s87, s87, s85
    s_mul_i32 s87, s87, 8192
    s_add_u32 s87, s87, 2097152
    v_mfma_f32_32x32x16_bf16 a[32:47], a[180:183], v[212:215], a[32:47]
    v_and_b32 v30, 31, v1
    v_min_u32 v30, 31, v30
    v_lshlrev_b32 v30, 7, v30
    v_lshrrev_b32 v29, 5, v1
    v_mul_u32_u24 v29, 4096, v29
    v_add_u32 v30, v30, v29
    v_mfma_f32_32x32x16_bf16 a[48:63], a[180:183], v[220:223], a[48:63]
    buffer_load_dword v31, v30, s[28:31], s87 offen
    v_exp_f32 v170, v170
    v_exp_f32 v171, v171
    v_add_f32 v242, v242, v168
    v_mfma_f32_32x32x16_bf16 a[64:79], a[184:187], v[212:215], a[64:79]
    v_add_f32 v243, v243, v169
    v_cvt_pk_bf16_f32 v236, v168, v169
    v_exp_f32 v172, v172
    v_exp_f32 v173, v173
    v_mfma_f32_32x32x16_bf16 a[80:95], a[184:187], v[220:223], a[80:95]
    v_add_f32 v242, v242, v170
    v_add_f32 v243, v243, v171
    v_cvt_pk_bf16_f32 v237, v170, v171
    v_exp_f32 v174, v174
    v_mfma_f32_32x32x16_bf16 a[96:111], a[188:191], v[212:215], a[96:111]
    v_exp_f32 v175, v175
    v_add_f32 v242, v242, v172
    v_add_f32 v243, v243, v173
    v_cvt_pk_bf16_f32 v238, v172, v173
    s_nop 0
    v_add_f32 v242, v242, v174
    v_mfma_f32_32x32x16_bf16 a[112:127], a[188:191], v[220:223], a[112:127]
    v_add_f32 v243, v243, v175
    v_cvt_pk_bf16_f32 v239, v174, v175
    s_waitcnt lgkmcnt(0)
    s_waitcnt vmcnt(17)
    s_barrier
    v_mfma_f32_32x32x16_bf16 v[144:159], a[128:131], v[48:51], v[176:191]
    ds_read_b64_tr_b16 a[160:161], v16 offset:40960
    ds_read_b64_tr_b16 a[162:163], v16 offset:43008
    v_exp_f32 v112, v112
    v_exp_f32 v113, v113
    v_mfma_f32_32x32x16_bf16 v[160:175], a[128:131], v[52:55], v[192:207]
    ds_read_b64_tr_b16 a[164:165], v17 offset:40960
    ds_read_b64_tr_b16 a[166:167], v17 offset:43008
    v_exp_f32 v114, v114
    v_exp_f32 v115, v115
    v_mfma_f32_32x32x16_bf16 v[144:159], a[132:135], v[56:59], v[144:159]
    ds_read_b64_tr_b16 a[168:169], v18 offset:40960
    v_add_f32 v240, v240, v112
    v_add_f32 v241, v241, v113
    v_cvt_pk_bf16_f32 v208, v112, v113
    v_exp_f32 v116, v116
    v_mfma_f32_32x32x16_bf16 v[160:175], a[132:135], v[60:63], v[160:175]
    ds_read_b64_tr_b16 a[170:171], v18 offset:43008
    ds_read_b64_tr_b16 a[172:173], v19 offset:40960
    v_exp_f32 v117, v117
    v_add_f32 v240, v240, v114
    v_mfma_f32_32x32x16_bf16 v[144:159], a[136:139], v[64:67], v[144:159]
    ds_read_b64_tr_b16 a[174:175], v19 offset:43008
    v_add_f32 v241, v241, v115
    v_cvt_pk_bf16_f32 v209, v114, v115
    v_exp_f32 v118, v118
    v_mfma_f32_32x32x16_bf16 v[160:175], a[136:139], v[68:71], v[160:175]
    ds_read_b64_tr_b16 a[176:177], v16 offset:45056
    ds_read_b64_tr_b16 a[178:179], v16 offset:47104
    v_exp_f32 v119, v119
    v_add_f32 v240, v240, v116
    v_mfma_f32_32x32x16_bf16 v[144:159], a[140:143], v[72:75], v[144:159]
    ds_read_b64_tr_b16 a[180:181], v17 offset:45056
    ds_read_b64_tr_b16 a[182:183], v17 offset:47104
    v_add_f32 v241, v241, v117
    v_cvt_pk_bf16_f32 v210, v116, v117
    v_exp_f32 v120, v120
    v_mfma_f32_32x32x16_bf16 v[160:175], a[140:143], v[76:79], v[160:175]
    ds_read_b64_tr_b16 a[184:185], v18 offset:45056
    v_exp_f32 v121, v121
    v_add_f32 v240, v240, v118
    v_mfma_f32_32x32x16_bf16 v[144:159], a[144:147], v[80:83], v[144:159]
    ds_read_b64_tr_b16 a[186:187], v18 offset:47104
    ds_read_b64_tr_b16 a[188:189], v19 offset:45056
    v_add_f32 v241, v241, v119
    v_cvt_pk_bf16_f32 v211, v118, v119
    v_exp_f32 v122, v122
    v_mfma_f32_32x32x16_bf16 v[160:175], a[144:147], v[84:87], v[160:175]
    ds_read_b64_tr_b16 a[190:191], v19 offset:47104
    v_exp_f32 v123, v123
    v_add_f32 v240, v240, v120
    v_mfma_f32_32x32x16_bf16 v[144:159], a[148:151], v[88:91], v[144:159]
    v_add_f32 v241, v241, v121
    v_cvt_pk_bf16_f32 v212, v120, v121
    v_exp_f32 v124, v124
    v_mfma_f32_32x32x16_bf16 v[160:175], a[148:151], v[92:95], v[160:175]
    v_exp_f32 v125, v125
    v_add_f32 v240, v240, v122
    v_mfma_f32_32x32x16_bf16 v[144:159], a[152:155], v[96:99], v[144:159]
    v_add_f32 v241, v241, v123
    v_cvt_pk_bf16_f32 v213, v122, v123
    v_exp_f32 v126, v126
    v_mfma_f32_32x32x16_bf16 v[160:175], a[152:155], v[100:103], v[160:175]
    v_exp_f32 v127, v127
    v_add_f32 v240, v240, v124
    v_mfma_f32_32x32x16_bf16 v[144:159], a[156:159], v[104:107], v[144:159]
    v_add_f32 v241, v241, v125
    v_cvt_pk_bf16_f32 v214, v124, v125
    v_exp_f32 v128, v128
    v_mfma_f32_32x32x16_bf16 v[160:175], a[156:159], v[108:111], v[160:175]
    v_exp_f32 v129, v129
    v_add_f32 v240, v240, v126
    s_waitcnt lgkmcnt(0)
    v_mfma_f32_32x32x16_bf16 a[0:15], a[160:163], v[224:227], a[0:15]
    ds_read_b128 a[128:131], v8 offset:0
    s_add_u32 m0, s68, 49152
    s_add_u32 s86, s68, 114688
    buffer_load_dwordx4 v20, s[16:19], s86 offen offset:0 lds
    v_add_f32 v241, v241, v127
    v_cvt_pk_bf16_f32 v215, v126, v127
    v_mfma_f32_32x32x16_bf16 a[16:31], a[160:163], v[232:235], a[16:31]
    ds_read_b128 a[132:135], v9 offset:0
    buffer_load_dwordx4 v21, s[16:19], s86 offen offset:1024 lds
    v_exp_f32 v130, v130
    v_exp_f32 v131, v131
    v_mfma_f32_32x32x16_bf16 a[32:47], a[164:167], v[224:227], a[32:47]
    ds_read_b128 a[136:139], v10 offset:0
    v_add_f32 v242, v242, v128
    v_add_f32 v243, v243, v129
    v_cvt_pk_bf16_f32 v216, v128, v129
    v_exp_f32 v132, v132
    v_mfma_f32_32x32x16_bf16 a[48:63], a[164:167], v[232:235], a[48:63]
    ds_read_b128 a[140:143], v11 offset:0
    buffer_load_dwordx4 v22, s[16:19], s86 offen offset:2048 lds
    v_exp_f32 v133, v133
    v_add_f32 v242, v242, v130
    v_add_f32 v243, v243, v131
    v_mfma_f32_32x32x16_bf16 a[64:79], a[168:171], v[224:227], a[64:79]
    v_cvt_pk_bf16_f32 v217, v130, v131
    v_exp_f32 v134, v134
    v_exp_f32 v135, v135
    v_mfma_f32_32x32x16_bf16 a[80:95], a[168:171], v[232:235], a[80:95]
    ds_read_b128 a[144:147], v12 offset:0
    buffer_load_dwordx4 v23, s[16:19], s86 offen offset:3072 lds
    v_add_f32 v242, v242, v132
    v_add_f32 v243, v243, v133
    v_cvt_pk_bf16_f32 v218, v132, v133
    v_mfma_f32_32x32x16_bf16 a[96:111], a[172:175], v[224:227], a[96:111]
    ds_read_b128 a[148:151], v13 offset:0
    v_exp_f32 v136, v136
    v_exp_f32 v137, v137
    v_add_f32 v242, v242, v134
    v_mfma_f32_32x32x16_bf16 a[112:127], a[172:175], v[232:235], a[112:127]
    ds_read_b128 a[152:155], v14 offset:0
    s_add_u32 m0, s68, 81920
    s_add_u32 s86, s68, 81920
    buffer_load_dwordx4 v24, s[20:23], s86 offen offset:0 lds
    v_add_f32 v243, v243, v135
    v_cvt_pk_bf16_f32 v219, v134, v135
    v_mfma_f32_32x32x16_bf16 a[0:15], a[176:179], v[228:231], a[0:15]
    ds_read_b128 a[156:159], v15 offset:0
    buffer_load_dwordx4 v24, s[20:23], s86 offen offset:1024 lds
    v_exp_f32 v138, v138
    v_exp_f32 v139, v139
    v_add_f32 v242, v242, v136
    v_mfma_f32_32x32x16_bf16 a[16:31], a[176:179], v[236:239], a[16:31]
    v_add_f32 v243, v243, v137
    v_cvt_pk_bf16_f32 v220, v136, v137
    v_exp_f32 v140, v140
    v_mfma_f32_32x32x16_bf16 a[32:47], a[180:183], v[228:231], a[32:47]
    buffer_load_dwordx4 v24, s[20:23], s86 offen offset:2048 lds
    v_exp_f32 v141, v141
    v_add_f32 v242, v242, v138
    v_add_f32 v243, v243, v139
    v_mfma_f32_32x32x16_bf16 a[48:63], a[180:183], v[236:239], a[48:63]
    v_cvt_pk_bf16_f32 v221, v138, v139
    v_exp_f32 v142, v142
    v_mfma_f32_32x32x16_bf16 a[64:79], a[184:187], v[228:231], a[64:79]
    buffer_load_dwordx4 v24, s[20:23], s86 offen offset:3072 lds
    v_exp_f32 v143, v143
    v_add_f32 v242, v242, v140
    v_add_f32 v243, v243, v141
    v_mfma_f32_32x32x16_bf16 a[80:95], a[184:187], v[236:239], a[80:95]
    v_cvt_pk_bf16_f32 v222, v140, v141
    s_nop 0
    v_add_f32 v242, v242, v142
    v_mfma_f32_32x32x16_bf16 a[96:111], a[188:191], v[228:231], a[96:111]
    s_mov_b32 s28, s56
    s_mov_b32 s29, s57
    s_mov_b32 s30, 0x600000
    s_mov_b32 s31, 0x00020000
    s_xor_b32 s87, s71, 3
    s_lshl_b32 s87, s87, 5
    s_add_u32 s87, s87, s81
    v_mfma_f32_32x32x16_bf16 a[112:127], a[188:191], v[236:239], a[112:127]
    s_lshl_b32 s87, s87, 2
    s_and_b32 s85, s2, 3
    s_add_u32 s87, s87, s85
    s_mul_i32 s87, s87, 8192
    s_add_u32 s87, s87, 4194304
    v_and_b32 v30, 31, v1
    v_min_u32 v30, 31, v30
    v_lshlrev_b32 v30, 7, v30
    v_lshrrev_b32 v29, 5, v1
    v_mul_u32_u24 v29, 4096, v29
    v_add_u32 v30, v30, v29
    buffer_load_dword v31, v30, s[28:31], s87 offen
    v_add_f32 v243, v243, v143
    v_cvt_pk_bf16_f32 v223, v142, v143
    s_waitcnt lgkmcnt(0)
    v_mfma_f32_32x32x16_bf16 v[112:127], a[128:131], v[48:51], v[176:191]
    ds_read_b64_tr_b16 a[160:161], v16 offset:49152
    ds_read_b64_tr_b16 a[162:163], v16 offset:51200
    v_exp_f32 v144, v144
    v_exp_f32 v145, v145
    v_mfma_f32_32x32x16_bf16 v[128:143], a[128:131], v[52:55], v[192:207]
    ds_read_b64_tr_b16 a[164:165], v17 offset:49152
    ds_read_b64_tr_b16 a[166:167], v17 offset:51200
    v_exp_f32 v146, v146
    v_exp_f32 v147, v147
    v_mfma_f32_32x32x16_bf16 v[112:127], a[132:135], v[56:59], v[112:127]
    ds_read_b64_tr_b16 a[168:169], v18 offset:49152
    v_add_f32 v240, v240, v144
    v_add_f32 v241, v241, v145
    v_cvt_pk_bf16_f32 v224, v144, v145
    v_exp_f32 v148, v148
    v_mfma_f32_32x32x16_bf16 v[128:143], a[132:135], v[60:63], v[128:143]
    ds_read_b64_tr_b16 a[170:171], v18 offset:51200
    ds_read_b64_tr_b16 a[172:173], v19 offset:49152
    v_exp_f32 v149, v149
    v_add_f32 v240, v240, v146
    v_mfma_f32_32x32x16_bf16 v[112:127], a[136:139], v[64:67], v[112:127]
    ds_read_b64_tr_b16 a[174:175], v19 offset:51200
    v_add_f32 v241, v241, v147
    v_cvt_pk_bf16_f32 v225, v146, v147
    v_exp_f32 v150, v150
    v_mfma_f32_32x32x16_bf16 v[128:143], a[136:139], v[68:71], v[128:143]
    ds_read_b64_tr_b16 a[176:177], v16 offset:53248
    ds_read_b64_tr_b16 a[178:179], v16 offset:55296
    v_exp_f32 v151, v151
    v_add_f32 v240, v240, v148
    v_mfma_f32_32x32x16_bf16 v[112:127], a[140:143], v[72:75], v[112:127]
    ds_read_b64_tr_b16 a[180:181], v17 offset:53248
    ds_read_b64_tr_b16 a[182:183], v17 offset:55296
    v_add_f32 v241, v241, v149
    v_cvt_pk_bf16_f32 v226, v148, v149
    v_exp_f32 v152, v152
    v_mfma_f32_32x32x16_bf16 v[128:143], a[140:143], v[76:79], v[128:143]
    ds_read_b64_tr_b16 a[184:185], v18 offset:53248
    v_exp_f32 v153, v153
    v_add_f32 v240, v240, v150
    v_mfma_f32_32x32x16_bf16 v[112:127], a[144:147], v[80:83], v[112:127]
    ds_read_b64_tr_b16 a[186:187], v18 offset:55296
    ds_read_b64_tr_b16 a[188:189], v19 offset:53248
    v_add_f32 v241, v241, v151
    v_cvt_pk_bf16_f32 v227, v150, v151
    v_exp_f32 v154, v154
    v_mfma_f32_32x32x16_bf16 v[128:143], a[144:147], v[84:87], v[128:143]
    ds_read_b64_tr_b16 a[190:191], v19 offset:55296
    v_exp_f32 v155, v155
    v_add_f32 v240, v240, v152
    v_mfma_f32_32x32x16_bf16 v[112:127], a[148:151], v[88:91], v[112:127]
    v_add_f32 v241, v241, v153
    v_cvt_pk_bf16_f32 v228, v152, v153
    v_exp_f32 v156, v156
    v_mfma_f32_32x32x16_bf16 v[128:143], a[148:151], v[92:95], v[128:143]
    v_exp_f32 v157, v157
    v_add_f32 v240, v240, v154
    v_mfma_f32_32x32x16_bf16 v[112:127], a[152:155], v[96:99], v[112:127]
    v_add_f32 v241, v241, v155
    v_cvt_pk_bf16_f32 v229, v154, v155
    v_exp_f32 v158, v158
    v_mfma_f32_32x32x16_bf16 v[128:143], a[152:155], v[100:103], v[128:143]
    v_exp_f32 v159, v159
    v_add_f32 v240, v240, v156
    v_mfma_f32_32x32x16_bf16 v[112:127], a[156:159], v[104:107], v[112:127]
    v_add_f32 v241, v241, v157
    v_cvt_pk_bf16_f32 v230, v156, v157
    v_exp_f32 v160, v160
    v_mfma_f32_32x32x16_bf16 v[128:143], a[156:159], v[108:111], v[128:143]
    v_exp_f32 v161, v161
    v_add_f32 v240, v240, v158
    s_waitcnt lgkmcnt(0)
    v_mfma_f32_32x32x16_bf16 a[0:15], a[160:163], v[208:211], a[0:15]
    ds_read_b128 a[128:131], v8 offset:8192
    s_mov_b32 s28, s48
    s_mov_b32 s29, s49
    s_mov_b32 s30, 0x600000
    s_mov_b32 s31, 0x00020000
    s_xor_b32 s87, s71, 3
    v_mfma_f32_32x32x16_bf16 a[16:31], a[160:163], v[216:219], a[16:31]
    ds_read_b128 a[132:135], v9 offset:8192
    s_lshl_b32 s87, s87, 5
    s_add_u32 s87, s87, s81
    s_lshl_b32 s87, s87, 2
    s_and_b32 s85, s2, 3
    s_add_u32 s87, s87, s85
    v_mfma_f32_32x32x16_bf16 a[32:47], a[164:167], v[208:211], a[32:47]
    ds_read_b128 a[136:139], v10 offset:8192
    s_mul_i32 s87, s87, 8192
    s_add_u32 s87, s87, 4194304
    v_and_b32 v30, 31, v1
    v_min_u32 v30, 31, v30
    v_lshlrev_b32 v30, 7, v30
    v_mfma_f32_32x32x16_bf16 a[48:63], a[164:167], v[216:219], a[48:63]
    ds_read_b128 a[140:143], v11 offset:8192
    v_lshrrev_b32 v29, 5, v1
    v_mul_u32_u24 v29, 4096, v29
    v_add_u32 v30, v30, v29
    buffer_load_dword v31, v30, s[28:31], s87 offen
    v_add_f32 v241, v241, v159
    v_mfma_f32_32x32x16_bf16 a[64:79], a[168:171], v[208:211], a[64:79]
    v_cvt_pk_bf16_f32 v231, v158, v159
    v_exp_f32 v162, v162
    v_exp_f32 v163, v163
    v_add_f32 v242, v242, v160
    v_mfma_f32_32x32x16_bf16 a[80:95], a[168:171], v[216:219], a[80:95]
    ds_read_b128 a[144:147], v12 offset:8192
    v_add_f32 v243, v243, v161
    v_cvt_pk_bf16_f32 v232, v160, v161
    v_exp_f32 v164, v164
    v_mfma_f32_32x32x16_bf16 a[96:111], a[172:175], v[208:211], a[96:111]
    ds_read_b128 a[148:151], v13 offset:8192
    v_exp_f32 v165, v165
    v_add_f32 v242, v242, v162
    v_add_f32 v243, v243, v163
    v_cvt_pk_bf16_f32 v233, v162, v163
    v_mfma_f32_32x32x16_bf16 a[112:127], a[172:175], v[216:219], a[112:127]
    ds_read_b128 a[152:155], v14 offset:8192
    v_exp_f32 v166, v166
    v_exp_f32 v167, v167
    v_add_f32 v242, v242, v164
    v_add_f32 v243, v243, v165
    v_mfma_f32_32x32x16_bf16 a[0:15], a[176:179], v[212:215], a[0:15]
    ds_read_b128 a[156:159], v15 offset:8192
    v_cvt_pk_bf16_f32 v234, v164, v165
    v_exp_f32 v168, v168
    v_exp_f32 v169, v169
    v_mfma_f32_32x32x16_bf16 a[16:31], a[176:179], v[220:223], a[16:31]
    v_add_f32 v242, v242, v166
    v_add_f32 v243, v243, v167
    v_cvt_pk_bf16_f32 v235, v166, v167
    v_exp_f32 v170, v170
    v_mfma_f32_32x32x16_bf16 a[32:47], a[180:183], v[212:215], a[32:47]
    v_exp_f32 v171, v171
    v_add_f32 v242, v242, v168
    v_add_f32 v243, v243, v169
    v_cvt_pk_bf16_f32 v236, v168, v169
    v_exp_f32 v172, v172
    v_mfma_f32_32x32x16_bf16 a[48:63], a[180:183], v[220:223], a[48:63]
    v_exp_f32 v173, v173
    v_add_f32 v242, v242, v170
    v_add_f32 v243, v243, v171
    v_cvt_pk_bf16_f32 v237, v170, v171
    v_mfma_f32_32x32x16_bf16 a[64:79], a[184:187], v[212:215], a[64:79]
    v_exp_f32 v174, v174
    v_exp_f32 v175, v175
    v_add_f32 v242, v242, v172
    v_add_f32 v243, v243, v173
    v_mfma_f32_32x32x16_bf16 a[80:95], a[184:187], v[220:223], a[80:95]
    v_cvt_pk_bf16_f32 v238, v172, v173
    s_nop 0
    v_add_f32 v242, v242, v174
    v_mfma_f32_32x32x16_bf16 a[96:111], a[188:191], v[212:215], a[96:111]
    v_add_f32 v243, v243, v175
    v_cvt_pk_bf16_f32 v239, v174, v175
    v_mfma_f32_32x32x16_bf16 a[112:127], a[188:191], v[220:223], a[112:127]
    s_waitcnt lgkmcnt(0)
    s_waitcnt vmcnt(13)
    s_barrier
    v_mfma_f32_32x32x16_bf16 v[144:159], a[128:131], v[48:51], v[176:191]
    ds_read_b64_tr_b16 a[160:161], v16 offset:57344
    ds_read_b64_tr_b16 a[162:163], v16 offset:59392
    v_exp_f32 v112, v112
    v_exp_f32 v113, v113
    v_mfma_f32_32x32x16_bf16 v[160:175], a[128:131], v[52:55], v[192:207]
    ds_read_b64_tr_b16 a[164:165], v17 offset:57344
    ds_read_b64_tr_b16 a[166:167], v17 offset:59392
    v_exp_f32 v114, v114
    v_exp_f32 v115, v115
    v_mfma_f32_32x32x16_bf16 v[144:159], a[132:135], v[56:59], v[144:159]
    ds_read_b64_tr_b16 a[168:169], v18 offset:57344
    v_add_f32 v240, v240, v112
    v_add_f32 v241, v241, v113
    v_cvt_pk_bf16_f32 v208, v112, v113
    v_exp_f32 v116, v116
    v_mfma_f32_32x32x16_bf16 v[160:175], a[132:135], v[60:63], v[160:175]
    ds_read_b64_tr_b16 a[170:171], v18 offset:59392
    ds_read_b64_tr_b16 a[172:173], v19 offset:57344
    v_exp_f32 v117, v117
    v_add_f32 v240, v240, v114
    v_mfma_f32_32x32x16_bf16 v[144:159], a[136:139], v[64:67], v[144:159]
    ds_read_b64_tr_b16 a[174:175], v19 offset:59392
    v_add_f32 v241, v241, v115
    v_cvt_pk_bf16_f32 v209, v114, v115
    v_exp_f32 v118, v118
    v_mfma_f32_32x32x16_bf16 v[160:175], a[136:139], v[68:71], v[160:175]
    ds_read_b64_tr_b16 a[176:177], v16 offset:61440
    ds_read_b64_tr_b16 a[178:179], v16 offset:63488
    v_exp_f32 v119, v119
    v_add_f32 v240, v240, v116
    v_mfma_f32_32x32x16_bf16 v[144:159], a[140:143], v[72:75], v[144:159]
    ds_read_b64_tr_b16 a[180:181], v17 offset:61440
    ds_read_b64_tr_b16 a[182:183], v17 offset:63488
    v_add_f32 v241, v241, v117
    v_cvt_pk_bf16_f32 v210, v116, v117
    v_exp_f32 v120, v120
    v_mfma_f32_32x32x16_bf16 v[160:175], a[140:143], v[76:79], v[160:175]
    ds_read_b64_tr_b16 a[184:185], v18 offset:61440
    v_exp_f32 v121, v121
    v_add_f32 v240, v240, v118
    v_mfma_f32_32x32x16_bf16 v[144:159], a[144:147], v[80:83], v[144:159]
    ds_read_b64_tr_b16 a[186:187], v18 offset:63488
    ds_read_b64_tr_b16 a[188:189], v19 offset:61440
    v_add_f32 v241, v241, v119
    v_cvt_pk_bf16_f32 v211, v118, v119
    v_exp_f32 v122, v122
    v_mfma_f32_32x32x16_bf16 v[160:175], a[144:147], v[84:87], v[160:175]
    ds_read_b64_tr_b16 a[190:191], v19 offset:63488
    v_exp_f32 v123, v123
    v_add_f32 v240, v240, v120
    v_mfma_f32_32x32x16_bf16 v[144:159], a[148:151], v[88:91], v[144:159]
    v_add_f32 v241, v241, v121
    v_cvt_pk_bf16_f32 v212, v120, v121
    v_exp_f32 v124, v124
    v_mfma_f32_32x32x16_bf16 v[160:175], a[148:151], v[92:95], v[160:175]
    v_exp_f32 v125, v125
    v_add_f32 v240, v240, v122
    v_mfma_f32_32x32x16_bf16 v[144:159], a[152:155], v[96:99], v[144:159]
    v_add_f32 v241, v241, v123
    v_cvt_pk_bf16_f32 v213, v122, v123
    v_exp_f32 v126, v126
    v_mfma_f32_32x32x16_bf16 v[160:175], a[152:155], v[100:103], v[160:175]
    v_exp_f32 v127, v127
    v_add_f32 v240, v240, v124
    v_mfma_f32_32x32x16_bf16 v[144:159], a[156:159], v[104:107], v[144:159]
    v_add_f32 v241, v241, v125
    v_cvt_pk_bf16_f32 v214, v124, v125
    v_exp_f32 v128, v128
    v_mfma_f32_32x32x16_bf16 v[160:175], a[156:159], v[108:111], v[160:175]
    v_exp_f32 v129, v129
    v_add_f32 v240, v240, v126
    s_waitcnt lgkmcnt(0)
    v_mfma_f32_32x32x16_bf16 a[0:15], a[160:163], v[224:227], a[0:15]
    ds_read_b128 a[128:131], v8 offset:16384
    s_add_u32 m0, s68, 98304
    s_add_u32 s86, s68, 98304
    buffer_load_dwordx4 v24, s[20:23], s86 offen offset:0 lds
    v_add_f32 v241, v241, v127
    v_cvt_pk_bf16_f32 v215, v126, v127
    v_mfma_f32_32x32x16_bf16 a[16:31], a[160:163], v[232:235], a[16:31]
    ds_read_b128 a[132:135], v9 offset:16384
    v_exp_f32 v130, v130
    v_exp_f32 v131, v131
    v_add_f32 v242, v242, v128
    v_mfma_f32_32x32x16_bf16 a[32:47], a[164:167], v[224:227], a[32:47]
    ds_read_b128 a[136:139], v10 offset:16384
    v_add_f32 v243, v243, v129
    v_cvt_pk_bf16_f32 v216, v128, v129
    v_exp_f32 v132, v132
    v_mfma_f32_32x32x16_bf16 a[48:63], a[164:167], v[232:235], a[48:63]
    ds_read_b128 a[140:143], v11 offset:16384
    buffer_load_dwordx4 v24, s[20:23], s86 offen offset:1024 lds
    v_exp_f32 v133, v133
    v_add_f32 v242, v242, v130
    v_add_f32 v243, v243, v131
    v_mfma_f32_32x32x16_bf16 a[64:79], a[168:171], v[224:227], a[64:79]
    v_cvt_pk_bf16_f32 v217, v130, v131
    v_exp_f32 v134, v134
    v_exp_f32 v135, v135
    v_mfma_f32_32x32x16_bf16 a[80:95], a[168:171], v[232:235], a[80:95]
    ds_read_b128 a[144:147], v12 offset:16384
    v_add_f32 v242, v242, v132
    v_add_f32 v243, v243, v133
    v_cvt_pk_bf16_f32 v218, v132, v133
    v_mfma_f32_32x32x16_bf16 a[96:111], a[172:175], v[224:227], a[96:111]
    ds_read_b128 a[148:151], v13 offset:16384
    buffer_load_dwordx4 v24, s[20:23], s86 offen offset:2048 lds
    v_exp_f32 v136, v136
    v_exp_f32 v137, v137
    v_add_f32 v242, v242, v134
    v_mfma_f32_32x32x16_bf16 a[112:127], a[172:175], v[232:235], a[112:127]
    ds_read_b128 a[152:155], v14 offset:16384
    v_add_f32 v243, v243, v135
    v_cvt_pk_bf16_f32 v219, v134, v135
    v_mfma_f32_32x32x16_bf16 a[0:15], a[176:179], v[228:231], a[0:15]
    ds_read_b128 a[156:159], v15 offset:16384
    v_exp_f32 v138, v138
    v_exp_f32 v139, v139
    v_add_f32 v242, v242, v136
    v_mfma_f32_32x32x16_bf16 a[16:31], a[176:179], v[236:239], a[16:31]
    buffer_load_dwordx4 v24, s[20:23], s86 offen offset:3072 lds
    v_add_f32 v243, v243, v137
    v_cvt_pk_bf16_f32 v220, v136, v137
    v_exp_f32 v140, v140
    v_mfma_f32_32x32x16_bf16 a[32:47], a[180:183], v[228:231], a[32:47]
    v_exp_f32 v141, v141
    v_add_f32 v242, v242, v138
    v_add_f32 v243, v243, v139
    v_mfma_f32_32x32x16_bf16 a[48:63], a[180:183], v[236:239], a[48:63]
    v_cvt_pk_bf16_f32 v221, v138, v139
    v_exp_f32 v142, v142
    v_mfma_f32_32x32x16_bf16 a[64:79], a[184:187], v[228:231], a[64:79]
    s_mov_b32 s28, s56
    s_mov_b32 s29, s57
    s_mov_b32 s30, 0x800000
    s_mov_b32 s31, 0x00020000
    s_xor_b32 s87, s71, 3
    s_lshl_b32 s87, s87, 5
    s_add_u32 s87, s87, s81
    v_mfma_f32_32x32x16_bf16 a[80:95], a[184:187], v[236:239], a[80:95]
    s_lshl_b32 s87, s87, 2
    s_and_b32 s85, s2, 3
    s_add_u32 s87, s87, s85
    s_mul_i32 s87, s87, 8192
    s_add_u32 s87, s87, 6291456
    v_and_b32 v30, 31, v1
    v_mfma_f32_32x32x16_bf16 a[96:111], a[188:191], v[228:231], a[96:111]
    v_min_u32 v30, 31, v30
    v_lshlrev_b32 v30, 7, v30
    v_lshrrev_b32 v29, 5, v1
    v_mul_u32_u24 v29, 4096, v29
    v_add_u32 v30, v30, v29
    buffer_load_dword v31, v30, s[28:31], s87 offen
    v_mfma_f32_32x32x16_bf16 a[112:127], a[188:191], v[236:239], a[112:127]
    v_exp_f32 v143, v143
    v_add_f32 v242, v242, v140
    v_add_f32 v243, v243, v141
    v_cvt_pk_bf16_f32 v222, v140, v141
    s_nop 0
    v_add_f32 v242, v242, v142
    v_add_f32 v243, v243, v143
    v_cvt_pk_bf16_f32 v223, v142, v143
    s_waitcnt lgkmcnt(0)
    v_mfma_f32_32x32x16_bf16 v[112:127], a[128:131], v[48:51], v[176:191]
    ds_read_b64_tr_b16 a[160:161], v16 offset:0
    ds_read_b64_tr_b16 a[162:163], v16 offset:2048
    v_exp_f32 v144, v144
    v_exp_f32 v145, v145
    v_mfma_f32_32x32x16_bf16 v[128:143], a[128:131], v[52:55], v[192:207]
    ds_read_b64_tr_b16 a[164:165], v17 offset:0
    ds_read_b64_tr_b16 a[166:167], v17 offset:2048
    v_exp_f32 v146, v146
    v_exp_f32 v147, v147
    v_mfma_f32_32x32x16_bf16 v[112:127], a[132:135], v[56:59], v[112:127]
    ds_read_b64_tr_b16 a[168:169], v18 offset:0
    v_add_f32 v240, v240, v144
    v_add_f32 v241, v241, v145
    v_cvt_pk_bf16_f32 v224, v144, v145
    v_exp_f32 v148, v148
    v_mfma_f32_32x32x16_bf16 v[128:143], a[132:135], v[60:63], v[128:143]
    ds_read_b64_tr_b16 a[170:171], v18 offset:2048
    ds_read_b64_tr_b16 a[172:173], v19 offset:0
    v_exp_f32 v149, v149
    v_add_f32 v240, v240, v146
    v_mfma_f32_32x32x16_bf16 v[112:127], a[136:139], v[64:67], v[112:127]
    ds_read_b64_tr_b16 a[174:175], v19 offset:2048
    v_add_f32 v241, v241, v147
    v_cvt_pk_bf16_f32 v225, v146, v147
    v_exp_f32 v150, v150
    v_mfma_f32_32x32x16_bf16 v[128:143], a[136:139], v[68:71], v[128:143]
    ds_read_b64_tr_b16 a[176:177], v16 offset:4096
    ds_read_b64_tr_b16 a[178:179], v16 offset:6144
    v_exp_f32 v151, v151
    v_add_f32 v240, v240, v148
    v_mfma_f32_32x32x16_bf16 v[112:127], a[140:143], v[72:75], v[112:127]
    ds_read_b64_tr_b16 a[180:181], v17 offset:4096
    ds_read_b64_tr_b16 a[182:183], v17 offset:6144
    v_add_f32 v241, v241, v149
    v_cvt_pk_bf16_f32 v226, v148, v149
    v_exp_f32 v152, v152
    v_mfma_f32_32x32x16_bf16 v[128:143], a[140:143], v[76:79], v[128:143]
    ds_read_b64_tr_b16 a[184:185], v18 offset:4096
    v_exp_f32 v153, v153
    v_add_f32 v240, v240, v150
    v_mfma_f32_32x32x16_bf16 v[112:127], a[144:147], v[80:83], v[112:127]
    ds_read_b64_tr_b16 a[186:187], v18 offset:6144
    ds_read_b64_tr_b16 a[188:189], v19 offset:4096
    v_add_f32 v241, v241, v151
    v_cvt_pk_bf16_f32 v227, v150, v151
    v_exp_f32 v154, v154
    v_mfma_f32_32x32x16_bf16 v[128:143], a[144:147], v[84:87], v[128:143]
    ds_read_b64_tr_b16 a[190:191], v19 offset:6144
    v_exp_f32 v155, v155
    v_add_f32 v240, v240, v152
    v_mfma_f32_32x32x16_bf16 v[112:127], a[148:151], v[88:91], v[112:127]
    v_add_f32 v241, v241, v153
    v_cvt_pk_bf16_f32 v228, v152, v153
    v_exp_f32 v156, v156
    v_mfma_f32_32x32x16_bf16 v[128:143], a[148:151], v[92:95], v[128:143]
    v_exp_f32 v157, v157
    v_add_f32 v240, v240, v154
    v_mfma_f32_32x32x16_bf16 v[112:127], a[152:155], v[96:99], v[112:127]
    v_add_f32 v241, v241, v155
    v_cvt_pk_bf16_f32 v229, v154, v155
    v_exp_f32 v158, v158
    v_mfma_f32_32x32x16_bf16 v[128:143], a[152:155], v[100:103], v[128:143]
    v_exp_f32 v159, v159
    v_add_f32 v240, v240, v156
    v_mfma_f32_32x32x16_bf16 v[112:127], a[156:159], v[104:107], v[112:127]
    v_add_f32 v241, v241, v157
    v_cvt_pk_bf16_f32 v230, v156, v157
    v_exp_f32 v160, v160
    v_mfma_f32_32x32x16_bf16 v[128:143], a[156:159], v[108:111], v[128:143]
    v_exp_f32 v161, v161
    v_add_f32 v240, v240, v158
    s_waitcnt lgkmcnt(0)
    v_mfma_f32_32x32x16_bf16 a[0:15], a[160:163], v[208:211], a[0:15]
    ds_read_b128 a[128:131], v8 offset:24576
    s_mov_b32 s28, s48
    s_mov_b32 s29, s49
    s_mov_b32 s30, 0x800000
    s_mov_b32 s31, 0x00020000
    s_xor_b32 s87, s71, 3
    v_mfma_f32_32x32x16_bf16 a[16:31], a[160:163], v[216:219], a[16:31]
    ds_read_b128 a[132:135], v9 offset:24576
    s_lshl_b32 s87, s87, 5
    s_add_u32 s87, s87, s81
    s_lshl_b32 s87, s87, 2
    s_and_b32 s85, s2, 3
    s_add_u32 s87, s87, s85
    v_mfma_f32_32x32x16_bf16 a[32:47], a[164:167], v[208:211], a[32:47]
    ds_read_b128 a[136:139], v10 offset:24576
    s_mul_i32 s87, s87, 8192
    s_add_u32 s87, s87, 6291456
    v_and_b32 v30, 31, v1
    v_min_u32 v30, 31, v30
    v_lshlrev_b32 v30, 7, v30
    v_mfma_f32_32x32x16_bf16 a[48:63], a[164:167], v[216:219], a[48:63]
    ds_read_b128 a[140:143], v11 offset:24576
    v_lshrrev_b32 v29, 5, v1
    v_mul_u32_u24 v29, 4096, v29
    v_add_u32 v30, v30, v29
    buffer_load_dword v31, v30, s[28:31], s87 offen
    v_add_f32 v241, v241, v159
    v_mfma_f32_32x32x16_bf16 a[64:79], a[168:171], v[208:211], a[64:79]
    v_cvt_pk_bf16_f32 v231, v158, v159
    v_exp_f32 v162, v162
    v_exp_f32 v163, v163
    v_add_f32 v242, v242, v160
    v_mfma_f32_32x32x16_bf16 a[80:95], a[168:171], v[216:219], a[80:95]
    ds_read_b128 a[144:147], v12 offset:24576
    v_add_f32 v243, v243, v161
    v_cvt_pk_bf16_f32 v232, v160, v161
    v_exp_f32 v164, v164
    v_mfma_f32_32x32x16_bf16 a[96:111], a[172:175], v[208:211], a[96:111]
    ds_read_b128 a[148:151], v13 offset:24576
    v_exp_f32 v165, v165
    v_add_f32 v242, v242, v162
    v_add_f32 v243, v243, v163
    v_cvt_pk_bf16_f32 v233, v162, v163
    v_mfma_f32_32x32x16_bf16 a[112:127], a[172:175], v[216:219], a[112:127]
    ds_read_b128 a[152:155], v14 offset:24576
    v_exp_f32 v166, v166
    v_exp_f32 v167, v167
    v_add_f32 v242, v242, v164
    v_add_f32 v243, v243, v165
    v_mfma_f32_32x32x16_bf16 a[0:15], a[176:179], v[212:215], a[0:15]
    ds_read_b128 a[156:159], v15 offset:24576
    v_cvt_pk_bf16_f32 v234, v164, v165
    v_exp_f32 v168, v168
    v_exp_f32 v169, v169
    v_mfma_f32_32x32x16_bf16 a[16:31], a[176:179], v[220:223], a[16:31]
    v_add_f32 v242, v242, v166
    v_add_f32 v243, v243, v167
    v_cvt_pk_bf16_f32 v235, v166, v167
    v_exp_f32 v170, v170
    v_mfma_f32_32x32x16_bf16 a[32:47], a[180:183], v[212:215], a[32:47]
    v_exp_f32 v171, v171
    v_add_f32 v242, v242, v168
    v_add_f32 v243, v243, v169
    v_cvt_pk_bf16_f32 v236, v168, v169
    v_exp_f32 v172, v172
    v_mfma_f32_32x32x16_bf16 a[48:63], a[180:183], v[220:223], a[48:63]
    v_exp_f32 v173, v173
    v_add_f32 v242, v242, v170
    v_add_f32 v243, v243, v171
    v_cvt_pk_bf16_f32 v237, v170, v171
    v_mfma_f32_32x32x16_bf16 a[64:79], a[184:187], v[212:215], a[64:79]
    v_exp_f32 v174, v174
    v_exp_f32 v175, v175
    v_add_f32 v242, v242, v172
    v_add_f32 v243, v243, v173
    v_mfma_f32_32x32x16_bf16 a[80:95], a[184:187], v[220:223], a[80:95]
    v_cvt_pk_bf16_f32 v238, v172, v173
    s_nop 0
    v_add_f32 v242, v242, v174
    v_mfma_f32_32x32x16_bf16 a[96:111], a[188:191], v[212:215], a[96:111]
    v_add_f32 v243, v243, v175
    v_cvt_pk_bf16_f32 v239, v174, v175
    v_mfma_f32_32x32x16_bf16 a[112:127], a[188:191], v[220:223], a[112:127]
    s_waitcnt lgkmcnt(0)
    s_waitcnt vmcnt(8)
    s_barrier
    s_mov_b32 s83, 0
km_pua_chk:
    v_cmp_ne_u64 vcc, s[50:51], v[248:249]
    s_add_u32 s83, s83, 1
    s_cbranch_vccz km_pua_ok
    s_cmp_gt_u32 s83, 0x20000
    s_cbranch_scc1 km_pua_ok
    s_sleep 2
    buffer_load_dwordx2 v[248:249], v26, s[36:39], 0 offen sc1
    s_waitcnt vmcnt(0)
    s_branch km_pua_chk
km_pua_ok:
    v_mfma_f32_32x32x16_bf16 v[144:159], a[128:131], v[48:51], v[176:191]
    ds_read_b64_tr_b16 a[160:161], v16 offset:8192
    ds_read_b64_tr_b16 a[162:163], v16 offset:10240
    v_exp_f32 v112, v112
    v_exp_f32 v113, v113
    v_mfma_f32_32x32x16_bf16 v[160:175], a[128:131], v[52:55], v[192:207]
    ds_read_b64_tr_b16 a[164:165], v17 offset:8192
    ds_read_b64_tr_b16 a[166:167], v17 offset:10240
    v_exp_f32 v114, v114
    v_exp_f32 v115, v115
    v_mfma_f32_32x32x16_bf16 v[144:159], a[132:135], v[56:59], v[144:159]
    ds_read_b64_tr_b16 a[168:169], v18 offset:8192
    v_add_f32 v240, v240, v112
    v_add_f32 v241, v241, v113
    v_cvt_pk_bf16_f32 v208, v112, v113
    v_exp_f32 v116, v116
    v_mfma_f32_32x32x16_bf16 v[160:175], a[132:135], v[60:63], v[160:175]
    ds_read_b64_tr_b16 a[170:171], v18 offset:10240
    ds_read_b64_tr_b16 a[172:173], v19 offset:8192
    v_exp_f32 v117, v117
    v_add_f32 v240, v240, v114
    v_mfma_f32_32x32x16_bf16 v[144:159], a[136:139], v[64:67], v[144:159]
    ds_read_b64_tr_b16 a[174:175], v19 offset:10240
    v_add_f32 v241, v241, v115
    v_cvt_pk_bf16_f32 v209, v114, v115
    v_exp_f32 v118, v118
    v_mfma_f32_32x32x16_bf16 v[160:175], a[136:139], v[68:71], v[160:175]
    ds_read_b64_tr_b16 a[176:177], v16 offset:12288
    ds_read_b64_tr_b16 a[178:179], v16 offset:14336
    v_exp_f32 v119, v119
    v_add_f32 v240, v240, v116
    v_mfma_f32_32x32x16_bf16 v[144:159], a[140:143], v[72:75], v[144:159]
    ds_read_b64_tr_b16 a[180:181], v17 offset:12288
    ds_read_b64_tr_b16 a[182:183], v17 offset:14336
    v_add_f32 v241, v241, v117
    v_cvt_pk_bf16_f32 v210, v116, v117
    v_exp_f32 v120, v120
    v_mfma_f32_32x32x16_bf16 v[160:175], a[140:143], v[76:79], v[160:175]
    ds_read_b64_tr_b16 a[184:185], v18 offset:12288
    v_exp_f32 v121, v121
    v_add_f32 v240, v240, v118
    v_mfma_f32_32x32x16_bf16 v[144:159], a[144:147], v[80:83], v[144:159]
    ds_read_b64_tr_b16 a[186:187], v18 offset:14336
    ds_read_b64_tr_b16 a[188:189], v19 offset:12288
    v_add_f32 v241, v241, v119
    v_cvt_pk_bf16_f32 v211, v118, v119
    v_exp_f32 v122, v122
    v_mfma_f32_32x32x16_bf16 v[160:175], a[144:147], v[84:87], v[160:175]
    ds_read_b64_tr_b16 a[190:191], v19 offset:14336
    v_exp_f32 v123, v123
    v_add_f32 v240, v240, v120
    v_mfma_f32_32x32x16_bf16 v[144:159], a[148:151], v[88:91], v[144:159]
    v_add_f32 v241, v241, v121
    v_cvt_pk_bf16_f32 v212, v120, v121
    v_exp_f32 v124, v124
    v_mfma_f32_32x32x16_bf16 v[160:175], a[148:151], v[92:95], v[160:175]
    v_exp_f32 v125, v125
    v_add_f32 v240, v240, v122
    v_mfma_f32_32x32x16_bf16 v[144:159], a[152:155], v[96:99], v[144:159]
    v_add_f32 v241, v241, v123
    v_cvt_pk_bf16_f32 v213, v122, v123
    v_exp_f32 v126, v126
    v_mfma_f32_32x32x16_bf16 v[160:175], a[152:155], v[100:103], v[160:175]
    v_exp_f32 v127, v127
    v_add_f32 v240, v240, v124
    v_mfma_f32_32x32x16_bf16 v[144:159], a[156:159], v[104:107], v[144:159]
    v_add_f32 v241, v241, v125
    v_cvt_pk_bf16_f32 v214, v124, v125
    v_exp_f32 v128, v128
    v_mfma_f32_32x32x16_bf16 v[160:175], a[156:159], v[108:111], v[160:175]
    v_exp_f32 v129, v129
    v_add_f32 v240, v240, v126
    s_waitcnt lgkmcnt(0)
    v_mfma_f32_32x32x16_bf16 a[0:15], a[160:163], v[224:227], a[0:15]
    ds_read_b128 a[128:131], v8 offset:32768
    s_add_u32 m0, s68, 114688
    s_add_u32 s86, s68, 114688
    buffer_load_dwordx4 v24, s[20:23], s86 offen offset:0 lds
    v_add_f32 v241, v241, v127
    v_cvt_pk_bf16_f32 v215, v126, v127
    v_mfma_f32_32x32x16_bf16 a[16:31], a[160:163], v[232:235], a[16:31]
    ds_read_b128 a[132:135], v9 offset:32768
    v_exp_f32 v130, v130
    v_exp_f32 v131, v131
    v_add_f32 v242, v242, v128
    v_mfma_f32_32x32x16_bf16 a[32:47], a[164:167], v[224:227], a[32:47]
    ds_read_b128 a[136:139], v10 offset:32768
    v_add_f32 v243, v243, v129
    v_cvt_pk_bf16_f32 v216, v128, v129
    v_exp_f32 v132, v132
    v_mfma_f32_32x32x16_bf16 a[48:63], a[164:167], v[232:235], a[48:63]
    ds_read_b128 a[140:143], v11 offset:32768
    v_exp_f32 v133, v133
    v_add_f32 v242, v242, v130
    v_add_f32 v243, v243, v131
    v_mfma_f32_32x32x16_bf16 a[64:79], a[168:171], v[224:227], a[64:79]
    buffer_load_dwordx4 v24, s[20:23], s86 offen offset:1024 lds
    v_cvt_pk_bf16_f32 v217, v130, v131
    v_exp_f32 v134, v134
    v_exp_f32 v135, v135
    v_mfma_f32_32x32x16_bf16 a[80:95], a[168:171], v[232:235], a[80:95]
    ds_read_b128 a[144:147], v12 offset:32768
    v_add_f32 v242, v242, v132
    v_add_f32 v243, v243, v133
    v_cvt_pk_bf16_f32 v218, v132, v133
    v_mfma_f32_32x32x16_bf16 a[96:111], a[172:175], v[224:227], a[96:111]
    ds_read_b128 a[148:151], v13 offset:32768
    v_exp_f32 v136, v136
    v_exp_f32 v137, v137
    v_add_f32 v242, v242, v134
    v_mfma_f32_32x32x16_bf16 a[112:127], a[172:175], v[232:235], a[112:127]
    ds_read_b128 a[152:155], v14 offset:32768
    v_add_f32 v243, v243, v135
    v_cvt_pk_bf16_f32 v219, v134, v135
    v_mfma_f32_32x32x16_bf16 a[0:15], a[176:179], v[228:231], a[0:15]
    ds_read_b128 a[156:159], v15 offset:32768
    buffer_load_dwordx4 v24, s[20:23], s86 offen offset:2048 lds
    v_exp_f32 v138, v138
    v_exp_f32 v139, v139
    v_add_f32 v242, v242, v136
    v_mfma_f32_32x32x16_bf16 a[16:31], a[176:179], v[236:239], a[16:31]
    v_add_f32 v243, v243, v137
    v_cvt_pk_bf16_f32 v220, v136, v137
    v_exp_f32 v140, v140
    v_mfma_f32_32x32x16_bf16 a[32:47], a[180:183], v[228:231], a[32:47]
    v_exp_f32 v141, v141
    v_add_f32 v242, v242, v138
    v_add_f32 v243, v243, v139
    v_mfma_f32_32x32x16_bf16 a[48:63], a[180:183], v[236:239], a[48:63]
    v_cvt_pk_bf16_f32 v221, v138, v139
    v_exp_f32 v142, v142
    v_mfma_f32_32x32x16_bf16 a[64:79], a[184:187], v[228:231], a[64:79]
    buffer_load_dwordx4 v24, s[20:23], s86 offen offset:3072 lds
    v_exp_f32 v143, v143
    v_add_f32 v242, v242, v140
    v_add_f32 v243, v243, v141
    v_mfma_f32_32x32x16_bf16 a[80:95], a[184:187], v[236:239], a[80:95]
    v_cvt_pk_bf16_f32 v222, v140, v141
    s_nop 0
    v_add_f32 v242, v242, v142
    v_mfma_f32_32x32x16_bf16 a[96:111], a[188:191], v[228:231], a[96:111]
    v_add_f32 v243, v243, v143
    v_cvt_pk_bf16_f32 v223, v142, v143
    v_mfma_f32_32x32x16_bf16 a[112:127], a[188:191], v[236:239], a[112:127]
    s_waitcnt lgkmcnt(0)
    v_mfma_f32_32x32x16_bf16 v[112:127], a[128:131], v[48:51], v[176:191]
    ds_read_b64_tr_b16 a[160:161], v16 offset:16384
    ds_read_b64_tr_b16 a[162:163], v16 offset:18432
    v_exp_f32 v144, v144
    v_exp_f32 v145, v145
    v_mfma_f32_32x32x16_bf16 v[128:143], a[128:131], v[52:55], v[192:207]
    ds_read_b64_tr_b16 a[164:165], v17 offset:16384
    ds_read_b64_tr_b16 a[166:167], v17 offset:18432
    v_exp_f32 v146, v146
    v_exp_f32 v147, v147
    v_mfma_f32_32x32x16_bf16 v[112:127], a[132:135], v[56:59], v[112:127]
    ds_read_b64_tr_b16 a[168:169], v18 offset:16384
    v_add_f32 v240, v240, v144
    v_add_f32 v241, v241, v145
    v_cvt_pk_bf16_f32 v224, v144, v145
    v_exp_f32 v148, v148
    v_mfma_f32_32x32x16_bf16 v[128:143], a[132:135], v[60:63], v[128:143]
    ds_read_b64_tr_b16 a[170:171], v18 offset:18432
    ds_read_b64_tr_b16 a[172:173], v19 offset:16384
    v_exp_f32 v149, v149
    v_add_f32 v240, v240, v146
    v_mfma_f32_32x32x16_bf16 v[112:127], a[136:139], v[64:67], v[112:127]
    ds_read_b64_tr_b16 a[174:175], v19 offset:18432
    v_add_f32 v241, v241, v147
    v_cvt_pk_bf16_f32 v225, v146, v147
    v_exp_f32 v150, v150
    v_mfma_f32_32x32x16_bf16 v[128:143], a[136:139], v[68:71], v[128:143]
    ds_read_b64_tr_b16 a[176:177], v16 offset:20480
    ds_read_b64_tr_b16 a[178:179], v16 offset:22528
    v_exp_f32 v151, v151
    v_add_f32 v240, v240, v148
    v_mfma_f32_32x32x16_bf16 v[112:127], a[140:143], v[72:75], v[112:127]
    ds_read_b64_tr_b16 a[180:181], v17 offset:20480
    ds_read_b64_tr_b16 a[182:183], v17 offset:22528
    v_add_f32 v241, v241, v149
    v_cvt_pk_bf16_f32 v226, v148, v149
    v_exp_f32 v152, v152
    v_mfma_f32_32x32x16_bf16 v[128:143], a[140:143], v[76:79], v[128:143]
    ds_read_b64_tr_b16 a[184:185], v18 offset:20480
    v_exp_f32 v153, v153
    v_add_f32 v240, v240, v150
    v_mfma_f32_32x32x16_bf16 v[112:127], a[144:147], v[80:83], v[112:127]
    ds_read_b64_tr_b16 a[186:187], v18 offset:22528
    ds_read_b64_tr_b16 a[188:189], v19 offset:20480
    v_add_f32 v241, v241, v151
    v_cvt_pk_bf16_f32 v227, v150, v151
    v_exp_f32 v154, v154
    v_mfma_f32_32x32x16_bf16 v[128:143], a[144:147], v[84:87], v[128:143]
    ds_read_b64_tr_b16 a[190:191], v19 offset:22528
    v_exp_f32 v155, v155
    v_add_f32 v240, v240, v152
    v_mfma_f32_32x32x16_bf16 v[112:127], a[148:151], v[88:91], v[112:127]
    v_add_f32 v241, v241, v153
    v_cvt_pk_bf16_f32 v228, v152, v153
    v_exp_f32 v156, v156
    v_mfma_f32_32x32x16_bf16 v[128:143], a[148:151], v[92:95], v[128:143]
    v_exp_f32 v157, v157
    v_add_f32 v240, v240, v154
    v_mfma_f32_32x32x16_bf16 v[112:127], a[152:155], v[96:99], v[112:127]
    v_add_f32 v241, v241, v155
    v_cvt_pk_bf16_f32 v229, v154, v155
    v_exp_f32 v158, v158
    v_mfma_f32_32x32x16_bf16 v[128:143], a[152:155], v[100:103], v[128:143]
    v_exp_f32 v159, v159
    v_add_f32 v240, v240, v156
    v_mfma_f32_32x32x16_bf16 v[112:127], a[156:159], v[104:107], v[112:127]
    v_add_f32 v241, v241, v157
    v_cvt_pk_bf16_f32 v230, v156, v157
    v_exp_f32 v160, v160
    v_mfma_f32_32x32x16_bf16 v[128:143], a[156:159], v[108:111], v[128:143]
    v_exp_f32 v161, v161
    v_add_f32 v240, v240, v158
    s_waitcnt lgkmcnt(0)
    v_mfma_f32_32x32x16_bf16 a[0:15], a[160:163], v[208:211], a[0:15]
    ds_read_b128 a[128:131], v8 offset:40960
    s_add_u32 m0, s69, 131072
    s_add_u32 s66, s66, 458752
    buffer_load_dwordx4 v2, s[8:11], s66 offen offset:0 lds
    v_add_f32 v241, v241, v159
    v_cvt_pk_bf16_f32 v231, v158, v159
    v_mfma_f32_32x32x16_bf16 a[16:31], a[160:163], v[216:219], a[16:31]
    ds_read_b128 a[132:135], v9 offset:40960
    v_exp_f32 v162, v162
    v_exp_f32 v163, v163
    v_add_f32 v242, v242, v160
    v_mfma_f32_32x32x16_bf16 a[32:47], a[164:167], v[208:211], a[32:47]
    ds_read_b128 a[136:139], v10 offset:40960
    buffer_load_dwordx4 v3, s[8:11], s66 offen offset:1024 lds
    v_add_f32 v243, v243, v161
    v_cvt_pk_bf16_f32 v232, v160, v161
    v_exp_f32 v164, v164
    v_mfma_f32_32x32x16_bf16 a[48:63], a[164:167], v[216:219], a[48:63]
    ds_read_b128 a[140:143], v11 offset:40960
    v_exp_f32 v165, v165
    v_add_f32 v242, v242, v162
    v_add_f32 v243, v243, v163
    v_mfma_f32_32x32x16_bf16 a[64:79], a[168:171], v[208:211], a[64:79]
    buffer_load_dwordx4 v4, s[8:11], s66 offen offset:2048 lds
    v_cvt_pk_bf16_f32 v233, v162, v163
    v_exp_f32 v166, v166
    v_exp_f32 v167, v167
    v_mfma_f32_32x32x16_bf16 a[80:95], a[168:171], v[216:219], a[80:95]
    ds_read_b128 a[144:147], v12 offset:40960
    v_add_f32 v242, v242, v164
    v_add_f32 v243, v243, v165
    v_cvt_pk_bf16_f32 v234, v164, v165
    v_mfma_f32_32x32x16_bf16 a[96:111], a[172:175], v[208:211], a[96:111]
    ds_read_b128 a[148:151], v13 offset:40960
    buffer_load_dwordx4 v5, s[8:11], s66 offen offset:3072 lds
    v_exp_f32 v168, v168
    v_exp_f32 v169, v169
    v_add_f32 v242, v242, v166
    v_mfma_f32_32x32x16_bf16 a[112:127], a[172:175], v[216:219], a[112:127]
    ds_read_b128 a[152:155], v14 offset:40960
    v_add_f32 v243, v243, v167
    v_cvt_pk_bf16_f32 v235, v166, v167
    v_mfma_f32_32x32x16_bf16 a[0:15], a[176:179], v[212:215], a[0:15]
    ds_read_b128 a[156:159], v15 offset:40960
    buffer_load_dwordx4 a[192:195], v6, s[12:15], s67 offen offset:0 sc1
    v_exp_f32 v170, v170
    v_exp_f32 v171, v171
    v_add_f32 v242, v242, v168
    v_mfma_f32_32x32x16_bf16 a[16:31], a[176:179], v[220:223], a[16:31]
    v_add_f32 v243, v243, v169
    v_cvt_pk_bf16_f32 v236, v168, v169
    v_exp_f32 v172, v172
    v_mfma_f32_32x32x16_bf16 a[32:47], a[180:183], v[212:215], a[32:47]
    buffer_load_dwordx4 a[196:199], v6, s[12:15], s67 offen offset:1024 sc1
    v_exp_f32 v173, v173
    v_add_f32 v242, v242, v170
    v_add_f32 v243, v243, v171
    v_mfma_f32_32x32x16_bf16 a[48:63], a[180:183], v[220:223], a[48:63]
    v_cvt_pk_bf16_f32 v237, v170, v171
    v_exp_f32 v174, v174
    v_mfma_f32_32x32x16_bf16 a[64:79], a[184:187], v[212:215], a[64:79]
    buffer_load_dwordx4 a[200:203], v6, s[12:15], s67 offen offset:2048 sc1
    v_exp_f32 v175, v175
    v_add_f32 v242, v242, v172
    v_add_f32 v243, v243, v173
    v_mfma_f32_32x32x16_bf16 a[80:95], a[184:187], v[220:223], a[80:95]
    v_cvt_pk_bf16_f32 v238, v172, v173
    s_nop 0
    v_add_f32 v242, v242, v174
    v_mfma_f32_32x32x16_bf16 a[96:111], a[188:191], v[212:215], a[96:111]
    buffer_load_dwordx4 a[204:207], v6, s[12:15], s67 offen offset:3072 sc1
    v_add_f32 v243, v243, v175
    v_cvt_pk_bf16_f32 v239, v174, v175
    v_mfma_f32_32x32x16_bf16 a[112:127], a[188:191], v[220:223], a[112:127]
    s_add_u32 s67, s67, 65536
    s_waitcnt lgkmcnt(0)
    s_waitcnt vmcnt(14)
    s_barrier
    v_mfma_f32_32x32x16_bf16 v[144:159], a[128:131], v[48:51], v[176:191]
    ds_read_b64_tr_b16 a[160:161], v16 offset:24576
    ds_read_b64_tr_b16 a[162:163], v16 offset:26624
    v_exp_f32 v112, v112
    v_exp_f32 v113, v113
    v_mfma_f32_32x32x16_bf16 v[160:175], a[128:131], v[52:55], v[192:207]
    ds_read_b64_tr_b16 a[164:165], v17 offset:24576
    ds_read_b64_tr_b16 a[166:167], v17 offset:26624
    v_exp_f32 v114, v114
    v_exp_f32 v115, v115
    v_mfma_f32_32x32x16_bf16 v[144:159], a[132:135], v[56:59], v[144:159]
    ds_read_b64_tr_b16 a[168:169], v18 offset:24576
    v_add_f32 v240, v240, v112
    v_add_f32 v241, v241, v113
    v_cvt_pk_bf16_f32 v208, v112, v113
    v_exp_f32 v116, v116
    v_mfma_f32_32x32x16_bf16 v[160:175], a[132:135], v[60:63], v[160:175]
    ds_read_b64_tr_b16 a[170:171], v18 offset:26624
    ds_read_b64_tr_b16 a[172:173], v19 offset:24576
    v_exp_f32 v117, v117
    v_add_f32 v240, v240, v114
    v_mfma_f32_32x32x16_bf16 v[144:159], a[136:139], v[64:67], v[144:159]
    ds_read_b64_tr_b16 a[174:175], v19 offset:26624
    v_add_f32 v241, v241, v115
    v_cvt_pk_bf16_f32 v209, v114, v115
    v_exp_f32 v118, v118
    v_mfma_f32_32x32x16_bf16 v[160:175], a[136:139], v[68:71], v[160:175]
    ds_read_b64_tr_b16 a[176:177], v16 offset:28672
    ds_read_b64_tr_b16 a[178:179], v16 offset:30720
    v_exp_f32 v119, v119
    v_add_f32 v240, v240, v116
    v_mfma_f32_32x32x16_bf16 v[144:159], a[140:143], v[72:75], v[144:159]
    ds_read_b64_tr_b16 a[180:181], v17 offset:28672
    ds_read_b64_tr_b16 a[182:183], v17 offset:30720
    v_add_f32 v241, v241, v117
    v_cvt_pk_bf16_f32 v210, v116, v117
    v_exp_f32 v120, v120
    v_mfma_f32_32x32x16_bf16 v[160:175], a[140:143], v[76:79], v[160:175]
    ds_read_b64_tr_b16 a[184:185], v18 offset:28672
    v_exp_f32 v121, v121
    v_add_f32 v240, v240, v118
    v_mfma_f32_32x32x16_bf16 v[144:159], a[144:147], v[80:83], v[144:159]
    ds_read_b64_tr_b16 a[186:187], v18 offset:30720
    ds_read_b64_tr_b16 a[188:189], v19 offset:28672
    v_add_f32 v241, v241, v119
    v_cvt_pk_bf16_f32 v211, v118, v119
    v_exp_f32 v122, v122
    v_mfma_f32_32x32x16_bf16 v[160:175], a[144:147], v[84:87], v[160:175]
    ds_read_b64_tr_b16 a[190:191], v19 offset:30720
    v_exp_f32 v123, v123
    v_add_f32 v240, v240, v120
    v_mfma_f32_32x32x16_bf16 v[144:159], a[148:151], v[88:91], v[144:159]
    v_add_f32 v241, v241, v121
    v_cvt_pk_bf16_f32 v212, v120, v121
    v_exp_f32 v124, v124
    v_mfma_f32_32x32x16_bf16 v[160:175], a[148:151], v[92:95], v[160:175]
    v_exp_f32 v125, v125
    v_add_f32 v240, v240, v122
    v_mfma_f32_32x32x16_bf16 v[144:159], a[152:155], v[96:99], v[144:159]
    v_add_f32 v241, v241, v123
    v_cvt_pk_bf16_f32 v213, v122, v123
    v_exp_f32 v126, v126
    v_mfma_f32_32x32x16_bf16 v[160:175], a[152:155], v[100:103], v[160:175]
    v_exp_f32 v127, v127
    v_add_f32 v240, v240, v124
    v_mfma_f32_32x32x16_bf16 v[144:159], a[156:159], v[104:107], v[144:159]
    v_add_f32 v241, v241, v125
    v_cvt_pk_bf16_f32 v214, v124, v125
    v_exp_f32 v128, v128
    v_mfma_f32_32x32x16_bf16 v[160:175], a[156:159], v[108:111], v[160:175]
    v_exp_f32 v129, v129
    v_add_f32 v240, v240, v126
    s_waitcnt lgkmcnt(0)
    v_mfma_f32_32x32x16_bf16 a[0:15], a[160:163], v[224:227], a[0:15]
    ds_read_b128 a[128:131], v8 offset:49152
    s_add_u32 m0, s69, 135168
    s_add_u32 s66, s66, 65536
    buffer_load_dwordx4 v2, s[8:11], s66 offen offset:0 lds
    v_add_f32 v241, v241, v127
    v_cvt_pk_bf16_f32 v215, v126, v127
    v_mfma_f32_32x32x16_bf16 a[16:31], a[160:163], v[232:235], a[16:31]
    ds_read_b128 a[132:135], v9 offset:49152
    v_exp_f32 v130, v130
    v_exp_f32 v131, v131
    v_add_f32 v242, v242, v128
    v_mfma_f32_32x32x16_bf16 a[32:47], a[164:167], v[224:227], a[32:47]
    ds_read_b128 a[136:139], v10 offset:49152
    buffer_load_dwordx4 v3, s[8:11], s66 offen offset:1024 lds
    v_add_f32 v243, v243, v129
    v_cvt_pk_bf16_f32 v216, v128, v129
    v_exp_f32 v132, v132
    v_mfma_f32_32x32x16_bf16 a[48:63], a[164:167], v[232:235], a[48:63]
    ds_read_b128 a[140:143], v11 offset:49152
    v_exp_f32 v133, v133
    v_add_f32 v242, v242, v130
    v_add_f32 v243, v243, v131
    v_mfma_f32_32x32x16_bf16 a[64:79], a[168:171], v[224:227], a[64:79]
    buffer_load_dwordx4 v4, s[8:11], s66 offen offset:2048 lds
    v_cvt_pk_bf16_f32 v217, v130, v131
    v_exp_f32 v134, v134
    v_exp_f32 v135, v135
    v_mfma_f32_32x32x16_bf16 a[80:95], a[168:171], v[232:235], a[80:95]
    ds_read_b128 a[144:147], v12 offset:49152
    v_add_f32 v242, v242, v132
    v_add_f32 v243, v243, v133
    v_cvt_pk_bf16_f32 v218, v132, v133
    v_mfma_f32_32x32x16_bf16 a[96:111], a[172:175], v[224:227], a[96:111]
    ds_read_b128 a[148:151], v13 offset:49152
    buffer_load_dwordx4 v5, s[8:11], s66 offen offset:3072 lds
    v_exp_f32 v136, v136
    v_exp_f32 v137, v137
    v_add_f32 v242, v242, v134
    v_mfma_f32_32x32x16_bf16 a[112:127], a[172:175], v[232:235], a[112:127]
    ds_read_b128 a[152:155], v14 offset:49152
    v_add_f32 v243, v243, v135
    v_cvt_pk_bf16_f32 v219, v134, v135
    v_mfma_f32_32x32x16_bf16 a[0:15], a[176:179], v[228:231], a[0:15]
    ds_read_b128 a[156:159], v15 offset:49152
    buffer_load_dwordx4 a[208:211], v6, s[12:15], s67 offen offset:0 sc1
    v_exp_f32 v138, v138
    v_exp_f32 v139, v139
    v_add_f32 v242, v242, v136
    v_mfma_f32_32x32x16_bf16 a[16:31], a[176:179], v[236:239], a[16:31]
    v_add_f32 v243, v243, v137
    v_cvt_pk_bf16_f32 v220, v136, v137
    v_exp_f32 v140, v140
    v_mfma_f32_32x32x16_bf16 a[32:47], a[180:183], v[228:231], a[32:47]
    buffer_load_dwordx4 a[212:215], v6, s[12:15], s67 offen offset:1024 sc1
    v_exp_f32 v141, v141
    v_add_f32 v242, v242, v138
    v_add_f32 v243, v243, v139
    v_mfma_f32_32x32x16_bf16 a[48:63], a[180:183], v[236:239], a[48:63]
    v_cvt_pk_bf16_f32 v221, v138, v139
    v_exp_f32 v142, v142
    v_mfma_f32_32x32x16_bf16 a[64:79], a[184:187], v[228:231], a[64:79]
    buffer_load_dwordx4 a[216:219], v6, s[12:15], s67 offen offset:2048 sc1
    v_exp_f32 v143, v143
    v_add_f32 v242, v242, v140
    v_add_f32 v243, v243, v141
    v_mfma_f32_32x32x16_bf16 a[80:95], a[184:187], v[236:239], a[80:95]
    v_cvt_pk_bf16_f32 v222, v140, v141
    s_nop 0
    v_add_f32 v242, v242, v142
    v_mfma_f32_32x32x16_bf16 a[96:111], a[188:191], v[228:231], a[96:111]
    buffer_load_dwordx4 a[220:223], v6, s[12:15], s67 offen offset:3072 sc1
    v_add_f32 v243, v243, v143
    v_cvt_pk_bf16_f32 v223, v142, v143
    v_mfma_f32_32x32x16_bf16 a[112:127], a[188:191], v[236:239], a[112:127]
    s_add_u32 s67, s67, 196608
    s_waitcnt lgkmcnt(0)
    v_mfma_f32_32x32x16_bf16 v[112:127], a[128:131], v[48:51], v[176:191]
    ds_read_b64_tr_b16 a[160:161], v16 offset:32768
    ds_read_b64_tr_b16 a[162:163], v16 offset:34816
    v_exp_f32 v144, v144
    v_exp_f32 v145, v145
    v_mfma_f32_32x32x16_bf16 v[128:143], a[128:131], v[52:55], v[192:207]
    ds_read_b64_tr_b16 a[164:165], v17 offset:32768
    ds_read_b64_tr_b16 a[166:167], v17 offset:34816
    v_exp_f32 v146, v146
    v_exp_f32 v147, v147
    v_mfma_f32_32x32x16_bf16 v[112:127], a[132:135], v[56:59], v[112:127]
    ds_read_b64_tr_b16 a[168:169], v18 offset:32768
    v_add_f32 v240, v240, v144
    v_add_f32 v241, v241, v145
    v_cvt_pk_bf16_f32 v224, v144, v145
    v_exp_f32 v148, v148
    v_mfma_f32_32x32x16_bf16 v[128:143], a[132:135], v[60:63], v[128:143]
    ds_read_b64_tr_b16 a[170:171], v18 offset:34816
    ds_read_b64_tr_b16 a[172:173], v19 offset:32768
    v_exp_f32 v149, v149
    v_add_f32 v240, v240, v146
    v_mfma_f32_32x32x16_bf16 v[112:127], a[136:139], v[64:67], v[112:127]
    ds_read_b64_tr_b16 a[174:175], v19 offset:34816
    v_add_f32 v241, v241, v147
    v_cvt_pk_bf16_f32 v225, v146, v147
    v_exp_f32 v150, v150
    v_mfma_f32_32x32x16_bf16 v[128:143], a[136:139], v[68:71], v[128:143]
    ds_read_b64_tr_b16 a[176:177], v16 offset:36864
    ds_read_b64_tr_b16 a[178:179], v16 offset:38912
    v_exp_f32 v151, v151
    v_add_f32 v240, v240, v148
    v_mfma_f32_32x32x16_bf16 v[112:127], a[140:143], v[72:75], v[112:127]
    ds_read_b64_tr_b16 a[180:181], v17 offset:36864
    ds_read_b64_tr_b16 a[182:183], v17 offset:38912
    v_add_f32 v241, v241, v149
    v_cvt_pk_bf16_f32 v226, v148, v149
    v_exp_f32 v152, v152
    v_mfma_f32_32x32x16_bf16 v[128:143], a[140:143], v[76:79], v[128:143]
    ds_read_b64_tr_b16 a[184:185], v18 offset:36864
    v_exp_f32 v153, v153
    v_add_f32 v240, v240, v150
    v_mfma_f32_32x32x16_bf16 v[112:127], a[144:147], v[80:83], v[112:127]
    ds_read_b64_tr_b16 a[186:187], v18 offset:38912
    ds_read_b64_tr_b16 a[188:189], v19 offset:36864
    v_add_f32 v241, v241, v151
    v_cvt_pk_bf16_f32 v227, v150, v151
    v_exp_f32 v154, v154
    v_mfma_f32_32x32x16_bf16 v[128:143], a[144:147], v[84:87], v[128:143]
    ds_read_b64_tr_b16 a[190:191], v19 offset:38912
    v_exp_f32 v155, v155
    v_add_f32 v240, v240, v152
    v_mfma_f32_32x32x16_bf16 v[112:127], a[148:151], v[88:91], v[112:127]
    v_add_f32 v241, v241, v153
    v_cvt_pk_bf16_f32 v228, v152, v153
    v_exp_f32 v156, v156
    v_mfma_f32_32x32x16_bf16 v[128:143], a[148:151], v[92:95], v[128:143]
    v_exp_f32 v157, v157
    v_add_f32 v240, v240, v154
    v_mfma_f32_32x32x16_bf16 v[112:127], a[152:155], v[96:99], v[112:127]
    v_add_f32 v241, v241, v155
    v_cvt_pk_bf16_f32 v229, v154, v155
    v_exp_f32 v158, v158
    v_mfma_f32_32x32x16_bf16 v[128:143], a[152:155], v[100:103], v[128:143]
    v_exp_f32 v159, v159
    v_add_f32 v240, v240, v156
    v_mfma_f32_32x32x16_bf16 v[112:127], a[156:159], v[104:107], v[112:127]
    v_add_f32 v241, v241, v157
    v_cvt_pk_bf16_f32 v230, v156, v157
    v_exp_f32 v160, v160
    v_mfma_f32_32x32x16_bf16 v[128:143], a[156:159], v[108:111], v[128:143]
    v_exp_f32 v161, v161
    v_add_f32 v240, v240, v158
    s_waitcnt lgkmcnt(0)
    v_mfma_f32_32x32x16_bf16 a[0:15], a[160:163], v[208:211], a[0:15]
    ds_read_b128 a[128:131], v8 offset:57344
    s_add_u32 m0, s69, 0
    s_add_u32 s66, s66, 458752
    buffer_load_dwordx4 v2, s[8:11], s66 offen offset:0 lds
    v_add_f32 v241, v241, v159
    v_cvt_pk_bf16_f32 v231, v158, v159
    v_mfma_f32_32x32x16_bf16 a[16:31], a[160:163], v[216:219], a[16:31]
    ds_read_b128 a[132:135], v9 offset:57344
    v_exp_f32 v162, v162
    v_exp_f32 v163, v163
    v_add_f32 v242, v242, v160
    v_mfma_f32_32x32x16_bf16 a[32:47], a[164:167], v[208:211], a[32:47]
    ds_read_b128 a[136:139], v10 offset:57344
    buffer_load_dwordx4 v3, s[8:11], s66 offen offset:1024 lds
    v_add_f32 v243, v243, v161
    v_cvt_pk_bf16_f32 v232, v160, v161
    v_exp_f32 v164, v164
    v_mfma_f32_32x32x16_bf16 a[48:63], a[164:167], v[216:219], a[48:63]
    ds_read_b128 a[140:143], v11 offset:57344
    v_exp_f32 v165, v165
    v_add_f32 v242, v242, v162
    v_add_f32 v243, v243, v163
    v_mfma_f32_32x32x16_bf16 a[64:79], a[168:171], v[208:211], a[64:79]
    buffer_load_dwordx4 v4, s[8:11], s66 offen offset:2048 lds
    v_cvt_pk_bf16_f32 v233, v162, v163
    v_exp_f32 v166, v166
    v_exp_f32 v167, v167
    v_mfma_f32_32x32x16_bf16 a[80:95], a[168:171], v[216:219], a[80:95]
    ds_read_b128 a[144:147], v12 offset:57344
    v_add_f32 v242, v242, v164
    v_add_f32 v243, v243, v165
    v_cvt_pk_bf16_f32 v234, v164, v165
    v_mfma_f32_32x32x16_bf16 a[96:111], a[172:175], v[208:211], a[96:111]
    ds_read_b128 a[148:151], v13 offset:57344
    buffer_load_dwordx4 v5, s[8:11], s66 offen offset:3072 lds
    v_exp_f32 v168, v168
    v_exp_f32 v169, v169
    v_add_f32 v242, v242, v166
    v_mfma_f32_32x32x16_bf16 a[112:127], a[172:175], v[216:219], a[112:127]
    ds_read_b128 a[152:155], v14 offset:57344
    v_add_f32 v243, v243, v167
    v_cvt_pk_bf16_f32 v235, v166, v167
    v_mfma_f32_32x32x16_bf16 a[0:15], a[176:179], v[212:215], a[0:15]
    ds_read_b128 a[156:159], v15 offset:57344
    buffer_load_dwordx4 a[224:227], v6, s[12:15], s67 offen offset:0 sc1
    v_exp_f32 v170, v170
    v_exp_f32 v171, v171
    v_add_f32 v242, v242, v168
    v_mfma_f32_32x32x16_bf16 a[16:31], a[176:179], v[220:223], a[16:31]
    v_add_f32 v243, v243, v169
    v_cvt_pk_bf16_f32 v236, v168, v169
    v_exp_f32 v172, v172
    v_mfma_f32_32x32x16_bf16 a[32:47], a[180:183], v[212:215], a[32:47]
    buffer_load_dwordx4 a[228:231], v6, s[12:15], s67 offen offset:1024 sc1
    v_exp_f32 v173, v173
    v_add_f32 v242, v242, v170
    v_add_f32 v243, v243, v171
    v_mfma_f32_32x32x16_bf16 a[48:63], a[180:183], v[220:223], a[48:63]
    v_cvt_pk_bf16_f32 v237, v170, v171
    v_exp_f32 v174, v174
    v_mfma_f32_32x32x16_bf16 a[64:79], a[184:187], v[212:215], a[64:79]
    buffer_load_dwordx4 a[232:235], v6, s[12:15], s67 offen offset:2048 sc1
    v_exp_f32 v175, v175
    v_add_f32 v242, v242, v172
    v_add_f32 v243, v243, v173
    v_mfma_f32_32x32x16_bf16 a[80:95], a[184:187], v[220:223], a[80:95]
    v_cvt_pk_bf16_f32 v238, v172, v173
    s_nop 0
    v_add_f32 v242, v242, v174
    v_mfma_f32_32x32x16_bf16 a[96:111], a[188:191], v[212:215], a[96:111]
    buffer_load_dwordx4 a[236:239], v6, s[12:15], s67 offen offset:3072 sc1
    v_add_f32 v243, v243, v175
    v_cvt_pk_bf16_f32 v239, v174, v175
    v_mfma_f32_32x32x16_bf16 a[112:127], a[188:191], v[220:223], a[112:127]
    s_add_u32 s67, s67, 65536
    s_waitcnt lgkmcnt(0)
    s_waitcnt vmcnt(24)
    s_barrier
    v_mfma_f32_32x32x16_bf16 v[144:159], a[128:131], v[48:51], v[176:191]
    ds_read_b64_tr_b16 a[160:161], v16 offset:40960
    ds_read_b64_tr_b16 a[162:163], v16 offset:43008
    v_exp_f32 v112, v112
    v_exp_f32 v113, v113
    v_mfma_f32_32x32x16_bf16 v[160:175], a[128:131], v[52:55], v[192:207]
    ds_read_b64_tr_b16 a[164:165], v17 offset:40960
    ds_read_b64_tr_b16 a[166:167], v17 offset:43008
    v_exp_f32 v114, v114
    v_exp_f32 v115, v115
    v_mfma_f32_32x32x16_bf16 v[144:159], a[132:135], v[56:59], v[144:159]
    ds_read_b64_tr_b16 a[168:169], v18 offset:40960
    v_add_f32 v240, v240, v112
    v_add_f32 v241, v241, v113
    v_cvt_pk_bf16_f32 v208, v112, v113
    v_exp_f32 v116, v116
    v_mfma_f32_32x32x16_bf16 v[160:175], a[132:135], v[60:63], v[160:175]
    ds_read_b64_tr_b16 a[170:171], v18 offset:43008
    ds_read_b64_tr_b16 a[172:173], v19 offset:40960
    v_exp_f32 v117, v117
    v_add_f32 v240, v240, v114
    v_mfma_f32_32x32x16_bf16 v[144:159], a[136:139], v[64:67], v[144:159]
    ds_read_b64_tr_b16 a[174:175], v19 offset:43008
    v_add_f32 v241, v241, v115
    v_cvt_pk_bf16_f32 v209, v114, v115
    v_exp_f32 v118, v118
    v_mfma_f32_32x32x16_bf16 v[160:175], a[136:139], v[68:71], v[160:175]
    ds_read_b64_tr_b16 a[176:177], v16 offset:45056
    ds_read_b64_tr_b16 a[178:179], v16 offset:47104
    v_exp_f32 v119, v119
    v_add_f32 v240, v240, v116
    v_mfma_f32_32x32x16_bf16 v[144:159], a[140:143], v[72:75], v[144:159]
    ds_read_b64_tr_b16 a[180:181], v17 offset:45056
    ds_read_b64_tr_b16 a[182:183], v17 offset:47104
    v_add_f32 v241, v241, v117
    v_cvt_pk_bf16_f32 v210, v116, v117
    v_exp_f32 v120, v120
    v_mfma_f32_32x32x16_bf16 v[160:175], a[140:143], v[76:79], v[160:175]
    ds_read_b64_tr_b16 a[184:185], v18 offset:45056
    v_exp_f32 v121, v121
    v_add_f32 v240, v240, v118
    v_mfma_f32_32x32x16_bf16 v[144:159], a[144:147], v[80:83], v[144:159]
    ds_read_b64_tr_b16 a[186:187], v18 offset:47104
    ds_read_b64_tr_b16 a[188:189], v19 offset:45056
    v_add_f32 v241, v241, v119
    v_cvt_pk_bf16_f32 v211, v118, v119
    v_exp_f32 v122, v122
    v_mfma_f32_32x32x16_bf16 v[160:175], a[144:147], v[84:87], v[160:175]
    ds_read_b64_tr_b16 a[190:191], v19 offset:47104
    v_exp_f32 v123, v123
    v_add_f32 v240, v240, v120
    v_mfma_f32_32x32x16_bf16 v[144:159], a[148:151], v[88:91], v[144:159]
    v_add_f32 v241, v241, v121
    v_cvt_pk_bf16_f32 v212, v120, v121
    v_exp_f32 v124, v124
    v_mfma_f32_32x32x16_bf16 v[160:175], a[148:151], v[92:95], v[160:175]
    v_exp_f32 v125, v125
    v_add_f32 v240, v240, v122
    v_mfma_f32_32x32x16_bf16 v[144:159], a[152:155], v[96:99], v[144:159]
    v_add_f32 v241, v241, v123
    v_cvt_pk_bf16_f32 v213, v122, v123
    v_exp_f32 v126, v126
    v_mfma_f32_32x32x16_bf16 v[160:175], a[152:155], v[100:103], v[160:175]
    v_exp_f32 v127, v127
    v_add_f32 v240, v240, v124
    v_mfma_f32_32x32x16_bf16 v[144:159], a[156:159], v[104:107], v[144:159]
    v_add_f32 v241, v241, v125
    v_cvt_pk_bf16_f32 v214, v124, v125
    v_exp_f32 v128, v128
    v_mfma_f32_32x32x16_bf16 v[160:175], a[156:159], v[108:111], v[160:175]
    v_exp_f32 v129, v129
    v_add_f32 v240, v240, v126
    s_waitcnt lgkmcnt(0)
    v_mfma_f32_32x32x16_bf16 a[0:15], a[160:163], v[224:227], a[0:15]
    s_add_u32 m0, s69, 4096
    s_add_u32 s66, s66, 65536
    buffer_load_dwordx4 v2, s[8:11], s66 offen offset:0 lds
    v_add_f32 v241, v241, v127
    v_cvt_pk_bf16_f32 v215, v126, v127
    v_mfma_f32_32x32x16_bf16 a[16:31], a[160:163], v[232:235], a[16:31]
    v_exp_f32 v130, v130
    v_exp_f32 v131, v131
    v_add_f32 v242, v242, v128
    v_add_f32 v243, v243, v129
    v_mfma_f32_32x32x16_bf16 a[32:47], a[164:167], v[224:227], a[32:47]
    buffer_load_dwordx4 v3, s[8:11], s66 offen offset:1024 lds
    v_cvt_pk_bf16_f32 v216, v128, v129
    v_exp_f32 v132, v132
    v_exp_f32 v133, v133
    v_mfma_f32_32x32x16_bf16 a[48:63], a[164:167], v[232:235], a[48:63]
    v_add_f32 v242, v242, v130
    v_add_f32 v243, v243, v131
    v_mfma_f32_32x32x16_bf16 a[64:79], a[168:171], v[224:227], a[64:79]
    buffer_load_dwordx4 v4, s[8:11], s66 offen offset:2048 lds
    v_cvt_pk_bf16_f32 v217, v130, v131
    v_exp_f32 v134, v134
    v_exp_f32 v135, v135
    v_mfma_f32_32x32x16_bf16 a[80:95], a[168:171], v[232:235], a[80:95]
    v_add_f32 v242, v242, v132
    v_add_f32 v243, v243, v133
    v_cvt_pk_bf16_f32 v218, v132, v133
    v_mfma_f32_32x32x16_bf16 a[96:111], a[172:175], v[224:227], a[96:111]
    buffer_load_dwordx4 v5, s[8:11], s66 offen offset:3072 lds
    v_exp_f32 v136, v136
    v_exp_f32 v137, v137
    v_add_f32 v242, v242, v134
    v_mfma_f32_32x32x16_bf16 a[112:127], a[172:175], v[232:235], a[112:127]
    v_add_f32 v243, v243, v135
    v_cvt_pk_bf16_f32 v219, v134, v135
    v_mfma_f32_32x32x16_bf16 a[0:15], a[176:179], v[228:231], a[0:15]
    buffer_load_dwordx4 a[240:243], v6, s[12:15], s67 offen offset:0 sc1
    v_exp_f32 v138, v138
    v_exp_f32 v139, v139
    v_add_f32 v242, v242, v136
    v_mfma_f32_32x32x16_bf16 a[16:31], a[176:179], v[236:239], a[16:31]
    v_add_f32 v243, v243, v137
    v_cvt_pk_bf16_f32 v220, v136, v137
    v_exp_f32 v140, v140
    v_mfma_f32_32x32x16_bf16 a[32:47], a[180:183], v[228:231], a[32:47]
    buffer_load_dwordx4 a[244:247], v6, s[12:15], s67 offen offset:1024 sc1
    v_exp_f32 v141, v141
    v_add_f32 v242, v242, v138
    v_add_f32 v243, v243, v139
    v_mfma_f32_32x32x16_bf16 a[48:63], a[180:183], v[236:239], a[48:63]
    v_cvt_pk_bf16_f32 v221, v138, v139
    v_exp_f32 v142, v142
    v_mfma_f32_32x32x16_bf16 a[64:79], a[184:187], v[228:231], a[64:79]
    buffer_load_dwordx4 a[248:251], v6, s[12:15], s67 offen offset:2048 sc1
    v_exp_f32 v143, v143
    v_add_f32 v242, v242, v140
    v_add_f32 v243, v243, v141
    v_mfma_f32_32x32x16_bf16 a[80:95], a[184:187], v[236:239], a[80:95]
    v_cvt_pk_bf16_f32 v222, v140, v141
    s_nop 0
    v_add_f32 v242, v242, v142
    v_mfma_f32_32x32x16_bf16 a[96:111], a[188:191], v[228:231], a[96:111]
    buffer_load_dwordx4 a[252:255], v6, s[12:15], s67 offen offset:3072 sc1
    v_add_f32 v243, v243, v143
    v_cvt_pk_bf16_f32 v223, v142, v143
    v_mfma_f32_32x32x16_bf16 a[112:127], a[188:191], v[236:239], a[112:127]
    s_add_u32 s67, s67, 196608
    ds_read_b64_tr_b16 a[160:161], v16 offset:49152
    ds_read_b64_tr_b16 a[162:163], v16 offset:51200
    ds_read_b64_tr_b16 a[164:165], v17 offset:49152
    ds_read_b64_tr_b16 a[166:167], v17 offset:51200
    ds_read_b64_tr_b16 a[168:169], v18 offset:49152
    ds_read_b64_tr_b16 a[170:171], v18 offset:51200
    ds_read_b64_tr_b16 a[172:173], v19 offset:49152
    ds_read_b64_tr_b16 a[174:175], v19 offset:51200
    ds_read_b64_tr_b16 a[176:177], v16 offset:53248
    ds_read_b64_tr_b16 a[178:179], v16 offset:55296
    ds_read_b64_tr_b16 a[180:181], v17 offset:53248
    ds_read_b64_tr_b16 a[182:183], v17 offset:55296
    ds_read_b64_tr_b16 a[184:185], v18 offset:53248
    ds_read_b64_tr_b16 a[186:187], v18 offset:55296
    ds_read_b64_tr_b16 a[188:189], v19 offset:53248
    ds_read_b64_tr_b16 a[190:191], v19 offset:55296
    v_exp_f32 v144, v144
    v_exp_f32 v145, v145
    v_exp_f32 v146, v146
    v_exp_f32 v147, v147
    v_add_f32 v240, v240, v144
    v_add_f32 v241, v241, v145
    v_cvt_pk_bf16_f32 v224, v144, v145
    v_exp_f32 v148, v148
    s_waitcnt lgkmcnt(0)
    v_mfma_f32_32x32x16_bf16 a[0:15], a[160:163], v[208:211], a[0:15]
    s_add_u32 m0, s69, 32768
    s_add_u32 s66, s66, 458752
    buffer_load_dwordx4 v2, s[8:11], s66 offen offset:0 lds
    v_exp_f32 v149, v149
    v_add_f32 v240, v240, v146
    v_mfma_f32_32x32x16_bf16 a[16:31], a[160:163], v[216:219], a[16:31]
    buffer_load_dwordx4 v3, s[8:11], s66 offen offset:1024 lds
    v_add_f32 v241, v241, v147
    v_cvt_pk_bf16_f32 v225, v146, v147
    v_exp_f32 v150, v150
    v_mfma_f32_32x32x16_bf16 a[32:47], a[164:167], v[208:211], a[32:47]
    buffer_load_dwordx4 v4, s[8:11], s66 offen offset:2048 lds
    v_exp_f32 v151, v151
    v_add_f32 v240, v240, v148
    v_add_f32 v241, v241, v149
    v_cvt_pk_bf16_f32 v226, v148, v149
    v_mfma_f32_32x32x16_bf16 a[48:63], a[164:167], v[216:219], a[48:63]
    buffer_load_dwordx4 v5, s[8:11], s66 offen offset:3072 lds
    v_exp_f32 v152, v152
    v_exp_f32 v153, v153
    v_add_f32 v240, v240, v150
    v_add_f32 v241, v241, v151
    v_mfma_f32_32x32x16_bf16 a[64:79], a[168:171], v[208:211], a[64:79]
    buffer_load_dwordx4 a[128:131], v6, s[12:15], s67 offen offset:0 sc1
    v_cvt_pk_bf16_f32 v227, v150, v151
    v_exp_f32 v154, v154
    v_exp_f32 v155, v155
    v_mfma_f32_32x32x16_bf16 a[80:95], a[168:171], v[216:219], a[80:95]
    buffer_load_dwordx4 a[132:135], v6, s[12:15], s67 offen offset:1024 sc1
    v_add_f32 v240, v240, v152
    v_add_f32 v241, v241, v153
    v_cvt_pk_bf16_f32 v228, v152, v153
    v_exp_f32 v156, v156
    v_mfma_f32_32x32x16_bf16 a[96:111], a[172:175], v[208:211], a[96:111]
    buffer_load_dwordx4 a[136:139], v6, s[12:15], s67 offen offset:2048 sc1
    v_exp_f32 v157, v157
    v_add_f32 v240, v240, v154
    v_add_f32 v241, v241, v155
    v_cvt_pk_bf16_f32 v229, v154, v155
    v_mfma_f32_32x32x16_bf16 a[112:127], a[172:175], v[216:219], a[112:127]
    buffer_load_dwordx4 a[140:143], v6, s[12:15], s67 offen offset:3072 sc1
    v_exp_f32 v158, v158
    v_exp_f32 v159, v159
    v_add_f32 v240, v240, v156
    v_mfma_f32_32x32x16_bf16 a[0:15], a[176:179], v[212:215], a[0:15]
    s_add_u32 s67, s67, 65536
    s_add_u32 m0, s69, 36864
    s_add_u32 s66, s66, 65536
    buffer_load_dwordx4 v2, s[8:11], s66 offen offset:0 lds
    v_add_f32 v241, v241, v157
    v_cvt_pk_bf16_f32 v230, v156, v157
    v_mfma_f32_32x32x16_bf16 a[16:31], a[176:179], v[220:223], a[16:31]
    buffer_load_dwordx4 v3, s[8:11], s66 offen offset:1024 lds
    v_exp_f32 v160, v160
    v_exp_f32 v161, v161
    v_add_f32 v240, v240, v158
    v_mfma_f32_32x32x16_bf16 a[32:47], a[180:183], v[212:215], a[32:47]
    buffer_load_dwordx4 v4, s[8:11], s66 offen offset:2048 lds
    v_add_f32 v241, v241, v159
    v_cvt_pk_bf16_f32 v231, v158, v159
    v_exp_f32 v162, v162
    v_mfma_f32_32x32x16_bf16 a[48:63], a[180:183], v[220:223], a[48:63]
    buffer_load_dwordx4 v5, s[8:11], s66 offen offset:3072 lds
    v_exp_f32 v163, v163
    v_add_f32 v242, v242, v160
    v_add_f32 v243, v243, v161
    v_cvt_pk_bf16_f32 v232, v160, v161
    v_mfma_f32_32x32x16_bf16 a[64:79], a[184:187], v[212:215], a[64:79]
    buffer_load_dwordx4 a[144:147], v6, s[12:15], s67 offen offset:0 sc1
    v_exp_f32 v164, v164
    v_exp_f32 v165, v165
    v_add_f32 v242, v242, v162
    v_add_f32 v243, v243, v163
    v_mfma_f32_32x32x16_bf16 a[80:95], a[184:187], v[220:223], a[80:95]
    buffer_load_dwordx4 a[148:151], v6, s[12:15], s67 offen offset:1024 sc1
    v_cvt_pk_bf16_f32 v233, v162, v163
    v_exp_f32 v166, v166
    v_exp_f32 v167, v167
    v_mfma_f32_32x32x16_bf16 a[96:111], a[188:191], v[212:215], a[96:111]
    buffer_load_dwordx4 a[152:155], v6, s[12:15], s67 offen offset:2048 sc1
    v_add_f32 v242, v242, v164
    v_add_f32 v243, v243, v165
    v_cvt_pk_bf16_f32 v234, v164, v165
    v_exp_f32 v168, v168
    v_mfma_f32_32x32x16_bf16 a[112:127], a[188:191], v[220:223], a[112:127]
    buffer_load_dwordx4 a[156:159], v6, s[12:15], s67 offen offset:3072 sc1
    v_exp_f32 v169, v169
    v_add_f32 v242, v242, v166
    v_add_f32 v243, v243, v167
    v_cvt_pk_bf16_f32 v235, v166, v167
    s_add_u32 s67, s67, 196608
    v_exp_f32 v170, v170
    v_exp_f32 v171, v171
    v_add_f32 v242, v242, v168
    v_add_f32 v243, v243, v169
    v_cvt_pk_bf16_f32 v236, v168, v169
    v_exp_f32 v172, v172
    v_exp_f32 v173, v173
    v_add_f32 v242, v242, v170
    v_add_f32 v243, v243, v171
    v_cvt_pk_bf16_f32 v237, v170, v171
    v_exp_f32 v174, v174
    v_exp_f32 v175, v175
    v_add_f32 v242, v242, v172
    v_add_f32 v243, v243, v173
    v_cvt_pk_bf16_f32 v238, v172, v173
    s_nop 0
    v_add_f32 v242, v242, v174
    v_add_f32 v243, v243, v175
    v_cvt_pk_bf16_f32 v239, v174, v175
    s_waitcnt vmcnt(32)
    s_barrier
    v_add_f32 v246, v240, v241
    v_add_f32 v247, v242, v243
    s_mov_b32 s84, 0x53800000
    v_add_f32 v246, v246, v247
    v_cmp_nge_f32 vcc, s84, v246
    s_cbranch_vccnz km_fallback
    ds_read_b64_tr_b16 a[160:161], v16 offset:57344
    ds_read_b64_tr_b16 a[162:163], v16 offset:59392
    ds_read_b64_tr_b16 a[164:165], v17 offset:57344
    ds_read_b64_tr_b16 a[166:167], v17 offset:59392
    ds_read_b64_tr_b16 a[168:169], v18 offset:57344
    ds_read_b64_tr_b16 a[170:171], v18 offset:59392
    ds_read_b64_tr_b16 a[172:173], v19 offset:57344
    ds_read_b64_tr_b16 a[174:175], v19 offset:59392
    ds_read_b64_tr_b16 a[176:177], v16 offset:61440
    ds_read_b64_tr_b16 a[178:179], v16 offset:63488
    ds_read_b64_tr_b16 a[180:181], v17 offset:61440
    ds_read_b64_tr_b16 a[182:183], v17 offset:63488
    ds_read_b64_tr_b16 a[184:185], v18 offset:61440
    ds_read_b64_tr_b16 a[186:187], v18 offset:63488
    ds_read_b64_tr_b16 a[188:189], v19 offset:61440
    ds_read_b64_tr_b16 a[190:191], v19 offset:63488
    s_waitcnt lgkmcnt(0)
    v_mfma_f32_32x32x16_bf16 a[0:15], a[160:163], v[224:227], a[0:15]
    ds_read_b64_tr_b16 v[48:49], v40 offset:32768
    ds_read_b64_tr_b16 v[50:51], v40 offset:36864
    v_mfma_f32_32x32x16_bf16 a[16:31], a[160:163], v[232:235], a[16:31]
    ds_read_b64_tr_b16 v[52:53], v41 offset:32768
    ds_read_b64_tr_b16 v[54:55], v41 offset:36864
    v_mfma_f32_32x32x16_bf16 a[32:47], a[164:167], v[224:227], a[32:47]
    ds_read_b64_tr_b16 v[56:57], v42 offset:32768
    v_mfma_f32_32x32x16_bf16 a[48:63], a[164:167], v[232:235], a[48:63]
    ds_read_b64_tr_b16 v[58:59], v42 offset:36864
    ds_read_b64_tr_b16 v[60:61], v43 offset:32768
    v_mfma_f32_32x32x16_bf16 a[64:79], a[168:171], v[224:227], a[64:79]
    ds_read_b64_tr_b16 v[62:63], v43 offset:36864
    v_mfma_f32_32x32x16_bf16 a[80:95], a[168:171], v[232:235], a[80:95]
    ds_read_b64_tr_b16 v[64:65], v44 offset:32768
    ds_read_b64_tr_b16 v[66:67], v44 offset:36864
    v_mfma_f32_32x32x16_bf16 a[96:111], a[172:175], v[224:227], a[96:111]
    ds_read_b64_tr_b16 v[68:69], v45 offset:32768
    ds_read_b64_tr_b16 v[70:71], v45 offset:36864
    v_mfma_f32_32x32x16_bf16 a[112:127], a[172:175], v[232:235], a[112:127]
    ds_read_b64_tr_b16 v[72:73], v46 offset:32768
    v_mfma_f32_32x32x16_bf16 a[0:15], a[176:179], v[228:231], a[0:15]
    ds_read_b64_tr_b16 v[74:75], v46 offset:36864
    ds_read_b64_tr_b16 v[76:77], v47 offset:32768
    v_mfma_f32_32x32x16_bf16 a[16:31], a[176:179], v[236:239], a[16:31]
    ds_read_b64_tr_b16 v[78:79], v47 offset:36864
    v_mfma_f32_32x32x16_bf16 a[32:47], a[180:183], v[228:231], a[32:47]
    v_mfma_f32_32x32x16_bf16 a[48:63], a[180:183], v[236:239], a[48:63]
    v_mfma_f32_32x32x16_bf16 a[64:79], a[184:187], v[228:231], a[64:79]
    v_mfma_f32_32x32x16_bf16 a[80:95], a[184:187], v[236:239], a[80:95]
    v_mfma_f32_32x32x16_bf16 a[96:111], a[188:191], v[228:231], a[96:111]
    v_mfma_f32_32x32x16_bf16 a[112:127], a[188:191], v[236:239], a[112:127]
    s_waitcnt lgkmcnt(0)
kmy_aend:
    v_add_f32 v240, v240, v241
    v_add_f32 v242, v242, v243
    s_nop 0
    v_mov_b32 v241, v240
    v_mov_b32 v243, v242
    s_nop 1
    v_permlane32_swap_b32 v240, v241
    v_permlane32_swap_b32 v242, v243
    s_nop 0
    v_add_f32 v240, v240, v241
    v_add_f32 v242, v242, v243
    v_rcp_f32 v241, v240
    v_rcp_f32 v243, v242
    s_lshl_b32 s4, s75, 19
    v_bfe_u32 v22, v25, 7, 3
    v_xor_b32 v22, 3, v22
    v_min_u32 v22, 1, v22
    v_add_u32 v22, -1, v22
    v_and_b32 v22, 0x3fffe80, v22
    v_add_u32 v23, v25, v22
    s_barrier
    s_add_u32 m0, s69, 98304
    s_add_u32 s66, s66, 458752
    buffer_load_dwordx4 v2, s[8:11], s66 offen offset:0 lds
    buffer_load_dwordx4 v3, s[8:11], s66 offen offset:1024 lds
    buffer_load_dwordx4 v4, s[8:11], s66 offen offset:2048 lds
    buffer_load_dwordx4 v5, s[8:11], s66 offen offset:3072 lds
    buffer_load_dwordx4 a[160:163], v6, s[12:15], s67 offen offset:0 sc1
    buffer_load_dwordx4 a[164:167], v6, s[12:15], s67 offen offset:1024 sc1
    buffer_load_dwordx4 a[168:171], v6, s[12:15], s67 offen offset:2048 sc1
    buffer_load_dwordx4 a[172:175], v6, s[12:15], s67 offen offset:3072 sc1
    s_add_u32 s67, s67, 65536
    v_mfma_f32_16x16x32_bf16 v[112:115], a[192:195], v[48:51], 0
    ds_read_b64_tr_b16 v[80:81], v40 offset:40960
    v_accvgpr_read_b32 v244, a0
    v_mfma_f32_16x16x32_bf16 v[116:119], a[196:199], v[48:51], 0
    ds_read_b64_tr_b16 v[82:83], v40 offset:45056
    s_add_u32 m0, s69, 102400
    v_mfma_f32_16x16x32_bf16 v[120:123], a[200:203], v[48:51], 0
    ds_read_b64_tr_b16 v[84:85], v41 offset:40960
    s_add_u32 s66, s66, 65536
    v_mfma_f32_16x16x32_bf16 v[124:127], a[204:207], v[48:51], 0
    ds_read_b64_tr_b16 v[86:87], v41 offset:45056
    buffer_load_dwordx4 v2, s[8:11], s66 offen offset:0 lds
    v_mfma_f32_16x16x32_bf16 v[128:131], a[192:195], v[52:55], 0
    buffer_load_dwordx4 v3, s[8:11], s66 offen offset:1024 lds
    v_accvgpr_read_b32 v245, a1
    v_mfma_f32_16x16x32_bf16 v[132:135], a[196:199], v[52:55], 0
    ds_read_b64_tr_b16 v[88:89], v42 offset:40960
    v_accvgpr_read_b32 v246, a2
    v_mfma_f32_16x16x32_bf16 v[136:139], a[200:203], v[52:55], 0
    ds_read_b64_tr_b16 v[90:91], v42 offset:45056
    v_accvgpr_read_b32 v247, a3
    v_mfma_f32_16x16x32_bf16 v[140:143], a[204:207], v[52:55], 0
    ds_read_b64_tr_b16 v[92:93], v43 offset:40960
    v_accvgpr_read_b32 v248, a8
    v_mfma_f32_16x16x32_bf16 v[144:147], a[192:195], v[56:59], 0
    ds_read_b64_tr_b16 v[94:95], v43 offset:45056
    buffer_load_dwordx4 v4, s[8:11], s66 offen offset:2048 lds
    v_mfma_f32_16x16x32_bf16 v[148:151], a[196:199], v[56:59], 0
    v_accvgpr_read_b32 v249, a9
    v_accvgpr_read_b32 v250, a10
    v_mfma_f32_16x16x32_bf16 v[152:155], a[200:203], v[56:59], 0
    ds_read_b64_tr_b16 v[96:97], v44 offset:40960
    v_accvgpr_read_b32 v251, a11
    v_mfma_f32_16x16x32_bf16 v[156:159], a[204:207], v[56:59], 0
    ds_read_b64_tr_b16 v[98:99], v44 offset:45056
    v_mul_f32 v244, v244, v241
    v_mfma_f32_16x16x32_bf16 v[160:163], a[192:195], v[60:63], 0
    ds_read_b64_tr_b16 v[100:101], v45 offset:40960
    buffer_load_dwordx4 v5, s[8:11], s66 offen offset:3072 lds
    v_mfma_f32_16x16x32_bf16 v[164:167], a[196:199], v[60:63], 0
    ds_read_b64_tr_b16 v[102:103], v45 offset:45056
    v_mul_f32 v245, v245, v241
    v_mfma_f32_16x16x32_bf16 v[168:171], a[200:203], v[60:63], 0
    v_mul_f32 v246, v246, v241
    v_mul_f32 v247, v247, v241
    v_mfma_f32_16x16x32_bf16 v[172:175], a[204:207], v[60:63], 0
    ds_read_b64_tr_b16 v[104:105], v46 offset:40960
    v_mul_f32 v248, v248, v241
    v_mfma_f32_16x16x32_bf16 v[176:179], a[192:195], v[64:67], 0
    ds_read_b64_tr_b16 v[106:107], v46 offset:45056
    buffer_load_dwordx4 a[176:179], v6, s[12:15], s67 offen offset:0 sc1
    v_mfma_f32_16x16x32_bf16 v[180:183], a[196:199], v[64:67], 0
    ds_read_b64_tr_b16 v[108:109], v47 offset:40960
    v_mul_f32 v249, v249, v241
    v_mfma_f32_16x16x32_bf16 v[184:187], a[200:203], v[64:67], 0
    ds_read_b64_tr_b16 v[110:111], v47 offset:45056
    v_mul_f32 v250, v250, v241
    v_mfma_f32_16x16x32_bf16 v[188:191], a[204:207], v[64:67], 0
    v_mul_f32 v251, v251, v241
    v_cvt_pk_bf16_f32 v252, v244, v245
    v_mfma_f32_16x16x32_bf16 v[192:195], a[192:195], v[68:71], 0
    buffer_load_dwordx4 a[180:183], v6, s[12:15], s67 offen offset:1024 sc1
    v_cvt_pk_bf16_f32 v253, v246, v247
    v_mfma_f32_16x16x32_bf16 v[196:199], a[196:199], v[68:71], 0
    v_cvt_pk_bf16_f32 v254, v248, v249
    v_cvt_pk_bf16_f32 v255, v250, v251
    v_mfma_f32_16x16x32_bf16 v[200:203], a[200:203], v[68:71], 0
    buffer_store_dwordx4 v[252:255], v23, s[24:27], s4 offen offset:0 sc1
    v_accvgpr_read_b32 v244, a4
    v_mfma_f32_16x16x32_bf16 v[204:207], a[204:207], v[68:71], 0
    v_accvgpr_read_b32 v245, a5
    v_accvgpr_read_b32 v246, a6
    v_mfma_f32_16x16x32_bf16 v[208:211], a[192:195], v[72:75], 0
    buffer_load_dwordx4 a[184:187], v6, s[12:15], s67 offen offset:2048 sc1
    v_accvgpr_read_b32 v247, a7
    v_mfma_f32_16x16x32_bf16 v[212:215], a[196:199], v[72:75], 0
    v_accvgpr_read_b32 v248, a12
    v_accvgpr_read_b32 v249, a13
    v_mfma_f32_16x16x32_bf16 v[216:219], a[200:203], v[72:75], 0
    v_accvgpr_read_b32 v250, a14
    v_accvgpr_read_b32 v251, a15
    v_mfma_f32_16x16x32_bf16 v[220:223], a[204:207], v[72:75], 0
    v_mul_f32 v244, v244, v241
    v_mul_f32 v245, v245, v241
    v_mfma_f32_16x16x32_bf16 v[224:227], a[192:195], v[76:79], 0
    buffer_load_dwordx4 a[188:191], v6, s[12:15], s67 offen offset:3072 sc1
    v_mul_f32 v246, v246, v241
    v_mfma_f32_16x16x32_bf16 v[228:231], a[196:199], v[76:79], 0
    v_mul_f32 v247, v247, v241
    v_mul_f32 v248, v248, v241
    v_mfma_f32_16x16x32_bf16 v[232:235], a[200:203], v[76:79], 0
    v_mul_f32 v249, v249, v241
    v_mul_f32 v250, v250, v241
    v_mfma_f32_16x16x32_bf16 v[236:239], a[204:207], v[76:79], 0
    v_mul_f32 v251, v251, v241
    v_cvt_pk_bf16_f32 v252, v244, v245
    s_add_u32 s67, s67, 196608
    v_cvt_pk_bf16_f32 v253, v246, v247
    v_cvt_pk_bf16_f32 v254, v248, v249
    v_cvt_pk_bf16_f32 v255, v250, v251
    buffer_store_dwordx4 v[252:255], v25, s[24:27], s4 offen offset:512 sc1
    v_accvgpr_read_b32 v244, a16
    v_accvgpr_read_b32 v245, a17
    v_accvgpr_read_b32 v246, a18
    v_accvgpr_read_b32 v247, a19
    v_accvgpr_read_b32 v248, a24
    v_accvgpr_read_b32 v249, a25
    v_accvgpr_read_b32 v250, a26
    v_accvgpr_read_b32 v251, a27
    v_mul_f32 v244, v244, v243
    v_mul_f32 v245, v245, v243
    v_mul_f32 v246, v246, v243
    v_mul_f32 v247, v247, v243
    v_mul_f32 v248, v248, v243
    v_mul_f32 v249, v249, v243
    v_mul_f32 v250, v250, v243
    v_mul_f32 v251, v251, v243
    v_cvt_pk_bf16_f32 v252, v244, v245
    v_cvt_pk_bf16_f32 v253, v246, v247
    v_cvt_pk_bf16_f32 v254, v248, v249
    v_cvt_pk_bf16_f32 v255, v250, v251
    buffer_store_dwordx4 v[252:255], v23, s[24:27], s4 offen offset:2048 sc1
    v_accvgpr_read_b32 v244, a20
    v_accvgpr_read_b32 v245, a21
    v_accvgpr_read_b32 v246, a22
    v_accvgpr_read_b32 v247, a23
    v_accvgpr_read_b32 v248, a28
    v_accvgpr_read_b32 v249, a29
    v_accvgpr_read_b32 v250, a30
    v_accvgpr_read_b32 v251, a31
    v_mul_f32 v244, v244, v243
    v_mul_f32 v245, v245, v243
    v_mul_f32 v246, v246, v243
    v_mul_f32 v247, v247, v243
    v_mul_f32 v248, v248, v243
    v_mul_f32 v249, v249, v243
    v_mul_f32 v250, v250, v243
    v_mul_f32 v251, v251, v243
    v_cvt_pk_bf16_f32 v252, v244, v245
    v_cvt_pk_bf16_f32 v253, v246, v247
    v_cvt_pk_bf16_f32 v254, v248, v249
    v_cvt_pk_bf16_f32 v255, v250, v251
    buffer_store_dwordx4 v[252:255], v25, s[24:27], s4 offen offset:2560 sc1
    s_add_u32 s4, s4, 131072
    s_waitcnt vmcnt(36) lgkmcnt(0)
    s_barrier
    v_mfma_f32_16x16x32_bf16 v[112:115], a[208:211], v[80:83], v[112:115]
    ds_read_b64_tr_b16 v[48:49], v32 offset:0
    v_accvgpr_read_b32 v244, a32
    v_mfma_f32_16x16x32_bf16 v[116:119], a[212:215], v[80:83], v[116:119]
    ds_read_b64_tr_b16 v[50:51], v32 offset:4096
    s_add_u32 m0, s69, 131072
    v_mfma_f32_16x16x32_bf16 v[120:123], a[216:219], v[80:83], v[120:123]
    ds_read_b64_tr_b16 v[52:53], v33 offset:0
    s_add_u32 s66, s66, 458752
    v_mfma_f32_16x16x32_bf16 v[124:127], a[220:223], v[80:83], v[124:127]
    ds_read_b64_tr_b16 v[54:55], v33 offset:4096
    buffer_load_dwordx4 v2, s[8:11], s66 offen offset:0 lds
    v_mfma_f32_16x16x32_bf16 v[128:131], a[208:211], v[84:87], v[128:131]
    buffer_load_dwordx4 v3, s[8:11], s66 offen offset:1024 lds
    v_accvgpr_read_b32 v245, a33
    v_mfma_f32_16x16x32_bf16 v[132:135], a[212:215], v[84:87], v[132:135]
    ds_read_b64_tr_b16 v[56:57], v34 offset:0
    v_accvgpr_read_b32 v246, a34
    v_mfma_f32_16x16x32_bf16 v[136:139], a[216:219], v[84:87], v[136:139]
    ds_read_b64_tr_b16 v[58:59], v34 offset:4096
    v_accvgpr_read_b32 v247, a35
    v_mfma_f32_16x16x32_bf16 v[140:143], a[220:223], v[84:87], v[140:143]
    ds_read_b64_tr_b16 v[60:61], v35 offset:0
    v_accvgpr_read_b32 v248, a40
    v_mfma_f32_16x16x32_bf16 v[144:147], a[208:211], v[88:91], v[144:147]
    ds_read_b64_tr_b16 v[62:63], v35 offset:4096
    buffer_load_dwordx4 v4, s[8:11], s66 offen offset:2048 lds
    v_mfma_f32_16x16x32_bf16 v[148:151], a[212:215], v[88:91], v[148:151]
    v_accvgpr_read_b32 v249, a41
    v_accvgpr_read_b32 v250, a42
    v_mfma_f32_16x16x32_bf16 v[152:155], a[216:219], v[88:91], v[152:155]
    ds_read_b64_tr_b16 v[64:65], v36 offset:0
    v_accvgpr_read_b32 v251, a43
    v_mfma_f32_16x16x32_bf16 v[156:159], a[220:223], v[88:91], v[156:159]
    ds_read_b64_tr_b16 v[66:67], v36 offset:4096
    v_mul_f32 v244, v244, v241
    v_mfma_f32_16x16x32_bf16 v[160:163], a[208:211], v[92:95], v[160:163]
    ds_read_b64_tr_b16 v[68:69], v37 offset:0
    buffer_load_dwordx4 v5, s[8:11], s66 offen offset:3072 lds
    v_mfma_f32_16x16x32_bf16 v[164:167], a[212:215], v[92:95], v[164:167]
    ds_read_b64_tr_b16 v[70:71], v37 offset:4096
    v_mul_f32 v245, v245, v241
    v_mfma_f32_16x16x32_bf16 v[168:171], a[216:219], v[92:95], v[168:171]
    v_mul_f32 v246, v246, v241
    v_mul_f32 v247, v247, v241
    v_mfma_f32_16x16x32_bf16 v[172:175], a[220:223], v[92:95], v[172:175]
    ds_read_b64_tr_b16 v[72:73], v38 offset:0
    v_mul_f32 v248, v248, v241
    v_mfma_f32_16x16x32_bf16 v[176:179], a[208:211], v[96:99], v[176:179]
    ds_read_b64_tr_b16 v[74:75], v38 offset:4096
    buffer_load_dwordx4 a[192:195], v6, s[12:15], s67 offen offset:0 sc1
    v_mfma_f32_16x16x32_bf16 v[180:183], a[212:215], v[96:99], v[180:183]
    ds_read_b64_tr_b16 v[76:77], v39 offset:0
    v_mul_f32 v249, v249, v241
    v_mfma_f32_16x16x32_bf16 v[184:187], a[216:219], v[96:99], v[184:187]
    ds_read_b64_tr_b16 v[78:79], v39 offset:4096
    v_mul_f32 v250, v250, v241
    v_mfma_f32_16x16x32_bf16 v[188:191], a[220:223], v[96:99], v[188:191]
    v_mul_f32 v251, v251, v241
    v_cvt_pk_bf16_f32 v252, v244, v245
    v_mfma_f32_16x16x32_bf16 v[192:195], a[208:211], v[100:103], v[192:195]
    buffer_load_dwordx4 a[196:199], v6, s[12:15], s67 offen offset:1024 sc1
    v_cvt_pk_bf16_f32 v253, v246, v247
    v_mfma_f32_16x16x32_bf16 v[196:199], a[212:215], v[100:103], v[196:199]
    v_cvt_pk_bf16_f32 v254, v248, v249
    v_cvt_pk_bf16_f32 v255, v250, v251
    v_mfma_f32_16x16x32_bf16 v[200:203], a[216:219], v[100:103], v[200:203]
    buffer_store_dwordx4 v[252:255], v23, s[24:27], s4 offen offset:0 sc1
    v_accvgpr_read_b32 v244, a36
    v_mfma_f32_16x16x32_bf16 v[204:207], a[220:223], v[100:103], v[204:207]
    v_accvgpr_read_b32 v245, a37
    v_accvgpr_read_b32 v246, a38
    v_mfma_f32_16x16x32_bf16 v[208:211], a[208:211], v[104:107], v[208:211]
    buffer_load_dwordx4 a[200:203], v6, s[12:15], s67 offen offset:2048 sc1
    v_accvgpr_read_b32 v247, a39
    v_mfma_f32_16x16x32_bf16 v[212:215], a[212:215], v[104:107], v[212:215]
    v_accvgpr_read_b32 v248, a44
    v_accvgpr_read_b32 v249, a45
    v_mfma_f32_16x16x32_bf16 v[216:219], a[216:219], v[104:107], v[216:219]
    v_accvgpr_read_b32 v250, a46
    v_accvgpr_read_b32 v251, a47
    v_mfma_f32_16x16x32_bf16 v[220:223], a[220:223], v[104:107], v[220:223]
    v_mul_f32 v244, v244, v241
    v_mul_f32 v245, v245, v241
    v_mfma_f32_16x16x32_bf16 v[224:227], a[208:211], v[108:111], v[224:227]
    buffer_load_dwordx4 a[204:207], v6, s[12:15], s67 offen offset:3072 sc1
    v_mul_f32 v246, v246, v241
    v_mfma_f32_16x16x32_bf16 v[228:231], a[212:215], v[108:111], v[228:231]
    v_mul_f32 v247, v247, v241
    v_mul_f32 v248, v248, v241
    v_mfma_f32_16x16x32_bf16 v[232:235], a[216:219], v[108:111], v[232:235]
    v_mul_f32 v249, v249, v241
    v_mul_f32 v250, v250, v241
    v_mfma_f32_16x16x32_bf16 v[236:239], a[220:223], v[108:111], v[236:239]
    v_mul_f32 v251, v251, v241
    v_cvt_pk_bf16_f32 v252, v244, v245
    s_add_u32 s67, s67, 65536
    v_cvt_pk_bf16_f32 v253, v246, v247
    v_cvt_pk_bf16_f32 v254, v248, v249
    v_cvt_pk_bf16_f32 v255, v250, v251
    buffer_store_dwordx4 v[252:255], v25, s[24:27], s4 offen offset:512 sc1
    v_accvgpr_read_b32 v244, a48
    v_accvgpr_read_b32 v245, a49
    v_accvgpr_read_b32 v246, a50
    v_accvgpr_read_b32 v247, a51
    v_accvgpr_read_b32 v248, a56
    v_accvgpr_read_b32 v249, a57
    v_accvgpr_read_b32 v250, a58
    v_accvgpr_read_b32 v251, a59
    v_mul_f32 v244, v244, v243
    v_mul_f32 v245, v245, v243
    v_mul_f32 v246, v246, v243
    v_mul_f32 v247, v247, v243
    v_mul_f32 v248, v248, v243
    v_mul_f32 v249, v249, v243
    v_mul_f32 v250, v250, v243
    v_mul_f32 v251, v251, v243
    v_cvt_pk_bf16_f32 v252, v244, v245
    v_cvt_pk_bf16_f32 v253, v246, v247
    v_cvt_pk_bf16_f32 v254, v248, v249
    v_cvt_pk_bf16_f32 v255, v250, v251
    buffer_store_dwordx4 v[252:255], v23, s[24:27], s4 offen offset:2048 sc1
    v_accvgpr_read_b32 v244, a52
    v_accvgpr_read_b32 v245, a53
    v_accvgpr_read_b32 v246, a54
    v_accvgpr_read_b32 v247, a55
    v_accvgpr_read_b32 v248, a60
    v_accvgpr_read_b32 v249, a61
    v_accvgpr_read_b32 v250, a62
    v_accvgpr_read_b32 v251, a63
    v_mul_f32 v244, v244, v243
    v_mul_f32 v245, v245, v243
    v_mul_f32 v246, v246, v243
    v_mul_f32 v247, v247, v243
    v_mul_f32 v248, v248, v243
    v_mul_f32 v249, v249, v243
    v_mul_f32 v250, v250, v243
    v_mul_f32 v251, v251, v243
    v_cvt_pk_bf16_f32 v252, v244, v245
    v_cvt_pk_bf16_f32 v253, v246, v247
    v_cvt_pk_bf16_f32 v254, v248, v249
    v_cvt_pk_bf16_f32 v255, v250, v251
    buffer_store_dwordx4 v[252:255], v25, s[24:27], s4 offen offset:2560 sc1
    s_add_u32 s4, s4, 131072
    s_waitcnt lgkmcnt(0)
    v_mfma_f32_16x16x32_bf16 v[112:115], a[224:227], v[48:51], v[112:115]
    ds_read_b64_tr_b16 v[80:81], v32 offset:8192
    v_accvgpr_read_b32 v244, a64
    v_mfma_f32_16x16x32_bf16 v[116:119], a[228:231], v[48:51], v[116:119]
    ds_read_b64_tr_b16 v[82:83], v32 offset:12288
    s_add_u32 m0, s69, 135168
    v_mfma_f32_16x16x32_bf16 v[120:123], a[232:235], v[48:51], v[120:123]
    ds_read_b64_tr_b16 v[84:85], v33 offset:8192
    s_add_u32 s66, s66, 65536
    v_mfma_f32_16x16x32_bf16 v[124:127], a[236:239], v[48:51], v[124:127]
    ds_read_b64_tr_b16 v[86:87], v33 offset:12288
    buffer_load_dwordx4 v2, s[8:11], s66 offen offset:0 lds
    v_mfma_f32_16x16x32_bf16 v[128:131], a[224:227], v[52:55], v[128:131]
    buffer_load_dwordx4 v3, s[8:11], s66 offen offset:1024 lds
    v_accvgpr_read_b32 v245, a65
    v_mfma_f32_16x16x32_bf16 v[132:135], a[228:231], v[52:55], v[132:135]
    ds_read_b64_tr_b16 v[88:89], v34 offset:8192
    v_accvgpr_read_b32 v246, a66
    v_mfma_f32_16x16x32_bf16 v[136:139], a[232:235], v[52:55], v[136:139]
    ds_read_b64_tr_b16 v[90:91], v34 offset:12288
    v_accvgpr_read_b32 v247, a67
    v_mfma_f32_16x16x32_bf16 v[140:143], a[236:239], v[52:55], v[140:143]
    ds_read_b64_tr_b16 v[92:93], v35 offset:8192
    v_accvgpr_read_b32 v248, a72
    v_mfma_f32_16x16x32_bf16 v[144:147], a[224:227], v[56:59], v[144:147]
    ds_read_b64_tr_b16 v[94:95], v35 offset:12288
    buffer_load_dwordx4 v4, s[8:11], s66 offen offset:2048 lds
    v_mfma_f32_16x16x32_bf16 v[148:151], a[228:231], v[56:59], v[148:151]
    v_accvgpr_read_b32 v249, a73
    v_accvgpr_read_b32 v250, a74
    v_mfma_f32_16x16x32_bf16 v[152:155], a[232:235], v[56:59], v[152:155]
    ds_read_b64_tr_b16 v[96:97], v36 offset:8192
    v_accvgpr_read_b32 v251, a75
    v_mfma_f32_16x16x32_bf16 v[156:159], a[236:239], v[56:59], v[156:159]
    ds_read_b64_tr_b16 v[98:99], v36 offset:12288
    v_mul_f32 v244, v244, v241
    v_mfma_f32_16x16x32_bf16 v[160:163], a[224:227], v[60:63], v[160:163]
    ds_read_b64_tr_b16 v[100:101], v37 offset:8192
    buffer_load_dwordx4 v5, s[8:11], s66 offen offset:3072 lds
    v_mfma_f32_16x16x32_bf16 v[164:167], a[228:231], v[60:63], v[164:167]
    ds_read_b64_tr_b16 v[102:103], v37 offset:12288
    v_mul_f32 v245, v245, v241
    v_mfma_f32_16x16x32_bf16 v[168:171], a[232:235], v[60:63], v[168:171]
    v_mul_f32 v246, v246, v241
    v_mul_f32 v247, v247, v241
    v_mfma_f32_16x16x32_bf16 v[172:175], a[236:239], v[60:63], v[172:175]
    ds_read_b64_tr_b16 v[104:105], v38 offset:8192
    v_mul_f32 v248, v248, v241
    v_mfma_f32_16x16x32_bf16 v[176:179], a[224:227], v[64:67], v[176:179]
    ds_read_b64_tr_b16 v[106:107], v38 offset:12288
    buffer_load_dwordx4 a[208:211], v6, s[12:15], s67 offen offset:0 sc1
    v_mfma_f32_16x16x32_bf16 v[180:183], a[228:231], v[64:67], v[180:183]
    ds_read_b64_tr_b16 v[108:109], v39 offset:8192
    v_mul_f32 v249, v249, v241
    v_mfma_f32_16x16x32_bf16 v[184:187], a[232:235], v[64:67], v[184:187]
    ds_read_b64_tr_b16 v[110:111], v39 offset:12288
    v_mul_f32 v250, v250, v241
    v_mfma_f32_16x16x32_bf16 v[188:191], a[236:239], v[64:67], v[188:191]
    v_mul_f32 v251, v251, v241
    v_cvt_pk_bf16_f32 v252, v244, v245
    v_mfma_f32_16x16x32_bf16 v[192:195], a[224:227], v[68:71], v[192:195]
    buffer_load_dwordx4 a[212:215], v6, s[12:15], s67 offen offset:1024 sc1
    v_cvt_pk_bf16_f32 v253, v246, v247
    v_mfma_f32_16x16x32_bf16 v[196:199], a[228:231], v[68:71], v[196:199]
    v_cvt_pk_bf16_f32 v254, v248, v249
    v_cvt_pk_bf16_f32 v255, v250, v251
    v_mfma_f32_16x16x32_bf16 v[200:203], a[232:235], v[68:71], v[200:203]
    buffer_store_dwordx4 v[252:255], v23, s[24:27], s4 offen offset:0 sc1
    v_accvgpr_read_b32 v244, a68
    v_mfma_f32_16x16x32_bf16 v[204:207], a[236:239], v[68:71], v[204:207]
    v_accvgpr_read_b32 v245, a69
    v_accvgpr_read_b32 v246, a70
    v_mfma_f32_16x16x32_bf16 v[208:211], a[224:227], v[72:75], v[208:211]
    buffer_load_dwordx4 a[216:219], v6, s[12:15], s67 offen offset:2048 sc1
    v_accvgpr_read_b32 v247, a71
    v_mfma_f32_16x16x32_bf16 v[212:215], a[228:231], v[72:75], v[212:215]
    v_accvgpr_read_b32 v248, a76
    v_accvgpr_read_b32 v249, a77
    v_mfma_f32_16x16x32_bf16 v[216:219], a[232:235], v[72:75], v[216:219]
    v_accvgpr_read_b32 v250, a78
    v_accvgpr_read_b32 v251, a79
    v_mfma_f32_16x16x32_bf16 v[220:223], a[236:239], v[72:75], v[220:223]
    v_mul_f32 v244, v244, v241
    v_mul_f32 v245, v245, v241
    v_mfma_f32_16x16x32_bf16 v[224:227], a[224:227], v[76:79], v[224:227]
    buffer_load_dwordx4 a[220:223], v6, s[12:15], s67 offen offset:3072 sc1
    v_mul_f32 v246, v246, v241
    v_mfma_f32_16x16x32_bf16 v[228:231], a[228:231], v[76:79], v[228:231]
    v_mul_f32 v247, v247, v241
    v_mul_f32 v248, v248, v241
    v_mfma_f32_16x16x32_bf16 v[232:235], a[232:235], v[76:79], v[232:235]
    v_mul_f32 v249, v249, v241
    v_mul_f32 v250, v250, v241
    v_mfma_f32_16x16x32_bf16 v[236:239], a[236:239], v[76:79], v[236:239]
    v_mul_f32 v251, v251, v241
    v_cvt_pk_bf16_f32 v252, v244, v245
    s_add_u32 s67, s67, 196608
    v_cvt_pk_bf16_f32 v253, v246, v247
    v_cvt_pk_bf16_f32 v254, v248, v249
    v_cvt_pk_bf16_f32 v255, v250, v251
    buffer_store_dwordx4 v[252:255], v25, s[24:27], s4 offen offset:512 sc1
    v_accvgpr_read_b32 v244, a80
    v_accvgpr_read_b32 v245, a81
    v_accvgpr_read_b32 v246, a82
    v_accvgpr_read_b32 v247, a83
    v_accvgpr_read_b32 v248, a88
    v_accvgpr_read_b32 v249, a89
    v_accvgpr_read_b32 v250, a90
    v_accvgpr_read_b32 v251, a91
    v_mul_f32 v244, v244, v243
    v_mul_f32 v245, v245, v243
    v_mul_f32 v246, v246, v243
    v_mul_f32 v247, v247, v243
    v_mul_f32 v248, v248, v243
    v_mul_f32 v249, v249, v243
    v_mul_f32 v250, v250, v243
    v_mul_f32 v251, v251, v243
    v_cvt_pk_bf16_f32 v252, v244, v245
    v_cvt_pk_bf16_f32 v253, v246, v247
    v_cvt_pk_bf16_f32 v254, v248, v249
    v_cvt_pk_bf16_f32 v255, v250, v251
    buffer_store_dwordx4 v[252:255], v23, s[24:27], s4 offen offset:2048 sc1
    v_accvgpr_read_b32 v244, a84
    v_accvgpr_read_b32 v245, a85
    v_accvgpr_read_b32 v246, a86
    v_accvgpr_read_b32 v247, a87
    v_accvgpr_read_b32 v248, a92
    v_accvgpr_read_b32 v249, a93
    v_accvgpr_read_b32 v250, a94
    v_accvgpr_read_b32 v251, a95
    v_mul_f32 v244, v244, v243
    v_mul_f32 v245, v245, v243
    v_mul_f32 v246, v246, v243
    v_mul_f32 v247, v247, v243
    v_mul_f32 v248, v248, v243
    v_mul_f32 v249, v249, v243
    v_mul_f32 v250, v250, v243
    v_mul_f32 v251, v251, v243
    v_cvt_pk_bf16_f32 v252, v244, v245
    v_cvt_pk_bf16_f32 v253, v246, v247
    v_cvt_pk_bf16_f32 v254, v248, v249
    v_cvt_pk_bf16_f32 v255, v250, v251
    buffer_store_dwordx4 v[252:255], v25, s[24:27], s4 offen offset:2560 sc1
    s_add_u32 s4, s4, 131072
    s_waitcnt vmcnt(44) lgkmcnt(0)
    s_barrier
    v_mfma_f32_16x16x32_bf16 v[112:115], a[240:243], v[80:83], v[112:115]
    ds_read_b64_tr_b16 v[48:49], v32 offset:32768
    v_accvgpr_read_b32 v244, a96
    v_mfma_f32_16x16x32_bf16 v[116:119], a[244:247], v[80:83], v[116:119]
    ds_read_b64_tr_b16 v[50:51], v32 offset:36864
    s_add_u32 m0, s69, 0
    v_mfma_f32_16x16x32_bf16 v[120:123], a[248:251], v[80:83], v[120:123]
    ds_read_b64_tr_b16 v[52:53], v33 offset:32768
    s_add_u32 s66, s66, 458752
    v_mfma_f32_16x16x32_bf16 v[124:127], a[252:255], v[80:83], v[124:127]
    ds_read_b64_tr_b16 v[54:55], v33 offset:36864
    buffer_load_dwordx4 v2, s[8:11], s66 offen offset:0 lds
    v_mfma_f32_16x16x32_bf16 v[128:131], a[240:243], v[84:87], v[128:131]
    buffer_load_dwordx4 v3, s[8:11], s66 offen offset:1024 lds
    v_accvgpr_read_b32 v245, a97
    v_mfma_f32_16x16x32_bf16 v[132:135], a[244:247], v[84:87], v[132:135]
    ds_read_b64_tr_b16 v[56:57], v34 offset:32768
    v_accvgpr_read_b32 v246, a98
    v_mfma_f32_16x16x32_bf16 v[136:139], a[248:251], v[84:87], v[136:139]
    ds_read_b64_tr_b16 v[58:59], v34 offset:36864
    v_accvgpr_read_b32 v247, a99
    v_mfma_f32_16x16x32_bf16 v[140:143], a[252:255], v[84:87], v[140:143]
    ds_read_b64_tr_b16 v[60:61], v35 offset:32768
    v_accvgpr_read_b32 v248, a104
    v_mfma_f32_16x16x32_bf16 v[144:147], a[240:243], v[88:91], v[144:147]
    ds_read_b64_tr_b16 v[62:63], v35 offset:36864
    buffer_load_dwordx4 v4, s[8:11], s66 offen offset:2048 lds
    v_mfma_f32_16x16x32_bf16 v[148:151], a[244:247], v[88:91], v[148:151]
    v_accvgpr_read_b32 v249, a105
    v_accvgpr_read_b32 v250, a106
    v_mfma_f32_16x16x32_bf16 v[152:155], a[248:251], v[88:91], v[152:155]
    ds_read_b64_tr_b16 v[64:65], v36 offset:32768
    v_accvgpr_read_b32 v251, a107
    v_mfma_f32_16x16x32_bf16 v[156:159], a[252:255], v[88:91], v[156:159]
    ds_read_b64_tr_b16 v[66:67], v36 offset:36864
    v_mul_f32 v244, v244, v241
    v_mfma_f32_16x16x32_bf16 v[160:163], a[240:243], v[92:95], v[160:163]
    ds_read_b64_tr_b16 v[68:69], v37 offset:32768
    buffer_load_dwordx4 v5, s[8:11], s66 offen offset:3072 lds
    v_mfma_f32_16x16x32_bf16 v[164:167], a[244:247], v[92:95], v[164:167]
    ds_read_b64_tr_b16 v[70:71], v37 offset:36864
    v_mul_f32 v245, v245, v241
    v_mfma_f32_16x16x32_bf16 v[168:171], a[248:251], v[92:95], v[168:171]
    v_mul_f32 v246, v246, v241
    v_mul_f32 v247, v247, v241
    v_mfma_f32_16x16x32_bf16 v[172:175], a[252:255], v[92:95], v[172:175]
    ds_read_b64_tr_b16 v[72:73], v38 offset:32768
    v_mul_f32 v248, v248, v241
    v_mfma_f32_16x16x32_bf16 v[176:179], a[240:243], v[96:99], v[176:179]
    ds_read_b64_tr_b16 v[74:75], v38 offset:36864
    buffer_load_dwordx4 a[224:227], v6, s[12:15], s67 offen offset:0 sc1
    v_mfma_f32_16x16x32_bf16 v[180:183], a[244:247], v[96:99], v[180:183]
    ds_read_b64_tr_b16 v[76:77], v39 offset:32768
    v_mul_f32 v249, v249, v241
    v_mfma_f32_16x16x32_bf16 v[184:187], a[248:251], v[96:99], v[184:187]
    ds_read_b64_tr_b16 v[78:79], v39 offset:36864
    v_mul_f32 v250, v250, v241
    v_mfma_f32_16x16x32_bf16 v[188:191], a[252:255], v[96:99], v[188:191]
    v_mul_f32 v251, v251, v241
    v_cvt_pk_bf16_f32 v252, v244, v245
    v_mfma_f32_16x16x32_bf16 v[192:195], a[240:243], v[100:103], v[192:195]
    buffer_load_dwordx4 a[228:231], v6, s[12:15], s67 offen offset:1024 sc1
    v_cvt_pk_bf16_f32 v253, v246, v247
    v_mfma_f32_16x16x32_bf16 v[196:199], a[244:247], v[100:103], v[196:199]
    v_cvt_pk_bf16_f32 v254, v248, v249
    v_cvt_pk_bf16_f32 v255, v250, v251
    v_mfma_f32_16x16x32_bf16 v[200:203], a[248:251], v[100:103], v[200:203]
    buffer_store_dwordx4 v[252:255], v23, s[24:27], s4 offen offset:0 sc1
    v_accvgpr_read_b32 v244, a100
    v_mfma_f32_16x16x32_bf16 v[204:207], a[252:255], v[100:103], v[204:207]
    v_accvgpr_read_b32 v245, a101
    v_accvgpr_read_b32 v246, a102
    v_mfma_f32_16x16x32_bf16 v[208:211], a[240:243], v[104:107], v[208:211]
    buffer_load_dwordx4 a[232:235], v6, s[12:15], s67 offen offset:2048 sc1
    v_accvgpr_read_b32 v247, a103
    v_mfma_f32_16x16x32_bf16 v[212:215], a[244:247], v[104:107], v[212:215]
    v_accvgpr_read_b32 v248, a108
    v_accvgpr_read_b32 v249, a109
    v_mfma_f32_16x16x32_bf16 v[216:219], a[248:251], v[104:107], v[216:219]
    v_accvgpr_read_b32 v250, a110
    v_accvgpr_read_b32 v251, a111
    v_mfma_f32_16x16x32_bf16 v[220:223], a[252:255], v[104:107], v[220:223]
    v_mul_f32 v244, v244, v241
    v_mul_f32 v245, v245, v241
    v_mfma_f32_16x16x32_bf16 v[224:227], a[240:243], v[108:111], v[224:227]
    buffer_load_dwordx4 a[236:239], v6, s[12:15], s67 offen offset:3072 sc1
    v_mul_f32 v246, v246, v241
    v_mfma_f32_16x16x32_bf16 v[228:231], a[244:247], v[108:111], v[228:231]
    v_mul_f32 v247, v247, v241
    v_mul_f32 v248, v248, v241
    v_mfma_f32_16x16x32_bf16 v[232:235], a[248:251], v[108:111], v[232:235]
    v_mul_f32 v249, v249, v241
    v_mul_f32 v250, v250, v241
    v_mfma_f32_16x16x32_bf16 v[236:239], a[252:255], v[108:111], v[236:239]
    v_mul_f32 v251, v251, v241
    v_cvt_pk_bf16_f32 v252, v244, v245
    s_add_u32 s67, s67, 65536
    v_cvt_pk_bf16_f32 v253, v246, v247
    v_cvt_pk_bf16_f32 v254, v248, v249
    v_cvt_pk_bf16_f32 v255, v250, v251
    buffer_store_dwordx4 v[252:255], v25, s[24:27], s4 offen offset:512 sc1
    v_accvgpr_read_b32 v244, a112
    v_accvgpr_read_b32 v245, a113
    v_accvgpr_read_b32 v246, a114
    v_accvgpr_read_b32 v247, a115
    v_accvgpr_read_b32 v248, a120
    v_accvgpr_read_b32 v249, a121
    v_accvgpr_read_b32 v250, a122
    v_accvgpr_read_b32 v251, a123
    v_mul_f32 v244, v244, v243
    v_mul_f32 v245, v245, v243
    v_mul_f32 v246, v246, v243
    v_mul_f32 v247, v247, v243
    v_mul_f32 v248, v248, v243
    v_mul_f32 v249, v249, v243
    v_mul_f32 v250, v250, v243
    v_mul_f32 v251, v251, v243
    v_cvt_pk_bf16_f32 v252, v244, v245
    v_cvt_pk_bf16_f32 v253, v246, v247
    v_cvt_pk_bf16_f32 v254, v248, v249
    v_cvt_pk_bf16_f32 v255, v250, v251
    buffer_store_dwordx4 v[252:255], v23, s[24:27], s4 offen offset:2048 sc1
    v_accvgpr_read_b32 v244, a116
    v_accvgpr_read_b32 v245, a117
    v_accvgpr_read_b32 v246, a118
    v_accvgpr_read_b32 v247, a119
    v_accvgpr_read_b32 v248, a124
    v_accvgpr_read_b32 v249, a125
    v_accvgpr_read_b32 v250, a126
    v_accvgpr_read_b32 v251, a127
    v_mul_f32 v244, v244, v243
    v_mul_f32 v245, v245, v243
    v_mul_f32 v246, v246, v243
    v_mul_f32 v247, v247, v243
    v_mul_f32 v248, v248, v243
    v_mul_f32 v249, v249, v243
    v_mul_f32 v250, v250, v243
    v_mul_f32 v251, v251, v243
    v_cvt_pk_bf16_f32 v252, v244, v245
    v_cvt_pk_bf16_f32 v253, v246, v247
    v_cvt_pk_bf16_f32 v254, v248, v249
    v_cvt_pk_bf16_f32 v255, v250, v251
    buffer_store_dwordx4 v[252:255], v25, s[24:27], s4 offen offset:2560 sc1
    s_waitcnt lgkmcnt(0)
    v_mfma_f32_16x16x32_bf16 v[112:115], a[128:131], v[48:51], v[112:115]
    ds_read_b64_tr_b16 v[80:81], v32 offset:40960
    s_mov_b32 s28, s58
    v_mfma_f32_16x16x32_bf16 v[116:119], a[132:135], v[48:51], v[116:119]
    ds_read_b64_tr_b16 v[82:83], v32 offset:45056
    s_add_u32 m0, s69, 4096
    v_mfma_f32_16x16x32_bf16 v[120:123], a[136:139], v[48:51], v[120:123]
    ds_read_b64_tr_b16 v[84:85], v33 offset:40960
    s_add_u32 s66, s66, 65536
    v_mfma_f32_16x16x32_bf16 v[124:127], a[140:143], v[48:51], v[124:127]
    ds_read_b64_tr_b16 v[86:87], v33 offset:45056
    buffer_load_dwordx4 v2, s[8:11], s66 offen offset:0 lds
    v_mfma_f32_16x16x32_bf16 v[128:131], a[128:131], v[52:55], v[128:131]
    buffer_load_dwordx4 v3, s[8:11], s66 offen offset:1024 lds
    s_mov_b32 s29, s59
    v_mfma_f32_16x16x32_bf16 v[132:135], a[132:135], v[52:55], v[132:135]
    ds_read_b64_tr_b16 v[88:89], v34 offset:40960
    s_mov_b32 s30, 0x1000
    v_mfma_f32_16x16x32_bf16 v[136:139], a[136:139], v[52:55], v[136:139]
    ds_read_b64_tr_b16 v[90:91], v34 offset:45056
    s_mov_b32 s31, 0x00020000
    v_mfma_f32_16x16x32_bf16 v[140:143], a[140:143], v[52:55], v[140:143]
    ds_read_b64_tr_b16 v[92:93], v35 offset:40960
    v_mfma_f32_16x16x32_bf16 v[144:147], a[128:131], v[56:59], v[144:147]
    ds_read_b64_tr_b16 v[94:95], v35 offset:45056
    buffer_load_dwordx4 v4, s[8:11], s66 offen offset:2048 lds
    v_mfma_f32_16x16x32_bf16 v[148:151], a[132:135], v[56:59], v[148:151]
    v_mfma_f32_16x16x32_bf16 v[152:155], a[136:139], v[56:59], v[152:155]
    ds_read_b64_tr_b16 v[96:97], v36 offset:40960
    v_mfma_f32_16x16x32_bf16 v[156:159], a[140:143], v[56:59], v[156:159]
    ds_read_b64_tr_b16 v[98:99], v36 offset:45056
    v_mfma_f32_16x16x32_bf16 v[160:163], a[128:131], v[60:63], v[160:163]
    ds_read_b64_tr_b16 v[100:101], v37 offset:40960
    buffer_load_dwordx4 v5, s[8:11], s66 offen offset:3072 lds
    v_mfma_f32_16x16x32_bf16 v[164:167], a[132:135], v[60:63], v[164:167]
    ds_read_b64_tr_b16 v[102:103], v37 offset:45056
    v_mfma_f32_16x16x32_bf16 v[168:171], a[136:139], v[60:63], v[168:171]
    v_mfma_f32_16x16x32_bf16 v[172:175], a[140:143], v[60:63], v[172:175]
    ds_read_b64_tr_b16 v[104:105], v38 offset:40960
    v_mfma_f32_16x16x32_bf16 v[176:179], a[128:131], v[64:67], v[176:179]
    ds_read_b64_tr_b16 v[106:107], v38 offset:45056
    buffer_load_dwordx4 a[240:243], v6, s[12:15], s67 offen offset:0 sc1
    v_mfma_f32_16x16x32_bf16 v[180:183], a[132:135], v[64:67], v[180:183]
    ds_read_b64_tr_b16 v[108:109], v39 offset:40960
    v_mfma_f32_16x16x32_bf16 v[184:187], a[136:139], v[64:67], v[184:187]
    ds_read_b64_tr_b16 v[110:111], v39 offset:45056
    v_mfma_f32_16x16x32_bf16 v[188:191], a[140:143], v[64:67], v[188:191]
    v_mfma_f32_16x16x32_bf16 v[192:195], a[128:131], v[68:71], v[192:195]
    buffer_load_dwordx4 a[244:247], v6, s[12:15], s67 offen offset:1024 sc1
    v_mfma_f32_16x16x32_bf16 v[196:199], a[132:135], v[68:71], v[196:199]
    v_mfma_f32_16x16x32_bf16 v[200:203], a[136:139], v[68:71], v[200:203]
    v_mfma_f32_16x16x32_bf16 v[204:207], a[140:143], v[68:71], v[204:207]
    v_mfma_f32_16x16x32_bf16 v[208:211], a[128:131], v[72:75], v[208:211]
    buffer_load_dwordx4 a[248:251], v6, s[12:15], s67 offen offset:2048 sc1
    v_mfma_f32_16x16x32_bf16 v[212:215], a[132:135], v[72:75], v[212:215]
    v_mfma_f32_16x16x32_bf16 v[216:219], a[136:139], v[72:75], v[216:219]
    v_mfma_f32_16x16x32_bf16 v[220:223], a[140:143], v[72:75], v[220:223]
    v_mfma_f32_16x16x32_bf16 v[224:227], a[128:131], v[76:79], v[224:227]
    buffer_load_dwordx4 a[252:255], v6, s[12:15], s67 offen offset:3072 sc1
    v_mfma_f32_16x16x32_bf16 v[228:231], a[132:135], v[76:79], v[228:231]
    v_mfma_f32_16x16x32_bf16 v[232:235], a[136:139], v[76:79], v[232:235]
    v_mfma_f32_16x16x32_bf16 v[236:239], a[140:143], v[76:79], v[236:239]
    s_add_u32 s67, s67, 196608
    s_waitcnt vmcnt(47) lgkmcnt(0)
    s_barrier
    v_mfma_f32_16x16x32_bf16 v[112:115], a[144:147], v[80:83], v[112:115]
    ds_read_b64_tr_b16 v[48:49], v40 offset:0
    v_and_b32 v252, 15, v1
    v_mfma_f32_16x16x32_bf16 v[116:119], a[148:151], v[80:83], v[116:119]
    ds_read_b64_tr_b16 v[50:51], v40 offset:4096
    s_add_u32 m0, s69, 32768
    v_mfma_f32_16x16x32_bf16 v[120:123], a[152:155], v[80:83], v[120:123]
    ds_read_b64_tr_b16 v[52:53], v41 offset:0
    s_add_u32 s66, s66, 458752
    v_mfma_f32_16x16x32_bf16 v[124:127], a[156:159], v[80:83], v[124:127]
    ds_read_b64_tr_b16 v[54:55], v41 offset:4096
    buffer_load_dwordx4 v2, s[8:11], s66 offen offset:0 lds
    v_mfma_f32_16x16x32_bf16 v[128:131], a[144:147], v[84:87], v[128:131]
    buffer_load_dwordx4 v3, s[8:11], s66 offen offset:1024 lds
    v_lshlrev_b32 v252, 1, v252
    v_mfma_f32_16x16x32_bf16 v[132:135], a[148:151], v[84:87], v[132:135]
    ds_read_b64_tr_b16 v[56:57], v42 offset:0
    s_lshl_b32 s86, s78, 1
    v_mfma_f32_16x16x32_bf16 v[136:139], a[152:155], v[84:87], v[136:139]
    ds_read_b64_tr_b16 v[58:59], v42 offset:4096
    s_add_u32 s86, s86, s72
    v_mfma_f32_16x16x32_bf16 v[140:143], a[156:159], v[84:87], v[140:143]
    ds_read_b64_tr_b16 v[60:61], v43 offset:0
    v_mfma_f32_16x16x32_bf16 v[144:147], a[144:147], v[88:91], v[144:147]
    ds_read_b64_tr_b16 v[62:63], v43 offset:4096
    buffer_load_dwordx4 v4, s[8:11], s66 offen offset:2048 lds
    v_mfma_f32_16x16x32_bf16 v[148:151], a[148:151], v[88:91], v[148:151]
    v_mfma_f32_16x16x32_bf16 v[152:155], a[152:155], v[88:91], v[152:155]
    ds_read_b64_tr_b16 v[64:65], v44 offset:0
    v_mfma_f32_16x16x32_bf16 v[156:159], a[156:159], v[88:91], v[156:159]
    ds_read_b64_tr_b16 v[66:67], v44 offset:4096
    v_mfma_f32_16x16x32_bf16 v[160:163], a[144:147], v[92:95], v[160:163]
    ds_read_b64_tr_b16 v[68:69], v45 offset:0
    buffer_load_dwordx4 v5, s[8:11], s66 offen offset:3072 lds
    v_mfma_f32_16x16x32_bf16 v[164:167], a[148:151], v[92:95], v[164:167]
    ds_read_b64_tr_b16 v[70:71], v45 offset:4096
    v_mfma_f32_16x16x32_bf16 v[168:171], a[152:155], v[92:95], v[168:171]
    v_mfma_f32_16x16x32_bf16 v[172:175], a[156:159], v[92:95], v[172:175]
    ds_read_b64_tr_b16 v[72:73], v46 offset:0
    v_mfma_f32_16x16x32_bf16 v[176:179], a[144:147], v[96:99], v[176:179]
    ds_read_b64_tr_b16 v[74:75], v46 offset:4096
    buffer_load_dwordx4 a[128:131], v6, s[12:15], s67 offen offset:0 sc1
    v_mfma_f32_16x16x32_bf16 v[180:183], a[148:151], v[96:99], v[180:183]
    ds_read_b64_tr_b16 v[76:77], v47 offset:0
    v_mfma_f32_16x16x32_bf16 v[184:187], a[152:155], v[96:99], v[184:187]
    ds_read_b64_tr_b16 v[78:79], v47 offset:4096
    v_mfma_f32_16x16x32_bf16 v[188:191], a[156:159], v[96:99], v[188:191]
    v_mfma_f32_16x16x32_bf16 v[192:195], a[144:147], v[100:103], v[192:195]
    buffer_load_dwordx4 a[132:135], v6, s[12:15], s67 offen offset:1024 sc1
    v_mfma_f32_16x16x32_bf16 v[196:199], a[148:151], v[100:103], v[196:199]
    v_mfma_f32_16x16x32_bf16 v[200:203], a[152:155], v[100:103], v[200:203]
    v_mfma_f32_16x16x32_bf16 v[204:207], a[156:159], v[100:103], v[204:207]
    v_mfma_f32_16x16x32_bf16 v[208:211], a[144:147], v[104:107], v[208:211]
    buffer_load_dwordx4 a[136:139], v6, s[12:15], s67 offen offset:2048 sc1
    v_mfma_f32_16x16x32_bf16 v[212:215], a[148:151], v[104:107], v[212:215]
    v_mfma_f32_16x16x32_bf16 v[216:219], a[152:155], v[104:107], v[216:219]
    v_mfma_f32_16x16x32_bf16 v[220:223], a[156:159], v[104:107], v[220:223]
    v_mfma_f32_16x16x32_bf16 v[224:227], a[144:147], v[108:111], v[224:227]
    buffer_load_dwordx4 a[140:143], v6, s[12:15], s67 offen offset:3072 sc1
    v_mfma_f32_16x16x32_bf16 v[228:231], a[148:151], v[108:111], v[228:231]
    v_mfma_f32_16x16x32_bf16 v[232:235], a[152:155], v[108:111], v[232:235]
    v_mfma_f32_16x16x32_bf16 v[236:239], a[156:159], v[108:111], v[236:239]
    s_add_u32 s67, s67, 65536
    s_waitcnt lgkmcnt(0)
    v_mfma_f32_16x16x32_bf16 v[112:115], a[160:163], v[48:51], v[112:115]
    ds_read_b64_tr_b16 v[80:81], v40 offset:8192
    s_lshl_b32 s86, s86, 7
    v_mfma_f32_16x16x32_bf16 v[116:119], a[164:167], v[48:51], v[116:119]
    ds_read_b64_tr_b16 v[82:83], v40 offset:12288
    s_add_u32 m0, s69, 36864
    v_mfma_f32_16x16x32_bf16 v[120:123], a[168:171], v[48:51], v[120:123]
    ds_read_b64_tr_b16 v[84:85], v41 offset:8192
    s_add_u32 s66, s66, 65536
    v_mfma_f32_16x16x32_bf16 v[124:127], a[172:175], v[48:51], v[124:127]
    ds_read_b64_tr_b16 v[86:87], v41 offset:12288
    buffer_load_dwordx4 v2, s[8:11], s66 offen offset:0 lds
    v_mfma_f32_16x16x32_bf16 v[128:131], a[160:163], v[52:55], v[128:131]
    buffer_load_dwordx4 v3, s[8:11], s66 offen offset:1024 lds
    buffer_load_ushort v8, v252, s[28:31], s86 offen offset:0
    v_mfma_f32_16x16x32_bf16 v[132:135], a[164:167], v[52:55], v[132:135]
    ds_read_b64_tr_b16 v[88:89], v42 offset:8192
    buffer_load_ushort v10, v252, s[28:31], s86 offen offset:32
    v_mfma_f32_16x16x32_bf16 v[136:139], a[168:171], v[52:55], v[136:139]
    ds_read_b64_tr_b16 v[90:91], v42 offset:12288
    buffer_load_ushort v12, v252, s[28:31], s86 offen offset:64
    v_mfma_f32_16x16x32_bf16 v[140:143], a[172:175], v[52:55], v[140:143]
    ds_read_b64_tr_b16 v[92:93], v43 offset:8192
    v_mfma_f32_16x16x32_bf16 v[144:147], a[160:163], v[56:59], v[144:147]
    ds_read_b64_tr_b16 v[94:95], v43 offset:12288
    buffer_load_dwordx4 v4, s[8:11], s66 offen offset:2048 lds
    v_mfma_f32_16x16x32_bf16 v[148:151], a[164:167], v[56:59], v[148:151]
    v_mfma_f32_16x16x32_bf16 v[152:155], a[168:171], v[56:59], v[152:155]
    ds_read_b64_tr_b16 v[96:97], v44 offset:8192
    v_mfma_f32_16x16x32_bf16 v[156:159], a[172:175], v[56:59], v[156:159]
    ds_read_b64_tr_b16 v[98:99], v44 offset:12288
    v_mfma_f32_16x16x32_bf16 v[160:163], a[160:163], v[60:63], v[160:163]
    ds_read_b64_tr_b16 v[100:101], v45 offset:8192
    buffer_load_dwordx4 v5, s[8:11], s66 offen offset:3072 lds
    v_mfma_f32_16x16x32_bf16 v[164:167], a[164:167], v[60:63], v[164:167]
    ds_read_b64_tr_b16 v[102:103], v45 offset:12288
    v_mfma_f32_16x16x32_bf16 v[168:171], a[168:171], v[60:63], v[168:171]
    v_mfma_f32_16x16x32_bf16 v[172:175], a[172:175], v[60:63], v[172:175]
    ds_read_b64_tr_b16 v[104:105], v46 offset:8192
    v_mfma_f32_16x16x32_bf16 v[176:179], a[160:163], v[64:67], v[176:179]
    ds_read_b64_tr_b16 v[106:107], v46 offset:12288
    buffer_load_dwordx4 a[144:147], v6, s[12:15], s67 offen offset:0 sc1
    v_mfma_f32_16x16x32_bf16 v[180:183], a[164:167], v[64:67], v[180:183]
    ds_read_b64_tr_b16 v[108:109], v47 offset:8192
    v_mfma_f32_16x16x32_bf16 v[184:187], a[168:171], v[64:67], v[184:187]
    ds_read_b64_tr_b16 v[110:111], v47 offset:12288
    v_mfma_f32_16x16x32_bf16 v[188:191], a[172:175], v[64:67], v[188:191]
    v_mfma_f32_16x16x32_bf16 v[192:195], a[160:163], v[68:71], v[192:195]
    buffer_load_dwordx4 a[148:151], v6, s[12:15], s67 offen offset:1024 sc1
    v_mfma_f32_16x16x32_bf16 v[196:199], a[164:167], v[68:71], v[196:199]
    v_mfma_f32_16x16x32_bf16 v[200:203], a[168:171], v[68:71], v[200:203]
    v_mfma_f32_16x16x32_bf16 v[204:207], a[172:175], v[68:71], v[204:207]
    v_mfma_f32_16x16x32_bf16 v[208:211], a[160:163], v[72:75], v[208:211]
    buffer_load_dwordx4 a[152:155], v6, s[12:15], s67 offen offset:2048 sc1
    v_mfma_f32_16x16x32_bf16 v[212:215], a[164:167], v[72:75], v[212:215]
    v_mfma_f32_16x16x32_bf16 v[216:219], a[168:171], v[72:75], v[216:219]
    v_mfma_f32_16x16x32_bf16 v[220:223], a[172:175], v[72:75], v[220:223]
    v_mfma_f32_16x16x32_bf16 v[224:227], a[160:163], v[76:79], v[224:227]
    buffer_load_dwordx4 a[156:159], v6, s[12:15], s67 offen offset:3072 sc1
    v_mfma_f32_16x16x32_bf16 v[228:231], a[164:167], v[76:79], v[228:231]
    v_mfma_f32_16x16x32_bf16 v[232:235], a[168:171], v[76:79], v[232:235]
    v_mfma_f32_16x16x32_bf16 v[236:239], a[172:175], v[76:79], v[236:239]
    s_add_u32 s67, s67, 196608
    s_waitcnt vmcnt(27) lgkmcnt(0)
    s_barrier
    v_mfma_f32_16x16x32_bf16 v[112:115], a[176:179], v[80:83], v[112:115]
    ds_read_b64_tr_b16 v[48:49], v40 offset:32768
    buffer_load_ushort v14, v252, s[28:31], s86 offen offset:96
    v_mfma_f32_16x16x32_bf16 v[116:119], a[180:183], v[80:83], v[116:119]
    ds_read_b64_tr_b16 v[50:51], v40 offset:36864
    s_add_u32 m0, s69, 98304
    v_mfma_f32_16x16x32_bf16 v[120:123], a[184:187], v[80:83], v[120:123]
    ds_read_b64_tr_b16 v[52:53], v41 offset:32768
    s_add_u32 s66, s66, 458752
    v_mfma_f32_16x16x32_bf16 v[124:127], a[188:191], v[80:83], v[124:127]
    ds_read_b64_tr_b16 v[54:55], v41 offset:36864
    buffer_load_dwordx4 v2, s[8:11], s66 offen offset:0 lds
    v_mfma_f32_16x16x32_bf16 v[128:131], a[176:179], v[84:87], v[128:131]
    buffer_load_dwordx4 v3, s[8:11], s66 offen offset:1024 lds
    v_mfma_f32_16x16x32_bf16 v[132:135], a[180:183], v[84:87], v[132:135]
    ds_read_b64_tr_b16 v[56:57], v42 offset:32768
    v_mfma_f32_16x16x32_bf16 v[136:139], a[184:187], v[84:87], v[136:139]
    ds_read_b64_tr_b16 v[58:59], v42 offset:36864
    v_mfma_f32_16x16x32_bf16 v[140:143], a[188:191], v[84:87], v[140:143]
    ds_read_b64_tr_b16 v[60:61], v43 offset:32768
    v_mfma_f32_16x16x32_bf16 v[144:147], a[176:179], v[88:91], v[144:147]
    ds_read_b64_tr_b16 v[62:63], v43 offset:36864
    buffer_load_dwordx4 v4, s[8:11], s66 offen offset:2048 lds
    v_mfma_f32_16x16x32_bf16 v[148:151], a[180:183], v[88:91], v[148:151]
    v_mfma_f32_16x16x32_bf16 v[152:155], a[184:187], v[88:91], v[152:155]
    ds_read_b64_tr_b16 v[64:65], v44 offset:32768
    v_mfma_f32_16x16x32_bf16 v[156:159], a[188:191], v[88:91], v[156:159]
    ds_read_b64_tr_b16 v[66:67], v44 offset:36864
    v_mfma_f32_16x16x32_bf16 v[160:163], a[176:179], v[92:95], v[160:163]
    ds_read_b64_tr_b16 v[68:69], v45 offset:32768
    buffer_load_dwordx4 v5, s[8:11], s66 offen offset:3072 lds
    v_mfma_f32_16x16x32_bf16 v[164:167], a[180:183], v[92:95], v[164:167]
    ds_read_b64_tr_b16 v[70:71], v45 offset:36864
    v_mfma_f32_16x16x32_bf16 v[168:171], a[184:187], v[92:95], v[168:171]
    v_mfma_f32_16x16x32_bf16 v[172:175], a[188:191], v[92:95], v[172:175]
    ds_read_b64_tr_b16 v[72:73], v46 offset:32768
    v_mfma_f32_16x16x32_bf16 v[176:179], a[176:179], v[96:99], v[176:179]
    ds_read_b64_tr_b16 v[74:75], v46 offset:36864
    buffer_load_dwordx4 a[160:163], v6, s[12:15], s67 offen offset:0 sc1
    v_mfma_f32_16x16x32_bf16 v[180:183], a[180:183], v[96:99], v[180:183]
    ds_read_b64_tr_b16 v[76:77], v47 offset:32768
    v_mfma_f32_16x16x32_bf16 v[184:187], a[184:187], v[96:99], v[184:187]
    ds_read_b64_tr_b16 v[78:79], v47 offset:36864
    v_mfma_f32_16x16x32_bf16 v[188:191], a[188:191], v[96:99], v[188:191]
    v_mfma_f32_16x16x32_bf16 v[192:195], a[176:179], v[100:103], v[192:195]
    buffer_load_dwordx4 a[164:167], v6, s[12:15], s67 offen offset:1024 sc1
    v_mfma_f32_16x16x32_bf16 v[196:199], a[180:183], v[100:103], v[196:199]
    v_mfma_f32_16x16x32_bf16 v[200:203], a[184:187], v[100:103], v[200:203]
    v_mfma_f32_16x16x32_bf16 v[204:207], a[188:191], v[100:103], v[204:207]
    v_mfma_f32_16x16x32_bf16 v[208:211], a[176:179], v[104:107], v[208:211]
    buffer_load_dwordx4 a[168:171], v6, s[12:15], s67 offen offset:2048 sc1
    v_mfma_f32_16x16x32_bf16 v[212:215], a[180:183], v[104:107], v[212:215]
    v_mfma_f32_16x16x32_bf16 v[216:219], a[184:187], v[104:107], v[216:219]
    v_mfma_f32_16x16x32_bf16 v[220:223], a[188:191], v[104:107], v[220:223]
    v_mfma_f32_16x16x32_bf16 v[224:227], a[176:179], v[108:111], v[224:227]
    buffer_load_dwordx4 a[172:175], v6, s[12:15], s67 offen offset:3072 sc1
    v_mfma_f32_16x16x32_bf16 v[228:231], a[180:183], v[108:111], v[228:231]
    v_mfma_f32_16x16x32_bf16 v[232:235], a[184:187], v[108:111], v[232:235]
    v_mfma_f32_16x16x32_bf16 v[236:239], a[188:191], v[108:111], v[236:239]
    s_add_u32 s67, s67, 65536
    s_waitcnt lgkmcnt(0)
    s_lshl_b32 s82, s74, 5
    s_add_u32 s82, s82, s75
    s_lshl_b32 s82, s82, 3
    s_add_u32 s82, s82, 16384
    v_mov_b32 v248, s50
    v_mov_b32 v249, s51
    v_lshlrev_b32 v250, 11, v0
    v_cmp_gt_u32 vcc, 1, v0
    s_and_saveexec_b64 s[84:85], vcc
    s_cbranch_execz 1f
    buffer_store_dwordx2 v[248:249], v250, s[36:39], s82 offen sc1
1:
    s_mov_b64 exec, s[84:85]
    s_mov_b32 s70, 6
.p2align 6
km_y_loop:
    v_mfma_f32_16x16x32_bf16 v[112:115], a[192:195], v[48:51], v[112:115]
    ds_read_b64_tr_b16 v[80:81], v40 offset:40960
    v_mfma_f32_16x16x32_bf16 v[116:119], a[196:199], v[48:51], v[116:119]
    ds_read_b64_tr_b16 v[82:83], v40 offset:45056
    s_add_u32 m0, s69, 102400
    s_add_u32 s66, s66, 65536
    v_mfma_f32_16x16x32_bf16 v[120:123], a[200:203], v[48:51], v[120:123]
    ds_read_b64_tr_b16 v[84:85], v41 offset:40960
    buffer_load_dwordx4 v2, s[8:11], s66 offen offset:0 lds
    v_mfma_f32_16x16x32_bf16 v[124:127], a[204:207], v[48:51], v[124:127]
    ds_read_b64_tr_b16 v[86:87], v41 offset:45056
    v_mfma_f32_16x16x32_bf16 v[128:131], a[192:195], v[52:55], v[128:131]
    buffer_load_dwordx4 v3, s[8:11], s66 offen offset:1024 lds
    v_mfma_f32_16x16x32_bf16 v[132:135], a[196:199], v[52:55], v[132:135]
    ds_read_b64_tr_b16 v[88:89], v42 offset:40960
    v_mfma_f32_16x16x32_bf16 v[136:139], a[200:203], v[52:55], v[136:139]
    ds_read_b64_tr_b16 v[90:91], v42 offset:45056
    v_mfma_f32_16x16x32_bf16 v[140:143], a[204:207], v[52:55], v[140:143]
    ds_read_b64_tr_b16 v[92:93], v43 offset:40960
    v_mfma_f32_16x16x32_bf16 v[144:147], a[192:195], v[56:59], v[144:147]
    ds_read_b64_tr_b16 v[94:95], v43 offset:45056
    buffer_load_dwordx4 v4, s[8:11], s66 offen offset:2048 lds
    v_mfma_f32_16x16x32_bf16 v[148:151], a[196:199], v[56:59], v[148:151]
    v_mfma_f32_16x16x32_bf16 v[152:155], a[200:203], v[56:59], v[152:155]
    ds_read_b64_tr_b16 v[96:97], v44 offset:40960
    v_mfma_f32_16x16x32_bf16 v[156:159], a[204:207], v[56:59], v[156:159]
    ds_read_b64_tr_b16 v[98:99], v44 offset:45056
    v_mfma_f32_16x16x32_bf16 v[160:163], a[192:195], v[60:63], v[160:163]
    ds_read_b64_tr_b16 v[100:101], v45 offset:40960
    buffer_load_dwordx4 v5, s[8:11], s66 offen offset:3072 lds
    v_mfma_f32_16x16x32_bf16 v[164:167], a[196:199], v[60:63], v[164:167]
    ds_read_b64_tr_b16 v[102:103], v45 offset:45056
    v_mfma_f32_16x16x32_bf16 v[168:171], a[200:203], v[60:63], v[168:171]
    v_mfma_f32_16x16x32_bf16 v[172:175], a[204:207], v[60:63], v[172:175]
    ds_read_b64_tr_b16 v[104:105], v46 offset:40960
    v_mfma_f32_16x16x32_bf16 v[176:179], a[192:195], v[64:67], v[176:179]
    ds_read_b64_tr_b16 v[106:107], v46 offset:45056
    buffer_load_dwordx4 a[176:179], v6, s[12:15], s67 offen offset:0 sc1
    v_mfma_f32_16x16x32_bf16 v[180:183], a[196:199], v[64:67], v[180:183]
    ds_read_b64_tr_b16 v[108:109], v47 offset:40960
    v_mfma_f32_16x16x32_bf16 v[184:187], a[200:203], v[64:67], v[184:187]
    ds_read_b64_tr_b16 v[110:111], v47 offset:45056
    v_mfma_f32_16x16x32_bf16 v[188:191], a[204:207], v[64:67], v[188:191]
    v_mfma_f32_16x16x32_bf16 v[192:195], a[192:195], v[68:71], v[192:195]
    buffer_load_dwordx4 a[180:183], v6, s[12:15], s67 offen offset:1024 sc1
    v_mfma_f32_16x16x32_bf16 v[196:199], a[196:199], v[68:71], v[196:199]
    v_mfma_f32_16x16x32_bf16 v[200:203], a[200:203], v[68:71], v[200:203]
    v_mfma_f32_16x16x32_bf16 v[204:207], a[204:207], v[68:71], v[204:207]
    v_mfma_f32_16x16x32_bf16 v[208:211], a[192:195], v[72:75], v[208:211]
    buffer_load_dwordx4 a[184:187], v6, s[12:15], s67 offen offset:2048 sc1
    v_mfma_f32_16x16x32_bf16 v[212:215], a[196:199], v[72:75], v[212:215]
    v_mfma_f32_16x16x32_bf16 v[216:219], a[200:203], v[72:75], v[216:219]
    v_mfma_f32_16x16x32_bf16 v[220:223], a[204:207], v[72:75], v[220:223]
    v_mfma_f32_16x16x32_bf16 v[224:227], a[192:195], v[76:79], v[224:227]
    buffer_load_dwordx4 a[188:191], v6, s[12:15], s67 offen offset:3072 sc1
    v_mfma_f32_16x16x32_bf16 v[228:231], a[196:199], v[76:79], v[228:231]
    v_mfma_f32_16x16x32_bf16 v[232:235], a[200:203], v[76:79], v[232:235]
    v_mfma_f32_16x16x32_bf16 v[236:239], a[204:207], v[76:79], v[236:239]
    s_add_u32 s67, s67, 196608
    s_waitcnt vmcnt(32) lgkmcnt(0)
    s_barrier
    s_cmp_eq_u32 s70, 6
    s_cbranch_scc1 km_ypi
km_ypi_ret:
    s_cmp_eq_u32 s70, 5
    s_cbranch_scc1 km_ywrap
km_ywrap_ret:
    v_mfma_f32_16x16x32_bf16 v[112:115], a[208:211], v[80:83], v[112:115]
    ds_read_b64_tr_b16 v[48:49], v32 offset:0
    v_mfma_f32_16x16x32_bf16 v[116:119], a[212:215], v[80:83], v[116:119]
    ds_read_b64_tr_b16 v[50:51], v32 offset:4096
    s_add_u32 m0, s69, 131072
    s_add_u32 s66, s66, 458752
    v_mfma_f32_16x16x32_bf16 v[120:123], a[216:219], v[80:83], v[120:123]
    ds_read_b64_tr_b16 v[52:53], v33 offset:0
    buffer_load_dwordx4 v2, s[8:11], s66 offen offset:0 lds
    v_mfma_f32_16x16x32_bf16 v[124:127], a[220:223], v[80:83], v[124:127]
    ds_read_b64_tr_b16 v[54:55], v33 offset:4096
    v_mfma_f32_16x16x32_bf16 v[128:131], a[208:211], v[84:87], v[128:131]
    buffer_load_dwordx4 v3, s[8:11], s66 offen offset:1024 lds
    v_mfma_f32_16x16x32_bf16 v[132:135], a[212:215], v[84:87], v[132:135]
    ds_read_b64_tr_b16 v[56:57], v34 offset:0
    v_mfma_f32_16x16x32_bf16 v[136:139], a[216:219], v[84:87], v[136:139]
    ds_read_b64_tr_b16 v[58:59], v34 offset:4096
    v_mfma_f32_16x16x32_bf16 v[140:143], a[220:223], v[84:87], v[140:143]
    ds_read_b64_tr_b16 v[60:61], v35 offset:0
    v_mfma_f32_16x16x32_bf16 v[144:147], a[208:211], v[88:91], v[144:147]
    ds_read_b64_tr_b16 v[62:63], v35 offset:4096
    buffer_load_dwordx4 v4, s[8:11], s66 offen offset:2048 lds
    v_mfma_f32_16x16x32_bf16 v[148:151], a[212:215], v[88:91], v[148:151]
    v_mfma_f32_16x16x32_bf16 v[152:155], a[216:219], v[88:91], v[152:155]
    ds_read_b64_tr_b16 v[64:65], v36 offset:0
    v_mfma_f32_16x16x32_bf16 v[156:159], a[220:223], v[88:91], v[156:159]
    ds_read_b64_tr_b16 v[66:67], v36 offset:4096
    v_mfma_f32_16x16x32_bf16 v[160:163], a[208:211], v[92:95], v[160:163]
    ds_read_b64_tr_b16 v[68:69], v37 offset:0
    buffer_load_dwordx4 v5, s[8:11], s66 offen offset:3072 lds
    v_mfma_f32_16x16x32_bf16 v[164:167], a[212:215], v[92:95], v[164:167]
    ds_read_b64_tr_b16 v[70:71], v37 offset:4096
    v_mfma_f32_16x16x32_bf16 v[168:171], a[216:219], v[92:95], v[168:171]
    v_mfma_f32_16x16x32_bf16 v[172:175], a[220:223], v[92:95], v[172:175]
    ds_read_b64_tr_b16 v[72:73], v38 offset:0
    v_mfma_f32_16x16x32_bf16 v[176:179], a[208:211], v[96:99], v[176:179]
    ds_read_b64_tr_b16 v[74:75], v38 offset:4096
    buffer_load_dwordx4 a[192:195], v6, s[12:15], s67 offen offset:0 sc1
    v_mfma_f32_16x16x32_bf16 v[180:183], a[212:215], v[96:99], v[180:183]
    ds_read_b64_tr_b16 v[76:77], v39 offset:0
    v_mfma_f32_16x16x32_bf16 v[184:187], a[216:219], v[96:99], v[184:187]
    ds_read_b64_tr_b16 v[78:79], v39 offset:4096
    v_mfma_f32_16x16x32_bf16 v[188:191], a[220:223], v[96:99], v[188:191]
    v_mfma_f32_16x16x32_bf16 v[192:195], a[208:211], v[100:103], v[192:195]
    buffer_load_dwordx4 a[196:199], v6, s[12:15], s67 offen offset:1024 sc1
    v_mfma_f32_16x16x32_bf16 v[196:199], a[212:215], v[100:103], v[196:199]
    v_mfma_f32_16x16x32_bf16 v[200:203], a[216:219], v[100:103], v[200:203]
    v_mfma_f32_16x16x32_bf16 v[204:207], a[220:223], v[100:103], v[204:207]
    v_mfma_f32_16x16x32_bf16 v[208:211], a[208:211], v[104:107], v[208:211]
    buffer_load_dwordx4 a[200:203], v6, s[12:15], s67 offen offset:2048 sc1
    v_mfma_f32_16x16x32_bf16 v[212:215], a[212:215], v[104:107], v[212:215]
    v_mfma_f32_16x16x32_bf16 v[216:219], a[216:219], v[104:107], v[216:219]
    v_mfma_f32_16x16x32_bf16 v[220:223], a[220:223], v[104:107], v[220:223]
    v_mfma_f32_16x16x32_bf16 v[224:227], a[208:211], v[108:111], v[224:227]
    buffer_load_dwordx4 a[204:207], v6, s[12:15], s67 offen offset:3072 sc1
    v_mfma_f32_16x16x32_bf16 v[228:231], a[212:215], v[108:111], v[228:231]
    v_mfma_f32_16x16x32_bf16 v[232:235], a[216:219], v[108:111], v[232:235]
    v_mfma_f32_16x16x32_bf16 v[236:239], a[220:223], v[108:111], v[236:239]
    s_add_u32 s67, s67, 65536
    s_waitcnt lgkmcnt(0)
    v_mfma_f32_16x16x32_bf16 v[112:115], a[224:227], v[48:51], v[112:115]
    ds_read_b64_tr_b16 v[80:81], v32 offset:8192
    v_mfma_f32_16x16x32_bf16 v[116:119], a[228:231], v[48:51], v[116:119]
    ds_read_b64_tr_b16 v[82:83], v32 offset:12288
    s_add_u32 m0, s69, 135168
    s_add_u32 s66, s66, 65536
    v_mfma_f32_16x16x32_bf16 v[120:123], a[232:235], v[48:51], v[120:123]
    ds_read_b64_tr_b16 v[84:85], v33 offset:8192
    buffer_load_dwordx4 v2, s[8:11], s66 offen offset:0 lds
    v_mfma_f32_16x16x32_bf16 v[124:127], a[236:239], v[48:51], v[124:127]
    ds_read_b64_tr_b16 v[86:87], v33 offset:12288
    v_mfma_f32_16x16x32_bf16 v[128:131], a[224:227], v[52:55], v[128:131]
    buffer_load_dwordx4 v3, s[8:11], s66 offen offset:1024 lds
    v_mfma_f32_16x16x32_bf16 v[132:135], a[228:231], v[52:55], v[132:135]
    ds_read_b64_tr_b16 v[88:89], v34 offset:8192
    v_mfma_f32_16x16x32_bf16 v[136:139], a[232:235], v[52:55], v[136:139]
    ds_read_b64_tr_b16 v[90:91], v34 offset:12288
    v_mfma_f32_16x16x32_bf16 v[140:143], a[236:239], v[52:55], v[140:143]
    ds_read_b64_tr_b16 v[92:93], v35 offset:8192
    v_mfma_f32_16x16x32_bf16 v[144:147], a[224:227], v[56:59], v[144:147]
    ds_read_b64_tr_b16 v[94:95], v35 offset:12288
    buffer_load_dwordx4 v4, s[8:11], s66 offen offset:2048 lds
    v_mfma_f32_16x16x32_bf16 v[148:151], a[228:231], v[56:59], v[148:151]
    v_mfma_f32_16x16x32_bf16 v[152:155], a[232:235], v[56:59], v[152:155]
    ds_read_b64_tr_b16 v[96:97], v36 offset:8192
    v_mfma_f32_16x16x32_bf16 v[156:159], a[236:239], v[56:59], v[156:159]
    ds_read_b64_tr_b16 v[98:99], v36 offset:12288
    v_mfma_f32_16x16x32_bf16 v[160:163], a[224:227], v[60:63], v[160:163]
    ds_read_b64_tr_b16 v[100:101], v37 offset:8192
    buffer_load_dwordx4 v5, s[8:11], s66 offen offset:3072 lds
    v_mfma_f32_16x16x32_bf16 v[164:167], a[228:231], v[60:63], v[164:167]
    ds_read_b64_tr_b16 v[102:103], v37 offset:12288
    v_mfma_f32_16x16x32_bf16 v[168:171], a[232:235], v[60:63], v[168:171]
    v_mfma_f32_16x16x32_bf16 v[172:175], a[236:239], v[60:63], v[172:175]
    ds_read_b64_tr_b16 v[104:105], v38 offset:8192
    v_mfma_f32_16x16x32_bf16 v[176:179], a[224:227], v[64:67], v[176:179]
    ds_read_b64_tr_b16 v[106:107], v38 offset:12288
    buffer_load_dwordx4 a[208:211], v6, s[12:15], s67 offen offset:0 sc1
    v_mfma_f32_16x16x32_bf16 v[180:183], a[228:231], v[64:67], v[180:183]
    ds_read_b64_tr_b16 v[108:109], v39 offset:8192
    v_mfma_f32_16x16x32_bf16 v[184:187], a[232:235], v[64:67], v[184:187]
    ds_read_b64_tr_b16 v[110:111], v39 offset:12288
    v_mfma_f32_16x16x32_bf16 v[188:191], a[236:239], v[64:67], v[188:191]
    v_mfma_f32_16x16x32_bf16 v[192:195], a[224:227], v[68:71], v[192:195]
    buffer_load_dwordx4 a[212:215], v6, s[12:15], s67 offen offset:1024 sc1
    v_mfma_f32_16x16x32_bf16 v[196:199], a[228:231], v[68:71], v[196:199]
    v_mfma_f32_16x16x32_bf16 v[200:203], a[232:235], v[68:71], v[200:203]
    v_mfma_f32_16x16x32_bf16 v[204:207], a[236:239], v[68:71], v[204:207]
    v_mfma_f32_16x16x32_bf16 v[208:211], a[224:227], v[72:75], v[208:211]
    buffer_load_dwordx4 a[216:219], v6, s[12:15], s67 offen offset:2048 sc1
    v_mfma_f32_16x16x32_bf16 v[212:215], a[228:231], v[72:75], v[212:215]
    v_mfma_f32_16x16x32_bf16 v[216:219], a[232:235], v[72:75], v[216:219]
    v_mfma_f32_16x16x32_bf16 v[220:223], a[236:239], v[72:75], v[220:223]
    v_mfma_f32_16x16x32_bf16 v[224:227], a[224:227], v[76:79], v[224:227]
    buffer_load_dwordx4 a[220:223], v6, s[12:15], s67 offen offset:3072 sc1
    v_mfma_f32_16x16x32_bf16 v[228:231], a[228:231], v[76:79], v[228:231]
    v_mfma_f32_16x16x32_bf16 v[232:235], a[232:235], v[76:79], v[232:235]
    v_mfma_f32_16x16x32_bf16 v[236:239], a[236:239], v[76:79], v[236:239]
    s_add_u32 s67, s67, 196608
    s_waitcnt vmcnt(32) lgkmcnt(0)
    s_barrier
    v_mfma_f32_16x16x32_bf16 v[112:115], a[240:243], v[80:83], v[112:115]
    ds_read_b64_tr_b16 v[48:49], v32 offset:32768
    v_mfma_f32_16x16x32_bf16 v[116:119], a[244:247], v[80:83], v[116:119]
    ds_read_b64_tr_b16 v[50:51], v32 offset:36864
    s_add_u32 m0, s69, 0
    s_add_u32 s66, s66, 458752
    v_mfma_f32_16x16x32_bf16 v[120:123], a[248:251], v[80:83], v[120:123]
    ds_read_b64_tr_b16 v[52:53], v33 offset:32768
    buffer_load_dwordx4 v2, s[8:11], s66 offen offset:0 lds
    v_mfma_f32_16x16x32_bf16 v[124:127], a[252:255], v[80:83], v[124:127]
    ds_read_b64_tr_b16 v[54:55], v33 offset:36864
    v_mfma_f32_16x16x32_bf16 v[128:131], a[240:243], v[84:87], v[128:131]
    buffer_load_dwordx4 v3, s[8:11], s66 offen offset:1024 lds
    v_mfma_f32_16x16x32_bf16 v[132:135], a[244:247], v[84:87], v[132:135]
    ds_read_b64_tr_b16 v[56:57], v34 offset:32768
    v_mfma_f32_16x16x32_bf16 v[136:139], a[248:251], v[84:87], v[136:139]
    ds_read_b64_tr_b16 v[58:59], v34 offset:36864
    v_mfma_f32_16x16x32_bf16 v[140:143], a[252:255], v[84:87], v[140:143]
    ds_read_b64_tr_b16 v[60:61], v35 offset:32768
    v_mfma_f32_16x16x32_bf16 v[144:147], a[240:243], v[88:91], v[144:147]
    ds_read_b64_tr_b16 v[62:63], v35 offset:36864
    buffer_load_dwordx4 v4, s[8:11], s66 offen offset:2048 lds
    v_mfma_f32_16x16x32_bf16 v[148:151], a[244:247], v[88:91], v[148:151]
    v_mfma_f32_16x16x32_bf16 v[152:155], a[248:251], v[88:91], v[152:155]
    ds_read_b64_tr_b16 v[64:65], v36 offset:32768
    v_mfma_f32_16x16x32_bf16 v[156:159], a[252:255], v[88:91], v[156:159]
    ds_read_b64_tr_b16 v[66:67], v36 offset:36864
    v_mfma_f32_16x16x32_bf16 v[160:163], a[240:243], v[92:95], v[160:163]
    ds_read_b64_tr_b16 v[68:69], v37 offset:32768
    buffer_load_dwordx4 v5, s[8:11], s66 offen offset:3072 lds
    v_mfma_f32_16x16x32_bf16 v[164:167], a[244:247], v[92:95], v[164:167]
    ds_read_b64_tr_b16 v[70:71], v37 offset:36864
    v_mfma_f32_16x16x32_bf16 v[168:171], a[248:251], v[92:95], v[168:171]
    v_mfma_f32_16x16x32_bf16 v[172:175], a[252:255], v[92:95], v[172:175]
    ds_read_b64_tr_b16 v[72:73], v38 offset:32768
    v_mfma_f32_16x16x32_bf16 v[176:179], a[240:243], v[96:99], v[176:179]
    ds_read_b64_tr_b16 v[74:75], v38 offset:36864
    buffer_load_dwordx4 a[224:227], v6, s[12:15], s67 offen offset:0 sc1
    v_mfma_f32_16x16x32_bf16 v[180:183], a[244:247], v[96:99], v[180:183]
    ds_read_b64_tr_b16 v[76:77], v39 offset:32768
    v_mfma_f32_16x16x32_bf16 v[184:187], a[248:251], v[96:99], v[184:187]
    ds_read_b64_tr_b16 v[78:79], v39 offset:36864
    v_mfma_f32_16x16x32_bf16 v[188:191], a[252:255], v[96:99], v[188:191]
    v_mfma_f32_16x16x32_bf16 v[192:195], a[240:243], v[100:103], v[192:195]
    buffer_load_dwordx4 a[228:231], v6, s[12:15], s67 offen offset:1024 sc1
    v_mfma_f32_16x16x32_bf16 v[196:199], a[244:247], v[100:103], v[196:199]
    v_mfma_f32_16x16x32_bf16 v[200:203], a[248:251], v[100:103], v[200:203]
    v_mfma_f32_16x16x32_bf16 v[204:207], a[252:255], v[100:103], v[204:207]
    v_mfma_f32_16x16x32_bf16 v[208:211], a[240:243], v[104:107], v[208:211]
    buffer_load_dwordx4 a[232:235], v6, s[12:15], s67 offen offset:2048 sc1
    v_mfma_f32_16x16x32_bf16 v[212:215], a[244:247], v[104:107], v[212:215]
    v_mfma_f32_16x16x32_bf16 v[216:219], a[248:251], v[104:107], v[216:219]
    v_mfma_f32_16x16x32_bf16 v[220:223], a[252:255], v[104:107], v[220:223]
    v_mfma_f32_16x16x32_bf16 v[224:227], a[240:243], v[108:111], v[224:227]
    buffer_load_dwordx4 a[236:239], v6, s[12:15], s67 offen offset:3072 sc1
    v_mfma_f32_16x16x32_bf16 v[228:231], a[244:247], v[108:111], v[228:231]
    v_mfma_f32_16x16x32_bf16 v[232:235], a[248:251], v[108:111], v[232:235]
    v_mfma_f32_16x16x32_bf16 v[236:239], a[252:255], v[108:111], v[236:239]
    s_add_u32 s67, s67, 65536
    s_waitcnt lgkmcnt(0)
    v_mfma_f32_16x16x32_bf16 v[112:115], a[128:131], v[48:51], v[112:115]
    ds_read_b64_tr_b16 v[80:81], v32 offset:40960
    v_mfma_f32_16x16x32_bf16 v[116:119], a[132:135], v[48:51], v[116:119]
    ds_read_b64_tr_b16 v[82:83], v32 offset:45056
    s_add_u32 m0, s69, 4096
    s_add_u32 s66, s66, 65536
    v_mfma_f32_16x16x32_bf16 v[120:123], a[136:139], v[48:51], v[120:123]
    ds_read_b64_tr_b16 v[84:85], v33 offset:40960
    buffer_load_dwordx4 v2, s[8:11], s66 offen offset:0 lds
    v_mfma_f32_16x16x32_bf16 v[124:127], a[140:143], v[48:51], v[124:127]
    ds_read_b64_tr_b16 v[86:87], v33 offset:45056
    v_mfma_f32_16x16x32_bf16 v[128:131], a[128:131], v[52:55], v[128:131]
    buffer_load_dwordx4 v3, s[8:11], s66 offen offset:1024 lds
    v_mfma_f32_16x16x32_bf16 v[132:135], a[132:135], v[52:55], v[132:135]
    ds_read_b64_tr_b16 v[88:89], v34 offset:40960
    v_mfma_f32_16x16x32_bf16 v[136:139], a[136:139], v[52:55], v[136:139]
    ds_read_b64_tr_b16 v[90:91], v34 offset:45056
    v_mfma_f32_16x16x32_bf16 v[140:143], a[140:143], v[52:55], v[140:143]
    ds_read_b64_tr_b16 v[92:93], v35 offset:40960
    v_mfma_f32_16x16x32_bf16 v[144:147], a[128:131], v[56:59], v[144:147]
    ds_read_b64_tr_b16 v[94:95], v35 offset:45056
    buffer_load_dwordx4 v4, s[8:11], s66 offen offset:2048 lds
    v_mfma_f32_16x16x32_bf16 v[148:151], a[132:135], v[56:59], v[148:151]
    v_mfma_f32_16x16x32_bf16 v[152:155], a[136:139], v[56:59], v[152:155]
    ds_read_b64_tr_b16 v[96:97], v36 offset:40960
    v_mfma_f32_16x16x32_bf16 v[156:159], a[140:143], v[56:59], v[156:159]
    ds_read_b64_tr_b16 v[98:99], v36 offset:45056
    v_mfma_f32_16x16x32_bf16 v[160:163], a[128:131], v[60:63], v[160:163]
    ds_read_b64_tr_b16 v[100:101], v37 offset:40960
    buffer_load_dwordx4 v5, s[8:11], s66 offen offset:3072 lds
    v_mfma_f32_16x16x32_bf16 v[164:167], a[132:135], v[60:63], v[164:167]
    ds_read_b64_tr_b16 v[102:103], v37 offset:45056
    v_mfma_f32_16x16x32_bf16 v[168:171], a[136:139], v[60:63], v[168:171]
    v_mfma_f32_16x16x32_bf16 v[172:175], a[140:143], v[60:63], v[172:175]
    ds_read_b64_tr_b16 v[104:105], v38 offset:40960
    v_mfma_f32_16x16x32_bf16 v[176:179], a[128:131], v[64:67], v[176:179]
    ds_read_b64_tr_b16 v[106:107], v38 offset:45056
    buffer_load_dwordx4 a[240:243], v6, s[12:15], s67 offen offset:0 sc1
    v_mfma_f32_16x16x32_bf16 v[180:183], a[132:135], v[64:67], v[180:183]
    ds_read_b64_tr_b16 v[108:109], v39 offset:40960
    v_mfma_f32_16x16x32_bf16 v[184:187], a[136:139], v[64:67], v[184:187]
    ds_read_b64_tr_b16 v[110:111], v39 offset:45056
    v_mfma_f32_16x16x32_bf16 v[188:191], a[140:143], v[64:67], v[188:191]
    v_mfma_f32_16x16x32_bf16 v[192:195], a[128:131], v[68:71], v[192:195]
    buffer_load_dwordx4 a[244:247], v6, s[12:15], s67 offen offset:1024 sc1
    v_mfma_f32_16x16x32_bf16 v[196:199], a[132:135], v[68:71], v[196:199]
    v_mfma_f32_16x16x32_bf16 v[200:203], a[136:139], v[68:71], v[200:203]
    v_mfma_f32_16x16x32_bf16 v[204:207], a[140:143], v[68:71], v[204:207]
    v_mfma_f32_16x16x32_bf16 v[208:211], a[128:131], v[72:75], v[208:211]
    buffer_load_dwordx4 a[248:251], v6, s[12:15], s67 offen offset:2048 sc1
    v_mfma_f32_16x16x32_bf16 v[212:215], a[132:135], v[72:75], v[212:215]
    v_mfma_f32_16x16x32_bf16 v[216:219], a[136:139], v[72:75], v[216:219]
    v_mfma_f32_16x16x32_bf16 v[220:223], a[140:143], v[72:75], v[220:223]
    v_mfma_f32_16x16x32_bf16 v[224:227], a[128:131], v[76:79], v[224:227]
    buffer_load_dwordx4 a[252:255], v6, s[12:15], s67 offen offset:3072 sc1
    v_mfma_f32_16x16x32_bf16 v[228:231], a[132:135], v[76:79], v[228:231]
    v_mfma_f32_16x16x32_bf16 v[232:235], a[136:139], v[76:79], v[232:235]
    v_mfma_f32_16x16x32_bf16 v[236:239], a[140:143], v[76:79], v[236:239]
    s_add_u32 s67, s67, 196608
    s_waitcnt vmcnt(32) lgkmcnt(0)
    s_barrier
    v_mfma_f32_16x16x32_bf16 v[112:115], a[144:147], v[80:83], v[112:115]
    ds_read_b64_tr_b16 v[48:49], v40 offset:0
    v_mfma_f32_16x16x32_bf16 v[116:119], a[148:151], v[80:83], v[116:119]
    ds_read_b64_tr_b16 v[50:51], v40 offset:4096
    s_add_u32 m0, s69, 32768
    s_add_u32 s66, s66, 458752
    v_mfma_f32_16x16x32_bf16 v[120:123], a[152:155], v[80:83], v[120:123]
    ds_read_b64_tr_b16 v[52:53], v41 offset:0
    buffer_load_dwordx4 v2, s[8:11], s66 offen offset:0 lds
    v_mfma_f32_16x16x32_bf16 v[124:127], a[156:159], v[80:83], v[124:127]
    ds_read_b64_tr_b16 v[54:55], v41 offset:4096
    v_mfma_f32_16x16x32_bf16 v[128:131], a[144:147], v[84:87], v[128:131]
    buffer_load_dwordx4 v3, s[8:11], s66 offen offset:1024 lds
    v_mfma_f32_16x16x32_bf16 v[132:135], a[148:151], v[84:87], v[132:135]
    ds_read_b64_tr_b16 v[56:57], v42 offset:0
    v_mfma_f32_16x16x32_bf16 v[136:139], a[152:155], v[84:87], v[136:139]
    ds_read_b64_tr_b16 v[58:59], v42 offset:4096
    v_mfma_f32_16x16x32_bf16 v[140:143], a[156:159], v[84:87], v[140:143]
    ds_read_b64_tr_b16 v[60:61], v43 offset:0
    v_mfma_f32_16x16x32_bf16 v[144:147], a[144:147], v[88:91], v[144:147]
    ds_read_b64_tr_b16 v[62:63], v43 offset:4096
    buffer_load_dwordx4 v4, s[8:11], s66 offen offset:2048 lds
    v_mfma_f32_16x16x32_bf16 v[148:151], a[148:151], v[88:91], v[148:151]
    v_mfma_f32_16x16x32_bf16 v[152:155], a[152:155], v[88:91], v[152:155]
    ds_read_b64_tr_b16 v[64:65], v44 offset:0
    v_mfma_f32_16x16x32_bf16 v[156:159], a[156:159], v[88:91], v[156:159]
    ds_read_b64_tr_b16 v[66:67], v44 offset:4096
    v_mfma_f32_16x16x32_bf16 v[160:163], a[144:147], v[92:95], v[160:163]
    ds_read_b64_tr_b16 v[68:69], v45 offset:0
    buffer_load_dwordx4 v5, s[8:11], s66 offen offset:3072 lds
    v_mfma_f32_16x16x32_bf16 v[164:167], a[148:151], v[92:95], v[164:167]
    ds_read_b64_tr_b16 v[70:71], v45 offset:4096
    v_mfma_f32_16x16x32_bf16 v[168:171], a[152:155], v[92:95], v[168:171]
    v_mfma_f32_16x16x32_bf16 v[172:175], a[156:159], v[92:95], v[172:175]
    ds_read_b64_tr_b16 v[72:73], v46 offset:0
    v_mfma_f32_16x16x32_bf16 v[176:179], a[144:147], v[96:99], v[176:179]
    ds_read_b64_tr_b16 v[74:75], v46 offset:4096
    buffer_load_dwordx4 a[128:131], v6, s[12:15], s67 offen offset:0 sc1
    v_mfma_f32_16x16x32_bf16 v[180:183], a[148:151], v[96:99], v[180:183]
    ds_read_b64_tr_b16 v[76:77], v47 offset:0
    v_mfma_f32_16x16x32_bf16 v[184:187], a[152:155], v[96:99], v[184:187]
    ds_read_b64_tr_b16 v[78:79], v47 offset:4096
    v_mfma_f32_16x16x32_bf16 v[188:191], a[156:159], v[96:99], v[188:191]
    v_mfma_f32_16x16x32_bf16 v[192:195], a[144:147], v[100:103], v[192:195]
    buffer_load_dwordx4 a[132:135], v6, s[12:15], s67 offen offset:1024 sc1
    v_mfma_f32_16x16x32_bf16 v[196:199], a[148:151], v[100:103], v[196:199]
    v_mfma_f32_16x16x32_bf16 v[200:203], a[152:155], v[100:103], v[200:203]
    v_mfma_f32_16x16x32_bf16 v[204:207], a[156:159], v[100:103], v[204:207]
    v_mfma_f32_16x16x32_bf16 v[208:211], a[144:147], v[104:107], v[208:211]
    buffer_load_dwordx4 a[136:139], v6, s[12:15], s67 offen offset:2048 sc1
    v_mfma_f32_16x16x32_bf16 v[212:215], a[148:151], v[104:107], v[212:215]
    v_mfma_f32_16x16x32_bf16 v[216:219], a[152:155], v[104:107], v[216:219]
    v_mfma_f32_16x16x32_bf16 v[220:223], a[156:159], v[104:107], v[220:223]
    v_mfma_f32_16x16x32_bf16 v[224:227], a[144:147], v[108:111], v[224:227]
    buffer_load_dwordx4 a[140:143], v6, s[12:15], s67 offen offset:3072 sc1
    v_mfma_f32_16x16x32_bf16 v[228:231], a[148:151], v[108:111], v[228:231]
    v_mfma_f32_16x16x32_bf16 v[232:235], a[152:155], v[108:111], v[232:235]
    v_mfma_f32_16x16x32_bf16 v[236:239], a[156:159], v[108:111], v[236:239]
    s_add_u32 s67, s67, 65536
    s_waitcnt lgkmcnt(0)
    v_mfma_f32_16x16x32_bf16 v[112:115], a[160:163], v[48:51], v[112:115]
    ds_read_b64_tr_b16 v[80:81], v40 offset:8192
    v_mfma_f32_16x16x32_bf16 v[116:119], a[164:167], v[48:51], v[116:119]
    ds_read_b64_tr_b16 v[82:83], v40 offset:12288
    s_add_u32 m0, s69, 36864
    s_add_u32 s66, s66, 65536
    v_mfma_f32_16x16x32_bf16 v[120:123], a[168:171], v[48:51], v[120:123]
    ds_read_b64_tr_b16 v[84:85], v41 offset:8192
    buffer_load_dwordx4 v2, s[8:11], s66 offen offset:0 lds
    v_mfma_f32_16x16x32_bf16 v[124:127], a[172:175], v[48:51], v[124:127]
    ds_read_b64_tr_b16 v[86:87], v41 offset:12288
    v_mfma_f32_16x16x32_bf16 v[128:131], a[160:163], v[52:55], v[128:131]
    buffer_load_dwordx4 v3, s[8:11], s66 offen offset:1024 lds
    v_mfma_f32_16x16x32_bf16 v[132:135], a[164:167], v[52:55], v[132:135]
    ds_read_b64_tr_b16 v[88:89], v42 offset:8192
    v_mfma_f32_16x16x32_bf16 v[136:139], a[168:171], v[52:55], v[136:139]
    ds_read_b64_tr_b16 v[90:91], v42 offset:12288
    v_mfma_f32_16x16x32_bf16 v[140:143], a[172:175], v[52:55], v[140:143]
    ds_read_b64_tr_b16 v[92:93], v43 offset:8192
    v_mfma_f32_16x16x32_bf16 v[144:147], a[160:163], v[56:59], v[144:147]
    ds_read_b64_tr_b16 v[94:95], v43 offset:12288
    buffer_load_dwordx4 v4, s[8:11], s66 offen offset:2048 lds
    v_mfma_f32_16x16x32_bf16 v[148:151], a[164:167], v[56:59], v[148:151]
    v_mfma_f32_16x16x32_bf16 v[152:155], a[168:171], v[56:59], v[152:155]
    ds_read_b64_tr_b16 v[96:97], v44 offset:8192
    v_mfma_f32_16x16x32_bf16 v[156:159], a[172:175], v[56:59], v[156:159]
    ds_read_b64_tr_b16 v[98:99], v44 offset:12288
    v_mfma_f32_16x16x32_bf16 v[160:163], a[160:163], v[60:63], v[160:163]
    ds_read_b64_tr_b16 v[100:101], v45 offset:8192
    buffer_load_dwordx4 v5, s[8:11], s66 offen offset:3072 lds
    v_mfma_f32_16x16x32_bf16 v[164:167], a[164:167], v[60:63], v[164:167]
    ds_read_b64_tr_b16 v[102:103], v45 offset:12288
    v_mfma_f32_16x16x32_bf16 v[168:171], a[168:171], v[60:63], v[168:171]
    v_mfma_f32_16x16x32_bf16 v[172:175], a[172:175], v[60:63], v[172:175]
    ds_read_b64_tr_b16 v[104:105], v46 offset:8192
    v_mfma_f32_16x16x32_bf16 v[176:179], a[160:163], v[64:67], v[176:179]
    ds_read_b64_tr_b16 v[106:107], v46 offset:12288
    buffer_load_dwordx4 a[144:147], v6, s[12:15], s67 offen offset:0 sc1
    v_mfma_f32_16x16x32_bf16 v[180:183], a[164:167], v[64:67], v[180:183]
    ds_read_b64_tr_b16 v[108:109], v47 offset:8192
    v_mfma_f32_16x16x32_bf16 v[184:187], a[168:171], v[64:67], v[184:187]
    ds_read_b64_tr_b16 v[110:111], v47 offset:12288
    v_mfma_f32_16x16x32_bf16 v[188:191], a[172:175], v[64:67], v[188:191]
    v_mfma_f32_16x16x32_bf16 v[192:195], a[160:163], v[68:71], v[192:195]
    buffer_load_dwordx4 a[148:151], v6, s[12:15], s67 offen offset:1024 sc1
    v_mfma_f32_16x16x32_bf16 v[196:199], a[164:167], v[68:71], v[196:199]
    v_mfma_f32_16x16x32_bf16 v[200:203], a[168:171], v[68:71], v[200:203]
    v_mfma_f32_16x16x32_bf16 v[204:207], a[172:175], v[68:71], v[204:207]
    v_mfma_f32_16x16x32_bf16 v[208:211], a[160:163], v[72:75], v[208:211]
    buffer_load_dwordx4 a[152:155], v6, s[12:15], s67 offen offset:2048 sc1
    v_mfma_f32_16x16x32_bf16 v[212:215], a[164:167], v[72:75], v[212:215]
    v_mfma_f32_16x16x32_bf16 v[216:219], a[168:171], v[72:75], v[216:219]
    v_mfma_f32_16x16x32_bf16 v[220:223], a[172:175], v[72:75], v[220:223]
    v_mfma_f32_16x16x32_bf16 v[224:227], a[160:163], v[76:79], v[224:227]
    buffer_load_dwordx4 a[156:159], v6, s[12:15], s67 offen offset:3072 sc1
    v_mfma_f32_16x16x32_bf16 v[228:231], a[164:167], v[76:79], v[228:231]
    v_mfma_f32_16x16x32_bf16 v[232:235], a[168:171], v[76:79], v[232:235]
    v_mfma_f32_16x16x32_bf16 v[236:239], a[172:175], v[76:79], v[236:239]
    s_add_u32 s67, s67, 196608
    s_waitcnt vmcnt(32) lgkmcnt(0)
    s_barrier
    v_mfma_f32_16x16x32_bf16 v[112:115], a[176:179], v[80:83], v[112:115]
    ds_read_b64_tr_b16 v[48:49], v40 offset:32768
    v_mfma_f32_16x16x32_bf16 v[116:119], a[180:183], v[80:83], v[116:119]
    ds_read_b64_tr_b16 v[50:51], v40 offset:36864
    s_add_u32 m0, s69, 98304
    s_add_u32 s66, s66, 458752
    v_mfma_f32_16x16x32_bf16 v[120:123], a[184:187], v[80:83], v[120:123]
    ds_read_b64_tr_b16 v[52:53], v41 offset:32768
    buffer_load_dwordx4 v2, s[8:11], s66 offen offset:0 lds
    v_mfma_f32_16x16x32_bf16 v[124:127], a[188:191], v[80:83], v[124:127]
    ds_read_b64_tr_b16 v[54:55], v41 offset:36864
    v_mfma_f32_16x16x32_bf16 v[128:131], a[176:179], v[84:87], v[128:131]
    buffer_load_dwordx4 v3, s[8:11], s66 offen offset:1024 lds
    v_mfma_f32_16x16x32_bf16 v[132:135], a[180:183], v[84:87], v[132:135]
    ds_read_b64_tr_b16 v[56:57], v42 offset:32768
    v_mfma_f32_16x16x32_bf16 v[136:139], a[184:187], v[84:87], v[136:139]
    ds_read_b64_tr_b16 v[58:59], v42 offset:36864
    v_mfma_f32_16x16x32_bf16 v[140:143], a[188:191], v[84:87], v[140:143]
    ds_read_b64_tr_b16 v[60:61], v43 offset:32768
    v_mfma_f32_16x16x32_bf16 v[144:147], a[176:179], v[88:91], v[144:147]
    ds_read_b64_tr_b16 v[62:63], v43 offset:36864
    buffer_load_dwordx4 v4, s[8:11], s66 offen offset:2048 lds
    v_mfma_f32_16x16x32_bf16 v[148:151], a[180:183], v[88:91], v[148:151]
    v_mfma_f32_16x16x32_bf16 v[152:155], a[184:187], v[88:91], v[152:155]
    ds_read_b64_tr_b16 v[64:65], v44 offset:32768
    v_mfma_f32_16x16x32_bf16 v[156:159], a[188:191], v[88:91], v[156:159]
    ds_read_b64_tr_b16 v[66:67], v44 offset:36864
    v_mfma_f32_16x16x32_bf16 v[160:163], a[176:179], v[92:95], v[160:163]
    ds_read_b64_tr_b16 v[68:69], v45 offset:32768
    buffer_load_dwordx4 v5, s[8:11], s66 offen offset:3072 lds
    v_mfma_f32_16x16x32_bf16 v[164:167], a[180:183], v[92:95], v[164:167]
    ds_read_b64_tr_b16 v[70:71], v45 offset:36864
    v_mfma_f32_16x16x32_bf16 v[168:171], a[184:187], v[92:95], v[168:171]
    v_mfma_f32_16x16x32_bf16 v[172:175], a[188:191], v[92:95], v[172:175]
    ds_read_b64_tr_b16 v[72:73], v46 offset:32768
    v_mfma_f32_16x16x32_bf16 v[176:179], a[176:179], v[96:99], v[176:179]
    ds_read_b64_tr_b16 v[74:75], v46 offset:36864
    buffer_load_dwordx4 a[160:163], v6, s[12:15], s67 offen offset:0 sc1
    v_mfma_f32_16x16x32_bf16 v[180:183], a[180:183], v[96:99], v[180:183]
    ds_read_b64_tr_b16 v[76:77], v47 offset:32768
    v_mfma_f32_16x16x32_bf16 v[184:187], a[184:187], v[96:99], v[184:187]
    ds_read_b64_tr_b16 v[78:79], v47 offset:36864
    v_mfma_f32_16x16x32_bf16 v[188:191], a[188:191], v[96:99], v[188:191]
    v_mfma_f32_16x16x32_bf16 v[192:195], a[176:179], v[100:103], v[192:195]
    buffer_load_dwordx4 a[164:167], v6, s[12:15], s67 offen offset:1024 sc1
    v_mfma_f32_16x16x32_bf16 v[196:199], a[180:183], v[100:103], v[196:199]
    v_mfma_f32_16x16x32_bf16 v[200:203], a[184:187], v[100:103], v[200:203]
    v_mfma_f32_16x16x32_bf16 v[204:207], a[188:191], v[100:103], v[204:207]
    v_mfma_f32_16x16x32_bf16 v[208:211], a[176:179], v[104:107], v[208:211]
    buffer_load_dwordx4 a[168:171], v6, s[12:15], s67 offen offset:2048 sc1
    v_mfma_f32_16x16x32_bf16 v[212:215], a[180:183], v[104:107], v[212:215]
    v_mfma_f32_16x16x32_bf16 v[216:219], a[184:187], v[104:107], v[216:219]
    v_mfma_f32_16x16x32_bf16 v[220:223], a[188:191], v[104:107], v[220:223]
    v_mfma_f32_16x16x32_bf16 v[224:227], a[176:179], v[108:111], v[224:227]
    buffer_load_dwordx4 a[172:175], v6, s[12:15], s67 offen offset:3072 sc1
    v_mfma_f32_16x16x32_bf16 v[228:231], a[180:183], v[108:111], v[228:231]
    v_mfma_f32_16x16x32_bf16 v[232:235], a[184:187], v[108:111], v[232:235]
    v_mfma_f32_16x16x32_bf16 v[236:239], a[188:191], v[108:111], v[236:239]
    s_add_u32 s67, s67, 65536
    s_sub_u32 s70, s70, 1
    s_cmp_eq_u32 s70, 1
    s_waitcnt lgkmcnt(0)
    s_cbranch_scc0 km_y_loop
    v_mfma_f32_16x16x32_bf16 v[112:115], a[192:195], v[48:51], v[112:115]
    ds_read_b64_tr_b16 v[80:81], v40 offset:40960
    v_xor_b32 v240, 0x4000, v40
    v_mfma_f32_16x16x32_bf16 v[116:119], a[196:199], v[48:51], v[116:119]
    ds_read_b64_tr_b16 v[82:83], v40 offset:45056
    s_add_u32 m0, s69, 102400
    v_mfma_f32_16x16x32_bf16 v[120:123], a[200:203], v[48:51], v[120:123]
    ds_read_b64_tr_b16 v[84:85], v41 offset:40960
    s_add_u32 s66, s66, 65536
    v_mfma_f32_16x16x32_bf16 v[124:127], a[204:207], v[48:51], v[124:127]
    ds_read_b64_tr_b16 v[86:87], v41 offset:45056
    buffer_load_dwordx4 v2, s[8:11], s66 offen offset:0 lds
    v_mfma_f32_16x16x32_bf16 v[128:131], a[192:195], v[52:55], v[128:131]
    buffer_load_dwordx4 v3, s[8:11], s66 offen offset:1024 lds
    v_xor_b32 v241, 0x4000, v41
    v_mfma_f32_16x16x32_bf16 v[132:135], a[196:199], v[52:55], v[132:135]
    ds_read_b64_tr_b16 v[88:89], v42 offset:40960
    v_xor_b32 v242, 0x4000, v42
    v_mfma_f32_16x16x32_bf16 v[136:139], a[200:203], v[52:55], v[136:139]
    ds_read_b64_tr_b16 v[90:91], v42 offset:45056
    v_xor_b32 v243, 0x4000, v43
    v_mfma_f32_16x16x32_bf16 v[140:143], a[204:207], v[52:55], v[140:143]
    ds_read_b64_tr_b16 v[92:93], v43 offset:40960
    s_lshl_b32 s85, s71, 14
    v_mfma_f32_16x16x32_bf16 v[144:147], a[192:195], v[56:59], v[144:147]
    ds_read_b64_tr_b16 v[94:95], v43 offset:45056
    buffer_load_dwordx4 v4, s[8:11], s66 offen offset:2048 lds
    v_mfma_f32_16x16x32_bf16 v[148:151], a[196:199], v[56:59], v[148:151]
    s_add_u32 s85, s85, 0
    v_add_u32 v244, s85, v7
    v_mfma_f32_16x16x32_bf16 v[152:155], a[200:203], v[56:59], v[152:155]
    ds_read_b64_tr_b16 v[96:97], v44 offset:40960
    s_xor_b32 s85, s71, 2
    v_mfma_f32_16x16x32_bf16 v[156:159], a[204:207], v[56:59], v[156:159]
    ds_read_b64_tr_b16 v[98:99], v44 offset:45056
    s_lshl_b32 s85, s85, 14
    v_mfma_f32_16x16x32_bf16 v[160:163], a[192:195], v[60:63], v[160:163]
    ds_read_b64_tr_b16 v[100:101], v45 offset:40960
    buffer_load_dwordx4 v5, s[8:11], s66 offen offset:3072 lds
    v_mfma_f32_16x16x32_bf16 v[164:167], a[196:199], v[60:63], v[164:167]
    ds_read_b64_tr_b16 v[102:103], v45 offset:45056
    s_add_u32 s85, s85, 0
    v_mfma_f32_16x16x32_bf16 v[168:171], a[200:203], v[60:63], v[168:171]
    v_add_u32 v245, s85, v7
    v_mfma_f32_16x16x32_bf16 v[172:175], a[204:207], v[60:63], v[172:175]
    ds_read_b64_tr_b16 v[104:105], v46 offset:40960
    v_mfma_f32_16x16x32_bf16 v[176:179], a[192:195], v[64:67], v[176:179]
    ds_read_b64_tr_b16 v[106:107], v46 offset:45056
    buffer_load_dwordx4 a[176:179], v6, s[12:15], s67 offen offset:0 sc1
    v_mfma_f32_16x16x32_bf16 v[180:183], a[196:199], v[64:67], v[180:183]
    ds_read_b64_tr_b16 v[108:109], v47 offset:40960
    v_mfma_f32_16x16x32_bf16 v[184:187], a[200:203], v[64:67], v[184:187]
    ds_read_b64_tr_b16 v[110:111], v47 offset:45056
    v_mfma_f32_16x16x32_bf16 v[188:191], a[204:207], v[64:67], v[188:191]
    v_mfma_f32_16x16x32_bf16 v[192:195], a[192:195], v[68:71], v[192:195]
    buffer_load_dwordx4 a[180:183], v6, s[12:15], s67 offen offset:1024 sc1
    v_mfma_f32_16x16x32_bf16 v[196:199], a[196:199], v[68:71], v[196:199]
    v_mfma_f32_16x16x32_bf16 v[200:203], a[200:203], v[68:71], v[200:203]
    v_mfma_f32_16x16x32_bf16 v[204:207], a[204:207], v[68:71], v[204:207]
    v_mfma_f32_16x16x32_bf16 v[208:211], a[192:195], v[72:75], v[208:211]
    buffer_load_dwordx4 a[184:187], v6, s[12:15], s67 offen offset:2048 sc1
    v_mfma_f32_16x16x32_bf16 v[212:215], a[196:199], v[72:75], v[212:215]
    v_mfma_f32_16x16x32_bf16 v[216:219], a[200:203], v[72:75], v[216:219]
    v_mfma_f32_16x16x32_bf16 v[220:223], a[204:207], v[72:75], v[220:223]
    v_mfma_f32_16x16x32_bf16 v[224:227], a[192:195], v[76:79], v[224:227]
    buffer_load_dwordx4 a[188:191], v6, s[12:15], s67 offen offset:3072 sc1
    v_mfma_f32_16x16x32_bf16 v[228:231], a[196:199], v[76:79], v[228:231]
    v_mfma_f32_16x16x32_bf16 v[232:235], a[200:203], v[76:79], v[232:235]
    v_mfma_f32_16x16x32_bf16 v[236:239], a[204:207], v[76:79], v[236:239]
    s_add_u32 s67, s67, 196608
    s_waitcnt vmcnt(32) lgkmcnt(0)
    s_barrier
    v_mfma_f32_16x16x32_bf16 v[112:115], a[208:211], v[80:83], v[112:115]
    ds_read_b64_tr_b16 v[48:49], v32 offset:0
    v_mfma_f32_16x16x32_bf16 v[116:119], a[212:215], v[80:83], v[116:119]
    ds_read_b64_tr_b16 v[50:51], v32 offset:4096
    s_xor_b32 s88, s72, 1
    s_mul_i32 s88, s88, 131072
    v_mfma_f32_16x16x32_bf16 v[120:123], a[216:219], v[80:83], v[120:123]
    ds_read_b64_tr_b16 v[52:53], v33 offset:0
    s_add_u32 s88, s88, 3932160
    v_mfma_f32_16x16x32_bf16 v[124:127], a[220:223], v[80:83], v[124:127]
    ds_read_b64_tr_b16 v[54:55], v33 offset:4096
    buffer_load_dwordx4 a[192:195], v6, s[12:15], s88 offen offset:0 sc1
    v_mfma_f32_16x16x32_bf16 v[128:131], a[208:211], v[84:87], v[128:131]
    v_mfma_f32_16x16x32_bf16 v[132:135], a[212:215], v[84:87], v[132:135]
    ds_read_b64_tr_b16 v[56:57], v34 offset:0
    v_mfma_f32_16x16x32_bf16 v[136:139], a[216:219], v[84:87], v[136:139]
    ds_read_b64_tr_b16 v[58:59], v34 offset:4096
    v_mfma_f32_16x16x32_bf16 v[140:143], a[220:223], v[84:87], v[140:143]
    ds_read_b64_tr_b16 v[60:61], v35 offset:0
    v_mfma_f32_16x16x32_bf16 v[144:147], a[208:211], v[88:91], v[144:147]
    ds_read_b64_tr_b16 v[62:63], v35 offset:4096
    buffer_load_dwordx4 a[196:199], v6, s[12:15], s88 offen offset:1024 sc1
    v_mfma_f32_16x16x32_bf16 v[148:151], a[212:215], v[88:91], v[148:151]
    v_mfma_f32_16x16x32_bf16 v[152:155], a[216:219], v[88:91], v[152:155]
    ds_read_b64_tr_b16 v[64:65], v36 offset:0
    v_mfma_f32_16x16x32_bf16 v[156:159], a[220:223], v[88:91], v[156:159]
    ds_read_b64_tr_b16 v[66:67], v36 offset:4096
    v_mfma_f32_16x16x32_bf16 v[160:163], a[208:211], v[92:95], v[160:163]
    ds_read_b64_tr_b16 v[68:69], v37 offset:0
    v_mfma_f32_16x16x32_bf16 v[164:167], a[212:215], v[92:95], v[164:167]
    ds_read_b64_tr_b16 v[70:71], v37 offset:4096
    v_mfma_f32_16x16x32_bf16 v[168:171], a[216:219], v[92:95], v[168:171]
    v_mfma_f32_16x16x32_bf16 v[172:175], a[220:223], v[92:95], v[172:175]
    ds_read_b64_tr_b16 v[72:73], v38 offset:0
    v_mfma_f32_16x16x32_bf16 v[176:179], a[208:211], v[96:99], v[176:179]
    ds_read_b64_tr_b16 v[74:75], v38 offset:4096
    buffer_load_dwordx4 a[200:203], v6, s[12:15], s88 offen offset:2048 sc1
    v_mfma_f32_16x16x32_bf16 v[180:183], a[212:215], v[96:99], v[180:183]
    ds_read_b64_tr_b16 v[76:77], v39 offset:0
    v_mfma_f32_16x16x32_bf16 v[184:187], a[216:219], v[96:99], v[184:187]
    ds_read_b64_tr_b16 v[78:79], v39 offset:4096
    v_mfma_f32_16x16x32_bf16 v[188:191], a[220:223], v[96:99], v[188:191]
    v_mfma_f32_16x16x32_bf16 v[192:195], a[208:211], v[100:103], v[192:195]
    v_mfma_f32_16x16x32_bf16 v[196:199], a[212:215], v[100:103], v[196:199]
    v_mfma_f32_16x16x32_bf16 v[200:203], a[216:219], v[100:103], v[200:203]
    v_mfma_f32_16x16x32_bf16 v[204:207], a[220:223], v[100:103], v[204:207]
    v_mfma_f32_16x16x32_bf16 v[208:211], a[208:211], v[104:107], v[208:211]
    buffer_load_dwordx4 a[204:207], v6, s[12:15], s88 offen offset:3072 sc1
    v_mfma_f32_16x16x32_bf16 v[212:215], a[212:215], v[104:107], v[212:215]
    v_mfma_f32_16x16x32_bf16 v[216:219], a[216:219], v[104:107], v[216:219]
    v_mfma_f32_16x16x32_bf16 v[220:223], a[220:223], v[104:107], v[220:223]
    v_mfma_f32_16x16x32_bf16 v[224:227], a[208:211], v[108:111], v[224:227]
    v_mfma_f32_16x16x32_bf16 v[228:231], a[212:215], v[108:111], v[228:231]
    v_mfma_f32_16x16x32_bf16 v[232:235], a[216:219], v[108:111], v[232:235]
    v_mfma_f32_16x16x32_bf16 v[236:239], a[220:223], v[108:111], v[236:239]
    s_waitcnt lgkmcnt(0)
    v_mfma_f32_16x16x32_bf16 v[112:115], a[224:227], v[48:51], v[112:115]
    ds_read_b64_tr_b16 v[80:81], v32 offset:8192
    v_mfma_f32_16x16x32_bf16 v[116:119], a[228:231], v[48:51], v[116:119]
    ds_read_b64_tr_b16 v[82:83], v32 offset:12288
    s_xor_b32 s88, s72, 1
    s_mul_i32 s88, s88, 131072
    v_mfma_f32_16x16x32_bf16 v[120:123], a[232:235], v[48:51], v[120:123]
    ds_read_b64_tr_b16 v[84:85], v33 offset:8192
    s_add_u32 s88, s88, 3997696
    v_mfma_f32_16x16x32_bf16 v[124:127], a[236:239], v[48:51], v[124:127]
    ds_read_b64_tr_b16 v[86:87], v33 offset:12288
    buffer_load_dwordx4 a[208:211], v6, s[12:15], s88 offen offset:0 sc1
    v_mfma_f32_16x16x32_bf16 v[128:131], a[224:227], v[52:55], v[128:131]
    v_mfma_f32_16x16x32_bf16 v[132:135], a[228:231], v[52:55], v[132:135]
    ds_read_b64_tr_b16 v[88:89], v34 offset:8192
    v_mfma_f32_16x16x32_bf16 v[136:139], a[232:235], v[52:55], v[136:139]
    ds_read_b64_tr_b16 v[90:91], v34 offset:12288
    v_mfma_f32_16x16x32_bf16 v[140:143], a[236:239], v[52:55], v[140:143]
    ds_read_b64_tr_b16 v[92:93], v35 offset:8192
    v_mfma_f32_16x16x32_bf16 v[144:147], a[224:227], v[56:59], v[144:147]
    ds_read_b64_tr_b16 v[94:95], v35 offset:12288
    buffer_load_dwordx4 a[212:215], v6, s[12:15], s88 offen offset:1024 sc1
    v_mfma_f32_16x16x32_bf16 v[148:151], a[228:231], v[56:59], v[148:151]
    v_mfma_f32_16x16x32_bf16 v[152:155], a[232:235], v[56:59], v[152:155]
    ds_read_b64_tr_b16 v[96:97], v36 offset:8192
    v_mfma_f32_16x16x32_bf16 v[156:159], a[236:239], v[56:59], v[156:159]
    ds_read_b64_tr_b16 v[98:99], v36 offset:12288
    v_mfma_f32_16x16x32_bf16 v[160:163], a[224:227], v[60:63], v[160:163]
    ds_read_b64_tr_b16 v[100:101], v37 offset:8192
    v_mfma_f32_16x16x32_bf16 v[164:167], a[228:231], v[60:63], v[164:167]
    ds_read_b64_tr_b16 v[102:103], v37 offset:12288
    v_mfma_f32_16x16x32_bf16 v[168:171], a[232:235], v[60:63], v[168:171]
    v_mfma_f32_16x16x32_bf16 v[172:175], a[236:239], v[60:63], v[172:175]
    ds_read_b64_tr_b16 v[104:105], v38 offset:8192
    v_mfma_f32_16x16x32_bf16 v[176:179], a[224:227], v[64:67], v[176:179]
    ds_read_b64_tr_b16 v[106:107], v38 offset:12288
    buffer_load_dwordx4 a[216:219], v6, s[12:15], s88 offen offset:2048 sc1
    v_mfma_f32_16x16x32_bf16 v[180:183], a[228:231], v[64:67], v[180:183]
    ds_read_b64_tr_b16 v[108:109], v39 offset:8192
    v_mfma_f32_16x16x32_bf16 v[184:187], a[232:235], v[64:67], v[184:187]
    ds_read_b64_tr_b16 v[110:111], v39 offset:12288
    v_mfma_f32_16x16x32_bf16 v[188:191], a[236:239], v[64:67], v[188:191]
    v_mfma_f32_16x16x32_bf16 v[192:195], a[224:227], v[68:71], v[192:195]
    v_mfma_f32_16x16x32_bf16 v[196:199], a[228:231], v[68:71], v[196:199]
    v_mfma_f32_16x16x32_bf16 v[200:203], a[232:235], v[68:71], v[200:203]
    v_mfma_f32_16x16x32_bf16 v[204:207], a[236:239], v[68:71], v[204:207]
    v_mfma_f32_16x16x32_bf16 v[208:211], a[224:227], v[72:75], v[208:211]
    buffer_load_dwordx4 a[220:223], v6, s[12:15], s88 offen offset:3072 sc1
    v_mfma_f32_16x16x32_bf16 v[212:215], a[228:231], v[72:75], v[212:215]
    v_mfma_f32_16x16x32_bf16 v[216:219], a[232:235], v[72:75], v[216:219]
    v_mfma_f32_16x16x32_bf16 v[220:223], a[236:239], v[72:75], v[220:223]
    v_mfma_f32_16x16x32_bf16 v[224:227], a[224:227], v[76:79], v[224:227]
    v_mfma_f32_16x16x32_bf16 v[228:231], a[228:231], v[76:79], v[228:231]
    v_mfma_f32_16x16x32_bf16 v[232:235], a[232:235], v[76:79], v[232:235]
    v_mfma_f32_16x16x32_bf16 v[236:239], a[236:239], v[76:79], v[236:239]
    s_waitcnt vmcnt(24) lgkmcnt(0)
    s_barrier
    v_mfma_f32_16x16x32_bf16 v[112:115], a[240:243], v[80:83], v[112:115]
    ds_read_b64_tr_b16 v[48:49], v32 offset:32768
    v_mfma_f32_16x16x32_bf16 v[116:119], a[244:247], v[80:83], v[116:119]
    ds_read_b64_tr_b16 v[50:51], v32 offset:36864
    v_mfma_f32_16x16x32_bf16 v[120:123], a[248:251], v[80:83], v[120:123]
    ds_read_b64_tr_b16 v[52:53], v33 offset:32768
    v_mfma_f32_16x16x32_bf16 v[124:127], a[252:255], v[80:83], v[124:127]
    ds_read_b64_tr_b16 v[54:55], v33 offset:36864
    v_mfma_f32_16x16x32_bf16 v[128:131], a[240:243], v[84:87], v[128:131]
    v_mfma_f32_16x16x32_bf16 v[132:135], a[244:247], v[84:87], v[132:135]
    ds_read_b64_tr_b16 v[56:57], v34 offset:32768
    v_mfma_f32_16x16x32_bf16 v[136:139], a[248:251], v[84:87], v[136:139]
    ds_read_b64_tr_b16 v[58:59], v34 offset:36864
    v_mfma_f32_16x16x32_bf16 v[140:143], a[252:255], v[84:87], v[140:143]
    ds_read_b64_tr_b16 v[60:61], v35 offset:32768
    v_mfma_f32_16x16x32_bf16 v[144:147], a[240:243], v[88:91], v[144:147]
    ds_read_b64_tr_b16 v[62:63], v35 offset:36864
    v_mfma_f32_16x16x32_bf16 v[148:151], a[244:247], v[88:91], v[148:151]
    v_mfma_f32_16x16x32_bf16 v[152:155], a[248:251], v[88:91], v[152:155]
    ds_read_b64_tr_b16 v[64:65], v36 offset:32768
    v_mfma_f32_16x16x32_bf16 v[156:159], a[252:255], v[88:91], v[156:159]
    ds_read_b64_tr_b16 v[66:67], v36 offset:36864
    v_mfma_f32_16x16x32_bf16 v[160:163], a[240:243], v[92:95], v[160:163]
    ds_read_b64_tr_b16 v[68:69], v37 offset:32768
    v_mfma_f32_16x16x32_bf16 v[164:167], a[244:247], v[92:95], v[164:167]
    ds_read_b64_tr_b16 v[70:71], v37 offset:36864
    v_mfma_f32_16x16x32_bf16 v[168:171], a[248:251], v[92:95], v[168:171]
    v_mfma_f32_16x16x32_bf16 v[172:175], a[252:255], v[92:95], v[172:175]
    ds_read_b64_tr_b16 v[72:73], v38 offset:32768
    v_mfma_f32_16x16x32_bf16 v[176:179], a[240:243], v[96:99], v[176:179]
    ds_read_b64_tr_b16 v[74:75], v38 offset:36864
    v_mfma_f32_16x16x32_bf16 v[180:183], a[244:247], v[96:99], v[180:183]
    ds_read_b64_tr_b16 v[76:77], v39 offset:32768
    v_mfma_f32_16x16x32_bf16 v[184:187], a[248:251], v[96:99], v[184:187]
    ds_read_b64_tr_b16 v[78:79], v39 offset:36864
    v_mfma_f32_16x16x32_bf16 v[188:191], a[252:255], v[96:99], v[188:191]
    v_mfma_f32_16x16x32_bf16 v[192:195], a[240:243], v[100:103], v[192:195]
    v_mfma_f32_16x16x32_bf16 v[196:199], a[244:247], v[100:103], v[196:199]
    v_mfma_f32_16x16x32_bf16 v[200:203], a[248:251], v[100:103], v[200:203]
    v_mfma_f32_16x16x32_bf16 v[204:207], a[252:255], v[100:103], v[204:207]
    v_mfma_f32_16x16x32_bf16 v[208:211], a[240:243], v[104:107], v[208:211]
    v_mfma_f32_16x16x32_bf16 v[212:215], a[244:247], v[104:107], v[212:215]
    v_mfma_f32_16x16x32_bf16 v[216:219], a[248:251], v[104:107], v[216:219]
    v_mfma_f32_16x16x32_bf16 v[220:223], a[252:255], v[104:107], v[220:223]
    v_mfma_f32_16x16x32_bf16 v[224:227], a[240:243], v[108:111], v[224:227]
    v_mfma_f32_16x16x32_bf16 v[228:231], a[244:247], v[108:111], v[228:231]
    v_mfma_f32_16x16x32_bf16 v[232:235], a[248:251], v[108:111], v[232:235]
    v_mfma_f32_16x16x32_bf16 v[236:239], a[252:255], v[108:111], v[236:239]
    s_waitcnt lgkmcnt(0)
    v_mfma_f32_16x16x32_bf16 v[112:115], a[128:131], v[48:51], v[112:115]
    ds_read_b64_tr_b16 v[80:81], v32 offset:40960
    v_mfma_f32_16x16x32_bf16 v[116:119], a[132:135], v[48:51], v[116:119]
    ds_read_b64_tr_b16 v[82:83], v32 offset:45056
    v_mfma_f32_16x16x32_bf16 v[120:123], a[136:139], v[48:51], v[120:123]
    ds_read_b64_tr_b16 v[84:85], v33 offset:40960
    v_mfma_f32_16x16x32_bf16 v[124:127], a[140:143], v[48:51], v[124:127]
    ds_read_b64_tr_b16 v[86:87], v33 offset:45056
    v_mfma_f32_16x16x32_bf16 v[128:131], a[128:131], v[52:55], v[128:131]
    v_mfma_f32_16x16x32_bf16 v[132:135], a[132:135], v[52:55], v[132:135]
    ds_read_b64_tr_b16 v[88:89], v34 offset:40960
    v_mfma_f32_16x16x32_bf16 v[136:139], a[136:139], v[52:55], v[136:139]
    ds_read_b64_tr_b16 v[90:91], v34 offset:45056
    v_mfma_f32_16x16x32_bf16 v[140:143], a[140:143], v[52:55], v[140:143]
    ds_read_b64_tr_b16 v[92:93], v35 offset:40960
    v_mfma_f32_16x16x32_bf16 v[144:147], a[128:131], v[56:59], v[144:147]
    ds_read_b64_tr_b16 v[94:95], v35 offset:45056
    v_mfma_f32_16x16x32_bf16 v[148:151], a[132:135], v[56:59], v[148:151]
    v_mfma_f32_16x16x32_bf16 v[152:155], a[136:139], v[56:59], v[152:155]
    ds_read_b64_tr_b16 v[96:97], v36 offset:40960
    v_mfma_f32_16x16x32_bf16 v[156:159], a[140:143], v[56:59], v[156:159]
    ds_read_b64_tr_b16 v[98:99], v36 offset:45056
    v_mfma_f32_16x16x32_bf16 v[160:163], a[128:131], v[60:63], v[160:163]
    ds_read_b64_tr_b16 v[100:101], v37 offset:40960
    v_mfma_f32_16x16x32_bf16 v[164:167], a[132:135], v[60:63], v[164:167]
    ds_read_b64_tr_b16 v[102:103], v37 offset:45056
    v_mfma_f32_16x16x32_bf16 v[168:171], a[136:139], v[60:63], v[168:171]
    v_mfma_f32_16x16x32_bf16 v[172:175], a[140:143], v[60:63], v[172:175]
    ds_read_b64_tr_b16 v[104:105], v38 offset:40960
    v_mfma_f32_16x16x32_bf16 v[176:179], a[128:131], v[64:67], v[176:179]
    ds_read_b64_tr_b16 v[106:107], v38 offset:45056
    v_mfma_f32_16x16x32_bf16 v[180:183], a[132:135], v[64:67], v[180:183]
    ds_read_b64_tr_b16 v[108:109], v39 offset:40960
    v_mfma_f32_16x16x32_bf16 v[184:187], a[136:139], v[64:67], v[184:187]
    ds_read_b64_tr_b16 v[110:111], v39 offset:45056
    v_mfma_f32_16x16x32_bf16 v[188:191], a[140:143], v[64:67], v[188:191]
    v_mfma_f32_16x16x32_bf16 v[192:195], a[128:131], v[68:71], v[192:195]
    v_mfma_f32_16x16x32_bf16 v[196:199], a[132:135], v[68:71], v[196:199]
    v_mfma_f32_16x16x32_bf16 v[200:203], a[136:139], v[68:71], v[200:203]
    v_mfma_f32_16x16x32_bf16 v[204:207], a[140:143], v[68:71], v[204:207]
    v_mfma_f32_16x16x32_bf16 v[208:211], a[128:131], v[72:75], v[208:211]
    v_mfma_f32_16x16x32_bf16 v[212:215], a[132:135], v[72:75], v[212:215]
    v_mfma_f32_16x16x32_bf16 v[216:219], a[136:139], v[72:75], v[216:219]
    v_mfma_f32_16x16x32_bf16 v[220:223], a[140:143], v[72:75], v[220:223]
    v_mfma_f32_16x16x32_bf16 v[224:227], a[128:131], v[76:79], v[224:227]
    v_mfma_f32_16x16x32_bf16 v[228:231], a[132:135], v[76:79], v[228:231]
    v_mfma_f32_16x16x32_bf16 v[232:235], a[136:139], v[76:79], v[232:235]
    v_mfma_f32_16x16x32_bf16 v[236:239], a[140:143], v[76:79], v[236:239]
    s_waitcnt vmcnt(8) lgkmcnt(0)
    s_barrier
    v_mfma_f32_16x16x32_bf16 v[112:115], a[144:147], v[80:83], v[112:115]
    ds_read_b64_tr_b16 v[48:49], v40 offset:0
    v_mfma_f32_16x16x32_bf16 v[116:119], a[148:151], v[80:83], v[116:119]
    ds_read_b64_tr_b16 v[50:51], v40 offset:4096
    v_mfma_f32_16x16x32_bf16 v[120:123], a[152:155], v[80:83], v[120:123]
    ds_read_b64_tr_b16 v[52:53], v41 offset:0
    v_mfma_f32_16x16x32_bf16 v[124:127], a[156:159], v[80:83], v[124:127]
    ds_read_b64_tr_b16 v[54:55], v41 offset:4096
    v_mfma_f32_16x16x32_bf16 v[128:131], a[144:147], v[84:87], v[128:131]
    v_mfma_f32_16x16x32_bf16 v[132:135], a[148:151], v[84:87], v[132:135]
    ds_read_b64_tr_b16 v[56:57], v42 offset:0
    v_mfma_f32_16x16x32_bf16 v[136:139], a[152:155], v[84:87], v[136:139]
    ds_read_b64_tr_b16 v[58:59], v42 offset:4096
    v_mfma_f32_16x16x32_bf16 v[140:143], a[156:159], v[84:87], v[140:143]
    ds_read_b64_tr_b16 v[60:61], v43 offset:0
    v_mfma_f32_16x16x32_bf16 v[144:147], a[144:147], v[88:91], v[144:147]
    ds_read_b64_tr_b16 v[62:63], v43 offset:4096
    v_mfma_f32_16x16x32_bf16 v[148:151], a[148:151], v[88:91], v[148:151]
    v_mfma_f32_16x16x32_bf16 v[152:155], a[152:155], v[88:91], v[152:155]
    ds_read_b64_tr_b16 v[64:65], v40 offset:8192
    v_mfma_f32_16x16x32_bf16 v[156:159], a[156:159], v[88:91], v[156:159]
    ds_read_b64_tr_b16 v[66:67], v40 offset:12288
    v_mfma_f32_16x16x32_bf16 v[160:163], a[144:147], v[92:95], v[160:163]
    ds_read_b64_tr_b16 v[68:69], v41 offset:8192
    v_mfma_f32_16x16x32_bf16 v[164:167], a[148:151], v[92:95], v[164:167]
    ds_read_b64_tr_b16 v[70:71], v41 offset:12288
    v_mfma_f32_16x16x32_bf16 v[168:171], a[152:155], v[92:95], v[168:171]
    v_mfma_f32_16x16x32_bf16 v[172:175], a[156:159], v[92:95], v[172:175]
    ds_read_b64_tr_b16 v[72:73], v42 offset:8192
    v_mfma_f32_16x16x32_bf16 v[176:179], a[144:147], v[96:99], v[176:179]
    ds_read_b64_tr_b16 v[74:75], v42 offset:12288
    v_mfma_f32_16x16x32_bf16 v[180:183], a[148:151], v[96:99], v[180:183]
    ds_read_b64_tr_b16 v[76:77], v43 offset:8192
    v_mfma_f32_16x16x32_bf16 v[184:187], a[152:155], v[96:99], v[184:187]
    ds_read_b64_tr_b16 v[78:79], v43 offset:12288
    v_mfma_f32_16x16x32_bf16 v[188:191], a[156:159], v[96:99], v[188:191]
    v_mfma_f32_16x16x32_bf16 v[192:195], a[144:147], v[100:103], v[192:195]
    v_mfma_f32_16x16x32_bf16 v[196:199], a[148:151], v[100:103], v[196:199]
    v_mfma_f32_16x16x32_bf16 v[200:203], a[152:155], v[100:103], v[200:203]
    v_mfma_f32_16x16x32_bf16 v[204:207], a[156:159], v[100:103], v[204:207]
    v_mfma_f32_16x16x32_bf16 v[208:211], a[144:147], v[104:107], v[208:211]
    v_mfma_f32_16x16x32_bf16 v[212:215], a[148:151], v[104:107], v[212:215]
    v_mfma_f32_16x16x32_bf16 v[216:219], a[152:155], v[104:107], v[216:219]
    v_mfma_f32_16x16x32_bf16 v[220:223], a[156:159], v[104:107], v[220:223]
    v_mfma_f32_16x16x32_bf16 v[224:227], a[144:147], v[108:111], v[224:227]
    v_mfma_f32_16x16x32_bf16 v[228:231], a[148:151], v[108:111], v[228:231]
    v_mfma_f32_16x16x32_bf16 v[232:235], a[152:155], v[108:111], v[232:235]
    v_mfma_f32_16x16x32_bf16 v[236:239], a[156:159], v[108:111], v[236:239]
    s_waitcnt lgkmcnt(0)
    v_mfma_f32_16x16x32_bf16 v[112:115], a[160:163], v[48:51], v[112:115]
    ds_read_b64_tr_b16 v[80:81], v240 offset:0
    v_mfma_f32_16x16x32_bf16 v[116:119], a[164:167], v[48:51], v[116:119]
    ds_write_b128 v244, v[176:179] offset:0
    ds_read_b64_tr_b16 v[82:83], v240 offset:4096
    v_mfma_f32_16x16x32_bf16 v[120:123], a[168:171], v[48:51], v[120:123]
    ds_write_b128 v244, v[180:183] offset:1024
    v_mfma_f32_16x16x32_bf16 v[124:127], a[172:175], v[48:51], v[124:127]
    ds_write_b128 v244, v[184:187] offset:2048
    ds_read_b64_tr_b16 v[84:85], v241 offset:0
    v_mfma_f32_16x16x32_bf16 v[128:131], a[160:163], v[52:55], v[128:131]
    ds_read_b64_tr_b16 v[86:87], v241 offset:4096
    v_mfma_f32_16x16x32_bf16 v[132:135], a[164:167], v[52:55], v[132:135]
    ds_write_b128 v244, v[188:191] offset:3072
    v_mfma_f32_16x16x32_bf16 v[136:139], a[168:171], v[52:55], v[136:139]
    ds_write_b128 v244, v[192:195] offset:4096
    ds_read_b64_tr_b16 v[88:89], v242 offset:0
    v_mfma_f32_16x16x32_bf16 v[140:143], a[172:175], v[52:55], v[140:143]
    ds_read_b64_tr_b16 v[90:91], v242 offset:4096
    v_mfma_f32_16x16x32_bf16 v[144:147], a[160:163], v[56:59], v[144:147]
    ds_write_b128 v244, v[196:199] offset:5120
    v_mfma_f32_16x16x32_bf16 v[148:151], a[164:167], v[56:59], v[148:151]
    ds_write_b128 v244, v[200:203] offset:6144
    ds_read_b64_tr_b16 v[92:93], v243 offset:0
    v_mfma_f32_16x16x32_bf16 v[152:155], a[168:171], v[56:59], v[152:155]
    ds_read_b64_tr_b16 v[94:95], v243 offset:4096
    v_mfma_f32_16x16x32_bf16 v[156:159], a[172:175], v[56:59], v[156:159]
    ds_write_b128 v244, v[204:207] offset:7168
    v_mfma_f32_16x16x32_bf16 v[160:163], a[160:163], v[60:63], v[160:163]
    ds_write_b128 v244, v[208:211] offset:8192
    ds_read_b64_tr_b16 v[96:97], v240 offset:8192
    v_mfma_f32_16x16x32_bf16 v[164:167], a[164:167], v[60:63], v[164:167]
    ds_write_b128 v244, v[212:215] offset:9216
    ds_read_b64_tr_b16 v[98:99], v240 offset:12288
    v_mfma_f32_16x16x32_bf16 v[168:171], a[168:171], v[60:63], v[168:171]
    v_mfma_f32_16x16x32_bf16 v[172:175], a[172:175], v[60:63], v[172:175]
    ds_write_b128 v244, v[216:219] offset:10240
    ds_read_b64_tr_b16 v[100:101], v241 offset:8192
    v_mfma_f32_16x16x32_bf16 v[112:115], a[176:179], v[64:67], v[112:115]
    ds_write_b128 v244, v[220:223] offset:11264
    ds_read_b64_tr_b16 v[102:103], v241 offset:12288
    v_mfma_f32_16x16x32_bf16 v[116:119], a[180:183], v[64:67], v[116:119]
    v_mfma_f32_16x16x32_bf16 v[120:123], a[184:187], v[64:67], v[120:123]
    ds_write_b128 v244, v[224:227] offset:12288
    ds_read_b64_tr_b16 v[104:105], v242 offset:8192
    v_mfma_f32_16x16x32_bf16 v[124:127], a[188:191], v[64:67], v[124:127]
    ds_write_b128 v244, v[228:231] offset:13312
    ds_read_b64_tr_b16 v[106:107], v242 offset:12288
    v_mfma_f32_16x16x32_bf16 v[128:131], a[176:179], v[68:71], v[128:131]
    v_mfma_f32_16x16x32_bf16 v[132:135], a[180:183], v[68:71], v[132:135]
    ds_write_b128 v244, v[232:235] offset:14336
    ds_read_b64_tr_b16 v[108:109], v243 offset:8192
    v_mfma_f32_16x16x32_bf16 v[136:139], a[184:187], v[68:71], v[136:139]
    ds_write_b128 v244, v[236:239] offset:15360
    ds_read_b64_tr_b16 v[110:111], v243 offset:12288
    v_mfma_f32_16x16x32_bf16 v[140:143], a[188:191], v[68:71], v[140:143]
    v_mfma_f32_16x16x32_bf16 v[144:147], a[176:179], v[72:75], v[144:147]
    v_mfma_f32_16x16x32_bf16 v[148:151], a[180:183], v[72:75], v[148:151]
    v_mfma_f32_16x16x32_bf16 v[152:155], a[184:187], v[72:75], v[152:155]
    v_mfma_f32_16x16x32_bf16 v[156:159], a[188:191], v[72:75], v[156:159]
    v_mfma_f32_16x16x32_bf16 v[160:163], a[176:179], v[76:79], v[160:163]
    v_mfma_f32_16x16x32_bf16 v[164:167], a[180:183], v[76:79], v[164:167]
    v_mfma_f32_16x16x32_bf16 v[168:171], a[184:187], v[76:79], v[168:171]
    v_mfma_f32_16x16x32_bf16 v[172:175], a[188:191], v[76:79], v[172:175]
    s_waitcnt vmcnt(0) lgkmcnt(0)
    s_barrier
    v_mfma_f32_16x16x32_bf16 v[112:115], a[192:195], v[80:83], v[112:115]
    ds_read_b128 v[176:179], v245 offset:0
    v_mfma_f32_16x16x32_bf16 v[116:119], a[196:199], v[80:83], v[116:119]
    ds_read_b128 v[180:183], v245 offset:1024
    v_mfma_f32_16x16x32_bf16 v[120:123], a[200:203], v[80:83], v[120:123]
    ds_read_b128 v[184:187], v245 offset:2048
    v_mfma_f32_16x16x32_bf16 v[124:127], a[204:207], v[80:83], v[124:127]
    ds_read_b128 v[188:191], v245 offset:3072
    v_mfma_f32_16x16x32_bf16 v[128:131], a[192:195], v[84:87], v[128:131]
    v_mfma_f32_16x16x32_bf16 v[132:135], a[196:199], v[84:87], v[132:135]
    ds_read_b128 v[192:195], v245 offset:4096
    v_mfma_f32_16x16x32_bf16 v[136:139], a[200:203], v[84:87], v[136:139]
    ds_read_b128 v[196:199], v245 offset:5120
    v_mfma_f32_16x16x32_bf16 v[140:143], a[204:207], v[84:87], v[140:143]
    ds_read_b128 v[200:203], v245 offset:6144
    v_mfma_f32_16x16x32_bf16 v[144:147], a[192:195], v[88:91], v[144:147]
    ds_read_b128 v[204:207], v245 offset:7168
    v_mfma_f32_16x16x32_bf16 v[148:151], a[196:199], v[88:91], v[148:151]
    v_mfma_f32_16x16x32_bf16 v[152:155], a[200:203], v[88:91], v[152:155]
    ds_read_b128 v[208:211], v245 offset:8192
    v_mfma_f32_16x16x32_bf16 v[156:159], a[204:207], v[88:91], v[156:159]
    ds_read_b128 v[212:215], v245 offset:9216
    v_mfma_f32_16x16x32_bf16 v[160:163], a[192:195], v[92:95], v[160:163]
    ds_read_b128 v[216:219], v245 offset:10240
    v_mfma_f32_16x16x32_bf16 v[164:167], a[196:199], v[92:95], v[164:167]
    ds_read_b128 v[220:223], v245 offset:11264
    v_mfma_f32_16x16x32_bf16 v[168:171], a[200:203], v[92:95], v[168:171]
    v_mfma_f32_16x16x32_bf16 v[172:175], a[204:207], v[92:95], v[172:175]
    ds_read_b128 v[224:227], v245 offset:12288
    v_mfma_f32_16x16x32_bf16 v[112:115], a[208:211], v[96:99], v[112:115]
    ds_read_b128 v[228:231], v245 offset:13312
    v_mfma_f32_16x16x32_bf16 v[116:119], a[212:215], v[96:99], v[116:119]
    ds_read_b128 v[232:235], v245 offset:14336
    v_mfma_f32_16x16x32_bf16 v[120:123], a[216:219], v[96:99], v[120:123]
    ds_read_b128 v[236:239], v245 offset:15360
    v_mfma_f32_16x16x32_bf16 v[124:127], a[220:223], v[96:99], v[124:127]
    v_mfma_f32_16x16x32_bf16 v[128:131], a[208:211], v[100:103], v[128:131]
    v_mfma_f32_16x16x32_bf16 v[132:135], a[212:215], v[100:103], v[132:135]
    v_mfma_f32_16x16x32_bf16 v[136:139], a[216:219], v[100:103], v[136:139]
    v_mfma_f32_16x16x32_bf16 v[140:143], a[220:223], v[100:103], v[140:143]
    v_mfma_f32_16x16x32_bf16 v[144:147], a[208:211], v[104:107], v[144:147]
    v_mfma_f32_16x16x32_bf16 v[148:151], a[212:215], v[104:107], v[148:151]
    v_mfma_f32_16x16x32_bf16 v[152:155], a[216:219], v[104:107], v[152:155]
    v_mfma_f32_16x16x32_bf16 v[156:159], a[220:223], v[104:107], v[156:159]
    v_mfma_f32_16x16x32_bf16 v[160:163], a[208:211], v[108:111], v[160:163]
    v_mfma_f32_16x16x32_bf16 v[164:167], a[212:215], v[108:111], v[164:167]
    v_mfma_f32_16x16x32_bf16 v[168:171], a[216:219], v[108:111], v[168:171]
    v_mfma_f32_16x16x32_bf16 v[172:175], a[220:223], v[108:111], v[172:175]
    s_waitcnt lgkmcnt(0)
    s_add_u32 s32, s64, 0x2000000
    s_addc_u32 s33, s65, 0
    s_mov_b32 s34, 0x400000
    s_mov_b32 s35, 0x00020000
    s_mov_b32 s86, 0xbfb8aa3b
    s_mov_b32 s87, 0xbfb8aa3b
    s_lshl_b32 s84, s80, 15
    s_lshl_b32 s85, s73, 14
    s_add_u32 s84, s84, s85
    s_lshl_b32 s85, s72, 12
    s_add_u32 s84, s84, s85
    s_add_u32 s85, s84, 8192
    v_mov_b32 v88, 1.0
    v_mov_b32 v89, 1.0
    v_lshlrev_b32 v8, 16, v8
    v_mov_b32 v9, v8
    v_lshlrev_b32 v10, 16, v10
    v_mov_b32 v11, v10
    v_lshlrev_b32 v12, 16, v12
    v_mov_b32 v13, v12
    v_lshlrev_b32 v14, 16, v14
    v_mov_b32 v15, v14
    v_pk_add_f32 v[112:113], v[112:113], v[8:9]
    v_pk_add_f32 v[114:115], v[114:115], v[8:9]
    v_pk_add_f32 v[116:117], v[116:117], v[8:9]
    v_pk_add_f32 v[118:119], v[118:119], v[8:9]
    v_pk_add_f32 v[120:121], v[120:121], v[8:9]
    v_pk_add_f32 v[122:123], v[122:123], v[8:9]
    v_pk_add_f32 v[124:125], v[124:125], v[8:9]
    v_pk_add_f32 v[126:127], v[126:127], v[8:9]
    v_pk_add_f32 v[128:129], v[128:129], v[10:11]
    v_pk_add_f32 v[130:131], v[130:131], v[10:11]
    v_pk_add_f32 v[132:133], v[132:133], v[10:11]
    v_pk_add_f32 v[134:135], v[134:135], v[10:11]
    v_pk_add_f32 v[136:137], v[136:137], v[10:11]
    v_pk_add_f32 v[138:139], v[138:139], v[10:11]
    v_pk_add_f32 v[140:141], v[140:141], v[10:11]
    v_pk_add_f32 v[142:143], v[142:143], v[10:11]
    v_pk_add_f32 v[144:145], v[144:145], v[12:13]
    v_pk_add_f32 v[146:147], v[146:147], v[12:13]
    v_pk_add_f32 v[148:149], v[148:149], v[12:13]
    v_pk_add_f32 v[150:151], v[150:151], v[12:13]
    v_pk_add_f32 v[152:153], v[152:153], v[12:13]
    v_pk_add_f32 v[154:155], v[154:155], v[12:13]
    v_pk_add_f32 v[156:157], v[156:157], v[12:13]
    v_pk_add_f32 v[158:159], v[158:159], v[12:13]
    v_pk_add_f32 v[160:161], v[160:161], v[14:15]
    v_pk_add_f32 v[162:163], v[162:163], v[14:15]
    v_pk_add_f32 v[164:165], v[164:165], v[14:15]
    v_pk_add_f32 v[166:167], v[166:167], v[14:15]
    v_pk_add_f32 v[168:169], v[168:169], v[14:15]
    v_pk_add_f32 v[170:171], v[170:171], v[14:15]
    v_pk_add_f32 v[172:173], v[172:173], v[14:15]
    v_pk_add_f32 v[174:175], v[174:175], v[14:15]
    v_pk_add_f32 v[112:113], v[112:113], v[176:177]
    v_pk_add_f32 v[114:115], v[114:115], v[178:179]
    v_pk_add_f32 v[116:117], v[116:117], v[180:181]
    v_pk_add_f32 v[118:119], v[118:119], v[182:183]
    v_pk_mul_f32 v[48:49], v[112:113], s[86:87]
    v_pk_mul_f32 v[50:51], v[114:115], s[86:87]
    v_pk_mul_f32 v[52:53], v[116:117], s[86:87]
    v_pk_mul_f32 v[54:55], v[118:119], s[86:87]
    v_exp_f32 v48, v48
    v_exp_f32 v49, v49
    v_exp_f32 v50, v50
    v_exp_f32 v51, v51
    v_exp_f32 v52, v52
    v_exp_f32 v53, v53
    v_exp_f32 v54, v54
    v_exp_f32 v55, v55
    v_pk_add_f32 v[48:49], v[48:49], v[88:89]
    v_pk_add_f32 v[50:51], v[50:51], v[88:89]
    v_pk_add_f32 v[52:53], v[52:53], v[88:89]
    v_pk_add_f32 v[54:55], v[54:55], v[88:89]
    v_rcp_f32 v48, v48
    v_rcp_f32 v49, v49
    v_rcp_f32 v50, v50
    v_rcp_f32 v51, v51
    v_rcp_f32 v52, v52
    v_rcp_f32 v53, v53
    v_rcp_f32 v54, v54
    v_rcp_f32 v55, v55
    v_pk_mul_f32 v[48:49], v[48:49], v[112:113]
    v_pk_mul_f32 v[50:51], v[50:51], v[114:115]
    v_pk_mul_f32 v[52:53], v[52:53], v[116:117]
    v_pk_mul_f32 v[54:55], v[54:55], v[118:119]
    v_cvt_pk_bf16_f32 v64, v48, v49
    v_cvt_pk_bf16_f32 v65, v50, v51
    v_cvt_pk_bf16_f32 v66, v52, v53
    v_cvt_pk_bf16_f32 v67, v54, v55
    buffer_store_dwordx4 v[64:67], v7, s[32:35], s84 offen offset:0 sc1
    v_pk_add_f32 v[120:121], v[120:121], v[184:185]
    v_pk_add_f32 v[122:123], v[122:123], v[186:187]
    v_pk_add_f32 v[124:125], v[124:125], v[188:189]
    v_pk_add_f32 v[126:127], v[126:127], v[190:191]
    v_pk_mul_f32 v[48:49], v[120:121], s[86:87]
    v_pk_mul_f32 v[50:51], v[122:123], s[86:87]
    v_pk_mul_f32 v[52:53], v[124:125], s[86:87]
    v_pk_mul_f32 v[54:55], v[126:127], s[86:87]
    v_exp_f32 v48, v48
    v_exp_f32 v49, v49
    v_exp_f32 v50, v50
    v_exp_f32 v51, v51
    v_exp_f32 v52, v52
    v_exp_f32 v53, v53
    v_exp_f32 v54, v54
    v_exp_f32 v55, v55
    v_pk_add_f32 v[48:49], v[48:49], v[88:89]
    v_pk_add_f32 v[50:51], v[50:51], v[88:89]
    v_pk_add_f32 v[52:53], v[52:53], v[88:89]
    v_pk_add_f32 v[54:55], v[54:55], v[88:89]
    v_rcp_f32 v48, v48
    v_rcp_f32 v49, v49
    v_rcp_f32 v50, v50
    v_rcp_f32 v51, v51
    v_rcp_f32 v52, v52
    v_rcp_f32 v53, v53
    v_rcp_f32 v54, v54
    v_rcp_f32 v55, v55
    v_pk_mul_f32 v[48:49], v[48:49], v[120:121]
    v_pk_mul_f32 v[50:51], v[50:51], v[122:123]
    v_pk_mul_f32 v[52:53], v[52:53], v[124:125]
    v_pk_mul_f32 v[54:55], v[54:55], v[126:127]
    v_cvt_pk_bf16_f32 v68, v48, v49
    v_cvt_pk_bf16_f32 v69, v50, v51
    v_cvt_pk_bf16_f32 v70, v52, v53
    v_cvt_pk_bf16_f32 v71, v54, v55
    buffer_store_dwordx4 v[68:71], v7, s[32:35], s85 offen offset:0 sc1
    v_pk_add_f32 v[128:129], v[128:129], v[192:193]
    v_pk_add_f32 v[130:131], v[130:131], v[194:195]
    v_pk_add_f32 v[132:133], v[132:133], v[196:197]
    v_pk_add_f32 v[134:135], v[134:135], v[198:199]
    v_pk_mul_f32 v[48:49], v[128:129], s[86:87]
    v_pk_mul_f32 v[50:51], v[130:131], s[86:87]
    v_pk_mul_f32 v[52:53], v[132:133], s[86:87]
    v_pk_mul_f32 v[54:55], v[134:135], s[86:87]
    v_exp_f32 v48, v48
    v_exp_f32 v49, v49
    v_exp_f32 v50, v50
    v_exp_f32 v51, v51
    v_exp_f32 v52, v52
    v_exp_f32 v53, v53
    v_exp_f32 v54, v54
    v_exp_f32 v55, v55
    v_pk_add_f32 v[48:49], v[48:49], v[88:89]
    v_pk_add_f32 v[50:51], v[50:51], v[88:89]
    v_pk_add_f32 v[52:53], v[52:53], v[88:89]
    v_pk_add_f32 v[54:55], v[54:55], v[88:89]
    v_rcp_f32 v48, v48
    v_rcp_f32 v49, v49
    v_rcp_f32 v50, v50
    v_rcp_f32 v51, v51
    v_rcp_f32 v52, v52
    v_rcp_f32 v53, v53
    v_rcp_f32 v54, v54
    v_rcp_f32 v55, v55
    v_pk_mul_f32 v[48:49], v[48:49], v[128:129]
    v_pk_mul_f32 v[50:51], v[50:51], v[130:131]
    v_pk_mul_f32 v[52:53], v[52:53], v[132:133]
    v_pk_mul_f32 v[54:55], v[54:55], v[134:135]
    v_cvt_pk_bf16_f32 v72, v48, v49
    v_cvt_pk_bf16_f32 v73, v50, v51
    v_cvt_pk_bf16_f32 v74, v52, v53
    v_cvt_pk_bf16_f32 v75, v54, v55
    buffer_store_dwordx4 v[72:75], v7, s[32:35], s84 offen offset:1024 sc1
    v_pk_add_f32 v[136:137], v[136:137], v[200:201]
    v_pk_add_f32 v[138:139], v[138:139], v[202:203]
    v_pk_add_f32 v[140:141], v[140:141], v[204:205]
    v_pk_add_f32 v[142:143], v[142:143], v[206:207]
    v_pk_mul_f32 v[48:49], v[136:137], s[86:87]
    v_pk_mul_f32 v[50:51], v[138:139], s[86:87]
    v_pk_mul_f32 v[52:53], v[140:141], s[86:87]
    v_pk_mul_f32 v[54:55], v[142:143], s[86:87]
    v_exp_f32 v48, v48
    v_exp_f32 v49, v49
    v_exp_f32 v50, v50
    v_exp_f32 v51, v51
    v_exp_f32 v52, v52
    v_exp_f32 v53, v53
    v_exp_f32 v54, v54
    v_exp_f32 v55, v55
    v_pk_add_f32 v[48:49], v[48:49], v[88:89]
    v_pk_add_f32 v[50:51], v[50:51], v[88:89]
    v_pk_add_f32 v[52:53], v[52:53], v[88:89]
    v_pk_add_f32 v[54:55], v[54:55], v[88:89]
    v_rcp_f32 v48, v48
    v_rcp_f32 v49, v49
    v_rcp_f32 v50, v50
    v_rcp_f32 v51, v51
    v_rcp_f32 v52, v52
    v_rcp_f32 v53, v53
    v_rcp_f32 v54, v54
    v_rcp_f32 v55, v55
    v_pk_mul_f32 v[48:49], v[48:49], v[136:137]
    v_pk_mul_f32 v[50:51], v[50:51], v[138:139]
    v_pk_mul_f32 v[52:53], v[52:53], v[140:141]
    v_pk_mul_f32 v[54:55], v[54:55], v[142:143]
    v_cvt_pk_bf16_f32 v76, v48, v49
    v_cvt_pk_bf16_f32 v77, v50, v51
    v_cvt_pk_bf16_f32 v78, v52, v53
    v_cvt_pk_bf16_f32 v79, v54, v55
    buffer_store_dwordx4 v[76:79], v7, s[32:35], s85 offen offset:1024 sc1
    v_pk_add_f32 v[144:145], v[144:145], v[208:209]
    v_pk_add_f32 v[146:147], v[146:147], v[210:211]
    v_pk_add_f32 v[148:149], v[148:149], v[212:213]
    v_pk_add_f32 v[150:151], v[150:151], v[214:215]
    v_pk_mul_f32 v[48:49], v[144:145], s[86:87]
    v_pk_mul_f32 v[50:51], v[146:147], s[86:87]
    v_pk_mul_f32 v[52:53], v[148:149], s[86:87]
    v_pk_mul_f32 v[54:55], v[150:151], s[86:87]
    v_exp_f32 v48, v48
    v_exp_f32 v49, v49
    v_exp_f32 v50, v50
    v_exp_f32 v51, v51
    v_exp_f32 v52, v52
    v_exp_f32 v53, v53
    v_exp_f32 v54, v54
    v_exp_f32 v55, v55
    v_pk_add_f32 v[48:49], v[48:49], v[88:89]
    v_pk_add_f32 v[50:51], v[50:51], v[88:89]
    v_pk_add_f32 v[52:53], v[52:53], v[88:89]
    v_pk_add_f32 v[54:55], v[54:55], v[88:89]
    v_rcp_f32 v48, v48
    v_rcp_f32 v49, v49
    v_rcp_f32 v50, v50
    v_rcp_f32 v51, v51
    v_rcp_f32 v52, v52
    v_rcp_f32 v53, v53
    v_rcp_f32 v54, v54
    v_rcp_f32 v55, v55
    v_pk_mul_f32 v[48:49], v[48:49], v[144:145]
    v_pk_mul_f32 v[50:51], v[50:51], v[146:147]
    v_pk_mul_f32 v[52:53], v[52:53], v[148:149]
    v_pk_mul_f32 v[54:55], v[54:55], v[150:151]
    v_cvt_pk_bf16_f32 v64, v48, v49
    v_cvt_pk_bf16_f32 v65, v50, v51
    v_cvt_pk_bf16_f32 v66, v52, v53
    v_cvt_pk_bf16_f32 v67, v54, v55
    buffer_store_dwordx4 v[64:67], v7, s[32:35], s84 offen offset:2048 sc1
    v_pk_add_f32 v[152:153], v[152:153], v[216:217]
    v_pk_add_f32 v[154:155], v[154:155], v[218:219]
    v_pk_add_f32 v[156:157], v[156:157], v[220:221]
    v_pk_add_f32 v[158:159], v[158:159], v[222:223]
    v_pk_mul_f32 v[48:49], v[152:153], s[86:87]
    v_pk_mul_f32 v[50:51], v[154:155], s[86:87]
    v_pk_mul_f32 v[52:53], v[156:157], s[86:87]
    v_pk_mul_f32 v[54:55], v[158:159], s[86:87]
    v_exp_f32 v48, v48
    v_exp_f32 v49, v49
    v_exp_f32 v50, v50
    v_exp_f32 v51, v51
    v_exp_f32 v52, v52
    v_exp_f32 v53, v53
    v_exp_f32 v54, v54
    v_exp_f32 v55, v55
    v_pk_add_f32 v[48:49], v[48:49], v[88:89]
    v_pk_add_f32 v[50:51], v[50:51], v[88:89]
    v_pk_add_f32 v[52:53], v[52:53], v[88:89]
    v_pk_add_f32 v[54:55], v[54:55], v[88:89]
    v_rcp_f32 v48, v48
    v_rcp_f32 v49, v49
    v_rcp_f32 v50, v50
    v_rcp_f32 v51, v51
    v_rcp_f32 v52, v52
    v_rcp_f32 v53, v53
    v_rcp_f32 v54, v54
    v_rcp_f32 v55, v55
    v_pk_mul_f32 v[48:49], v[48:49], v[152:153]
    v_pk_mul_f32 v[50:51], v[50:51], v[154:155]
    v_pk_mul_f32 v[52:53], v[52:53], v[156:157]
    v_pk_mul_f32 v[54:55], v[54:55], v[158:159]
    v_cvt_pk_bf16_f32 v68, v48, v49
    v_cvt_pk_bf16_f32 v69, v50, v51
    v_cvt_pk_bf16_f32 v70, v52, v53
    v_cvt_pk_bf16_f32 v71, v54, v55
    buffer_store_dwordx4 v[68:71], v7, s[32:35], s85 offen offset:2048 sc1
    v_pk_add_f32 v[160:161], v[160:161], v[224:225]
    v_pk_add_f32 v[162:163], v[162:163], v[226:227]
    v_pk_add_f32 v[164:165], v[164:165], v[228:229]
    v_pk_add_f32 v[166:167], v[166:167], v[230:231]
    v_pk_mul_f32 v[48:49], v[160:161], s[86:87]
    v_pk_mul_f32 v[50:51], v[162:163], s[86:87]
    v_pk_mul_f32 v[52:53], v[164:165], s[86:87]
    v_pk_mul_f32 v[54:55], v[166:167], s[86:87]
    v_exp_f32 v48, v48
    v_exp_f32 v49, v49
    v_exp_f32 v50, v50
    v_exp_f32 v51, v51
    v_exp_f32 v52, v52
    v_exp_f32 v53, v53
    v_exp_f32 v54, v54
    v_exp_f32 v55, v55
    v_pk_add_f32 v[48:49], v[48:49], v[88:89]
    v_pk_add_f32 v[50:51], v[50:51], v[88:89]
    v_pk_add_f32 v[52:53], v[52:53], v[88:89]
    v_pk_add_f32 v[54:55], v[54:55], v[88:89]
    v_rcp_f32 v48, v48
    v_rcp_f32 v49, v49
    v_rcp_f32 v50, v50
    v_rcp_f32 v51, v51
    v_rcp_f32 v52, v52
    v_rcp_f32 v53, v53
    v_rcp_f32 v54, v54
    v_rcp_f32 v55, v55
    v_pk_mul_f32 v[48:49], v[48:49], v[160:161]
    v_pk_mul_f32 v[50:51], v[50:51], v[162:163]
    v_pk_mul_f32 v[52:53], v[52:53], v[164:165]
    v_pk_mul_f32 v[54:55], v[54:55], v[166:167]
    v_cvt_pk_bf16_f32 v72, v48, v49
    v_cvt_pk_bf16_f32 v73, v50, v51
    v_cvt_pk_bf16_f32 v74, v52, v53
    v_cvt_pk_bf16_f32 v75, v54, v55
    buffer_store_dwordx4 v[72:75], v7, s[32:35], s84 offen offset:3072 sc1
    v_pk_add_f32 v[168:169], v[168:169], v[232:233]
    v_pk_add_f32 v[170:171], v[170:171], v[234:235]
    v_pk_add_f32 v[172:173], v[172:173], v[236:237]
    v_pk_add_f32 v[174:175], v[174:175], v[238:239]
    v_pk_mul_f32 v[48:49], v[168:169], s[86:87]
    v_pk_mul_f32 v[50:51], v[170:171], s[86:87]
    v_pk_mul_f32 v[52:53], v[172:173], s[86:87]
    v_pk_mul_f32 v[54:55], v[174:175], s[86:87]
    v_exp_f32 v48, v48
    v_exp_f32 v49, v49
    v_exp_f32 v50, v50
    v_exp_f32 v51, v51
    v_exp_f32 v52, v52
    v_exp_f32 v53, v53
    v_exp_f32 v54, v54
    v_exp_f32 v55, v55
    v_pk_add_f32 v[48:49], v[48:49], v[88:89]
    v_pk_add_f32 v[50:51], v[50:51], v[88:89]
    v_pk_add_f32 v[52:53], v[52:53], v[88:89]
    v_pk_add_f32 v[54:55], v[54:55], v[88:89]
    v_rcp_f32 v48, v48
    v_rcp_f32 v49, v49
    v_rcp_f32 v50, v50
    v_rcp_f32 v51, v51
    v_rcp_f32 v52, v52
    v_rcp_f32 v53, v53
    v_rcp_f32 v54, v54
    v_rcp_f32 v55, v55
    v_pk_mul_f32 v[48:49], v[48:49], v[168:169]
    v_pk_mul_f32 v[50:51], v[50:51], v[170:171]
    v_pk_mul_f32 v[52:53], v[52:53], v[172:173]
    v_pk_mul_f32 v[54:55], v[54:55], v[174:175]
    v_cvt_pk_bf16_f32 v76, v48, v49
    v_cvt_pk_bf16_f32 v77, v50, v51
    v_cvt_pk_bf16_f32 v78, v52, v53
    v_cvt_pk_bf16_f32 v79, v54, v55
    buffer_store_dwordx4 v[76:79], v7, s[32:35], s85 offen offset:3072 sc1
    s_waitcnt vmcnt(0)
    s_barrier
    s_lshl_b32 s82, s80, 6
    s_add_u32 s82, s82, 20480
    v_mov_b32 v248, s50
    v_mov_b32 v249, s51
    v_lshlrev_b32 v250, 11, v0
    v_cmp_gt_u32 vcc, 1, v0
    s_and_saveexec_b64 s[84:85], vcc
    s_cbranch_execz 1f
    buffer_store_dwordx2 v[248:249], v250, s[36:39], s82 offen sc1
1:
    s_mov_b64 exec, s[84:85]
km_end:
    s_endpgm
km_yq1:
    s_cmp_eq_u32 s3, 2
    s_cbranch_scc1 km_yq1_ret
    s_lshl_b32 s82, s77, 5
    s_add_u32 s82, s82, s76
    s_lshl_b32 s82, s82, 3
    s_add_u32 s82, s82, 18432
    v_mov_b32 v248, s50
    v_mov_b32 v249, s51
    v_lshlrev_b32 v250, 11, v0
    v_cmp_gt_u32 vcc, 1, v0
    s_and_saveexec_b64 s[84:85], vcc
    s_cbranch_execz 1f
    buffer_store_dwordx2 v[248:249], v250, s[36:39], s82 offen sc1
1:
    s_mov_b64 exec, s[84:85]
    s_branch km_yq1_ret
km_yq2:
    s_and_b32 s84, s2, 1
    s_lshl_b32 s84, s84, 5
    s_add_u32 s87, s81, s84
    s_lshl_b32 s87, s87, 11
    s_lshl_b32 s84, s71, 9
    s_add_u32 s87, s87, s84
    v_and_b32 v30, 3, v1
    v_lshlrev_b32 v30, 7, v30
    buffer_load_dword v31, v30, s[16:19], s87 offen
    buffer_load_dword v31, v30, s[20:23], s87 offen
    s_branch km_yq2_ret
km_ypi:
    buffer_load_dwordx2 v[16:17], v27, s[36:39], 0 offen sc1
    s_branch km_ypi_ret
km_ywrap:
    s_sub_u32 s66, s66, 14680064
    s_sub_u32 s67, s67, 7340032
    s_mov_b32 s10, 8388608
    s_mov_b32 s83, 0
km_pub_chk:
    v_cmp_ne_u64 vcc, s[50:51], v[16:17]
    s_add_u32 s83, s83, 1
    s_cbranch_vccz km_pub_ok
    s_cmp_gt_u32 s83, 0x20000
    s_cbranch_scc1 km_pub_ok
    s_sleep 2
    buffer_load_dwordx2 v[16:17], v27, s[36:39], 0 offen sc1
    s_waitcnt vmcnt(0)
    s_branch km_pub_chk
km_pub_ok:
    s_branch km_ywrap_ret
km_spare:
    s_mov_b32 s28, s46
    s_mov_b32 s29, s47
    s_mov_b32 s30, 0x600000
    s_mov_b32 s31, 0x00020000
    s_and_b32 s87, s2, 3
    s_lshl_b32 s87, s87, 3
    s_add_u32 s87, s87, s81
    s_sub_u32 s87, s87, 24
    s_lshl_b32 s87, s87, 2
    s_add_u32 s87, s87, s71
    s_mul_i32 s87, s87, 16384
    s_add_u32 s87, s87, 4194304
    v_and_b32 v208, 31, v1
    v_min_u32 v208, 31, v208
    v_lshlrev_b32 v208, 7, v208
    v_lshrrev_b32 v209, 5, v1
    v_mul_u32_u24 v209, 8192, v209
    v_add_u32 v208, v208, v209
    buffer_load_dword v31, v208, s[28:31], s87 offen
    s_nop 0
    s_mov_b32 s28, s52
    s_mov_b32 s29, s53
    s_mov_b32 s30, 0x8c0000
    s_mov_b32 s31, 0x00020000
    s_and_b32 s87, s2, 3
    s_lshl_b32 s87, s87, 3
    s_add_u32 s87, s87, s81
    s_sub_u32 s87, s87, 24
    s_lshl_b32 s87, s87, 2
    s_add_u32 s87, s87, s71
    s_mul_i32 s87, s87, 14336
    s_add_u32 s87, s87, 7344128
    v_and_b32 v208, 31, v1
    v_min_u32 v208, 23, v208
    v_lshlrev_b32 v208, 7, v208
    v_lshrrev_b32 v209, 5, v1
    v_mul_u32_u24 v209, 7168, v209
    v_add_u32 v208, v208, v209
    buffer_load_dword v31, v208, s[28:31], s87 offen
    s_nop 0
    s_mov_b32 s28, s46
    s_mov_b32 s29, s47
    s_mov_b32 s30, 0x800000
    s_mov_b32 s31, 0x00020000
    s_and_b32 s87, s2, 3
    s_lshl_b32 s87, s87, 3
    s_add_u32 s87, s87, s81
    s_sub_u32 s87, s87, 24
    s_lshl_b32 s87, s87, 2
    s_add_u32 s87, s87, s71
    s_mul_i32 s87, s87, 16384
    s_add_u32 s87, s87, 6291456
    v_and_b32 v208, 31, v1
    v_min_u32 v208, 31, v208
    v_lshlrev_b32 v208, 7, v208
    v_lshrrev_b32 v209, 5, v1
    v_mul_u32_u24 v209, 8192, v209
    v_add_u32 v208, v208, v209
    buffer_load_dword v31, v208, s[28:31], s87 offen
    s_nop 0
    s_mov_b32 s28, s52
    s_mov_b32 s29, s53
    s_mov_b32 s30, 0xa80000
    s_mov_b32 s31, 0x00020000
    s_and_b32 s87, s2, 3
    s_lshl_b32 s87, s87, 3
    s_add_u32 s87, s87, s81
    s_sub_u32 s87, s87, 24
    s_lshl_b32 s87, s87, 2
    s_add_u32 s87, s87, s71
    s_mul_i32 s87, s87, 14336
    s_add_u32 s87, s87, 9179136
    v_and_b32 v208, 31, v1
    v_min_u32 v208, 23, v208
    v_lshlrev_b32 v208, 7, v208
    v_lshrrev_b32 v209, 5, v1
    v_mul_u32_u24 v209, 7168, v209
    v_add_u32 v208, v208, v209
    buffer_load_dword v31, v208, s[28:31], s87 offen
    s_nop 0
    s_mov_b32 s28, s52
    s_mov_b32 s29, s53
    s_mov_b32 s30, 0xc40000
    s_mov_b32 s31, 0x00020000
    s_and_b32 s87, s2, 3
    s_lshl_b32 s87, s87, 3
    s_add_u32 s87, s87, s81
    s_sub_u32 s87, s87, 24
    s_lshl_b32 s87, s87, 2
    s_add_u32 s87, s87, s71
    s_mul_i32 s87, s87, 14336
    s_add_u32 s87, s87, 11014144
    v_and_b32 v208, 31, v1
    v_min_u32 v208, 23, v208
    v_lshlrev_b32 v208, 7, v208
    v_lshrrev_b32 v209, 5, v1
    v_mul_u32_u24 v209, 7168, v209
    v_add_u32 v208, v208, v209
    buffer_load_dword v31, v208, s[28:31], s87 offen
    s_nop 0
    s_mov_b32 s28, s52
    s_mov_b32 s29, s53
    s_mov_b32 s30, 0xe00000
    s_mov_b32 s31, 0x00020000
    s_and_b32 s87, s2, 3
    s_lshl_b32 s87, s87, 3
    s_add_u32 s87, s87, s81
    s_sub_u32 s87, s87, 24
    s_lshl_b32 s87, s87, 2
    s_add_u32 s87, s87, s71
    s_mul_i32 s87, s87, 14336
    s_add_u32 s87, s87, 12849152
    v_and_b32 v208, 31, v1
    v_min_u32 v208, 23, v208
    v_lshlrev_b32 v208, 7, v208
    v_lshrrev_b32 v209, 5, v1
    v_mul_u32_u24 v209, 7168, v209
    v_add_u32 v208, v208, v209
    buffer_load_dword v31, v208, s[28:31], s87 offen
    s_nop 0
    s_mov_b32 s28, s46
    s_mov_b32 s29, s47
    s_mov_b32 s30, 0x200000
    s_mov_b32 s31, 0x00020000
    s_and_b32 s87, s2, 3
    s_lshl_b32 s87, s87, 3
    s_add_u32 s87, s87, s81
    s_sub_u32 s87, s87, 24
    s_lshl_b32 s87, s87, 2
    s_add_u32 s87, s87, s71
    s_mul_i32 s87, s87, 16384
    s_add_u32 s87, s87, 4096
    v_and_b32 v208, 31, v1
    v_min_u32 v208, 31, v208
    v_lshlrev_b32 v208, 7, v208
    v_lshrrev_b32 v209, 5, v1
    v_mul_u32_u24 v209, 8192, v209
    v_add_u32 v208, v208, v209
    buffer_load_dword v31, v208, s[28:31], s87 offen
    s_nop 0
    s_mov_b32 s28, s46
    s_mov_b32 s29, s47
    s_mov_b32 s30, 0x400000
    s_mov_b32 s31, 0x00020000
    s_and_b32 s87, s2, 3
    s_lshl_b32 s87, s87, 3
    s_add_u32 s87, s87, s81
    s_sub_u32 s87, s87, 24
    s_lshl_b32 s87, s87, 2
    s_add_u32 s87, s87, s71
    s_mul_i32 s87, s87, 16384
    s_add_u32 s87, s87, 2101248
    v_and_b32 v208, 31, v1
    v_min_u32 v208, 31, v208
    v_lshlrev_b32 v208, 7, v208
    v_lshrrev_b32 v209, 5, v1
    v_mul_u32_u24 v209, 8192, v209
    v_add_u32 v208, v208, v209
    buffer_load_dword v31, v208, s[28:31], s87 offen
    s_nop 0
    s_mov_b32 s28, s46
    s_mov_b32 s29, s47
    s_mov_b32 s30, 0x600000
    s_mov_b32 s31, 0x00020000
    s_and_b32 s87, s2, 3
    s_lshl_b32 s87, s87, 3
    s_add_u32 s87, s87, s81
    s_sub_u32 s87, s87, 24
    s_lshl_b32 s87, s87, 2
    s_add_u32 s87, s87, s71
    s_mul_i32 s87, s87, 16384
    s_add_u32 s87, s87, 4198400
    v_and_b32 v208, 31, v1
    v_min_u32 v208, 31, v208
    v_lshlrev_b32 v208, 7, v208
    v_lshrrev_b32 v209, 5, v1
    v_mul_u32_u24 v209, 8192, v209
    v_add_u32 v208, v208, v209
    buffer_load_dword v31, v208, s[28:31], s87 offen
    s_nop 0
    s_mov_b32 s28, s46
    s_mov_b32 s29, s47
    s_mov_b32 s30, 0x800000
    s_mov_b32 s31, 0x00020000
    s_and_b32 s87, s2, 3
    s_lshl_b32 s87, s87, 3
    s_add_u32 s87, s87, s81
    s_sub_u32 s87, s87, 24
    s_lshl_b32 s87, s87, 2
    s_add_u32 s87, s87, s71
    s_mul_i32 s87, s87, 16384
    s_add_u32 s87, s87, 6295552
    v_and_b32 v208, 31, v1
    v_min_u32 v208, 31, v208
    v_lshlrev_b32 v208, 7, v208
    v_lshrrev_b32 v209, 5, v1
    v_mul_u32_u24 v209, 8192, v209
    v_add_u32 v208, v208, v209
    buffer_load_dword v31, v208, s[28:31], s87 offen
    s_nop 0
    s_mov_b32 s28, s52
    s_mov_b32 s29, s53
    s_mov_b32 s30, 0x1c0000
    s_mov_b32 s31, 0x00020000
    s_and_b32 s87, s2, 3
    s_lshl_b32 s87, s87, 3
    s_add_u32 s87, s87, s81
    s_sub_u32 s87, s87, 24
    s_lshl_b32 s87, s87, 2
    s_add_u32 s87, s87, s71
    s_mul_i32 s87, s87, 14336
    s_add_u32 s87, s87, 0
    v_and_b32 v208, 31, v1
    v_min_u32 v208, 31, v208
    v_lshlrev_b32 v208, 7, v208
    v_lshrrev_b32 v209, 5, v1
    v_mul_u32_u24 v209, 7168, v209
    v_add_u32 v208, v208, v209
    buffer_load_dword v31, v208, s[28:31], s87 offen
    s_nop 0
    s_mov_b32 s28, s52
    s_mov_b32 s29, s53
    s_mov_b32 s30, 0x380000
    s_mov_b32 s31, 0x00020000
    s_and_b32 s87, s2, 3
    s_lshl_b32 s87, s87, 3
    s_add_u32 s87, s87, s81
    s_sub_u32 s87, s87, 24
    s_lshl_b32 s87, s87, 2
    s_add_u32 s87, s87, s71
    s_mul_i32 s87, s87, 14336
    s_add_u32 s87, s87, 1835008
    v_and_b32 v208, 31, v1
    v_min_u32 v208, 31, v208
    v_lshlrev_b32 v208, 7, v208
    v_lshrrev_b32 v209, 5, v1
    v_mul_u32_u24 v209, 7168, v209
    v_add_u32 v208, v208, v209
    buffer_load_dword v31, v208, s[28:31], s87 offen
    s_nop 0
    s_mov_b32 s28, s52
    s_mov_b32 s29, s53
    s_mov_b32 s30, 0x540000
    s_mov_b32 s31, 0x00020000
    s_and_b32 s87, s2, 3
    s_lshl_b32 s87, s87, 3
    s_add_u32 s87, s87, s81
    s_sub_u32 s87, s87, 24
    s_lshl_b32 s87, s87, 2
    s_add_u32 s87, s87, s71
    s_mul_i32 s87, s87, 14336
    s_add_u32 s87, s87, 3670016
    v_and_b32 v208, 31, v1
    v_min_u32 v208, 31, v208
    v_lshlrev_b32 v208, 7, v208
    v_lshrrev_b32 v209, 5, v1
    v_mul_u32_u24 v209, 7168, v209
    v_add_u32 v208, v208, v209
    buffer_load_dword v31, v208, s[28:31], s87 offen
    s_nop 0
    s_mov_b32 s28, s52
    s_mov_b32 s29, s53
    s_mov_b32 s30, 0x700000
    s_mov_b32 s31, 0x00020000
    s_and_b32 s87, s2, 3
    s_lshl_b32 s87, s87, 3
    s_add_u32 s87, s87, s81
    s_sub_u32 s87, s87, 24
    s_lshl_b32 s87, s87, 2
    s_add_u32 s87, s87, s71
    s_mul_i32 s87, s87, 14336
    s_add_u32 s87, s87, 5505024
    v_and_b32 v208, 31, v1
    v_min_u32 v208, 31, v208
    v_lshlrev_b32 v208, 7, v208
    v_lshrrev_b32 v209, 5, v1
    v_mul_u32_u24 v209, 7168, v209
    v_add_u32 v208, v208, v209
    buffer_load_dword v31, v208, s[28:31], s87 offen
    s_nop 0
    v_lshrrev_b32 v208, 4, v1
    v_and_b32 v209, 15, v1
    v_lshrrev_b32 v210, 2, v209
    v_and_b32 v211, 3, v209
    v_lshrrev_b32 v212, 1, v208
    v_and_b32 v214, 1, v208
    v_lshl_add_u32 v213, v212, 2, v210
    v_lshlrev_b32 v213, 8, v213
    v_lshl_add_u32 v213, v214, 5, v213
    v_lshl_add_u32 v213, v211, 3, v213
    v_add_u32 v213, 65536, v213
    v_xor_b32 v214, 0, v210
    v_lshl_add_u32 v16, v214, 6, v213
    v_xor_b32 v214, 1, v210
    v_lshl_add_u32 v17, v214, 6, v213
    v_xor_b32 v214, 2, v210
    v_lshl_add_u32 v18, v214, 6, v213
    v_xor_b32 v214, 3, v210
    v_lshl_add_u32 v19, v214, 6, v213
    v_add_u32 v214, 0, v208
    v_xor_b32 v214, v214, v209
    v_lshlrev_b32 v214, 4, v214
    v_lshl_add_u32 v20, v208, 8, v214
    v_add_u32 v214, 4, v208
    v_xor_b32 v214, v214, v209
    v_lshlrev_b32 v214, 4, v214
    v_lshl_add_u32 v21, v208, 8, v214
    v_add_u32 v214, 8, v208
    v_xor_b32 v214, v214, v209
    v_lshlrev_b32 v214, 4, v214
    v_lshl_add_u32 v22, v208, 8, v214
    v_add_u32 v214, 12, v208
    v_xor_b32 v214, v214, v209
    v_lshlrev_b32 v214, 4, v214
    v_lshl_add_u32 v23, v208, 8, v214
    v_and_b32 v213, 31, v1
    v_lshlrev_b32 v214, 8, v213
    v_xor_b32 v215, v212, v209
    s_lshl_b32 s84, s72, 3
    v_xor_b32 v215, s84, v215
    v_xor_b32 v216, 0, v215
    v_lshl_add_u32 v8, v216, 4, v214
    v_xor_b32 v216, 2, v215
    v_lshl_add_u32 v9, v216, 4, v214
    v_xor_b32 v216, 4, v215
    v_lshl_add_u32 v10, v216, 4, v214
    v_xor_b32 v216, 6, v215
    v_lshl_add_u32 v11, v216, 4, v214
    v_xor_b32 v216, 8, v215
    v_lshl_add_u32 v12, v216, 4, v214
    v_xor_b32 v216, 10, v215
    v_lshl_add_u32 v13, v216, 4, v214
    v_xor_b32 v216, 12, v215
    v_lshl_add_u32 v14, v216, 4, v214
    v_xor_b32 v216, 14, v215
    v_lshl_add_u32 v15, v216, 4, v214
    v_bfe_u32 v214, v213, 2, 1
    v_lshlrev_b32 v214, 10, v214
    v_lshl_add_u32 v214, v212, 8, v214
    v_lshrrev_b32 v215, 3, v213
    v_lshl_add_u32 v214, v215, 6, v214
    v_and_b32 v215, 3, v213
    v_lshl_add_u32 v214, v215, 4, v214
    s_lshl_b32 s84, s74, 2
    s_add_u32 s84, s84, s71
    s_lshl_b32 s84, s84, 12
    v_add_u32 v25, s84, v214
    s_lshl_b32 s84, s72, 14
    v_subrev_u32 v40, s84, v40
    v_subrev_u32 v41, s84, v41
    v_subrev_u32 v42, s84, v42
    v_subrev_u32 v43, s84, v43
    v_subrev_u32 v44, s84, v44
    v_subrev_u32 v45, s84, v45
    v_subrev_u32 v46, s84, v46
    v_subrev_u32 v47, s84, v47
    s_cmp_lg_u32 s71, 0
    s_cbranch_scc1 km_ps_ok
    buffer_load_dwordx4 v[248:251], v30, s[36:39], 0 offen sc1
    buffer_load_dwordx4 v[252:255], v30, s[36:39], 0 offen offset:1024 sc1
    s_waitcnt vmcnt(0)
    s_mov_b32 s83, 0
km_ps_chk:
    v_cmp_ne_u64 vcc, s[50:51], v[248:249]
    v_cmp_ne_u64 s[84:85], s[50:51], v[250:251]
    s_or_b64 vcc, vcc, s[84:85]
    v_cmp_ne_u64 s[84:85], s[50:51], v[252:253]
    s_or_b64 vcc, vcc, s[84:85]
    v_cmp_ne_u64 s[84:85], s[50:51], v[254:255]
    s_or_b64 vcc, vcc, s[84:85]
    s_add_u32 s83, s83, 1
    s_cbranch_vccz km_ps_ok
    s_cmp_gt_u32 s83, 0x20000
    s_cbranch_scc1 km_ps_ok
    s_sleep 4
    buffer_load_dwordx4 v[248:251], v30, s[36:39], 0 offen sc1
    buffer_load_dwordx4 v[252:255], v30, s[36:39], 0 offen offset:1024 sc1
    s_waitcnt vmcnt(0)
    s_branch km_ps_chk
km_ps_ok:
    s_barrier
    buffer_load_dwordx4 a[192:195], v6, s[12:15], s67 offen offset:0 sc1
    buffer_load_dwordx4 a[196:199], v6, s[12:15], s67 offen offset:1024 sc1
    buffer_load_dwordx4 a[200:203], v6, s[12:15], s67 offen offset:2048 sc1
    buffer_load_dwordx4 a[204:207], v6, s[12:15], s67 offen offset:3072 sc1
    s_add_u32 s67, s67, 131072
    buffer_load_dwordx4 a[208:211], v6, s[12:15], s67 offen offset:0 sc1
    buffer_load_dwordx4 a[212:215], v6, s[12:15], s67 offen offset:1024 sc1
    buffer_load_dwordx4 a[216:219], v6, s[12:15], s67 offen offset:2048 sc1
    buffer_load_dwordx4 a[220:223], v6, s[12:15], s67 offen offset:3072 sc1
    s_add_u32 s67, s67, 131072
    buffer_load_dwordx4 a[224:227], v6, s[12:15], s67 offen offset:0 sc1
    buffer_load_dwordx4 a[228:231], v6, s[12:15], s67 offen offset:1024 sc1
    buffer_load_dwordx4 a[232:235], v6, s[12:15], s67 offen offset:2048 sc1
    buffer_load_dwordx4 a[236:239], v6, s[12:15], s67 offen offset:3072 sc1
    s_add_u32 s67, s67, 131072
    buffer_load_dwordx4 a[240:243], v6, s[12:15], s67 offen offset:0 sc1
    buffer_load_dwordx4 a[244:247], v6, s[12:15], s67 offen offset:1024 sc1
    buffer_load_dwordx4 a[248:251], v6, s[12:15], s67 offen offset:2048 sc1
    buffer_load_dwordx4 a[252:255], v6, s[12:15], s67 offen offset:3072 sc1
    s_add_u32 s67, s67, 131072
    buffer_load_dwordx4 a[128:131], v6, s[12:15], s67 offen offset:0 sc1
    buffer_load_dwordx4 a[132:135], v6, s[12:15], s67 offen offset:1024 sc1
    buffer_load_dwordx4 a[136:139], v6, s[12:15], s67 offen offset:2048 sc1
    buffer_load_dwordx4 a[140:143], v6, s[12:15], s67 offen offset:3072 sc1
    s_add_u32 s67, s67, 131072
    buffer_load_dwordx4 a[144:147], v6, s[12:15], s67 offen offset:0 sc1
    buffer_load_dwordx4 a[148:151], v6, s[12:15], s67 offen offset:1024 sc1
    buffer_load_dwordx4 a[152:155], v6, s[12:15], s67 offen offset:2048 sc1
    buffer_load_dwordx4 a[156:159], v6, s[12:15], s67 offen offset:3072 sc1
    s_add_u32 s67, s67, 131072
    ds_read_b64_tr_b16 v[48:49], v40 offset:32768
    ds_read_b64_tr_b16 v[50:51], v40 offset:36864
    ds_read_b64_tr_b16 v[52:53], v41 offset:32768
    ds_read_b64_tr_b16 v[54:55], v41 offset:36864
    ds_read_b64_tr_b16 v[56:57], v42 offset:32768
    ds_read_b64_tr_b16 v[58:59], v42 offset:36864
    ds_read_b64_tr_b16 v[60:61], v43 offset:32768
    ds_read_b64_tr_b16 v[62:63], v43 offset:36864
    ds_read_b64_tr_b16 v[64:65], v44 offset:32768
    ds_read_b64_tr_b16 v[66:67], v44 offset:36864
    ds_read_b64_tr_b16 v[68:69], v45 offset:32768
    ds_read_b64_tr_b16 v[70:71], v45 offset:36864
    ds_read_b64_tr_b16 v[72:73], v46 offset:32768
    ds_read_b64_tr_b16 v[74:75], v46 offset:36864
    ds_read_b64_tr_b16 v[76:77], v47 offset:32768
    ds_read_b64_tr_b16 v[78:79], v47 offset:36864
    s_waitcnt vmcnt(0)
    s_branch km_yq
km_fallback:
    s_lshl_b32 s87, s71, 13
    s_add_u32 s88, s87, 65536
    v_mov_b32 v244, 0xff800000
    v_mov_b32 v245, 0xff800000
    v_add_u32 v224, s88, v8
    v_add_u32 v225, s88, v9
    v_add_u32 v226, s88, v10
    v_add_u32 v227, s88, v11
    v_add_u32 v228, s88, v12
    v_add_u32 v229, s88, v13
    v_add_u32 v230, s88, v14
    v_add_u32 v231, s88, v15
    v_add_u32 v232, s87, v16
    v_add_u32 v233, s87, v17
    v_add_u32 v234, s87, v18
    v_add_u32 v235, s87, v19
    s_mov_b32 s89, 0
km_fb1:
    s_add_u32 m0, s88, 0
    s_add_u32 s86, s89, 0
    buffer_load_dwordx4 v20, s[16:19], s86 offen offset:0 lds
    buffer_load_dwordx4 v21, s[16:19], s86 offen offset:1024 lds
    buffer_load_dwordx4 v22, s[16:19], s86 offen offset:2048 lds
    buffer_load_dwordx4 v23, s[16:19], s86 offen offset:3072 lds
    s_add_u32 m0, s88, 4096
    s_add_u32 s86, s89, 4096
    buffer_load_dwordx4 v20, s[16:19], s86 offen offset:0 lds
    buffer_load_dwordx4 v21, s[16:19], s86 offen offset:1024 lds
    buffer_load_dwordx4 v22, s[16:19], s86 offen offset:2048 lds
    buffer_load_dwordx4 v23, s[16:19], s86 offen offset:3072 lds
    s_waitcnt vmcnt(0)
    ds_read_b128 v[144:147], v224
    ds_read_b128 v[148:151], v225
    ds_read_b128 v[152:155], v226
    ds_read_b128 v[156:159], v227
    ds_read_b128 v[160:163], v228
    ds_read_b128 v[164:167], v229
    ds_read_b128 v[168:171], v230
    ds_read_b128 v[172:175], v231
    s_waitcnt lgkmcnt(0)
    v_mfma_f32_32x32x16_bf16 v[112:127], v[144:147], v[48:51], 0
    v_mfma_f32_32x32x16_bf16 v[128:143], v[144:147], v[52:55], 0
    v_mfma_f32_32x32x16_bf16 v[112:127], v[148:151], v[56:59], v[112:127]
    v_mfma_f32_32x32x16_bf16 v[128:143], v[148:151], v[60:63], v[128:143]
    v_mfma_f32_32x32x16_bf16 v[112:127], v[152:155], v[64:67], v[112:127]
    v_mfma_f32_32x32x16_bf16 v[128:143], v[152:155], v[68:71], v[128:143]
    v_mfma_f32_32x32x16_bf16 v[112:127], v[156:159], v[72:75], v[112:127]
    v_mfma_f32_32x32x16_bf16 v[128:143], v[156:159], v[76:79], v[128:143]
    v_mfma_f32_32x32x16_bf16 v[112:127], v[160:163], v[80:83], v[112:127]
    v_mfma_f32_32x32x16_bf16 v[128:143], v[160:163], v[84:87], v[128:143]
    v_mfma_f32_32x32x16_bf16 v[112:127], v[164:167], v[88:91], v[112:127]
    v_mfma_f32_32x32x16_bf16 v[128:143], v[164:167], v[92:95], v[128:143]
    v_mfma_f32_32x32x16_bf16 v[112:127], v[168:171], v[96:99], v[112:127]
    v_mfma_f32_32x32x16_bf16 v[128:143], v[168:171], v[100:103], v[128:143]
    v_mfma_f32_32x32x16_bf16 v[112:127], v[172:175], v[104:107], v[112:127]
    v_mfma_f32_32x32x16_bf16 v[128:143], v[172:175], v[108:111], v[128:143]
    s_nop 7
    s_nop 7
    v_max3_f32 v244, v244, v112, v113
    v_max3_f32 v244, v244, v114, v115
    v_max3_f32 v244, v244, v116, v117
    v_max3_f32 v244, v244, v118, v119
    v_max3_f32 v244, v244, v120, v121
    v_max3_f32 v244, v244, v122, v123
    v_max3_f32 v244, v244, v124, v125
    v_max3_f32 v244, v244, v126, v127
    v_max3_f32 v245, v245, v128, v129
    v_max3_f32 v245, v245, v130, v131
    v_max3_f32 v245, v245, v132, v133
    v_max3_f32 v245, v245, v134, v135
    v_max3_f32 v245, v245, v136, v137
    v_max3_f32 v245, v245, v138, v139
    v_max3_f32 v245, v245, v140, v141
    v_max3_f32 v245, v245, v142, v143
    s_add_u32 s89, s89, 8192
    s_cmp_lt_u32 s89, 0x20000
    s_cbranch_scc1 km_fb1
    v_mov_b32 v246, v244
    v_mov_b32 v247, v245
    s_nop 1
    v_permlane32_swap_b32 v244, v246
    v_permlane32_swap_b32 v245, v247
    s_nop 0
    v_max_f32 v244, v244, v246
    v_max_f32 v245, v245, v247
    v_sub_f32 v176, 0, v244
    v_sub_f32 v177, 0, v244
    v_sub_f32 v192, 0, v245
    v_sub_f32 v193, 0, v245
    v_mov_b64 v[178:179], v[176:177]
    v_mov_b64 v[180:181], v[176:177]
    v_mov_b64 v[182:183], v[176:177]
    v_mov_b64 v[184:185], v[176:177]
    v_mov_b64 v[186:187], v[176:177]
    v_mov_b64 v[188:189], v[176:177]
    v_mov_b64 v[190:191], v[176:177]
    v_mov_b64 v[194:195], v[192:193]
    v_mov_b64 v[196:197], v[192:193]
    v_mov_b64 v[198:199], v[192:193]
    v_mov_b64 v[200:201], v[192:193]
    v_mov_b64 v[202:203], v[192:193]
    v_mov_b64 v[204:205], v[192:193]
    v_mov_b64 v[206:207], v[192:193]
    v_mov_b32 v240, 0
    v_mov_b32 v241, 0
    v_mov_b32 v242, 0
    v_mov_b32 v243, 0
    v_accvgpr_write_b32 a0, 0
    v_accvgpr_write_b32 a1, 0
    v_accvgpr_write_b32 a2, 0
    v_accvgpr_write_b32 a3, 0
    v_accvgpr_write_b32 a4, 0
    v_accvgpr_write_b32 a5, 0
    v_accvgpr_write_b32 a6, 0
    v_accvgpr_write_b32 a7, 0
    v_accvgpr_write_b32 a8, 0
    v_accvgpr_write_b32 a9, 0
    v_accvgpr_write_b32 a10, 0
    v_accvgpr_write_b32 a11, 0
    v_accvgpr_write_b32 a12, 0
    v_accvgpr_write_b32 a13, 0
    v_accvgpr_write_b32 a14, 0
    v_accvgpr_write_b32 a15, 0
    v_accvgpr_write_b32 a16, 0
    v_accvgpr_write_b32 a17, 0
    v_accvgpr_write_b32 a18, 0
    v_accvgpr_write_b32 a19, 0
    v_accvgpr_write_b32 a20, 0
    v_accvgpr_write_b32 a21, 0
    v_accvgpr_write_b32 a22, 0
    v_accvgpr_write_b32 a23, 0
    v_accvgpr_write_b32 a24, 0
    v_accvgpr_write_b32 a25, 0
    v_accvgpr_write_b32 a26, 0
    v_accvgpr_write_b32 a27, 0
    v_accvgpr_write_b32 a28, 0
    v_accvgpr_write_b32 a29, 0
    v_accvgpr_write_b32 a30, 0
    v_accvgpr_write_b32 a31, 0
    v_accvgpr_write_b32 a32, 0
    v_accvgpr_write_b32 a33, 0
    v_accvgpr_write_b32 a34, 0
    v_accvgpr_write_b32 a35, 0
    v_accvgpr_write_b32 a36, 0
    v_accvgpr_write_b32 a37, 0
    v_accvgpr_write_b32 a38, 0
    v_accvgpr_write_b32 a39, 0
    v_accvgpr_write_b32 a40, 0
    v_accvgpr_write_b32 a41, 0
    v_accvgpr_write_b32 a42, 0
    v_accvgpr_write_b32 a43, 0
    v_accvgpr_write_b32 a44, 0
    v_accvgpr_write_b32 a45, 0
    v_accvgpr_write_b32 a46, 0
    v_accvgpr_write_b32 a47, 0
    v_accvgpr_write_b32 a48, 0
    v_accvgpr_write_b32 a49, 0
    v_accvgpr_write_b32 a50, 0
    v_accvgpr_write_b32 a51, 0
    v_accvgpr_write_b32 a52, 0
    v_accvgpr_write_b32 a53, 0
    v_accvgpr_write_b32 a54, 0
    v_accvgpr_write_b32 a55, 0
    v_accvgpr_write_b32 a56, 0
    v_accvgpr_write_b32 a57, 0
    v_accvgpr_write_b32 a58, 0
    v_accvgpr_write_b32 a59, 0
    v_accvgpr_write_b32 a60, 0
    v_accvgpr_write_b32 a61, 0
    v_accvgpr_write_b32 a62, 0
    v_accvgpr_write_b32 a63, 0
    v_accvgpr_write_b32 a64, 0
    v_accvgpr_write_b32 a65, 0
    v_accvgpr_write_b32 a66, 0
    v_accvgpr_write_b32 a67, 0
    v_accvgpr_write_b32 a68, 0
    v_accvgpr_write_b32 a69, 0
    v_accvgpr_write_b32 a70, 0
    v_accvgpr_write_b32 a71, 0
    v_accvgpr_write_b32 a72, 0
    v_accvgpr_write_b32 a73, 0
    v_accvgpr_write_b32 a74, 0
    v_accvgpr_write_b32 a75, 0
    v_accvgpr_write_b32 a76, 0
    v_accvgpr_write_b32 a77, 0
    v_accvgpr_write_b32 a78, 0
    v_accvgpr_write_b32 a79, 0
    v_accvgpr_write_b32 a80, 0
    v_accvgpr_write_b32 a81, 0
    v_accvgpr_write_b32 a82, 0
    v_accvgpr_write_b32 a83, 0
    v_accvgpr_write_b32 a84, 0
    v_accvgpr_write_b32 a85, 0
    v_accvgpr_write_b32 a86, 0
    v_accvgpr_write_b32 a87, 0
    v_accvgpr_write_b32 a88, 0
    v_accvgpr_write_b32 a89, 0
    v_accvgpr_write_b32 a90, 0
    v_accvgpr_write_b32 a91, 0
    v_accvgpr_write_b32 a92, 0
    v_accvgpr_write_b32 a93, 0
    v_accvgpr_write_b32 a94, 0
    v_accvgpr_write_b32 a95, 0
    v_accvgpr_write_b32 a96, 0
    v_accvgpr_write_b32 a97, 0
    v_accvgpr_write_b32 a98, 0
    v_accvgpr_write_b32 a99, 0
    v_accvgpr_write_b32 a100, 0
    v_accvgpr_write_b32 a101, 0
    v_accvgpr_write_b32 a102, 0
    v_accvgpr_write_b32 a103, 0
    v_accvgpr_write_b32 a104, 0
    v_accvgpr_write_b32 a105, 0
    v_accvgpr_write_b32 a106, 0
    v_accvgpr_write_b32 a107, 0
    v_accvgpr_write_b32 a108, 0
    v_accvgpr_write_b32 a109, 0
    v_accvgpr_write_b32 a110, 0
    v_accvgpr_write_b32 a111, 0
    v_accvgpr_write_b32 a112, 0
    v_accvgpr_write_b32 a113, 0
    v_accvgpr_write_b32 a114, 0
    v_accvgpr_write_b32 a115, 0
    v_accvgpr_write_b32 a116, 0
    v_accvgpr_write_b32 a117, 0
    v_accvgpr_write_b32 a118, 0
    v_accvgpr_write_b32 a119, 0
    v_accvgpr_write_b32 a120, 0
    v_accvgpr_write_b32 a121, 0
    v_accvgpr_write_b32 a122, 0
    v_accvgpr_write_b32 a123, 0
    v_accvgpr_write_b32 a124, 0
    v_accvgpr_write_b32 a125, 0
    v_accvgpr_write_b32 a126, 0
    v_accvgpr_write_b32 a127, 0
    s_mov_b32 s89, 0
km_fb2:
    s_add_u32 m0, s88, 0
    s_add_u32 s86, s89, 0
    buffer_load_dwordx4 v20, s[16:19], s86 offen offset:0 lds
    buffer_load_dwordx4 v21, s[16:19], s86 offen offset:1024 lds
    buffer_load_dwordx4 v22, s[16:19], s86 offen offset:2048 lds
    buffer_load_dwordx4 v23, s[16:19], s86 offen offset:3072 lds
    s_add_u32 m0, s88, 4096
    s_add_u32 s86, s89, 4096
    buffer_load_dwordx4 v20, s[16:19], s86 offen offset:0 lds
    buffer_load_dwordx4 v21, s[16:19], s86 offen offset:1024 lds
    buffer_load_dwordx4 v22, s[16:19], s86 offen offset:2048 lds
    buffer_load_dwordx4 v23, s[16:19], s86 offen offset:3072 lds
    s_waitcnt vmcnt(0)
    ds_read_b128 v[144:147], v224
    ds_read_b128 v[148:151], v225
    ds_read_b128 v[152:155], v226
    ds_read_b128 v[156:159], v227
    ds_read_b128 v[160:163], v228
    ds_read_b128 v[164:167], v229
    ds_read_b128 v[168:171], v230
    ds_read_b128 v[172:175], v231
    s_waitcnt lgkmcnt(0)
    s_add_u32 m0, s88, 0
    s_add_u32 s86, s89, 0
    buffer_load_dwordx4 v24, s[20:23], s86 offen offset:0 lds
    buffer_load_dwordx4 v24, s[20:23], s86 offen offset:1024 lds
    buffer_load_dwordx4 v24, s[20:23], s86 offen offset:2048 lds
    buffer_load_dwordx4 v24, s[20:23], s86 offen offset:3072 lds
    s_add_u32 m0, s88, 4096
    s_add_u32 s86, s89, 4096
    buffer_load_dwordx4 v24, s[20:23], s86 offen offset:0 lds
    buffer_load_dwordx4 v24, s[20:23], s86 offen offset:1024 lds
    buffer_load_dwordx4 v24, s[20:23], s86 offen offset:2048 lds
    buffer_load_dwordx4 v24, s[20:23], s86 offen offset:3072 lds
    v_mfma_f32_32x32x16_bf16 v[112:127], v[144:147], v[48:51], v[176:191]
    v_mfma_f32_32x32x16_bf16 v[128:143], v[144:147], v[52:55], v[192:207]
    v_mfma_f32_32x32x16_bf16 v[112:127], v[148:151], v[56:59], v[112:127]
    v_mfma_f32_32x32x16_bf16 v[128:143], v[148:151], v[60:63], v[128:143]
    v_mfma_f32_32x32x16_bf16 v[112:127], v[152:155], v[64:67], v[112:127]
    v_mfma_f32_32x32x16_bf16 v[128:143], v[152:155], v[68:71], v[128:143]
    v_mfma_f32_32x32x16_bf16 v[112:127], v[156:159], v[72:75], v[112:127]
    v_mfma_f32_32x32x16_bf16 v[128:143], v[156:159], v[76:79], v[128:143]
    v_mfma_f32_32x32x16_bf16 v[112:127], v[160:163], v[80:83], v[112:127]
    v_mfma_f32_32x32x16_bf16 v[128:143], v[160:163], v[84:87], v[128:143]
    v_mfma_f32_32x32x16_bf16 v[112:127], v[164:167], v[88:91], v[112:127]
    v_mfma_f32_32x32x16_bf16 v[128:143], v[164:167], v[92:95], v[128:143]
    v_mfma_f32_32x32x16_bf16 v[112:127], v[168:171], v[96:99], v[112:127]
    v_mfma_f32_32x32x16_bf16 v[128:143], v[168:171], v[100:103], v[128:143]
    v_mfma_f32_32x32x16_bf16 v[112:127], v[172:175], v[104:107], v[112:127]
    v_mfma_f32_32x32x16_bf16 v[128:143], v[172:175], v[108:111], v[128:143]
    s_nop 7
    s_nop 7
    v_exp_f32 v112, v112
    v_exp_f32 v113, v113
    v_exp_f32 v114, v114
    v_exp_f32 v115, v115
    v_add_f32 v240, v240, v112
    v_add_f32 v241, v241, v113
    v_cvt_pk_bf16_f32 v208, v112, v113
    v_exp_f32 v116, v116
    v_exp_f32 v117, v117
    v_add_f32 v240, v240, v114
    v_add_f32 v241, v241, v115
    v_cvt_pk_bf16_f32 v209, v114, v115
    v_exp_f32 v118, v118
    v_exp_f32 v119, v119
    v_add_f32 v240, v240, v116
    v_add_f32 v241, v241, v117
    v_cvt_pk_bf16_f32 v210, v116, v117
    v_exp_f32 v120, v120
    v_exp_f32 v121, v121
    v_add_f32 v240, v240, v118
    v_add_f32 v241, v241, v119
    v_cvt_pk_bf16_f32 v211, v118, v119
    v_exp_f32 v122, v122
    v_exp_f32 v123, v123
    v_add_f32 v240, v240, v120
    v_add_f32 v241, v241, v121
    v_cvt_pk_bf16_f32 v212, v120, v121
    v_exp_f32 v124, v124
    v_exp_f32 v125, v125
    v_add_f32 v240, v240, v122
    v_add_f32 v241, v241, v123
    v_cvt_pk_bf16_f32 v213, v122, v123
    v_exp_f32 v126, v126
    v_exp_f32 v127, v127
    v_add_f32 v240, v240, v124
    v_add_f32 v241, v241, v125
    v_cvt_pk_bf16_f32 v214, v124, v125
    v_exp_f32 v128, v128
    v_exp_f32 v129, v129
    v_add_f32 v240, v240, v126
    v_add_f32 v241, v241, v127
    v_cvt_pk_bf16_f32 v215, v126, v127
    v_exp_f32 v130, v130
    v_exp_f32 v131, v131
    v_add_f32 v242, v242, v128
    v_add_f32 v243, v243, v129
    v_cvt_pk_bf16_f32 v216, v128, v129
    v_exp_f32 v132, v132
    v_exp_f32 v133, v133
    v_add_f32 v242, v242, v130
    v_add_f32 v243, v243, v131
    v_cvt_pk_bf16_f32 v217, v130, v131
    v_exp_f32 v134, v134
    v_exp_f32 v135, v135
    v_add_f32 v242, v242, v132
    v_add_f32 v243, v243, v133
    v_cvt_pk_bf16_f32 v218, v132, v133
    v_exp_f32 v136, v136
    v_exp_f32 v137, v137
    v_add_f32 v242, v242, v134
    v_add_f32 v243, v243, v135
    v_cvt_pk_bf16_f32 v219, v134, v135
    v_exp_f32 v138, v138
    v_exp_f32 v139, v139
    v_add_f32 v242, v242, v136
    v_add_f32 v243, v243, v137
    v_cvt_pk_bf16_f32 v220, v136, v137
    v_exp_f32 v140, v140
    v_exp_f32 v141, v141
    v_add_f32 v242, v242, v138
    v_add_f32 v243, v243, v139
    v_cvt_pk_bf16_f32 v221, v138, v139
    v_exp_f32 v142, v142
    v_exp_f32 v143, v143
    v_add_f32 v242, v242, v140
    v_add_f32 v243, v243, v141
    v_cvt_pk_bf16_f32 v222, v140, v141
    s_nop 0
    v_add_f32 v242, v242, v142
    v_add_f32 v243, v243, v143
    v_cvt_pk_bf16_f32 v223, v142, v143
    s_waitcnt vmcnt(0)
    ds_read_b64_tr_b16 v[144:145], v232 offset:0
    ds_read_b64_tr_b16 v[146:147], v232 offset:2048
    ds_read_b64_tr_b16 v[148:149], v233 offset:0
    ds_read_b64_tr_b16 v[150:151], v233 offset:2048
    ds_read_b64_tr_b16 v[152:153], v234 offset:0
    ds_read_b64_tr_b16 v[154:155], v234 offset:2048
    ds_read_b64_tr_b16 v[156:157], v235 offset:0
    ds_read_b64_tr_b16 v[158:159], v235 offset:2048
    ds_read_b64_tr_b16 v[160:161], v232 offset:4096
    ds_read_b64_tr_b16 v[162:163], v232 offset:6144
    ds_read_b64_tr_b16 v[164:165], v233 offset:4096
    ds_read_b64_tr_b16 v[166:167], v233 offset:6144
    ds_read_b64_tr_b16 v[168:169], v234 offset:4096
    ds_read_b64_tr_b16 v[170:171], v234 offset:6144
    ds_read_b64_tr_b16 v[172:173], v235 offset:4096
    ds_read_b64_tr_b16 v[174:175], v235 offset:6144
    s_waitcnt lgkmcnt(0)
    v_mfma_f32_32x32x16_bf16 a[0:15], v[144:147], v[208:211], a[0:15]
    v_mfma_f32_32x32x16_bf16 a[16:31], v[144:147], v[216:219], a[16:31]
    v_mfma_f32_32x32x16_bf16 a[32:47], v[148:151], v[208:211], a[32:47]
    v_mfma_f32_32x32x16_bf16 a[48:63], v[148:151], v[216:219], a[48:63]
    v_mfma_f32_32x32x16_bf16 a[64:79], v[152:155], v[208:211], a[64:79]
    v_mfma_f32_32x32x16_bf16 a[80:95], v[152:155], v[216:219], a[80:95]
    v_mfma_f32_32x32x16_bf16 a[96:111], v[156:159], v[208:211], a[96:111]
    v_mfma_f32_32x32x16_bf16 a[112:127], v[156:159], v[216:219], a[112:127]
    v_mfma_f32_32x32x16_bf16 a[0:15], v[160:163], v[212:215], a[0:15]
    v_mfma_f32_32x32x16_bf16 a[16:31], v[160:163], v[220:223], a[16:31]
    v_mfma_f32_32x32x16_bf16 a[32:47], v[164:167], v[212:215], a[32:47]
    v_mfma_f32_32x32x16_bf16 a[48:63], v[164:167], v[220:223], a[48:63]
    v_mfma_f32_32x32x16_bf16 a[64:79], v[168:171], v[212:215], a[64:79]
    v_mfma_f32_32x32x16_bf16 a[80:95], v[168:171], v[220:223], a[80:95]
    v_mfma_f32_32x32x16_bf16 a[96:111], v[172:175], v[212:215], a[96:111]
    v_mfma_f32_32x32x16_bf16 a[112:127], v[172:175], v[220:223], a[112:127]
    s_add_u32 s89, s89, 8192
    s_cmp_lt_u32 s89, 0x20000
    s_cbranch_scc1 km_fb2
    ds_read_b64_tr_b16 v[48:49], v40 offset:32768
    ds_read_b64_tr_b16 v[50:51], v40 offset:36864
    ds_read_b64_tr_b16 v[52:53], v41 offset:32768
    ds_read_b64_tr_b16 v[54:55], v41 offset:36864
    ds_read_b64_tr_b16 v[56:57], v42 offset:32768
    ds_read_b64_tr_b16 v[58:59], v42 offset:36864
    ds_read_b64_tr_b16 v[60:61], v43 offset:32768
    ds_read_b64_tr_b16 v[62:63], v43 offset:36864
    ds_read_b64_tr_b16 v[64:65], v44 offset:32768
    ds_read_b64_tr_b16 v[66:67], v44 offset:36864
    ds_read_b64_tr_b16 v[68:69], v45 offset:32768
    ds_read_b64_tr_b16 v[70:71], v45 offset:36864
    ds_read_b64_tr_b16 v[72:73], v46 offset:32768
    ds_read_b64_tr_b16 v[74:75], v46 offset:36864
    ds_read_b64_tr_b16 v[76:77], v47 offset:32768
    ds_read_b64_tr_b16 v[78:79], v47 offset:36864
    s_waitcnt lgkmcnt(0)
    s_cmp_eq_u32 s3, 0
    s_cbranch_scc1 kms_aend
    s_branch kmy_aend
km_codeend:
.section .rodata,"a"
.p2align 6
.amdhsa_kernel recurrent_scan__sliding_block_cached__mixer_token_mlp__prompt_kernel
  .amdhsa_next_free_vgpr 512
  .amdhsa_next_free_sgpr 102
  .amdhsa_accum_offset 256
  .amdhsa_group_segment_fixed_size 0
  .amdhsa_kernarg_size 104
  .amdhsa_user_sgpr_count 2
  .amdhsa_user_sgpr_kernarg_segment_ptr 1
  .amdhsa_system_sgpr_workgroup_id_x 1
  .amdhsa_float_denorm_mode_32 3
.end_amdhsa_kernel
```
